```python
import torch

def _softmax(x, axis=-1):
    return torch.softmax(x, dim=axis)

def _gelu(x):
    return torch.nn.functional.gelu(x, approximate='tanh')

def _silu(x):
    return torch.nn.functional.silu(x)

def _sigmoid(x):
    return torch.sigmoid(x)

def _layernorm(x, axis=-1, eps=1e-05):
    m = x.mean(dim=axis, keepdim=True)
    v = x.var(dim=axis, keepdim=True, unbiased=False)
    return (x - m) / torch.sqrt(v + eps)

def _scatter_add(tgt, idx, src, axis=0):
    return tgt.clone().index_add_(axis, idx, src)

def _segment_sum(src, seg, n):
    out = torch.zeros((n,) + src.shape[1:], dtype=src.dtype)
    return out.index_add_(0, seg, src)

def _pad(x, pw):
    flat = tuple((v for pair in reversed(pw) for v in pair))
    return torch.nn.functional.pad(x, flat)
kernel_name = 'standalone__swin_window_attn__vision'

def setup_inputs():

    _w = lambda a: (lambda t: t.to(torch.bfloat16) if t.is_floating_point() else t)(torch.as_tensor(a))
    H = W = 512 // 8 * 8
    C, win = (192, 8)
    return {'x': _w((lambda *s: torch.randn(*s, dtype=torch.bfloat16) * 0.2)(1, H, W, C)), 'wqkv': _w((lambda *s: torch.randn(*s, dtype=torch.bfloat16) * 0.2)(C, 3 * C)), 'wo': _w((lambda *s: torch.randn(*s, dtype=torch.bfloat16) * 0.05)(C, C))}

def reference(x, wqkv, wo):
    B, H, W, C = x.shape
    win = 8
    nh, nw = (H // win, W // win)
    xw = (lambda x, *d: x.permute(*d))(x.reshape(B, nh, win, nw, win, C), 0, 1, 3, 2, 4, 5)
    xw = xw.reshape(B * nh * nw, win * win, C)
    qkv = xw @ wqkv
    q, k, v = (qkv[..., :C].clone(), qkv[..., C:2 * C].clone(), qkv[..., 2 * C:].clone())
    scale = C ** (-0.5)
    p = _softmax(torch.einsum('bqc,bkc->bqk', q, k) * scale, axis=-1)
    o = torch.einsum('bqk,bkc->bqc', p, v) @ wo
    o = (lambda x, *d: x.permute(*d))(o.reshape(B, nh, nw, win, win, C), 0, 1, 3, 2, 4, 5)
    return o.reshape(B, H, W, C)
```

```asm
; @launch grid=(256,1,1) block=(256,1,1) lds=163840
.amdgcn_target "amdgcn-amd-amdhsa--gfx950"
.text
.globl standalone__swin_window_attn__vision_kernel
.p2align 8
.type standalone__swin_window_attn__vision_kernel,@function
standalone__swin_window_attn__vision_kernel:
    s_cmp_ge_u32 s2, 256
    s_cbranch_scc1 L_end
    s_load_dwordx4 s[4:7], s[0:1], 0
    s_load_dwordx4 s[20:23], s[0:1], 16
    s_load_dwordx4 s[56:59], s[0:1], 32
    v_lshrrev_b32 v16, 6, v0
    v_and_b32 v0, 63, v0
    s_getpc_b64 s[44:45]
L_pc_ref:
    v_readfirstlane_b32 s49, v16
    s_mov_b32 s46, L_code_end-L_pc_ref
    s_mov_b32 s47, 0x00020000
    v_lshlrev_b32 v7, 6, v0
    s_lshr_b32 s60, s2, 3
    s_and_b32 s42, s60, 3
    s_lshl_b32 s42, s42, 2
    s_add_u32 s42, s42, s49
    s_lshl_b32 s42, s42, 12
    buffer_load_dword v8, v7, s[44:47], s42 offen
    s_cmp_lt_u32 s60, 24
    s_cbranch_scc0 L_setup
    s_cmp_ge_u32 s60, 12
    s_cselect_b32 s61, 12, 0
    s_cselect_b32 s62, 36, 0
    s_sub_u32 s61, s60, s61
    s_and_b32 s64, s61, 1
    s_mul_i32 s64, s64, 3
    s_max_u32 s65, s49, 1
    s_add_u32 s64, s64, s65
    s_sub_u32 s64, s64, 1
    s_mul_i32 s64, s64, 6
    s_lshr_b32 s61, s61, 1
    s_add_u32 s60, s64, s61
    s_add_u32 s60, s60, s62
    s_cmp_eq_u32 s49, 0
    s_cselect_b32 s63, 2, 0
L_raw:
    s_cmp_ge_u32 s60, 36
    s_cselect_b32 s65, 36, 0
    s_cselect_b32 s97, 768, 0
    s_sub_u32 s65, s60, s65
    s_mul_i32 s66, s65, 43
    s_lshr_b32 s66, s66, 8
    s_mul_i32 s67, s66, 6
    s_sub_u32 s67, s65, s67
    s_max_u32 s64, s49, 1
    s_mul_i32 s64, s64, 12288
    s_mul_i32 s61, s66, 36864
    s_add_u32 s61, s61, 384
    s_mul_i32 s62, s67, 36864
    s_add_u32 s62, s62, s97
    s_bitcmp1_b32 s63, 1
    s_cselect_b32 s61, s62, s61
    s_cselect_b32 s64, 0, s64
    s_cselect_b32 s97, 0, s97
    s_movk_i32 s62, 128
    s_movk_i32 s65, 9216
    s_mov_b32 s96, 32
    v_lshrrev_b32 v16, 3, v0
    v_and_b32 v17, 7, v0
    v_bfe_u32 v18, v0, 4, 1
    v_xor_b32 v17, v17, v18
    v_lshlrev_b32 v17, 4, v17
    v_mul_u32_u24 v16, 1152, v16
    s_cmp_eq_u32 s97, 0
    s_mov_b32 s18, 221184
    s_cbranch_scc1 L_raw_rows
    s_mov_b32 s18, 73728
    s_lshl_b32 s61, s66, 6
    s_movk_i32 s62, 6144
    s_movk_i32 s65, 18432
    s_mov_b32 s96, 0
    v_lshrrev_b32 v16, 2, v0
    v_mul_u32_u24 v16, 384, v16
    v_and_b32 v17, 3, v0
    v_lshlrev_b32 v17, 4, v17
L_raw_rows:
    s_waitcnt lgkmcnt(0)
    s_cmp_eq_u32 s97, 0
    s_cselect_b32 s16, s6, s20
    s_cselect_b32 s17, s7, s21
    s_mov_b32 s19, 0x00020000
    s_mov_b32 m0, s64
    s_mov_b32 s97, 4
L_raw_lp:
    v_add_u32 v18, v16, v17
    s_add_u32 s42, s61, s62
    buffer_load_dwordx4 v18, s[16:19], s61 offen lds
    s_add_u32 m0, m0, 1024
    s_add_u32 s41, s42, s62
    buffer_load_dwordx4 v18, s[16:19], s42 offen lds
    s_add_u32 m0, m0, 1024
    s_add_u32 s61, s61, s65
    buffer_load_dwordx4 v18, s[16:19], s41 offen lds
    s_add_u32 m0, m0, 1024
    s_and_b32 s42, s97, 1
    s_mul_i32 s42, s42, s96
    s_lshl_b32 s42, s42, 1
    s_add_u32 s42, s42, s96
    v_xor_b32 v17, s42, v17
    s_sub_u32 s97, s97, 1
    s_cmp_lg_u32 s97, 0
    s_cbranch_scc1 L_raw_lp
    s_bitcmp1_b32 s63, 0
    s_cbranch_scc1 L_fb_raw
L_setup:
    s_mov_b32 s43, 0x400000
    v_lshlrev_b32 v1, 4, v0
    v_add_u32 v2, 0x10000, v1
    v_add_u32 v3, 0x20000, v1
    s_nop 1
    v_and_b32 v16, 15, v0
    v_lshrrev_b32 v17, 3, v16
    v_mul_u32_u24 v17, 196608, v17
    v_and_b32 v18, 7, v16
    v_mul_u32_u24 v18, 384, v18
    v_lshrrev_b32 v16, 4, v0
    v_lshlrev_b32 v16, 4, v16
    v_add3_u32 v9, v16, v17, v18
    s_lshl_b32 s52, s49, 12
    s_cmp_eq_u32 s49, 3
    s_cselect_b32 s52, 0, s52
    s_add_u32 s52, s52, 147456
    v_add_u32 v4, s52, v1
    v_and_b32 v16, 15, v0
    v_lshrrev_b32 v17, 4, v0
    v_and_b32 v18, 7, v16
    v_xor_b32 v18, v18, v17
    v_lshlrev_b32 v18, 4, v18
    v_lshl_add_u32 v18, v16, 7, v18
    v_add_u32 v5, s52, v18
    v_xor_b32 v6, 64, v5
    v_lshrrev_b32 v16, 3, v0
    v_and_b32 v17, 7, v0
    v_xor_b32 v17, v17, v16
    v_lshlrev_b32 v17, 4, v17
    v_mul_u32_u24 v16, 384, v16
    v_add_u32 v10, v16, v17
    v_lshrrev_b32 v16, 5, v0
    v_mul_u32_u24 v16, 196608, v16
    v_lshrrev_b32 v17, 4, v0
    v_and_b32 v17, 1, v17
    v_mul_u32_u24 v17, 1536, v17
    v_and_b32 v18, 15, v0
    v_lshlrev_b32 v18, 3, v18
    v_add3_u32 v11, v16, v17, v18
    s_lshr_b32 s53, s2, 4
    s_mul_i32 s53, s53, 1572864
    s_and_b32 s54, s2, 15
    s_lshl_b32 s54, s54, 2
    s_add_u32 s54, s54, s49
    s_mul_i32 s54, s54, 3072
    s_add_u32 s53, s53, s54
    s_add_u32 s24, s53, 0
    s_add_u32 s32, s53, 0
    s_add_u32 s25, s53, 196608
    s_add_u32 s33, s53, 196608
    s_add_u32 s26, s53, 393216
    s_add_u32 s34, s53, 393216
    s_add_u32 s27, s53, 589824
    s_add_u32 s35, s53, 589824
    s_add_u32 s28, s53, 786432
    s_add_u32 s36, s53, 786432
    s_add_u32 s29, s53, 983040
    s_add_u32 s37, s53, 983040
    s_add_u32 s30, s53, 1179648
    s_add_u32 s38, s53, 1179648
    s_add_u32 s31, s53, 1376256
    s_add_u32 s39, s53, 1376256
    v_mov_b32 v29, 159744
    v_mov_b32 v30, 0
    v_mov_b32 v31, 0
    ds_write_b64 v29, v[30:31]
    s_getreg_b32 s48, hwreg(HW_REG_XCC_ID, 0, 3)
    s_waitcnt lgkmcnt(0)
    s_barrier
    s_mov_b32 s8, s4
    s_mov_b32 s9, s5
    s_mov_b32 s10, 100663296
    s_mov_b32 s11, 0x00020000
    s_mov_b32 s12, s22
    s_mov_b32 s13, s23
    s_mov_b32 s14, 100663296
    s_mov_b32 s15, 0x00020000
    s_mov_b32 s40, 0x3dd53b95
    s_mov_b32 s50, s58
    s_mov_b32 s51, s59
    s_mov_b32 s58, 256
    s_mov_b32 s59, 0x00020000
    s_mul_i32 s52, s48, 147456
    s_add_u32 s52, s50, s52
    s_addc_u32 s53, s51, 0
    s_mov_b32 s54, 147456
    s_mov_b32 s55, 0x00020000
    s_lshl_b32 s48, s48, 5
    s_cmp_eq_u32 s49, 0
    s_cbranch_scc1 L_stream
    s_cmp_lt_u32 s2, 192
    s_cbranch_scc0 L_noprod
L_prod:
    s_mul_i32 s61, s66, 12
    s_add_u32 s61, s61, s67
    s_lshl_b32 s61, s61, 10
    s_add_u32 s62, s61, 6144
    v_mov_b32 v27, v1
    v_bfe_u32 v22, v0, 2, 2
    v_and_b32 v23, 3, v0
    v_lshrrev_b32 v26, 4, v0
    s_cmp_ge_u32 s60, 36
    s_cbranch_scc0 L_prod_A
    v_mul_u32_u24 v27, 6144, v23
    v_lshlrev_b32 v24, 8, v26
    v_lshlrev_b32 v25, 4, v22
    v_add3_u32 v27, v27, v24, v25
    s_lshr_b32 s61, s66, 1
    s_mul_i32 s61, s61, 24576
    s_and_b32 s62, s66, 1
    s_lshl_b32 s62, s62, 7
    s_add_u32 s61, s61, s62
    s_lshl_b32 s62, s67, 10
    s_add_u32 s61, s61, s62
    s_add_u32 s61, s61, 73728
    s_add_u32 s62, s61, 64
L_prod_A:
    v_mul_u32_u24 v24, 3072, v22
    v_lshl_add_u32 v24, v23, 7, v24
    v_bfe_u32 v25, v0, 1, 1
    v_lshl_add_u32 v25, v22, 1, v25
    v_xor_b32 v25, v25, v26
    v_lshl_add_u32 v24, v25, 4, v24
    v_xor_b32 v25, 64, v24
    v_lshl_add_u32 v26, v26, 3, v22
    v_lshlrev_b32 v26, 6, v26
    v_lshl_add_u32 v26, v23, 3, v26
    v_add_u32 v26, s64, v26
    s_waitcnt vmcnt(0)
    s_bitcmp1_b32 s63, 0
    s_cbranch_scc1 L_gotA
L_wA:
    s_sub_u32 s43, s43, 1
    s_cbranch_scc1 L_end
    ds_read_b32 v30, v29
    s_waitcnt lgkmcnt(0)
    v_readfirstlane_b32 s41, v30
    s_nop 1
    s_and_b32 s42, s41, 0x100000
    s_cmp_eq_u32 s42, 0x100000
    s_cbranch_scc0 L_wA
L_gotA:
    ds_read_b128 v[32:35], v24 offset:0
    ds_read_b128 v[56:59], v24 offset:512
    ds_read_b128 v[36:39], v25 offset:0
    ds_read_b128 v[60:63], v25 offset:512
    ds_read_b128 v[40:43], v24 offset:1024
    ds_read_b128 v[64:67], v24 offset:1536
    ds_read_b128 v[44:47], v25 offset:1024
    ds_read_b128 v[68:71], v25 offset:1536
    ds_read_b128 v[48:51], v24 offset:2048
    ds_read_b128 v[72:75], v24 offset:2560
    ds_read_b128 v[52:55], v25 offset:2048
    ds_read_b128 v[76:79], v25 offset:2560
    s_cmp_ge_u32 s60, 36
    s_cbranch_scc1 L_prod_N2
    v_add_u32 v24, s64, v24
    v_add_u32 v25, s64, v25
    ds_read_b128 v[80:83], v24 offset:0
    ds_read_b128 v[104:107], v24 offset:512
    ds_read_b128 v[84:87], v25 offset:0
    ds_read_b128 v[108:111], v25 offset:512
    ds_read_b128 v[88:91], v24 offset:1024
    ds_read_b128 v[112:115], v24 offset:1536
    ds_read_b128 v[92:95], v25 offset:1024
    ds_read_b128 v[116:119], v25 offset:1536
    ds_read_b128 v[96:99], v24 offset:2048
    ds_read_b128 v[120:123], v24 offset:2560
    ds_read_b128 v[100:103], v25 offset:2048
    ds_read_b128 v[124:127], v25 offset:2560
    s_branch L_prod_mm
L_prod_N2:
    ds_read_b64_tr_b16 v[80:81], v26 offset:0
    ds_read_b64_tr_b16 v[82:83], v26 offset:256
    ds_read_b64_tr_b16 v[104:105], v26 offset:32
    ds_read_b64_tr_b16 v[106:107], v26 offset:288
    ds_read_b64_tr_b16 v[84:85], v26 offset:2048
    ds_read_b64_tr_b16 v[86:87], v26 offset:2304
    ds_read_b64_tr_b16 v[108:109], v26 offset:2080
    ds_read_b64_tr_b16 v[110:111], v26 offset:2336
    ds_read_b64_tr_b16 v[88:89], v26 offset:4096
    ds_read_b64_tr_b16 v[90:91], v26 offset:4352
    ds_read_b64_tr_b16 v[112:113], v26 offset:4128
    ds_read_b64_tr_b16 v[114:115], v26 offset:4384
    ds_read_b64_tr_b16 v[92:93], v26 offset:6144
    ds_read_b64_tr_b16 v[94:95], v26 offset:6400
    ds_read_b64_tr_b16 v[116:117], v26 offset:6176
    ds_read_b64_tr_b16 v[118:119], v26 offset:6432
    ds_read_b64_tr_b16 v[96:97], v26 offset:8192
    ds_read_b64_tr_b16 v[98:99], v26 offset:8448
    ds_read_b64_tr_b16 v[120:121], v26 offset:8224
    ds_read_b64_tr_b16 v[122:123], v26 offset:8480
    ds_read_b64_tr_b16 v[100:101], v26 offset:10240
    ds_read_b64_tr_b16 v[102:103], v26 offset:10496
    ds_read_b64_tr_b16 v[124:125], v26 offset:10272
    ds_read_b64_tr_b16 v[126:127], v26 offset:10528
L_prod_mm:
    s_waitcnt lgkmcnt(0)
    v_mfma_f32_16x16x32_bf16 v[128:131], v[32:35], v[80:83], 0
    v_mfma_f32_16x16x32_bf16 v[132:135], v[56:59], v[80:83], 0
    v_mfma_f32_16x16x32_bf16 v[128:131], v[36:39], v[84:87], v[128:131]
    v_mfma_f32_16x16x32_bf16 v[132:135], v[60:63], v[84:87], v[132:135]
    v_mfma_f32_16x16x32_bf16 v[128:131], v[40:43], v[88:91], v[128:131]
    v_mfma_f32_16x16x32_bf16 v[132:135], v[64:67], v[88:91], v[132:135]
    v_mfma_f32_16x16x32_bf16 v[128:131], v[44:47], v[92:95], v[128:131]
    v_mfma_f32_16x16x32_bf16 v[132:135], v[68:71], v[92:95], v[132:135]
    v_mfma_f32_16x16x32_bf16 v[128:131], v[48:51], v[96:99], v[128:131]
    v_mfma_f32_16x16x32_bf16 v[132:135], v[72:75], v[96:99], v[132:135]
    v_mfma_f32_16x16x32_bf16 v[128:131], v[52:55], v[100:103], v[128:131]
    v_mfma_f32_16x16x32_bf16 v[132:135], v[76:79], v[100:103], v[132:135]
    v_mfma_f32_16x16x32_bf16 v[136:139], v[32:35], v[104:107], 0
    v_mfma_f32_16x16x32_bf16 v[140:143], v[56:59], v[104:107], 0
    v_mfma_f32_16x16x32_bf16 v[136:139], v[36:39], v[108:111], v[136:139]
    v_mfma_f32_16x16x32_bf16 v[140:143], v[60:63], v[108:111], v[140:143]
    v_mfma_f32_16x16x32_bf16 v[136:139], v[40:43], v[112:115], v[136:139]
    v_mfma_f32_16x16x32_bf16 v[140:143], v[64:67], v[112:115], v[140:143]
    v_mfma_f32_16x16x32_bf16 v[136:139], v[44:47], v[116:119], v[136:139]
    v_mfma_f32_16x16x32_bf16 v[140:143], v[68:71], v[116:119], v[140:143]
    v_mfma_f32_16x16x32_bf16 v[136:139], v[48:51], v[120:123], v[136:139]
    v_mfma_f32_16x16x32_bf16 v[140:143], v[72:75], v[120:123], v[140:143]
    v_mfma_f32_16x16x32_bf16 v[136:139], v[52:55], v[124:127], v[136:139]
    v_mfma_f32_16x16x32_bf16 v[140:143], v[76:79], v[124:127], v[140:143]
    v_cvt_pk_bf16_f32 v144, v128, v129
    v_cvt_pk_bf16_f32 v145, v130, v131
    v_cvt_pk_bf16_f32 v146, v132, v133
    v_cvt_pk_bf16_f32 v147, v134, v135
    buffer_store_dwordx4 v[144:147], v27, s[52:55], s61 offen
    s_nop 7
    v_cvt_pk_bf16_f32 v148, v136, v137
    v_cvt_pk_bf16_f32 v149, v138, v139
    v_cvt_pk_bf16_f32 v150, v140, v141
    v_cvt_pk_bf16_f32 v151, v142, v143
    buffer_store_dwordx4 v[148:151], v27, s[52:55], s62 offen
    s_waitcnt vmcnt(0)
    s_bitcmp1_b32 s63, 0
    s_cbranch_scc1 L_fb_next
    v_mov_b32 v32, 1
    s_lshr_b32 s60, s2, 3
    s_add_u32 s60, s60, s48
    v_mov_b32 v33, s60
    s_mov_b64 exec, 1
    ds_add_rtn_u32 v34, v29, v32 offset:4
    s_waitcnt lgkmcnt(0)
    v_readfirstlane_b32 s61, v34
    s_nop 1
    s_cmp_eq_u32 s61, 2
    s_cbranch_scc0 L_notlast
    buffer_store_byte v32, v33, s[56:59], 0 offen
L_notlast:
    s_mov_b64 exec, -1
L_noprod:
    s_lshl_b32 s60, 2048, s49
    s_cmp_eq_u32 s49, 3
    s_cselect_b32 s61, 0x10000, 0
    s_or_b32 s60, s60, s61
    s_cmp_ge_u32 s49, 2
    s_cselect_b32 s61, 0x200000, 0
    s_or_b32 s60, s60, s61
L_wpace:
    s_sub_u32 s43, s43, 1
    s_cbranch_scc1 L_end
    ds_read_b32 v30, v29
    s_waitcnt lgkmcnt(0)
    v_readfirstlane_b32 s41, v30
    s_nop 1
    s_and_b32 s42, s41, s60
    s_cmp_eq_u32 s42, s60
    s_cbranch_scc0 L_wpace
    s_cmp_eq_u32 s49, 1
    s_cbranch_scc1 L_stream
    buffer_load_dwordx4 a[96:99], v10, s[8:11], s24 offen offset:0 nt
    buffer_load_dwordx4 a[100:103], v10, s[8:11], s25 offen offset:0 nt
    buffer_load_dwordx4 a[104:107], v10, s[8:11], s26 offen offset:0 nt
    buffer_load_dwordx4 a[108:111], v10, s[8:11], s27 offen offset:0 nt
    buffer_load_dwordx4 a[112:115], v10, s[8:11], s28 offen offset:0 nt
    buffer_load_dwordx4 a[116:119], v10, s[8:11], s29 offen offset:0 nt
    buffer_load_dwordx4 a[120:123], v10, s[8:11], s30 offen offset:0 nt
    buffer_load_dwordx4 a[124:127], v10, s[8:11], s31 offen offset:0 nt
    buffer_load_dwordx4 a[128:131], v10, s[8:11], s24 offen offset:128 nt
    buffer_load_dwordx4 a[132:135], v10, s[8:11], s25 offen offset:128 nt
    buffer_load_dwordx4 a[136:139], v10, s[8:11], s26 offen offset:128 nt
    buffer_load_dwordx4 a[140:143], v10, s[8:11], s27 offen offset:128 nt
    buffer_load_dwordx4 a[144:147], v10, s[8:11], s28 offen offset:128 nt
    buffer_load_dwordx4 a[148:151], v10, s[8:11], s29 offen offset:128 nt
    buffer_load_dwordx4 a[152:155], v10, s[8:11], s30 offen offset:128 nt
    buffer_load_dwordx4 a[156:159], v10, s[8:11], s31 offen offset:128 nt
    buffer_load_dwordx4 a[160:163], v10, s[8:11], s24 offen offset:256 nt
    buffer_load_dwordx4 a[164:167], v10, s[8:11], s25 offen offset:256 nt
    buffer_load_dwordx4 a[168:171], v10, s[8:11], s26 offen offset:256 nt
    buffer_load_dwordx4 a[172:175], v10, s[8:11], s27 offen offset:256 nt
    buffer_load_dwordx4 a[176:179], v10, s[8:11], s28 offen offset:256 nt
    buffer_load_dwordx4 a[180:183], v10, s[8:11], s29 offen offset:256 nt
    buffer_load_dwordx4 a[184:187], v10, s[8:11], s30 offen offset:256 nt
    buffer_load_dwordx4 a[188:191], v10, s[8:11], s31 offen offset:256 nt
    s_cmp_eq_u32 s49, 3
    s_cbranch_scc1 L_w3
    v_mov_b32 v31, 0x4000
    s_mov_b32 s60, 73728
    v_mov_b32 v23, 64
    v_mov_b32 v24, 128
    s_waitcnt vmcnt(20)
    ds_or_b32 v29, v31
    ds_write_b128 v4, a[96:99] offset:0
    ds_write_b128 v4, a[100:103] offset:1024
    ds_write_b128 v4, a[104:107] offset:2048
    ds_write_b128 v4, a[108:111] offset:3072
    ds_read_b128 a[0:3], v5 offset:0
    ds_read_b128 a[24:27], v5 offset:2048
    ds_read_b128 a[4:7], v6 offset:0
    ds_read_b128 a[28:31], v6 offset:2048
    s_add_u32 s61, s60, 0
    s_mov_b32 m0, s61
    s_nop 0
    buffer_load_dwordx4 v1, s[52:55], s61 offen offset:0 lds
    buffer_load_dwordx4 v1, s[52:55], s61 offen offset:1024 lds
    buffer_load_dwordx4 v1, s[52:55], s61 offen offset:2048 lds
    buffer_load_dwordx4 v1, s[52:55], s61 offen offset:3072 lds
    s_add_u32 s61, s60, 4096
    s_mov_b32 m0, s61
    s_nop 0
    buffer_load_dwordx4 v1, s[52:55], s61 offen offset:0 lds
    buffer_load_dwordx4 v1, s[52:55], s61 offen offset:1024 lds
    buffer_load_dwordx4 v1, s[52:55], s61 offen offset:2048 lds
    buffer_load_dwordx4 v1, s[52:55], s61 offen offset:3072 lds
    s_add_u32 s61, s60, 8192
    s_mov_b32 m0, s61
    s_nop 0
    buffer_load_dwordx4 v1, s[52:55], s61 offen offset:0 lds
    buffer_load_dwordx4 v1, s[52:55], s61 offen offset:1024 lds
    buffer_load_dwordx4 v1, s[52:55], s61 offen offset:2048 lds
    buffer_load_dwordx4 v1, s[52:55], s61 offen offset:3072 lds
    s_waitcnt vmcnt(28)
    ds_write_b128 v4, a[112:115] offset:0
    ds_write_b128 v4, a[116:119] offset:1024
    ds_write_b128 v4, a[120:123] offset:2048
    ds_write_b128 v4, a[124:127] offset:3072
    ds_read_b128 a[48:51], v5 offset:0
    ds_read_b128 a[72:75], v5 offset:2048
    ds_read_b128 a[52:55], v6 offset:0
    ds_read_b128 a[76:79], v6 offset:2048
    s_add_u32 s61, s60, 12288
    s_mov_b32 m0, s61
    s_nop 0
    buffer_load_dwordx4 v1, s[52:55], s61 offen offset:0 lds
    buffer_load_dwordx4 v1, s[52:55], s61 offen offset:1024 lds
    buffer_load_dwordx4 v1, s[52:55], s61 offen offset:2048 lds
    buffer_load_dwordx4 v1, s[52:55], s61 offen offset:3072 lds
    s_add_u32 s61, s60, 16384
    s_mov_b32 m0, s61
    s_nop 0
    buffer_load_dwordx4 v1, s[52:55], s61 offen offset:0 lds
    buffer_load_dwordx4 v1, s[52:55], s61 offen offset:1024 lds
    buffer_load_dwordx4 v1, s[52:55], s61 offen offset:2048 lds
    buffer_load_dwordx4 v1, s[52:55], s61 offen offset:3072 lds
    s_add_u32 s61, s60, 20480
    s_mov_b32 m0, s61
    s_nop 0
    buffer_load_dwordx4 v1, s[52:55], s61 offen offset:0 lds
    buffer_load_dwordx4 v1, s[52:55], s61 offen offset:1024 lds
    buffer_load_dwordx4 v1, s[52:55], s61 offen offset:2048 lds
    buffer_load_dwordx4 v1, s[52:55], s61 offen offset:3072 lds
    s_waitcnt vmcnt(36)
    ds_write_b128 v4, a[128:131] offset:0
    ds_write_b128 v4, a[132:135] offset:1024
    ds_write_b128 v4, a[136:139] offset:2048
    ds_write_b128 v4, a[140:143] offset:3072
    ds_read_b128 a[8:11], v5 offset:0
    ds_read_b128 a[32:35], v5 offset:2048
    ds_read_b128 a[12:15], v6 offset:0
    ds_read_b128 a[36:39], v6 offset:2048
    s_waitcnt vmcnt(32)
    ds_write_b128 v4, a[144:147] offset:0
    ds_write_b128 v4, a[148:151] offset:1024
    ds_write_b128 v4, a[152:155] offset:2048
    ds_write_b128 v4, a[156:159] offset:3072
    ds_read_b128 a[56:59], v5 offset:0
    ds_read_b128 a[80:83], v5 offset:2048
    ds_read_b128 a[60:63], v6 offset:0
    ds_read_b128 a[84:87], v6 offset:2048
    s_waitcnt vmcnt(28)
    ds_write_b128 v4, a[160:163] offset:0
    ds_write_b128 v4, a[164:167] offset:1024
    ds_write_b128 v4, a[168:171] offset:2048
    ds_write_b128 v4, a[172:175] offset:3072
    ds_read_b128 a[16:19], v5 offset:0
    ds_read_b128 a[40:43], v5 offset:2048
    ds_read_b128 a[20:23], v6 offset:0
    ds_read_b128 a[44:47], v6 offset:2048
    s_waitcnt vmcnt(24)
    ds_write_b128 v4, a[176:179] offset:0
    ds_write_b128 v4, a[180:183] offset:1024
    ds_write_b128 v4, a[184:187] offset:2048
    ds_write_b128 v4, a[188:191] offset:3072
    ds_read_b128 a[64:67], v5 offset:0
    ds_read_b128 a[88:91], v5 offset:2048
    ds_read_b128 a[68:71], v6 offset:0
    ds_read_b128 a[92:95], v6 offset:2048
    v_lshlrev_b32 v31, 4, v31
    ds_or_b32 v29, v31
    s_branch L_enter
L_w3:
    v_mov_b32 v31, 0x8000
    s_mov_b32 s60, 98304
    v_mov_b32 v23, 0x300
    v_mov_b32 v24, 0xc00
    s_waitcnt vmcnt(20)
    ds_or_b32 v29, v31
    ds_write_b128 v4, a[96:99] offset:0
    ds_write_b128 v4, a[100:103] offset:1024
    ds_write_b128 v4, a[104:107] offset:2048
    ds_write_b128 v4, a[108:111] offset:3072
    ds_read_b128 a[0:3], v5 offset:0
    ds_read_b128 a[24:27], v5 offset:2048
    ds_read_b128 a[4:7], v6 offset:0
    ds_read_b128 a[28:31], v6 offset:2048
    s_add_u32 s61, s60, 0
    s_mov_b32 m0, s61
    s_nop 0
    buffer_load_dwordx4 v1, s[52:55], s61 offen offset:0 lds
    buffer_load_dwordx4 v1, s[52:55], s61 offen offset:1024 lds
    buffer_load_dwordx4 v1, s[52:55], s61 offen offset:2048 lds
    buffer_load_dwordx4 v1, s[52:55], s61 offen offset:3072 lds
    s_add_u32 s61, s60, 4096
    s_mov_b32 m0, s61
    s_nop 0
    buffer_load_dwordx4 v1, s[52:55], s61 offen offset:0 lds
    buffer_load_dwordx4 v1, s[52:55], s61 offen offset:1024 lds
    buffer_load_dwordx4 v1, s[52:55], s61 offen offset:2048 lds
    buffer_load_dwordx4 v1, s[52:55], s61 offen offset:3072 lds
    s_add_u32 s61, s60, 8192
    s_mov_b32 m0, s61
    s_nop 0
    buffer_load_dwordx4 v1, s[52:55], s61 offen offset:0 lds
    buffer_load_dwordx4 v1, s[52:55], s61 offen offset:1024 lds
    buffer_load_dwordx4 v1, s[52:55], s61 offen offset:2048 lds
    buffer_load_dwordx4 v1, s[52:55], s61 offen offset:3072 lds
    s_waitcnt vmcnt(28)
    ds_write_b128 v4, a[112:115] offset:0
    ds_write_b128 v4, a[116:119] offset:1024
    ds_write_b128 v4, a[120:123] offset:2048
    ds_write_b128 v4, a[124:127] offset:3072
    ds_read_b128 a[48:51], v5 offset:0
    ds_read_b128 a[72:75], v5 offset:2048
    ds_read_b128 a[52:55], v6 offset:0
    ds_read_b128 a[76:79], v6 offset:2048
    s_add_u32 s61, s60, 12288
    s_mov_b32 m0, s61
    s_nop 0
    buffer_load_dwordx4 v1, s[52:55], s61 offen offset:0 lds
    buffer_load_dwordx4 v1, s[52:55], s61 offen offset:1024 lds
    buffer_load_dwordx4 v1, s[52:55], s61 offen offset:2048 lds
    buffer_load_dwordx4 v1, s[52:55], s61 offen offset:3072 lds
    s_add_u32 s61, s60, 16384
    s_mov_b32 m0, s61
    s_nop 0
    buffer_load_dwordx4 v1, s[52:55], s61 offen offset:0 lds
    buffer_load_dwordx4 v1, s[52:55], s61 offen offset:1024 lds
    buffer_load_dwordx4 v1, s[52:55], s61 offen offset:2048 lds
    buffer_load_dwordx4 v1, s[52:55], s61 offen offset:3072 lds
    s_add_u32 s61, s60, 20480
    s_mov_b32 m0, s61
    s_nop 0
    buffer_load_dwordx4 v1, s[52:55], s61 offen offset:0 lds
    buffer_load_dwordx4 v1, s[52:55], s61 offen offset:1024 lds
    buffer_load_dwordx4 v1, s[52:55], s61 offen offset:2048 lds
    buffer_load_dwordx4 v1, s[52:55], s61 offen offset:3072 lds
    s_waitcnt vmcnt(36)
    ds_write_b128 v4, a[128:131] offset:0
    ds_write_b128 v4, a[132:135] offset:1024
    ds_write_b128 v4, a[136:139] offset:2048
    ds_write_b128 v4, a[140:143] offset:3072
    ds_read_b128 a[8:11], v5 offset:0
    ds_read_b128 a[32:35], v5 offset:2048
    ds_read_b128 a[12:15], v6 offset:0
    ds_read_b128 a[36:39], v6 offset:2048
    s_add_u32 s61, s60, 24576
    s_mov_b32 m0, s61
    s_nop 0
    buffer_load_dwordx4 v1, s[52:55], s61 offen offset:0 lds
    buffer_load_dwordx4 v1, s[52:55], s61 offen offset:1024 lds
    buffer_load_dwordx4 v1, s[52:55], s61 offen offset:2048 lds
    buffer_load_dwordx4 v1, s[52:55], s61 offen offset:3072 lds
    s_add_u32 s61, s60, 28672
    s_mov_b32 m0, s61
    s_nop 0
    buffer_load_dwordx4 v1, s[52:55], s61 offen offset:0 lds
    buffer_load_dwordx4 v1, s[52:55], s61 offen offset:1024 lds
    buffer_load_dwordx4 v1, s[52:55], s61 offen offset:2048 lds
    buffer_load_dwordx4 v1, s[52:55], s61 offen offset:3072 lds
    s_add_u32 s61, s60, 32768
    s_mov_b32 m0, s61
    s_nop 0
    buffer_load_dwordx4 v1, s[52:55], s61 offen offset:0 lds
    buffer_load_dwordx4 v1, s[52:55], s61 offen offset:1024 lds
    buffer_load_dwordx4 v1, s[52:55], s61 offen offset:2048 lds
    buffer_load_dwordx4 v1, s[52:55], s61 offen offset:3072 lds
    s_waitcnt vmcnt(44)
    ds_write_b128 v4, a[144:147] offset:0
    ds_write_b128 v4, a[148:151] offset:1024
    ds_write_b128 v4, a[152:155] offset:2048
    ds_write_b128 v4, a[156:159] offset:3072
    ds_read_b128 a[56:59], v5 offset:0
    ds_read_b128 a[80:83], v5 offset:2048
    ds_read_b128 a[60:63], v6 offset:0
    ds_read_b128 a[84:87], v6 offset:2048
    s_add_u32 s61, s60, 36864
    s_mov_b32 m0, s61
    s_nop 0
    buffer_load_dwordx4 v1, s[52:55], s61 offen offset:0 lds
    buffer_load_dwordx4 v1, s[52:55], s61 offen offset:1024 lds
    buffer_load_dwordx4 v1, s[52:55], s61 offen offset:2048 lds
    buffer_load_dwordx4 v1, s[52:55], s61 offen offset:3072 lds
    s_add_u32 s61, s60, 40960
    s_mov_b32 m0, s61
    s_nop 0
    buffer_load_dwordx4 v1, s[52:55], s61 offen offset:0 lds
    buffer_load_dwordx4 v1, s[52:55], s61 offen offset:1024 lds
    buffer_load_dwordx4 v1, s[52:55], s61 offen offset:2048 lds
    buffer_load_dwordx4 v1, s[52:55], s61 offen offset:3072 lds
    s_add_u32 s61, s60, 45056
    s_mov_b32 m0, s61
    s_nop 0
    buffer_load_dwordx4 v1, s[52:55], s61 offen offset:0 lds
    buffer_load_dwordx4 v1, s[52:55], s61 offen offset:1024 lds
    buffer_load_dwordx4 v1, s[52:55], s61 offen offset:2048 lds
    buffer_load_dwordx4 v1, s[52:55], s61 offen offset:3072 lds
    s_waitcnt vmcnt(52)
    ds_write_b128 v4, a[160:163] offset:0
    ds_write_b128 v4, a[164:167] offset:1024
    ds_write_b128 v4, a[168:171] offset:2048
    ds_write_b128 v4, a[172:175] offset:3072
    ds_read_b128 a[16:19], v5 offset:0
    ds_read_b128 a[40:43], v5 offset:2048
    ds_read_b128 a[20:23], v6 offset:0
    ds_read_b128 a[44:47], v6 offset:2048
    s_waitcnt vmcnt(48)
    ds_write_b128 v4, a[176:179] offset:0
    ds_write_b128 v4, a[180:183] offset:1024
    ds_write_b128 v4, a[184:187] offset:2048
    ds_write_b128 v4, a[188:191] offset:3072
    ds_read_b128 a[64:67], v5 offset:0
    ds_read_b128 a[88:91], v5 offset:2048
    ds_read_b128 a[68:71], v6 offset:0
    ds_read_b128 a[92:95], v6 offset:2048
    v_lshlrev_b32 v31, 4, v31
    ds_or_b32 v29, v31
    s_branch L_enter
L_stream:
    s_lshl_b32 s60, 4096, s49
    v_mov_b32 v31, s60
    buffer_load_dwordx4 a[96:99], v10, s[8:11], s24 offen offset:0 nt
    buffer_load_dwordx4 a[100:103], v10, s[8:11], s25 offen offset:0 nt
    buffer_load_dwordx4 a[104:107], v10, s[8:11], s26 offen offset:0 nt
    buffer_load_dwordx4 a[108:111], v10, s[8:11], s27 offen offset:0 nt
    buffer_load_dwordx4 a[112:115], v10, s[8:11], s28 offen offset:0 nt
    buffer_load_dwordx4 a[116:119], v10, s[8:11], s29 offen offset:0 nt
    buffer_load_dwordx4 a[120:123], v10, s[8:11], s30 offen offset:0 nt
    buffer_load_dwordx4 a[124:127], v10, s[8:11], s31 offen offset:0 nt
    buffer_load_dwordx4 a[128:131], v10, s[8:11], s24 offen offset:128 nt
    buffer_load_dwordx4 a[132:135], v10, s[8:11], s25 offen offset:128 nt
    buffer_load_dwordx4 a[136:139], v10, s[8:11], s26 offen offset:128 nt
    buffer_load_dwordx4 a[140:143], v10, s[8:11], s27 offen offset:128 nt
    buffer_load_dwordx4 a[144:147], v10, s[8:11], s28 offen offset:128 nt
    buffer_load_dwordx4 a[148:151], v10, s[8:11], s29 offen offset:128 nt
    buffer_load_dwordx4 a[152:155], v10, s[8:11], s30 offen offset:128 nt
    buffer_load_dwordx4 a[156:159], v10, s[8:11], s31 offen offset:128 nt
    buffer_load_dwordx4 a[160:163], v10, s[8:11], s24 offen offset:256 nt
    buffer_load_dwordx4 a[164:167], v10, s[8:11], s25 offen offset:256 nt
    buffer_load_dwordx4 a[168:171], v10, s[8:11], s26 offen offset:256 nt
    buffer_load_dwordx4 a[172:175], v10, s[8:11], s27 offen offset:256 nt
    buffer_load_dwordx4 a[176:179], v10, s[8:11], s28 offen offset:256 nt
    buffer_load_dwordx4 a[180:183], v10, s[8:11], s29 offen offset:256 nt
    buffer_load_dwordx4 a[184:187], v10, s[8:11], s30 offen offset:256 nt
    buffer_load_dwordx4 a[188:191], v10, s[8:11], s31 offen offset:256 nt
    s_waitcnt vmcnt(24)
    v_mov_b32 v30, 1048576
    ds_or_b32 v29, v30
    s_waitcnt vmcnt(20)
    ds_or_b32 v29, v31
    ds_write_b128 v4, a[96:99] offset:0
    ds_write_b128 v4, a[100:103] offset:1024
    ds_write_b128 v4, a[104:107] offset:2048
    ds_write_b128 v4, a[108:111] offset:3072
    ds_read_b128 a[0:3], v5 offset:0
    ds_read_b128 a[24:27], v5 offset:2048
    ds_read_b128 a[4:7], v6 offset:0
    ds_read_b128 a[28:31], v6 offset:2048
    s_waitcnt vmcnt(16)
    ds_write_b128 v4, a[112:115] offset:0
    ds_write_b128 v4, a[116:119] offset:1024
    ds_write_b128 v4, a[120:123] offset:2048
    ds_write_b128 v4, a[124:127] offset:3072
    ds_read_b128 a[48:51], v5 offset:0
    ds_read_b128 a[72:75], v5 offset:2048
    ds_read_b128 a[52:55], v6 offset:0
    ds_read_b128 a[76:79], v6 offset:2048
    s_waitcnt vmcnt(12)
    ds_write_b128 v4, a[128:131] offset:0
    ds_write_b128 v4, a[132:135] offset:1024
    ds_write_b128 v4, a[136:139] offset:2048
    ds_write_b128 v4, a[140:143] offset:3072
    ds_read_b128 a[8:11], v5 offset:0
    ds_read_b128 a[32:35], v5 offset:2048
    ds_read_b128 a[12:15], v6 offset:0
    ds_read_b128 a[36:39], v6 offset:2048
    s_waitcnt vmcnt(8)
    ds_write_b128 v4, a[144:147] offset:0
    ds_write_b128 v4, a[148:151] offset:1024
    ds_write_b128 v4, a[152:155] offset:2048
    ds_write_b128 v4, a[156:159] offset:3072
    ds_read_b128 a[56:59], v5 offset:0
    ds_read_b128 a[80:83], v5 offset:2048
    ds_read_b128 a[60:63], v6 offset:0
    ds_read_b128 a[84:87], v6 offset:2048
    s_waitcnt vmcnt(4)
    ds_write_b128 v4, a[160:163] offset:0
    ds_write_b128 v4, a[164:167] offset:1024
    ds_write_b128 v4, a[168:171] offset:2048
    ds_write_b128 v4, a[172:175] offset:3072
    ds_read_b128 a[16:19], v5 offset:0
    ds_read_b128 a[40:43], v5 offset:2048
    ds_read_b128 a[20:23], v6 offset:0
    ds_read_b128 a[44:47], v6 offset:2048
    s_waitcnt vmcnt(0)
    ds_write_b128 v4, a[176:179] offset:0
    ds_write_b128 v4, a[180:183] offset:1024
    ds_write_b128 v4, a[184:187] offset:2048
    ds_write_b128 v4, a[188:191] offset:3072
    ds_read_b128 a[64:67], v5 offset:0
    ds_read_b128 a[88:91], v5 offset:2048
    ds_read_b128 a[68:71], v6 offset:0
    ds_read_b128 a[92:95], v6 offset:2048
    v_lshlrev_b32 v31, 4, v31
    ds_or_b32 v29, v31
    s_cmp_eq_u32 s49, 0
    s_cbranch_scc1 L_poll0
L_wgo:
    s_sub_u32 s43, s43, 1
    s_cbranch_scc1 L_end
    ds_read_b32 v30, v29
    s_waitcnt lgkmcnt(0)
    v_readfirstlane_b32 s41, v30
    s_nop 1
    s_and_b32 s42, s41, 0x200000
    s_cmp_eq_u32 s42, 0x200000
    s_cbranch_scc0 L_wgo
    s_branch L_go2
L_poll0:
    s_mov_b32 s61, 0
    v_min_u32 v33, 5, v0
    v_lshlrev_b32 v33, 2, v33
    s_mov_b32 s62, 0x01010101
L_poll:
    buffer_load_dword v34, v33, s[56:59], s48 offen nt
    s_add_u32 s61, s61, 1
    s_waitcnt vmcnt(0)
    v_cmp_ne_u32 vcc, s62, v34
    s_nop 4
    s_cbranch_vccz L_go
    s_sleep 2
    s_cmp_lt_u32 s61, 200
    s_cbranch_scc1 L_poll
    s_branch L_fb
L_go:
    s_mov_b32 s60, 0
    s_add_u32 s61, s60, 0
    s_mov_b32 m0, s61
    s_nop 0
    buffer_load_dwordx4 v1, s[52:55], s61 offen offset:0 lds
    buffer_load_dwordx4 v1, s[52:55], s61 offen offset:1024 lds
    buffer_load_dwordx4 v1, s[52:55], s61 offen offset:2048 lds
    buffer_load_dwordx4 v1, s[52:55], s61 offen offset:3072 lds
    s_add_u32 s61, s60, 4096
    s_mov_b32 m0, s61
    s_nop 0
    buffer_load_dwordx4 v1, s[52:55], s61 offen offset:0 lds
    buffer_load_dwordx4 v1, s[52:55], s61 offen offset:1024 lds
    buffer_load_dwordx4 v1, s[52:55], s61 offen offset:2048 lds
    buffer_load_dwordx4 v1, s[52:55], s61 offen offset:3072 lds
    s_add_u32 s61, s60, 8192
    s_mov_b32 m0, s61
    s_nop 0
    buffer_load_dwordx4 v1, s[52:55], s61 offen offset:0 lds
    buffer_load_dwordx4 v1, s[52:55], s61 offen offset:1024 lds
    buffer_load_dwordx4 v1, s[52:55], s61 offen offset:2048 lds
    buffer_load_dwordx4 v1, s[52:55], s61 offen offset:3072 lds
    v_mov_b32 v30, 2097152
    ds_or_b32 v29, v30
    s_mov_b32 s60, 12288
    s_branch L_go3
L_go2:
    s_mov_b32 s60, 36864
    s_add_u32 s61, s60, 0
    s_mov_b32 m0, s61
    s_nop 0
    buffer_load_dwordx4 v1, s[52:55], s61 offen offset:0 lds
    buffer_load_dwordx4 v1, s[52:55], s61 offen offset:1024 lds
    buffer_load_dwordx4 v1, s[52:55], s61 offen offset:2048 lds
    buffer_load_dwordx4 v1, s[52:55], s61 offen offset:3072 lds
    s_add_u32 s61, s60, 4096
    s_mov_b32 m0, s61
    s_nop 0
    buffer_load_dwordx4 v1, s[52:55], s61 offen offset:0 lds
    buffer_load_dwordx4 v1, s[52:55], s61 offen offset:1024 lds
    buffer_load_dwordx4 v1, s[52:55], s61 offen offset:2048 lds
    buffer_load_dwordx4 v1, s[52:55], s61 offen offset:3072 lds
    s_add_u32 s61, s60, 8192
    s_mov_b32 m0, s61
    s_nop 0
    buffer_load_dwordx4 v1, s[52:55], s61 offen offset:0 lds
    buffer_load_dwordx4 v1, s[52:55], s61 offen offset:1024 lds
    buffer_load_dwordx4 v1, s[52:55], s61 offen offset:2048 lds
    buffer_load_dwordx4 v1, s[52:55], s61 offen offset:3072 lds
    s_mov_b32 s60, 49152
L_go3:
    s_add_u32 s61, s60, 0
    s_mov_b32 m0, s61
    s_nop 0
    buffer_load_dwordx4 v1, s[52:55], s61 offen offset:0 lds
    buffer_load_dwordx4 v1, s[52:55], s61 offen offset:1024 lds
    buffer_load_dwordx4 v1, s[52:55], s61 offen offset:2048 lds
    buffer_load_dwordx4 v1, s[52:55], s61 offen offset:3072 lds
    s_add_u32 s61, s60, 4096
    s_mov_b32 m0, s61
    s_nop 0
    buffer_load_dwordx4 v1, s[52:55], s61 offen offset:0 lds
    buffer_load_dwordx4 v1, s[52:55], s61 offen offset:1024 lds
    buffer_load_dwordx4 v1, s[52:55], s61 offen offset:2048 lds
    buffer_load_dwordx4 v1, s[52:55], s61 offen offset:3072 lds
    s_add_u32 s61, s60, 8192
    s_mov_b32 m0, s61
    s_nop 0
    buffer_load_dwordx4 v1, s[52:55], s61 offen offset:0 lds
    buffer_load_dwordx4 v1, s[52:55], s61 offen offset:1024 lds
    buffer_load_dwordx4 v1, s[52:55], s61 offen offset:2048 lds
    buffer_load_dwordx4 v1, s[52:55], s61 offen offset:3072 lds
    s_add_u32 s61, s60, 12288
    s_mov_b32 m0, s61
    s_nop 0
    buffer_load_dwordx4 v1, s[52:55], s61 offen offset:0 lds
    buffer_load_dwordx4 v1, s[52:55], s61 offen offset:1024 lds
    buffer_load_dwordx4 v1, s[52:55], s61 offen offset:2048 lds
    buffer_load_dwordx4 v1, s[52:55], s61 offen offset:3072 lds
    s_add_u32 s61, s60, 16384
    s_mov_b32 m0, s61
    s_nop 0
    buffer_load_dwordx4 v1, s[52:55], s61 offen offset:0 lds
    buffer_load_dwordx4 v1, s[52:55], s61 offen offset:1024 lds
    buffer_load_dwordx4 v1, s[52:55], s61 offen offset:2048 lds
    buffer_load_dwordx4 v1, s[52:55], s61 offen offset:3072 lds
    s_add_u32 s61, s60, 20480
    s_mov_b32 m0, s61
    s_nop 0
    buffer_load_dwordx4 v1, s[52:55], s61 offen offset:0 lds
    buffer_load_dwordx4 v1, s[52:55], s61 offen offset:1024 lds
    buffer_load_dwordx4 v1, s[52:55], s61 offen offset:2048 lds
    buffer_load_dwordx4 v1, s[52:55], s61 offen offset:3072 lds
    s_mul_i32 s60, s49, 3
    s_lshl_b32 s60, 1, s60
    v_mov_b32 v30, s60
    v_lshlrev_b32 v23, 1, v30
    v_lshlrev_b32 v24, 2, v30
    s_waitcnt vmcnt(24)
    ds_or_b32 v29, v30
L_enter:
    s_waitcnt lgkmcnt(0)
    s_add_u32 s24, s24, 25165824
    s_add_u32 s26, s26, 25165824
    s_add_u32 s28, s28, 25165824
    s_add_u32 s30, s30, 25165824
    ds_read_b32 v30, v29
    s_waitcnt lgkmcnt(0)
    v_readfirstlane_b32 s41, v30
    s_nop 1
    s_bitcmp1_b32 s41, 0
    s_cbranch_scc0 L_slow0
L_ok0:
    ds_read_b128 a[192:195], v1 offset:0
    s_waitcnt lgkmcnt(0)
    v_mfma_f32_16x16x32_bf16 v[96:99], a[192:195], a[0:3], 0
    ds_read_b128 a[196:199], v1 offset:1024
    v_mfma_f32_16x16x32_bf16 v[100:103], a[192:195], a[24:27], 0
    ds_read_b128 a[200:203], v1 offset:2048
    v_mfma_f32_16x16x32_bf16 v[104:107], a[192:195], a[48:51], 0
    ds_read_b128 a[204:207], v1 offset:3072
    v_mfma_f32_16x16x32_bf16 v[108:111], a[192:195], a[72:75], 0
    ds_read_b128 a[208:211], v1 offset:4096
    s_waitcnt lgkmcnt(3)
    v_mfma_f32_16x16x32_bf16 v[96:99], a[196:199], a[4:7], v[96:99]
    ds_read_b128 a[212:215], v1 offset:5120
    v_mfma_f32_16x16x32_bf16 v[100:103], a[196:199], a[28:31], v[100:103]
    ds_read_b128 a[216:219], v1 offset:6144
    v_mfma_f32_16x16x32_bf16 v[104:107], a[196:199], a[52:55], v[104:107]
    ds_read_b128 a[220:223], v1 offset:7168
    v_mfma_f32_16x16x32_bf16 v[108:111], a[196:199], a[76:79], v[108:111]
    ds_read_b128 a[224:227], v1 offset:8192
    s_waitcnt lgkmcnt(6)
    v_mfma_f32_16x16x32_bf16 v[96:99], a[200:203], a[8:11], v[96:99]
    ds_read_b128 a[228:231], v1 offset:9216
    v_mfma_f32_16x16x32_bf16 v[100:103], a[200:203], a[32:35], v[100:103]
    ds_read_b128 a[232:235], v1 offset:10240
    v_mfma_f32_16x16x32_bf16 v[104:107], a[200:203], a[56:59], v[104:107]
    ds_read_b128 a[236:239], v1 offset:11264
    v_mfma_f32_16x16x32_bf16 v[108:111], a[200:203], a[80:83], v[108:111]
    s_waitcnt lgkmcnt(7)
    v_mfma_f32_16x16x32_bf16 v[96:99], a[204:207], a[12:15], v[96:99]
    s_cmp_lt_u32 s49, 3
    s_cbranch_scc0 L_pub0
    s_waitcnt vmcnt(12)
    ds_or_b32 v29, v23
L_pub0:
    v_mfma_f32_16x16x32_bf16 v[100:103], a[204:207], a[36:39], v[100:103]
    v_mfma_f32_16x16x32_bf16 v[104:107], a[204:207], a[60:63], v[104:107]
    ds_read_b32 v30, v29
    v_mfma_f32_16x16x32_bf16 v[108:111], a[204:207], a[84:87], v[108:111]
    v_mfma_f32_16x16x32_bf16 v[96:99], a[208:211], a[16:19], v[96:99]
    v_mfma_f32_16x16x32_bf16 v[100:103], a[208:211], a[40:43], v[100:103]
    v_mfma_f32_16x16x32_bf16 v[104:107], a[208:211], a[64:67], v[104:107]
    v_mfma_f32_16x16x32_bf16 v[108:111], a[208:211], a[88:91], v[108:111]
    s_waitcnt lgkmcnt(6)
    v_mfma_f32_16x16x32_bf16 v[96:99], a[212:215], a[20:23], v[96:99]
    v_mfma_f32_16x16x32_bf16 v[100:103], a[212:215], a[44:47], v[100:103]
    v_mfma_f32_16x16x32_bf16 v[104:107], a[212:215], a[68:71], v[104:107]
    v_mfma_f32_16x16x32_bf16 v[108:111], a[212:215], a[92:95], v[108:111]
    s_waitcnt lgkmcnt(0)
    v_readfirstlane_b32 s41, v30
    v_mfma_f32_16x16x32_bf16 v[112:115], a[216:219], a[0:3], 0
    v_cvt_pk_bf16_f32 v208, v96, v97
    v_cvt_pk_bf16_f32 v209, v98, v99
    v_mfma_f32_16x16x32_bf16 v[116:119], a[216:219], a[24:27], 0
    s_bitcmp1_b32 s41, 1
    s_cbranch_scc0 L_slow1
L_ok1:
    v_mfma_f32_16x16x32_bf16 v[120:123], a[216:219], a[48:51], 0
    ds_read_b128 a[240:243], v1 offset:12288
    v_cvt_pk_bf16_f32 v212, v100, v101
    v_mfma_f32_16x16x32_bf16 v[124:127], a[216:219], a[72:75], 0
    ds_read_b128 a[244:247], v1 offset:13312
    v_cvt_pk_bf16_f32 v213, v102, v103
    v_mfma_f32_16x16x32_bf16 v[112:115], a[220:223], a[4:7], v[112:115]
    ds_read_b128 a[248:251], v1 offset:14336
    v_cvt_pk_bf16_f32 v216, v104, v105
    v_mfma_f32_16x16x32_bf16 v[116:119], a[220:223], a[28:31], v[116:119]
    v_cvt_pk_bf16_f32 v217, v106, v107
    v_cvt_pk_bf16_f32 v220, v108, v109
    v_mfma_f32_16x16x32_bf16 v[120:123], a[220:223], a[52:55], v[120:123]
    v_cvt_pk_bf16_f32 v221, v110, v111
    v_mfma_f32_16x16x32_bf16 v[124:127], a[220:223], a[76:79], v[124:127]
    v_mfma_f32_16x16x32_bf16 v[112:115], a[224:227], a[8:11], v[112:115]
    ds_read_b128 a[252:255], v1 offset:15360
    v_mfma_f32_16x16x32_bf16 v[116:119], a[224:227], a[32:35], v[116:119]
    v_mfma_f32_16x16x32_bf16 v[120:123], a[224:227], a[56:59], v[120:123]
    v_mfma_f32_16x16x32_bf16 v[124:127], a[224:227], a[80:83], v[124:127]
    v_mfma_f32_16x16x32_bf16 v[112:115], a[228:231], a[12:15], v[112:115]
    ds_read_b128 a[192:195], v1 offset:16384
    v_mfma_f32_16x16x32_bf16 v[116:119], a[228:231], a[36:39], v[116:119]
    v_mfma_f32_16x16x32_bf16 v[120:123], a[228:231], a[60:63], v[120:123]
    v_mfma_f32_16x16x32_bf16 v[124:127], a[228:231], a[84:87], v[124:127]
    v_mfma_f32_16x16x32_bf16 v[112:115], a[232:235], a[16:19], v[112:115]
    ds_read_b128 a[196:199], v1 offset:17408
    v_mfma_f32_16x16x32_bf16 v[116:119], a[232:235], a[40:43], v[116:119]
    v_mfma_f32_16x16x32_bf16 v[120:123], a[232:235], a[64:67], v[120:123]
    v_mfma_f32_16x16x32_bf16 v[124:127], a[232:235], a[88:91], v[124:127]
    v_mfma_f32_16x16x32_bf16 v[112:115], a[236:239], a[20:23], v[112:115]
    ds_read_b128 a[200:203], v1 offset:18432
    v_mfma_f32_16x16x32_bf16 v[116:119], a[236:239], a[44:47], v[116:119]
    v_mfma_f32_16x16x32_bf16 v[120:123], a[236:239], a[68:71], v[120:123]
    v_mfma_f32_16x16x32_bf16 v[124:127], a[236:239], a[92:95], v[124:127]
    v_cvt_pk_bf16_f32 v210, v112, v113
    s_waitcnt lgkmcnt(3)
    v_mfma_f32_16x16x32_bf16 v[96:99], a[240:243], a[0:3], 0
    ds_read_b128 a[204:207], v1 offset:19456
    v_cvt_pk_bf16_f32 v211, v114, v115
    v_mfma_f32_16x16x32_bf16 v[100:103], a[240:243], a[24:27], 0
    v_cvt_pk_bf16_f32 v214, v116, v117
    v_cvt_pk_bf16_f32 v215, v118, v119
    v_mfma_f32_16x16x32_bf16 v[104:107], a[240:243], a[48:51], 0
    v_cvt_pk_bf16_f32 v218, v120, v121
    v_cvt_pk_bf16_f32 v219, v122, v123
    v_mfma_f32_16x16x32_bf16 v[108:111], a[240:243], a[72:75], 0
    v_cvt_pk_bf16_f32 v222, v124, v125
    v_cvt_pk_bf16_f32 v223, v126, v127
    v_mfma_f32_16x16x32_bf16 v[96:99], a[244:247], a[4:7], v[96:99]
    ds_read_b128 a[208:211], v1 offset:20480
    v_mfma_f32_16x16x32_bf16 v[100:103], a[244:247], a[28:31], v[100:103]
    v_mfma_f32_16x16x32_bf16 v[104:107], a[244:247], a[52:55], v[104:107]
    v_mfma_f32_16x16x32_bf16 v[108:111], a[244:247], a[76:79], v[108:111]
    v_mfma_f32_16x16x32_bf16 v[96:99], a[248:251], a[8:11], v[96:99]
    ds_read_b128 a[212:215], v1 offset:21504
    v_mfma_f32_16x16x32_bf16 v[100:103], a[248:251], a[32:35], v[100:103]
    v_mfma_f32_16x16x32_bf16 v[104:107], a[248:251], a[56:59], v[104:107]
    v_mfma_f32_16x16x32_bf16 v[108:111], a[248:251], a[80:83], v[108:111]
    v_mfma_f32_16x16x32_bf16 v[32:35], a[0:3], v[208:211], 0
    ds_read_b128 a[216:219], v1 offset:22528
    v_mfma_f32_16x16x32_bf16 v[36:39], a[24:27], v[208:211], 0
    s_cmp_lt_u32 s49, 3
    s_cbranch_scc0 L_pub1
    s_waitcnt vmcnt(0)
    ds_or_b32 v29, v24
L_pub1:
    v_mfma_f32_16x16x32_bf16 v[40:43], a[48:51], v[208:211], 0
    v_mfma_f32_16x16x32_bf16 v[44:47], a[72:75], v[208:211], 0
    v_mfma_f32_16x16x32_bf16 v[48:51], a[0:3], v[212:215], 0
    ds_read_b128 a[220:223], v1 offset:23552
    v_mfma_f32_16x16x32_bf16 v[52:55], a[24:27], v[212:215], 0
    v_mfma_f32_16x16x32_bf16 v[56:59], a[48:51], v[212:215], 0
    v_mfma_f32_16x16x32_bf16 v[60:63], a[72:75], v[212:215], 0
    v_mfma_f32_16x16x32_bf16 v[64:67], a[0:3], v[216:219], 0
    v_mfma_f32_16x16x32_bf16 v[68:71], a[24:27], v[216:219], 0
    v_mfma_f32_16x16x32_bf16 v[72:75], a[48:51], v[216:219], 0
    s_cmp_eq_u32 s49, 3
    s_cbranch_scc0 L_pub2
    s_waitcnt vmcnt(24)
    ds_or_b32 v29, v23
L_pub2:
    v_mfma_f32_16x16x32_bf16 v[76:79], a[72:75], v[216:219], 0
    v_mfma_f32_16x16x32_bf16 v[80:83], a[0:3], v[220:223], 0
    v_mfma_f32_16x16x32_bf16 v[84:87], a[24:27], v[220:223], 0
    v_mfma_f32_16x16x32_bf16 v[88:91], a[48:51], v[220:223], 0
    v_mfma_f32_16x16x32_bf16 v[92:95], a[72:75], v[220:223], 0
    v_mfma_f32_16x16x32_bf16 v[96:99], a[252:255], a[12:15], v[96:99]
    v_mfma_f32_16x16x32_bf16 v[100:103], a[252:255], a[36:39], v[100:103]
    v_mfma_f32_16x16x32_bf16 v[104:107], a[252:255], a[60:63], v[104:107]
    ds_read_b32 v30, v29
    v_mfma_f32_16x16x32_bf16 v[108:111], a[252:255], a[84:87], v[108:111]
    s_waitcnt lgkmcnt(1)
    v_mfma_f32_16x16x32_bf16 v[96:99], a[192:195], a[16:19], v[96:99]
    v_mfma_f32_16x16x32_bf16 v[100:103], a[192:195], a[40:43], v[100:103]
    v_mfma_f32_16x16x32_bf16 v[104:107], a[192:195], a[64:67], v[104:107]
    v_mfma_f32_16x16x32_bf16 v[108:111], a[192:195], a[88:91], v[108:111]
    v_mfma_f32_16x16x32_bf16 v[96:99], a[196:199], a[20:23], v[96:99]
    v_mfma_f32_16x16x32_bf16 v[100:103], a[196:199], a[44:47], v[100:103]
    v_mfma_f32_16x16x32_bf16 v[104:107], a[196:199], a[68:71], v[104:107]
    v_mfma_f32_16x16x32_bf16 v[108:111], a[196:199], a[92:95], v[108:111]
    s_waitcnt lgkmcnt(0)
    v_readfirstlane_b32 s41, v30
    v_mfma_f32_16x16x32_bf16 v[112:115], a[200:203], a[0:3], 0
    v_cvt_pk_bf16_f32 v208, v96, v97
    v_cvt_pk_bf16_f32 v209, v98, v99
    v_mfma_f32_16x16x32_bf16 v[116:119], a[200:203], a[24:27], 0
    s_bitcmp1_b32 s41, 2
    s_cbranch_scc0 L_slow2
L_ok2:
    v_mfma_f32_16x16x32_bf16 v[120:123], a[200:203], a[48:51], 0
    ds_read_b128 a[224:227], v1 offset:24576
    v_cvt_pk_bf16_f32 v212, v100, v101
    v_mfma_f32_16x16x32_bf16 v[124:127], a[200:203], a[72:75], 0
    ds_read_b128 a[228:231], v1 offset:25600
    v_cvt_pk_bf16_f32 v213, v102, v103
    v_mfma_f32_16x16x32_bf16 v[112:115], a[204:207], a[4:7], v[112:115]
    ds_read_b128 a[232:235], v1 offset:26624
    v_cvt_pk_bf16_f32 v216, v104, v105
    v_mfma_f32_16x16x32_bf16 v[116:119], a[204:207], a[28:31], v[116:119]
    v_cvt_pk_bf16_f32 v217, v106, v107
    v_cvt_pk_bf16_f32 v220, v108, v109
    v_mfma_f32_16x16x32_bf16 v[120:123], a[204:207], a[52:55], v[120:123]
    v_cvt_pk_bf16_f32 v221, v110, v111
    v_mfma_f32_16x16x32_bf16 v[124:127], a[204:207], a[76:79], v[124:127]
    v_mfma_f32_16x16x32_bf16 v[112:115], a[208:211], a[8:11], v[112:115]
    ds_read_b128 a[236:239], v1 offset:27648
    v_mfma_f32_16x16x32_bf16 v[116:119], a[208:211], a[32:35], v[116:119]
    v_mfma_f32_16x16x32_bf16 v[120:123], a[208:211], a[56:59], v[120:123]
    v_mfma_f32_16x16x32_bf16 v[124:127], a[208:211], a[80:83], v[124:127]
    v_mfma_f32_16x16x32_bf16 v[112:115], a[212:215], a[12:15], v[112:115]
    ds_read_b128 a[240:243], v1 offset:28672
    v_mfma_f32_16x16x32_bf16 v[116:119], a[212:215], a[36:39], v[116:119]
    v_mfma_f32_16x16x32_bf16 v[120:123], a[212:215], a[60:63], v[120:123]
    v_mfma_f32_16x16x32_bf16 v[124:127], a[212:215], a[84:87], v[124:127]
    v_mfma_f32_16x16x32_bf16 v[112:115], a[216:219], a[16:19], v[112:115]
    ds_read_b128 a[244:247], v1 offset:29696
    v_mfma_f32_16x16x32_bf16 v[116:119], a[216:219], a[40:43], v[116:119]
    v_mfma_f32_16x16x32_bf16 v[120:123], a[216:219], a[64:67], v[120:123]
    v_mfma_f32_16x16x32_bf16 v[124:127], a[216:219], a[88:91], v[124:127]
    v_mfma_f32_16x16x32_bf16 v[112:115], a[220:223], a[20:23], v[112:115]
    ds_read_b128 a[248:251], v1 offset:30720
    v_mfma_f32_16x16x32_bf16 v[116:119], a[220:223], a[44:47], v[116:119]
    v_mfma_f32_16x16x32_bf16 v[120:123], a[220:223], a[68:71], v[120:123]
    v_mfma_f32_16x16x32_bf16 v[124:127], a[220:223], a[92:95], v[124:127]
    v_cvt_pk_bf16_f32 v210, v112, v113
    s_waitcnt lgkmcnt(3)
    v_mfma_f32_16x16x32_bf16 v[96:99], a[224:227], a[0:3], 0
    ds_read_b128 a[252:255], v1 offset:31744
    v_cvt_pk_bf16_f32 v211, v114, v115
    v_mfma_f32_16x16x32_bf16 v[100:103], a[224:227], a[24:27], 0
    v_cvt_pk_bf16_f32 v214, v116, v117
    v_cvt_pk_bf16_f32 v215, v118, v119
    v_mfma_f32_16x16x32_bf16 v[104:107], a[224:227], a[48:51], 0
    v_cvt_pk_bf16_f32 v218, v120, v121
    v_cvt_pk_bf16_f32 v219, v122, v123
    v_mfma_f32_16x16x32_bf16 v[108:111], a[224:227], a[72:75], 0
    v_cvt_pk_bf16_f32 v222, v124, v125
    v_cvt_pk_bf16_f32 v223, v126, v127
    v_mfma_f32_16x16x32_bf16 v[96:99], a[228:231], a[4:7], v[96:99]
    ds_read_b128 a[192:195], v1 offset:32768
    v_mfma_f32_16x16x32_bf16 v[100:103], a[228:231], a[28:31], v[100:103]
    v_mfma_f32_16x16x32_bf16 v[104:107], a[228:231], a[52:55], v[104:107]
    v_mfma_f32_16x16x32_bf16 v[108:111], a[228:231], a[76:79], v[108:111]
    v_mfma_f32_16x16x32_bf16 v[96:99], a[232:235], a[8:11], v[96:99]
    ds_read_b128 a[196:199], v1 offset:33792
    v_mfma_f32_16x16x32_bf16 v[100:103], a[232:235], a[32:35], v[100:103]
    v_mfma_f32_16x16x32_bf16 v[104:107], a[232:235], a[56:59], v[104:107]
    v_mfma_f32_16x16x32_bf16 v[108:111], a[232:235], a[80:83], v[108:111]
    v_mfma_f32_16x16x32_bf16 v[32:35], a[4:7], v[208:211], v[32:35]
    ds_read_b128 a[200:203], v1 offset:34816
    v_mfma_f32_16x16x32_bf16 v[36:39], a[28:31], v[208:211], v[36:39]
    v_mfma_f32_16x16x32_bf16 v[40:43], a[52:55], v[208:211], v[40:43]
    v_mfma_f32_16x16x32_bf16 v[44:47], a[76:79], v[208:211], v[44:47]
    v_mfma_f32_16x16x32_bf16 v[48:51], a[4:7], v[212:215], v[48:51]
    ds_read_b128 a[204:207], v1 offset:35840
    v_mfma_f32_16x16x32_bf16 v[52:55], a[28:31], v[212:215], v[52:55]
    v_mfma_f32_16x16x32_bf16 v[56:59], a[52:55], v[212:215], v[56:59]
    s_cmp_eq_u32 s49, 3
    s_cbranch_scc0 L_pub3
    s_waitcnt vmcnt(0)
    ds_or_b32 v29, v24
L_pub3:
    v_mfma_f32_16x16x32_bf16 v[60:63], a[76:79], v[212:215], v[60:63]
    v_mfma_f32_16x16x32_bf16 v[64:67], a[4:7], v[216:219], v[64:67]
    v_mfma_f32_16x16x32_bf16 v[68:71], a[28:31], v[216:219], v[68:71]
    v_mfma_f32_16x16x32_bf16 v[72:75], a[52:55], v[216:219], v[72:75]
    v_mfma_f32_16x16x32_bf16 v[76:79], a[76:79], v[216:219], v[76:79]
    v_mfma_f32_16x16x32_bf16 v[80:83], a[4:7], v[220:223], v[80:83]
    v_mfma_f32_16x16x32_bf16 v[84:87], a[28:31], v[220:223], v[84:87]
    v_mfma_f32_16x16x32_bf16 v[88:91], a[52:55], v[220:223], v[88:91]
    v_mfma_f32_16x16x32_bf16 v[92:95], a[76:79], v[220:223], v[92:95]
    v_mfma_f32_16x16x32_bf16 v[96:99], a[236:239], a[12:15], v[96:99]
    v_mfma_f32_16x16x32_bf16 v[100:103], a[236:239], a[36:39], v[100:103]
    v_mfma_f32_16x16x32_bf16 v[104:107], a[236:239], a[60:63], v[104:107]
    ds_read_b32 v30, v29
    v_mfma_f32_16x16x32_bf16 v[108:111], a[236:239], a[84:87], v[108:111]
    s_waitcnt lgkmcnt(1)
    v_mfma_f32_16x16x32_bf16 v[96:99], a[240:243], a[16:19], v[96:99]
    v_mfma_f32_16x16x32_bf16 v[100:103], a[240:243], a[40:43], v[100:103]
    v_mfma_f32_16x16x32_bf16 v[104:107], a[240:243], a[64:67], v[104:107]
    v_mfma_f32_16x16x32_bf16 v[108:111], a[240:243], a[88:91], v[108:111]
    v_mfma_f32_16x16x32_bf16 v[96:99], a[244:247], a[20:23], v[96:99]
    v_mfma_f32_16x16x32_bf16 v[100:103], a[244:247], a[44:47], v[100:103]
    v_mfma_f32_16x16x32_bf16 v[104:107], a[244:247], a[68:71], v[104:107]
    v_mfma_f32_16x16x32_bf16 v[108:111], a[244:247], a[92:95], v[108:111]
    s_waitcnt lgkmcnt(0)
    v_readfirstlane_b32 s41, v30
    v_mfma_f32_16x16x32_bf16 v[112:115], a[248:251], a[0:3], 0
    v_cvt_pk_bf16_f32 v208, v96, v97
    v_cvt_pk_bf16_f32 v209, v98, v99
    v_mfma_f32_16x16x32_bf16 v[116:119], a[248:251], a[24:27], 0
    s_bitcmp1_b32 s41, 3
    s_cbranch_scc0 L_slow3
L_ok3:
    v_mfma_f32_16x16x32_bf16 v[120:123], a[248:251], a[48:51], 0
    ds_read_b128 a[208:211], v1 offset:36864
    v_cvt_pk_bf16_f32 v212, v100, v101
    v_mfma_f32_16x16x32_bf16 v[124:127], a[248:251], a[72:75], 0
    ds_read_b128 a[212:215], v1 offset:37888
    v_cvt_pk_bf16_f32 v213, v102, v103
    v_mfma_f32_16x16x32_bf16 v[112:115], a[252:255], a[4:7], v[112:115]
    ds_read_b128 a[216:219], v1 offset:38912
    v_cvt_pk_bf16_f32 v216, v104, v105
    v_mfma_f32_16x16x32_bf16 v[116:119], a[252:255], a[28:31], v[116:119]
    v_cvt_pk_bf16_f32 v217, v106, v107
    v_cvt_pk_bf16_f32 v220, v108, v109
    v_mfma_f32_16x16x32_bf16 v[120:123], a[252:255], a[52:55], v[120:123]
    v_cvt_pk_bf16_f32 v221, v110, v111
    v_mfma_f32_16x16x32_bf16 v[124:127], a[252:255], a[76:79], v[124:127]
    v_mfma_f32_16x16x32_bf16 v[112:115], a[192:195], a[8:11], v[112:115]
    ds_read_b128 a[220:223], v1 offset:39936
    v_mfma_f32_16x16x32_bf16 v[116:119], a[192:195], a[32:35], v[116:119]
    v_mfma_f32_16x16x32_bf16 v[120:123], a[192:195], a[56:59], v[120:123]
    v_mfma_f32_16x16x32_bf16 v[124:127], a[192:195], a[80:83], v[124:127]
    v_mfma_f32_16x16x32_bf16 v[112:115], a[196:199], a[12:15], v[112:115]
    ds_read_b128 a[224:227], v1 offset:40960
    v_mfma_f32_16x16x32_bf16 v[116:119], a[196:199], a[36:39], v[116:119]
    v_mfma_f32_16x16x32_bf16 v[120:123], a[196:199], a[60:63], v[120:123]
    v_mfma_f32_16x16x32_bf16 v[124:127], a[196:199], a[84:87], v[124:127]
    v_mfma_f32_16x16x32_bf16 v[112:115], a[200:203], a[16:19], v[112:115]
    ds_read_b128 a[228:231], v1 offset:41984
    v_mfma_f32_16x16x32_bf16 v[116:119], a[200:203], a[40:43], v[116:119]
    v_mfma_f32_16x16x32_bf16 v[120:123], a[200:203], a[64:67], v[120:123]
    v_mfma_f32_16x16x32_bf16 v[124:127], a[200:203], a[88:91], v[124:127]
    v_mfma_f32_16x16x32_bf16 v[112:115], a[204:207], a[20:23], v[112:115]
    ds_read_b128 a[232:235], v1 offset:43008
    v_mfma_f32_16x16x32_bf16 v[116:119], a[204:207], a[44:47], v[116:119]
    v_mfma_f32_16x16x32_bf16 v[120:123], a[204:207], a[68:71], v[120:123]
    v_mfma_f32_16x16x32_bf16 v[124:127], a[204:207], a[92:95], v[124:127]
    v_cvt_pk_bf16_f32 v210, v112, v113
    s_waitcnt lgkmcnt(3)
    v_mfma_f32_16x16x32_bf16 v[96:99], a[208:211], a[0:3], 0
    ds_read_b128 a[236:239], v1 offset:44032
    v_cvt_pk_bf16_f32 v211, v114, v115
    v_mfma_f32_16x16x32_bf16 v[100:103], a[208:211], a[24:27], 0
    v_cvt_pk_bf16_f32 v214, v116, v117
    v_cvt_pk_bf16_f32 v215, v118, v119
    v_mfma_f32_16x16x32_bf16 v[104:107], a[208:211], a[48:51], 0
    v_cvt_pk_bf16_f32 v218, v120, v121
    v_cvt_pk_bf16_f32 v219, v122, v123
    v_mfma_f32_16x16x32_bf16 v[108:111], a[208:211], a[72:75], 0
    v_cvt_pk_bf16_f32 v222, v124, v125
    v_cvt_pk_bf16_f32 v223, v126, v127
    v_mfma_f32_16x16x32_bf16 v[96:99], a[212:215], a[4:7], v[96:99]
    ds_read_b128 a[240:243], v1 offset:45056
    v_mfma_f32_16x16x32_bf16 v[100:103], a[212:215], a[28:31], v[100:103]
    v_mfma_f32_16x16x32_bf16 v[104:107], a[212:215], a[52:55], v[104:107]
    v_mfma_f32_16x16x32_bf16 v[108:111], a[212:215], a[76:79], v[108:111]
    v_mfma_f32_16x16x32_bf16 v[96:99], a[216:219], a[8:11], v[96:99]
    ds_read_b128 a[244:247], v1 offset:46080
    v_mfma_f32_16x16x32_bf16 v[100:103], a[216:219], a[32:35], v[100:103]
    v_mfma_f32_16x16x32_bf16 v[104:107], a[216:219], a[56:59], v[104:107]
    v_mfma_f32_16x16x32_bf16 v[108:111], a[216:219], a[80:83], v[108:111]
    v_mfma_f32_16x16x32_bf16 v[32:35], a[8:11], v[208:211], v[32:35]
    ds_read_b128 a[248:251], v1 offset:47104
    v_mfma_f32_16x16x32_bf16 v[36:39], a[32:35], v[208:211], v[36:39]
    v_mfma_f32_16x16x32_bf16 v[40:43], a[56:59], v[208:211], v[40:43]
    v_mfma_f32_16x16x32_bf16 v[44:47], a[80:83], v[208:211], v[44:47]
    v_mfma_f32_16x16x32_bf16 v[48:51], a[8:11], v[212:215], v[48:51]
    ds_read_b128 a[252:255], v1 offset:48128
    v_mfma_f32_16x16x32_bf16 v[52:55], a[32:35], v[212:215], v[52:55]
    v_mfma_f32_16x16x32_bf16 v[56:59], a[56:59], v[212:215], v[56:59]
    v_mfma_f32_16x16x32_bf16 v[60:63], a[80:83], v[212:215], v[60:63]
    v_mfma_f32_16x16x32_bf16 v[64:67], a[8:11], v[216:219], v[64:67]
    v_mfma_f32_16x16x32_bf16 v[68:71], a[32:35], v[216:219], v[68:71]
    v_mfma_f32_16x16x32_bf16 v[72:75], a[56:59], v[216:219], v[72:75]
    v_mfma_f32_16x16x32_bf16 v[76:79], a[80:83], v[216:219], v[76:79]
    v_mfma_f32_16x16x32_bf16 v[80:83], a[8:11], v[220:223], v[80:83]
    v_mfma_f32_16x16x32_bf16 v[84:87], a[32:35], v[220:223], v[84:87]
    v_mfma_f32_16x16x32_bf16 v[88:91], a[56:59], v[220:223], v[88:91]
    v_mfma_f32_16x16x32_bf16 v[92:95], a[80:83], v[220:223], v[92:95]
    v_mfma_f32_16x16x32_bf16 v[96:99], a[220:223], a[12:15], v[96:99]
    v_mfma_f32_16x16x32_bf16 v[100:103], a[220:223], a[36:39], v[100:103]
    v_mfma_f32_16x16x32_bf16 v[104:107], a[220:223], a[60:63], v[104:107]
    ds_read_b32 v30, v29
    v_mfma_f32_16x16x32_bf16 v[108:111], a[220:223], a[84:87], v[108:111]
    s_waitcnt lgkmcnt(1)
    v_mfma_f32_16x16x32_bf16 v[96:99], a[224:227], a[16:19], v[96:99]
    v_mfma_f32_16x16x32_bf16 v[100:103], a[224:227], a[40:43], v[100:103]
    v_mfma_f32_16x16x32_bf16 v[104:107], a[224:227], a[64:67], v[104:107]
    v_mfma_f32_16x16x32_bf16 v[108:111], a[224:227], a[88:91], v[108:111]
    v_mfma_f32_16x16x32_bf16 v[96:99], a[228:231], a[20:23], v[96:99]
    v_mfma_f32_16x16x32_bf16 v[100:103], a[228:231], a[44:47], v[100:103]
    v_mfma_f32_16x16x32_bf16 v[104:107], a[228:231], a[68:71], v[104:107]
    v_mfma_f32_16x16x32_bf16 v[108:111], a[228:231], a[92:95], v[108:111]
    s_waitcnt lgkmcnt(0)
    v_readfirstlane_b32 s41, v30
    v_mfma_f32_16x16x32_bf16 v[112:115], a[232:235], a[0:3], 0
    v_cvt_pk_bf16_f32 v208, v96, v97
    v_cvt_pk_bf16_f32 v209, v98, v99
    v_mfma_f32_16x16x32_bf16 v[116:119], a[232:235], a[24:27], 0
    s_bitcmp1_b32 s41, 4
    s_cbranch_scc0 L_slow4
L_ok4:
    v_mfma_f32_16x16x32_bf16 v[120:123], a[232:235], a[48:51], 0
    ds_read_b128 a[192:195], v1 offset:49152
    v_cvt_pk_bf16_f32 v212, v100, v101
    v_mfma_f32_16x16x32_bf16 v[124:127], a[232:235], a[72:75], 0
    ds_read_b128 a[196:199], v1 offset:50176
    v_cvt_pk_bf16_f32 v213, v102, v103
    v_mfma_f32_16x16x32_bf16 v[112:115], a[236:239], a[4:7], v[112:115]
    ds_read_b128 a[200:203], v1 offset:51200
    v_cvt_pk_bf16_f32 v216, v104, v105
    v_mfma_f32_16x16x32_bf16 v[116:119], a[236:239], a[28:31], v[116:119]
    v_cvt_pk_bf16_f32 v217, v106, v107
    v_cvt_pk_bf16_f32 v220, v108, v109
    v_mfma_f32_16x16x32_bf16 v[120:123], a[236:239], a[52:55], v[120:123]
    v_cvt_pk_bf16_f32 v221, v110, v111
    v_mfma_f32_16x16x32_bf16 v[124:127], a[236:239], a[76:79], v[124:127]
    v_mfma_f32_16x16x32_bf16 v[112:115], a[240:243], a[8:11], v[112:115]
    ds_read_b128 a[204:207], v1 offset:52224
    v_mfma_f32_16x16x32_bf16 v[116:119], a[240:243], a[32:35], v[116:119]
    v_mfma_f32_16x16x32_bf16 v[120:123], a[240:243], a[56:59], v[120:123]
    v_mfma_f32_16x16x32_bf16 v[124:127], a[240:243], a[80:83], v[124:127]
    v_mfma_f32_16x16x32_bf16 v[112:115], a[244:247], a[12:15], v[112:115]
    ds_read_b128 a[208:211], v1 offset:53248
    v_mfma_f32_16x16x32_bf16 v[116:119], a[244:247], a[36:39], v[116:119]
    v_mfma_f32_16x16x32_bf16 v[120:123], a[244:247], a[60:63], v[120:123]
    v_mfma_f32_16x16x32_bf16 v[124:127], a[244:247], a[84:87], v[124:127]
    v_mfma_f32_16x16x32_bf16 v[112:115], a[248:251], a[16:19], v[112:115]
    ds_read_b128 a[212:215], v1 offset:54272
    v_mfma_f32_16x16x32_bf16 v[116:119], a[248:251], a[40:43], v[116:119]
    v_mfma_f32_16x16x32_bf16 v[120:123], a[248:251], a[64:67], v[120:123]
    v_mfma_f32_16x16x32_bf16 v[124:127], a[248:251], a[88:91], v[124:127]
    v_mfma_f32_16x16x32_bf16 v[112:115], a[252:255], a[20:23], v[112:115]
    ds_read_b128 a[216:219], v1 offset:55296
    v_mfma_f32_16x16x32_bf16 v[116:119], a[252:255], a[44:47], v[116:119]
    v_mfma_f32_16x16x32_bf16 v[120:123], a[252:255], a[68:71], v[120:123]
    v_mfma_f32_16x16x32_bf16 v[124:127], a[252:255], a[92:95], v[124:127]
    v_cvt_pk_bf16_f32 v210, v112, v113
    s_waitcnt lgkmcnt(3)
    v_mfma_f32_16x16x32_bf16 v[96:99], a[192:195], a[0:3], 0
    ds_read_b128 a[220:223], v1 offset:56320
    v_cvt_pk_bf16_f32 v211, v114, v115
    v_mfma_f32_16x16x32_bf16 v[100:103], a[192:195], a[24:27], 0
    v_cvt_pk_bf16_f32 v214, v116, v117
    v_cvt_pk_bf16_f32 v215, v118, v119
    v_mfma_f32_16x16x32_bf16 v[104:107], a[192:195], a[48:51], 0
    v_cvt_pk_bf16_f32 v218, v120, v121
    v_cvt_pk_bf16_f32 v219, v122, v123
    v_mfma_f32_16x16x32_bf16 v[108:111], a[192:195], a[72:75], 0
    v_cvt_pk_bf16_f32 v222, v124, v125
    v_cvt_pk_bf16_f32 v223, v126, v127
    v_mfma_f32_16x16x32_bf16 v[96:99], a[196:199], a[4:7], v[96:99]
    ds_read_b128 a[224:227], v1 offset:57344
    v_mfma_f32_16x16x32_bf16 v[100:103], a[196:199], a[28:31], v[100:103]
    v_mfma_f32_16x16x32_bf16 v[104:107], a[196:199], a[52:55], v[104:107]
    v_mfma_f32_16x16x32_bf16 v[108:111], a[196:199], a[76:79], v[108:111]
    v_mfma_f32_16x16x32_bf16 v[96:99], a[200:203], a[8:11], v[96:99]
    ds_read_b128 a[228:231], v1 offset:58368
    v_mfma_f32_16x16x32_bf16 v[100:103], a[200:203], a[32:35], v[100:103]
    v_mfma_f32_16x16x32_bf16 v[104:107], a[200:203], a[56:59], v[104:107]
    v_mfma_f32_16x16x32_bf16 v[108:111], a[200:203], a[80:83], v[108:111]
    v_mfma_f32_16x16x32_bf16 v[32:35], a[12:15], v[208:211], v[32:35]
    ds_read_b128 a[232:235], v1 offset:59392
    v_mfma_f32_16x16x32_bf16 v[36:39], a[36:39], v[208:211], v[36:39]
    v_mfma_f32_16x16x32_bf16 v[40:43], a[60:63], v[208:211], v[40:43]
    v_mfma_f32_16x16x32_bf16 v[44:47], a[84:87], v[208:211], v[44:47]
    v_mfma_f32_16x16x32_bf16 v[48:51], a[12:15], v[212:215], v[48:51]
    ds_read_b128 a[236:239], v1 offset:60416
    v_mfma_f32_16x16x32_bf16 v[52:55], a[36:39], v[212:215], v[52:55]
    v_mfma_f32_16x16x32_bf16 v[56:59], a[60:63], v[212:215], v[56:59]
    v_mfma_f32_16x16x32_bf16 v[60:63], a[84:87], v[212:215], v[60:63]
    v_mfma_f32_16x16x32_bf16 v[64:67], a[12:15], v[216:219], v[64:67]
    v_mfma_f32_16x16x32_bf16 v[68:71], a[36:39], v[216:219], v[68:71]
    v_mfma_f32_16x16x32_bf16 v[72:75], a[60:63], v[216:219], v[72:75]
    v_mfma_f32_16x16x32_bf16 v[76:79], a[84:87], v[216:219], v[76:79]
    v_mfma_f32_16x16x32_bf16 v[80:83], a[12:15], v[220:223], v[80:83]
    v_mfma_f32_16x16x32_bf16 v[84:87], a[36:39], v[220:223], v[84:87]
    v_mfma_f32_16x16x32_bf16 v[88:91], a[60:63], v[220:223], v[88:91]
    v_mfma_f32_16x16x32_bf16 v[92:95], a[84:87], v[220:223], v[92:95]
    v_mfma_f32_16x16x32_bf16 v[96:99], a[204:207], a[12:15], v[96:99]
    v_mfma_f32_16x16x32_bf16 v[100:103], a[204:207], a[36:39], v[100:103]
    v_mfma_f32_16x16x32_bf16 v[104:107], a[204:207], a[60:63], v[104:107]
    ds_read_b32 v30, v29
    v_mfma_f32_16x16x32_bf16 v[108:111], a[204:207], a[84:87], v[108:111]
    s_waitcnt lgkmcnt(1)
    v_mfma_f32_16x16x32_bf16 v[96:99], a[208:211], a[16:19], v[96:99]
    v_mfma_f32_16x16x32_bf16 v[100:103], a[208:211], a[40:43], v[100:103]
    v_mfma_f32_16x16x32_bf16 v[104:107], a[208:211], a[64:67], v[104:107]
    v_mfma_f32_16x16x32_bf16 v[108:111], a[208:211], a[88:91], v[108:111]
    v_mfma_f32_16x16x32_bf16 v[96:99], a[212:215], a[20:23], v[96:99]
    v_mfma_f32_16x16x32_bf16 v[100:103], a[212:215], a[44:47], v[100:103]
    v_mfma_f32_16x16x32_bf16 v[104:107], a[212:215], a[68:71], v[104:107]
    v_mfma_f32_16x16x32_bf16 v[108:111], a[212:215], a[92:95], v[108:111]
    s_waitcnt lgkmcnt(0)
    v_readfirstlane_b32 s41, v30
    v_mfma_f32_16x16x32_bf16 v[112:115], a[216:219], a[0:3], 0
    buffer_load_dwordx4 a[96:99], v9, s[8:11], s24 offen offset:0 nt
    v_cvt_pk_bf16_f32 v208, v96, v97
    v_mfma_f32_16x16x32_bf16 v[116:119], a[216:219], a[24:27], 0
    buffer_load_dwordx4 a[100:103], v9, s[8:11], s24 offen offset:64 nt
    v_cvt_pk_bf16_f32 v209, v98, v99
    v_mfma_f32_16x16x32_bf16 v[120:123], a[216:219], a[48:51], 0
    s_bitcmp1_b32 s41, 5
    s_cbranch_scc0 L_slow5
L_ok5:
    v_mfma_f32_16x16x32_bf16 v[124:127], a[216:219], a[72:75], 0
    ds_read_b128 a[240:243], v1 offset:61440
    v_cvt_pk_bf16_f32 v212, v100, v101
    v_mfma_f32_16x16x32_bf16 v[112:115], a[220:223], a[4:7], v[112:115]
    ds_read_b128 a[244:247], v1 offset:62464
    v_cvt_pk_bf16_f32 v213, v102, v103
    v_mfma_f32_16x16x32_bf16 v[116:119], a[220:223], a[28:31], v[116:119]
    ds_read_b128 a[248:251], v1 offset:63488
    v_cvt_pk_bf16_f32 v216, v104, v105
    v_mfma_f32_16x16x32_bf16 v[120:123], a[220:223], a[52:55], v[120:123]
    v_cvt_pk_bf16_f32 v217, v106, v107
    v_cvt_pk_bf16_f32 v220, v108, v109
    v_mfma_f32_16x16x32_bf16 v[124:127], a[220:223], a[76:79], v[124:127]
    v_cvt_pk_bf16_f32 v221, v110, v111
    v_mfma_f32_16x16x32_bf16 v[112:115], a[224:227], a[8:11], v[112:115]
    ds_read_b128 a[252:255], v1 offset:64512
    v_mfma_f32_16x16x32_bf16 v[116:119], a[224:227], a[32:35], v[116:119]
    v_mfma_f32_16x16x32_bf16 v[120:123], a[224:227], a[56:59], v[120:123]
    buffer_load_dwordx4 a[120:123], v9, s[8:11], s26 offen offset:0 nt
    v_mfma_f32_16x16x32_bf16 v[124:127], a[224:227], a[80:83], v[124:127]
    buffer_load_dwordx4 a[124:127], v9, s[8:11], s26 offen offset:64 nt
    v_mfma_f32_16x16x32_bf16 v[112:115], a[228:231], a[12:15], v[112:115]
    ds_read_b128 a[192:195], v2 offset:0
    v_mfma_f32_16x16x32_bf16 v[116:119], a[228:231], a[36:39], v[116:119]
    v_mfma_f32_16x16x32_bf16 v[120:123], a[228:231], a[60:63], v[120:123]
    v_mfma_f32_16x16x32_bf16 v[124:127], a[228:231], a[84:87], v[124:127]
    v_mfma_f32_16x16x32_bf16 v[112:115], a[232:235], a[16:19], v[112:115]
    ds_read_b128 a[196:199], v2 offset:1024
    v_mfma_f32_16x16x32_bf16 v[116:119], a[232:235], a[40:43], v[116:119]
    v_mfma_f32_16x16x32_bf16 v[120:123], a[232:235], a[64:67], v[120:123]
    v_mfma_f32_16x16x32_bf16 v[124:127], a[232:235], a[88:91], v[124:127]
    v_mfma_f32_16x16x32_bf16 v[112:115], a[236:239], a[20:23], v[112:115]
    buffer_load_dwordx4 a[144:147], v9, s[8:11], s28 offen offset:0 nt
    v_mfma_f32_16x16x32_bf16 v[116:119], a[236:239], a[44:47], v[116:119]
    buffer_load_dwordx4 a[148:151], v9, s[8:11], s28 offen offset:64 nt
    v_mfma_f32_16x16x32_bf16 v[120:123], a[236:239], a[68:71], v[120:123]
    ds_read_b128 a[200:203], v2 offset:2048
    v_mfma_f32_16x16x32_bf16 v[124:127], a[236:239], a[92:95], v[124:127]
    v_cvt_pk_bf16_f32 v210, v112, v113
    s_waitcnt lgkmcnt(3)
    v_mfma_f32_16x16x32_bf16 v[96:99], a[240:243], a[0:3], 0
    ds_read_b128 a[204:207], v2 offset:3072
    v_cvt_pk_bf16_f32 v211, v114, v115
    v_mfma_f32_16x16x32_bf16 v[100:103], a[240:243], a[24:27], 0
    v_cvt_pk_bf16_f32 v214, v116, v117
    v_cvt_pk_bf16_f32 v215, v118, v119
    v_mfma_f32_16x16x32_bf16 v[104:107], a[240:243], a[48:51], 0
    v_cvt_pk_bf16_f32 v218, v120, v121
    v_cvt_pk_bf16_f32 v219, v122, v123
    v_mfma_f32_16x16x32_bf16 v[108:111], a[240:243], a[72:75], 0
    v_cvt_pk_bf16_f32 v222, v124, v125
    v_cvt_pk_bf16_f32 v223, v126, v127
    v_mfma_f32_16x16x32_bf16 v[96:99], a[244:247], a[4:7], v[96:99]
    ds_read_b128 a[208:211], v2 offset:4096
    v_mfma_f32_16x16x32_bf16 v[100:103], a[244:247], a[28:31], v[100:103]
    v_mfma_f32_16x16x32_bf16 v[104:107], a[244:247], a[52:55], v[104:107]
    buffer_load_dwordx4 a[168:171], v9, s[8:11], s30 offen offset:0 nt
    v_mfma_f32_16x16x32_bf16 v[108:111], a[244:247], a[76:79], v[108:111]
    buffer_load_dwordx4 a[172:175], v9, s[8:11], s30 offen offset:64 nt
    v_mfma_f32_16x16x32_bf16 v[96:99], a[248:251], a[8:11], v[96:99]
    ds_read_b128 a[212:215], v2 offset:5120
    v_mfma_f32_16x16x32_bf16 v[100:103], a[248:251], a[32:35], v[100:103]
    v_mfma_f32_16x16x32_bf16 v[104:107], a[248:251], a[56:59], v[104:107]
    v_mfma_f32_16x16x32_bf16 v[108:111], a[248:251], a[80:83], v[108:111]
    v_mfma_f32_16x16x32_bf16 v[32:35], a[16:19], v[208:211], v[32:35]
    ds_read_b128 a[216:219], v2 offset:6144
    v_mfma_f32_16x16x32_bf16 v[36:39], a[40:43], v[208:211], v[36:39]
    v_mfma_f32_16x16x32_bf16 v[40:43], a[64:67], v[208:211], v[40:43]
    v_mfma_f32_16x16x32_bf16 v[44:47], a[88:91], v[208:211], v[44:47]
    v_mfma_f32_16x16x32_bf16 v[48:51], a[16:19], v[212:215], v[48:51]
    buffer_load_dwordx4 a[104:107], v9, s[8:11], s24 offen offset:128 nt
    v_mfma_f32_16x16x32_bf16 v[52:55], a[40:43], v[212:215], v[52:55]
    buffer_load_dwordx4 a[108:111], v9, s[8:11], s24 offen offset:192 nt
    v_mfma_f32_16x16x32_bf16 v[56:59], a[64:67], v[212:215], v[56:59]
    ds_read_b128 a[220:223], v2 offset:7168
    v_mfma_f32_16x16x32_bf16 v[60:63], a[88:91], v[212:215], v[60:63]
    v_mfma_f32_16x16x32_bf16 v[64:67], a[16:19], v[216:219], v[64:67]
    v_mfma_f32_16x16x32_bf16 v[68:71], a[40:43], v[216:219], v[68:71]
    v_mfma_f32_16x16x32_bf16 v[72:75], a[64:67], v[216:219], v[72:75]
    v_mfma_f32_16x16x32_bf16 v[76:79], a[88:91], v[216:219], v[76:79]
    v_mfma_f32_16x16x32_bf16 v[80:83], a[16:19], v[220:223], v[80:83]
    v_mfma_f32_16x16x32_bf16 v[84:87], a[40:43], v[220:223], v[84:87]
    v_mfma_f32_16x16x32_bf16 v[88:91], a[64:67], v[220:223], v[88:91]
    buffer_load_dwordx4 a[128:131], v9, s[8:11], s26 offen offset:128 nt
    v_mfma_f32_16x16x32_bf16 v[92:95], a[88:91], v[220:223], v[92:95]
    buffer_load_dwordx4 a[132:135], v9, s[8:11], s26 offen offset:192 nt
    v_mfma_f32_16x16x32_bf16 v[96:99], a[252:255], a[12:15], v[96:99]
    v_mfma_f32_16x16x32_bf16 v[100:103], a[252:255], a[36:39], v[100:103]
    v_mfma_f32_16x16x32_bf16 v[104:107], a[252:255], a[60:63], v[104:107]
    ds_read_b32 v30, v29
    v_mfma_f32_16x16x32_bf16 v[108:111], a[252:255], a[84:87], v[108:111]
    s_waitcnt lgkmcnt(2)
    v_mfma_f32_16x16x32_bf16 v[96:99], a[192:195], a[16:19], v[96:99]
    v_mfma_f32_16x16x32_bf16 v[100:103], a[192:195], a[40:43], v[100:103]
    v_mfma_f32_16x16x32_bf16 v[104:107], a[192:195], a[64:67], v[104:107]
    v_mfma_f32_16x16x32_bf16 v[108:111], a[192:195], a[88:91], v[108:111]
    v_mfma_f32_16x16x32_bf16 v[96:99], a[196:199], a[20:23], v[96:99]
    buffer_load_dwordx4 a[152:155], v9, s[8:11], s28 offen offset:128 nt
    v_mfma_f32_16x16x32_bf16 v[100:103], a[196:199], a[44:47], v[100:103]
    buffer_load_dwordx4 a[156:159], v9, s[8:11], s28 offen offset:192 nt
    v_mfma_f32_16x16x32_bf16 v[104:107], a[196:199], a[68:71], v[104:107]
    v_mfma_f32_16x16x32_bf16 v[108:111], a[196:199], a[92:95], v[108:111]
    s_waitcnt lgkmcnt(0)
    v_readfirstlane_b32 s41, v30
    v_mfma_f32_16x16x32_bf16 v[112:115], a[200:203], a[0:3], 0
    v_cvt_pk_bf16_f32 v208, v96, v97
    v_cvt_pk_bf16_f32 v209, v98, v99
    v_mfma_f32_16x16x32_bf16 v[116:119], a[200:203], a[24:27], 0
    s_bitcmp1_b32 s41, 6
    s_cbranch_scc0 L_slow6
L_ok6:
    v_mfma_f32_16x16x32_bf16 v[120:123], a[200:203], a[48:51], 0
    ds_read_b128 a[224:227], v2 offset:8192
    v_cvt_pk_bf16_f32 v212, v100, v101
    v_mfma_f32_16x16x32_bf16 v[124:127], a[200:203], a[72:75], 0
    ds_read_b128 a[228:231], v2 offset:9216
    v_cvt_pk_bf16_f32 v213, v102, v103
    v_mfma_f32_16x16x32_bf16 v[112:115], a[204:207], a[4:7], v[112:115]
    ds_read_b128 a[232:235], v2 offset:10240
    v_cvt_pk_bf16_f32 v216, v104, v105
    v_mfma_f32_16x16x32_bf16 v[116:119], a[204:207], a[28:31], v[116:119]
    v_cvt_pk_bf16_f32 v217, v106, v107
    v_cvt_pk_bf16_f32 v220, v108, v109
    v_mfma_f32_16x16x32_bf16 v[120:123], a[204:207], a[52:55], v[120:123]
    buffer_load_dwordx4 a[176:179], v9, s[8:11], s30 offen offset:128 nt
    v_cvt_pk_bf16_f32 v221, v110, v111
    v_mfma_f32_16x16x32_bf16 v[124:127], a[204:207], a[76:79], v[124:127]
    buffer_load_dwordx4 a[180:183], v9, s[8:11], s30 offen offset:192 nt
    v_mfma_f32_16x16x32_bf16 v[112:115], a[208:211], a[8:11], v[112:115]
    v_mfma_f32_16x16x32_bf16 v[116:119], a[208:211], a[32:35], v[116:119]
    v_mfma_f32_16x16x32_bf16 v[120:123], a[208:211], a[56:59], v[120:123]
    v_mfma_f32_16x16x32_bf16 v[124:127], a[208:211], a[80:83], v[124:127]
    v_mfma_f32_16x16x32_bf16 v[112:115], a[212:215], a[12:15], v[112:115]
    v_mfma_f32_16x16x32_bf16 v[116:119], a[212:215], a[36:39], v[116:119]
    v_mfma_f32_16x16x32_bf16 v[120:123], a[212:215], a[60:63], v[120:123]
    v_mfma_f32_16x16x32_bf16 v[124:127], a[212:215], a[84:87], v[124:127]
    v_mfma_f32_16x16x32_bf16 v[112:115], a[216:219], a[16:19], v[112:115]
    v_mfma_f32_16x16x32_bf16 v[116:119], a[216:219], a[40:43], v[116:119]
    v_mfma_f32_16x16x32_bf16 v[120:123], a[216:219], a[64:67], v[120:123]
    v_mfma_f32_16x16x32_bf16 v[124:127], a[216:219], a[88:91], v[124:127]
    v_mfma_f32_16x16x32_bf16 v[112:115], a[220:223], a[20:23], v[112:115]
    v_mfma_f32_16x16x32_bf16 v[116:119], a[220:223], a[44:47], v[116:119]
    v_mfma_f32_16x16x32_bf16 v[120:123], a[220:223], a[68:71], v[120:123]
    v_mfma_f32_16x16x32_bf16 v[124:127], a[220:223], a[92:95], v[124:127]
    v_cvt_pk_bf16_f32 v210, v112, v113
    v_cvt_pk_bf16_f32 v211, v114, v115
    v_cvt_pk_bf16_f32 v214, v116, v117
    v_cvt_pk_bf16_f32 v215, v118, v119
    s_nop 0
    v_cvt_pk_bf16_f32 v218, v120, v121
    v_cvt_pk_bf16_f32 v219, v122, v123
    s_nop 0
    v_cvt_pk_bf16_f32 v222, v124, v125
    v_cvt_pk_bf16_f32 v223, v126, v127
L_fin:
    s_sub_u32 s43, s43, 1
    s_cbranch_scc1 L_end
    ds_read_b32 v30, v29
    s_waitcnt lgkmcnt(0)
    v_readfirstlane_b32 s41, v30
    s_nop 1
    s_and_b32 s41, s41, 3968
    s_cmp_eq_u32 s41, 3968
    s_cbranch_scc0 L_fin
    s_mov_b32 s16, s12
    s_mov_b32 s17, s13
    s_mov_b32 s18, 0
    s_mov_b32 s19, 0x00020000
    s_mov_b32 s52, 0
    s_mov_b32 s54, 0
    s_mov_b32 s56, 0
    s_mov_b32 s58, 0
    s_mov_b32 s48, 0
    .p2align 6
L_loop:
    s_waitcnt lgkmcnt(2)
    v_mfma_f32_16x16x32_bf16 v[96:99], a[0:3], a[224:227], 0
    buffer_store_dwordx2 v[178:179], v11, s[16:19], s56 offen offset:640 sc1
    v_mfma_f32_16x16x32_bf16 v[100:103], a[24:27], a[224:227], 0
    v_mfma_f32_16x16x32_bf16 v[104:107], a[48:51], a[224:227], 0
    v_mfma_f32_16x16x32_bf16 v[108:111], a[72:75], a[224:227], 0
    s_waitcnt lgkmcnt(1)
    v_mfma_f32_16x16x32_bf16 v[96:99], a[4:7], a[228:231], v[96:99]
    buffer_load_dwordx4 a[112:115], v9, s[8:11], s24 offen offset:256 nt
    v_mfma_f32_16x16x32_bf16 v[100:103], a[28:31], a[228:231], v[100:103]
    buffer_load_dwordx4 a[116:119], v9, s[8:11], s24 offen offset:320 nt
    s_add_u32 s24, s24, 25165824
    v_mfma_f32_16x16x32_bf16 v[104:107], a[52:55], a[228:231], v[104:107]
    v_mfma_f32_16x16x32_bf16 v[108:111], a[76:79], a[228:231], v[108:111]
    s_waitcnt lgkmcnt(0)
    v_mfma_f32_16x16x32_bf16 v[96:99], a[8:11], a[232:235], v[96:99]
    ds_read_b128 a[236:239], v2 offset:11264
    v_mfma_f32_16x16x32_bf16 v[100:103], a[32:35], a[232:235], v[100:103]
    v_mfma_f32_16x16x32_bf16 v[104:107], a[56:59], a[232:235], v[104:107]
    v_mfma_f32_16x16x32_bf16 v[108:111], a[80:83], a[232:235], v[108:111]
    v_mfma_f32_16x16x32_bf16 v[32:35], a[20:23], v[208:211], v[32:35]
    ds_read_b128 a[240:243], v2 offset:12288
    v_mfma_f32_16x16x32_bf16 v[36:39], a[44:47], v[208:211], v[36:39]
    v_mfma_f32_16x16x32_bf16 v[40:43], a[68:71], v[208:211], v[40:43]
    buffer_store_dwordx2 v[180:181], v11, s[16:19], s56 offen offset:1024 sc1
    v_mfma_f32_16x16x32_bf16 v[44:47], a[92:95], v[208:211], v[44:47]
    ds_read_b128 a[244:247], v2 offset:13312
    v_max3_f32 v12, v32, v33, v34
    v_mfma_f32_16x16x32_bf16 v[48:51], a[20:23], v[212:215], v[48:51]
    v_max3_f32 v12, v12, v35, v36
    v_max3_f32 v12, v12, v37, v38
    v_mfma_f32_16x16x32_bf16 v[52:55], a[44:47], v[212:215], v[52:55]
    v_max3_f32 v12, v12, v39, v40
    v_max3_f32 v12, v12, v41, v42
    v_mfma_f32_16x16x32_bf16 v[56:59], a[68:71], v[212:215], v[56:59]
    v_max3_f32 v12, v12, v43, v44
    v_max3_f32 v12, v12, v45, v46
    v_mfma_f32_16x16x32_bf16 v[60:63], a[92:95], v[212:215], v[60:63]
    ds_read_b128 a[248:251], v2 offset:14336
    v_max3_f32 v13, v48, v49, v50
    v_mfma_f32_16x16x32_bf16 v[64:67], a[20:23], v[216:219], v[64:67]
    v_max3_f32 v13, v13, v51, v52
    v_max3_f32 v13, v13, v53, v54
    v_mfma_f32_16x16x32_bf16 v[68:71], a[44:47], v[216:219], v[68:71]
    v_max3_f32 v13, v13, v55, v56
    v_max3_f32 v13, v13, v57, v58
    v_mfma_f32_16x16x32_bf16 v[72:75], a[68:71], v[216:219], v[72:75]
    v_max3_f32 v13, v13, v59, v60
    v_max3_f32 v13, v13, v61, v62
    v_mfma_f32_16x16x32_bf16 v[76:79], a[92:95], v[216:219], v[76:79]
    ds_read_b128 a[252:255], v2 offset:15360
    v_max3_f32 v14, v64, v65, v66
    v_mfma_f32_16x16x32_bf16 v[80:83], a[20:23], v[220:223], v[80:83]
    v_max3_f32 v14, v14, v67, v68
    v_max3_f32 v14, v14, v69, v70
    v_mfma_f32_16x16x32_bf16 v[84:87], a[44:47], v[220:223], v[84:87]
    v_max3_f32 v14, v14, v71, v72
    v_max3_f32 v14, v14, v73, v74
    v_mfma_f32_16x16x32_bf16 v[88:91], a[68:71], v[220:223], v[88:91]
    v_max3_f32 v14, v14, v75, v76
    v_max3_f32 v14, v14, v77, v78
    v_mfma_f32_16x16x32_bf16 v[92:95], a[92:95], v[220:223], v[92:95]
    buffer_store_dwordx2 v[182:183], v11, s[16:19], s56 offen offset:1408 sc1
    s_waitcnt lgkmcnt(3)
    v_mfma_f32_16x16x32_bf16 v[96:99], a[12:15], a[236:239], v[96:99]
    ds_read_b128 a[192:195], v2 offset:16384
    v_max3_f32 v15, v80, v81, v82
    v_mfma_f32_16x16x32_bf16 v[100:103], a[36:39], a[236:239], v[100:103]
    v_max3_f32 v15, v15, v83, v84
    v_max3_f32 v15, v15, v85, v86
    v_mfma_f32_16x16x32_bf16 v[104:107], a[60:63], a[236:239], v[104:107]
    v_max3_f32 v15, v15, v87, v88
    v_max3_f32 v15, v15, v89, v90
    v_mfma_f32_16x16x32_bf16 v[108:111], a[84:87], a[236:239], v[108:111]
    ds_read_b128 a[196:199], v2 offset:17408
    v_max3_f32 v15, v15, v91, v92
    v_mfma_f32_16x16x32_bf16 v[96:99], a[16:19], a[240:243], v[96:99]
    v_max3_f32 v15, v15, v93, v94
    v_max_f32 v12, v12, v47
    v_mfma_f32_16x16x32_bf16 v[100:103], a[40:43], a[240:243], v[100:103]
    v_max_f32 v13, v13, v63
    v_max_f32 v14, v14, v79
    v_mfma_f32_16x16x32_bf16 v[104:107], a[64:67], a[240:243], v[104:107]
    v_max_f32 v15, v15, v95
    v_permlane16_swap_b32 v12, v13
    v_mfma_f32_16x16x32_bf16 v[108:111], a[88:91], a[240:243], v[108:111]
    ds_read_b128 a[200:203], v2 offset:18432
    s_waitcnt lgkmcnt(4)
    v_mfma_f32_16x16x32_bf16 v[96:99], a[20:23], a[244:247], v[96:99]
    v_permlane16_swap_b32 v14, v15
    v_max_f32 v12, v12, v13
    v_mfma_f32_16x16x32_bf16 v[100:103], a[44:47], a[244:247], v[100:103]
    v_max_f32 v14, v14, v15
    v_mfma_f32_16x16x32_bf16 v[104:107], a[68:71], a[244:247], v[104:107]
    v_mfma_f32_16x16x32_bf16 v[108:111], a[92:95], a[244:247], v[108:111]
    ds_read_b128 a[204:207], v2 offset:19456
    v_cvt_pk_bf16_f32 v128, v96, v97
    v_mfma_f32_16x16x32_bf16 v[112:115], a[0:3], a[248:251], 0
    v_cvt_pk_bf16_f32 v129, v98, v99
    v_cvt_pk_bf16_f32 v130, v100, v101
    v_mfma_f32_16x16x32_bf16 v[116:119], a[24:27], a[248:251], 0
    buffer_store_dwordx2 v[184:185], v11, s[16:19], s58 offen offset:256 sc1
    v_mfma_f32_16x16x32_bf16 v[120:123], a[48:51], a[248:251], 0
    v_cvt_pk_bf16_f32 v131, v102, v103
    v_cvt_pk_bf16_f32 v132, v104, v105
    v_mfma_f32_16x16x32_bf16 v[124:127], a[72:75], a[248:251], 0
    ds_read_b128 a[208:211], v2 offset:20480
    s_waitcnt lgkmcnt(4)
    v_mfma_f32_16x16x32_bf16 v[112:115], a[4:7], a[252:255], v[112:115]
    v_cvt_pk_bf16_f32 v133, v106, v107
    v_cvt_pk_bf16_f32 v134, v108, v109
    v_mfma_f32_16x16x32_bf16 v[116:119], a[28:31], a[252:255], v[116:119]
    v_cvt_pk_bf16_f32 v135, v110, v111
    v_permlane32_swap_b32 v12, v14
    v_mfma_f32_16x16x32_bf16 v[120:123], a[52:55], a[252:255], v[120:123]
    v_max_f32 v12, v12, v14
    v_mul_f32 v12, s40, v12
    v_mfma_f32_16x16x32_bf16 v[124:127], a[76:79], a[252:255], v[124:127]
    ds_read_b128 a[212:215], v2 offset:21504
    v_mov_b32 v14, v12
    v_mfma_f32_16x16x32_bf16 v[112:115], a[8:11], a[192:195], v[112:115]
    v_mfma_f32_16x16x32_bf16 v[116:119], a[32:35], a[192:195], v[116:119]
    v_permlane32_swap_b32 v12, v14
    v_mov_b32 v13, v12
    v_mfma_f32_16x16x32_bf16 v[120:123], a[56:59], a[192:195], v[120:123]
    v_mov_b32 v15, v14
    v_permlane16_swap_b32 v12, v13
    v_mfma_f32_16x16x32_bf16 v[124:127], a[80:83], a[192:195], v[124:127]
    ds_read_b128 a[216:219], v2 offset:22528
    s_waitcnt lgkmcnt(4)
    v_mfma_f32_16x16x32_bf16 v[112:115], a[12:15], a[196:199], v[112:115]
    v_permlane16_swap_b32 v14, v15
    v_fma_f32 v32, v32, s40, -v12
    v_mfma_f32_16x16x32_bf16 v[116:119], a[36:39], a[196:199], v[116:119]
    v_fma_f32 v33, v33, s40, -v12
    v_fma_f32 v48, v48, s40, -v13
    v_mfma_f32_16x16x32_bf16 v[120:123], a[60:63], a[196:199], v[120:123]
    v_fma_f32 v49, v49, s40, -v13
    v_fma_f32 v64, v64, s40, -v14
    v_mfma_f32_16x16x32_bf16 v[124:127], a[84:87], a[196:199], v[124:127]
    buffer_store_dwordx2 v[186:187], v11, s[16:19], s58 offen offset:640 sc1
    v_mfma_f32_16x16x32_bf16 v[112:115], a[16:19], a[200:203], v[112:115]
    ds_read_b128 a[220:223], v2 offset:23552
    v_fma_f32 v65, v65, s40, -v14
    v_mfma_f32_16x16x32_bf16 v[116:119], a[40:43], a[200:203], v[116:119]
    v_fma_f32 v80, v80, s40, -v15
    v_fma_f32 v81, v81, s40, -v15
    v_mfma_f32_16x16x32_bf16 v[120:123], a[64:67], a[200:203], v[120:123]
    v_exp_f32 v32, v32
    v_mfma_f32_16x16x32_bf16 v[124:127], a[88:91], a[200:203], v[124:127]
    ds_read_b128 a[224:227], v2 offset:24576
    s_waitcnt lgkmcnt(4)
    v_mfma_f32_16x16x32_bf16 v[112:115], a[20:23], a[204:207], v[112:115]
    v_exp_f32 v33, v33
    v_mfma_f32_16x16x32_bf16 v[116:119], a[44:47], a[204:207], v[116:119]
    buffer_load_dwordx4 a[136:139], v9, s[8:11], s26 offen offset:256 nt
    v_fma_f32 v34, v34, s40, -v12
    v_mfma_f32_16x16x32_bf16 v[120:123], a[68:71], a[204:207], v[120:123]
    buffer_load_dwordx4 a[140:143], v9, s[8:11], s26 offen offset:320 nt
    v_fma_f32 v50, v50, s40, -v13
    v_mfma_f32_16x16x32_bf16 v[124:127], a[92:95], a[204:207], v[124:127]
    ds_read_b128 a[228:231], v2 offset:25600
    v_cvt_pk_bf16_f32 v136, v112, v113
    v_mfma_f32_16x16x32_bf16 v[96:99], a[0:3], a[208:211], 0
    v_cvt_pk_bf16_f32 v137, v114, v115
    v_cvt_pk_bf16_f32 v138, v116, v117
    v_mfma_f32_16x16x32_bf16 v[100:103], a[24:27], a[208:211], 0
    v_cvt_pk_bf16_f32 v139, v118, v119
    v_cvt_pk_bf16_f32 v140, v120, v121
    v_mfma_f32_16x16x32_bf16 v[104:107], a[48:51], a[208:211], 0
    v_cvt_pk_bf16_f32 v141, v122, v123
    v_cvt_pk_bf16_f32 v142, v124, v125
    v_mfma_f32_16x16x32_bf16 v[108:111], a[72:75], a[208:211], 0
    ds_read_b128 a[232:235], v2 offset:26624
    s_waitcnt lgkmcnt(4)
    v_mfma_f32_16x16x32_bf16 v[96:99], a[4:7], a[212:215], v[96:99]
    v_cvt_pk_bf16_f32 v143, v126, v127
    v_fma_f32 v66, v66, s40, -v14
    v_mfma_f32_16x16x32_bf16 v[100:103], a[28:31], a[212:215], v[100:103]
    buffer_store_dwordx2 v[188:189], v11, s[16:19], s58 offen offset:1024 sc1
    v_mfma_f32_16x16x32_bf16 v[104:107], a[52:55], a[212:215], v[104:107]
    ds_read_b128 a[236:239], v2 offset:27648
    v_fma_f32 v82, v82, s40, -v15
    v_mfma_f32_16x16x32_bf16 v[108:111], a[76:79], a[212:215], v[108:111]
    v_exp_f32 v48, v48
    v_mfma_f32_16x16x32_bf16 v[96:99], a[8:11], a[216:219], v[96:99]
    v_exp_f32 v49, v49
    v_mfma_f32_16x16x32_bf16 v[100:103], a[32:35], a[216:219], v[100:103]
    v_exp_f32 v64, v64
    v_mfma_f32_16x16x32_bf16 v[104:107], a[56:59], a[216:219], v[104:107]
    ds_read_b128 a[240:243], v2 offset:28672
    v_fma_f32 v35, v35, s40, -v12
    v_mfma_f32_16x16x32_bf16 v[108:111], a[80:83], a[216:219], v[108:111]
    v_fma_f32 v51, v51, s40, -v13
    s_waitcnt lgkmcnt(4)
    v_mfma_f32_16x16x32_bf16 v[96:99], a[12:15], a[220:223], v[96:99]
    v_exp_f32 v65, v65
    v_mfma_f32_16x16x32_bf16 v[100:103], a[36:39], a[220:223], v[100:103]
    v_exp_f32 v80, v80
    v_mfma_f32_16x16x32_bf16 v[104:107], a[60:63], a[220:223], v[104:107]
    ds_read_b128 a[244:247], v2 offset:29696
    v_fma_f32 v67, v67, s40, -v14
    v_mfma_f32_16x16x32_bf16 v[108:111], a[84:87], a[220:223], v[108:111]
    v_exp_f32 v81, v81
    v_mfma_f32_16x16x32_bf16 v[96:99], a[16:19], a[224:227], v[96:99]
    v_exp_f32 v34, v34
    v_mfma_f32_16x16x32_bf16 v[100:103], a[40:43], a[224:227], v[100:103]
    v_exp_f32 v50, v50
    v_mfma_f32_16x16x32_bf16 v[104:107], a[64:67], a[224:227], v[104:107]
    buffer_store_dwordx2 v[190:191], v11, s[16:19], s58 offen offset:1408 sc1
    v_mfma_f32_16x16x32_bf16 v[108:111], a[88:91], a[224:227], v[108:111]
    ds_read_b128 a[248:251], v2 offset:30720
    s_waitcnt lgkmcnt(4)
    v_mfma_f32_16x16x32_bf16 v[96:99], a[20:23], a[228:231], v[96:99]
    v_exp_f32 v66, v66
    v_mfma_f32_16x16x32_bf16 v[100:103], a[44:47], a[228:231], v[100:103]
    v_exp_f32 v82, v82
    v_mfma_f32_16x16x32_bf16 v[104:107], a[68:71], a[228:231], v[104:107]
    ds_read_b128 a[252:255], v2 offset:31744
    v_fma_f32 v83, v83, s40, -v15
    v_mfma_f32_16x16x32_bf16 v[108:111], a[92:95], a[228:231], v[108:111]
    v_cvt_pk_bf16_f32 v144, v96, v97
    v_cvt_pk_bf16_f32 v145, v98, v99
    v_mfma_f32_16x16x32_bf16 v[112:115], a[0:3], a[232:235], 0
    v_cvt_pk_bf16_f32 v146, v100, v101
    v_cvt_pk_bf16_f32 v147, v102, v103
    v_mfma_f32_16x16x32_bf16 v[116:119], a[24:27], a[232:235], 0
    v_cvt_pk_bf16_f32 v148, v104, v105
    v_cvt_pk_bf16_f32 v149, v106, v107
    v_mfma_f32_16x16x32_bf16 v[120:123], a[48:51], a[232:235], 0
    ds_read_b128 a[192:195], v2 offset:32768
    v_cvt_pk_bf16_f32 v150, v108, v109
    v_mfma_f32_16x16x32_bf16 v[124:127], a[72:75], a[232:235], 0
    v_cvt_pk_bf16_f32 v151, v110, v111
    v_fma_f32 v36, v36, s40, -v12
    s_waitcnt lgkmcnt(3)
    v_mfma_f32_16x16x32_bf16 v[112:115], a[4:7], a[236:239], v[112:115]
    v_exp_f32 v35, v35
    v_mfma_f32_16x16x32_bf16 v[116:119], a[28:31], a[236:239], v[116:119]
    v_exp_f32 v51, v51
    v_mfma_f32_16x16x32_bf16 v[120:123], a[52:55], a[236:239], v[120:123]
    ds_read_b128 a[196:199], v2 offset:33792
    v_fma_f32 v52, v52, s40, -v13
    v_mfma_f32_16x16x32_bf16 v[124:127], a[76:79], a[236:239], v[124:127]
    v_fma_f32 v68, v68, s40, -v14
    v_mfma_f32_16x16x32_bf16 v[112:115], a[8:11], a[240:243], v[112:115]
    v_exp_f32 v67, v67
    v_mfma_f32_16x16x32_bf16 v[116:119], a[32:35], a[240:243], v[116:119]
    v_exp_f32 v83, v83
    v_mfma_f32_16x16x32_bf16 v[120:123], a[56:59], a[240:243], v[120:123]
    ds_read_b128 a[200:203], v2 offset:34816
    v_fma_f32 v84, v84, s40, -v15
    v_mfma_f32_16x16x32_bf16 v[124:127], a[80:83], a[240:243], v[124:127]
    v_add_f32 v20, v32, v33
    v_fma_f32 v37, v37, s40, -v12
    v_mfma_f32_16x16x32_bf16 v[112:115], a[12:15], a[244:247], v[112:115]
    v_exp_f32 v36, v36
    v_mfma_f32_16x16x32_bf16 v[116:119], a[36:39], a[244:247], v[116:119]
    v_add_f32 v21, v48, v49
    v_fma_f32 v53, v53, s40, -v13
    v_mfma_f32_16x16x32_bf16 v[120:123], a[60:63], a[244:247], v[120:123]
    buffer_store_dwordx2 v[224:225], v11, s[16:19], s52 offen offset:0 sc1
    v_mfma_f32_16x16x32_bf16 v[124:127], a[84:87], a[244:247], v[124:127]
    ds_read_b128 a[204:207], v2 offset:35840
    s_waitcnt lgkmcnt(4)
    v_mfma_f32_16x16x32_bf16 v[112:115], a[16:19], a[248:251], v[112:115]
    v_exp_f32 v52, v52
    v_mfma_f32_16x16x32_bf16 v[116:119], a[40:43], a[248:251], v[116:119]
    v_add_f32 v22, v64, v65
    v_fma_f32 v69, v69, s40, -v14
    v_mfma_f32_16x16x32_bf16 v[120:123], a[64:67], a[248:251], v[120:123]
    ds_read_b128 a[208:211], v2 offset:36864
    v_add_f32 v23, v80, v81
    v_mfma_f32_16x16x32_bf16 v[124:127], a[88:91], a[248:251], v[124:127]
    v_exp_f32 v68, v68
    v_mfma_f32_16x16x32_bf16 v[112:115], a[20:23], a[252:255], v[112:115]
    v_exp_f32 v84, v84
    v_mfma_f32_16x16x32_bf16 v[116:119], a[44:47], a[252:255], v[116:119]
    v_fma_f32 v85, v85, s40, -v15
    v_add_f32 v20, v20, v34
    v_mfma_f32_16x16x32_bf16 v[120:123], a[68:71], a[252:255], v[120:123]
    ds_read_b128 a[212:215], v2 offset:37888
    v_fma_f32 v38, v38, s40, -v12
    v_mfma_f32_16x16x32_bf16 v[124:127], a[92:95], a[252:255], v[124:127]
    v_cvt_pk_bf16_f32 v152, v112, v113
    v_cvt_pk_bf16_f32 v153, v114, v115
    s_waitcnt lgkmcnt(3)
    v_mfma_f32_16x16x32_bf16 v[96:99], a[0:3], a[192:195], 0
    v_cvt_pk_bf16_f32 v154, v116, v117
    v_cvt_pk_bf16_f32 v155, v118, v119
    v_mfma_f32_16x16x32_bf16 v[100:103], a[24:27], a[192:195], 0
    v_cvt_pk_bf16_f32 v156, v120, v121
    v_cvt_pk_bf16_f32 v157, v122, v123
    v_mfma_f32_16x16x32_bf16 v[104:107], a[48:51], a[192:195], 0
    buffer_store_dwordx2 v[226:227], v11, s[16:19], s52 offen offset:384 sc1
    v_mfma_f32_16x16x32_bf16 v[108:111], a[72:75], a[192:195], 0
    ds_read_b128 a[216:219], v2 offset:38912
    v_mfma_f32_16x16x32_bf16 v[96:99], a[4:7], a[196:199], v[96:99]
    v_cvt_pk_bf16_f32 v158, v124, v125
    v_cvt_pk_bf16_f32 v159, v126, v127
    v_mfma_f32_16x16x32_bf16 v[100:103], a[28:31], a[196:199], v[100:103]
    v_exp_f32 v37, v37
    v_mfma_f32_16x16x32_bf16 v[104:107], a[52:55], a[196:199], v[104:107]
    buffer_load_dwordx4 a[160:163], v9, s[8:11], s28 offen offset:256 nt
    v_add_f32 v21, v21, v50
    v_mfma_f32_16x16x32_bf16 v[108:111], a[76:79], a[196:199], v[108:111]
    buffer_load_dwordx4 a[164:167], v9, s[8:11], s28 offen offset:320 nt
    v_fma_f32 v54, v54, s40, -v13
    v_mfma_f32_16x16x32_bf16 v[96:99], a[8:11], a[200:203], v[96:99]
    ds_read_b128 a[220:223], v2 offset:39936
    v_add_f32 v22, v22, v66
    v_mfma_f32_16x16x32_bf16 v[100:103], a[32:35], a[200:203], v[100:103]
    v_exp_f32 v53, v53
    v_mfma_f32_16x16x32_bf16 v[104:107], a[56:59], a[200:203], v[104:107]
    ds_read_b128 a[224:227], v2 offset:40960
    v_fma_f32 v70, v70, s40, -v14
    v_mfma_f32_16x16x32_bf16 v[108:111], a[80:83], a[200:203], v[108:111]
    v_add_f32 v23, v23, v82
    s_waitcnt lgkmcnt(4)
    v_mfma_f32_16x16x32_bf16 v[96:99], a[12:15], a[204:207], v[96:99]
    v_exp_f32 v69, v69
    v_mfma_f32_16x16x32_bf16 v[100:103], a[36:39], a[204:207], v[100:103]
    v_exp_f32 v85, v85
    v_mfma_f32_16x16x32_bf16 v[104:107], a[60:63], a[204:207], v[104:107]
    buffer_store_dwordx2 v[228:229], v11, s[16:19], s52 offen offset:768 sc1
    v_mfma_f32_16x16x32_bf16 v[108:111], a[84:87], a[204:207], v[108:111]
    ds_read_b128 a[228:231], v2 offset:41984
    v_fma_f32 v86, v86, s40, -v15
    v_mfma_f32_16x16x32_bf16 v[96:99], a[16:19], a[208:211], v[96:99]
    v_add_f32 v20, v20, v35
    v_fma_f32 v39, v39, s40, -v12
    v_mfma_f32_16x16x32_bf16 v[100:103], a[40:43], a[208:211], v[100:103]
    ds_read_b128 a[232:235], v2 offset:43008
    v_add_f32 v21, v21, v51
    v_mfma_f32_16x16x32_bf16 v[104:107], a[64:67], a[208:211], v[104:107]
    v_exp_f32 v38, v38
    v_mfma_f32_16x16x32_bf16 v[108:111], a[88:91], a[208:211], v[108:111]
    v_exp_f32 v54, v54
    s_waitcnt lgkmcnt(4)
    v_mfma_f32_16x16x32_bf16 v[96:99], a[20:23], a[212:215], v[96:99]
    v_fma_f32 v55, v55, s40, -v13
    v_add_f32 v22, v22, v67
    v_mfma_f32_16x16x32_bf16 v[100:103], a[44:47], a[212:215], v[100:103]
    ds_read_b128 a[236:239], v2 offset:44032
    v_fma_f32 v71, v71, s40, -v14
    v_mfma_f32_16x16x32_bf16 v[104:107], a[68:71], a[212:215], v[104:107]
    v_exp_f32 v70, v70
    v_mfma_f32_16x16x32_bf16 v[108:111], a[92:95], a[212:215], v[108:111]
    v_cvt_pk_bf16_f32 v160, v96, v97
    v_mfma_f32_16x16x32_bf16 v[112:115], a[0:3], a[216:219], 0
    v_cvt_pk_bf16_f32 v161, v98, v99
    v_cvt_pk_bf16_f32 v162, v100, v101
    v_mfma_f32_16x16x32_bf16 v[116:119], a[24:27], a[216:219], 0
    buffer_store_dwordx2 v[230:231], v11, s[16:19], s52 offen offset:1152 sc1
    v_mfma_f32_16x16x32_bf16 v[120:123], a[48:51], a[216:219], 0
    ds_read_b128 a[240:243], v2 offset:45056
    v_cvt_pk_bf16_f32 v163, v102, v103
    v_mfma_f32_16x16x32_bf16 v[124:127], a[72:75], a[216:219], 0
    v_cvt_pk_bf16_f32 v164, v104, v105
    v_cvt_pk_bf16_f32 v165, v106, v107
    s_waitcnt lgkmcnt(4)
    v_mfma_f32_16x16x32_bf16 v[112:115], a[4:7], a[220:223], v[112:115]
    v_cvt_pk_bf16_f32 v166, v108, v109
    v_cvt_pk_bf16_f32 v167, v110, v111
    v_mfma_f32_16x16x32_bf16 v[116:119], a[28:31], a[220:223], v[116:119]
    ds_read_b128 a[244:247], v2 offset:46080
    v_add_f32 v23, v23, v83
    v_mfma_f32_16x16x32_bf16 v[120:123], a[52:55], a[220:223], v[120:123]
    v_exp_f32 v86, v86
    v_mfma_f32_16x16x32_bf16 v[124:127], a[76:79], a[220:223], v[124:127]
    v_fma_f32 v87, v87, s40, -v15
    v_add_f32 v20, v20, v36
    v_mfma_f32_16x16x32_bf16 v[112:115], a[8:11], a[224:227], v[112:115]
    v_exp_f32 v39, v39
    v_mfma_f32_16x16x32_bf16 v[116:119], a[32:35], a[224:227], v[116:119]
    ds_read_b128 a[248:251], v2 offset:47104
    v_fma_f32 v40, v40, s40, -v12
    v_mfma_f32_16x16x32_bf16 v[120:123], a[56:59], a[224:227], v[120:123]
    v_add_f32 v21, v21, v52
    v_fma_f32 v56, v56, s40, -v13
    v_mfma_f32_16x16x32_bf16 v[124:127], a[80:83], a[224:227], v[124:127]
    v_add_f32 v22, v22, v68
    s_waitcnt lgkmcnt(3)
    v_mfma_f32_16x16x32_bf16 v[112:115], a[12:15], a[228:231], v[112:115]
    v_exp_f32 v55, v55
    v_mfma_f32_16x16x32_bf16 v[116:119], a[36:39], a[228:231], v[116:119]
    buffer_store_dwordx2 v[232:233], v11, s[16:19], s54 offen offset:0 sc1
    v_mfma_f32_16x16x32_bf16 v[120:123], a[60:63], a[228:231], v[120:123]
    ds_read_b128 a[252:255], v2 offset:48128
    v_fma_f32 v72, v72, s40, -v14
    v_mfma_f32_16x16x32_bf16 v[124:127], a[84:87], a[228:231], v[124:127]
    v_exp_f32 v71, v71
    v_mfma_f32_16x16x32_bf16 v[112:115], a[16:19], a[232:235], v[112:115]
    v_add_f32 v23, v23, v84
    v_fma_f32 v88, v88, s40, -v15
    v_mfma_f32_16x16x32_bf16 v[116:119], a[40:43], a[232:235], v[116:119]
    ds_read_b128 a[192:195], v2 offset:49152
    v_add_f32 v20, v20, v37
    v_mfma_f32_16x16x32_bf16 v[120:123], a[64:67], a[232:235], v[120:123]
    v_exp_f32 v87, v87
    v_mfma_f32_16x16x32_bf16 v[124:127], a[88:91], a[232:235], v[124:127]
    v_exp_f32 v40, v40
    v_mfma_f32_16x16x32_bf16 v[112:115], a[20:23], a[236:239], v[112:115]
    v_fma_f32 v41, v41, s40, -v12
    v_add_f32 v21, v21, v53
    v_mfma_f32_16x16x32_bf16 v[116:119], a[44:47], a[236:239], v[116:119]
    ds_read_b128 a[196:199], v2 offset:50176
    v_fma_f32 v57, v57, s40, -v13
    v_mfma_f32_16x16x32_bf16 v[120:123], a[68:71], a[236:239], v[120:123]
    v_exp_f32 v56, v56
    v_mfma_f32_16x16x32_bf16 v[124:127], a[92:95], a[236:239], v[124:127]
    v_cvt_pk_bf16_f32 v168, v112, v113
    s_waitcnt lgkmcnt(3)
    v_mfma_f32_16x16x32_bf16 v[96:99], a[0:3], a[240:243], 0
    v_cvt_pk_bf16_f32 v169, v114, v115
    v_cvt_pk_bf16_f32 v170, v116, v117
    v_mfma_f32_16x16x32_bf16 v[100:103], a[24:27], a[240:243], 0
    buffer_store_dwordx2 v[234:235], v11, s[16:19], s54 offen offset:384 sc1
    v_mfma_f32_16x16x32_bf16 v[104:107], a[48:51], a[240:243], 0
    ds_read_b128 a[200:203], v2 offset:51200
    v_cvt_pk_bf16_f32 v171, v118, v119
    v_mfma_f32_16x16x32_bf16 v[108:111], a[72:75], a[240:243], 0
    v_cvt_pk_bf16_f32 v172, v120, v121
    v_cvt_pk_bf16_f32 v173, v122, v123
    v_mfma_f32_16x16x32_bf16 v[96:99], a[4:7], a[244:247], v[96:99]
    v_cvt_pk_bf16_f32 v174, v124, v125
    v_cvt_pk_bf16_f32 v175, v126, v127
    v_mfma_f32_16x16x32_bf16 v[100:103], a[28:31], a[244:247], v[100:103]
    ds_read_b128 a[204:207], v2 offset:52224
    v_add_f32 v22, v22, v69
    v_mfma_f32_16x16x32_bf16 v[104:107], a[52:55], a[244:247], v[104:107]
    v_exp_f32 v72, v72
    v_mfma_f32_16x16x32_bf16 v[108:111], a[76:79], a[244:247], v[108:111]
    v_fma_f32 v73, v73, s40, -v14
    v_add_f32 v23, v23, v85
    v_mfma_f32_16x16x32_bf16 v[96:99], a[8:11], a[248:251], v[96:99]
    v_exp_f32 v88, v88
    v_mfma_f32_16x16x32_bf16 v[100:103], a[32:35], a[248:251], v[100:103]
    ds_read_b128 a[208:211], v2 offset:53248
    v_fma_f32 v89, v89, s40, -v15
    v_mfma_f32_16x16x32_bf16 v[104:107], a[56:59], a[248:251], v[104:107]
    v_add_f32 v20, v20, v38
    v_fma_f32 v42, v42, s40, -v12
    v_mfma_f32_16x16x32_bf16 v[108:111], a[80:83], a[248:251], v[108:111]
    v_add_f32 v21, v21, v54
    s_waitcnt lgkmcnt(3)
    v_mfma_f32_16x16x32_bf16 v[96:99], a[12:15], a[252:255], v[96:99]
    v_exp_f32 v41, v41
    v_mfma_f32_16x16x32_bf16 v[100:103], a[36:39], a[252:255], v[100:103]
    buffer_store_dwordx2 v[236:237], v11, s[16:19], s54 offen offset:768 sc1
    v_mfma_f32_16x16x32_bf16 v[104:107], a[60:63], a[252:255], v[104:107]
    buffer_load_dwordx4 a[184:187], v9, s[8:11], s30 offen offset:256 nt
    v_fma_f32 v58, v58, s40, -v13
    v_mfma_f32_16x16x32_bf16 v[108:111], a[84:87], a[252:255], v[108:111]
    buffer_load_dwordx4 a[188:191], v9, s[8:11], s30 offen offset:320 nt
    v_add_f32 v22, v22, v70
    v_mfma_f32_16x16x32_bf16 v[96:99], a[16:19], a[192:195], v[96:99]
    ds_read_b128 a[212:215], v2 offset:54272
    v_fma_f32 v74, v74, s40, -v14
    v_mfma_f32_16x16x32_bf16 v[100:103], a[40:43], a[192:195], v[100:103]
    ds_read_b128 a[216:219], v2 offset:55296
    v_add_f32 v23, v23, v86
    v_mfma_f32_16x16x32_bf16 v[104:107], a[64:67], a[192:195], v[104:107]
    v_exp_f32 v57, v57
    v_mfma_f32_16x16x32_bf16 v[108:111], a[88:91], a[192:195], v[108:111]
    v_exp_f32 v73, v73
    v_mfma_f32_16x16x32_bf16 v[96:99], a[20:23], a[196:199], v[96:99]
    ds_read_b128 a[220:223], v2 offset:56320
    v_fma_f32 v90, v90, s40, -v15
    v_mfma_f32_16x16x32_bf16 v[100:103], a[44:47], a[196:199], v[100:103]
    v_exp_f32 v89, v89
    v_mfma_f32_16x16x32_bf16 v[104:107], a[68:71], a[196:199], v[104:107]
    v_add_f32 v20, v20, v39
    v_fma_f32 v43, v43, s40, -v12
    v_mfma_f32_16x16x32_bf16 v[108:111], a[92:95], a[196:199], v[108:111]
    v_cvt_pk_bf16_f32 v176, v96, v97
    s_waitcnt lgkmcnt(3)
    v_mfma_f32_16x16x32_bf16 v[112:115], a[0:3], a[200:203], 0
    buffer_store_dwordx2 v[238:239], v11, s[16:19], s54 offen offset:1152 sc1
    v_mfma_f32_16x16x32_bf16 v[116:119], a[24:27], a[200:203], 0
    ds_read_b128 a[224:227], v2 offset:57344
    v_cvt_pk_bf16_f32 v177, v98, v99
    v_mfma_f32_16x16x32_bf16 v[120:123], a[48:51], a[200:203], 0
    v_cvt_pk_bf16_f32 v178, v100, v101
    v_cvt_pk_bf16_f32 v179, v102, v103
    v_mfma_f32_16x16x32_bf16 v[124:127], a[72:75], a[200:203], 0
    v_cvt_pk_bf16_f32 v180, v104, v105
    v_cvt_pk_bf16_f32 v181, v106, v107
    v_mfma_f32_16x16x32_bf16 v[112:115], a[4:7], a[204:207], v[112:115]
    ds_read_b128 a[228:231], v2 offset:58368
    v_cvt_pk_bf16_f32 v182, v108, v109
    v_mfma_f32_16x16x32_bf16 v[116:119], a[28:31], a[204:207], v[116:119]
    v_cvt_pk_bf16_f32 v183, v110, v111
    v_add_f32 v21, v21, v55
    v_mfma_f32_16x16x32_bf16 v[120:123], a[52:55], a[204:207], v[120:123]
    v_exp_f32 v42, v42
    v_mfma_f32_16x16x32_bf16 v[124:127], a[76:79], a[204:207], v[124:127]
    v_exp_f32 v58, v58
    v_mfma_f32_16x16x32_bf16 v[112:115], a[8:11], a[208:211], v[112:115]
    ds_read_b128 a[232:235], v2 offset:59392
    v_fma_f32 v59, v59, s40, -v13
    v_mfma_f32_16x16x32_bf16 v[116:119], a[32:35], a[208:211], v[116:119]
    v_add_f32 v22, v22, v71
    v_fma_f32 v75, v75, s40, -v14
    v_mfma_f32_16x16x32_bf16 v[120:123], a[56:59], a[208:211], v[120:123]
    v_exp_f32 v74, v74
    v_mfma_f32_16x16x32_bf16 v[124:127], a[80:83], a[208:211], v[124:127]
    v_add_f32 v23, v23, v87
    s_waitcnt lgkmcnt(3)
    v_mfma_f32_16x16x32_bf16 v[112:115], a[12:15], a[212:215], v[112:115]
    buffer_store_dwordx2 v[240:241], v11, s[16:19], s56 offen offset:0 sc1
    v_mfma_f32_16x16x32_bf16 v[116:119], a[36:39], a[212:215], v[116:119]
    ds_read_b128 a[236:239], v2 offset:60416
    v_fma_f32 v91, v91, s40, -v15
    v_mfma_f32_16x16x32_bf16 v[120:123], a[60:63], a[212:215], v[120:123]
    v_exp_f32 v90, v90
    v_mfma_f32_16x16x32_bf16 v[124:127], a[84:87], a[212:215], v[124:127]
    v_add_f32 v20, v20, v40
    v_fma_f32 v44, v44, s40, -v12
    v_mfma_f32_16x16x32_bf16 v[112:115], a[16:19], a[216:219], v[112:115]
    ds_read_b128 a[240:243], v2 offset:61440
    v_add_f32 v21, v21, v56
    v_mfma_f32_16x16x32_bf16 v[116:119], a[40:43], a[216:219], v[116:119]
    v_exp_f32 v43, v43
    v_mfma_f32_16x16x32_bf16 v[120:123], a[64:67], a[216:219], v[120:123]
    v_exp_f32 v59, v59
    v_mfma_f32_16x16x32_bf16 v[124:127], a[88:91], a[216:219], v[124:127]
    v_fma_f32 v60, v60, s40, -v13
    v_add_f32 v22, v22, v72
    v_mfma_f32_16x16x32_bf16 v[112:115], a[20:23], a[220:223], v[112:115]
    ds_read_b128 a[244:247], v2 offset:62464
    v_fma_f32 v76, v76, s40, -v14
    v_mfma_f32_16x16x32_bf16 v[116:119], a[44:47], a[220:223], v[116:119]
    v_exp_f32 v75, v75
    v_mfma_f32_16x16x32_bf16 v[120:123], a[68:71], a[220:223], v[120:123]
    v_add_f32 v23, v23, v88
    v_fma_f32 v92, v92, s40, -v15
    v_mfma_f32_16x16x32_bf16 v[124:127], a[92:95], a[220:223], v[124:127]
    v_cvt_pk_bf16_f32 v184, v112, v113
    s_waitcnt lgkmcnt(3)
    v_mfma_f32_16x16x32_bf16 v[96:99], a[0:3], a[224:227], 0
    buffer_store_dwordx2 v[242:243], v11, s[16:19], s56 offen offset:384 sc1
    v_mfma_f32_16x16x32_bf16 v[100:103], a[24:27], a[224:227], 0
    ds_read_b128 a[248:251], v2 offset:63488
    v_cvt_pk_bf16_f32 v185, v114, v115
    v_mfma_f32_16x16x32_bf16 v[104:107], a[48:51], a[224:227], 0
    v_cvt_pk_bf16_f32 v186, v116, v117
    v_cvt_pk_bf16_f32 v187, v118, v119
    v_mfma_f32_16x16x32_bf16 v[108:111], a[72:75], a[224:227], 0
    v_cvt_pk_bf16_f32 v188, v120, v121
    v_cvt_pk_bf16_f32 v189, v122, v123
    v_mfma_f32_16x16x32_bf16 v[96:99], a[4:7], a[228:231], v[96:99]
    ds_read_b128 a[252:255], v2 offset:64512
    v_cvt_pk_bf16_f32 v190, v124, v125
    v_mfma_f32_16x16x32_bf16 v[100:103], a[28:31], a[228:231], v[100:103]
    v_cvt_pk_bf16_f32 v191, v126, v127
    v_add_f32 v20, v20, v41
    v_mfma_f32_16x16x32_bf16 v[104:107], a[52:55], a[228:231], v[104:107]
    v_exp_f32 v91, v91
    v_mfma_f32_16x16x32_bf16 v[108:111], a[76:79], a[228:231], v[108:111]
    v_exp_f32 v44, v44
    v_mfma_f32_16x16x32_bf16 v[96:99], a[8:11], a[232:235], v[96:99]
    ds_read_b128 a[192:195], v3 offset:0
    v_fma_f32 v45, v45, s40, -v12
    v_mfma_f32_16x16x32_bf16 v[100:103], a[32:35], a[232:235], v[100:103]
    v_add_f32 v21, v21, v57
    v_fma_f32 v61, v61, s40, -v13
    v_mfma_f32_16x16x32_bf16 v[104:107], a[56:59], a[232:235], v[104:107]
    v_exp_f32 v60, v60
    v_mfma_f32_16x16x32_bf16 v[108:111], a[80:83], a[232:235], v[108:111]
    v_add_f32 v22, v22, v73
    s_waitcnt lgkmcnt(3)
    v_mfma_f32_16x16x32_bf16 v[96:99], a[12:15], a[236:239], v[96:99]
    buffer_store_dwordx2 v[244:245], v11, s[16:19], s56 offen offset:768 sc1
    v_mfma_f32_16x16x32_bf16 v[100:103], a[36:39], a[236:239], v[100:103]
    ds_read_b128 a[196:199], v3 offset:1024
    v_fma_f32 v77, v77, s40, -v14
    v_mfma_f32_16x16x32_bf16 v[104:107], a[60:63], a[236:239], v[104:107]
    v_exp_f32 v76, v76
    v_mfma_f32_16x16x32_bf16 v[108:111], a[84:87], a[236:239], v[108:111]
    ds_read_b128 a[200:203], v3 offset:2048
    v_add_f32 v23, v23, v89
    v_mfma_f32_16x16x32_bf16 v[96:99], a[16:19], a[240:243], v[96:99]
    v_exp_f32 v92, v92
    v_mfma_f32_16x16x32_bf16 v[100:103], a[40:43], a[240:243], v[100:103]
    v_fma_f32 v93, v93, s40, -v15
    v_add_f32 v20, v20, v42
    v_mfma_f32_16x16x32_bf16 v[104:107], a[64:67], a[240:243], v[104:107]
    v_exp_f32 v45, v45
    v_mfma_f32_16x16x32_bf16 v[108:111], a[88:91], a[240:243], v[108:111]
    ds_read_b128 a[204:207], v3 offset:3072
    v_fma_f32 v46, v46, s40, -v12
    v_mfma_f32_16x16x32_bf16 v[96:99], a[20:23], a[244:247], v[96:99]
    v_add_f32 v21, v21, v58
    v_fma_f32 v62, v62, s40, -v13
    v_mfma_f32_16x16x32_bf16 v[100:103], a[44:47], a[244:247], v[100:103]
    v_exp_f32 v61, v61
    v_mfma_f32_16x16x32_bf16 v[104:107], a[68:71], a[244:247], v[104:107]
    v_add_f32 v22, v22, v74
    v_fma_f32 v78, v78, s40, -v14
    v_mfma_f32_16x16x32_bf16 v[108:111], a[92:95], a[244:247], v[108:111]
    buffer_store_dwordx2 v[246:247], v11, s[16:19], s56 offen offset:1152 sc1
    s_waitcnt lgkmcnt(3)
    v_mfma_f32_16x16x32_bf16 v[112:115], a[0:3], a[248:251], 0
    ds_read_b128 a[208:211], v3 offset:4096
    v_cvt_pk_bf16_f32 v192, v96, v97
    v_mfma_f32_16x16x32_bf16 v[116:119], a[24:27], a[248:251], 0
    v_cvt_pk_bf16_f32 v193, v98, v99
    v_cvt_pk_bf16_f32 v194, v100, v101
    v_mfma_f32_16x16x32_bf16 v[120:123], a[48:51], a[248:251], 0
    v_cvt_pk_bf16_f32 v195, v102, v103
    v_cvt_pk_bf16_f32 v196, v104, v105
    v_mfma_f32_16x16x32_bf16 v[124:127], a[72:75], a[248:251], 0
    ds_read_b128 a[212:215], v3 offset:5120
    v_cvt_pk_bf16_f32 v197, v106, v107
    v_mfma_f32_16x16x32_bf16 v[112:115], a[4:7], a[252:255], v[112:115]
    v_cvt_pk_bf16_f32 v198, v108, v109
    v_cvt_pk_bf16_f32 v199, v110, v111
    v_mfma_f32_16x16x32_bf16 v[116:119], a[28:31], a[252:255], v[116:119]
    v_exp_f32 v77, v77
    v_mfma_f32_16x16x32_bf16 v[120:123], a[52:55], a[252:255], v[120:123]
    v_add_f32 v23, v23, v90
    v_fma_f32 v94, v94, s40, -v15
    v_mfma_f32_16x16x32_bf16 v[124:127], a[76:79], a[252:255], v[124:127]
    ds_read_b128 a[216:219], v3 offset:6144
    v_add_f32 v20, v20, v43
    v_mfma_f32_16x16x32_bf16 v[112:115], a[8:11], a[192:195], v[112:115]
    v_exp_f32 v93, v93
    v_mfma_f32_16x16x32_bf16 v[116:119], a[32:35], a[192:195], v[116:119]
    v_exp_f32 v46, v46
    v_mfma_f32_16x16x32_bf16 v[120:123], a[56:59], a[192:195], v[120:123]
    v_fma_f32 v47, v47, s40, -v12
    v_add_f32 v21, v21, v59
    v_mfma_f32_16x16x32_bf16 v[124:127], a[80:83], a[192:195], v[124:127]
    buffer_store_dwordx2 v[248:249], v11, s[16:19], s58 offen offset:0 sc1
    s_waitcnt lgkmcnt(3)
    v_mfma_f32_16x16x32_bf16 v[112:115], a[12:15], a[196:199], v[112:115]
    ds_read_b128 a[220:223], v3 offset:7168
    v_fma_f32 v63, v63, s40, -v13
    v_mfma_f32_16x16x32_bf16 v[116:119], a[36:39], a[196:199], v[116:119]
    v_exp_f32 v62, v62
    v_mfma_f32_16x16x32_bf16 v[120:123], a[60:63], a[196:199], v[120:123]
    v_add_f32 v22, v22, v75
    v_fma_f32 v79, v79, s40, -v14
    v_mfma_f32_16x16x32_bf16 v[124:127], a[84:87], a[196:199], v[124:127]
    ds_read_b128 a[224:227], v3 offset:8192
    v_add_f32 v23, v23, v91
    v_mfma_f32_16x16x32_bf16 v[112:115], a[16:19], a[200:203], v[112:115]
    v_exp_f32 v78, v78
    v_mfma_f32_16x16x32_bf16 v[116:119], a[40:43], a[200:203], v[116:119]
    v_exp_f32 v94, v94
    v_mfma_f32_16x16x32_bf16 v[120:123], a[64:67], a[200:203], v[120:123]
    v_fma_f32 v95, v95, s40, -v15
    v_add_f32 v20, v20, v44
    v_mfma_f32_16x16x32_bf16 v[124:127], a[88:91], a[200:203], v[124:127]
    ds_read_b128 a[228:231], v3 offset:9216
    v_add_f32 v21, v21, v60
    v_mfma_f32_16x16x32_bf16 v[112:115], a[20:23], a[204:207], v[112:115]
    v_exp_f32 v47, v47
    v_mfma_f32_16x16x32_bf16 v[116:119], a[44:47], a[204:207], v[116:119]
    v_exp_f32 v63, v63
    v_mfma_f32_16x16x32_bf16 v[120:123], a[68:71], a[204:207], v[120:123]
    v_add_f32 v22, v22, v76
    v_add_f32 v23, v23, v92
    v_mfma_f32_16x16x32_bf16 v[124:127], a[92:95], a[204:207], v[124:127]
    buffer_store_dwordx2 v[250:251], v11, s[16:19], s58 offen offset:384 sc1
    s_waitcnt lgkmcnt(3)
    v_mfma_f32_16x16x32_bf16 v[96:99], a[0:3], a[208:211], 0
    ds_read_b128 a[232:235], v3 offset:10240
    v_cvt_pk_bf16_f32 v200, v112, v113
    v_mfma_f32_16x16x32_bf16 v[100:103], a[24:27], a[208:211], 0
    v_cvt_pk_bf16_f32 v201, v114, v115
    v_cvt_pk_bf16_f32 v202, v116, v117
    v_mfma_f32_16x16x32_bf16 v[104:107], a[48:51], a[208:211], 0
    v_cvt_pk_bf16_f32 v203, v118, v119
    v_cvt_pk_bf16_f32 v204, v120, v121
    v_mfma_f32_16x16x32_bf16 v[108:111], a[72:75], a[208:211], 0
    ds_read_b128 a[236:239], v3 offset:11264
    v_cvt_pk_bf16_f32 v205, v122, v123
    v_mfma_f32_16x16x32_bf16 v[96:99], a[4:7], a[212:215], v[96:99]
    v_cvt_pk_bf16_f32 v206, v124, v125
    v_cvt_pk_bf16_f32 v207, v126, v127
    v_mfma_f32_16x16x32_bf16 v[100:103], a[28:31], a[212:215], v[100:103]
    v_exp_f32 v79, v79
    v_mfma_f32_16x16x32_bf16 v[104:107], a[52:55], a[212:215], v[104:107]
    v_exp_f32 v95, v95
    v_mfma_f32_16x16x32_bf16 v[108:111], a[76:79], a[212:215], v[108:111]
    ds_read_b128 a[240:243], v3 offset:12288
    v_add_f32 v20, v20, v45
    v_mfma_f32_16x16x32_bf16 v[96:99], a[8:11], a[216:219], v[96:99]
    v_add_f32 v21, v21, v61
    v_add_f32 v22, v22, v77
    v_mfma_f32_16x16x32_bf16 v[100:103], a[32:35], a[216:219], v[100:103]
    v_add_f32 v23, v23, v93
    v_add_f32 v20, v20, v46
    v_mfma_f32_16x16x32_bf16 v[104:107], a[56:59], a[216:219], v[104:107]
    v_add_f32 v21, v21, v62
    v_add_f32 v22, v22, v78
    v_mfma_f32_16x16x32_bf16 v[108:111], a[80:83], a[216:219], v[108:111]
    buffer_store_dwordx2 v[252:253], v11, s[16:19], s58 offen offset:768 sc1
    s_waitcnt lgkmcnt(3)
    v_mfma_f32_16x16x32_bf16 v[96:99], a[12:15], a[220:223], v[96:99]
    ds_read_b128 a[244:247], v3 offset:13312
    v_add_f32 v23, v23, v94
    v_mfma_f32_16x16x32_bf16 v[100:103], a[36:39], a[220:223], v[100:103]
    v_add_f32 v20, v20, v47
    v_add_f32 v21, v21, v63
    v_mfma_f32_16x16x32_bf16 v[104:107], a[60:63], a[220:223], v[104:107]
    ds_read_b128 a[248:251], v3 offset:14336
    v_add_f32 v22, v22, v79
    v_mfma_f32_16x16x32_bf16 v[108:111], a[84:87], a[220:223], v[108:111]
    v_add_f32 v23, v23, v95
    v_permlane16_swap_b32 v20, v21
    v_mfma_f32_16x16x32_bf16 v[96:99], a[16:19], a[224:227], v[96:99]
    v_permlane16_swap_b32 v22, v23
    v_add_f32 v20, v20, v21
    v_mfma_f32_16x16x32_bf16 v[100:103], a[40:43], a[224:227], v[100:103]
    v_add_f32 v22, v22, v23
    s_add_u32 s26, s26, 25165824
    v_mfma_f32_16x16x32_bf16 v[104:107], a[64:67], a[224:227], v[104:107]
    ds_read_b128 a[252:255], v3 offset:15360
    v_permlane32_swap_b32 v20, v22
    v_mfma_f32_16x16x32_bf16 v[108:111], a[88:91], a[224:227], v[108:111]
    v_add_f32 v20, v20, v22
    s_add_u32 s28, s28, 25165824
    v_mfma_f32_16x16x32_bf16 v[96:99], a[20:23], a[228:231], v[96:99]
    v_rcp_f32 v20, v20
    v_mfma_f32_16x16x32_bf16 v[100:103], a[44:47], a[228:231], v[100:103]
    v_mov_b32 v22, v20
    s_add_u32 s30, s30, 25165824
    v_mfma_f32_16x16x32_bf16 v[104:107], a[68:71], a[228:231], v[104:107]
    buffer_store_dwordx2 v[254:255], v11, s[16:19], s58 offen offset:1152 sc1
    v_mfma_f32_16x16x32_bf16 v[108:111], a[92:95], a[228:231], v[108:111]
    v_permlane32_swap_b32 v20, v22
    s_waitcnt lgkmcnt(3)
    v_mfma_f32_16x16x32_bf16 v[112:115], a[0:3], a[232:235], 0
    v_mov_b32 v21, v20
    v_mov_b32 v23, v22
    v_mfma_f32_16x16x32_bf16 v[116:119], a[24:27], a[232:235], 0
    v_permlane16_swap_b32 v20, v21
    v_mul_f32 v32, v32, v20
    v_mfma_f32_16x16x32_bf16 v[120:123], a[48:51], a[232:235], 0
    v_mul_f32 v33, v33, v20
    v_cvt_pk_bf16_f32 v32, v32, v33
    v_mfma_f32_16x16x32_bf16 v[124:127], a[72:75], a[232:235], 0
    v_mul_f32 v34, v34, v20
    v_mul_f32 v35, v35, v20
    v_mfma_f32_16x16x32_bf16 v[112:115], a[4:7], a[236:239], v[112:115]
    v_cvt_pk_bf16_f32 v33, v34, v35
    v_mul_f32 v36, v36, v20
    v_mfma_f32_16x16x32_bf16 v[116:119], a[28:31], a[236:239], v[116:119]
    v_mul_f32 v37, v37, v20
    v_cvt_pk_bf16_f32 v34, v36, v37
    v_mfma_f32_16x16x32_bf16 v[120:123], a[52:55], a[236:239], v[120:123]
    v_mul_f32 v38, v38, v20
    v_mul_f32 v39, v39, v20
    v_mfma_f32_16x16x32_bf16 v[124:127], a[76:79], a[236:239], v[124:127]
    v_mul_f32 v40, v40, v20
    v_mul_f32 v41, v41, v20
    v_mfma_f32_16x16x32_bf16 v[112:115], a[8:11], a[240:243], v[112:115]
    v_permlane16_swap_b32 v22, v23
    v_cvt_pk_bf16_f32 v35, v38, v39
    v_mfma_f32_16x16x32_bf16 v[116:119], a[32:35], a[240:243], v[116:119]
    v_cvt_pk_bf16_f32 v36, v40, v41
    v_mul_f32 v48, v48, v21
    v_mfma_f32_16x16x32_bf16 v[120:123], a[56:59], a[240:243], v[120:123]
    v_mul_f32 v49, v49, v21
    v_cvt_pk_bf16_f32 v40, v48, v49
    v_mfma_f32_16x16x32_bf16 v[124:127], a[80:83], a[240:243], v[124:127]
    v_mul_f32 v64, v64, v22
    s_waitcnt lgkmcnt(0)
    v_mfma_f32_16x16x32_bf16 v[112:115], a[12:15], a[244:247], v[112:115]
    v_mul_f32 v65, v65, v22
    v_mul_f32 v66, v66, v22
    v_mfma_f32_16x16x32_bf16 v[116:119], a[36:39], a[244:247], v[116:119]
    v_mul_f32 v67, v67, v22
    v_cvt_pk_bf16_f32 v48, v64, v65
    v_mfma_f32_16x16x32_bf16 v[120:123], a[60:63], a[244:247], v[120:123]
    v_cvt_pk_bf16_f32 v49, v66, v67
    v_mul_f32 v50, v50, v21
    v_mfma_f32_16x16x32_bf16 v[124:127], a[84:87], a[244:247], v[124:127]
    v_mul_f32 v51, v51, v21
    v_cvt_pk_bf16_f32 v41, v50, v51
    v_mfma_f32_16x16x32_bf16 v[112:115], a[16:19], a[248:251], v[112:115]
    v_mul_f32 v68, v68, v22
    v_mul_f32 v69, v69, v22
    v_mfma_f32_16x16x32_bf16 v[116:119], a[40:43], a[248:251], v[116:119]
    v_mul_f32 v70, v70, v22
    v_mul_f32 v71, v71, v22
    v_mfma_f32_16x16x32_bf16 v[120:123], a[64:67], a[248:251], v[120:123]
    v_cvt_pk_bf16_f32 v50, v68, v69
    v_cvt_pk_bf16_f32 v51, v70, v71
    v_mfma_f32_16x16x32_bf16 v[124:127], a[88:91], a[248:251], v[124:127]
    v_mul_f32 v42, v42, v20
    v_mul_f32 v43, v43, v20
    v_mfma_f32_16x16x32_bf16 v[112:115], a[20:23], a[252:255], v[112:115]
    v_cvt_pk_bf16_f32 v37, v42, v43
    v_mul_f32 v52, v52, v21
    v_mfma_f32_16x16x32_bf16 v[116:119], a[44:47], a[252:255], v[116:119]
    v_mul_f32 v53, v53, v21
    v_cvt_pk_bf16_f32 v42, v52, v53
    v_mfma_f32_16x16x32_bf16 v[120:123], a[68:71], a[252:255], v[120:123]
    buffer_load_dwordx4 a[0:3], v9, s[8:11], s24 offen offset:0 nt
    v_mul_f32 v72, v72, v22
    v_mfma_f32_16x16x32_bf16 v[124:127], a[92:95], a[252:255], v[124:127]
    buffer_load_dwordx4 a[4:7], v9, s[8:11], s24 offen offset:64 nt
    v_mul_f32 v73, v73, v22
    v_mfma_f32_16x16x32_bf16 v[64:67], v[32:35], v[128:131], 0
    v_mul_f32 v74, v74, v22
    v_mul_f32 v75, v75, v22
    v_mfma_f32_16x16x32_bf16 v[68:71], v[32:35], v[136:139], 0
    v_cvt_pk_bf16_f32 v52, v72, v73
    v_cvt_pk_bf16_f32 v53, v74, v75
    v_mfma_f32_16x16x32_bf16 v[72:75], v[32:35], v[144:147], 0
    v_mul_f32 v54, v54, v21
    v_mul_f32 v55, v55, v21
    v_cvt_pk_bf16_f32 v43, v54, v55
    v_mul_f32 v76, v76, v22
    v_mul_f32 v77, v77, v22
    v_cvt_pk_bf16_f32 v54, v76, v77
    v_mul_f32 v78, v78, v22
    v_mul_f32 v79, v79, v22
    v_cvt_pk_bf16_f32 v55, v78, v79
    v_mfma_f32_16x16x32_bf16 v[76:79], v[32:35], v[152:155], 0
    v_mul_f32 v44, v44, v20
    v_mul_f32 v45, v45, v20
    v_cvt_pk_bf16_f32 v38, v44, v45
    v_mul_f32 v46, v46, v20
    v_mul_f32 v47, v47, v20
    v_cvt_pk_bf16_f32 v39, v46, v47
    s_nop 1
    v_mfma_f32_16x16x32_bf16 v[64:67], v[36:39], v[132:135], v[64:67]
    v_mul_f32 v56, v56, v21
    v_mul_f32 v57, v57, v21
    v_mfma_f32_16x16x32_bf16 v[68:71], v[36:39], v[140:143], v[68:71]
    v_cvt_pk_bf16_f32 v44, v56, v57
    v_mul_f32 v80, v80, v23
    v_mfma_f32_16x16x32_bf16 v[72:75], v[36:39], v[148:151], v[72:75]
    v_mul_f32 v81, v81, v23
    v_mul_f32 v82, v82, v23
    v_mfma_f32_16x16x32_bf16 v[76:79], v[36:39], v[156:159], v[76:79]
    v_mul_f32 v83, v83, v23
    v_cvt_pk_bf16_f32 v56, v80, v81
    v_cvt_pk_bf16_f32 v57, v82, v83
    v_mfma_f32_16x16x32_bf16 v[80:83], v[40:43], v[128:131], 0
    v_mul_f32 v58, v58, v21
    v_mul_f32 v59, v59, v21
    v_cvt_pk_bf16_f32 v45, v58, v59
    v_mul_f32 v84, v84, v23
    v_mul_f32 v85, v85, v23
    v_cvt_pk_bf16_f32 v58, v84, v85
    v_mul_f32 v86, v86, v23
    v_mul_f32 v87, v87, v23
    v_cvt_pk_bf16_f32 v59, v86, v87
    v_mfma_f32_16x16x32_bf16 v[84:87], v[40:43], v[136:139], 0
    v_mul_f32 v60, v60, v21
    v_mul_f32 v61, v61, v21
    v_cvt_pk_bf16_f32 v46, v60, v61
    v_mul_f32 v88, v88, v23
    v_mul_f32 v89, v89, v23
    v_cvt_pk_bf16_f32 v60, v88, v89
    v_mul_f32 v90, v90, v23
    v_mul_f32 v91, v91, v23
    v_cvt_pk_bf16_f32 v61, v90, v91
    v_mfma_f32_16x16x32_bf16 v[88:91], v[40:43], v[144:147], 0
    v_mul_f32 v62, v62, v21
    v_mul_f32 v63, v63, v21
    v_cvt_pk_bf16_f32 v47, v62, v63
    v_mul_f32 v92, v92, v23
    v_mul_f32 v93, v93, v23
    v_cvt_pk_bf16_f32 v62, v92, v93
    v_mul_f32 v94, v94, v23
    v_mul_f32 v95, v95, v23
    v_cvt_pk_bf16_f32 v63, v94, v95
    v_mfma_f32_16x16x32_bf16 v[92:95], v[40:43], v[152:155], 0
    v_cvt_pk_bf16_f32 v208, v96, v97
    v_cvt_pk_bf16_f32 v209, v98, v99
    v_mfma_f32_16x16x32_bf16 v[80:83], v[44:47], v[132:135], v[80:83]
    v_cvt_pk_bf16_f32 v210, v100, v101
    v_cvt_pk_bf16_f32 v211, v102, v103
    v_mfma_f32_16x16x32_bf16 v[84:87], v[44:47], v[140:143], v[84:87]
    v_cvt_pk_bf16_f32 v212, v104, v105
    v_cvt_pk_bf16_f32 v213, v106, v107
    v_mfma_f32_16x16x32_bf16 v[88:91], v[44:47], v[148:151], v[88:91]
    v_cvt_pk_bf16_f32 v214, v108, v109
    v_cvt_pk_bf16_f32 v215, v110, v111
    v_mfma_f32_16x16x32_bf16 v[92:95], v[44:47], v[156:159], v[92:95]
    v_cvt_pk_bf16_f32 v216, v112, v113
    v_cvt_pk_bf16_f32 v217, v114, v115
    v_mfma_f32_16x16x32_bf16 v[96:99], v[48:51], v[128:131], 0
    v_cvt_pk_bf16_f32 v218, v116, v117
    v_cvt_pk_bf16_f32 v219, v118, v119
    v_mfma_f32_16x16x32_bf16 v[100:103], v[48:51], v[136:139], 0
    v_cvt_pk_bf16_f32 v220, v120, v121
    v_cvt_pk_bf16_f32 v221, v122, v123
    v_mfma_f32_16x16x32_bf16 v[104:107], v[48:51], v[144:147], 0
    v_cvt_pk_bf16_f32 v222, v124, v125
    v_cvt_pk_bf16_f32 v223, v126, v127
    v_mfma_f32_16x16x32_bf16 v[108:111], v[48:51], v[152:155], 0
    v_cvt_pk_bf16_f32 v224, v64, v68
    v_cvt_pk_bf16_f32 v226, v65, v69
    v_mfma_f32_16x16x32_bf16 v[96:99], v[52:55], v[132:135], v[96:99]
    v_cvt_pk_bf16_f32 v228, v66, v70
    v_cvt_pk_bf16_f32 v230, v67, v71
    v_mfma_f32_16x16x32_bf16 v[100:103], v[52:55], v[140:143], v[100:103]
    v_cvt_pk_bf16_f32 v225, v72, v76
    v_cvt_pk_bf16_f32 v227, v73, v77
    v_mfma_f32_16x16x32_bf16 v[104:107], v[52:55], v[148:151], v[104:107]
    v_cvt_pk_bf16_f32 v229, v74, v78
    v_cvt_pk_bf16_f32 v231, v75, v79
    v_mfma_f32_16x16x32_bf16 v[108:111], v[52:55], v[156:159], v[108:111]
    v_cvt_pk_bf16_f32 v232, v80, v84
    v_cvt_pk_bf16_f32 v234, v81, v85
    v_mfma_f32_16x16x32_bf16 v[112:115], v[56:59], v[128:131], 0
    v_cvt_pk_bf16_f32 v236, v82, v86
    v_cvt_pk_bf16_f32 v238, v83, v87
    v_mfma_f32_16x16x32_bf16 v[116:119], v[56:59], v[136:139], 0
    v_cvt_pk_bf16_f32 v233, v88, v92
    v_cvt_pk_bf16_f32 v235, v89, v93
    v_mfma_f32_16x16x32_bf16 v[120:123], v[56:59], v[144:147], 0
    v_cvt_pk_bf16_f32 v237, v90, v94
    v_cvt_pk_bf16_f32 v239, v91, v95
    v_mfma_f32_16x16x32_bf16 v[124:127], v[56:59], v[152:155], 0
    v_cvt_pk_bf16_f32 v240, v96, v100
    v_cvt_pk_bf16_f32 v242, v97, v101
    v_mfma_f32_16x16x32_bf16 v[112:115], v[60:63], v[132:135], v[112:115]
    v_cvt_pk_bf16_f32 v244, v98, v102
    v_cvt_pk_bf16_f32 v246, v99, v103
    v_mfma_f32_16x16x32_bf16 v[116:119], v[60:63], v[140:143], v[116:119]
    v_cvt_pk_bf16_f32 v241, v104, v108
    v_cvt_pk_bf16_f32 v243, v105, v109
    v_mfma_f32_16x16x32_bf16 v[120:123], v[60:63], v[148:151], v[120:123]
    v_cvt_pk_bf16_f32 v245, v106, v110
    v_cvt_pk_bf16_f32 v247, v107, v111
    v_mfma_f32_16x16x32_bf16 v[124:127], v[60:63], v[156:159], v[124:127]
    s_mov_b32 s52, s32
    s_mov_b32 s54, s34
    v_mfma_f32_16x16x32_bf16 v[64:67], v[32:35], v[160:163], 0
    v_cvt_pk_bf16_f32 v248, v112, v116
    v_cvt_pk_bf16_f32 v250, v113, v117
    v_mfma_f32_16x16x32_bf16 v[68:71], v[32:35], v[168:171], 0
    v_cvt_pk_bf16_f32 v252, v114, v118
    v_cvt_pk_bf16_f32 v254, v115, v119
    v_mfma_f32_16x16x32_bf16 v[72:75], v[32:35], v[176:179], 0
    v_cvt_pk_bf16_f32 v249, v120, v124
    v_cvt_pk_bf16_f32 v251, v121, v125
    v_mfma_f32_16x16x32_bf16 v[76:79], v[32:35], v[184:187], 0
    v_cvt_pk_bf16_f32 v253, v122, v126
    v_cvt_pk_bf16_f32 v255, v123, v127
    v_mfma_f32_16x16x32_bf16 v[64:67], v[36:39], v[164:167], v[64:67]
    s_mov_b32 s56, s36
    s_mov_b32 s58, s38
    v_mfma_f32_16x16x32_bf16 v[68:71], v[36:39], v[172:175], v[68:71]
    s_mov_b32 s18, 100663296
    v_mfma_f32_16x16x32_bf16 v[72:75], v[36:39], v[180:183], v[72:75]
    v_mfma_f32_16x16x32_bf16 v[76:79], v[36:39], v[188:191], v[76:79]
    v_mfma_f32_16x16x32_bf16 v[80:83], v[40:43], v[160:163], 0
    v_cvt_pk_bf16_f32 v128, v64, v68
    v_cvt_pk_bf16_f32 v130, v65, v69
    v_mfma_f32_16x16x32_bf16 v[84:87], v[40:43], v[168:171], 0
    v_cvt_pk_bf16_f32 v132, v66, v70
    v_cvt_pk_bf16_f32 v134, v67, v71
    v_mfma_f32_16x16x32_bf16 v[88:91], v[40:43], v[176:179], 0
    v_cvt_pk_bf16_f32 v129, v72, v76
    v_cvt_pk_bf16_f32 v131, v73, v77
    v_mfma_f32_16x16x32_bf16 v[92:95], v[40:43], v[184:187], 0
    v_cvt_pk_bf16_f32 v133, v74, v78
    v_cvt_pk_bf16_f32 v135, v75, v79
    v_mfma_f32_16x16x32_bf16 v[80:83], v[44:47], v[164:167], v[80:83]
    v_mfma_f32_16x16x32_bf16 v[84:87], v[44:47], v[172:175], v[84:87]
    v_mfma_f32_16x16x32_bf16 v[88:91], v[44:47], v[180:183], v[88:91]
    v_mfma_f32_16x16x32_bf16 v[92:95], v[44:47], v[188:191], v[92:95]
    buffer_load_dwordx4 a[24:27], v9, s[8:11], s26 offen offset:0 nt
    v_mfma_f32_16x16x32_bf16 v[96:99], v[48:51], v[160:163], 0
    buffer_load_dwordx4 a[28:31], v9, s[8:11], s26 offen offset:64 nt
    v_cvt_pk_bf16_f32 v136, v80, v84
    v_mfma_f32_16x16x32_bf16 v[100:103], v[48:51], v[168:171], 0
    v_cvt_pk_bf16_f32 v138, v81, v85
    v_cvt_pk_bf16_f32 v140, v82, v86
    v_mfma_f32_16x16x32_bf16 v[104:107], v[48:51], v[176:179], 0
    v_cvt_pk_bf16_f32 v142, v83, v87
    v_cvt_pk_bf16_f32 v137, v88, v92
    v_mfma_f32_16x16x32_bf16 v[108:111], v[48:51], v[184:187], 0
    v_cvt_pk_bf16_f32 v139, v89, v93
    v_cvt_pk_bf16_f32 v141, v90, v94
    v_mfma_f32_16x16x32_bf16 v[96:99], v[52:55], v[164:167], v[96:99]
    v_cvt_pk_bf16_f32 v143, v91, v95
    v_mfma_f32_16x16x32_bf16 v[100:103], v[52:55], v[172:175], v[100:103]
    v_mfma_f32_16x16x32_bf16 v[104:107], v[52:55], v[180:183], v[104:107]
    v_mfma_f32_16x16x32_bf16 v[108:111], v[52:55], v[188:191], v[108:111]
    v_mfma_f32_16x16x32_bf16 v[112:115], v[56:59], v[160:163], 0
    v_cvt_pk_bf16_f32 v144, v96, v100
    v_cvt_pk_bf16_f32 v146, v97, v101
    v_mfma_f32_16x16x32_bf16 v[116:119], v[56:59], v[168:171], 0
    v_cvt_pk_bf16_f32 v148, v98, v102
    v_cvt_pk_bf16_f32 v150, v99, v103
    v_mfma_f32_16x16x32_bf16 v[120:123], v[56:59], v[176:179], 0
    v_cvt_pk_bf16_f32 v145, v104, v108
    v_cvt_pk_bf16_f32 v147, v105, v109
    v_mfma_f32_16x16x32_bf16 v[124:127], v[56:59], v[184:187], 0
    v_cvt_pk_bf16_f32 v149, v106, v110
    v_cvt_pk_bf16_f32 v151, v107, v111
    v_mfma_f32_16x16x32_bf16 v[112:115], v[60:63], v[164:167], v[112:115]
    v_mfma_f32_16x16x32_bf16 v[116:119], v[60:63], v[172:175], v[116:119]
    ds_read_b128 a[192:195], v1 offset:0
    v_mfma_f32_16x16x32_bf16 v[120:123], v[60:63], v[180:183], v[120:123]
    v_mfma_f32_16x16x32_bf16 v[124:127], v[60:63], v[188:191], v[124:127]
    buffer_store_dwordx2 v[128:129], v11, s[12:15], s32 offen offset:128 sc1
    v_mfma_f32_16x16x32_bf16 v[64:67], v[32:35], v[192:195], 0
    v_cvt_pk_bf16_f32 v152, v112, v116
    v_cvt_pk_bf16_f32 v154, v113, v117
    v_mfma_f32_16x16x32_bf16 v[68:71], v[32:35], v[200:203], 0
    ds_read_b128 a[196:199], v1 offset:1024
    v_cvt_pk_bf16_f32 v156, v114, v118
    v_mfma_f32_16x16x32_bf16 v[72:75], v[32:35], v[208:211], 0
    v_cvt_pk_bf16_f32 v158, v115, v119
    v_cvt_pk_bf16_f32 v153, v120, v124
    v_mfma_f32_16x16x32_bf16 v[76:79], v[32:35], v[216:219], 0
    v_cvt_pk_bf16_f32 v155, v121, v125
    v_cvt_pk_bf16_f32 v157, v122, v126
    v_mfma_f32_16x16x32_bf16 v[64:67], v[36:39], v[196:199], v[64:67]
    v_cvt_pk_bf16_f32 v159, v123, v127
    v_mfma_f32_16x16x32_bf16 v[68:71], v[36:39], v[204:207], v[68:71]
    ds_read_b128 a[200:203], v1 offset:2048
    v_mfma_f32_16x16x32_bf16 v[72:75], v[36:39], v[212:215], v[72:75]
    v_mfma_f32_16x16x32_bf16 v[76:79], v[36:39], v[220:223], v[76:79]
    v_mfma_f32_16x16x32_bf16 v[80:83], v[40:43], v[192:195], 0
    v_cvt_pk_bf16_f32 v160, v64, v68
    v_cvt_pk_bf16_f32 v162, v65, v69
    v_mfma_f32_16x16x32_bf16 v[84:87], v[40:43], v[200:203], 0
    ds_read_b128 a[204:207], v1 offset:3072
    v_cvt_pk_bf16_f32 v164, v66, v70
    v_mfma_f32_16x16x32_bf16 v[88:91], v[40:43], v[208:211], 0
    v_cvt_pk_bf16_f32 v166, v67, v71
    v_cvt_pk_bf16_f32 v161, v72, v76
    v_mfma_f32_16x16x32_bf16 v[92:95], v[40:43], v[216:219], 0
    v_cvt_pk_bf16_f32 v163, v73, v77
    v_cvt_pk_bf16_f32 v165, v74, v78
    v_mfma_f32_16x16x32_bf16 v[80:83], v[44:47], v[196:199], v[80:83]
    v_cvt_pk_bf16_f32 v167, v75, v79
    v_mfma_f32_16x16x32_bf16 v[84:87], v[44:47], v[204:207], v[84:87]
    ds_read_b128 a[208:211], v1 offset:4096
    v_mfma_f32_16x16x32_bf16 v[88:91], v[44:47], v[212:215], v[88:91]
    v_mfma_f32_16x16x32_bf16 v[92:95], v[44:47], v[220:223], v[92:95]
    buffer_store_dwordx2 v[130:131], v11, s[12:15], s32 offen offset:512 sc1
    v_mfma_f32_16x16x32_bf16 v[96:99], v[48:51], v[192:195], 0
    v_cvt_pk_bf16_f32 v168, v80, v84
    v_cvt_pk_bf16_f32 v170, v81, v85
    v_mfma_f32_16x16x32_bf16 v[100:103], v[48:51], v[200:203], 0
    ds_read_b128 a[212:215], v1 offset:5120
    v_cvt_pk_bf16_f32 v172, v82, v86
    v_mfma_f32_16x16x32_bf16 v[104:107], v[48:51], v[208:211], 0
    v_cvt_pk_bf16_f32 v174, v83, v87
    v_cvt_pk_bf16_f32 v169, v88, v92
    v_mfma_f32_16x16x32_bf16 v[108:111], v[48:51], v[216:219], 0
    v_cvt_pk_bf16_f32 v171, v89, v93
    v_cvt_pk_bf16_f32 v173, v90, v94
    v_mfma_f32_16x16x32_bf16 v[96:99], v[52:55], v[196:199], v[96:99]
    v_cvt_pk_bf16_f32 v175, v91, v95
    v_mfma_f32_16x16x32_bf16 v[100:103], v[52:55], v[204:207], v[100:103]
    ds_read_b128 a[216:219], v1 offset:6144
    v_mfma_f32_16x16x32_bf16 v[104:107], v[52:55], v[212:215], v[104:107]
    v_mfma_f32_16x16x32_bf16 v[108:111], v[52:55], v[220:223], v[108:111]
    v_mfma_f32_16x16x32_bf16 v[112:115], v[56:59], v[192:195], 0
    v_cvt_pk_bf16_f32 v176, v96, v100
    v_cvt_pk_bf16_f32 v178, v97, v101
    v_mfma_f32_16x16x32_bf16 v[116:119], v[56:59], v[200:203], 0
    ds_read_b128 a[220:223], v1 offset:7168
    v_cvt_pk_bf16_f32 v180, v98, v102
    v_mfma_f32_16x16x32_bf16 v[120:123], v[56:59], v[208:211], 0
    v_cvt_pk_bf16_f32 v182, v99, v103
    v_cvt_pk_bf16_f32 v177, v104, v108
    v_mfma_f32_16x16x32_bf16 v[124:127], v[56:59], v[216:219], 0
    v_cvt_pk_bf16_f32 v179, v105, v109
    v_cvt_pk_bf16_f32 v181, v106, v110
    v_mfma_f32_16x16x32_bf16 v[112:115], v[60:63], v[196:199], v[112:115]
    v_cvt_pk_bf16_f32 v183, v107, v111
    v_mfma_f32_16x16x32_bf16 v[116:119], v[60:63], v[204:207], v[116:119]
    ds_read_b128 a[224:227], v1 offset:8192
    v_mfma_f32_16x16x32_bf16 v[120:123], v[60:63], v[212:215], v[120:123]
    v_mfma_f32_16x16x32_bf16 v[124:127], v[60:63], v[220:223], v[124:127]
    buffer_store_dwordx2 v[132:133], v11, s[12:15], s32 offen offset:896 sc1
    s_waitcnt vmcnt(53) lgkmcnt(3)
    v_mfma_f32_16x16x32_bf16 v[96:99], a[192:195], a[96:99], 0
    v_cvt_pk_bf16_f32 v184, v112, v116
    v_cvt_pk_bf16_f32 v186, v113, v117
    s_waitcnt vmcnt(51)
    v_mfma_f32_16x16x32_bf16 v[100:103], a[192:195], a[120:123], 0
    ds_read_b128 a[228:231], v1 offset:9216
    v_cvt_pk_bf16_f32 v188, v114, v118
    s_waitcnt vmcnt(49)
    v_mfma_f32_16x16x32_bf16 v[104:107], a[192:195], a[144:147], 0
    v_cvt_pk_bf16_f32 v190, v115, v119
    v_cvt_pk_bf16_f32 v185, v120, v124
    s_waitcnt vmcnt(47)
    v_mfma_f32_16x16x32_bf16 v[108:111], a[192:195], a[168:171], 0
    v_cvt_pk_bf16_f32 v187, v121, v125
    v_cvt_pk_bf16_f32 v189, v122, v126
    v_mfma_f32_16x16x32_bf16 v[96:99], a[196:199], a[100:103], v[96:99]
    v_cvt_pk_bf16_f32 v191, v123, v127
    v_mfma_f32_16x16x32_bf16 v[100:103], a[196:199], a[124:127], v[100:103]
    ds_read_b128 a[232:235], v1 offset:10240
    v_mfma_f32_16x16x32_bf16 v[104:107], a[196:199], a[148:151], v[104:107]
    s_waitcnt vmcnt(46)
    v_mfma_f32_16x16x32_bf16 v[108:111], a[196:199], a[172:175], v[108:111]
    s_waitcnt vmcnt(45)
    v_mfma_f32_16x16x32_bf16 v[96:99], a[200:203], a[104:107], v[96:99]
    s_waitcnt vmcnt(43)
    v_mfma_f32_16x16x32_bf16 v[100:103], a[200:203], a[128:131], v[100:103]
    buffer_load_dwordx4 a[48:51], v9, s[8:11], s28 offen offset:0 nt
    s_waitcnt vmcnt(42)
    v_mfma_f32_16x16x32_bf16 v[104:107], a[200:203], a[152:155], v[104:107]
    buffer_load_dwordx4 a[52:55], v9, s[8:11], s28 offen offset:64 nt
    s_waitcnt vmcnt(41)
    v_mfma_f32_16x16x32_bf16 v[108:111], a[200:203], a[176:179], v[108:111]
    ds_read_b128 a[236:239], v1 offset:11264
    v_mfma_f32_16x16x32_bf16 v[96:99], a[204:207], a[108:111], v[96:99]
    v_mfma_f32_16x16x32_bf16 v[100:103], a[204:207], a[132:135], v[100:103]
    ds_read_b128 a[240:243], v1 offset:12288
    v_mfma_f32_16x16x32_bf16 v[104:107], a[204:207], a[156:159], v[104:107]
    s_waitcnt vmcnt(40)
    v_mfma_f32_16x16x32_bf16 v[108:111], a[204:207], a[180:183], v[108:111]
    buffer_store_dwordx2 v[134:135], v11, s[12:15], s32 offen offset:1280 sc1
    s_waitcnt vmcnt(38)
    v_mfma_f32_16x16x32_bf16 v[96:99], a[208:211], a[112:115], v[96:99]
    ds_read_b128 a[244:247], v1 offset:13312
    s_waitcnt vmcnt(32)
    v_mfma_f32_16x16x32_bf16 v[100:103], a[208:211], a[136:139], v[100:103]
    s_waitcnt vmcnt(26)
    v_mfma_f32_16x16x32_bf16 v[104:107], a[208:211], a[160:163], v[104:107]
    s_waitcnt vmcnt(19)
    v_mfma_f32_16x16x32_bf16 v[108:111], a[208:211], a[184:187], v[108:111]
    v_mfma_f32_16x16x32_bf16 v[96:99], a[212:215], a[116:119], v[96:99]
    ds_read_b128 a[248:251], v1 offset:14336
    v_mfma_f32_16x16x32_bf16 v[100:103], a[212:215], a[140:143], v[100:103]
    v_mfma_f32_16x16x32_bf16 v[104:107], a[212:215], a[164:167], v[104:107]
    v_mfma_f32_16x16x32_bf16 v[108:111], a[212:215], a[188:191], v[108:111]
    v_cvt_pk_bf16_f32 v208, v96, v97
    s_waitcnt lgkmcnt(4)
    v_mfma_f32_16x16x32_bf16 v[112:115], a[216:219], a[96:99], 0
    v_cvt_pk_bf16_f32 v209, v98, v99
    v_cvt_pk_bf16_f32 v212, v100, v101
    v_mfma_f32_16x16x32_bf16 v[116:119], a[216:219], a[120:123], 0
    v_cvt_pk_bf16_f32 v213, v102, v103
    v_cvt_pk_bf16_f32 v216, v104, v105
    v_mfma_f32_16x16x32_bf16 v[120:123], a[216:219], a[144:147], 0
    v_cvt_pk_bf16_f32 v217, v106, v107
    v_cvt_pk_bf16_f32 v220, v108, v109
    v_mfma_f32_16x16x32_bf16 v[124:127], a[216:219], a[168:171], 0
    v_cvt_pk_bf16_f32 v221, v110, v111
    v_mfma_f32_16x16x32_bf16 v[112:115], a[220:223], a[100:103], v[112:115]
    v_mfma_f32_16x16x32_bf16 v[116:119], a[220:223], a[124:127], v[116:119]
    v_mfma_f32_16x16x32_bf16 v[120:123], a[220:223], a[148:151], v[120:123]
    buffer_store_dwordx2 v[136:137], v11, s[12:15], s34 offen offset:128 sc1
    v_mfma_f32_16x16x32_bf16 v[124:127], a[220:223], a[172:175], v[124:127]
    v_mfma_f32_16x16x32_bf16 v[112:115], a[224:227], a[104:107], v[112:115]
    v_mfma_f32_16x16x32_bf16 v[116:119], a[224:227], a[128:131], v[116:119]
    v_mfma_f32_16x16x32_bf16 v[120:123], a[224:227], a[152:155], v[120:123]
    v_mfma_f32_16x16x32_bf16 v[124:127], a[224:227], a[176:179], v[124:127]
    v_mfma_f32_16x16x32_bf16 v[112:115], a[228:231], a[108:111], v[112:115]
    v_mfma_f32_16x16x32_bf16 v[116:119], a[228:231], a[132:135], v[116:119]
    v_mfma_f32_16x16x32_bf16 v[120:123], a[228:231], a[156:159], v[120:123]
    v_mfma_f32_16x16x32_bf16 v[124:127], a[228:231], a[180:183], v[124:127]
    v_mfma_f32_16x16x32_bf16 v[112:115], a[232:235], a[112:115], v[112:115]
    ds_read_b128 a[252:255], v1 offset:15360
    v_mfma_f32_16x16x32_bf16 v[116:119], a[232:235], a[136:139], v[116:119]
    v_mfma_f32_16x16x32_bf16 v[120:123], a[232:235], a[160:163], v[120:123]
    v_mfma_f32_16x16x32_bf16 v[124:127], a[232:235], a[184:187], v[124:127]
    s_waitcnt lgkmcnt(1)
    v_mfma_f32_16x16x32_bf16 v[112:115], a[236:239], a[116:119], v[112:115]
    ds_read_b128 a[192:195], v1 offset:16384
    v_mfma_f32_16x16x32_bf16 v[116:119], a[236:239], a[140:143], v[116:119]
    v_mfma_f32_16x16x32_bf16 v[120:123], a[236:239], a[164:167], v[120:123]
    buffer_store_dwordx2 v[138:139], v11, s[12:15], s34 offen offset:512 sc1
    v_mfma_f32_16x16x32_bf16 v[124:127], a[236:239], a[188:191], v[124:127]
    v_cvt_pk_bf16_f32 v210, v112, v113
    v_cvt_pk_bf16_f32 v211, v114, v115
    v_mfma_f32_16x16x32_bf16 v[96:99], a[240:243], a[96:99], 0
    ds_read_b128 a[196:199], v1 offset:17408
    v_cvt_pk_bf16_f32 v214, v116, v117
    v_mfma_f32_16x16x32_bf16 v[100:103], a[240:243], a[120:123], 0
    v_cvt_pk_bf16_f32 v215, v118, v119
    v_cvt_pk_bf16_f32 v218, v120, v121
    v_mfma_f32_16x16x32_bf16 v[104:107], a[240:243], a[144:147], 0
    v_cvt_pk_bf16_f32 v219, v122, v123
    v_cvt_pk_bf16_f32 v222, v124, v125
    v_mfma_f32_16x16x32_bf16 v[108:111], a[240:243], a[168:171], 0
    v_cvt_pk_bf16_f32 v223, v126, v127
    v_mfma_f32_16x16x32_bf16 v[96:99], a[244:247], a[100:103], v[96:99]
    ds_read_b128 a[200:203], v1 offset:18432
    v_mfma_f32_16x16x32_bf16 v[100:103], a[244:247], a[124:127], v[100:103]
    v_mfma_f32_16x16x32_bf16 v[104:107], a[244:247], a[148:151], v[104:107]
    v_mfma_f32_16x16x32_bf16 v[108:111], a[244:247], a[172:175], v[108:111]
    v_mfma_f32_16x16x32_bf16 v[96:99], a[248:251], a[104:107], v[96:99]
    ds_read_b128 a[204:207], v1 offset:19456
    v_mfma_f32_16x16x32_bf16 v[100:103], a[248:251], a[128:131], v[100:103]
    v_mfma_f32_16x16x32_bf16 v[104:107], a[248:251], a[152:155], v[104:107]
    v_mfma_f32_16x16x32_bf16 v[108:111], a[248:251], a[176:179], v[108:111]
    v_mfma_f32_16x16x32_bf16 v[32:35], a[96:99], v[208:211], 0
    ds_read_b128 a[208:211], v1 offset:20480
    v_mfma_f32_16x16x32_bf16 v[36:39], a[120:123], v[208:211], 0
    v_mfma_f32_16x16x32_bf16 v[40:43], a[144:147], v[208:211], 0
    buffer_store_dwordx2 v[140:141], v11, s[12:15], s34 offen offset:896 sc1
    v_mfma_f32_16x16x32_bf16 v[44:47], a[168:171], v[208:211], 0
    v_mfma_f32_16x16x32_bf16 v[48:51], a[96:99], v[212:215], 0
    ds_read_b128 a[212:215], v1 offset:21504
    v_mfma_f32_16x16x32_bf16 v[52:55], a[120:123], v[212:215], 0
    v_mfma_f32_16x16x32_bf16 v[56:59], a[144:147], v[212:215], 0
    buffer_load_dwordx4 a[72:75], v9, s[8:11], s30 offen offset:0 nt
    v_mfma_f32_16x16x32_bf16 v[60:63], a[168:171], v[212:215], 0
    buffer_load_dwordx4 a[76:79], v9, s[8:11], s30 offen offset:64 nt
    v_mfma_f32_16x16x32_bf16 v[64:67], a[96:99], v[216:219], 0
    ds_read_b128 a[216:219], v1 offset:22528
    v_mfma_f32_16x16x32_bf16 v[68:71], a[120:123], v[216:219], 0
    v_mfma_f32_16x16x32_bf16 v[72:75], a[144:147], v[216:219], 0
    v_mfma_f32_16x16x32_bf16 v[76:79], a[168:171], v[216:219], 0
    v_mfma_f32_16x16x32_bf16 v[80:83], a[96:99], v[220:223], 0
    ds_read_b128 a[220:223], v1 offset:23552
    v_mfma_f32_16x16x32_bf16 v[84:87], a[120:123], v[220:223], 0
    v_mfma_f32_16x16x32_bf16 v[88:91], a[144:147], v[220:223], 0
    v_mfma_f32_16x16x32_bf16 v[92:95], a[168:171], v[220:223], 0
    s_waitcnt lgkmcnt(3)
    v_mfma_f32_16x16x32_bf16 v[96:99], a[252:255], a[108:111], v[96:99]
    ds_read_b128 a[224:227], v1 offset:24576
    v_mfma_f32_16x16x32_bf16 v[100:103], a[252:255], a[132:135], v[100:103]
    v_mfma_f32_16x16x32_bf16 v[104:107], a[252:255], a[156:159], v[104:107]
    buffer_store_dwordx2 v[142:143], v11, s[12:15], s34 offen offset:1280 sc1
    v_mfma_f32_16x16x32_bf16 v[108:111], a[252:255], a[180:183], v[108:111]
    ds_read_b128 a[228:231], v1 offset:25600
    v_mfma_f32_16x16x32_bf16 v[96:99], a[192:195], a[112:115], v[96:99]
    v_mfma_f32_16x16x32_bf16 v[100:103], a[192:195], a[136:139], v[100:103]
    v_mfma_f32_16x16x32_bf16 v[104:107], a[192:195], a[160:163], v[104:107]
    v_mfma_f32_16x16x32_bf16 v[108:111], a[192:195], a[184:187], v[108:111]
    ds_read_b128 a[232:235], v1 offset:26624
    v_mfma_f32_16x16x32_bf16 v[96:99], a[196:199], a[116:119], v[96:99]
    v_mfma_f32_16x16x32_bf16 v[100:103], a[196:199], a[140:143], v[100:103]
    v_mfma_f32_16x16x32_bf16 v[104:107], a[196:199], a[164:167], v[104:107]
    v_mfma_f32_16x16x32_bf16 v[108:111], a[196:199], a[188:191], v[108:111]
    v_cvt_pk_bf16_f32 v208, v96, v97
    v_cvt_pk_bf16_f32 v209, v98, v99
    v_mfma_f32_16x16x32_bf16 v[112:115], a[200:203], a[96:99], 0
    v_cvt_pk_bf16_f32 v212, v100, v101
    v_cvt_pk_bf16_f32 v213, v102, v103
    v_mfma_f32_16x16x32_bf16 v[116:119], a[200:203], a[120:123], 0
    v_cvt_pk_bf16_f32 v216, v104, v105
    v_cvt_pk_bf16_f32 v217, v106, v107
    v_mfma_f32_16x16x32_bf16 v[120:123], a[200:203], a[144:147], 0
    v_cvt_pk_bf16_f32 v220, v108, v109
    v_cvt_pk_bf16_f32 v221, v110, v111
    v_mfma_f32_16x16x32_bf16 v[124:127], a[200:203], a[168:171], 0
    v_mfma_f32_16x16x32_bf16 v[112:115], a[204:207], a[100:103], v[112:115]
    v_mfma_f32_16x16x32_bf16 v[116:119], a[204:207], a[124:127], v[116:119]
    buffer_store_dwordx2 v[144:145], v11, s[12:15], s36 offen offset:128 sc1
    v_mfma_f32_16x16x32_bf16 v[120:123], a[204:207], a[148:151], v[120:123]
    v_mfma_f32_16x16x32_bf16 v[124:127], a[204:207], a[172:175], v[124:127]
    v_mfma_f32_16x16x32_bf16 v[112:115], a[208:211], a[104:107], v[112:115]
    v_mfma_f32_16x16x32_bf16 v[116:119], a[208:211], a[128:131], v[116:119]
    v_mfma_f32_16x16x32_bf16 v[120:123], a[208:211], a[152:155], v[120:123]
    v_mfma_f32_16x16x32_bf16 v[124:127], a[208:211], a[176:179], v[124:127]
    s_waitcnt lgkmcnt(0)
    v_mfma_f32_16x16x32_bf16 v[112:115], a[212:215], a[108:111], v[112:115]
    v_mfma_f32_16x16x32_bf16 v[116:119], a[212:215], a[132:135], v[116:119]
    v_mfma_f32_16x16x32_bf16 v[120:123], a[212:215], a[156:159], v[120:123]
    v_mfma_f32_16x16x32_bf16 v[124:127], a[212:215], a[180:183], v[124:127]
    ds_read_b128 a[236:239], v1 offset:27648
    v_mfma_f32_16x16x32_bf16 v[112:115], a[216:219], a[112:115], v[112:115]
    v_mfma_f32_16x16x32_bf16 v[116:119], a[216:219], a[136:139], v[116:119]
    v_mfma_f32_16x16x32_bf16 v[120:123], a[216:219], a[160:163], v[120:123]
    v_mfma_f32_16x16x32_bf16 v[124:127], a[216:219], a[184:187], v[124:127]
    ds_read_b128 a[240:243], v1 offset:28672
    v_mfma_f32_16x16x32_bf16 v[112:115], a[220:223], a[116:119], v[112:115]
    v_mfma_f32_16x16x32_bf16 v[116:119], a[220:223], a[140:143], v[116:119]
    buffer_store_dwordx2 v[146:147], v11, s[12:15], s36 offen offset:512 sc1
    v_mfma_f32_16x16x32_bf16 v[120:123], a[220:223], a[164:167], v[120:123]
    v_mfma_f32_16x16x32_bf16 v[124:127], a[220:223], a[188:191], v[124:127]
    ds_read_b128 a[244:247], v1 offset:29696
    v_cvt_pk_bf16_f32 v210, v112, v113
    v_mfma_f32_16x16x32_bf16 v[96:99], a[224:227], a[96:99], 0
    v_cvt_pk_bf16_f32 v211, v114, v115
    v_cvt_pk_bf16_f32 v214, v116, v117
    v_mfma_f32_16x16x32_bf16 v[100:103], a[224:227], a[120:123], 0
    v_cvt_pk_bf16_f32 v215, v118, v119
    v_cvt_pk_bf16_f32 v218, v120, v121
    v_mfma_f32_16x16x32_bf16 v[104:107], a[224:227], a[144:147], 0
    v_cvt_pk_bf16_f32 v219, v122, v123
    v_cvt_pk_bf16_f32 v222, v124, v125
    v_mfma_f32_16x16x32_bf16 v[108:111], a[224:227], a[168:171], 0
    ds_read_b128 a[248:251], v1 offset:30720
    v_cvt_pk_bf16_f32 v223, v126, v127
    v_mfma_f32_16x16x32_bf16 v[96:99], a[228:231], a[100:103], v[96:99]
    v_mfma_f32_16x16x32_bf16 v[100:103], a[228:231], a[124:127], v[100:103]
    v_mfma_f32_16x16x32_bf16 v[104:107], a[228:231], a[148:151], v[104:107]
    v_mfma_f32_16x16x32_bf16 v[108:111], a[228:231], a[172:175], v[108:111]
    ds_read_b128 a[252:255], v1 offset:31744
    v_mfma_f32_16x16x32_bf16 v[96:99], a[232:235], a[104:107], v[96:99]
    v_mfma_f32_16x16x32_bf16 v[100:103], a[232:235], a[128:131], v[100:103]
    v_mfma_f32_16x16x32_bf16 v[104:107], a[232:235], a[152:155], v[104:107]
    v_mfma_f32_16x16x32_bf16 v[108:111], a[232:235], a[176:179], v[108:111]
    buffer_load_dwordx4 a[8:11], v9, s[8:11], s24 offen offset:128 nt
    v_mfma_f32_16x16x32_bf16 v[32:35], a[100:103], v[208:211], v[32:35]
    buffer_load_dwordx4 a[12:15], v9, s[8:11], s24 offen offset:192 nt
    v_mfma_f32_16x16x32_bf16 v[36:39], a[124:127], v[208:211], v[36:39]
    buffer_store_dwordx2 v[148:149], v11, s[12:15], s36 offen offset:896 sc1
    v_mfma_f32_16x16x32_bf16 v[40:43], a[148:151], v[208:211], v[40:43]
    ds_read_b128 a[192:195], v1 offset:32768
    v_mfma_f32_16x16x32_bf16 v[44:47], a[172:175], v[208:211], v[44:47]
    ds_read_b128 a[196:199], v1 offset:33792
    v_mfma_f32_16x16x32_bf16 v[48:51], a[100:103], v[212:215], v[48:51]
    v_mfma_f32_16x16x32_bf16 v[52:55], a[124:127], v[212:215], v[52:55]
    v_mfma_f32_16x16x32_bf16 v[56:59], a[148:151], v[212:215], v[56:59]
    v_mfma_f32_16x16x32_bf16 v[60:63], a[172:175], v[212:215], v[60:63]
    ds_read_b128 a[200:203], v1 offset:34816
    v_mfma_f32_16x16x32_bf16 v[64:67], a[100:103], v[216:219], v[64:67]
    v_mfma_f32_16x16x32_bf16 v[68:71], a[124:127], v[216:219], v[68:71]
    v_mfma_f32_16x16x32_bf16 v[72:75], a[148:151], v[216:219], v[72:75]
    v_mfma_f32_16x16x32_bf16 v[76:79], a[172:175], v[216:219], v[76:79]
    ds_read_b128 a[204:207], v1 offset:35840
    v_mfma_f32_16x16x32_bf16 v[80:83], a[100:103], v[220:223], v[80:83]
    v_mfma_f32_16x16x32_bf16 v[84:87], a[124:127], v[220:223], v[84:87]
    v_mfma_f32_16x16x32_bf16 v[88:91], a[148:151], v[220:223], v[88:91]
    v_mfma_f32_16x16x32_bf16 v[92:95], a[172:175], v[220:223], v[92:95]
    ds_read_b128 a[208:211], v1 offset:36864
    s_waitcnt lgkmcnt(5)
    v_mfma_f32_16x16x32_bf16 v[96:99], a[236:239], a[108:111], v[96:99]
    v_mfma_f32_16x16x32_bf16 v[100:103], a[236:239], a[132:135], v[100:103]
    buffer_store_dwordx2 v[150:151], v11, s[12:15], s36 offen offset:1280 sc1
    v_mfma_f32_16x16x32_bf16 v[104:107], a[236:239], a[156:159], v[104:107]
    ds_read_b128 a[212:215], v1 offset:37888
    v_mfma_f32_16x16x32_bf16 v[108:111], a[236:239], a[180:183], v[108:111]
    v_mfma_f32_16x16x32_bf16 v[96:99], a[240:243], a[112:115], v[96:99]
    v_mfma_f32_16x16x32_bf16 v[100:103], a[240:243], a[136:139], v[100:103]
    v_mfma_f32_16x16x32_bf16 v[104:107], a[240:243], a[160:163], v[104:107]
    ds_read_b128 a[216:219], v1 offset:38912
    v_mfma_f32_16x16x32_bf16 v[108:111], a[240:243], a[184:187], v[108:111]
    v_mfma_f32_16x16x32_bf16 v[96:99], a[244:247], a[116:119], v[96:99]
    v_mfma_f32_16x16x32_bf16 v[100:103], a[244:247], a[140:143], v[100:103]
    v_mfma_f32_16x16x32_bf16 v[104:107], a[244:247], a[164:167], v[104:107]
    v_mfma_f32_16x16x32_bf16 v[108:111], a[244:247], a[188:191], v[108:111]
    v_cvt_pk_bf16_f32 v208, v96, v97
    v_cvt_pk_bf16_f32 v209, v98, v99
    v_mfma_f32_16x16x32_bf16 v[112:115], a[248:251], a[96:99], 0
    v_cvt_pk_bf16_f32 v212, v100, v101
    v_cvt_pk_bf16_f32 v213, v102, v103
    v_mfma_f32_16x16x32_bf16 v[116:119], a[248:251], a[120:123], 0
    v_cvt_pk_bf16_f32 v216, v104, v105
    v_cvt_pk_bf16_f32 v217, v106, v107
    v_mfma_f32_16x16x32_bf16 v[120:123], a[248:251], a[144:147], 0
    v_cvt_pk_bf16_f32 v220, v108, v109
    v_cvt_pk_bf16_f32 v221, v110, v111
    v_mfma_f32_16x16x32_bf16 v[124:127], a[248:251], a[168:171], 0
    v_mfma_f32_16x16x32_bf16 v[112:115], a[252:255], a[100:103], v[112:115]
    buffer_store_dwordx2 v[152:153], v11, s[12:15], s38 offen offset:128 sc1
    v_mfma_f32_16x16x32_bf16 v[116:119], a[252:255], a[124:127], v[116:119]
    v_mfma_f32_16x16x32_bf16 v[120:123], a[252:255], a[148:151], v[120:123]
    v_mfma_f32_16x16x32_bf16 v[124:127], a[252:255], a[172:175], v[124:127]
    s_waitcnt lgkmcnt(0)
    v_mfma_f32_16x16x32_bf16 v[112:115], a[192:195], a[104:107], v[112:115]
    v_mfma_f32_16x16x32_bf16 v[116:119], a[192:195], a[128:131], v[116:119]
    v_mfma_f32_16x16x32_bf16 v[120:123], a[192:195], a[152:155], v[120:123]
    v_mfma_f32_16x16x32_bf16 v[124:127], a[192:195], a[176:179], v[124:127]
    v_mfma_f32_16x16x32_bf16 v[112:115], a[196:199], a[108:111], v[112:115]
    v_mfma_f32_16x16x32_bf16 v[116:119], a[196:199], a[132:135], v[116:119]
    v_mfma_f32_16x16x32_bf16 v[120:123], a[196:199], a[156:159], v[120:123]
    ds_read_b128 a[220:223], v1 offset:39936
    v_mfma_f32_16x16x32_bf16 v[124:127], a[196:199], a[180:183], v[124:127]
    v_mfma_f32_16x16x32_bf16 v[112:115], a[200:203], a[112:115], v[112:115]
    v_mfma_f32_16x16x32_bf16 v[116:119], a[200:203], a[136:139], v[116:119]
    v_mfma_f32_16x16x32_bf16 v[120:123], a[200:203], a[160:163], v[120:123]
    ds_read_b128 a[224:227], v1 offset:40960
    v_mfma_f32_16x16x32_bf16 v[124:127], a[200:203], a[184:187], v[124:127]
    v_mfma_f32_16x16x32_bf16 v[112:115], a[204:207], a[116:119], v[112:115]
    buffer_store_dwordx2 v[154:155], v11, s[12:15], s38 offen offset:512 sc1
    v_mfma_f32_16x16x32_bf16 v[116:119], a[204:207], a[140:143], v[116:119]
    v_mfma_f32_16x16x32_bf16 v[120:123], a[204:207], a[164:167], v[120:123]
    ds_read_b128 a[228:231], v1 offset:41984
    v_mfma_f32_16x16x32_bf16 v[124:127], a[204:207], a[188:191], v[124:127]
    v_cvt_pk_bf16_f32 v210, v112, v113
    v_cvt_pk_bf16_f32 v211, v114, v115
    v_mfma_f32_16x16x32_bf16 v[96:99], a[208:211], a[96:99], 0
    v_cvt_pk_bf16_f32 v214, v116, v117
    v_cvt_pk_bf16_f32 v215, v118, v119
    v_mfma_f32_16x16x32_bf16 v[100:103], a[208:211], a[120:123], 0
    v_cvt_pk_bf16_f32 v218, v120, v121
    v_cvt_pk_bf16_f32 v219, v122, v123
    v_mfma_f32_16x16x32_bf16 v[104:107], a[208:211], a[144:147], 0
    ds_read_b128 a[232:235], v1 offset:43008
    v_cvt_pk_bf16_f32 v222, v124, v125
    v_mfma_f32_16x16x32_bf16 v[108:111], a[208:211], a[168:171], 0
    v_cvt_pk_bf16_f32 v223, v126, v127
    v_mfma_f32_16x16x32_bf16 v[96:99], a[212:215], a[100:103], v[96:99]
    buffer_load_dwordx4 a[32:35], v9, s[8:11], s26 offen offset:128 nt
    v_mfma_f32_16x16x32_bf16 v[100:103], a[212:215], a[124:127], v[100:103]
    buffer_load_dwordx4 a[36:39], v9, s[8:11], s26 offen offset:192 nt
    v_mfma_f32_16x16x32_bf16 v[104:107], a[212:215], a[148:151], v[104:107]
    ds_read_b128 a[236:239], v1 offset:44032
    v_mfma_f32_16x16x32_bf16 v[108:111], a[212:215], a[172:175], v[108:111]
    v_mfma_f32_16x16x32_bf16 v[96:99], a[216:219], a[104:107], v[96:99]
    v_mfma_f32_16x16x32_bf16 v[100:103], a[216:219], a[128:131], v[100:103]
    v_mfma_f32_16x16x32_bf16 v[104:107], a[216:219], a[152:155], v[104:107]
    ds_read_b128 a[240:243], v1 offset:45056
    v_mfma_f32_16x16x32_bf16 v[108:111], a[216:219], a[176:179], v[108:111]
    v_mfma_f32_16x16x32_bf16 v[32:35], a[104:107], v[208:211], v[32:35]
    buffer_store_dwordx2 v[156:157], v11, s[12:15], s38 offen offset:896 sc1
    v_mfma_f32_16x16x32_bf16 v[36:39], a[128:131], v[208:211], v[36:39]
    v_mfma_f32_16x16x32_bf16 v[40:43], a[152:155], v[208:211], v[40:43]
    ds_read_b128 a[244:247], v1 offset:46080
    v_mfma_f32_16x16x32_bf16 v[44:47], a[176:179], v[208:211], v[44:47]
    v_mfma_f32_16x16x32_bf16 v[48:51], a[104:107], v[212:215], v[48:51]
    v_mfma_f32_16x16x32_bf16 v[52:55], a[128:131], v[212:215], v[52:55]
    v_mfma_f32_16x16x32_bf16 v[56:59], a[152:155], v[212:215], v[56:59]
    ds_read_b128 a[248:251], v1 offset:47104
    v_mfma_f32_16x16x32_bf16 v[60:63], a[176:179], v[212:215], v[60:63]
    v_mfma_f32_16x16x32_bf16 v[64:67], a[104:107], v[216:219], v[64:67]
    v_mfma_f32_16x16x32_bf16 v[68:71], a[128:131], v[216:219], v[68:71]
    v_mfma_f32_16x16x32_bf16 v[72:75], a[152:155], v[216:219], v[72:75]
    ds_read_b128 a[252:255], v1 offset:48128
    v_mfma_f32_16x16x32_bf16 v[76:79], a[176:179], v[216:219], v[76:79]
    v_mfma_f32_16x16x32_bf16 v[80:83], a[104:107], v[220:223], v[80:83]
    v_mfma_f32_16x16x32_bf16 v[84:87], a[128:131], v[220:223], v[84:87]
    v_mfma_f32_16x16x32_bf16 v[88:91], a[152:155], v[220:223], v[88:91]
    ds_read_b128 a[192:195], v1 offset:49152
    v_mfma_f32_16x16x32_bf16 v[92:95], a[176:179], v[220:223], v[92:95]
    s_waitcnt lgkmcnt(4)
    v_mfma_f32_16x16x32_bf16 v[96:99], a[220:223], a[108:111], v[96:99]
    buffer_store_dwordx2 v[158:159], v11, s[12:15], s38 offen offset:1280 sc1
    v_mfma_f32_16x16x32_bf16 v[100:103], a[220:223], a[132:135], v[100:103]
    ds_read_b128 a[196:199], v1 offset:50176
    v_mfma_f32_16x16x32_bf16 v[104:107], a[220:223], a[156:159], v[104:107]
    v_mfma_f32_16x16x32_bf16 v[108:111], a[220:223], a[180:183], v[108:111]
    v_mfma_f32_16x16x32_bf16 v[96:99], a[224:227], a[112:115], v[96:99]
    v_mfma_f32_16x16x32_bf16 v[100:103], a[224:227], a[136:139], v[100:103]
    ds_read_b128 a[200:203], v1 offset:51200
    v_mfma_f32_16x16x32_bf16 v[104:107], a[224:227], a[160:163], v[104:107]
    v_mfma_f32_16x16x32_bf16 v[108:111], a[224:227], a[184:187], v[108:111]
    v_mfma_f32_16x16x32_bf16 v[96:99], a[228:231], a[116:119], v[96:99]
    v_mfma_f32_16x16x32_bf16 v[100:103], a[228:231], a[140:143], v[100:103]
    v_mfma_f32_16x16x32_bf16 v[104:107], a[228:231], a[164:167], v[104:107]
    v_mfma_f32_16x16x32_bf16 v[108:111], a[228:231], a[188:191], v[108:111]
    v_cvt_pk_bf16_f32 v208, v96, v97
    v_cvt_pk_bf16_f32 v209, v98, v99
    v_mfma_f32_16x16x32_bf16 v[112:115], a[232:235], a[96:99], 0
    v_cvt_pk_bf16_f32 v212, v100, v101
    v_cvt_pk_bf16_f32 v213, v102, v103
    v_mfma_f32_16x16x32_bf16 v[116:119], a[232:235], a[120:123], 0
    v_cvt_pk_bf16_f32 v216, v104, v105
    v_cvt_pk_bf16_f32 v217, v106, v107
    v_mfma_f32_16x16x32_bf16 v[120:123], a[232:235], a[144:147], 0
    v_cvt_pk_bf16_f32 v220, v108, v109
    v_cvt_pk_bf16_f32 v221, v110, v111
    v_mfma_f32_16x16x32_bf16 v[124:127], a[232:235], a[168:171], 0
    v_mfma_f32_16x16x32_bf16 v[112:115], a[236:239], a[100:103], v[112:115]
    v_mfma_f32_16x16x32_bf16 v[116:119], a[236:239], a[124:127], v[116:119]
    v_mfma_f32_16x16x32_bf16 v[120:123], a[236:239], a[148:151], v[120:123]
    v_mfma_f32_16x16x32_bf16 v[124:127], a[236:239], a[172:175], v[124:127]
    buffer_store_dwordx2 v[160:161], v11, s[12:15], s32 offen offset:256 sc1
    v_mfma_f32_16x16x32_bf16 v[112:115], a[240:243], a[104:107], v[112:115]
    v_mfma_f32_16x16x32_bf16 v[116:119], a[240:243], a[128:131], v[116:119]
    v_mfma_f32_16x16x32_bf16 v[120:123], a[240:243], a[152:155], v[120:123]
    v_mfma_f32_16x16x32_bf16 v[124:127], a[240:243], a[176:179], v[124:127]
    s_waitcnt lgkmcnt(0)
    v_mfma_f32_16x16x32_bf16 v[112:115], a[244:247], a[108:111], v[112:115]
    v_mfma_f32_16x16x32_bf16 v[116:119], a[244:247], a[132:135], v[116:119]
    ds_read_b128 a[204:207], v1 offset:52224
    v_mfma_f32_16x16x32_bf16 v[120:123], a[244:247], a[156:159], v[120:123]
    v_mfma_f32_16x16x32_bf16 v[124:127], a[244:247], a[180:183], v[124:127]
    v_mfma_f32_16x16x32_bf16 v[112:115], a[248:251], a[112:115], v[112:115]
    v_mfma_f32_16x16x32_bf16 v[116:119], a[248:251], a[136:139], v[116:119]
    ds_read_b128 a[208:211], v1 offset:53248
    v_mfma_f32_16x16x32_bf16 v[120:123], a[248:251], a[160:163], v[120:123]
    v_mfma_f32_16x16x32_bf16 v[124:127], a[248:251], a[184:187], v[124:127]
    v_mfma_f32_16x16x32_bf16 v[112:115], a[252:255], a[116:119], v[112:115]
    v_mfma_f32_16x16x32_bf16 v[116:119], a[252:255], a[140:143], v[116:119]
    buffer_store_dwordx2 v[162:163], v11, s[12:15], s32 offen offset:640 sc1
    v_mfma_f32_16x16x32_bf16 v[120:123], a[252:255], a[164:167], v[120:123]
    buffer_load_dwordx4 a[56:59], v9, s[8:11], s28 offen offset:128 nt
    v_mfma_f32_16x16x32_bf16 v[124:127], a[252:255], a[188:191], v[124:127]
    buffer_load_dwordx4 a[60:63], v9, s[8:11], s28 offen offset:192 nt
    v_cvt_pk_bf16_f32 v210, v112, v113
    v_mfma_f32_16x16x32_bf16 v[96:99], a[192:195], a[96:99], 0
    ds_read_b128 a[212:215], v1 offset:54272
    v_cvt_pk_bf16_f32 v211, v114, v115
    v_mfma_f32_16x16x32_bf16 v[100:103], a[192:195], a[120:123], 0
    ds_read_b128 a[216:219], v1 offset:55296
    v_cvt_pk_bf16_f32 v214, v116, v117
    v_mfma_f32_16x16x32_bf16 v[104:107], a[192:195], a[144:147], 0
    v_cvt_pk_bf16_f32 v215, v118, v119
    v_cvt_pk_bf16_f32 v218, v120, v121
    v_mfma_f32_16x16x32_bf16 v[108:111], a[192:195], a[168:171], 0
    v_cvt_pk_bf16_f32 v219, v122, v123
    v_cvt_pk_bf16_f32 v222, v124, v125
    v_mfma_f32_16x16x32_bf16 v[96:99], a[196:199], a[100:103], v[96:99]
    v_cvt_pk_bf16_f32 v223, v126, v127
    v_mfma_f32_16x16x32_bf16 v[100:103], a[196:199], a[124:127], v[100:103]
    ds_read_b128 a[220:223], v1 offset:56320
    v_mfma_f32_16x16x32_bf16 v[104:107], a[196:199], a[148:151], v[104:107]
    v_mfma_f32_16x16x32_bf16 v[108:111], a[196:199], a[172:175], v[108:111]
    v_mfma_f32_16x16x32_bf16 v[96:99], a[200:203], a[104:107], v[96:99]
    v_mfma_f32_16x16x32_bf16 v[100:103], a[200:203], a[128:131], v[100:103]
    ds_read_b128 a[224:227], v1 offset:57344
    v_mfma_f32_16x16x32_bf16 v[104:107], a[200:203], a[152:155], v[104:107]
    v_mfma_f32_16x16x32_bf16 v[108:111], a[200:203], a[176:179], v[108:111]
    buffer_store_dwordx2 v[164:165], v11, s[12:15], s32 offen offset:1024 sc1
    v_mfma_f32_16x16x32_bf16 v[32:35], a[108:111], v[208:211], v[32:35]
    v_mfma_f32_16x16x32_bf16 v[36:39], a[132:135], v[208:211], v[36:39]
    ds_read_b128 a[228:231], v1 offset:58368
    v_mfma_f32_16x16x32_bf16 v[40:43], a[156:159], v[208:211], v[40:43]
    v_mfma_f32_16x16x32_bf16 v[44:47], a[180:183], v[208:211], v[44:47]
    v_mfma_f32_16x16x32_bf16 v[48:51], a[108:111], v[212:215], v[48:51]
    v_mfma_f32_16x16x32_bf16 v[52:55], a[132:135], v[212:215], v[52:55]
    ds_read_b128 a[232:235], v1 offset:59392
    v_mfma_f32_16x16x32_bf16 v[56:59], a[156:159], v[212:215], v[56:59]
    v_mfma_f32_16x16x32_bf16 v[60:63], a[180:183], v[212:215], v[60:63]
    v_mfma_f32_16x16x32_bf16 v[64:67], a[108:111], v[216:219], v[64:67]
    v_mfma_f32_16x16x32_bf16 v[68:71], a[132:135], v[216:219], v[68:71]
    ds_read_b128 a[236:239], v1 offset:60416
    v_mfma_f32_16x16x32_bf16 v[72:75], a[156:159], v[216:219], v[72:75]
    v_mfma_f32_16x16x32_bf16 v[76:79], a[180:183], v[216:219], v[76:79]
    v_mfma_f32_16x16x32_bf16 v[80:83], a[108:111], v[220:223], v[80:83]
    v_mfma_f32_16x16x32_bf16 v[84:87], a[132:135], v[220:223], v[84:87]
    buffer_store_dwordx2 v[166:167], v11, s[12:15], s32 offen offset:1408 sc1
    v_mfma_f32_16x16x32_bf16 v[88:91], a[156:159], v[220:223], v[88:91]
    ds_read_b128 a[240:243], v1 offset:61440
    s_add_u32 s32, s32, 25165824
    v_mfma_f32_16x16x32_bf16 v[92:95], a[180:183], v[220:223], v[92:95]
    s_waitcnt lgkmcnt(3)
    v_mfma_f32_16x16x32_bf16 v[96:99], a[204:207], a[108:111], v[96:99]
    ds_read_b128 a[244:247], v1 offset:62464
    v_mfma_f32_16x16x32_bf16 v[100:103], a[204:207], a[132:135], v[100:103]
    v_mfma_f32_16x16x32_bf16 v[104:107], a[204:207], a[156:159], v[104:107]
    v_mfma_f32_16x16x32_bf16 v[108:111], a[204:207], a[180:183], v[108:111]
    v_mfma_f32_16x16x32_bf16 v[96:99], a[208:211], a[112:115], v[96:99]
    ds_read_b128 a[248:251], v1 offset:63488
    v_mfma_f32_16x16x32_bf16 v[100:103], a[208:211], a[136:139], v[100:103]
    v_mfma_f32_16x16x32_bf16 v[104:107], a[208:211], a[160:163], v[104:107]
    v_mfma_f32_16x16x32_bf16 v[108:111], a[208:211], a[184:187], v[108:111]
    v_mfma_f32_16x16x32_bf16 v[96:99], a[212:215], a[116:119], v[96:99]
    v_mfma_f32_16x16x32_bf16 v[100:103], a[212:215], a[140:143], v[100:103]
    v_mfma_f32_16x16x32_bf16 v[104:107], a[212:215], a[164:167], v[104:107]
    buffer_store_dwordx2 v[168:169], v11, s[12:15], s34 offen offset:256 sc1
    v_mfma_f32_16x16x32_bf16 v[108:111], a[212:215], a[188:191], v[108:111]
    v_cvt_pk_bf16_f32 v208, v96, v97
    v_cvt_pk_bf16_f32 v209, v98, v99
    v_mfma_f32_16x16x32_bf16 v[112:115], a[216:219], a[96:99], 0
    v_cvt_pk_bf16_f32 v212, v100, v101
    v_cvt_pk_bf16_f32 v213, v102, v103
    v_mfma_f32_16x16x32_bf16 v[116:119], a[216:219], a[120:123], 0
    v_cvt_pk_bf16_f32 v216, v104, v105
    v_cvt_pk_bf16_f32 v217, v106, v107
    v_mfma_f32_16x16x32_bf16 v[120:123], a[216:219], a[144:147], 0
    v_cvt_pk_bf16_f32 v220, v108, v109
    v_cvt_pk_bf16_f32 v221, v110, v111
    v_mfma_f32_16x16x32_bf16 v[124:127], a[216:219], a[168:171], 0
    v_mfma_f32_16x16x32_bf16 v[112:115], a[220:223], a[100:103], v[112:115]
    v_mfma_f32_16x16x32_bf16 v[116:119], a[220:223], a[124:127], v[116:119]
    v_mfma_f32_16x16x32_bf16 v[120:123], a[220:223], a[148:151], v[120:123]
    v_mfma_f32_16x16x32_bf16 v[124:127], a[220:223], a[172:175], v[124:127]
    v_mfma_f32_16x16x32_bf16 v[112:115], a[224:227], a[104:107], v[112:115]
    v_mfma_f32_16x16x32_bf16 v[116:119], a[224:227], a[128:131], v[116:119]
    v_mfma_f32_16x16x32_bf16 v[120:123], a[224:227], a[152:155], v[120:123]
    v_mfma_f32_16x16x32_bf16 v[124:127], a[224:227], a[176:179], v[124:127]
    v_mfma_f32_16x16x32_bf16 v[112:115], a[228:231], a[108:111], v[112:115]
    buffer_store_dwordx2 v[170:171], v11, s[12:15], s34 offen offset:640 sc1
    v_mfma_f32_16x16x32_bf16 v[116:119], a[228:231], a[132:135], v[116:119]
    ds_read_b128 a[252:255], v1 offset:64512
    v_mfma_f32_16x16x32_bf16 v[120:123], a[228:231], a[156:159], v[120:123]
    buffer_load_dwordx4 a[80:83], v9, s[8:11], s30 offen offset:128 nt
    v_mfma_f32_16x16x32_bf16 v[124:127], a[228:231], a[180:183], v[124:127]
    buffer_load_dwordx4 a[84:87], v9, s[8:11], s30 offen offset:192 nt
    s_waitcnt lgkmcnt(1)
    v_mfma_f32_16x16x32_bf16 v[112:115], a[232:235], a[112:115], v[112:115]
    ds_read_b128 a[192:195], v2 offset:0
    v_mfma_f32_16x16x32_bf16 v[116:119], a[232:235], a[136:139], v[116:119]
    v_mfma_f32_16x16x32_bf16 v[120:123], a[232:235], a[160:163], v[120:123]
    v_mfma_f32_16x16x32_bf16 v[124:127], a[232:235], a[184:187], v[124:127]
    v_mfma_f32_16x16x32_bf16 v[112:115], a[236:239], a[116:119], v[112:115]
    ds_read_b128 a[196:199], v2 offset:1024
    v_mfma_f32_16x16x32_bf16 v[116:119], a[236:239], a[140:143], v[116:119]
    v_mfma_f32_16x16x32_bf16 v[120:123], a[236:239], a[164:167], v[120:123]
    v_mfma_f32_16x16x32_bf16 v[124:127], a[236:239], a[188:191], v[124:127]
    v_cvt_pk_bf16_f32 v210, v112, v113
    v_cvt_pk_bf16_f32 v211, v114, v115
    v_mfma_f32_16x16x32_bf16 v[96:99], a[240:243], a[96:99], 0
    ds_read_b128 a[200:203], v2 offset:2048
    v_cvt_pk_bf16_f32 v214, v116, v117
    v_mfma_f32_16x16x32_bf16 v[100:103], a[240:243], a[120:123], 0
    v_cvt_pk_bf16_f32 v215, v118, v119
    v_cvt_pk_bf16_f32 v218, v120, v121
    v_mfma_f32_16x16x32_bf16 v[104:107], a[240:243], a[144:147], 0
    buffer_store_dwordx2 v[172:173], v11, s[12:15], s34 offen offset:1024 sc1
    v_mfma_f32_16x16x32_bf16 v[108:111], a[240:243], a[168:171], 0
    v_cvt_pk_bf16_f32 v219, v122, v123
    v_cvt_pk_bf16_f32 v222, v124, v125
    v_mfma_f32_16x16x32_bf16 v[96:99], a[244:247], a[100:103], v[96:99]
    ds_read_b128 a[204:207], v2 offset:3072
    v_cvt_pk_bf16_f32 v223, v126, v127
    v_mfma_f32_16x16x32_bf16 v[100:103], a[244:247], a[124:127], v[100:103]
    v_mfma_f32_16x16x32_bf16 v[104:107], a[244:247], a[148:151], v[104:107]
    v_mfma_f32_16x16x32_bf16 v[108:111], a[244:247], a[172:175], v[108:111]
    v_mfma_f32_16x16x32_bf16 v[96:99], a[248:251], a[104:107], v[96:99]
    ds_read_b128 a[208:211], v2 offset:4096
    v_mfma_f32_16x16x32_bf16 v[100:103], a[248:251], a[128:131], v[100:103]
    v_mfma_f32_16x16x32_bf16 v[104:107], a[248:251], a[152:155], v[104:107]
    v_mfma_f32_16x16x32_bf16 v[108:111], a[248:251], a[176:179], v[108:111]
    v_mfma_f32_16x16x32_bf16 v[32:35], a[112:115], v[208:211], v[32:35]
    ds_read_b128 a[212:215], v2 offset:5120
    v_mfma_f32_16x16x32_bf16 v[36:39], a[136:139], v[208:211], v[36:39]
    v_mfma_f32_16x16x32_bf16 v[40:43], a[160:163], v[208:211], v[40:43]
    v_mfma_f32_16x16x32_bf16 v[44:47], a[184:187], v[208:211], v[44:47]
    v_mfma_f32_16x16x32_bf16 v[48:51], a[112:115], v[212:215], v[48:51]
    buffer_store_dwordx2 v[174:175], v11, s[12:15], s34 offen offset:1408 sc1
    v_mfma_f32_16x16x32_bf16 v[52:55], a[136:139], v[212:215], v[52:55]
    ds_read_b128 a[216:219], v2 offset:6144
    s_add_u32 s34, s34, 25165824
    v_mfma_f32_16x16x32_bf16 v[56:59], a[160:163], v[212:215], v[56:59]
    v_mfma_f32_16x16x32_bf16 v[60:63], a[184:187], v[212:215], v[60:63]
    ds_read_b128 a[220:223], v2 offset:7168
    v_mfma_f32_16x16x32_bf16 v[64:67], a[112:115], v[216:219], v[64:67]
    v_mfma_f32_16x16x32_bf16 v[68:71], a[136:139], v[216:219], v[68:71]
    v_mfma_f32_16x16x32_bf16 v[72:75], a[160:163], v[216:219], v[72:75]
    v_mfma_f32_16x16x32_bf16 v[76:79], a[184:187], v[216:219], v[76:79]
    ds_read_b128 a[224:227], v2 offset:8192
    v_mfma_f32_16x16x32_bf16 v[80:83], a[112:115], v[220:223], v[80:83]
    v_mfma_f32_16x16x32_bf16 v[84:87], a[136:139], v[220:223], v[84:87]
    v_mfma_f32_16x16x32_bf16 v[88:91], a[160:163], v[220:223], v[88:91]
    v_mfma_f32_16x16x32_bf16 v[92:95], a[184:187], v[220:223], v[92:95]
    ds_read_b128 a[228:231], v2 offset:9216
    s_waitcnt lgkmcnt(4)
    v_mfma_f32_16x16x32_bf16 v[96:99], a[252:255], a[108:111], v[96:99]
    v_mfma_f32_16x16x32_bf16 v[100:103], a[252:255], a[132:135], v[100:103]
    buffer_store_dwordx2 v[176:177], v11, s[12:15], s36 offen offset:256 sc1
    v_mfma_f32_16x16x32_bf16 v[104:107], a[252:255], a[156:159], v[104:107]
    s_add_u32 s36, s36, 25165824
    s_add_u32 s38, s38, 25165824
    v_mfma_f32_16x16x32_bf16 v[108:111], a[252:255], a[180:183], v[108:111]
    ds_read_b128 a[232:235], v2 offset:10240
    v_mfma_f32_16x16x32_bf16 v[96:99], a[192:195], a[112:115], v[96:99]
    v_mfma_f32_16x16x32_bf16 v[100:103], a[192:195], a[136:139], v[100:103]
    v_mfma_f32_16x16x32_bf16 v[104:107], a[192:195], a[160:163], v[104:107]
    v_mfma_f32_16x16x32_bf16 v[108:111], a[192:195], a[184:187], v[108:111]
    v_mfma_f32_16x16x32_bf16 v[96:99], a[196:199], a[116:119], v[96:99]
    v_mfma_f32_16x16x32_bf16 v[100:103], a[196:199], a[140:143], v[100:103]
    v_mfma_f32_16x16x32_bf16 v[104:107], a[196:199], a[164:167], v[104:107]
    v_mfma_f32_16x16x32_bf16 v[108:111], a[196:199], a[188:191], v[108:111]
    v_cvt_pk_bf16_f32 v208, v96, v97
    v_cvt_pk_bf16_f32 v209, v98, v99
    v_mfma_f32_16x16x32_bf16 v[112:115], a[200:203], a[96:99], 0
    v_cvt_pk_bf16_f32 v212, v100, v101
    v_cvt_pk_bf16_f32 v213, v102, v103
    v_mfma_f32_16x16x32_bf16 v[116:119], a[200:203], a[120:123], 0
    v_cvt_pk_bf16_f32 v216, v104, v105
    v_cvt_pk_bf16_f32 v217, v106, v107
    v_mfma_f32_16x16x32_bf16 v[120:123], a[200:203], a[144:147], 0
    v_cvt_pk_bf16_f32 v220, v108, v109
    v_cvt_pk_bf16_f32 v221, v110, v111
    v_mfma_f32_16x16x32_bf16 v[124:127], a[200:203], a[168:171], 0
    v_mfma_f32_16x16x32_bf16 v[112:115], a[204:207], a[100:103], v[112:115]
    v_mfma_f32_16x16x32_bf16 v[116:119], a[204:207], a[124:127], v[116:119]
    v_mfma_f32_16x16x32_bf16 v[120:123], a[204:207], a[148:151], v[120:123]
    v_mfma_f32_16x16x32_bf16 v[124:127], a[204:207], a[172:175], v[124:127]
    v_mfma_f32_16x16x32_bf16 v[112:115], a[208:211], a[104:107], v[112:115]
    v_mfma_f32_16x16x32_bf16 v[116:119], a[208:211], a[128:131], v[116:119]
    v_mfma_f32_16x16x32_bf16 v[120:123], a[208:211], a[152:155], v[120:123]
    v_mfma_f32_16x16x32_bf16 v[124:127], a[208:211], a[176:179], v[124:127]
    v_mfma_f32_16x16x32_bf16 v[112:115], a[212:215], a[108:111], v[112:115]
    v_mfma_f32_16x16x32_bf16 v[116:119], a[212:215], a[132:135], v[116:119]
    v_mfma_f32_16x16x32_bf16 v[120:123], a[212:215], a[156:159], v[120:123]
    v_mfma_f32_16x16x32_bf16 v[124:127], a[212:215], a[180:183], v[124:127]
    s_waitcnt lgkmcnt(0)
    v_mfma_f32_16x16x32_bf16 v[112:115], a[216:219], a[112:115], v[112:115]
    v_mfma_f32_16x16x32_bf16 v[116:119], a[216:219], a[136:139], v[116:119]
    v_mfma_f32_16x16x32_bf16 v[120:123], a[216:219], a[160:163], v[120:123]
    v_mfma_f32_16x16x32_bf16 v[124:127], a[216:219], a[184:187], v[124:127]
    v_mfma_f32_16x16x32_bf16 v[112:115], a[220:223], a[116:119], v[112:115]
    v_mfma_f32_16x16x32_bf16 v[116:119], a[220:223], a[140:143], v[116:119]
    v_mfma_f32_16x16x32_bf16 v[120:123], a[220:223], a[164:167], v[120:123]
    v_mfma_f32_16x16x32_bf16 v[124:127], a[220:223], a[188:191], v[124:127]
    v_cvt_pk_bf16_f32 v210, v112, v113
    v_cvt_pk_bf16_f32 v211, v114, v115
    v_cvt_pk_bf16_f32 v214, v116, v117
    v_cvt_pk_bf16_f32 v215, v118, v119
    s_nop 0
    v_cvt_pk_bf16_f32 v218, v120, v121
    v_cvt_pk_bf16_f32 v219, v122, v123
    s_nop 0
    v_cvt_pk_bf16_f32 v222, v124, v125
    v_cvt_pk_bf16_f32 v223, v126, v127
    v_mfma_f32_16x16x32_bf16 v[96:99], a[96:99], a[224:227], 0
    buffer_store_dwordx2 v[178:179], v11, s[16:19], s56 offen offset:640 sc1
    v_mfma_f32_16x16x32_bf16 v[100:103], a[120:123], a[224:227], 0
    v_mfma_f32_16x16x32_bf16 v[104:107], a[144:147], a[224:227], 0
    v_mfma_f32_16x16x32_bf16 v[108:111], a[168:171], a[224:227], 0
    v_mfma_f32_16x16x32_bf16 v[96:99], a[100:103], a[228:231], v[96:99]
    buffer_load_dwordx4 a[16:19], v9, s[8:11], s24 offen offset:256 nt
    v_mfma_f32_16x16x32_bf16 v[100:103], a[124:127], a[228:231], v[100:103]
    buffer_load_dwordx4 a[20:23], v9, s[8:11], s24 offen offset:320 nt
    s_add_u32 s24, s24, 25165824
    v_mfma_f32_16x16x32_bf16 v[104:107], a[148:151], a[228:231], v[104:107]
    v_mfma_f32_16x16x32_bf16 v[108:111], a[172:175], a[228:231], v[108:111]
    v_mfma_f32_16x16x32_bf16 v[96:99], a[104:107], a[232:235], v[96:99]
    ds_read_b128 a[236:239], v2 offset:11264
    v_mfma_f32_16x16x32_bf16 v[100:103], a[128:131], a[232:235], v[100:103]
    v_mfma_f32_16x16x32_bf16 v[104:107], a[152:155], a[232:235], v[104:107]
    v_mfma_f32_16x16x32_bf16 v[108:111], a[176:179], a[232:235], v[108:111]
    v_mfma_f32_16x16x32_bf16 v[32:35], a[116:119], v[208:211], v[32:35]
    ds_read_b128 a[240:243], v2 offset:12288
    v_mfma_f32_16x16x32_bf16 v[36:39], a[140:143], v[208:211], v[36:39]
    v_mfma_f32_16x16x32_bf16 v[40:43], a[164:167], v[208:211], v[40:43]
    buffer_store_dwordx2 v[180:181], v11, s[16:19], s56 offen offset:1024 sc1
    v_mfma_f32_16x16x32_bf16 v[44:47], a[188:191], v[208:211], v[44:47]
    ds_read_b128 a[244:247], v2 offset:13312
    v_max3_f32 v12, v32, v33, v34
    v_mfma_f32_16x16x32_bf16 v[48:51], a[116:119], v[212:215], v[48:51]
    v_max3_f32 v12, v12, v35, v36
    v_max3_f32 v12, v12, v37, v38
    v_mfma_f32_16x16x32_bf16 v[52:55], a[140:143], v[212:215], v[52:55]
    v_max3_f32 v12, v12, v39, v40
    v_max3_f32 v12, v12, v41, v42
    v_mfma_f32_16x16x32_bf16 v[56:59], a[164:167], v[212:215], v[56:59]
    v_max3_f32 v12, v12, v43, v44
    v_max3_f32 v12, v12, v45, v46
    v_mfma_f32_16x16x32_bf16 v[60:63], a[188:191], v[212:215], v[60:63]
    ds_read_b128 a[248:251], v2 offset:14336
    v_max3_f32 v13, v48, v49, v50
    v_mfma_f32_16x16x32_bf16 v[64:67], a[116:119], v[216:219], v[64:67]
    v_max3_f32 v13, v13, v51, v52
    v_max3_f32 v13, v13, v53, v54
    v_mfma_f32_16x16x32_bf16 v[68:71], a[140:143], v[216:219], v[68:71]
    v_max3_f32 v13, v13, v55, v56
    v_max3_f32 v13, v13, v57, v58
    v_mfma_f32_16x16x32_bf16 v[72:75], a[164:167], v[216:219], v[72:75]
    v_max3_f32 v13, v13, v59, v60
    v_max3_f32 v13, v13, v61, v62
    v_mfma_f32_16x16x32_bf16 v[76:79], a[188:191], v[216:219], v[76:79]
    ds_read_b128 a[252:255], v2 offset:15360
    v_max3_f32 v14, v64, v65, v66
    v_mfma_f32_16x16x32_bf16 v[80:83], a[116:119], v[220:223], v[80:83]
    v_max3_f32 v14, v14, v67, v68
    v_max3_f32 v14, v14, v69, v70
    v_mfma_f32_16x16x32_bf16 v[84:87], a[140:143], v[220:223], v[84:87]
    v_max3_f32 v14, v14, v71, v72
    v_max3_f32 v14, v14, v73, v74
    v_mfma_f32_16x16x32_bf16 v[88:91], a[164:167], v[220:223], v[88:91]
    v_max3_f32 v14, v14, v75, v76
    v_max3_f32 v14, v14, v77, v78
    v_mfma_f32_16x16x32_bf16 v[92:95], a[188:191], v[220:223], v[92:95]
    buffer_store_dwordx2 v[182:183], v11, s[16:19], s56 offen offset:1408 sc1
    s_waitcnt lgkmcnt(3)
    v_mfma_f32_16x16x32_bf16 v[96:99], a[108:111], a[236:239], v[96:99]
    ds_read_b128 a[192:195], v2 offset:16384
    v_max3_f32 v15, v80, v81, v82
    v_mfma_f32_16x16x32_bf16 v[100:103], a[132:135], a[236:239], v[100:103]
    v_max3_f32 v15, v15, v83, v84
    v_max3_f32 v15, v15, v85, v86
    v_mfma_f32_16x16x32_bf16 v[104:107], a[156:159], a[236:239], v[104:107]
    v_max3_f32 v15, v15, v87, v88
    v_max3_f32 v15, v15, v89, v90
    v_mfma_f32_16x16x32_bf16 v[108:111], a[180:183], a[236:239], v[108:111]
    ds_read_b128 a[196:199], v2 offset:17408
    v_max3_f32 v15, v15, v91, v92
    v_mfma_f32_16x16x32_bf16 v[96:99], a[112:115], a[240:243], v[96:99]
    v_max3_f32 v15, v15, v93, v94
    v_max_f32 v12, v12, v47
    v_mfma_f32_16x16x32_bf16 v[100:103], a[136:139], a[240:243], v[100:103]
    v_max_f32 v13, v13, v63
    v_max_f32 v14, v14, v79
    v_mfma_f32_16x16x32_bf16 v[104:107], a[160:163], a[240:243], v[104:107]
    v_max_f32 v15, v15, v95
    v_permlane16_swap_b32 v12, v13
    v_mfma_f32_16x16x32_bf16 v[108:111], a[184:187], a[240:243], v[108:111]
    ds_read_b128 a[200:203], v2 offset:18432
    s_waitcnt lgkmcnt(4)
    v_mfma_f32_16x16x32_bf16 v[96:99], a[116:119], a[244:247], v[96:99]
    v_permlane16_swap_b32 v14, v15
    v_max_f32 v12, v12, v13
    v_mfma_f32_16x16x32_bf16 v[100:103], a[140:143], a[244:247], v[100:103]
    v_max_f32 v14, v14, v15
    v_mfma_f32_16x16x32_bf16 v[104:107], a[164:167], a[244:247], v[104:107]
    v_mfma_f32_16x16x32_bf16 v[108:111], a[188:191], a[244:247], v[108:111]
    ds_read_b128 a[204:207], v2 offset:19456
    v_cvt_pk_bf16_f32 v128, v96, v97
    v_mfma_f32_16x16x32_bf16 v[112:115], a[96:99], a[248:251], 0
    v_cvt_pk_bf16_f32 v129, v98, v99
    v_cvt_pk_bf16_f32 v130, v100, v101
    v_mfma_f32_16x16x32_bf16 v[116:119], a[120:123], a[248:251], 0
    buffer_store_dwordx2 v[184:185], v11, s[16:19], s58 offen offset:256 sc1
    v_mfma_f32_16x16x32_bf16 v[120:123], a[144:147], a[248:251], 0
    v_cvt_pk_bf16_f32 v131, v102, v103
    v_cvt_pk_bf16_f32 v132, v104, v105
    v_mfma_f32_16x16x32_bf16 v[124:127], a[168:171], a[248:251], 0
    ds_read_b128 a[208:211], v2 offset:20480
    s_waitcnt lgkmcnt(4)
    v_mfma_f32_16x16x32_bf16 v[112:115], a[100:103], a[252:255], v[112:115]
    v_cvt_pk_bf16_f32 v133, v106, v107
    v_cvt_pk_bf16_f32 v134, v108, v109
    v_mfma_f32_16x16x32_bf16 v[116:119], a[124:127], a[252:255], v[116:119]
    v_cvt_pk_bf16_f32 v135, v110, v111
    v_permlane32_swap_b32 v12, v14
    v_mfma_f32_16x16x32_bf16 v[120:123], a[148:151], a[252:255], v[120:123]
    v_max_f32 v12, v12, v14
    v_mul_f32 v12, s40, v12
    v_mfma_f32_16x16x32_bf16 v[124:127], a[172:175], a[252:255], v[124:127]
    ds_read_b128 a[212:215], v2 offset:21504
    v_mov_b32 v14, v12
    v_mfma_f32_16x16x32_bf16 v[112:115], a[104:107], a[192:195], v[112:115]
    v_mfma_f32_16x16x32_bf16 v[116:119], a[128:131], a[192:195], v[116:119]
    v_permlane32_swap_b32 v12, v14
    v_mov_b32 v13, v12
    v_mfma_f32_16x16x32_bf16 v[120:123], a[152:155], a[192:195], v[120:123]
    v_mov_b32 v15, v14
    v_permlane16_swap_b32 v12, v13
    v_mfma_f32_16x16x32_bf16 v[124:127], a[176:179], a[192:195], v[124:127]
    ds_read_b128 a[216:219], v2 offset:22528
    s_waitcnt lgkmcnt(4)
    v_mfma_f32_16x16x32_bf16 v[112:115], a[108:111], a[196:199], v[112:115]
    v_permlane16_swap_b32 v14, v15
    v_fma_f32 v32, v32, s40, -v12
    v_mfma_f32_16x16x32_bf16 v[116:119], a[132:135], a[196:199], v[116:119]
    v_fma_f32 v33, v33, s40, -v12
    v_fma_f32 v48, v48, s40, -v13
    v_mfma_f32_16x16x32_bf16 v[120:123], a[156:159], a[196:199], v[120:123]
    v_fma_f32 v49, v49, s40, -v13
    v_fma_f32 v64, v64, s40, -v14
    v_mfma_f32_16x16x32_bf16 v[124:127], a[180:183], a[196:199], v[124:127]
    buffer_store_dwordx2 v[186:187], v11, s[16:19], s58 offen offset:640 sc1
    v_mfma_f32_16x16x32_bf16 v[112:115], a[112:115], a[200:203], v[112:115]
    ds_read_b128 a[220:223], v2 offset:23552
    v_fma_f32 v65, v65, s40, -v14
    v_mfma_f32_16x16x32_bf16 v[116:119], a[136:139], a[200:203], v[116:119]
    v_fma_f32 v80, v80, s40, -v15
    v_fma_f32 v81, v81, s40, -v15
    v_mfma_f32_16x16x32_bf16 v[120:123], a[160:163], a[200:203], v[120:123]
    v_exp_f32 v32, v32
    v_mfma_f32_16x16x32_bf16 v[124:127], a[184:187], a[200:203], v[124:127]
    ds_read_b128 a[224:227], v2 offset:24576
    s_waitcnt lgkmcnt(4)
    v_mfma_f32_16x16x32_bf16 v[112:115], a[116:119], a[204:207], v[112:115]
    v_exp_f32 v33, v33
    v_mfma_f32_16x16x32_bf16 v[116:119], a[140:143], a[204:207], v[116:119]
    buffer_load_dwordx4 a[40:43], v9, s[8:11], s26 offen offset:256 nt
    v_fma_f32 v34, v34, s40, -v12
    v_mfma_f32_16x16x32_bf16 v[120:123], a[164:167], a[204:207], v[120:123]
    buffer_load_dwordx4 a[44:47], v9, s[8:11], s26 offen offset:320 nt
    v_fma_f32 v50, v50, s40, -v13
    v_mfma_f32_16x16x32_bf16 v[124:127], a[188:191], a[204:207], v[124:127]
    ds_read_b128 a[228:231], v2 offset:25600
    v_cvt_pk_bf16_f32 v136, v112, v113
    v_mfma_f32_16x16x32_bf16 v[96:99], a[96:99], a[208:211], 0
    v_cvt_pk_bf16_f32 v137, v114, v115
    v_cvt_pk_bf16_f32 v138, v116, v117
    v_mfma_f32_16x16x32_bf16 v[100:103], a[120:123], a[208:211], 0
    v_cvt_pk_bf16_f32 v139, v118, v119
    v_cvt_pk_bf16_f32 v140, v120, v121
    v_mfma_f32_16x16x32_bf16 v[104:107], a[144:147], a[208:211], 0
    v_cvt_pk_bf16_f32 v141, v122, v123
    v_cvt_pk_bf16_f32 v142, v124, v125
    v_mfma_f32_16x16x32_bf16 v[108:111], a[168:171], a[208:211], 0
    ds_read_b128 a[232:235], v2 offset:26624
    s_waitcnt lgkmcnt(4)
    v_mfma_f32_16x16x32_bf16 v[96:99], a[100:103], a[212:215], v[96:99]
    v_cvt_pk_bf16_f32 v143, v126, v127
    v_fma_f32 v66, v66, s40, -v14
    v_mfma_f32_16x16x32_bf16 v[100:103], a[124:127], a[212:215], v[100:103]
    buffer_store_dwordx2 v[188:189], v11, s[16:19], s58 offen offset:1024 sc1
    v_mfma_f32_16x16x32_bf16 v[104:107], a[148:151], a[212:215], v[104:107]
    ds_read_b128 a[236:239], v2 offset:27648
    v_fma_f32 v82, v82, s40, -v15
    v_mfma_f32_16x16x32_bf16 v[108:111], a[172:175], a[212:215], v[108:111]
    v_exp_f32 v48, v48
    v_mfma_f32_16x16x32_bf16 v[96:99], a[104:107], a[216:219], v[96:99]
    v_exp_f32 v49, v49
    v_mfma_f32_16x16x32_bf16 v[100:103], a[128:131], a[216:219], v[100:103]
    v_exp_f32 v64, v64
    v_mfma_f32_16x16x32_bf16 v[104:107], a[152:155], a[216:219], v[104:107]
    ds_read_b128 a[240:243], v2 offset:28672
    v_fma_f32 v35, v35, s40, -v12
    v_mfma_f32_16x16x32_bf16 v[108:111], a[176:179], a[216:219], v[108:111]
    v_fma_f32 v51, v51, s40, -v13
    s_waitcnt lgkmcnt(4)
    v_mfma_f32_16x16x32_bf16 v[96:99], a[108:111], a[220:223], v[96:99]
    v_exp_f32 v65, v65
    v_mfma_f32_16x16x32_bf16 v[100:103], a[132:135], a[220:223], v[100:103]
    v_exp_f32 v80, v80
    v_mfma_f32_16x16x32_bf16 v[104:107], a[156:159], a[220:223], v[104:107]
    ds_read_b128 a[244:247], v2 offset:29696
    v_fma_f32 v67, v67, s40, -v14
    v_mfma_f32_16x16x32_bf16 v[108:111], a[180:183], a[220:223], v[108:111]
    v_exp_f32 v81, v81
    v_mfma_f32_16x16x32_bf16 v[96:99], a[112:115], a[224:227], v[96:99]
    v_exp_f32 v34, v34
    v_mfma_f32_16x16x32_bf16 v[100:103], a[136:139], a[224:227], v[100:103]
    v_exp_f32 v50, v50
    v_mfma_f32_16x16x32_bf16 v[104:107], a[160:163], a[224:227], v[104:107]
    buffer_store_dwordx2 v[190:191], v11, s[16:19], s58 offen offset:1408 sc1
    v_mfma_f32_16x16x32_bf16 v[108:111], a[184:187], a[224:227], v[108:111]
    ds_read_b128 a[248:251], v2 offset:30720
    s_waitcnt lgkmcnt(4)
    v_mfma_f32_16x16x32_bf16 v[96:99], a[116:119], a[228:231], v[96:99]
    v_exp_f32 v66, v66
    v_mfma_f32_16x16x32_bf16 v[100:103], a[140:143], a[228:231], v[100:103]
    v_exp_f32 v82, v82
    v_mfma_f32_16x16x32_bf16 v[104:107], a[164:167], a[228:231], v[104:107]
    ds_read_b128 a[252:255], v2 offset:31744
    v_fma_f32 v83, v83, s40, -v15
    v_mfma_f32_16x16x32_bf16 v[108:111], a[188:191], a[228:231], v[108:111]
    v_cvt_pk_bf16_f32 v144, v96, v97
    v_cvt_pk_bf16_f32 v145, v98, v99
    v_mfma_f32_16x16x32_bf16 v[112:115], a[96:99], a[232:235], 0
    v_cvt_pk_bf16_f32 v146, v100, v101
    v_cvt_pk_bf16_f32 v147, v102, v103
    v_mfma_f32_16x16x32_bf16 v[116:119], a[120:123], a[232:235], 0
    v_cvt_pk_bf16_f32 v148, v104, v105
    v_cvt_pk_bf16_f32 v149, v106, v107
    v_mfma_f32_16x16x32_bf16 v[120:123], a[144:147], a[232:235], 0
    ds_read_b128 a[192:195], v2 offset:32768
    v_cvt_pk_bf16_f32 v150, v108, v109
    v_mfma_f32_16x16x32_bf16 v[124:127], a[168:171], a[232:235], 0
    v_cvt_pk_bf16_f32 v151, v110, v111
    v_fma_f32 v36, v36, s40, -v12
    s_waitcnt lgkmcnt(3)
    v_mfma_f32_16x16x32_bf16 v[112:115], a[100:103], a[236:239], v[112:115]
    v_exp_f32 v35, v35
    v_mfma_f32_16x16x32_bf16 v[116:119], a[124:127], a[236:239], v[116:119]
    v_exp_f32 v51, v51
    v_mfma_f32_16x16x32_bf16 v[120:123], a[148:151], a[236:239], v[120:123]
    ds_read_b128 a[196:199], v2 offset:33792
    v_fma_f32 v52, v52, s40, -v13
    v_mfma_f32_16x16x32_bf16 v[124:127], a[172:175], a[236:239], v[124:127]
    v_fma_f32 v68, v68, s40, -v14
    v_mfma_f32_16x16x32_bf16 v[112:115], a[104:107], a[240:243], v[112:115]
    v_exp_f32 v67, v67
    v_mfma_f32_16x16x32_bf16 v[116:119], a[128:131], a[240:243], v[116:119]
    v_exp_f32 v83, v83
    v_mfma_f32_16x16x32_bf16 v[120:123], a[152:155], a[240:243], v[120:123]
    ds_read_b128 a[200:203], v2 offset:34816
    v_fma_f32 v84, v84, s40, -v15
    v_mfma_f32_16x16x32_bf16 v[124:127], a[176:179], a[240:243], v[124:127]
    v_add_f32 v20, v32, v33
    v_fma_f32 v37, v37, s40, -v12
    v_mfma_f32_16x16x32_bf16 v[112:115], a[108:111], a[244:247], v[112:115]
    v_exp_f32 v36, v36
    v_mfma_f32_16x16x32_bf16 v[116:119], a[132:135], a[244:247], v[116:119]
    v_add_f32 v21, v48, v49
    v_fma_f32 v53, v53, s40, -v13
    v_mfma_f32_16x16x32_bf16 v[120:123], a[156:159], a[244:247], v[120:123]
    buffer_store_dwordx2 v[224:225], v11, s[16:19], s52 offen offset:0 sc1
    v_mfma_f32_16x16x32_bf16 v[124:127], a[180:183], a[244:247], v[124:127]
    ds_read_b128 a[204:207], v2 offset:35840
    s_waitcnt lgkmcnt(4)
    v_mfma_f32_16x16x32_bf16 v[112:115], a[112:115], a[248:251], v[112:115]
    v_exp_f32 v52, v52
    v_mfma_f32_16x16x32_bf16 v[116:119], a[136:139], a[248:251], v[116:119]
    v_add_f32 v22, v64, v65
    v_fma_f32 v69, v69, s40, -v14
    v_mfma_f32_16x16x32_bf16 v[120:123], a[160:163], a[248:251], v[120:123]
    ds_read_b128 a[208:211], v2 offset:36864
    v_add_f32 v23, v80, v81
    v_mfma_f32_16x16x32_bf16 v[124:127], a[184:187], a[248:251], v[124:127]
    v_exp_f32 v68, v68
    v_mfma_f32_16x16x32_bf16 v[112:115], a[116:119], a[252:255], v[112:115]
    v_exp_f32 v84, v84
    v_mfma_f32_16x16x32_bf16 v[116:119], a[140:143], a[252:255], v[116:119]
    v_fma_f32 v85, v85, s40, -v15
    v_add_f32 v20, v20, v34
    v_mfma_f32_16x16x32_bf16 v[120:123], a[164:167], a[252:255], v[120:123]
    ds_read_b128 a[212:215], v2 offset:37888
    v_fma_f32 v38, v38, s40, -v12
    v_mfma_f32_16x16x32_bf16 v[124:127], a[188:191], a[252:255], v[124:127]
    v_cvt_pk_bf16_f32 v152, v112, v113
    v_cvt_pk_bf16_f32 v153, v114, v115
    s_waitcnt lgkmcnt(3)
    v_mfma_f32_16x16x32_bf16 v[96:99], a[96:99], a[192:195], 0
    v_cvt_pk_bf16_f32 v154, v116, v117
    v_cvt_pk_bf16_f32 v155, v118, v119
    v_mfma_f32_16x16x32_bf16 v[100:103], a[120:123], a[192:195], 0
    v_cvt_pk_bf16_f32 v156, v120, v121
    v_cvt_pk_bf16_f32 v157, v122, v123
    v_mfma_f32_16x16x32_bf16 v[104:107], a[144:147], a[192:195], 0
    buffer_store_dwordx2 v[226:227], v11, s[16:19], s52 offen offset:384 sc1
    v_mfma_f32_16x16x32_bf16 v[108:111], a[168:171], a[192:195], 0
    ds_read_b128 a[216:219], v2 offset:38912
    v_mfma_f32_16x16x32_bf16 v[96:99], a[100:103], a[196:199], v[96:99]
    v_cvt_pk_bf16_f32 v158, v124, v125
    v_cvt_pk_bf16_f32 v159, v126, v127
    v_mfma_f32_16x16x32_bf16 v[100:103], a[124:127], a[196:199], v[100:103]
    v_exp_f32 v37, v37
    v_mfma_f32_16x16x32_bf16 v[104:107], a[148:151], a[196:199], v[104:107]
    buffer_load_dwordx4 a[64:67], v9, s[8:11], s28 offen offset:256 nt
    v_add_f32 v21, v21, v50
    v_mfma_f32_16x16x32_bf16 v[108:111], a[172:175], a[196:199], v[108:111]
    buffer_load_dwordx4 a[68:71], v9, s[8:11], s28 offen offset:320 nt
    v_fma_f32 v54, v54, s40, -v13
    v_mfma_f32_16x16x32_bf16 v[96:99], a[104:107], a[200:203], v[96:99]
    ds_read_b128 a[220:223], v2 offset:39936
    v_add_f32 v22, v22, v66
    v_mfma_f32_16x16x32_bf16 v[100:103], a[128:131], a[200:203], v[100:103]
    v_exp_f32 v53, v53
    v_mfma_f32_16x16x32_bf16 v[104:107], a[152:155], a[200:203], v[104:107]
    ds_read_b128 a[224:227], v2 offset:40960
    v_fma_f32 v70, v70, s40, -v14
    v_mfma_f32_16x16x32_bf16 v[108:111], a[176:179], a[200:203], v[108:111]
    v_add_f32 v23, v23, v82
    s_waitcnt lgkmcnt(4)
    v_mfma_f32_16x16x32_bf16 v[96:99], a[108:111], a[204:207], v[96:99]
    v_exp_f32 v69, v69
    v_mfma_f32_16x16x32_bf16 v[100:103], a[132:135], a[204:207], v[100:103]
    v_exp_f32 v85, v85
    v_mfma_f32_16x16x32_bf16 v[104:107], a[156:159], a[204:207], v[104:107]
    buffer_store_dwordx2 v[228:229], v11, s[16:19], s52 offen offset:768 sc1
    v_mfma_f32_16x16x32_bf16 v[108:111], a[180:183], a[204:207], v[108:111]
    ds_read_b128 a[228:231], v2 offset:41984
    v_fma_f32 v86, v86, s40, -v15
    v_mfma_f32_16x16x32_bf16 v[96:99], a[112:115], a[208:211], v[96:99]
    v_add_f32 v20, v20, v35
    v_fma_f32 v39, v39, s40, -v12
    v_mfma_f32_16x16x32_bf16 v[100:103], a[136:139], a[208:211], v[100:103]
    ds_read_b128 a[232:235], v2 offset:43008
    v_add_f32 v21, v21, v51
    v_mfma_f32_16x16x32_bf16 v[104:107], a[160:163], a[208:211], v[104:107]
    v_exp_f32 v38, v38
    v_mfma_f32_16x16x32_bf16 v[108:111], a[184:187], a[208:211], v[108:111]
    v_exp_f32 v54, v54
    s_waitcnt lgkmcnt(4)
    v_mfma_f32_16x16x32_bf16 v[96:99], a[116:119], a[212:215], v[96:99]
    v_fma_f32 v55, v55, s40, -v13
    v_add_f32 v22, v22, v67
    v_mfma_f32_16x16x32_bf16 v[100:103], a[140:143], a[212:215], v[100:103]
    ds_read_b128 a[236:239], v2 offset:44032
    v_fma_f32 v71, v71, s40, -v14
    v_mfma_f32_16x16x32_bf16 v[104:107], a[164:167], a[212:215], v[104:107]
    v_exp_f32 v70, v70
    v_mfma_f32_16x16x32_bf16 v[108:111], a[188:191], a[212:215], v[108:111]
    v_cvt_pk_bf16_f32 v160, v96, v97
    v_mfma_f32_16x16x32_bf16 v[112:115], a[96:99], a[216:219], 0
    v_cvt_pk_bf16_f32 v161, v98, v99
    v_cvt_pk_bf16_f32 v162, v100, v101
    v_mfma_f32_16x16x32_bf16 v[116:119], a[120:123], a[216:219], 0
    buffer_store_dwordx2 v[230:231], v11, s[16:19], s52 offen offset:1152 sc1
    v_mfma_f32_16x16x32_bf16 v[120:123], a[144:147], a[216:219], 0
    ds_read_b128 a[240:243], v2 offset:45056
    v_cvt_pk_bf16_f32 v163, v102, v103
    v_mfma_f32_16x16x32_bf16 v[124:127], a[168:171], a[216:219], 0
    v_cvt_pk_bf16_f32 v164, v104, v105
    v_cvt_pk_bf16_f32 v165, v106, v107
    s_waitcnt lgkmcnt(4)
    v_mfma_f32_16x16x32_bf16 v[112:115], a[100:103], a[220:223], v[112:115]
    v_cvt_pk_bf16_f32 v166, v108, v109
    v_cvt_pk_bf16_f32 v167, v110, v111
    v_mfma_f32_16x16x32_bf16 v[116:119], a[124:127], a[220:223], v[116:119]
    ds_read_b128 a[244:247], v2 offset:46080
    v_add_f32 v23, v23, v83
    v_mfma_f32_16x16x32_bf16 v[120:123], a[148:151], a[220:223], v[120:123]
    v_exp_f32 v86, v86
    v_mfma_f32_16x16x32_bf16 v[124:127], a[172:175], a[220:223], v[124:127]
    v_fma_f32 v87, v87, s40, -v15
    v_add_f32 v20, v20, v36
    v_mfma_f32_16x16x32_bf16 v[112:115], a[104:107], a[224:227], v[112:115]
    v_exp_f32 v39, v39
    v_mfma_f32_16x16x32_bf16 v[116:119], a[128:131], a[224:227], v[116:119]
    ds_read_b128 a[248:251], v2 offset:47104
    v_fma_f32 v40, v40, s40, -v12
    v_mfma_f32_16x16x32_bf16 v[120:123], a[152:155], a[224:227], v[120:123]
    v_add_f32 v21, v21, v52
    v_fma_f32 v56, v56, s40, -v13
    v_mfma_f32_16x16x32_bf16 v[124:127], a[176:179], a[224:227], v[124:127]
    v_add_f32 v22, v22, v68
    s_waitcnt lgkmcnt(3)
    v_mfma_f32_16x16x32_bf16 v[112:115], a[108:111], a[228:231], v[112:115]
    v_exp_f32 v55, v55
    v_mfma_f32_16x16x32_bf16 v[116:119], a[132:135], a[228:231], v[116:119]
    buffer_store_dwordx2 v[232:233], v11, s[16:19], s54 offen offset:0 sc1
    v_mfma_f32_16x16x32_bf16 v[120:123], a[156:159], a[228:231], v[120:123]
    ds_read_b128 a[252:255], v2 offset:48128
    v_fma_f32 v72, v72, s40, -v14
    v_mfma_f32_16x16x32_bf16 v[124:127], a[180:183], a[228:231], v[124:127]
    v_exp_f32 v71, v71
    v_mfma_f32_16x16x32_bf16 v[112:115], a[112:115], a[232:235], v[112:115]
    v_add_f32 v23, v23, v84
    v_fma_f32 v88, v88, s40, -v15
    v_mfma_f32_16x16x32_bf16 v[116:119], a[136:139], a[232:235], v[116:119]
    ds_read_b128 a[192:195], v2 offset:49152
    v_add_f32 v20, v20, v37
    v_mfma_f32_16x16x32_bf16 v[120:123], a[160:163], a[232:235], v[120:123]
    v_exp_f32 v87, v87
    v_mfma_f32_16x16x32_bf16 v[124:127], a[184:187], a[232:235], v[124:127]
    v_exp_f32 v40, v40
    v_mfma_f32_16x16x32_bf16 v[112:115], a[116:119], a[236:239], v[112:115]
    v_fma_f32 v41, v41, s40, -v12
    v_add_f32 v21, v21, v53
    v_mfma_f32_16x16x32_bf16 v[116:119], a[140:143], a[236:239], v[116:119]
    ds_read_b128 a[196:199], v2 offset:50176
    v_fma_f32 v57, v57, s40, -v13
    v_mfma_f32_16x16x32_bf16 v[120:123], a[164:167], a[236:239], v[120:123]
    v_exp_f32 v56, v56
    v_mfma_f32_16x16x32_bf16 v[124:127], a[188:191], a[236:239], v[124:127]
    v_cvt_pk_bf16_f32 v168, v112, v113
    s_waitcnt lgkmcnt(3)
    v_mfma_f32_16x16x32_bf16 v[96:99], a[96:99], a[240:243], 0
    v_cvt_pk_bf16_f32 v169, v114, v115
    v_cvt_pk_bf16_f32 v170, v116, v117
    v_mfma_f32_16x16x32_bf16 v[100:103], a[120:123], a[240:243], 0
    buffer_store_dwordx2 v[234:235], v11, s[16:19], s54 offen offset:384 sc1
    v_mfma_f32_16x16x32_bf16 v[104:107], a[144:147], a[240:243], 0
    ds_read_b128 a[200:203], v2 offset:51200
    v_cvt_pk_bf16_f32 v171, v118, v119
    v_mfma_f32_16x16x32_bf16 v[108:111], a[168:171], a[240:243], 0
    v_cvt_pk_bf16_f32 v172, v120, v121
    v_cvt_pk_bf16_f32 v173, v122, v123
    v_mfma_f32_16x16x32_bf16 v[96:99], a[100:103], a[244:247], v[96:99]
    v_cvt_pk_bf16_f32 v174, v124, v125
    v_cvt_pk_bf16_f32 v175, v126, v127
    v_mfma_f32_16x16x32_bf16 v[100:103], a[124:127], a[244:247], v[100:103]
    ds_read_b128 a[204:207], v2 offset:52224
    v_add_f32 v22, v22, v69
    v_mfma_f32_16x16x32_bf16 v[104:107], a[148:151], a[244:247], v[104:107]
    v_exp_f32 v72, v72
    v_mfma_f32_16x16x32_bf16 v[108:111], a[172:175], a[244:247], v[108:111]
    v_fma_f32 v73, v73, s40, -v14
    v_add_f32 v23, v23, v85
    v_mfma_f32_16x16x32_bf16 v[96:99], a[104:107], a[248:251], v[96:99]
    v_exp_f32 v88, v88
    v_mfma_f32_16x16x32_bf16 v[100:103], a[128:131], a[248:251], v[100:103]
    ds_read_b128 a[208:211], v2 offset:53248
    v_fma_f32 v89, v89, s40, -v15
    v_mfma_f32_16x16x32_bf16 v[104:107], a[152:155], a[248:251], v[104:107]
    v_add_f32 v20, v20, v38
    v_fma_f32 v42, v42, s40, -v12
    v_mfma_f32_16x16x32_bf16 v[108:111], a[176:179], a[248:251], v[108:111]
    v_add_f32 v21, v21, v54
    s_waitcnt lgkmcnt(3)
    v_mfma_f32_16x16x32_bf16 v[96:99], a[108:111], a[252:255], v[96:99]
    v_exp_f32 v41, v41
    v_mfma_f32_16x16x32_bf16 v[100:103], a[132:135], a[252:255], v[100:103]
    buffer_store_dwordx2 v[236:237], v11, s[16:19], s54 offen offset:768 sc1
    v_mfma_f32_16x16x32_bf16 v[104:107], a[156:159], a[252:255], v[104:107]
    buffer_load_dwordx4 a[88:91], v9, s[8:11], s30 offen offset:256 nt
    v_fma_f32 v58, v58, s40, -v13
    v_mfma_f32_16x16x32_bf16 v[108:111], a[180:183], a[252:255], v[108:111]
    buffer_load_dwordx4 a[92:95], v9, s[8:11], s30 offen offset:320 nt
    v_add_f32 v22, v22, v70
    v_mfma_f32_16x16x32_bf16 v[96:99], a[112:115], a[192:195], v[96:99]
    ds_read_b128 a[212:215], v2 offset:54272
    v_fma_f32 v74, v74, s40, -v14
    v_mfma_f32_16x16x32_bf16 v[100:103], a[136:139], a[192:195], v[100:103]
    ds_read_b128 a[216:219], v2 offset:55296
    v_add_f32 v23, v23, v86
    v_mfma_f32_16x16x32_bf16 v[104:107], a[160:163], a[192:195], v[104:107]
    v_exp_f32 v57, v57
    v_mfma_f32_16x16x32_bf16 v[108:111], a[184:187], a[192:195], v[108:111]
    v_exp_f32 v73, v73
    v_mfma_f32_16x16x32_bf16 v[96:99], a[116:119], a[196:199], v[96:99]
    ds_read_b128 a[220:223], v2 offset:56320
    v_fma_f32 v90, v90, s40, -v15
    v_mfma_f32_16x16x32_bf16 v[100:103], a[140:143], a[196:199], v[100:103]
    v_exp_f32 v89, v89
    v_mfma_f32_16x16x32_bf16 v[104:107], a[164:167], a[196:199], v[104:107]
    v_add_f32 v20, v20, v39
    v_fma_f32 v43, v43, s40, -v12
    v_mfma_f32_16x16x32_bf16 v[108:111], a[188:191], a[196:199], v[108:111]
    v_cvt_pk_bf16_f32 v176, v96, v97
    s_waitcnt lgkmcnt(3)
    v_mfma_f32_16x16x32_bf16 v[112:115], a[96:99], a[200:203], 0
    buffer_store_dwordx2 v[238:239], v11, s[16:19], s54 offen offset:1152 sc1
    v_mfma_f32_16x16x32_bf16 v[116:119], a[120:123], a[200:203], 0
    ds_read_b128 a[224:227], v2 offset:57344
    v_cvt_pk_bf16_f32 v177, v98, v99
    v_mfma_f32_16x16x32_bf16 v[120:123], a[144:147], a[200:203], 0
    v_cvt_pk_bf16_f32 v178, v100, v101
    v_cvt_pk_bf16_f32 v179, v102, v103
    v_mfma_f32_16x16x32_bf16 v[124:127], a[168:171], a[200:203], 0
    v_cvt_pk_bf16_f32 v180, v104, v105
    v_cvt_pk_bf16_f32 v181, v106, v107
    v_mfma_f32_16x16x32_bf16 v[112:115], a[100:103], a[204:207], v[112:115]
    ds_read_b128 a[228:231], v2 offset:58368
    v_cvt_pk_bf16_f32 v182, v108, v109
    v_mfma_f32_16x16x32_bf16 v[116:119], a[124:127], a[204:207], v[116:119]
    v_cvt_pk_bf16_f32 v183, v110, v111
    v_add_f32 v21, v21, v55
    v_mfma_f32_16x16x32_bf16 v[120:123], a[148:151], a[204:207], v[120:123]
    v_exp_f32 v42, v42
    v_mfma_f32_16x16x32_bf16 v[124:127], a[172:175], a[204:207], v[124:127]
    v_exp_f32 v58, v58
    v_mfma_f32_16x16x32_bf16 v[112:115], a[104:107], a[208:211], v[112:115]
    ds_read_b128 a[232:235], v2 offset:59392
    v_fma_f32 v59, v59, s40, -v13
    v_mfma_f32_16x16x32_bf16 v[116:119], a[128:131], a[208:211], v[116:119]
    v_add_f32 v22, v22, v71
    v_fma_f32 v75, v75, s40, -v14
    v_mfma_f32_16x16x32_bf16 v[120:123], a[152:155], a[208:211], v[120:123]
    v_exp_f32 v74, v74
    v_mfma_f32_16x16x32_bf16 v[124:127], a[176:179], a[208:211], v[124:127]
    v_add_f32 v23, v23, v87
    s_waitcnt lgkmcnt(3)
    v_mfma_f32_16x16x32_bf16 v[112:115], a[108:111], a[212:215], v[112:115]
    buffer_store_dwordx2 v[240:241], v11, s[16:19], s56 offen offset:0 sc1
    v_mfma_f32_16x16x32_bf16 v[116:119], a[132:135], a[212:215], v[116:119]
    ds_read_b128 a[236:239], v2 offset:60416
    v_fma_f32 v91, v91, s40, -v15
    v_mfma_f32_16x16x32_bf16 v[120:123], a[156:159], a[212:215], v[120:123]
    v_exp_f32 v90, v90
    v_mfma_f32_16x16x32_bf16 v[124:127], a[180:183], a[212:215], v[124:127]
    v_add_f32 v20, v20, v40
    v_fma_f32 v44, v44, s40, -v12
    v_mfma_f32_16x16x32_bf16 v[112:115], a[112:115], a[216:219], v[112:115]
    ds_read_b128 a[240:243], v2 offset:61440
    v_add_f32 v21, v21, v56
    v_mfma_f32_16x16x32_bf16 v[116:119], a[136:139], a[216:219], v[116:119]
    v_exp_f32 v43, v43
    v_mfma_f32_16x16x32_bf16 v[120:123], a[160:163], a[216:219], v[120:123]
    v_exp_f32 v59, v59
    v_mfma_f32_16x16x32_bf16 v[124:127], a[184:187], a[216:219], v[124:127]
    v_fma_f32 v60, v60, s40, -v13
    v_add_f32 v22, v22, v72
    v_mfma_f32_16x16x32_bf16 v[112:115], a[116:119], a[220:223], v[112:115]
    ds_read_b128 a[244:247], v2 offset:62464
    v_fma_f32 v76, v76, s40, -v14
    v_mfma_f32_16x16x32_bf16 v[116:119], a[140:143], a[220:223], v[116:119]
    v_exp_f32 v75, v75
    v_mfma_f32_16x16x32_bf16 v[120:123], a[164:167], a[220:223], v[120:123]
    v_add_f32 v23, v23, v88
    v_fma_f32 v92, v92, s40, -v15
    v_mfma_f32_16x16x32_bf16 v[124:127], a[188:191], a[220:223], v[124:127]
    v_cvt_pk_bf16_f32 v184, v112, v113
    s_waitcnt lgkmcnt(3)
    v_mfma_f32_16x16x32_bf16 v[96:99], a[96:99], a[224:227], 0
    buffer_store_dwordx2 v[242:243], v11, s[16:19], s56 offen offset:384 sc1
    v_mfma_f32_16x16x32_bf16 v[100:103], a[120:123], a[224:227], 0
    ds_read_b128 a[248:251], v2 offset:63488
    v_cvt_pk_bf16_f32 v185, v114, v115
    v_mfma_f32_16x16x32_bf16 v[104:107], a[144:147], a[224:227], 0
    v_cvt_pk_bf16_f32 v186, v116, v117
    v_cvt_pk_bf16_f32 v187, v118, v119
    v_mfma_f32_16x16x32_bf16 v[108:111], a[168:171], a[224:227], 0
    v_cvt_pk_bf16_f32 v188, v120, v121
    v_cvt_pk_bf16_f32 v189, v122, v123
    v_mfma_f32_16x16x32_bf16 v[96:99], a[100:103], a[228:231], v[96:99]
    ds_read_b128 a[252:255], v2 offset:64512
    v_cvt_pk_bf16_f32 v190, v124, v125
    v_mfma_f32_16x16x32_bf16 v[100:103], a[124:127], a[228:231], v[100:103]
    v_cvt_pk_bf16_f32 v191, v126, v127
    v_add_f32 v20, v20, v41
    v_mfma_f32_16x16x32_bf16 v[104:107], a[148:151], a[228:231], v[104:107]
    v_exp_f32 v91, v91
    v_mfma_f32_16x16x32_bf16 v[108:111], a[172:175], a[228:231], v[108:111]
    v_exp_f32 v44, v44
    v_mfma_f32_16x16x32_bf16 v[96:99], a[104:107], a[232:235], v[96:99]
    ds_read_b128 a[192:195], v3 offset:0
    v_fma_f32 v45, v45, s40, -v12
    v_mfma_f32_16x16x32_bf16 v[100:103], a[128:131], a[232:235], v[100:103]
    v_add_f32 v21, v21, v57
    v_fma_f32 v61, v61, s40, -v13
    v_mfma_f32_16x16x32_bf16 v[104:107], a[152:155], a[232:235], v[104:107]
    v_exp_f32 v60, v60
    v_mfma_f32_16x16x32_bf16 v[108:111], a[176:179], a[232:235], v[108:111]
    v_add_f32 v22, v22, v73
    s_waitcnt lgkmcnt(3)
    v_mfma_f32_16x16x32_bf16 v[96:99], a[108:111], a[236:239], v[96:99]
    buffer_store_dwordx2 v[244:245], v11, s[16:19], s56 offen offset:768 sc1
    v_mfma_f32_16x16x32_bf16 v[100:103], a[132:135], a[236:239], v[100:103]
    ds_read_b128 a[196:199], v3 offset:1024
    v_fma_f32 v77, v77, s40, -v14
    v_mfma_f32_16x16x32_bf16 v[104:107], a[156:159], a[236:239], v[104:107]
    v_exp_f32 v76, v76
    v_mfma_f32_16x16x32_bf16 v[108:111], a[180:183], a[236:239], v[108:111]
    ds_read_b128 a[200:203], v3 offset:2048
    v_add_f32 v23, v23, v89
    v_mfma_f32_16x16x32_bf16 v[96:99], a[112:115], a[240:243], v[96:99]
    v_exp_f32 v92, v92
    v_mfma_f32_16x16x32_bf16 v[100:103], a[136:139], a[240:243], v[100:103]
    v_fma_f32 v93, v93, s40, -v15
    v_add_f32 v20, v20, v42
    v_mfma_f32_16x16x32_bf16 v[104:107], a[160:163], a[240:243], v[104:107]
    v_exp_f32 v45, v45
    v_mfma_f32_16x16x32_bf16 v[108:111], a[184:187], a[240:243], v[108:111]
    ds_read_b128 a[204:207], v3 offset:3072
    v_fma_f32 v46, v46, s40, -v12
    v_mfma_f32_16x16x32_bf16 v[96:99], a[116:119], a[244:247], v[96:99]
    v_add_f32 v21, v21, v58
    v_fma_f32 v62, v62, s40, -v13
    v_mfma_f32_16x16x32_bf16 v[100:103], a[140:143], a[244:247], v[100:103]
    v_exp_f32 v61, v61
    v_mfma_f32_16x16x32_bf16 v[104:107], a[164:167], a[244:247], v[104:107]
    v_add_f32 v22, v22, v74
    v_fma_f32 v78, v78, s40, -v14
    v_mfma_f32_16x16x32_bf16 v[108:111], a[188:191], a[244:247], v[108:111]
    buffer_store_dwordx2 v[246:247], v11, s[16:19], s56 offen offset:1152 sc1
    s_waitcnt lgkmcnt(3)
    v_mfma_f32_16x16x32_bf16 v[112:115], a[96:99], a[248:251], 0
    ds_read_b128 a[208:211], v3 offset:4096
    v_cvt_pk_bf16_f32 v192, v96, v97
    v_mfma_f32_16x16x32_bf16 v[116:119], a[120:123], a[248:251], 0
    v_cvt_pk_bf16_f32 v193, v98, v99
    v_cvt_pk_bf16_f32 v194, v100, v101
    v_mfma_f32_16x16x32_bf16 v[120:123], a[144:147], a[248:251], 0
    v_cvt_pk_bf16_f32 v195, v102, v103
    v_cvt_pk_bf16_f32 v196, v104, v105
    v_mfma_f32_16x16x32_bf16 v[124:127], a[168:171], a[248:251], 0
    ds_read_b128 a[212:215], v3 offset:5120
    v_cvt_pk_bf16_f32 v197, v106, v107
    v_mfma_f32_16x16x32_bf16 v[112:115], a[100:103], a[252:255], v[112:115]
    v_cvt_pk_bf16_f32 v198, v108, v109
    v_cvt_pk_bf16_f32 v199, v110, v111
    v_mfma_f32_16x16x32_bf16 v[116:119], a[124:127], a[252:255], v[116:119]
    v_exp_f32 v77, v77
    v_mfma_f32_16x16x32_bf16 v[120:123], a[148:151], a[252:255], v[120:123]
    v_add_f32 v23, v23, v90
    v_fma_f32 v94, v94, s40, -v15
    v_mfma_f32_16x16x32_bf16 v[124:127], a[172:175], a[252:255], v[124:127]
    ds_read_b128 a[216:219], v3 offset:6144
    v_add_f32 v20, v20, v43
    v_mfma_f32_16x16x32_bf16 v[112:115], a[104:107], a[192:195], v[112:115]
    v_exp_f32 v93, v93
    v_mfma_f32_16x16x32_bf16 v[116:119], a[128:131], a[192:195], v[116:119]
    v_exp_f32 v46, v46
    v_mfma_f32_16x16x32_bf16 v[120:123], a[152:155], a[192:195], v[120:123]
    v_fma_f32 v47, v47, s40, -v12
    v_add_f32 v21, v21, v59
    v_mfma_f32_16x16x32_bf16 v[124:127], a[176:179], a[192:195], v[124:127]
    buffer_store_dwordx2 v[248:249], v11, s[16:19], s58 offen offset:0 sc1
    s_waitcnt lgkmcnt(3)
    v_mfma_f32_16x16x32_bf16 v[112:115], a[108:111], a[196:199], v[112:115]
    ds_read_b128 a[220:223], v3 offset:7168
    v_fma_f32 v63, v63, s40, -v13
    v_mfma_f32_16x16x32_bf16 v[116:119], a[132:135], a[196:199], v[116:119]
    v_exp_f32 v62, v62
    v_mfma_f32_16x16x32_bf16 v[120:123], a[156:159], a[196:199], v[120:123]
    v_add_f32 v22, v22, v75
    v_fma_f32 v79, v79, s40, -v14
    v_mfma_f32_16x16x32_bf16 v[124:127], a[180:183], a[196:199], v[124:127]
    ds_read_b128 a[224:227], v3 offset:8192
    v_add_f32 v23, v23, v91
    v_mfma_f32_16x16x32_bf16 v[112:115], a[112:115], a[200:203], v[112:115]
    v_exp_f32 v78, v78
    v_mfma_f32_16x16x32_bf16 v[116:119], a[136:139], a[200:203], v[116:119]
    v_exp_f32 v94, v94
    v_mfma_f32_16x16x32_bf16 v[120:123], a[160:163], a[200:203], v[120:123]
    v_fma_f32 v95, v95, s40, -v15
    v_add_f32 v20, v20, v44
    v_mfma_f32_16x16x32_bf16 v[124:127], a[184:187], a[200:203], v[124:127]
    ds_read_b128 a[228:231], v3 offset:9216
    v_add_f32 v21, v21, v60
    v_mfma_f32_16x16x32_bf16 v[112:115], a[116:119], a[204:207], v[112:115]
    v_exp_f32 v47, v47
    v_mfma_f32_16x16x32_bf16 v[116:119], a[140:143], a[204:207], v[116:119]
    v_exp_f32 v63, v63
    v_mfma_f32_16x16x32_bf16 v[120:123], a[164:167], a[204:207], v[120:123]
    v_add_f32 v22, v22, v76
    v_add_f32 v23, v23, v92
    v_mfma_f32_16x16x32_bf16 v[124:127], a[188:191], a[204:207], v[124:127]
    buffer_store_dwordx2 v[250:251], v11, s[16:19], s58 offen offset:384 sc1
    s_waitcnt lgkmcnt(3)
    v_mfma_f32_16x16x32_bf16 v[96:99], a[96:99], a[208:211], 0
    ds_read_b128 a[232:235], v3 offset:10240
    v_cvt_pk_bf16_f32 v200, v112, v113
    v_mfma_f32_16x16x32_bf16 v[100:103], a[120:123], a[208:211], 0
    v_cvt_pk_bf16_f32 v201, v114, v115
    v_cvt_pk_bf16_f32 v202, v116, v117
    v_mfma_f32_16x16x32_bf16 v[104:107], a[144:147], a[208:211], 0
    v_cvt_pk_bf16_f32 v203, v118, v119
    v_cvt_pk_bf16_f32 v204, v120, v121
    v_mfma_f32_16x16x32_bf16 v[108:111], a[168:171], a[208:211], 0
    ds_read_b128 a[236:239], v3 offset:11264
    v_cvt_pk_bf16_f32 v205, v122, v123
    v_mfma_f32_16x16x32_bf16 v[96:99], a[100:103], a[212:215], v[96:99]
    v_cvt_pk_bf16_f32 v206, v124, v125
    v_cvt_pk_bf16_f32 v207, v126, v127
    v_mfma_f32_16x16x32_bf16 v[100:103], a[124:127], a[212:215], v[100:103]
    v_exp_f32 v79, v79
    v_mfma_f32_16x16x32_bf16 v[104:107], a[148:151], a[212:215], v[104:107]
    v_exp_f32 v95, v95
    v_mfma_f32_16x16x32_bf16 v[108:111], a[172:175], a[212:215], v[108:111]
    ds_read_b128 a[240:243], v3 offset:12288
    v_add_f32 v20, v20, v45
    v_mfma_f32_16x16x32_bf16 v[96:99], a[104:107], a[216:219], v[96:99]
    v_add_f32 v21, v21, v61
    v_add_f32 v22, v22, v77
    v_mfma_f32_16x16x32_bf16 v[100:103], a[128:131], a[216:219], v[100:103]
    v_add_f32 v23, v23, v93
    v_add_f32 v20, v20, v46
    v_mfma_f32_16x16x32_bf16 v[104:107], a[152:155], a[216:219], v[104:107]
    v_add_f32 v21, v21, v62
    v_add_f32 v22, v22, v78
    v_mfma_f32_16x16x32_bf16 v[108:111], a[176:179], a[216:219], v[108:111]
    buffer_store_dwordx2 v[252:253], v11, s[16:19], s58 offen offset:768 sc1
    s_waitcnt lgkmcnt(3)
    v_mfma_f32_16x16x32_bf16 v[96:99], a[108:111], a[220:223], v[96:99]
    ds_read_b128 a[244:247], v3 offset:13312
    v_add_f32 v23, v23, v94
    v_mfma_f32_16x16x32_bf16 v[100:103], a[132:135], a[220:223], v[100:103]
    v_add_f32 v20, v20, v47
    v_add_f32 v21, v21, v63
    v_mfma_f32_16x16x32_bf16 v[104:107], a[156:159], a[220:223], v[104:107]
    ds_read_b128 a[248:251], v3 offset:14336
    v_add_f32 v22, v22, v79
    v_mfma_f32_16x16x32_bf16 v[108:111], a[180:183], a[220:223], v[108:111]
    v_add_f32 v23, v23, v95
    v_permlane16_swap_b32 v20, v21
    v_mfma_f32_16x16x32_bf16 v[96:99], a[112:115], a[224:227], v[96:99]
    v_permlane16_swap_b32 v22, v23
    v_add_f32 v20, v20, v21
    v_mfma_f32_16x16x32_bf16 v[100:103], a[136:139], a[224:227], v[100:103]
    v_add_f32 v22, v22, v23
    s_add_u32 s26, s26, 25165824
    v_mfma_f32_16x16x32_bf16 v[104:107], a[160:163], a[224:227], v[104:107]
    ds_read_b128 a[252:255], v3 offset:15360
    v_permlane32_swap_b32 v20, v22
    v_mfma_f32_16x16x32_bf16 v[108:111], a[184:187], a[224:227], v[108:111]
    v_add_f32 v20, v20, v22
    s_add_u32 s28, s28, 25165824
    v_mfma_f32_16x16x32_bf16 v[96:99], a[116:119], a[228:231], v[96:99]
    v_rcp_f32 v20, v20
    v_mfma_f32_16x16x32_bf16 v[100:103], a[140:143], a[228:231], v[100:103]
    v_mov_b32 v22, v20
    s_add_u32 s30, s30, 25165824
    v_mfma_f32_16x16x32_bf16 v[104:107], a[164:167], a[228:231], v[104:107]
    buffer_store_dwordx2 v[254:255], v11, s[16:19], s58 offen offset:1152 sc1
    v_mfma_f32_16x16x32_bf16 v[108:111], a[188:191], a[228:231], v[108:111]
    v_permlane32_swap_b32 v20, v22
    s_waitcnt lgkmcnt(3)
    v_mfma_f32_16x16x32_bf16 v[112:115], a[96:99], a[232:235], 0
    v_mov_b32 v21, v20
    v_mov_b32 v23, v22
    v_mfma_f32_16x16x32_bf16 v[116:119], a[120:123], a[232:235], 0
    v_permlane16_swap_b32 v20, v21
    v_mul_f32 v32, v32, v20
    v_mfma_f32_16x16x32_bf16 v[120:123], a[144:147], a[232:235], 0
    v_mul_f32 v33, v33, v20
    v_cvt_pk_bf16_f32 v32, v32, v33
    v_mfma_f32_16x16x32_bf16 v[124:127], a[168:171], a[232:235], 0
    v_mul_f32 v34, v34, v20
    v_mul_f32 v35, v35, v20
    v_mfma_f32_16x16x32_bf16 v[112:115], a[100:103], a[236:239], v[112:115]
    v_cvt_pk_bf16_f32 v33, v34, v35
    v_mul_f32 v36, v36, v20
    v_mfma_f32_16x16x32_bf16 v[116:119], a[124:127], a[236:239], v[116:119]
    v_mul_f32 v37, v37, v20
    v_cvt_pk_bf16_f32 v34, v36, v37
    v_mfma_f32_16x16x32_bf16 v[120:123], a[148:151], a[236:239], v[120:123]
    v_mul_f32 v38, v38, v20
    v_mul_f32 v39, v39, v20
    v_mfma_f32_16x16x32_bf16 v[124:127], a[172:175], a[236:239], v[124:127]
    v_mul_f32 v40, v40, v20
    v_mul_f32 v41, v41, v20
    v_mfma_f32_16x16x32_bf16 v[112:115], a[104:107], a[240:243], v[112:115]
    v_permlane16_swap_b32 v22, v23
    v_cvt_pk_bf16_f32 v35, v38, v39
    v_mfma_f32_16x16x32_bf16 v[116:119], a[128:131], a[240:243], v[116:119]
    v_cvt_pk_bf16_f32 v36, v40, v41
    v_mul_f32 v48, v48, v21
    v_mfma_f32_16x16x32_bf16 v[120:123], a[152:155], a[240:243], v[120:123]
    v_mul_f32 v49, v49, v21
    v_cvt_pk_bf16_f32 v40, v48, v49
    v_mfma_f32_16x16x32_bf16 v[124:127], a[176:179], a[240:243], v[124:127]
    v_mul_f32 v64, v64, v22
    s_waitcnt lgkmcnt(0)
    v_mfma_f32_16x16x32_bf16 v[112:115], a[108:111], a[244:247], v[112:115]
    v_mul_f32 v65, v65, v22
    v_mul_f32 v66, v66, v22
    v_mfma_f32_16x16x32_bf16 v[116:119], a[132:135], a[244:247], v[116:119]
    v_mul_f32 v67, v67, v22
    v_cvt_pk_bf16_f32 v48, v64, v65
    v_mfma_f32_16x16x32_bf16 v[120:123], a[156:159], a[244:247], v[120:123]
    v_cvt_pk_bf16_f32 v49, v66, v67
    v_mul_f32 v50, v50, v21
    v_mfma_f32_16x16x32_bf16 v[124:127], a[180:183], a[244:247], v[124:127]
    v_mul_f32 v51, v51, v21
    v_cvt_pk_bf16_f32 v41, v50, v51
    v_mfma_f32_16x16x32_bf16 v[112:115], a[112:115], a[248:251], v[112:115]
    v_mul_f32 v68, v68, v22
    v_mul_f32 v69, v69, v22
    v_mfma_f32_16x16x32_bf16 v[116:119], a[136:139], a[248:251], v[116:119]
    v_mul_f32 v70, v70, v22
    v_mul_f32 v71, v71, v22
    v_mfma_f32_16x16x32_bf16 v[120:123], a[160:163], a[248:251], v[120:123]
    v_cvt_pk_bf16_f32 v50, v68, v69
    v_cvt_pk_bf16_f32 v51, v70, v71
    v_mfma_f32_16x16x32_bf16 v[124:127], a[184:187], a[248:251], v[124:127]
    v_mul_f32 v42, v42, v20
    v_mul_f32 v43, v43, v20
    v_mfma_f32_16x16x32_bf16 v[112:115], a[116:119], a[252:255], v[112:115]
    v_cvt_pk_bf16_f32 v37, v42, v43
    v_mul_f32 v52, v52, v21
    v_mfma_f32_16x16x32_bf16 v[116:119], a[140:143], a[252:255], v[116:119]
    v_mul_f32 v53, v53, v21
    v_cvt_pk_bf16_f32 v42, v52, v53
    v_mfma_f32_16x16x32_bf16 v[120:123], a[164:167], a[252:255], v[120:123]
    buffer_load_dwordx4 a[96:99], v9, s[8:11], s24 offen offset:0 nt
    v_mul_f32 v72, v72, v22
    v_mfma_f32_16x16x32_bf16 v[124:127], a[188:191], a[252:255], v[124:127]
    buffer_load_dwordx4 a[100:103], v9, s[8:11], s24 offen offset:64 nt
    v_mul_f32 v73, v73, v22
    s_cmp_eq_u32 s48, 1
    s_cbranch_scc1 L_tail
    s_add_u32 s48, s48, 1
    v_mfma_f32_16x16x32_bf16 v[64:67], v[32:35], v[128:131], 0
    v_mul_f32 v74, v74, v22
    v_mul_f32 v75, v75, v22
    v_mfma_f32_16x16x32_bf16 v[68:71], v[32:35], v[136:139], 0
    v_cvt_pk_bf16_f32 v52, v72, v73
    v_cvt_pk_bf16_f32 v53, v74, v75
    v_mfma_f32_16x16x32_bf16 v[72:75], v[32:35], v[144:147], 0
    v_mul_f32 v54, v54, v21
    v_mul_f32 v55, v55, v21
    v_cvt_pk_bf16_f32 v43, v54, v55
    v_mul_f32 v76, v76, v22
    v_mul_f32 v77, v77, v22
    v_cvt_pk_bf16_f32 v54, v76, v77
    v_mul_f32 v78, v78, v22
    v_mul_f32 v79, v79, v22
    v_cvt_pk_bf16_f32 v55, v78, v79
    v_mfma_f32_16x16x32_bf16 v[76:79], v[32:35], v[152:155], 0
    v_mul_f32 v44, v44, v20
    v_mul_f32 v45, v45, v20
    v_cvt_pk_bf16_f32 v38, v44, v45
    v_mul_f32 v46, v46, v20
    v_mul_f32 v47, v47, v20
    v_cvt_pk_bf16_f32 v39, v46, v47
    s_nop 1
    v_mfma_f32_16x16x32_bf16 v[64:67], v[36:39], v[132:135], v[64:67]
    v_mul_f32 v56, v56, v21
    v_mul_f32 v57, v57, v21
    v_mfma_f32_16x16x32_bf16 v[68:71], v[36:39], v[140:143], v[68:71]
    v_cvt_pk_bf16_f32 v44, v56, v57
    v_mul_f32 v80, v80, v23
    v_mfma_f32_16x16x32_bf16 v[72:75], v[36:39], v[148:151], v[72:75]
    v_mul_f32 v81, v81, v23
    v_mul_f32 v82, v82, v23
    v_mfma_f32_16x16x32_bf16 v[76:79], v[36:39], v[156:159], v[76:79]
    v_mul_f32 v83, v83, v23
    v_cvt_pk_bf16_f32 v56, v80, v81
    v_cvt_pk_bf16_f32 v57, v82, v83
    v_mfma_f32_16x16x32_bf16 v[80:83], v[40:43], v[128:131], 0
    v_mul_f32 v58, v58, v21
    v_mul_f32 v59, v59, v21
    v_cvt_pk_bf16_f32 v45, v58, v59
    v_mul_f32 v84, v84, v23
    v_mul_f32 v85, v85, v23
    v_cvt_pk_bf16_f32 v58, v84, v85
    v_mul_f32 v86, v86, v23
    v_mul_f32 v87, v87, v23
    v_cvt_pk_bf16_f32 v59, v86, v87
    v_mfma_f32_16x16x32_bf16 v[84:87], v[40:43], v[136:139], 0
    v_mul_f32 v60, v60, v21
    v_mul_f32 v61, v61, v21
    v_cvt_pk_bf16_f32 v46, v60, v61
    v_mul_f32 v88, v88, v23
    v_mul_f32 v89, v89, v23
    v_cvt_pk_bf16_f32 v60, v88, v89
    v_mul_f32 v90, v90, v23
    v_mul_f32 v91, v91, v23
    v_cvt_pk_bf16_f32 v61, v90, v91
    v_mfma_f32_16x16x32_bf16 v[88:91], v[40:43], v[144:147], 0
    v_mul_f32 v62, v62, v21
    v_mul_f32 v63, v63, v21
    v_cvt_pk_bf16_f32 v47, v62, v63
    v_mul_f32 v92, v92, v23
    v_mul_f32 v93, v93, v23
    v_cvt_pk_bf16_f32 v62, v92, v93
    v_mul_f32 v94, v94, v23
    v_mul_f32 v95, v95, v23
    v_cvt_pk_bf16_f32 v63, v94, v95
    v_mfma_f32_16x16x32_bf16 v[92:95], v[40:43], v[152:155], 0
    v_cvt_pk_bf16_f32 v208, v96, v97
    v_cvt_pk_bf16_f32 v209, v98, v99
    v_mfma_f32_16x16x32_bf16 v[80:83], v[44:47], v[132:135], v[80:83]
    v_cvt_pk_bf16_f32 v210, v100, v101
    v_cvt_pk_bf16_f32 v211, v102, v103
    v_mfma_f32_16x16x32_bf16 v[84:87], v[44:47], v[140:143], v[84:87]
    v_cvt_pk_bf16_f32 v212, v104, v105
    v_cvt_pk_bf16_f32 v213, v106, v107
    v_mfma_f32_16x16x32_bf16 v[88:91], v[44:47], v[148:151], v[88:91]
    v_cvt_pk_bf16_f32 v214, v108, v109
    v_cvt_pk_bf16_f32 v215, v110, v111
    v_mfma_f32_16x16x32_bf16 v[92:95], v[44:47], v[156:159], v[92:95]
    v_cvt_pk_bf16_f32 v216, v112, v113
    v_cvt_pk_bf16_f32 v217, v114, v115
    v_mfma_f32_16x16x32_bf16 v[96:99], v[48:51], v[128:131], 0
    v_cvt_pk_bf16_f32 v218, v116, v117
    v_cvt_pk_bf16_f32 v219, v118, v119
    v_mfma_f32_16x16x32_bf16 v[100:103], v[48:51], v[136:139], 0
    v_cvt_pk_bf16_f32 v220, v120, v121
    v_cvt_pk_bf16_f32 v221, v122, v123
    v_mfma_f32_16x16x32_bf16 v[104:107], v[48:51], v[144:147], 0
    v_cvt_pk_bf16_f32 v222, v124, v125
    v_cvt_pk_bf16_f32 v223, v126, v127
    v_mfma_f32_16x16x32_bf16 v[108:111], v[48:51], v[152:155], 0
    v_cvt_pk_bf16_f32 v224, v64, v68
    v_cvt_pk_bf16_f32 v226, v65, v69
    v_mfma_f32_16x16x32_bf16 v[96:99], v[52:55], v[132:135], v[96:99]
    v_cvt_pk_bf16_f32 v228, v66, v70
    v_cvt_pk_bf16_f32 v230, v67, v71
    v_mfma_f32_16x16x32_bf16 v[100:103], v[52:55], v[140:143], v[100:103]
    v_cvt_pk_bf16_f32 v225, v72, v76
    v_cvt_pk_bf16_f32 v227, v73, v77
    v_mfma_f32_16x16x32_bf16 v[104:107], v[52:55], v[148:151], v[104:107]
    v_cvt_pk_bf16_f32 v229, v74, v78
    v_cvt_pk_bf16_f32 v231, v75, v79
    v_mfma_f32_16x16x32_bf16 v[108:111], v[52:55], v[156:159], v[108:111]
    v_cvt_pk_bf16_f32 v232, v80, v84
    v_cvt_pk_bf16_f32 v234, v81, v85
    v_mfma_f32_16x16x32_bf16 v[112:115], v[56:59], v[128:131], 0
    v_cvt_pk_bf16_f32 v236, v82, v86
    v_cvt_pk_bf16_f32 v238, v83, v87
    v_mfma_f32_16x16x32_bf16 v[116:119], v[56:59], v[136:139], 0
    v_cvt_pk_bf16_f32 v233, v88, v92
    v_cvt_pk_bf16_f32 v235, v89, v93
    v_mfma_f32_16x16x32_bf16 v[120:123], v[56:59], v[144:147], 0
    v_cvt_pk_bf16_f32 v237, v90, v94
    v_cvt_pk_bf16_f32 v239, v91, v95
    v_mfma_f32_16x16x32_bf16 v[124:127], v[56:59], v[152:155], 0
    v_cvt_pk_bf16_f32 v240, v96, v100
    v_cvt_pk_bf16_f32 v242, v97, v101
    v_mfma_f32_16x16x32_bf16 v[112:115], v[60:63], v[132:135], v[112:115]
    v_cvt_pk_bf16_f32 v244, v98, v102
    v_cvt_pk_bf16_f32 v246, v99, v103
    v_mfma_f32_16x16x32_bf16 v[116:119], v[60:63], v[140:143], v[116:119]
    v_cvt_pk_bf16_f32 v241, v104, v108
    v_cvt_pk_bf16_f32 v243, v105, v109
    v_mfma_f32_16x16x32_bf16 v[120:123], v[60:63], v[148:151], v[120:123]
    v_cvt_pk_bf16_f32 v245, v106, v110
    v_cvt_pk_bf16_f32 v247, v107, v111
    v_mfma_f32_16x16x32_bf16 v[124:127], v[60:63], v[156:159], v[124:127]
    s_mov_b32 s52, s32
    s_mov_b32 s54, s34
    v_mfma_f32_16x16x32_bf16 v[64:67], v[32:35], v[160:163], 0
    v_cvt_pk_bf16_f32 v248, v112, v116
    v_cvt_pk_bf16_f32 v250, v113, v117
    v_mfma_f32_16x16x32_bf16 v[68:71], v[32:35], v[168:171], 0
    v_cvt_pk_bf16_f32 v252, v114, v118
    v_cvt_pk_bf16_f32 v254, v115, v119
    v_mfma_f32_16x16x32_bf16 v[72:75], v[32:35], v[176:179], 0
    v_cvt_pk_bf16_f32 v249, v120, v124
    v_cvt_pk_bf16_f32 v251, v121, v125
    v_mfma_f32_16x16x32_bf16 v[76:79], v[32:35], v[184:187], 0
    v_cvt_pk_bf16_f32 v253, v122, v126
    v_cvt_pk_bf16_f32 v255, v123, v127
    v_mfma_f32_16x16x32_bf16 v[64:67], v[36:39], v[164:167], v[64:67]
    s_mov_b32 s56, s36
    s_mov_b32 s58, s38
    v_mfma_f32_16x16x32_bf16 v[68:71], v[36:39], v[172:175], v[68:71]
    s_mov_b32 s18, 100663296
    v_mfma_f32_16x16x32_bf16 v[72:75], v[36:39], v[180:183], v[72:75]
    v_mfma_f32_16x16x32_bf16 v[76:79], v[36:39], v[188:191], v[76:79]
    v_mfma_f32_16x16x32_bf16 v[80:83], v[40:43], v[160:163], 0
    v_cvt_pk_bf16_f32 v128, v64, v68
    v_cvt_pk_bf16_f32 v130, v65, v69
    v_mfma_f32_16x16x32_bf16 v[84:87], v[40:43], v[168:171], 0
    v_cvt_pk_bf16_f32 v132, v66, v70
    v_cvt_pk_bf16_f32 v134, v67, v71
    v_mfma_f32_16x16x32_bf16 v[88:91], v[40:43], v[176:179], 0
    v_cvt_pk_bf16_f32 v129, v72, v76
    v_cvt_pk_bf16_f32 v131, v73, v77
    v_mfma_f32_16x16x32_bf16 v[92:95], v[40:43], v[184:187], 0
    v_cvt_pk_bf16_f32 v133, v74, v78
    v_cvt_pk_bf16_f32 v135, v75, v79
    v_mfma_f32_16x16x32_bf16 v[80:83], v[44:47], v[164:167], v[80:83]
    v_mfma_f32_16x16x32_bf16 v[84:87], v[44:47], v[172:175], v[84:87]
    v_mfma_f32_16x16x32_bf16 v[88:91], v[44:47], v[180:183], v[88:91]
    v_mfma_f32_16x16x32_bf16 v[92:95], v[44:47], v[188:191], v[92:95]
    buffer_load_dwordx4 a[120:123], v9, s[8:11], s26 offen offset:0 nt
    v_mfma_f32_16x16x32_bf16 v[96:99], v[48:51], v[160:163], 0
    buffer_load_dwordx4 a[124:127], v9, s[8:11], s26 offen offset:64 nt
    v_cvt_pk_bf16_f32 v136, v80, v84
    v_mfma_f32_16x16x32_bf16 v[100:103], v[48:51], v[168:171], 0
    v_cvt_pk_bf16_f32 v138, v81, v85
    v_cvt_pk_bf16_f32 v140, v82, v86
    v_mfma_f32_16x16x32_bf16 v[104:107], v[48:51], v[176:179], 0
    v_cvt_pk_bf16_f32 v142, v83, v87
    v_cvt_pk_bf16_f32 v137, v88, v92
    v_mfma_f32_16x16x32_bf16 v[108:111], v[48:51], v[184:187], 0
    v_cvt_pk_bf16_f32 v139, v89, v93
    v_cvt_pk_bf16_f32 v141, v90, v94
    v_mfma_f32_16x16x32_bf16 v[96:99], v[52:55], v[164:167], v[96:99]
    v_cvt_pk_bf16_f32 v143, v91, v95
    v_mfma_f32_16x16x32_bf16 v[100:103], v[52:55], v[172:175], v[100:103]
    v_mfma_f32_16x16x32_bf16 v[104:107], v[52:55], v[180:183], v[104:107]
    v_mfma_f32_16x16x32_bf16 v[108:111], v[52:55], v[188:191], v[108:111]
    v_mfma_f32_16x16x32_bf16 v[112:115], v[56:59], v[160:163], 0
    v_cvt_pk_bf16_f32 v144, v96, v100
    v_cvt_pk_bf16_f32 v146, v97, v101
    v_mfma_f32_16x16x32_bf16 v[116:119], v[56:59], v[168:171], 0
    v_cvt_pk_bf16_f32 v148, v98, v102
    v_cvt_pk_bf16_f32 v150, v99, v103
    v_mfma_f32_16x16x32_bf16 v[120:123], v[56:59], v[176:179], 0
    v_cvt_pk_bf16_f32 v145, v104, v108
    v_cvt_pk_bf16_f32 v147, v105, v109
    v_mfma_f32_16x16x32_bf16 v[124:127], v[56:59], v[184:187], 0
    v_cvt_pk_bf16_f32 v149, v106, v110
    v_cvt_pk_bf16_f32 v151, v107, v111
    v_mfma_f32_16x16x32_bf16 v[112:115], v[60:63], v[164:167], v[112:115]
    v_mfma_f32_16x16x32_bf16 v[116:119], v[60:63], v[172:175], v[116:119]
    ds_read_b128 a[192:195], v1 offset:0
    v_mfma_f32_16x16x32_bf16 v[120:123], v[60:63], v[180:183], v[120:123]
    v_mfma_f32_16x16x32_bf16 v[124:127], v[60:63], v[188:191], v[124:127]
    buffer_store_dwordx2 v[128:129], v11, s[12:15], s32 offen offset:128 sc1
    v_mfma_f32_16x16x32_bf16 v[64:67], v[32:35], v[192:195], 0
    v_cvt_pk_bf16_f32 v152, v112, v116
    v_cvt_pk_bf16_f32 v154, v113, v117
    v_mfma_f32_16x16x32_bf16 v[68:71], v[32:35], v[200:203], 0
    ds_read_b128 a[196:199], v1 offset:1024
    v_cvt_pk_bf16_f32 v156, v114, v118
    v_mfma_f32_16x16x32_bf16 v[72:75], v[32:35], v[208:211], 0
    v_cvt_pk_bf16_f32 v158, v115, v119
    v_cvt_pk_bf16_f32 v153, v120, v124
    v_mfma_f32_16x16x32_bf16 v[76:79], v[32:35], v[216:219], 0
    v_cvt_pk_bf16_f32 v155, v121, v125
    v_cvt_pk_bf16_f32 v157, v122, v126
    v_mfma_f32_16x16x32_bf16 v[64:67], v[36:39], v[196:199], v[64:67]
    v_cvt_pk_bf16_f32 v159, v123, v127
    v_mfma_f32_16x16x32_bf16 v[68:71], v[36:39], v[204:207], v[68:71]
    ds_read_b128 a[200:203], v1 offset:2048
    v_mfma_f32_16x16x32_bf16 v[72:75], v[36:39], v[212:215], v[72:75]
    v_mfma_f32_16x16x32_bf16 v[76:79], v[36:39], v[220:223], v[76:79]
    v_mfma_f32_16x16x32_bf16 v[80:83], v[40:43], v[192:195], 0
    v_cvt_pk_bf16_f32 v160, v64, v68
    v_cvt_pk_bf16_f32 v162, v65, v69
    v_mfma_f32_16x16x32_bf16 v[84:87], v[40:43], v[200:203], 0
    ds_read_b128 a[204:207], v1 offset:3072
    v_cvt_pk_bf16_f32 v164, v66, v70
    v_mfma_f32_16x16x32_bf16 v[88:91], v[40:43], v[208:211], 0
    v_cvt_pk_bf16_f32 v166, v67, v71
    v_cvt_pk_bf16_f32 v161, v72, v76
    v_mfma_f32_16x16x32_bf16 v[92:95], v[40:43], v[216:219], 0
    v_cvt_pk_bf16_f32 v163, v73, v77
    v_cvt_pk_bf16_f32 v165, v74, v78
    v_mfma_f32_16x16x32_bf16 v[80:83], v[44:47], v[196:199], v[80:83]
    v_cvt_pk_bf16_f32 v167, v75, v79
    v_mfma_f32_16x16x32_bf16 v[84:87], v[44:47], v[204:207], v[84:87]
    ds_read_b128 a[208:211], v1 offset:4096
    v_mfma_f32_16x16x32_bf16 v[88:91], v[44:47], v[212:215], v[88:91]
    v_mfma_f32_16x16x32_bf16 v[92:95], v[44:47], v[220:223], v[92:95]
    buffer_store_dwordx2 v[130:131], v11, s[12:15], s32 offen offset:512 sc1
    v_mfma_f32_16x16x32_bf16 v[96:99], v[48:51], v[192:195], 0
    v_cvt_pk_bf16_f32 v168, v80, v84
    v_cvt_pk_bf16_f32 v170, v81, v85
    v_mfma_f32_16x16x32_bf16 v[100:103], v[48:51], v[200:203], 0
    ds_read_b128 a[212:215], v1 offset:5120
    v_cvt_pk_bf16_f32 v172, v82, v86
    v_mfma_f32_16x16x32_bf16 v[104:107], v[48:51], v[208:211], 0
    v_cvt_pk_bf16_f32 v174, v83, v87
    v_cvt_pk_bf16_f32 v169, v88, v92
    v_mfma_f32_16x16x32_bf16 v[108:111], v[48:51], v[216:219], 0
    v_cvt_pk_bf16_f32 v171, v89, v93
    v_cvt_pk_bf16_f32 v173, v90, v94
    v_mfma_f32_16x16x32_bf16 v[96:99], v[52:55], v[196:199], v[96:99]
    v_cvt_pk_bf16_f32 v175, v91, v95
    v_mfma_f32_16x16x32_bf16 v[100:103], v[52:55], v[204:207], v[100:103]
    ds_read_b128 a[216:219], v1 offset:6144
    v_mfma_f32_16x16x32_bf16 v[104:107], v[52:55], v[212:215], v[104:107]
    v_mfma_f32_16x16x32_bf16 v[108:111], v[52:55], v[220:223], v[108:111]
    v_mfma_f32_16x16x32_bf16 v[112:115], v[56:59], v[192:195], 0
    v_cvt_pk_bf16_f32 v176, v96, v100
    v_cvt_pk_bf16_f32 v178, v97, v101
    v_mfma_f32_16x16x32_bf16 v[116:119], v[56:59], v[200:203], 0
    ds_read_b128 a[220:223], v1 offset:7168
    v_cvt_pk_bf16_f32 v180, v98, v102
    v_mfma_f32_16x16x32_bf16 v[120:123], v[56:59], v[208:211], 0
    v_cvt_pk_bf16_f32 v182, v99, v103
    v_cvt_pk_bf16_f32 v177, v104, v108
    v_mfma_f32_16x16x32_bf16 v[124:127], v[56:59], v[216:219], 0
    v_cvt_pk_bf16_f32 v179, v105, v109
    v_cvt_pk_bf16_f32 v181, v106, v110
    v_mfma_f32_16x16x32_bf16 v[112:115], v[60:63], v[196:199], v[112:115]
    v_cvt_pk_bf16_f32 v183, v107, v111
    v_mfma_f32_16x16x32_bf16 v[116:119], v[60:63], v[204:207], v[116:119]
    ds_read_b128 a[224:227], v1 offset:8192
    v_mfma_f32_16x16x32_bf16 v[120:123], v[60:63], v[212:215], v[120:123]
    v_mfma_f32_16x16x32_bf16 v[124:127], v[60:63], v[220:223], v[124:127]
    buffer_store_dwordx2 v[132:133], v11, s[12:15], s32 offen offset:896 sc1
    s_waitcnt vmcnt(63) lgkmcnt(3)
    v_mfma_f32_16x16x32_bf16 v[96:99], a[192:195], a[0:3], 0
    v_cvt_pk_bf16_f32 v184, v112, v116
    v_cvt_pk_bf16_f32 v186, v113, v117
    v_mfma_f32_16x16x32_bf16 v[100:103], a[192:195], a[24:27], 0
    ds_read_b128 a[228:231], v1 offset:9216
    v_cvt_pk_bf16_f32 v188, v114, v118
    v_mfma_f32_16x16x32_bf16 v[104:107], a[192:195], a[48:51], 0
    v_cvt_pk_bf16_f32 v190, v115, v119
    v_cvt_pk_bf16_f32 v185, v120, v124
    v_mfma_f32_16x16x32_bf16 v[108:111], a[192:195], a[72:75], 0
    v_cvt_pk_bf16_f32 v187, v121, v125
    v_cvt_pk_bf16_f32 v189, v122, v126
    v_mfma_f32_16x16x32_bf16 v[96:99], a[196:199], a[4:7], v[96:99]
    v_cvt_pk_bf16_f32 v191, v123, v127
    v_mfma_f32_16x16x32_bf16 v[100:103], a[196:199], a[28:31], v[100:103]
    ds_read_b128 a[232:235], v1 offset:10240
    v_mfma_f32_16x16x32_bf16 v[104:107], a[196:199], a[52:55], v[104:107]
    v_mfma_f32_16x16x32_bf16 v[108:111], a[196:199], a[76:79], v[108:111]
    s_waitcnt vmcnt(59)
    v_mfma_f32_16x16x32_bf16 v[96:99], a[200:203], a[8:11], v[96:99]
    s_waitcnt vmcnt(53)
    v_mfma_f32_16x16x32_bf16 v[100:103], a[200:203], a[32:35], v[100:103]
    buffer_load_dwordx4 a[144:147], v9, s[8:11], s28 offen offset:0 nt
    s_waitcnt vmcnt(48)
    v_mfma_f32_16x16x32_bf16 v[104:107], a[200:203], a[56:59], v[104:107]
    buffer_load_dwordx4 a[148:151], v9, s[8:11], s28 offen offset:64 nt
    s_waitcnt vmcnt(43)
    v_mfma_f32_16x16x32_bf16 v[108:111], a[200:203], a[80:83], v[108:111]
    ds_read_b128 a[236:239], v1 offset:11264
    v_mfma_f32_16x16x32_bf16 v[96:99], a[204:207], a[12:15], v[96:99]
    v_mfma_f32_16x16x32_bf16 v[100:103], a[204:207], a[36:39], v[100:103]
    ds_read_b128 a[240:243], v1 offset:12288
    v_mfma_f32_16x16x32_bf16 v[104:107], a[204:207], a[60:63], v[104:107]
    v_mfma_f32_16x16x32_bf16 v[108:111], a[204:207], a[84:87], v[108:111]
    buffer_store_dwordx2 v[134:135], v11, s[12:15], s32 offen offset:1280 sc1
    s_waitcnt vmcnt(38)
    v_mfma_f32_16x16x32_bf16 v[96:99], a[208:211], a[16:19], v[96:99]
    ds_read_b128 a[244:247], v1 offset:13312
    s_waitcnt vmcnt(32)
    v_mfma_f32_16x16x32_bf16 v[100:103], a[208:211], a[40:43], v[100:103]
    s_waitcnt vmcnt(26)
    v_mfma_f32_16x16x32_bf16 v[104:107], a[208:211], a[64:67], v[104:107]
    s_waitcnt vmcnt(19)
    v_mfma_f32_16x16x32_bf16 v[108:111], a[208:211], a[88:91], v[108:111]
    v_mfma_f32_16x16x32_bf16 v[96:99], a[212:215], a[20:23], v[96:99]
    ds_read_b128 a[248:251], v1 offset:14336
    v_mfma_f32_16x16x32_bf16 v[100:103], a[212:215], a[44:47], v[100:103]
    v_mfma_f32_16x16x32_bf16 v[104:107], a[212:215], a[68:71], v[104:107]
    v_mfma_f32_16x16x32_bf16 v[108:111], a[212:215], a[92:95], v[108:111]
    v_cvt_pk_bf16_f32 v208, v96, v97
    s_waitcnt lgkmcnt(4)
    v_mfma_f32_16x16x32_bf16 v[112:115], a[216:219], a[0:3], 0
    v_cvt_pk_bf16_f32 v209, v98, v99
    v_cvt_pk_bf16_f32 v212, v100, v101
    v_mfma_f32_16x16x32_bf16 v[116:119], a[216:219], a[24:27], 0
    v_cvt_pk_bf16_f32 v213, v102, v103
    v_cvt_pk_bf16_f32 v216, v104, v105
    v_mfma_f32_16x16x32_bf16 v[120:123], a[216:219], a[48:51], 0
    v_cvt_pk_bf16_f32 v217, v106, v107
    v_cvt_pk_bf16_f32 v220, v108, v109
    v_mfma_f32_16x16x32_bf16 v[124:127], a[216:219], a[72:75], 0
    v_cvt_pk_bf16_f32 v221, v110, v111
    v_mfma_f32_16x16x32_bf16 v[112:115], a[220:223], a[4:7], v[112:115]
    v_mfma_f32_16x16x32_bf16 v[116:119], a[220:223], a[28:31], v[116:119]
    v_mfma_f32_16x16x32_bf16 v[120:123], a[220:223], a[52:55], v[120:123]
    buffer_store_dwordx2 v[136:137], v11, s[12:15], s34 offen offset:128 sc1
    v_mfma_f32_16x16x32_bf16 v[124:127], a[220:223], a[76:79], v[124:127]
    v_mfma_f32_16x16x32_bf16 v[112:115], a[224:227], a[8:11], v[112:115]
    v_mfma_f32_16x16x32_bf16 v[116:119], a[224:227], a[32:35], v[116:119]
    v_mfma_f32_16x16x32_bf16 v[120:123], a[224:227], a[56:59], v[120:123]
    v_mfma_f32_16x16x32_bf16 v[124:127], a[224:227], a[80:83], v[124:127]
    v_mfma_f32_16x16x32_bf16 v[112:115], a[228:231], a[12:15], v[112:115]
    v_mfma_f32_16x16x32_bf16 v[116:119], a[228:231], a[36:39], v[116:119]
    v_mfma_f32_16x16x32_bf16 v[120:123], a[228:231], a[60:63], v[120:123]
    v_mfma_f32_16x16x32_bf16 v[124:127], a[228:231], a[84:87], v[124:127]
    v_mfma_f32_16x16x32_bf16 v[112:115], a[232:235], a[16:19], v[112:115]
    ds_read_b128 a[252:255], v1 offset:15360
    v_mfma_f32_16x16x32_bf16 v[116:119], a[232:235], a[40:43], v[116:119]
    v_mfma_f32_16x16x32_bf16 v[120:123], a[232:235], a[64:67], v[120:123]
    v_mfma_f32_16x16x32_bf16 v[124:127], a[232:235], a[88:91], v[124:127]
    s_waitcnt lgkmcnt(1)
    v_mfma_f32_16x16x32_bf16 v[112:115], a[236:239], a[20:23], v[112:115]
    ds_read_b128 a[192:195], v1 offset:16384
    v_mfma_f32_16x16x32_bf16 v[116:119], a[236:239], a[44:47], v[116:119]
    v_mfma_f32_16x16x32_bf16 v[120:123], a[236:239], a[68:71], v[120:123]
    buffer_store_dwordx2 v[138:139], v11, s[12:15], s34 offen offset:512 sc1
    v_mfma_f32_16x16x32_bf16 v[124:127], a[236:239], a[92:95], v[124:127]
    v_cvt_pk_bf16_f32 v210, v112, v113
    v_cvt_pk_bf16_f32 v211, v114, v115
    v_mfma_f32_16x16x32_bf16 v[96:99], a[240:243], a[0:3], 0
    ds_read_b128 a[196:199], v1 offset:17408
    v_cvt_pk_bf16_f32 v214, v116, v117
    v_mfma_f32_16x16x32_bf16 v[100:103], a[240:243], a[24:27], 0
    v_cvt_pk_bf16_f32 v215, v118, v119
    v_cvt_pk_bf16_f32 v218, v120, v121
    v_mfma_f32_16x16x32_bf16 v[104:107], a[240:243], a[48:51], 0
    v_cvt_pk_bf16_f32 v219, v122, v123
    v_cvt_pk_bf16_f32 v222, v124, v125
    v_mfma_f32_16x16x32_bf16 v[108:111], a[240:243], a[72:75], 0
    v_cvt_pk_bf16_f32 v223, v126, v127
    v_mfma_f32_16x16x32_bf16 v[96:99], a[244:247], a[4:7], v[96:99]
    ds_read_b128 a[200:203], v1 offset:18432
    v_mfma_f32_16x16x32_bf16 v[100:103], a[244:247], a[28:31], v[100:103]
    v_mfma_f32_16x16x32_bf16 v[104:107], a[244:247], a[52:55], v[104:107]
    v_mfma_f32_16x16x32_bf16 v[108:111], a[244:247], a[76:79], v[108:111]
    v_mfma_f32_16x16x32_bf16 v[96:99], a[248:251], a[8:11], v[96:99]
    ds_read_b128 a[204:207], v1 offset:19456
    v_mfma_f32_16x16x32_bf16 v[100:103], a[248:251], a[32:35], v[100:103]
    v_mfma_f32_16x16x32_bf16 v[104:107], a[248:251], a[56:59], v[104:107]
    v_mfma_f32_16x16x32_bf16 v[108:111], a[248:251], a[80:83], v[108:111]
    v_mfma_f32_16x16x32_bf16 v[32:35], a[0:3], v[208:211], 0
    ds_read_b128 a[208:211], v1 offset:20480
    v_mfma_f32_16x16x32_bf16 v[36:39], a[24:27], v[208:211], 0
    v_mfma_f32_16x16x32_bf16 v[40:43], a[48:51], v[208:211], 0
    buffer_store_dwordx2 v[140:141], v11, s[12:15], s34 offen offset:896 sc1
    v_mfma_f32_16x16x32_bf16 v[44:47], a[72:75], v[208:211], 0
    v_mfma_f32_16x16x32_bf16 v[48:51], a[0:3], v[212:215], 0
    ds_read_b128 a[212:215], v1 offset:21504
    v_mfma_f32_16x16x32_bf16 v[52:55], a[24:27], v[212:215], 0
    v_mfma_f32_16x16x32_bf16 v[56:59], a[48:51], v[212:215], 0
    buffer_load_dwordx4 a[168:171], v9, s[8:11], s30 offen offset:0 nt
    v_mfma_f32_16x16x32_bf16 v[60:63], a[72:75], v[212:215], 0
    buffer_load_dwordx4 a[172:175], v9, s[8:11], s30 offen offset:64 nt
    v_mfma_f32_16x16x32_bf16 v[64:67], a[0:3], v[216:219], 0
    ds_read_b128 a[216:219], v1 offset:22528
    v_mfma_f32_16x16x32_bf16 v[68:71], a[24:27], v[216:219], 0
    v_mfma_f32_16x16x32_bf16 v[72:75], a[48:51], v[216:219], 0
    v_mfma_f32_16x16x32_bf16 v[76:79], a[72:75], v[216:219], 0
    v_mfma_f32_16x16x32_bf16 v[80:83], a[0:3], v[220:223], 0
    ds_read_b128 a[220:223], v1 offset:23552
    v_mfma_f32_16x16x32_bf16 v[84:87], a[24:27], v[220:223], 0
    v_mfma_f32_16x16x32_bf16 v[88:91], a[48:51], v[220:223], 0
    v_mfma_f32_16x16x32_bf16 v[92:95], a[72:75], v[220:223], 0
    s_waitcnt lgkmcnt(3)
    v_mfma_f32_16x16x32_bf16 v[96:99], a[252:255], a[12:15], v[96:99]
    ds_read_b128 a[224:227], v1 offset:24576
    v_mfma_f32_16x16x32_bf16 v[100:103], a[252:255], a[36:39], v[100:103]
    v_mfma_f32_16x16x32_bf16 v[104:107], a[252:255], a[60:63], v[104:107]
    buffer_store_dwordx2 v[142:143], v11, s[12:15], s34 offen offset:1280 sc1
    v_mfma_f32_16x16x32_bf16 v[108:111], a[252:255], a[84:87], v[108:111]
    ds_read_b128 a[228:231], v1 offset:25600
    v_mfma_f32_16x16x32_bf16 v[96:99], a[192:195], a[16:19], v[96:99]
    v_mfma_f32_16x16x32_bf16 v[100:103], a[192:195], a[40:43], v[100:103]
    v_mfma_f32_16x16x32_bf16 v[104:107], a[192:195], a[64:67], v[104:107]
    v_mfma_f32_16x16x32_bf16 v[108:111], a[192:195], a[88:91], v[108:111]
    ds_read_b128 a[232:235], v1 offset:26624
    v_mfma_f32_16x16x32_bf16 v[96:99], a[196:199], a[20:23], v[96:99]
    v_mfma_f32_16x16x32_bf16 v[100:103], a[196:199], a[44:47], v[100:103]
    v_mfma_f32_16x16x32_bf16 v[104:107], a[196:199], a[68:71], v[104:107]
    v_mfma_f32_16x16x32_bf16 v[108:111], a[196:199], a[92:95], v[108:111]
    v_cvt_pk_bf16_f32 v208, v96, v97
    v_cvt_pk_bf16_f32 v209, v98, v99
    v_mfma_f32_16x16x32_bf16 v[112:115], a[200:203], a[0:3], 0
    v_cvt_pk_bf16_f32 v212, v100, v101
    v_cvt_pk_bf16_f32 v213, v102, v103
    v_mfma_f32_16x16x32_bf16 v[116:119], a[200:203], a[24:27], 0
    v_cvt_pk_bf16_f32 v216, v104, v105
    v_cvt_pk_bf16_f32 v217, v106, v107
    v_mfma_f32_16x16x32_bf16 v[120:123], a[200:203], a[48:51], 0
    v_cvt_pk_bf16_f32 v220, v108, v109
    v_cvt_pk_bf16_f32 v221, v110, v111
    v_mfma_f32_16x16x32_bf16 v[124:127], a[200:203], a[72:75], 0
    v_mfma_f32_16x16x32_bf16 v[112:115], a[204:207], a[4:7], v[112:115]
    v_mfma_f32_16x16x32_bf16 v[116:119], a[204:207], a[28:31], v[116:119]
    buffer_store_dwordx2 v[144:145], v11, s[12:15], s36 offen offset:128 sc1
    v_mfma_f32_16x16x32_bf16 v[120:123], a[204:207], a[52:55], v[120:123]
    v_mfma_f32_16x16x32_bf16 v[124:127], a[204:207], a[76:79], v[124:127]
    v_mfma_f32_16x16x32_bf16 v[112:115], a[208:211], a[8:11], v[112:115]
    v_mfma_f32_16x16x32_bf16 v[116:119], a[208:211], a[32:35], v[116:119]
    v_mfma_f32_16x16x32_bf16 v[120:123], a[208:211], a[56:59], v[120:123]
    v_mfma_f32_16x16x32_bf16 v[124:127], a[208:211], a[80:83], v[124:127]
    s_waitcnt lgkmcnt(0)
    v_mfma_f32_16x16x32_bf16 v[112:115], a[212:215], a[12:15], v[112:115]
    v_mfma_f32_16x16x32_bf16 v[116:119], a[212:215], a[36:39], v[116:119]
    v_mfma_f32_16x16x32_bf16 v[120:123], a[212:215], a[60:63], v[120:123]
    v_mfma_f32_16x16x32_bf16 v[124:127], a[212:215], a[84:87], v[124:127]
    ds_read_b128 a[236:239], v1 offset:27648
    v_mfma_f32_16x16x32_bf16 v[112:115], a[216:219], a[16:19], v[112:115]
    v_mfma_f32_16x16x32_bf16 v[116:119], a[216:219], a[40:43], v[116:119]
    v_mfma_f32_16x16x32_bf16 v[120:123], a[216:219], a[64:67], v[120:123]
    v_mfma_f32_16x16x32_bf16 v[124:127], a[216:219], a[88:91], v[124:127]
    ds_read_b128 a[240:243], v1 offset:28672
    v_mfma_f32_16x16x32_bf16 v[112:115], a[220:223], a[20:23], v[112:115]
    v_mfma_f32_16x16x32_bf16 v[116:119], a[220:223], a[44:47], v[116:119]
    buffer_store_dwordx2 v[146:147], v11, s[12:15], s36 offen offset:512 sc1
    v_mfma_f32_16x16x32_bf16 v[120:123], a[220:223], a[68:71], v[120:123]
    v_mfma_f32_16x16x32_bf16 v[124:127], a[220:223], a[92:95], v[124:127]
    ds_read_b128 a[244:247], v1 offset:29696
    v_cvt_pk_bf16_f32 v210, v112, v113
    v_mfma_f32_16x16x32_bf16 v[96:99], a[224:227], a[0:3], 0
    v_cvt_pk_bf16_f32 v211, v114, v115
    v_cvt_pk_bf16_f32 v214, v116, v117
    v_mfma_f32_16x16x32_bf16 v[100:103], a[224:227], a[24:27], 0
    v_cvt_pk_bf16_f32 v215, v118, v119
    v_cvt_pk_bf16_f32 v218, v120, v121
    v_mfma_f32_16x16x32_bf16 v[104:107], a[224:227], a[48:51], 0
    v_cvt_pk_bf16_f32 v219, v122, v123
    v_cvt_pk_bf16_f32 v222, v124, v125
    v_mfma_f32_16x16x32_bf16 v[108:111], a[224:227], a[72:75], 0
    ds_read_b128 a[248:251], v1 offset:30720
    v_cvt_pk_bf16_f32 v223, v126, v127
    v_mfma_f32_16x16x32_bf16 v[96:99], a[228:231], a[4:7], v[96:99]
    v_mfma_f32_16x16x32_bf16 v[100:103], a[228:231], a[28:31], v[100:103]
    v_mfma_f32_16x16x32_bf16 v[104:107], a[228:231], a[52:55], v[104:107]
    v_mfma_f32_16x16x32_bf16 v[108:111], a[228:231], a[76:79], v[108:111]
    ds_read_b128 a[252:255], v1 offset:31744
    v_mfma_f32_16x16x32_bf16 v[96:99], a[232:235], a[8:11], v[96:99]
    v_mfma_f32_16x16x32_bf16 v[100:103], a[232:235], a[32:35], v[100:103]
    v_mfma_f32_16x16x32_bf16 v[104:107], a[232:235], a[56:59], v[104:107]
    v_mfma_f32_16x16x32_bf16 v[108:111], a[232:235], a[80:83], v[108:111]
    buffer_load_dwordx4 a[104:107], v9, s[8:11], s24 offen offset:128 nt
    v_mfma_f32_16x16x32_bf16 v[32:35], a[4:7], v[208:211], v[32:35]
    buffer_load_dwordx4 a[108:111], v9, s[8:11], s24 offen offset:192 nt
    v_mfma_f32_16x16x32_bf16 v[36:39], a[28:31], v[208:211], v[36:39]
    buffer_store_dwordx2 v[148:149], v11, s[12:15], s36 offen offset:896 sc1
    v_mfma_f32_16x16x32_bf16 v[40:43], a[52:55], v[208:211], v[40:43]
    ds_read_b128 a[192:195], v1 offset:32768
    v_mfma_f32_16x16x32_bf16 v[44:47], a[76:79], v[208:211], v[44:47]
    ds_read_b128 a[196:199], v1 offset:33792
    v_mfma_f32_16x16x32_bf16 v[48:51], a[4:7], v[212:215], v[48:51]
    v_mfma_f32_16x16x32_bf16 v[52:55], a[28:31], v[212:215], v[52:55]
    v_mfma_f32_16x16x32_bf16 v[56:59], a[52:55], v[212:215], v[56:59]
    v_mfma_f32_16x16x32_bf16 v[60:63], a[76:79], v[212:215], v[60:63]
    ds_read_b128 a[200:203], v1 offset:34816
    v_mfma_f32_16x16x32_bf16 v[64:67], a[4:7], v[216:219], v[64:67]
    v_mfma_f32_16x16x32_bf16 v[68:71], a[28:31], v[216:219], v[68:71]
    v_mfma_f32_16x16x32_bf16 v[72:75], a[52:55], v[216:219], v[72:75]
    v_mfma_f32_16x16x32_bf16 v[76:79], a[76:79], v[216:219], v[76:79]
    ds_read_b128 a[204:207], v1 offset:35840
    v_mfma_f32_16x16x32_bf16 v[80:83], a[4:7], v[220:223], v[80:83]
    v_mfma_f32_16x16x32_bf16 v[84:87], a[28:31], v[220:223], v[84:87]
    v_mfma_f32_16x16x32_bf16 v[88:91], a[52:55], v[220:223], v[88:91]
    v_mfma_f32_16x16x32_bf16 v[92:95], a[76:79], v[220:223], v[92:95]
    ds_read_b128 a[208:211], v1 offset:36864
    s_waitcnt lgkmcnt(5)
    v_mfma_f32_16x16x32_bf16 v[96:99], a[236:239], a[12:15], v[96:99]
    v_mfma_f32_16x16x32_bf16 v[100:103], a[236:239], a[36:39], v[100:103]
    buffer_store_dwordx2 v[150:151], v11, s[12:15], s36 offen offset:1280 sc1
    v_mfma_f32_16x16x32_bf16 v[104:107], a[236:239], a[60:63], v[104:107]
    ds_read_b128 a[212:215], v1 offset:37888
    v_mfma_f32_16x16x32_bf16 v[108:111], a[236:239], a[84:87], v[108:111]
    v_mfma_f32_16x16x32_bf16 v[96:99], a[240:243], a[16:19], v[96:99]
    v_mfma_f32_16x16x32_bf16 v[100:103], a[240:243], a[40:43], v[100:103]
    v_mfma_f32_16x16x32_bf16 v[104:107], a[240:243], a[64:67], v[104:107]
    ds_read_b128 a[216:219], v1 offset:38912
    v_mfma_f32_16x16x32_bf16 v[108:111], a[240:243], a[88:91], v[108:111]
    v_mfma_f32_16x16x32_bf16 v[96:99], a[244:247], a[20:23], v[96:99]
    v_mfma_f32_16x16x32_bf16 v[100:103], a[244:247], a[44:47], v[100:103]
    v_mfma_f32_16x16x32_bf16 v[104:107], a[244:247], a[68:71], v[104:107]
    v_mfma_f32_16x16x32_bf16 v[108:111], a[244:247], a[92:95], v[108:111]
    v_cvt_pk_bf16_f32 v208, v96, v97
    v_cvt_pk_bf16_f32 v209, v98, v99
    v_mfma_f32_16x16x32_bf16 v[112:115], a[248:251], a[0:3], 0
    v_cvt_pk_bf16_f32 v212, v100, v101
    v_cvt_pk_bf16_f32 v213, v102, v103
    v_mfma_f32_16x16x32_bf16 v[116:119], a[248:251], a[24:27], 0
    v_cvt_pk_bf16_f32 v216, v104, v105
    v_cvt_pk_bf16_f32 v217, v106, v107
    v_mfma_f32_16x16x32_bf16 v[120:123], a[248:251], a[48:51], 0
    v_cvt_pk_bf16_f32 v220, v108, v109
    v_cvt_pk_bf16_f32 v221, v110, v111
    v_mfma_f32_16x16x32_bf16 v[124:127], a[248:251], a[72:75], 0
    v_mfma_f32_16x16x32_bf16 v[112:115], a[252:255], a[4:7], v[112:115]
    buffer_store_dwordx2 v[152:153], v11, s[12:15], s38 offen offset:128 sc1
    v_mfma_f32_16x16x32_bf16 v[116:119], a[252:255], a[28:31], v[116:119]
    v_mfma_f32_16x16x32_bf16 v[120:123], a[252:255], a[52:55], v[120:123]
    v_mfma_f32_16x16x32_bf16 v[124:127], a[252:255], a[76:79], v[124:127]
    s_waitcnt lgkmcnt(0)
    v_mfma_f32_16x16x32_bf16 v[112:115], a[192:195], a[8:11], v[112:115]
    v_mfma_f32_16x16x32_bf16 v[116:119], a[192:195], a[32:35], v[116:119]
    v_mfma_f32_16x16x32_bf16 v[120:123], a[192:195], a[56:59], v[120:123]
    v_mfma_f32_16x16x32_bf16 v[124:127], a[192:195], a[80:83], v[124:127]
    v_mfma_f32_16x16x32_bf16 v[112:115], a[196:199], a[12:15], v[112:115]
    v_mfma_f32_16x16x32_bf16 v[116:119], a[196:199], a[36:39], v[116:119]
    v_mfma_f32_16x16x32_bf16 v[120:123], a[196:199], a[60:63], v[120:123]
    ds_read_b128 a[220:223], v1 offset:39936
    v_mfma_f32_16x16x32_bf16 v[124:127], a[196:199], a[84:87], v[124:127]
    v_mfma_f32_16x16x32_bf16 v[112:115], a[200:203], a[16:19], v[112:115]
    v_mfma_f32_16x16x32_bf16 v[116:119], a[200:203], a[40:43], v[116:119]
    v_mfma_f32_16x16x32_bf16 v[120:123], a[200:203], a[64:67], v[120:123]
    ds_read_b128 a[224:227], v1 offset:40960
    v_mfma_f32_16x16x32_bf16 v[124:127], a[200:203], a[88:91], v[124:127]
    v_mfma_f32_16x16x32_bf16 v[112:115], a[204:207], a[20:23], v[112:115]
    buffer_store_dwordx2 v[154:155], v11, s[12:15], s38 offen offset:512 sc1
    v_mfma_f32_16x16x32_bf16 v[116:119], a[204:207], a[44:47], v[116:119]
    v_mfma_f32_16x16x32_bf16 v[120:123], a[204:207], a[68:71], v[120:123]
    ds_read_b128 a[228:231], v1 offset:41984
    v_mfma_f32_16x16x32_bf16 v[124:127], a[204:207], a[92:95], v[124:127]
    v_cvt_pk_bf16_f32 v210, v112, v113
    v_cvt_pk_bf16_f32 v211, v114, v115
    v_mfma_f32_16x16x32_bf16 v[96:99], a[208:211], a[0:3], 0
    v_cvt_pk_bf16_f32 v214, v116, v117
    v_cvt_pk_bf16_f32 v215, v118, v119
    v_mfma_f32_16x16x32_bf16 v[100:103], a[208:211], a[24:27], 0
    v_cvt_pk_bf16_f32 v218, v120, v121
    v_cvt_pk_bf16_f32 v219, v122, v123
    v_mfma_f32_16x16x32_bf16 v[104:107], a[208:211], a[48:51], 0
    ds_read_b128 a[232:235], v1 offset:43008
    v_cvt_pk_bf16_f32 v222, v124, v125
    v_mfma_f32_16x16x32_bf16 v[108:111], a[208:211], a[72:75], 0
    v_cvt_pk_bf16_f32 v223, v126, v127
    v_mfma_f32_16x16x32_bf16 v[96:99], a[212:215], a[4:7], v[96:99]
    buffer_load_dwordx4 a[128:131], v9, s[8:11], s26 offen offset:128 nt
    v_mfma_f32_16x16x32_bf16 v[100:103], a[212:215], a[28:31], v[100:103]
    buffer_load_dwordx4 a[132:135], v9, s[8:11], s26 offen offset:192 nt
    v_mfma_f32_16x16x32_bf16 v[104:107], a[212:215], a[52:55], v[104:107]
    ds_read_b128 a[236:239], v1 offset:44032
    v_mfma_f32_16x16x32_bf16 v[108:111], a[212:215], a[76:79], v[108:111]
    v_mfma_f32_16x16x32_bf16 v[96:99], a[216:219], a[8:11], v[96:99]
    v_mfma_f32_16x16x32_bf16 v[100:103], a[216:219], a[32:35], v[100:103]
    v_mfma_f32_16x16x32_bf16 v[104:107], a[216:219], a[56:59], v[104:107]
    ds_read_b128 a[240:243], v1 offset:45056
    v_mfma_f32_16x16x32_bf16 v[108:111], a[216:219], a[80:83], v[108:111]
    v_mfma_f32_16x16x32_bf16 v[32:35], a[8:11], v[208:211], v[32:35]
    buffer_store_dwordx2 v[156:157], v11, s[12:15], s38 offen offset:896 sc1
    v_mfma_f32_16x16x32_bf16 v[36:39], a[32:35], v[208:211], v[36:39]
    v_mfma_f32_16x16x32_bf16 v[40:43], a[56:59], v[208:211], v[40:43]
    ds_read_b128 a[244:247], v1 offset:46080
    v_mfma_f32_16x16x32_bf16 v[44:47], a[80:83], v[208:211], v[44:47]
    v_mfma_f32_16x16x32_bf16 v[48:51], a[8:11], v[212:215], v[48:51]
    v_mfma_f32_16x16x32_bf16 v[52:55], a[32:35], v[212:215], v[52:55]
    v_mfma_f32_16x16x32_bf16 v[56:59], a[56:59], v[212:215], v[56:59]
    ds_read_b128 a[248:251], v1 offset:47104
    v_mfma_f32_16x16x32_bf16 v[60:63], a[80:83], v[212:215], v[60:63]
    v_mfma_f32_16x16x32_bf16 v[64:67], a[8:11], v[216:219], v[64:67]
    v_mfma_f32_16x16x32_bf16 v[68:71], a[32:35], v[216:219], v[68:71]
    v_mfma_f32_16x16x32_bf16 v[72:75], a[56:59], v[216:219], v[72:75]
    ds_read_b128 a[252:255], v1 offset:48128
    v_mfma_f32_16x16x32_bf16 v[76:79], a[80:83], v[216:219], v[76:79]
    v_mfma_f32_16x16x32_bf16 v[80:83], a[8:11], v[220:223], v[80:83]
    v_mfma_f32_16x16x32_bf16 v[84:87], a[32:35], v[220:223], v[84:87]
    v_mfma_f32_16x16x32_bf16 v[88:91], a[56:59], v[220:223], v[88:91]
    ds_read_b128 a[192:195], v1 offset:49152
    v_mfma_f32_16x16x32_bf16 v[92:95], a[80:83], v[220:223], v[92:95]
    s_waitcnt lgkmcnt(4)
    v_mfma_f32_16x16x32_bf16 v[96:99], a[220:223], a[12:15], v[96:99]
    buffer_store_dwordx2 v[158:159], v11, s[12:15], s38 offen offset:1280 sc1
    v_mfma_f32_16x16x32_bf16 v[100:103], a[220:223], a[36:39], v[100:103]
    ds_read_b128 a[196:199], v1 offset:50176
    v_mfma_f32_16x16x32_bf16 v[104:107], a[220:223], a[60:63], v[104:107]
    v_mfma_f32_16x16x32_bf16 v[108:111], a[220:223], a[84:87], v[108:111]
    v_mfma_f32_16x16x32_bf16 v[96:99], a[224:227], a[16:19], v[96:99]
    v_mfma_f32_16x16x32_bf16 v[100:103], a[224:227], a[40:43], v[100:103]
    ds_read_b128 a[200:203], v1 offset:51200
    v_mfma_f32_16x16x32_bf16 v[104:107], a[224:227], a[64:67], v[104:107]
    v_mfma_f32_16x16x32_bf16 v[108:111], a[224:227], a[88:91], v[108:111]
    v_mfma_f32_16x16x32_bf16 v[96:99], a[228:231], a[20:23], v[96:99]
    v_mfma_f32_16x16x32_bf16 v[100:103], a[228:231], a[44:47], v[100:103]
    v_mfma_f32_16x16x32_bf16 v[104:107], a[228:231], a[68:71], v[104:107]
    v_mfma_f32_16x16x32_bf16 v[108:111], a[228:231], a[92:95], v[108:111]
    v_cvt_pk_bf16_f32 v208, v96, v97
    v_cvt_pk_bf16_f32 v209, v98, v99
    v_mfma_f32_16x16x32_bf16 v[112:115], a[232:235], a[0:3], 0
    v_cvt_pk_bf16_f32 v212, v100, v101
    v_cvt_pk_bf16_f32 v213, v102, v103
    v_mfma_f32_16x16x32_bf16 v[116:119], a[232:235], a[24:27], 0
    v_cvt_pk_bf16_f32 v216, v104, v105
    v_cvt_pk_bf16_f32 v217, v106, v107
    v_mfma_f32_16x16x32_bf16 v[120:123], a[232:235], a[48:51], 0
    v_cvt_pk_bf16_f32 v220, v108, v109
    v_cvt_pk_bf16_f32 v221, v110, v111
    v_mfma_f32_16x16x32_bf16 v[124:127], a[232:235], a[72:75], 0
    v_mfma_f32_16x16x32_bf16 v[112:115], a[236:239], a[4:7], v[112:115]
    v_mfma_f32_16x16x32_bf16 v[116:119], a[236:239], a[28:31], v[116:119]
    v_mfma_f32_16x16x32_bf16 v[120:123], a[236:239], a[52:55], v[120:123]
    v_mfma_f32_16x16x32_bf16 v[124:127], a[236:239], a[76:79], v[124:127]
    buffer_store_dwordx2 v[160:161], v11, s[12:15], s32 offen offset:256 sc1
    v_mfma_f32_16x16x32_bf16 v[112:115], a[240:243], a[8:11], v[112:115]
    v_mfma_f32_16x16x32_bf16 v[116:119], a[240:243], a[32:35], v[116:119]
    v_mfma_f32_16x16x32_bf16 v[120:123], a[240:243], a[56:59], v[120:123]
    v_mfma_f32_16x16x32_bf16 v[124:127], a[240:243], a[80:83], v[124:127]
    s_waitcnt lgkmcnt(0)
    v_mfma_f32_16x16x32_bf16 v[112:115], a[244:247], a[12:15], v[112:115]
    v_mfma_f32_16x16x32_bf16 v[116:119], a[244:247], a[36:39], v[116:119]
    ds_read_b128 a[204:207], v1 offset:52224
    v_mfma_f32_16x16x32_bf16 v[120:123], a[244:247], a[60:63], v[120:123]
    v_mfma_f32_16x16x32_bf16 v[124:127], a[244:247], a[84:87], v[124:127]
    v_mfma_f32_16x16x32_bf16 v[112:115], a[248:251], a[16:19], v[112:115]
    v_mfma_f32_16x16x32_bf16 v[116:119], a[248:251], a[40:43], v[116:119]
    ds_read_b128 a[208:211], v1 offset:53248
    v_mfma_f32_16x16x32_bf16 v[120:123], a[248:251], a[64:67], v[120:123]
    v_mfma_f32_16x16x32_bf16 v[124:127], a[248:251], a[88:91], v[124:127]
    v_mfma_f32_16x16x32_bf16 v[112:115], a[252:255], a[20:23], v[112:115]
    v_mfma_f32_16x16x32_bf16 v[116:119], a[252:255], a[44:47], v[116:119]
    buffer_store_dwordx2 v[162:163], v11, s[12:15], s32 offen offset:640 sc1
    v_mfma_f32_16x16x32_bf16 v[120:123], a[252:255], a[68:71], v[120:123]
    buffer_load_dwordx4 a[152:155], v9, s[8:11], s28 offen offset:128 nt
    v_mfma_f32_16x16x32_bf16 v[124:127], a[252:255], a[92:95], v[124:127]
    buffer_load_dwordx4 a[156:159], v9, s[8:11], s28 offen offset:192 nt
    v_cvt_pk_bf16_f32 v210, v112, v113
    v_mfma_f32_16x16x32_bf16 v[96:99], a[192:195], a[0:3], 0
    ds_read_b128 a[212:215], v1 offset:54272
    v_cvt_pk_bf16_f32 v211, v114, v115
    v_mfma_f32_16x16x32_bf16 v[100:103], a[192:195], a[24:27], 0
    ds_read_b128 a[216:219], v1 offset:55296
    v_cvt_pk_bf16_f32 v214, v116, v117
    v_mfma_f32_16x16x32_bf16 v[104:107], a[192:195], a[48:51], 0
    v_cvt_pk_bf16_f32 v215, v118, v119
    v_cvt_pk_bf16_f32 v218, v120, v121
    v_mfma_f32_16x16x32_bf16 v[108:111], a[192:195], a[72:75], 0
    v_cvt_pk_bf16_f32 v219, v122, v123
    v_cvt_pk_bf16_f32 v222, v124, v125
    v_mfma_f32_16x16x32_bf16 v[96:99], a[196:199], a[4:7], v[96:99]
    v_cvt_pk_bf16_f32 v223, v126, v127
    v_mfma_f32_16x16x32_bf16 v[100:103], a[196:199], a[28:31], v[100:103]
    ds_read_b128 a[220:223], v1 offset:56320
    v_mfma_f32_16x16x32_bf16 v[104:107], a[196:199], a[52:55], v[104:107]
    v_mfma_f32_16x16x32_bf16 v[108:111], a[196:199], a[76:79], v[108:111]
    v_mfma_f32_16x16x32_bf16 v[96:99], a[200:203], a[8:11], v[96:99]
    v_mfma_f32_16x16x32_bf16 v[100:103], a[200:203], a[32:35], v[100:103]
    ds_read_b128 a[224:227], v1 offset:57344
    v_mfma_f32_16x16x32_bf16 v[104:107], a[200:203], a[56:59], v[104:107]
    v_mfma_f32_16x16x32_bf16 v[108:111], a[200:203], a[80:83], v[108:111]
    buffer_store_dwordx2 v[164:165], v11, s[12:15], s32 offen offset:1024 sc1
    v_mfma_f32_16x16x32_bf16 v[32:35], a[12:15], v[208:211], v[32:35]
    v_mfma_f32_16x16x32_bf16 v[36:39], a[36:39], v[208:211], v[36:39]
    ds_read_b128 a[228:231], v1 offset:58368
    v_mfma_f32_16x16x32_bf16 v[40:43], a[60:63], v[208:211], v[40:43]
    v_mfma_f32_16x16x32_bf16 v[44:47], a[84:87], v[208:211], v[44:47]
    v_mfma_f32_16x16x32_bf16 v[48:51], a[12:15], v[212:215], v[48:51]
    v_mfma_f32_16x16x32_bf16 v[52:55], a[36:39], v[212:215], v[52:55]
    ds_read_b128 a[232:235], v1 offset:59392
    v_mfma_f32_16x16x32_bf16 v[56:59], a[60:63], v[212:215], v[56:59]
    v_mfma_f32_16x16x32_bf16 v[60:63], a[84:87], v[212:215], v[60:63]
    v_mfma_f32_16x16x32_bf16 v[64:67], a[12:15], v[216:219], v[64:67]
    v_mfma_f32_16x16x32_bf16 v[68:71], a[36:39], v[216:219], v[68:71]
    ds_read_b128 a[236:239], v1 offset:60416
    v_mfma_f32_16x16x32_bf16 v[72:75], a[60:63], v[216:219], v[72:75]
    v_mfma_f32_16x16x32_bf16 v[76:79], a[84:87], v[216:219], v[76:79]
    v_mfma_f32_16x16x32_bf16 v[80:83], a[12:15], v[220:223], v[80:83]
    v_mfma_f32_16x16x32_bf16 v[84:87], a[36:39], v[220:223], v[84:87]
    buffer_store_dwordx2 v[166:167], v11, s[12:15], s32 offen offset:1408 sc1
    v_mfma_f32_16x16x32_bf16 v[88:91], a[60:63], v[220:223], v[88:91]
    ds_read_b128 a[240:243], v1 offset:61440
    s_add_u32 s32, s32, 25165824
    v_mfma_f32_16x16x32_bf16 v[92:95], a[84:87], v[220:223], v[92:95]
    s_waitcnt lgkmcnt(3)
    v_mfma_f32_16x16x32_bf16 v[96:99], a[204:207], a[12:15], v[96:99]
    ds_read_b128 a[244:247], v1 offset:62464
    v_mfma_f32_16x16x32_bf16 v[100:103], a[204:207], a[36:39], v[100:103]
    v_mfma_f32_16x16x32_bf16 v[104:107], a[204:207], a[60:63], v[104:107]
    v_mfma_f32_16x16x32_bf16 v[108:111], a[204:207], a[84:87], v[108:111]
    v_mfma_f32_16x16x32_bf16 v[96:99], a[208:211], a[16:19], v[96:99]
    ds_read_b128 a[248:251], v1 offset:63488
    v_mfma_f32_16x16x32_bf16 v[100:103], a[208:211], a[40:43], v[100:103]
    v_mfma_f32_16x16x32_bf16 v[104:107], a[208:211], a[64:67], v[104:107]
    v_mfma_f32_16x16x32_bf16 v[108:111], a[208:211], a[88:91], v[108:111]
    v_mfma_f32_16x16x32_bf16 v[96:99], a[212:215], a[20:23], v[96:99]
    v_mfma_f32_16x16x32_bf16 v[100:103], a[212:215], a[44:47], v[100:103]
    v_mfma_f32_16x16x32_bf16 v[104:107], a[212:215], a[68:71], v[104:107]
    buffer_store_dwordx2 v[168:169], v11, s[12:15], s34 offen offset:256 sc1
    v_mfma_f32_16x16x32_bf16 v[108:111], a[212:215], a[92:95], v[108:111]
    v_cvt_pk_bf16_f32 v208, v96, v97
    v_cvt_pk_bf16_f32 v209, v98, v99
    v_mfma_f32_16x16x32_bf16 v[112:115], a[216:219], a[0:3], 0
    v_cvt_pk_bf16_f32 v212, v100, v101
    v_cvt_pk_bf16_f32 v213, v102, v103
    v_mfma_f32_16x16x32_bf16 v[116:119], a[216:219], a[24:27], 0
    v_cvt_pk_bf16_f32 v216, v104, v105
    v_cvt_pk_bf16_f32 v217, v106, v107
    v_mfma_f32_16x16x32_bf16 v[120:123], a[216:219], a[48:51], 0
    v_cvt_pk_bf16_f32 v220, v108, v109
    v_cvt_pk_bf16_f32 v221, v110, v111
    v_mfma_f32_16x16x32_bf16 v[124:127], a[216:219], a[72:75], 0
    v_mfma_f32_16x16x32_bf16 v[112:115], a[220:223], a[4:7], v[112:115]
    v_mfma_f32_16x16x32_bf16 v[116:119], a[220:223], a[28:31], v[116:119]
    v_mfma_f32_16x16x32_bf16 v[120:123], a[220:223], a[52:55], v[120:123]
    v_mfma_f32_16x16x32_bf16 v[124:127], a[220:223], a[76:79], v[124:127]
    v_mfma_f32_16x16x32_bf16 v[112:115], a[224:227], a[8:11], v[112:115]
    v_mfma_f32_16x16x32_bf16 v[116:119], a[224:227], a[32:35], v[116:119]
    v_mfma_f32_16x16x32_bf16 v[120:123], a[224:227], a[56:59], v[120:123]
    v_mfma_f32_16x16x32_bf16 v[124:127], a[224:227], a[80:83], v[124:127]
    v_mfma_f32_16x16x32_bf16 v[112:115], a[228:231], a[12:15], v[112:115]
    buffer_store_dwordx2 v[170:171], v11, s[12:15], s34 offen offset:640 sc1
    v_mfma_f32_16x16x32_bf16 v[116:119], a[228:231], a[36:39], v[116:119]
    ds_read_b128 a[252:255], v1 offset:64512
    v_mfma_f32_16x16x32_bf16 v[120:123], a[228:231], a[60:63], v[120:123]
    buffer_load_dwordx4 a[176:179], v9, s[8:11], s30 offen offset:128 nt
    v_mfma_f32_16x16x32_bf16 v[124:127], a[228:231], a[84:87], v[124:127]
    buffer_load_dwordx4 a[180:183], v9, s[8:11], s30 offen offset:192 nt
    s_waitcnt lgkmcnt(1)
    v_mfma_f32_16x16x32_bf16 v[112:115], a[232:235], a[16:19], v[112:115]
    ds_read_b128 a[192:195], v2 offset:0
    v_mfma_f32_16x16x32_bf16 v[116:119], a[232:235], a[40:43], v[116:119]
    v_mfma_f32_16x16x32_bf16 v[120:123], a[232:235], a[64:67], v[120:123]
    v_mfma_f32_16x16x32_bf16 v[124:127], a[232:235], a[88:91], v[124:127]
    v_mfma_f32_16x16x32_bf16 v[112:115], a[236:239], a[20:23], v[112:115]
    ds_read_b128 a[196:199], v2 offset:1024
    v_mfma_f32_16x16x32_bf16 v[116:119], a[236:239], a[44:47], v[116:119]
    v_mfma_f32_16x16x32_bf16 v[120:123], a[236:239], a[68:71], v[120:123]
    v_mfma_f32_16x16x32_bf16 v[124:127], a[236:239], a[92:95], v[124:127]
    v_cvt_pk_bf16_f32 v210, v112, v113
    v_cvt_pk_bf16_f32 v211, v114, v115
    v_mfma_f32_16x16x32_bf16 v[96:99], a[240:243], a[0:3], 0
    ds_read_b128 a[200:203], v2 offset:2048
    v_cvt_pk_bf16_f32 v214, v116, v117
    v_mfma_f32_16x16x32_bf16 v[100:103], a[240:243], a[24:27], 0
    v_cvt_pk_bf16_f32 v215, v118, v119
    v_cvt_pk_bf16_f32 v218, v120, v121
    v_mfma_f32_16x16x32_bf16 v[104:107], a[240:243], a[48:51], 0
    buffer_store_dwordx2 v[172:173], v11, s[12:15], s34 offen offset:1024 sc1
    v_mfma_f32_16x16x32_bf16 v[108:111], a[240:243], a[72:75], 0
    v_cvt_pk_bf16_f32 v219, v122, v123
    v_cvt_pk_bf16_f32 v222, v124, v125
    v_mfma_f32_16x16x32_bf16 v[96:99], a[244:247], a[4:7], v[96:99]
    ds_read_b128 a[204:207], v2 offset:3072
    v_cvt_pk_bf16_f32 v223, v126, v127
    v_mfma_f32_16x16x32_bf16 v[100:103], a[244:247], a[28:31], v[100:103]
    v_mfma_f32_16x16x32_bf16 v[104:107], a[244:247], a[52:55], v[104:107]
    v_mfma_f32_16x16x32_bf16 v[108:111], a[244:247], a[76:79], v[108:111]
    v_mfma_f32_16x16x32_bf16 v[96:99], a[248:251], a[8:11], v[96:99]
    ds_read_b128 a[208:211], v2 offset:4096
    v_mfma_f32_16x16x32_bf16 v[100:103], a[248:251], a[32:35], v[100:103]
    v_mfma_f32_16x16x32_bf16 v[104:107], a[248:251], a[56:59], v[104:107]
    v_mfma_f32_16x16x32_bf16 v[108:111], a[248:251], a[80:83], v[108:111]
    v_mfma_f32_16x16x32_bf16 v[32:35], a[16:19], v[208:211], v[32:35]
    ds_read_b128 a[212:215], v2 offset:5120
    v_mfma_f32_16x16x32_bf16 v[36:39], a[40:43], v[208:211], v[36:39]
    v_mfma_f32_16x16x32_bf16 v[40:43], a[64:67], v[208:211], v[40:43]
    v_mfma_f32_16x16x32_bf16 v[44:47], a[88:91], v[208:211], v[44:47]
    v_mfma_f32_16x16x32_bf16 v[48:51], a[16:19], v[212:215], v[48:51]
    buffer_store_dwordx2 v[174:175], v11, s[12:15], s34 offen offset:1408 sc1
    v_mfma_f32_16x16x32_bf16 v[52:55], a[40:43], v[212:215], v[52:55]
    ds_read_b128 a[216:219], v2 offset:6144
    s_add_u32 s34, s34, 25165824
    v_mfma_f32_16x16x32_bf16 v[56:59], a[64:67], v[212:215], v[56:59]
    v_mfma_f32_16x16x32_bf16 v[60:63], a[88:91], v[212:215], v[60:63]
    ds_read_b128 a[220:223], v2 offset:7168
    v_mfma_f32_16x16x32_bf16 v[64:67], a[16:19], v[216:219], v[64:67]
    v_mfma_f32_16x16x32_bf16 v[68:71], a[40:43], v[216:219], v[68:71]
    v_mfma_f32_16x16x32_bf16 v[72:75], a[64:67], v[216:219], v[72:75]
    v_mfma_f32_16x16x32_bf16 v[76:79], a[88:91], v[216:219], v[76:79]
    ds_read_b128 a[224:227], v2 offset:8192
    v_mfma_f32_16x16x32_bf16 v[80:83], a[16:19], v[220:223], v[80:83]
    v_mfma_f32_16x16x32_bf16 v[84:87], a[40:43], v[220:223], v[84:87]
    v_mfma_f32_16x16x32_bf16 v[88:91], a[64:67], v[220:223], v[88:91]
    v_mfma_f32_16x16x32_bf16 v[92:95], a[88:91], v[220:223], v[92:95]
    ds_read_b128 a[228:231], v2 offset:9216
    s_waitcnt lgkmcnt(4)
    v_mfma_f32_16x16x32_bf16 v[96:99], a[252:255], a[12:15], v[96:99]
    v_mfma_f32_16x16x32_bf16 v[100:103], a[252:255], a[36:39], v[100:103]
    buffer_store_dwordx2 v[176:177], v11, s[12:15], s36 offen offset:256 sc1
    v_mfma_f32_16x16x32_bf16 v[104:107], a[252:255], a[60:63], v[104:107]
    s_add_u32 s36, s36, 25165824
    s_add_u32 s38, s38, 25165824
    v_mfma_f32_16x16x32_bf16 v[108:111], a[252:255], a[84:87], v[108:111]
    ds_read_b128 a[232:235], v2 offset:10240
    v_mfma_f32_16x16x32_bf16 v[96:99], a[192:195], a[16:19], v[96:99]
    v_mfma_f32_16x16x32_bf16 v[100:103], a[192:195], a[40:43], v[100:103]
    v_mfma_f32_16x16x32_bf16 v[104:107], a[192:195], a[64:67], v[104:107]
    v_mfma_f32_16x16x32_bf16 v[108:111], a[192:195], a[88:91], v[108:111]
    v_mfma_f32_16x16x32_bf16 v[96:99], a[196:199], a[20:23], v[96:99]
    v_mfma_f32_16x16x32_bf16 v[100:103], a[196:199], a[44:47], v[100:103]
    v_mfma_f32_16x16x32_bf16 v[104:107], a[196:199], a[68:71], v[104:107]
    v_mfma_f32_16x16x32_bf16 v[108:111], a[196:199], a[92:95], v[108:111]
    v_cvt_pk_bf16_f32 v208, v96, v97
    v_cvt_pk_bf16_f32 v209, v98, v99
    v_mfma_f32_16x16x32_bf16 v[112:115], a[200:203], a[0:3], 0
    v_cvt_pk_bf16_f32 v212, v100, v101
    v_cvt_pk_bf16_f32 v213, v102, v103
    v_mfma_f32_16x16x32_bf16 v[116:119], a[200:203], a[24:27], 0
    v_cvt_pk_bf16_f32 v216, v104, v105
    v_cvt_pk_bf16_f32 v217, v106, v107
    v_mfma_f32_16x16x32_bf16 v[120:123], a[200:203], a[48:51], 0
    v_cvt_pk_bf16_f32 v220, v108, v109
    v_cvt_pk_bf16_f32 v221, v110, v111
    v_mfma_f32_16x16x32_bf16 v[124:127], a[200:203], a[72:75], 0
    v_mfma_f32_16x16x32_bf16 v[112:115], a[204:207], a[4:7], v[112:115]
    v_mfma_f32_16x16x32_bf16 v[116:119], a[204:207], a[28:31], v[116:119]
    v_mfma_f32_16x16x32_bf16 v[120:123], a[204:207], a[52:55], v[120:123]
    v_mfma_f32_16x16x32_bf16 v[124:127], a[204:207], a[76:79], v[124:127]
    v_mfma_f32_16x16x32_bf16 v[112:115], a[208:211], a[8:11], v[112:115]
    v_mfma_f32_16x16x32_bf16 v[116:119], a[208:211], a[32:35], v[116:119]
    v_mfma_f32_16x16x32_bf16 v[120:123], a[208:211], a[56:59], v[120:123]
    v_mfma_f32_16x16x32_bf16 v[124:127], a[208:211], a[80:83], v[124:127]
    v_mfma_f32_16x16x32_bf16 v[112:115], a[212:215], a[12:15], v[112:115]
    v_mfma_f32_16x16x32_bf16 v[116:119], a[212:215], a[36:39], v[116:119]
    v_mfma_f32_16x16x32_bf16 v[120:123], a[212:215], a[60:63], v[120:123]
    v_mfma_f32_16x16x32_bf16 v[124:127], a[212:215], a[84:87], v[124:127]
    s_waitcnt lgkmcnt(0)
    v_mfma_f32_16x16x32_bf16 v[112:115], a[216:219], a[16:19], v[112:115]
    v_mfma_f32_16x16x32_bf16 v[116:119], a[216:219], a[40:43], v[116:119]
    v_mfma_f32_16x16x32_bf16 v[120:123], a[216:219], a[64:67], v[120:123]
    v_mfma_f32_16x16x32_bf16 v[124:127], a[216:219], a[88:91], v[124:127]
    v_mfma_f32_16x16x32_bf16 v[112:115], a[220:223], a[20:23], v[112:115]
    v_mfma_f32_16x16x32_bf16 v[116:119], a[220:223], a[44:47], v[116:119]
    v_mfma_f32_16x16x32_bf16 v[120:123], a[220:223], a[68:71], v[120:123]
    v_mfma_f32_16x16x32_bf16 v[124:127], a[220:223], a[92:95], v[124:127]
    v_cvt_pk_bf16_f32 v210, v112, v113
    v_cvt_pk_bf16_f32 v211, v114, v115
    v_cvt_pk_bf16_f32 v214, v116, v117
    v_cvt_pk_bf16_f32 v215, v118, v119
    s_nop 0
    v_cvt_pk_bf16_f32 v218, v120, v121
    v_cvt_pk_bf16_f32 v219, v122, v123
    s_nop 0
    v_cvt_pk_bf16_f32 v222, v124, v125
    v_cvt_pk_bf16_f32 v223, v126, v127
    s_branch L_loop
L_tail:
    v_mfma_f32_16x16x32_bf16 v[64:67], v[32:35], v[128:131], 0
    v_mul_f32 v74, v74, v22
    v_mul_f32 v75, v75, v22
    v_mfma_f32_16x16x32_bf16 v[68:71], v[32:35], v[136:139], 0
    v_cvt_pk_bf16_f32 v52, v72, v73
    v_cvt_pk_bf16_f32 v53, v74, v75
    v_mfma_f32_16x16x32_bf16 v[72:75], v[32:35], v[144:147], 0
    v_mul_f32 v54, v54, v21
    v_mul_f32 v55, v55, v21
    v_cvt_pk_bf16_f32 v43, v54, v55
    v_mul_f32 v76, v76, v22
    v_mul_f32 v77, v77, v22
    v_cvt_pk_bf16_f32 v54, v76, v77
    v_mul_f32 v78, v78, v22
    v_mul_f32 v79, v79, v22
    v_cvt_pk_bf16_f32 v55, v78, v79
    v_mfma_f32_16x16x32_bf16 v[76:79], v[32:35], v[152:155], 0
    v_mul_f32 v44, v44, v20
    v_mul_f32 v45, v45, v20
    v_cvt_pk_bf16_f32 v38, v44, v45
    v_mul_f32 v46, v46, v20
    v_mul_f32 v47, v47, v20
    v_cvt_pk_bf16_f32 v39, v46, v47
    s_nop 1
    v_mfma_f32_16x16x32_bf16 v[64:67], v[36:39], v[132:135], v[64:67]
    v_mul_f32 v56, v56, v21
    v_mul_f32 v57, v57, v21
    v_mfma_f32_16x16x32_bf16 v[68:71], v[36:39], v[140:143], v[68:71]
    v_cvt_pk_bf16_f32 v44, v56, v57
    v_mul_f32 v80, v80, v23
    v_mfma_f32_16x16x32_bf16 v[72:75], v[36:39], v[148:151], v[72:75]
    v_mul_f32 v81, v81, v23
    v_mul_f32 v82, v82, v23
    v_mfma_f32_16x16x32_bf16 v[76:79], v[36:39], v[156:159], v[76:79]
    v_mul_f32 v83, v83, v23
    v_cvt_pk_bf16_f32 v56, v80, v81
    v_cvt_pk_bf16_f32 v57, v82, v83
    v_mfma_f32_16x16x32_bf16 v[80:83], v[40:43], v[128:131], 0
    v_cvt_pk_bf16_f32 v224, v64, v68
    v_cvt_pk_bf16_f32 v226, v65, v69
    v_mul_f32 v58, v58, v21
    v_mul_f32 v59, v59, v21
    v_cvt_pk_bf16_f32 v45, v58, v59
    v_mul_f32 v84, v84, v23
    v_mul_f32 v85, v85, v23
    v_cvt_pk_bf16_f32 v58, v84, v85
    v_mul_f32 v86, v86, v23
    v_mul_f32 v87, v87, v23
    v_cvt_pk_bf16_f32 v59, v86, v87
    v_mfma_f32_16x16x32_bf16 v[84:87], v[40:43], v[136:139], 0
    v_cvt_pk_bf16_f32 v225, v72, v76
    v_cvt_pk_bf16_f32 v227, v73, v77
    v_mul_f32 v60, v60, v21
    v_mul_f32 v61, v61, v21
    v_cvt_pk_bf16_f32 v46, v60, v61
    v_mul_f32 v88, v88, v23
    v_mul_f32 v89, v89, v23
    v_cvt_pk_bf16_f32 v60, v88, v89
    v_mul_f32 v90, v90, v23
    v_mul_f32 v91, v91, v23
    v_cvt_pk_bf16_f32 v61, v90, v91
    v_mfma_f32_16x16x32_bf16 v[88:91], v[40:43], v[144:147], 0
    buffer_store_dwordx2 v[224:225], v11, s[12:15], s32 offen offset:0 sc1
    v_mul_f32 v62, v62, v21
    v_mul_f32 v63, v63, v21
    v_cvt_pk_bf16_f32 v47, v62, v63
    v_mul_f32 v92, v92, v23
    v_mul_f32 v93, v93, v23
    v_cvt_pk_bf16_f32 v62, v92, v93
    v_mul_f32 v94, v94, v23
    v_mul_f32 v95, v95, v23
    v_cvt_pk_bf16_f32 v63, v94, v95
    v_mfma_f32_16x16x32_bf16 v[92:95], v[40:43], v[152:155], 0
    buffer_store_dwordx2 v[226:227], v11, s[12:15], s32 offen offset:384 sc1
    v_mfma_f32_16x16x32_bf16 v[80:83], v[44:47], v[132:135], v[80:83]
    v_cvt_pk_bf16_f32 v228, v66, v70
    v_cvt_pk_bf16_f32 v229, v74, v78
    v_mfma_f32_16x16x32_bf16 v[84:87], v[44:47], v[140:143], v[84:87]
    buffer_store_dwordx2 v[228:229], v11, s[12:15], s32 offen offset:768 sc1
    v_mfma_f32_16x16x32_bf16 v[88:91], v[44:47], v[148:151], v[88:91]
    v_cvt_pk_bf16_f32 v230, v67, v71
    v_cvt_pk_bf16_f32 v231, v75, v79
    v_mfma_f32_16x16x32_bf16 v[92:95], v[44:47], v[156:159], v[92:95]
    buffer_store_dwordx2 v[230:231], v11, s[12:15], s32 offen offset:1152 sc1
    v_cvt_pk_bf16_f32 v208, v96, v97
    v_cvt_pk_bf16_f32 v209, v98, v99
    v_mfma_f32_16x16x32_bf16 v[96:99], v[48:51], v[128:131], 0
    v_cvt_pk_bf16_f32 v232, v80, v84
    v_cvt_pk_bf16_f32 v234, v81, v85
    v_cvt_pk_bf16_f32 v210, v100, v101
    v_cvt_pk_bf16_f32 v211, v102, v103
    v_mfma_f32_16x16x32_bf16 v[100:103], v[48:51], v[136:139], 0
    v_cvt_pk_bf16_f32 v233, v88, v92
    v_cvt_pk_bf16_f32 v235, v89, v93
    v_cvt_pk_bf16_f32 v212, v104, v105
    v_cvt_pk_bf16_f32 v213, v106, v107
    v_mfma_f32_16x16x32_bf16 v[104:107], v[48:51], v[144:147], 0
    buffer_store_dwordx2 v[232:233], v11, s[12:15], s34 offen offset:0 sc1
    v_cvt_pk_bf16_f32 v214, v108, v109
    v_cvt_pk_bf16_f32 v215, v110, v111
    v_mfma_f32_16x16x32_bf16 v[108:111], v[48:51], v[152:155], 0
    buffer_store_dwordx2 v[234:235], v11, s[12:15], s34 offen offset:384 sc1
    v_mfma_f32_16x16x32_bf16 v[96:99], v[52:55], v[132:135], v[96:99]
    v_cvt_pk_bf16_f32 v236, v82, v86
    v_cvt_pk_bf16_f32 v237, v90, v94
    v_mfma_f32_16x16x32_bf16 v[100:103], v[52:55], v[140:143], v[100:103]
    buffer_store_dwordx2 v[236:237], v11, s[12:15], s34 offen offset:768 sc1
    v_mfma_f32_16x16x32_bf16 v[104:107], v[52:55], v[148:151], v[104:107]
    v_cvt_pk_bf16_f32 v238, v83, v87
    v_cvt_pk_bf16_f32 v239, v91, v95
    v_mfma_f32_16x16x32_bf16 v[108:111], v[52:55], v[156:159], v[108:111]
    buffer_store_dwordx2 v[238:239], v11, s[12:15], s34 offen offset:1152 sc1
    v_cvt_pk_bf16_f32 v216, v112, v113
    v_cvt_pk_bf16_f32 v217, v114, v115
    v_mfma_f32_16x16x32_bf16 v[112:115], v[56:59], v[128:131], 0
    v_cvt_pk_bf16_f32 v240, v96, v100
    v_cvt_pk_bf16_f32 v242, v97, v101
    v_cvt_pk_bf16_f32 v218, v116, v117
    v_cvt_pk_bf16_f32 v219, v118, v119
    v_mfma_f32_16x16x32_bf16 v[116:119], v[56:59], v[136:139], 0
    v_cvt_pk_bf16_f32 v241, v104, v108
    v_cvt_pk_bf16_f32 v243, v105, v109
    v_cvt_pk_bf16_f32 v220, v120, v121
    v_cvt_pk_bf16_f32 v221, v122, v123
    v_mfma_f32_16x16x32_bf16 v[120:123], v[56:59], v[144:147], 0
    buffer_store_dwordx2 v[240:241], v11, s[12:15], s36 offen offset:0 sc1
    v_cvt_pk_bf16_f32 v222, v124, v125
    v_cvt_pk_bf16_f32 v223, v126, v127
    v_mfma_f32_16x16x32_bf16 v[124:127], v[56:59], v[152:155], 0
    buffer_store_dwordx2 v[242:243], v11, s[12:15], s36 offen offset:384 sc1
    v_mfma_f32_16x16x32_bf16 v[112:115], v[60:63], v[132:135], v[112:115]
    v_cvt_pk_bf16_f32 v244, v98, v102
    v_cvt_pk_bf16_f32 v245, v106, v110
    v_mfma_f32_16x16x32_bf16 v[116:119], v[60:63], v[140:143], v[116:119]
    buffer_store_dwordx2 v[244:245], v11, s[12:15], s36 offen offset:768 sc1
    v_mfma_f32_16x16x32_bf16 v[120:123], v[60:63], v[148:151], v[120:123]
    v_cvt_pk_bf16_f32 v246, v99, v103
    v_cvt_pk_bf16_f32 v247, v107, v111
    v_mfma_f32_16x16x32_bf16 v[124:127], v[60:63], v[156:159], v[124:127]
    buffer_store_dwordx2 v[246:247], v11, s[12:15], s36 offen offset:1152 sc1
    v_mfma_f32_16x16x32_bf16 v[64:67], v[32:35], v[160:163], 0
    v_cvt_pk_bf16_f32 v248, v112, v116
    v_cvt_pk_bf16_f32 v250, v113, v117
    v_mfma_f32_16x16x32_bf16 v[68:71], v[32:35], v[168:171], 0
    v_cvt_pk_bf16_f32 v252, v114, v118
    v_cvt_pk_bf16_f32 v254, v115, v119
    v_mfma_f32_16x16x32_bf16 v[72:75], v[32:35], v[176:179], 0
    v_cvt_pk_bf16_f32 v249, v120, v124
    v_cvt_pk_bf16_f32 v251, v121, v125
    v_mfma_f32_16x16x32_bf16 v[76:79], v[32:35], v[184:187], 0
    buffer_store_dwordx2 v[248:249], v11, s[12:15], s38 offen offset:0 sc1
    v_mfma_f32_16x16x32_bf16 v[64:67], v[36:39], v[164:167], v[64:67]
    buffer_store_dwordx2 v[250:251], v11, s[12:15], s38 offen offset:384 sc1
    v_mfma_f32_16x16x32_bf16 v[68:71], v[36:39], v[172:175], v[68:71]
    v_cvt_pk_bf16_f32 v253, v122, v126
    v_cvt_pk_bf16_f32 v255, v123, v127
    v_mfma_f32_16x16x32_bf16 v[72:75], v[36:39], v[180:183], v[72:75]
    buffer_store_dwordx2 v[252:253], v11, s[12:15], s38 offen offset:768 sc1
    v_mfma_f32_16x16x32_bf16 v[76:79], v[36:39], v[188:191], v[76:79]
    buffer_store_dwordx2 v[254:255], v11, s[12:15], s38 offen offset:1152 sc1
    v_mfma_f32_16x16x32_bf16 v[80:83], v[40:43], v[160:163], 0
    v_cvt_pk_bf16_f32 v128, v64, v68
    v_cvt_pk_bf16_f32 v130, v65, v69
    v_mfma_f32_16x16x32_bf16 v[84:87], v[40:43], v[168:171], 0
    v_cvt_pk_bf16_f32 v132, v66, v70
    v_cvt_pk_bf16_f32 v134, v67, v71
    v_mfma_f32_16x16x32_bf16 v[88:91], v[40:43], v[176:179], 0
    v_cvt_pk_bf16_f32 v129, v72, v76
    v_cvt_pk_bf16_f32 v131, v73, v77
    v_mfma_f32_16x16x32_bf16 v[92:95], v[40:43], v[184:187], 0
    buffer_store_dwordx2 v[128:129], v11, s[12:15], s32 offen offset:128 sc1
    v_mfma_f32_16x16x32_bf16 v[80:83], v[44:47], v[164:167], v[80:83]
    buffer_store_dwordx2 v[130:131], v11, s[12:15], s32 offen offset:512 sc1
    v_mfma_f32_16x16x32_bf16 v[84:87], v[44:47], v[172:175], v[84:87]
    v_cvt_pk_bf16_f32 v133, v74, v78
    v_cvt_pk_bf16_f32 v135, v75, v79
    v_mfma_f32_16x16x32_bf16 v[88:91], v[44:47], v[180:183], v[88:91]
    buffer_store_dwordx2 v[132:133], v11, s[12:15], s32 offen offset:896 sc1
    v_mfma_f32_16x16x32_bf16 v[92:95], v[44:47], v[188:191], v[92:95]
    buffer_store_dwordx2 v[134:135], v11, s[12:15], s32 offen offset:1280 sc1
    v_mfma_f32_16x16x32_bf16 v[96:99], v[48:51], v[160:163], 0
    v_cvt_pk_bf16_f32 v136, v80, v84
    v_cvt_pk_bf16_f32 v138, v81, v85
    v_mfma_f32_16x16x32_bf16 v[100:103], v[48:51], v[168:171], 0
    v_cvt_pk_bf16_f32 v140, v82, v86
    v_cvt_pk_bf16_f32 v142, v83, v87
    v_mfma_f32_16x16x32_bf16 v[104:107], v[48:51], v[176:179], 0
    v_cvt_pk_bf16_f32 v137, v88, v92
    v_cvt_pk_bf16_f32 v139, v89, v93
    v_mfma_f32_16x16x32_bf16 v[108:111], v[48:51], v[184:187], 0
    buffer_store_dwordx2 v[136:137], v11, s[12:15], s34 offen offset:128 sc1
    v_mfma_f32_16x16x32_bf16 v[96:99], v[52:55], v[164:167], v[96:99]
    buffer_store_dwordx2 v[138:139], v11, s[12:15], s34 offen offset:512 sc1
    v_mfma_f32_16x16x32_bf16 v[100:103], v[52:55], v[172:175], v[100:103]
    v_cvt_pk_bf16_f32 v141, v90, v94
    v_cvt_pk_bf16_f32 v143, v91, v95
    v_mfma_f32_16x16x32_bf16 v[104:107], v[52:55], v[180:183], v[104:107]
    buffer_store_dwordx2 v[140:141], v11, s[12:15], s34 offen offset:896 sc1
    v_mfma_f32_16x16x32_bf16 v[108:111], v[52:55], v[188:191], v[108:111]
    buffer_store_dwordx2 v[142:143], v11, s[12:15], s34 offen offset:1280 sc1
    v_mfma_f32_16x16x32_bf16 v[112:115], v[56:59], v[160:163], 0
    v_cvt_pk_bf16_f32 v144, v96, v100
    v_cvt_pk_bf16_f32 v146, v97, v101
    v_mfma_f32_16x16x32_bf16 v[116:119], v[56:59], v[168:171], 0
    v_cvt_pk_bf16_f32 v148, v98, v102
    v_cvt_pk_bf16_f32 v150, v99, v103
    v_mfma_f32_16x16x32_bf16 v[120:123], v[56:59], v[176:179], 0
    v_cvt_pk_bf16_f32 v145, v104, v108
    v_cvt_pk_bf16_f32 v147, v105, v109
    v_mfma_f32_16x16x32_bf16 v[124:127], v[56:59], v[184:187], 0
    buffer_store_dwordx2 v[144:145], v11, s[12:15], s36 offen offset:128 sc1
    v_mfma_f32_16x16x32_bf16 v[112:115], v[60:63], v[164:167], v[112:115]
    buffer_store_dwordx2 v[146:147], v11, s[12:15], s36 offen offset:512 sc1
    v_mfma_f32_16x16x32_bf16 v[116:119], v[60:63], v[172:175], v[116:119]
    v_cvt_pk_bf16_f32 v149, v106, v110
    v_cvt_pk_bf16_f32 v151, v107, v111
    v_mfma_f32_16x16x32_bf16 v[120:123], v[60:63], v[180:183], v[120:123]
    buffer_store_dwordx2 v[148:149], v11, s[12:15], s36 offen offset:896 sc1
    v_mfma_f32_16x16x32_bf16 v[124:127], v[60:63], v[188:191], v[124:127]
    buffer_store_dwordx2 v[150:151], v11, s[12:15], s36 offen offset:1280 sc1
    v_mfma_f32_16x16x32_bf16 v[64:67], v[32:35], v[192:195], 0
    v_cvt_pk_bf16_f32 v152, v112, v116
    v_cvt_pk_bf16_f32 v154, v113, v117
    v_mfma_f32_16x16x32_bf16 v[68:71], v[32:35], v[200:203], 0
    v_cvt_pk_bf16_f32 v156, v114, v118
    v_cvt_pk_bf16_f32 v158, v115, v119
    v_mfma_f32_16x16x32_bf16 v[72:75], v[32:35], v[208:211], 0
    v_cvt_pk_bf16_f32 v153, v120, v124
    v_cvt_pk_bf16_f32 v155, v121, v125
    v_mfma_f32_16x16x32_bf16 v[76:79], v[32:35], v[216:219], 0
    buffer_store_dwordx2 v[152:153], v11, s[12:15], s38 offen offset:128 sc1
    v_mfma_f32_16x16x32_bf16 v[64:67], v[36:39], v[196:199], v[64:67]
    buffer_store_dwordx2 v[154:155], v11, s[12:15], s38 offen offset:512 sc1
    v_mfma_f32_16x16x32_bf16 v[68:71], v[36:39], v[204:207], v[68:71]
    v_cvt_pk_bf16_f32 v157, v122, v126
    v_cvt_pk_bf16_f32 v159, v123, v127
    v_mfma_f32_16x16x32_bf16 v[72:75], v[36:39], v[212:215], v[72:75]
    buffer_store_dwordx2 v[156:157], v11, s[12:15], s38 offen offset:896 sc1
    v_mfma_f32_16x16x32_bf16 v[76:79], v[36:39], v[220:223], v[76:79]
    buffer_store_dwordx2 v[158:159], v11, s[12:15], s38 offen offset:1280 sc1
    v_mfma_f32_16x16x32_bf16 v[80:83], v[40:43], v[192:195], 0
    v_cvt_pk_bf16_f32 v160, v64, v68
    v_cvt_pk_bf16_f32 v162, v65, v69
    v_mfma_f32_16x16x32_bf16 v[84:87], v[40:43], v[200:203], 0
    v_cvt_pk_bf16_f32 v164, v66, v70
    v_cvt_pk_bf16_f32 v166, v67, v71
    v_mfma_f32_16x16x32_bf16 v[88:91], v[40:43], v[208:211], 0
    v_cvt_pk_bf16_f32 v161, v72, v76
    v_cvt_pk_bf16_f32 v163, v73, v77
    v_mfma_f32_16x16x32_bf16 v[92:95], v[40:43], v[216:219], 0
    buffer_store_dwordx2 v[160:161], v11, s[12:15], s32 offen offset:256 sc1
    v_mfma_f32_16x16x32_bf16 v[80:83], v[44:47], v[196:199], v[80:83]
    buffer_store_dwordx2 v[162:163], v11, s[12:15], s32 offen offset:640 sc1
    v_mfma_f32_16x16x32_bf16 v[84:87], v[44:47], v[204:207], v[84:87]
    v_cvt_pk_bf16_f32 v165, v74, v78
    v_cvt_pk_bf16_f32 v167, v75, v79
    v_mfma_f32_16x16x32_bf16 v[88:91], v[44:47], v[212:215], v[88:91]
    buffer_store_dwordx2 v[164:165], v11, s[12:15], s32 offen offset:1024 sc1
    v_mfma_f32_16x16x32_bf16 v[92:95], v[44:47], v[220:223], v[92:95]
    buffer_store_dwordx2 v[166:167], v11, s[12:15], s32 offen offset:1408 sc1
    v_mfma_f32_16x16x32_bf16 v[96:99], v[48:51], v[192:195], 0
    v_cvt_pk_bf16_f32 v168, v80, v84
    v_cvt_pk_bf16_f32 v170, v81, v85
    v_mfma_f32_16x16x32_bf16 v[100:103], v[48:51], v[200:203], 0
    v_cvt_pk_bf16_f32 v172, v82, v86
    v_cvt_pk_bf16_f32 v174, v83, v87
    v_mfma_f32_16x16x32_bf16 v[104:107], v[48:51], v[208:211], 0
    v_cvt_pk_bf16_f32 v169, v88, v92
    v_cvt_pk_bf16_f32 v171, v89, v93
    v_mfma_f32_16x16x32_bf16 v[108:111], v[48:51], v[216:219], 0
    buffer_store_dwordx2 v[168:169], v11, s[12:15], s34 offen offset:256 sc1
    v_mfma_f32_16x16x32_bf16 v[96:99], v[52:55], v[196:199], v[96:99]
    buffer_store_dwordx2 v[170:171], v11, s[12:15], s34 offen offset:640 sc1
    v_mfma_f32_16x16x32_bf16 v[100:103], v[52:55], v[204:207], v[100:103]
    v_cvt_pk_bf16_f32 v173, v90, v94
    v_cvt_pk_bf16_f32 v175, v91, v95
    v_mfma_f32_16x16x32_bf16 v[104:107], v[52:55], v[212:215], v[104:107]
    buffer_store_dwordx2 v[172:173], v11, s[12:15], s34 offen offset:1024 sc1
    v_mfma_f32_16x16x32_bf16 v[108:111], v[52:55], v[220:223], v[108:111]
    buffer_store_dwordx2 v[174:175], v11, s[12:15], s34 offen offset:1408 sc1
    v_mfma_f32_16x16x32_bf16 v[112:115], v[56:59], v[192:195], 0
    v_cvt_pk_bf16_f32 v176, v96, v100
    v_cvt_pk_bf16_f32 v178, v97, v101
    v_mfma_f32_16x16x32_bf16 v[116:119], v[56:59], v[200:203], 0
    v_cvt_pk_bf16_f32 v180, v98, v102
    v_cvt_pk_bf16_f32 v182, v99, v103
    v_mfma_f32_16x16x32_bf16 v[120:123], v[56:59], v[208:211], 0
    v_cvt_pk_bf16_f32 v177, v104, v108
    v_cvt_pk_bf16_f32 v179, v105, v109
    v_mfma_f32_16x16x32_bf16 v[124:127], v[56:59], v[216:219], 0
    buffer_store_dwordx2 v[176:177], v11, s[12:15], s36 offen offset:256 sc1
    v_mfma_f32_16x16x32_bf16 v[112:115], v[60:63], v[196:199], v[112:115]
    buffer_store_dwordx2 v[178:179], v11, s[12:15], s36 offen offset:640 sc1
    v_mfma_f32_16x16x32_bf16 v[116:119], v[60:63], v[204:207], v[116:119]
    v_cvt_pk_bf16_f32 v181, v106, v110
    v_cvt_pk_bf16_f32 v183, v107, v111
    v_mfma_f32_16x16x32_bf16 v[120:123], v[60:63], v[212:215], v[120:123]
    buffer_store_dwordx2 v[180:181], v11, s[12:15], s36 offen offset:1024 sc1
    v_mfma_f32_16x16x32_bf16 v[124:127], v[60:63], v[220:223], v[124:127]
    buffer_store_dwordx2 v[182:183], v11, s[12:15], s36 offen offset:1408 sc1
    s_nop 0
    v_cvt_pk_bf16_f32 v184, v112, v116
    s_nop 4
    v_cvt_pk_bf16_f32 v185, v120, v124
    v_cvt_pk_bf16_f32 v186, v113, v117
    v_cvt_pk_bf16_f32 v187, v121, v125
    v_cvt_pk_bf16_f32 v188, v114, v118
    v_cvt_pk_bf16_f32 v189, v122, v126
    v_cvt_pk_bf16_f32 v190, v115, v119
    v_cvt_pk_bf16_f32 v191, v123, v127
    buffer_store_dwordx2 v[184:185], v11, s[12:15], s38 offen offset:256 sc1
    buffer_store_dwordx2 v[186:187], v11, s[12:15], s38 offen offset:640 sc1
    buffer_store_dwordx2 v[188:189], v11, s[12:15], s38 offen offset:1024 sc1
    buffer_store_dwordx2 v[190:191], v11, s[12:15], s38 offen offset:1408 sc1
L_end:
    s_endpgm
L_slow0:
    s_sub_u32 s43, s43, 1
    s_cbranch_scc1 L_end
    ds_read_b32 v30, v29
    s_waitcnt lgkmcnt(0)
    v_readfirstlane_b32 s41, v30
    s_nop 1
    s_bitcmp1_b32 s41, 0
    s_cbranch_scc0 L_slow0
    s_branch L_ok0
L_slow1:
    s_sub_u32 s43, s43, 1
    s_cbranch_scc1 L_end
    ds_read_b32 v30, v29
    s_waitcnt lgkmcnt(0)
    v_readfirstlane_b32 s41, v30
    s_nop 1
    s_bitcmp1_b32 s41, 1
    s_cbranch_scc0 L_slow1
    s_branch L_ok1
L_slow2:
    s_sub_u32 s43, s43, 1
    s_cbranch_scc1 L_end
    ds_read_b32 v30, v29
    s_waitcnt lgkmcnt(0)
    v_readfirstlane_b32 s41, v30
    s_nop 1
    s_bitcmp1_b32 s41, 2
    s_cbranch_scc0 L_slow2
    s_branch L_ok2
L_slow3:
    s_sub_u32 s43, s43, 1
    s_cbranch_scc1 L_end
    ds_read_b32 v30, v29
    s_waitcnt lgkmcnt(0)
    v_readfirstlane_b32 s41, v30
    s_nop 1
    s_bitcmp1_b32 s41, 3
    s_cbranch_scc0 L_slow3
    s_branch L_ok3
L_slow4:
    s_sub_u32 s43, s43, 1
    s_cbranch_scc1 L_end
    ds_read_b32 v30, v29
    s_waitcnt lgkmcnt(0)
    v_readfirstlane_b32 s41, v30
    s_nop 1
    s_bitcmp1_b32 s41, 4
    s_cbranch_scc0 L_slow4
    s_branch L_ok4
L_slow5:
    s_sub_u32 s43, s43, 1
    s_cbranch_scc1 L_end
    ds_read_b32 v30, v29
    s_waitcnt lgkmcnt(0)
    v_readfirstlane_b32 s41, v30
    s_nop 1
    s_bitcmp1_b32 s41, 5
    s_cbranch_scc0 L_slow5
    s_branch L_ok5
L_slow6:
    s_sub_u32 s43, s43, 1
    s_cbranch_scc1 L_end
    ds_read_b32 v30, v29
    s_waitcnt lgkmcnt(0)
    v_readfirstlane_b32 s41, v30
    s_nop 1
    s_bitcmp1_b32 s41, 6
    s_cbranch_scc0 L_slow6
    s_branch L_ok6
L_fb:
    s_mov_b32 s60, 0
    s_cmp_lt_u32 s2, 192
    s_cbranch_scc0 L_fb_task
L_fbw:
    s_sub_u32 s43, s43, 1
    s_cbranch_scc1 L_end
    ds_read_b32 v34, v29 offset:4
    s_waitcnt lgkmcnt(0)
    v_readfirstlane_b32 s61, v34
    s_nop 1
    s_cmp_eq_u32 s61, 3
    s_cbranch_scc0 L_fbw
L_fb_task:
    s_mov_b32 s63, 3
    s_branch L_raw
L_fb_raw:
    s_bitcmp1_b32 s63, 1
    s_mov_b32 s63, 1
    s_cbranch_scc1 L_raw
    s_branch L_prod
L_fb_next:
    s_add_u32 s60, s60, 1
    s_cmp_lt_u32 s60, 72
    s_cbranch_scc1 L_fb_task
    s_branch L_go
L_code_end:
.section .rodata,"a"
.p2align 6
.amdhsa_kernel standalone__swin_window_attn__vision_kernel
  .amdhsa_next_free_vgpr 512
  .amdhsa_next_free_sgpr 102
  .amdhsa_accum_offset 256
  .amdhsa_group_segment_fixed_size 0
  .amdhsa_kernarg_size 48
  .amdhsa_user_sgpr_count 2
  .amdhsa_user_sgpr_kernarg_segment_ptr 1
  .amdhsa_system_sgpr_workgroup_id_x 1
.end_amdhsa_kernel
```

```asm
; @launch grid=(256,1,1) block=(256,1,1) lds=163840
.amdgcn_target "amdgcn-amd-amdhsa--gfx950"
.text
.globl standalone__swin_window_attn__vision_kernel
.p2align 8
.type standalone__swin_window_attn__vision_kernel,@function
standalone__swin_window_attn__vision_kernel:
    s_cmp_ge_u32 s2, 256
    s_cbranch_scc1 L_end
    s_load_dwordx4 s[4:7], s[0:1], 0
    s_load_dwordx4 s[20:23], s[0:1], 16
    s_load_dwordx4 s[56:59], s[0:1], 32
    v_lshrrev_b32 v16, 6, v0
    v_and_b32 v0, 63, v0
    s_getpc_b64 s[44:45]
L_pc_ref:
    v_readfirstlane_b32 s49, v16
    s_mov_b32 s46, L_code_end-L_pc_ref
    s_mov_b32 s47, 0x00020000
    v_lshlrev_b32 v7, 6, v0
    s_lshr_b32 s60, s2, 3
    s_and_b32 s42, s60, 3
    s_lshl_b32 s42, s42, 2
    s_add_u32 s42, s42, s49
    s_lshl_b32 s42, s42, 12
    buffer_load_dword v8, v7, s[44:47], s42 offen
    s_cmp_lt_u32 s60, 24
    s_cbranch_scc0 L_setup
    s_cmp_ge_u32 s60, 12
    s_cselect_b32 s61, 12, 0
    s_cselect_b32 s62, 36, 0
    s_sub_u32 s61, s60, s61
    s_and_b32 s64, s61, 1
    s_mul_i32 s64, s64, 3
    s_max_u32 s65, s49, 1
    s_add_u32 s64, s64, s65
    s_sub_u32 s64, s64, 1
    s_mul_i32 s64, s64, 6
    s_lshr_b32 s61, s61, 1
    s_add_u32 s60, s64, s61
    s_add_u32 s60, s60, s62
    s_cmp_eq_u32 s49, 0
    s_cselect_b32 s63, 2, 0
L_raw:
    s_cmp_ge_u32 s60, 36
    s_cselect_b32 s65, 36, 0
    s_cselect_b32 s97, 768, 0
    s_sub_u32 s65, s60, s65
    s_mul_i32 s66, s65, 43
    s_lshr_b32 s66, s66, 8
    s_mul_i32 s67, s66, 6
    s_sub_u32 s67, s65, s67
    s_max_u32 s64, s49, 1
    s_mul_i32 s64, s64, 12288
    s_mul_i32 s61, s66, 36864
    s_add_u32 s61, s61, 384
    s_mul_i32 s62, s67, 36864
    s_add_u32 s62, s62, s97
    s_bitcmp1_b32 s63, 1
    s_cselect_b32 s61, s62, s61
    s_cselect_b32 s64, 0, s64
    s_cselect_b32 s97, 0, s97
    s_movk_i32 s62, 128
    s_movk_i32 s65, 9216
    s_mov_b32 s96, 32
    v_lshrrev_b32 v16, 3, v0
    v_and_b32 v17, 7, v0
    v_bfe_u32 v18, v0, 4, 1
    v_xor_b32 v17, v17, v18
    v_lshlrev_b32 v17, 4, v17
    v_mul_u32_u24 v16, 1152, v16
    s_cmp_eq_u32 s97, 0
    s_mov_b32 s18, 221184
    s_cbranch_scc1 L_raw_rows
    s_mov_b32 s18, 73728
    s_lshl_b32 s61, s66, 6
    s_movk_i32 s62, 6144
    s_movk_i32 s65, 18432
    s_mov_b32 s96, 0
    v_lshrrev_b32 v16, 2, v0
    v_mul_u32_u24 v16, 384, v16
    v_and_b32 v17, 3, v0
    v_lshlrev_b32 v17, 4, v17
L_raw_rows:
    s_waitcnt lgkmcnt(0)
    s_cmp_eq_u32 s97, 0
    s_cselect_b32 s16, s6, s20
    s_cselect_b32 s17, s7, s21
    s_mov_b32 s19, 0x00020000
    s_mov_b32 m0, s64
    s_mov_b32 s97, 4
L_raw_lp:
    v_add_u32 v18, v16, v17
    s_add_u32 s42, s61, s62
    buffer_load_dwordx4 v18, s[16:19], s61 offen lds
    s_add_u32 m0, m0, 1024
    s_add_u32 s41, s42, s62
    buffer_load_dwordx4 v18, s[16:19], s42 offen lds
    s_add_u32 m0, m0, 1024
    s_add_u32 s61, s61, s65
    buffer_load_dwordx4 v18, s[16:19], s41 offen lds
    s_add_u32 m0, m0, 1024
    s_and_b32 s42, s97, 1
    s_mul_i32 s42, s42, s96
    s_lshl_b32 s42, s42, 1
    s_add_u32 s42, s42, s96
    v_xor_b32 v17, s42, v17
    s_sub_u32 s97, s97, 1
    s_cmp_lg_u32 s97, 0
    s_cbranch_scc1 L_raw_lp
    s_bitcmp1_b32 s63, 0
    s_cbranch_scc1 L_fb_raw
L_setup:
    s_mov_b32 s43, 0x400000
    v_lshlrev_b32 v1, 4, v0
    v_add_u32 v2, 0x10000, v1
    v_add_u32 v3, 0x20000, v1
    v_lshrrev_b32 v16, 3, v0
    v_and_b32 v17, 7, v0
    v_lshrrev_b32 v18, 4, v0
    v_xor_b32 v17, v17, v18
    v_lshlrev_b32 v17, 4, v17
    v_mul_u32_u24 v16, 384, v16
    v_add_u32 v9, v16, v17
    v_xor_b32 v10, 64, v9
    v_add_u32 v10, 196608, v10
    s_lshl_b32 s52, s49, 11
    s_add_u32 s52, s52, 147456
    v_lshlrev_b32 v16, 3, v0
    v_add_u32 v4, s52, v16
    v_and_b32 v16, 15, v0
    v_lshrrev_b32 v17, 4, v0
    v_lshrrev_b32 v18, 1, v16
    v_xor_b32 v18, v18, v17
    v_lshlrev_b32 v18, 3, v18
    v_lshl_add_u32 v18, v16, 6, v18
    v_add_u32 v5, s52, v18
    v_xor_b32 v6, 32, v5
    v_lshrrev_b32 v16, 5, v0
    v_mul_u32_u24 v16, 196608, v16
    v_lshrrev_b32 v17, 4, v0
    v_and_b32 v17, 1, v17
    v_mul_u32_u24 v17, 1536, v17
    v_and_b32 v18, 15, v0
    v_lshlrev_b32 v18, 3, v18
    v_add3_u32 v11, v16, v17, v18
    s_nop 0
    s_and_b32 s53, s2, 7
    s_lshl_b32 s53, s53, 3
    s_lshr_b32 s54, s2, 7
    s_add_u32 s53, s53, s54
    s_lshr_b32 s54, s2, 3
    s_and_b32 s54, s54, 15
    s_mul_i32 s53, s53, 1572864
    s_lshl_b32 s54, s54, 2
    s_add_u32 s54, s54, s49
    s_mul_i32 s54, s54, 3072
    s_add_u32 s53, s53, s54
    s_add_u32 s24, s53, 0
    s_add_u32 s26, s53, 393216
    s_add_u32 s28, s53, 786432
    s_add_u32 s30, s53, 1179648
    v_mov_b32 v29, 155648
    v_mov_b32 v30, 0
    v_mov_b32 v31, 0
    ds_write_b64 v29, v[30:31]
    s_getreg_b32 s48, hwreg(HW_REG_XCC_ID, 0, 3)
    s_waitcnt lgkmcnt(0)
    s_mov_b32 s8, s4
    s_mov_b32 s9, s5
    s_mov_b32 s10, 100663296
    s_mov_b32 s11, 0x00020000
    s_barrier
    s_cmp_eq_u32 s49, 0
    s_cbranch_scc0 L_nox0
    buffer_load_dwordx4 a[0:3], v9, s[8:11], s24 offen offset:0 nt
    buffer_load_dwordx4 a[4:7], v10, s[8:11], s24 offen offset:0 nt
    buffer_load_dwordx4 a[8:11], v9, s[8:11], s24 offen offset:128 nt
    buffer_load_dwordx4 a[12:15], v10, s[8:11], s24 offen offset:128 nt
    buffer_load_dwordx4 a[16:19], v9, s[8:11], s24 offen offset:256 nt
    buffer_load_dwordx4 a[20:23], v10, s[8:11], s24 offen offset:256 nt
    buffer_load_dwordx4 a[24:27], v9, s[8:11], s26 offen offset:0 nt
    buffer_load_dwordx4 a[28:31], v10, s[8:11], s26 offen offset:0 nt
    buffer_load_dwordx4 a[32:35], v9, s[8:11], s26 offen offset:128 nt
    buffer_load_dwordx4 a[36:39], v10, s[8:11], s26 offen offset:128 nt
    buffer_load_dwordx4 a[40:43], v9, s[8:11], s26 offen offset:256 nt
    buffer_load_dwordx4 a[44:47], v10, s[8:11], s26 offen offset:256 nt
    buffer_load_dwordx4 a[48:51], v9, s[8:11], s28 offen offset:0 nt
    buffer_load_dwordx4 a[52:55], v10, s[8:11], s28 offen offset:0 nt
    buffer_load_dwordx4 a[56:59], v9, s[8:11], s28 offen offset:128 nt
    buffer_load_dwordx4 a[60:63], v10, s[8:11], s28 offen offset:128 nt
    buffer_load_dwordx4 a[64:67], v9, s[8:11], s28 offen offset:256 nt
    buffer_load_dwordx4 a[68:71], v10, s[8:11], s28 offen offset:256 nt
    buffer_load_dwordx4 a[72:75], v9, s[8:11], s30 offen offset:0 nt
    buffer_load_dwordx4 a[76:79], v10, s[8:11], s30 offen offset:0 nt
    buffer_load_dwordx4 a[80:83], v9, s[8:11], s30 offen offset:128 nt
    buffer_load_dwordx4 a[84:87], v10, s[8:11], s30 offen offset:128 nt
    buffer_load_dwordx4 a[88:91], v9, s[8:11], s30 offen offset:256 nt
    buffer_load_dwordx4 a[92:95], v10, s[8:11], s30 offen offset:256 nt
L_nox0:
    s_mov_b32 s3, s53
    s_mov_b32 s12, s22
    s_mov_b32 s13, s23
    s_mov_b32 s14, 100663296
    s_mov_b32 s15, 0x00020000
    s_mov_b32 s40, 0x3dd53b95
    s_mov_b32 s50, s58
    s_mov_b32 s51, s59
    s_mov_b32 s58, 256
    s_mov_b32 s59, 0x00020000
    s_mul_i32 s52, s48, 147456
    s_add_u32 s52, s50, s52
    s_addc_u32 s53, s51, 0
    s_mov_b32 s54, 147456
    s_mov_b32 s55, 0x00020000
    s_lshl_b32 s48, s48, 5
    s_lshl_b32 s42, 4096, s49
    v_mov_b32 v31, s42
    s_cmp_eq_u32 s49, 0
    s_cbranch_scc1 L_w0
    s_cmp_lt_u32 s2, 192
    s_cbranch_scc0 L_noprod
L_prod:
    s_mul_i32 s61, s66, 12
    s_add_u32 s61, s61, s67
    s_lshl_b32 s61, s61, 10
    s_add_u32 s62, s61, 6144
    v_mov_b32 v27, v1
    v_bfe_u32 v22, v0, 2, 2
    v_and_b32 v23, 3, v0
    v_lshrrev_b32 v26, 4, v0
    s_cmp_ge_u32 s60, 36
    s_cbranch_scc0 L_prod_A
    v_mul_u32_u24 v27, 6144, v23
    v_lshlrev_b32 v24, 8, v26
    v_lshlrev_b32 v25, 4, v22
    v_add3_u32 v27, v27, v24, v25
    s_lshr_b32 s61, s66, 1
    s_mul_i32 s61, s61, 24576
    s_and_b32 s62, s66, 1
    s_lshl_b32 s62, s62, 7
    s_add_u32 s61, s61, s62
    s_lshl_b32 s62, s67, 10
    s_add_u32 s61, s61, s62
    s_add_u32 s61, s61, 73728
    s_add_u32 s62, s61, 64
L_prod_A:
    v_mul_u32_u24 v24, 3072, v22
    v_lshl_add_u32 v24, v23, 7, v24
    v_bfe_u32 v25, v0, 1, 1
    v_lshl_add_u32 v25, v22, 1, v25
    v_xor_b32 v25, v25, v26
    v_lshl_add_u32 v24, v25, 4, v24
    v_xor_b32 v25, 64, v24
    v_lshl_add_u32 v26, v26, 3, v22
    v_lshlrev_b32 v26, 6, v26
    v_lshl_add_u32 v26, v23, 3, v26
    v_add_u32 v26, s64, v26
    s_waitcnt vmcnt(0)
    s_bitcmp1_b32 s63, 0
    s_cbranch_scc1 L_gotA
L_wA:
    s_sub_u32 s43, s43, 1
    s_cbranch_scc1 L_end
    ds_read_b32 v30, v29
    s_waitcnt lgkmcnt(0)
    v_readfirstlane_b32 s41, v30
    s_nop 1
    s_and_b32 s42, s41, 0x100000
    s_cmp_eq_u32 s42, 0x100000
    s_cbranch_scc0 L_wA
L_gotA:
    ds_read_b128 v[32:35], v24 offset:0
    ds_read_b128 v[56:59], v24 offset:512
    ds_read_b128 v[36:39], v25 offset:0
    ds_read_b128 v[60:63], v25 offset:512
    ds_read_b128 v[40:43], v24 offset:1024
    ds_read_b128 v[64:67], v24 offset:1536
    ds_read_b128 v[44:47], v25 offset:1024
    ds_read_b128 v[68:71], v25 offset:1536
    ds_read_b128 v[48:51], v24 offset:2048
    ds_read_b128 v[72:75], v24 offset:2560
    ds_read_b128 v[52:55], v25 offset:2048
    ds_read_b128 v[76:79], v25 offset:2560
    s_cmp_ge_u32 s60, 36
    s_cbranch_scc1 L_prod_N2
    v_add_u32 v24, s64, v24
    v_add_u32 v25, s64, v25
    ds_read_b128 v[80:83], v24 offset:0
    ds_read_b128 v[104:107], v24 offset:512
    ds_read_b128 v[84:87], v25 offset:0
    ds_read_b128 v[108:111], v25 offset:512
    ds_read_b128 v[88:91], v24 offset:1024
    ds_read_b128 v[112:115], v24 offset:1536
    ds_read_b128 v[92:95], v25 offset:1024
    ds_read_b128 v[116:119], v25 offset:1536
    ds_read_b128 v[96:99], v24 offset:2048
    ds_read_b128 v[120:123], v24 offset:2560
    ds_read_b128 v[100:103], v25 offset:2048
    ds_read_b128 v[124:127], v25 offset:2560
    s_branch L_prod_mm
L_prod_N2:
    ds_read_b64_tr_b16 v[80:81], v26 offset:0
    ds_read_b64_tr_b16 v[82:83], v26 offset:256
    ds_read_b64_tr_b16 v[104:105], v26 offset:32
    ds_read_b64_tr_b16 v[106:107], v26 offset:288
    ds_read_b64_tr_b16 v[84:85], v26 offset:2048
    ds_read_b64_tr_b16 v[86:87], v26 offset:2304
    ds_read_b64_tr_b16 v[108:109], v26 offset:2080
    ds_read_b64_tr_b16 v[110:111], v26 offset:2336
    ds_read_b64_tr_b16 v[88:89], v26 offset:4096
    ds_read_b64_tr_b16 v[90:91], v26 offset:4352
    ds_read_b64_tr_b16 v[112:113], v26 offset:4128
    ds_read_b64_tr_b16 v[114:115], v26 offset:4384
    ds_read_b64_tr_b16 v[92:93], v26 offset:6144
    ds_read_b64_tr_b16 v[94:95], v26 offset:6400
    ds_read_b64_tr_b16 v[116:117], v26 offset:6176
    ds_read_b64_tr_b16 v[118:119], v26 offset:6432
    ds_read_b64_tr_b16 v[96:97], v26 offset:8192
    ds_read_b64_tr_b16 v[98:99], v26 offset:8448
    ds_read_b64_tr_b16 v[120:121], v26 offset:8224
    ds_read_b64_tr_b16 v[122:123], v26 offset:8480
    ds_read_b64_tr_b16 v[100:101], v26 offset:10240
    ds_read_b64_tr_b16 v[102:103], v26 offset:10496
    ds_read_b64_tr_b16 v[124:125], v26 offset:10272
    ds_read_b64_tr_b16 v[126:127], v26 offset:10528
L_prod_mm:
    s_cmp_ge_u32 s60, 36
    s_cselect_b32 s65, 1.0, s40
    s_waitcnt lgkmcnt(0)
    v_mfma_f32_16x16x32_bf16 v[128:131], v[32:35], v[80:83], 0
    v_mfma_f32_16x16x32_bf16 v[132:135], v[56:59], v[80:83], 0
    v_mfma_f32_16x16x32_bf16 v[128:131], v[36:39], v[84:87], v[128:131]
    v_mfma_f32_16x16x32_bf16 v[132:135], v[60:63], v[84:87], v[132:135]
    v_mfma_f32_16x16x32_bf16 v[128:131], v[40:43], v[88:91], v[128:131]
    v_mfma_f32_16x16x32_bf16 v[132:135], v[64:67], v[88:91], v[132:135]
    v_mfma_f32_16x16x32_bf16 v[128:131], v[44:47], v[92:95], v[128:131]
    v_mfma_f32_16x16x32_bf16 v[132:135], v[68:71], v[92:95], v[132:135]
    v_mfma_f32_16x16x32_bf16 v[128:131], v[48:51], v[96:99], v[128:131]
    v_mfma_f32_16x16x32_bf16 v[132:135], v[72:75], v[96:99], v[132:135]
    v_mfma_f32_16x16x32_bf16 v[128:131], v[52:55], v[100:103], v[128:131]
    v_mfma_f32_16x16x32_bf16 v[132:135], v[76:79], v[100:103], v[132:135]
    v_mfma_f32_16x16x32_bf16 v[136:139], v[32:35], v[104:107], 0
    v_mfma_f32_16x16x32_bf16 v[140:143], v[56:59], v[104:107], 0
    v_mfma_f32_16x16x32_bf16 v[136:139], v[36:39], v[108:111], v[136:139]
    v_mfma_f32_16x16x32_bf16 v[140:143], v[60:63], v[108:111], v[140:143]
    v_mfma_f32_16x16x32_bf16 v[136:139], v[40:43], v[112:115], v[136:139]
    v_mfma_f32_16x16x32_bf16 v[140:143], v[64:67], v[112:115], v[140:143]
    v_mfma_f32_16x16x32_bf16 v[136:139], v[44:47], v[116:119], v[136:139]
    v_mfma_f32_16x16x32_bf16 v[140:143], v[68:71], v[116:119], v[140:143]
    v_mfma_f32_16x16x32_bf16 v[136:139], v[48:51], v[120:123], v[136:139]
    v_mfma_f32_16x16x32_bf16 v[140:143], v[72:75], v[120:123], v[140:143]
    v_mfma_f32_16x16x32_bf16 v[136:139], v[52:55], v[124:127], v[136:139]
    v_mfma_f32_16x16x32_bf16 v[140:143], v[76:79], v[124:127], v[140:143]
    v_mul_f32 v128, s65, v128
    v_mul_f32 v129, s65, v129
    v_mul_f32 v130, s65, v130
    v_mul_f32 v131, s65, v131
    v_mul_f32 v132, s65, v132
    v_mul_f32 v133, s65, v133
    v_mul_f32 v134, s65, v134
    v_mul_f32 v135, s65, v135
    v_cvt_pk_bf16_f32 v144, v128, v129
    v_cvt_pk_bf16_f32 v145, v130, v131
    v_cvt_pk_bf16_f32 v146, v132, v133
    v_cvt_pk_bf16_f32 v147, v134, v135
    buffer_store_dwordx4 v[144:147], v27, s[52:55], s61 offen
    s_nop 7
    v_mul_f32 v136, s65, v136
    v_mul_f32 v137, s65, v137
    v_mul_f32 v138, s65, v138
    v_mul_f32 v139, s65, v139
    v_mul_f32 v140, s65, v140
    v_mul_f32 v141, s65, v141
    v_mul_f32 v142, s65, v142
    v_mul_f32 v143, s65, v143
    v_cvt_pk_bf16_f32 v148, v136, v137
    v_cvt_pk_bf16_f32 v149, v138, v139
    v_cvt_pk_bf16_f32 v150, v140, v141
    v_cvt_pk_bf16_f32 v151, v142, v143
    buffer_store_dwordx4 v[148:151], v27, s[52:55], s62 offen
    s_bitcmp1_b32 s63, 0
    s_cbranch_scc1 L_fb_next
    s_cmp_eq_u32 s49, 1
    s_cbranch_scc0 L_p23
    buffer_load_dwordx4 a[0:3], v9, s[8:11], s24 offen offset:0 nt
    buffer_load_dwordx4 a[4:7], v10, s[8:11], s24 offen offset:0 nt
    buffer_load_dwordx4 a[8:11], v9, s[8:11], s24 offen offset:128 nt
    buffer_load_dwordx4 a[12:15], v10, s[8:11], s24 offen offset:128 nt
    buffer_load_dwordx4 a[16:19], v9, s[8:11], s24 offen offset:256 nt
    buffer_load_dwordx4 a[20:23], v10, s[8:11], s24 offen offset:256 nt
    buffer_load_dwordx4 a[24:27], v9, s[8:11], s26 offen offset:0 nt
    buffer_load_dwordx4 a[28:31], v10, s[8:11], s26 offen offset:0 nt
    buffer_load_dwordx4 a[32:35], v9, s[8:11], s26 offen offset:128 nt
    buffer_load_dwordx4 a[36:39], v10, s[8:11], s26 offen offset:128 nt
    buffer_load_dwordx4 a[40:43], v9, s[8:11], s26 offen offset:256 nt
    buffer_load_dwordx4 a[44:47], v10, s[8:11], s26 offen offset:256 nt
    buffer_load_dwordx4 a[48:51], v9, s[8:11], s28 offen offset:0 nt
    buffer_load_dwordx4 a[52:55], v10, s[8:11], s28 offen offset:0 nt
    buffer_load_dwordx4 a[56:59], v9, s[8:11], s28 offen offset:128 nt
    buffer_load_dwordx4 a[60:63], v10, s[8:11], s28 offen offset:128 nt
    buffer_load_dwordx4 a[64:67], v9, s[8:11], s28 offen offset:256 nt
    buffer_load_dwordx4 a[68:71], v10, s[8:11], s28 offen offset:256 nt
    buffer_load_dwordx4 a[72:75], v9, s[8:11], s30 offen offset:0 nt
    buffer_load_dwordx4 a[76:79], v10, s[8:11], s30 offen offset:0 nt
    buffer_load_dwordx4 a[80:83], v9, s[8:11], s30 offen offset:128 nt
    buffer_load_dwordx4 a[84:87], v10, s[8:11], s30 offen offset:128 nt
    buffer_load_dwordx4 a[88:91], v9, s[8:11], s30 offen offset:256 nt
    buffer_load_dwordx4 a[92:95], v10, s[8:11], s30 offen offset:256 nt
    s_waitcnt vmcnt(24)
    v_mov_b32 v32, 1
    s_lshr_b32 s60, s2, 3
    s_add_u32 s60, s60, s48
    v_mov_b32 v33, s60
    s_mov_b64 exec, 1
    ds_add_rtn_u32 v34, v29, v32 offset:4
    s_waitcnt lgkmcnt(0)
    v_readfirstlane_b32 s61, v34
    s_nop 1
    s_cmp_eq_u32 s61, 2
    s_cbranch_scc0 L_nl1
    buffer_store_byte v32, v33, s[56:59], 0 offen
L_nl1:
    s_mov_b64 exec, -1
    s_waitcnt vmcnt(22)
    ds_write_b64 v4, a[0:1] offset:0
    ds_write_b64 v4, a[2:3] offset:1024
    ds_write_b64 v4, a[4:5] offset:512
    ds_write_b64 v4, a[6:7] offset:1536
    ds_read2_b64 a[0:3], v5 offset0:0 offset1:128
    ds_read2_b64 a[4:7], v6 offset0:0 offset1:128
    s_waitcnt vmcnt(20)
    ds_or_b32 v29, v31
    ds_write_b64 v4, a[8:9] offset:0
    ds_write_b64 v4, a[10:11] offset:1024
    ds_write_b64 v4, a[12:13] offset:512
    ds_write_b64 v4, a[14:15] offset:1536
    ds_read2_b64 a[8:11], v5 offset0:0 offset1:128
    ds_read2_b64 a[12:15], v6 offset0:0 offset1:128
    s_waitcnt vmcnt(18)
    ds_write_b64 v4, a[16:17] offset:0
    ds_write_b64 v4, a[18:19] offset:1024
    ds_write_b64 v4, a[20:21] offset:512
    ds_write_b64 v4, a[22:23] offset:1536
    ds_read2_b64 a[16:19], v5 offset0:0 offset1:128
    ds_read2_b64 a[20:23], v6 offset0:0 offset1:128
    s_waitcnt vmcnt(16)
    ds_write_b64 v4, a[24:25] offset:0
    ds_write_b64 v4, a[26:27] offset:1024
    ds_write_b64 v4, a[28:29] offset:512
    ds_write_b64 v4, a[30:31] offset:1536
    ds_read2_b64 a[24:27], v5 offset0:0 offset1:128
    ds_read2_b64 a[28:31], v6 offset0:0 offset1:128
    s_waitcnt vmcnt(14)
    ds_write_b64 v4, a[32:33] offset:0
    ds_write_b64 v4, a[34:35] offset:1024
    ds_write_b64 v4, a[36:37] offset:512
    ds_write_b64 v4, a[38:39] offset:1536
    ds_read2_b64 a[32:35], v5 offset0:0 offset1:128
    ds_read2_b64 a[36:39], v6 offset0:0 offset1:128
    s_waitcnt vmcnt(12)
    ds_write_b64 v4, a[40:41] offset:0
    ds_write_b64 v4, a[42:43] offset:1024
    ds_write_b64 v4, a[44:45] offset:512
    ds_write_b64 v4, a[46:47] offset:1536
    ds_read2_b64 a[40:43], v5 offset0:0 offset1:128
    ds_read2_b64 a[44:47], v6 offset0:0 offset1:128
    s_waitcnt vmcnt(10)
    ds_write_b64 v4, a[48:49] offset:0
    ds_write_b64 v4, a[50:51] offset:1024
    ds_write_b64 v4, a[52:53] offset:512
    ds_write_b64 v4, a[54:55] offset:1536
    ds_read2_b64 a[48:51], v5 offset0:0 offset1:128
    ds_read2_b64 a[52:55], v6 offset0:0 offset1:128
    s_waitcnt vmcnt(8)
    ds_write_b64 v4, a[56:57] offset:0
    ds_write_b64 v4, a[58:59] offset:1024
    ds_write_b64 v4, a[60:61] offset:512
    ds_write_b64 v4, a[62:63] offset:1536
    ds_read2_b64 a[56:59], v5 offset0:0 offset1:128
    ds_read2_b64 a[60:63], v6 offset0:0 offset1:128
    s_waitcnt vmcnt(6)
    ds_write_b64 v4, a[64:65] offset:0
    ds_write_b64 v4, a[66:67] offset:1024
    ds_write_b64 v4, a[68:69] offset:512
    ds_write_b64 v4, a[70:71] offset:1536
    ds_read2_b64 a[64:67], v5 offset0:0 offset1:128
    ds_read2_b64 a[68:71], v6 offset0:0 offset1:128
    s_waitcnt vmcnt(4)
    ds_write_b64 v4, a[72:73] offset:0
    ds_write_b64 v4, a[74:75] offset:1024
    ds_write_b64 v4, a[76:77] offset:512
    ds_write_b64 v4, a[78:79] offset:1536
    ds_read2_b64 a[72:75], v5 offset0:0 offset1:128
    ds_read2_b64 a[76:79], v6 offset0:0 offset1:128
    s_waitcnt vmcnt(2)
    ds_write_b64 v4, a[80:81] offset:0
    ds_write_b64 v4, a[82:83] offset:1024
    ds_write_b64 v4, a[84:85] offset:512
    ds_write_b64 v4, a[86:87] offset:1536
    ds_read2_b64 a[80:83], v5 offset0:0 offset1:128
    ds_read2_b64 a[84:87], v6 offset0:0 offset1:128
    s_waitcnt vmcnt(0)
    ds_write_b64 v4, a[88:89] offset:0
    ds_write_b64 v4, a[90:91] offset:1024
    ds_write_b64 v4, a[92:93] offset:512
    ds_write_b64 v4, a[94:95] offset:1536
    ds_read2_b64 a[88:91], v5 offset0:0 offset1:128
    ds_read2_b64 a[92:95], v6 offset0:0 offset1:128
    s_branch L_w1go
L_p23:
    s_waitcnt vmcnt(0)
    v_mov_b32 v32, 1
    s_lshr_b32 s60, s2, 3
    s_add_u32 s60, s60, s48
    v_mov_b32 v33, s60
    s_mov_b64 exec, 1
    ds_add_rtn_u32 v34, v29, v32 offset:4
    s_waitcnt lgkmcnt(0)
    v_readfirstlane_b32 s61, v34
    s_nop 1
    s_cmp_eq_u32 s61, 2
    s_cbranch_scc0 L_nl2
    buffer_store_byte v32, v33, s[56:59], 0 offen
L_nl2:
    s_mov_b64 exec, -1
L_noprod:
    s_lshl_b32 s60, 2048, s49
L_wpace:
    s_sub_u32 s43, s43, 1
    s_cbranch_scc1 L_end
    ds_read_b32 v30, v29
    s_waitcnt lgkmcnt(0)
    v_readfirstlane_b32 s41, v30
    s_nop 1
    s_and_b32 s42, s41, s60
    s_cmp_eq_u32 s42, s60
    s_cbranch_scc0 L_wpace
    buffer_load_dwordx4 a[0:3], v9, s[8:11], s24 offen offset:0 nt
    buffer_load_dwordx4 a[4:7], v10, s[8:11], s24 offen offset:0 nt
    buffer_load_dwordx4 a[8:11], v9, s[8:11], s24 offen offset:128 nt
    buffer_load_dwordx4 a[12:15], v10, s[8:11], s24 offen offset:128 nt
    buffer_load_dwordx4 a[16:19], v9, s[8:11], s24 offen offset:256 nt
    buffer_load_dwordx4 a[20:23], v10, s[8:11], s24 offen offset:256 nt
    buffer_load_dwordx4 a[24:27], v9, s[8:11], s26 offen offset:0 nt
    buffer_load_dwordx4 a[28:31], v10, s[8:11], s26 offen offset:0 nt
    buffer_load_dwordx4 a[32:35], v9, s[8:11], s26 offen offset:128 nt
    buffer_load_dwordx4 a[36:39], v10, s[8:11], s26 offen offset:128 nt
    buffer_load_dwordx4 a[40:43], v9, s[8:11], s26 offen offset:256 nt
    buffer_load_dwordx4 a[44:47], v10, s[8:11], s26 offen offset:256 nt
    buffer_load_dwordx4 a[48:51], v9, s[8:11], s28 offen offset:0 nt
    buffer_load_dwordx4 a[52:55], v10, s[8:11], s28 offen offset:0 nt
    buffer_load_dwordx4 a[56:59], v9, s[8:11], s28 offen offset:128 nt
    buffer_load_dwordx4 a[60:63], v10, s[8:11], s28 offen offset:128 nt
    buffer_load_dwordx4 a[64:67], v9, s[8:11], s28 offen offset:256 nt
    buffer_load_dwordx4 a[68:71], v10, s[8:11], s28 offen offset:256 nt
    buffer_load_dwordx4 a[72:75], v9, s[8:11], s30 offen offset:0 nt
    buffer_load_dwordx4 a[76:79], v10, s[8:11], s30 offen offset:0 nt
    buffer_load_dwordx4 a[80:83], v9, s[8:11], s30 offen offset:128 nt
    buffer_load_dwordx4 a[84:87], v10, s[8:11], s30 offen offset:128 nt
    buffer_load_dwordx4 a[88:91], v9, s[8:11], s30 offen offset:256 nt
    buffer_load_dwordx4 a[92:95], v10, s[8:11], s30 offen offset:256 nt
    s_waitcnt vmcnt(22)
    ds_write_b64 v4, a[0:1] offset:0
    ds_write_b64 v4, a[2:3] offset:1024
    ds_write_b64 v4, a[4:5] offset:512
    ds_write_b64 v4, a[6:7] offset:1536
    ds_read2_b64 a[0:3], v5 offset0:0 offset1:128
    ds_read2_b64 a[4:7], v6 offset0:0 offset1:128
    s_waitcnt vmcnt(20)
    ds_or_b32 v29, v31
    ds_write_b64 v4, a[8:9] offset:0
    ds_write_b64 v4, a[10:11] offset:1024
    ds_write_b64 v4, a[12:13] offset:512
    ds_write_b64 v4, a[14:15] offset:1536
    ds_read2_b64 a[8:11], v5 offset0:0 offset1:128
    ds_read2_b64 a[12:15], v6 offset0:0 offset1:128
    s_waitcnt vmcnt(18)
    ds_write_b64 v4, a[16:17] offset:0
    ds_write_b64 v4, a[18:19] offset:1024
    ds_write_b64 v4, a[20:21] offset:512
    ds_write_b64 v4, a[22:23] offset:1536
    ds_read2_b64 a[16:19], v5 offset0:0 offset1:128
    ds_read2_b64 a[20:23], v6 offset0:0 offset1:128
    s_waitcnt vmcnt(16)
    ds_write_b64 v4, a[24:25] offset:0
    ds_write_b64 v4, a[26:27] offset:1024
    ds_write_b64 v4, a[28:29] offset:512
    ds_write_b64 v4, a[30:31] offset:1536
    ds_read2_b64 a[24:27], v5 offset0:0 offset1:128
    ds_read2_b64 a[28:31], v6 offset0:0 offset1:128
    s_waitcnt vmcnt(14)
    ds_write_b64 v4, a[32:33] offset:0
    ds_write_b64 v4, a[34:35] offset:1024
    ds_write_b64 v4, a[36:37] offset:512
    ds_write_b64 v4, a[38:39] offset:1536
    ds_read2_b64 a[32:35], v5 offset0:0 offset1:128
    ds_read2_b64 a[36:39], v6 offset0:0 offset1:128
    s_waitcnt vmcnt(12)
    ds_write_b64 v4, a[40:41] offset:0
    ds_write_b64 v4, a[42:43] offset:1024
    ds_write_b64 v4, a[44:45] offset:512
    ds_write_b64 v4, a[46:47] offset:1536
    ds_read2_b64 a[40:43], v5 offset0:0 offset1:128
    ds_read2_b64 a[44:47], v6 offset0:0 offset1:128
    s_waitcnt vmcnt(10)
    ds_write_b64 v4, a[48:49] offset:0
    ds_write_b64 v4, a[50:51] offset:1024
    ds_write_b64 v4, a[52:53] offset:512
    ds_write_b64 v4, a[54:55] offset:1536
    ds_read2_b64 a[48:51], v5 offset0:0 offset1:128
    ds_read2_b64 a[52:55], v6 offset0:0 offset1:128
    s_waitcnt vmcnt(8)
    ds_write_b64 v4, a[56:57] offset:0
    ds_write_b64 v4, a[58:59] offset:1024
    ds_write_b64 v4, a[60:61] offset:512
    ds_write_b64 v4, a[62:63] offset:1536
    ds_read2_b64 a[56:59], v5 offset0:0 offset1:128
    ds_read2_b64 a[60:63], v6 offset0:0 offset1:128
    s_waitcnt vmcnt(6)
    ds_write_b64 v4, a[64:65] offset:0
    ds_write_b64 v4, a[66:67] offset:1024
    ds_write_b64 v4, a[68:69] offset:512
    ds_write_b64 v4, a[70:71] offset:1536
    ds_read2_b64 a[64:67], v5 offset0:0 offset1:128
    ds_read2_b64 a[68:71], v6 offset0:0 offset1:128
    s_waitcnt vmcnt(4)
    ds_write_b64 v4, a[72:73] offset:0
    ds_write_b64 v4, a[74:75] offset:1024
    ds_write_b64 v4, a[76:77] offset:512
    ds_write_b64 v4, a[78:79] offset:1536
    ds_read2_b64 a[72:75], v5 offset0:0 offset1:128
    ds_read2_b64 a[76:79], v6 offset0:0 offset1:128
    s_waitcnt vmcnt(2)
    ds_write_b64 v4, a[80:81] offset:0
    ds_write_b64 v4, a[82:83] offset:1024
    ds_write_b64 v4, a[84:85] offset:512
    ds_write_b64 v4, a[86:87] offset:1536
    ds_read2_b64 a[80:83], v5 offset0:0 offset1:128
    ds_read2_b64 a[84:87], v6 offset0:0 offset1:128
    s_waitcnt vmcnt(0)
    ds_write_b64 v4, a[88:89] offset:0
    ds_write_b64 v4, a[90:91] offset:1024
    ds_write_b64 v4, a[92:93] offset:512
    ds_write_b64 v4, a[94:95] offset:1536
    ds_read2_b64 a[88:91], v5 offset0:0 offset1:128
    ds_read2_b64 a[92:95], v6 offset0:0 offset1:128
L_w1go:
    s_cmp_eq_u32 s49, 1
    s_cbranch_scc0 L_enter
L_wgo:
    s_sub_u32 s43, s43, 1
    s_cbranch_scc1 L_end
    ds_read_b32 v30, v29
    s_waitcnt lgkmcnt(0)
    v_readfirstlane_b32 s41, v30
    s_nop 1
    s_and_b32 s42, s41, 0x200000
    s_cmp_eq_u32 s42, 0x200000
    s_cbranch_scc0 L_wgo
    s_mov_b32 s60, 36864
    s_add_u32 s61, s60, 0
    s_mov_b32 m0, s61
    s_nop 0
    buffer_load_dwordx4 v1, s[52:55], s61 offen offset:0 lds
    buffer_load_dwordx4 v1, s[52:55], s61 offen offset:1024 lds
    buffer_load_dwordx4 v1, s[52:55], s61 offen offset:2048 lds
    buffer_load_dwordx4 v1, s[52:55], s61 offen offset:3072 lds
    s_add_u32 s61, s60, 4096
    s_mov_b32 m0, s61
    s_nop 0
    buffer_load_dwordx4 v1, s[52:55], s61 offen offset:0 lds
    buffer_load_dwordx4 v1, s[52:55], s61 offen offset:1024 lds
    buffer_load_dwordx4 v1, s[52:55], s61 offen offset:2048 lds
    buffer_load_dwordx4 v1, s[52:55], s61 offen offset:3072 lds
    s_add_u32 s61, s60, 8192
    s_mov_b32 m0, s61
    s_nop 0
    buffer_load_dwordx4 v1, s[52:55], s61 offen offset:0 lds
    buffer_load_dwordx4 v1, s[52:55], s61 offen offset:1024 lds
    buffer_load_dwordx4 v1, s[52:55], s61 offen offset:2048 lds
    buffer_load_dwordx4 v1, s[52:55], s61 offen offset:3072 lds
    s_add_u32 s61, s60, 12288
    s_mov_b32 m0, s61
    s_nop 0
    buffer_load_dwordx4 v1, s[52:55], s61 offen offset:0 lds
    buffer_load_dwordx4 v1, s[52:55], s61 offen offset:1024 lds
    buffer_load_dwordx4 v1, s[52:55], s61 offen offset:2048 lds
    buffer_load_dwordx4 v1, s[52:55], s61 offen offset:3072 lds
    s_add_u32 s61, s60, 16384
    s_mov_b32 m0, s61
    s_nop 0
    buffer_load_dwordx4 v1, s[52:55], s61 offen offset:0 lds
    buffer_load_dwordx4 v1, s[52:55], s61 offen offset:1024 lds
    buffer_load_dwordx4 v1, s[52:55], s61 offen offset:2048 lds
    buffer_load_dwordx4 v1, s[52:55], s61 offen offset:3072 lds
    s_add_u32 s61, s60, 20480
    s_mov_b32 m0, s61
    s_nop 0
    buffer_load_dwordx4 v1, s[52:55], s61 offen offset:0 lds
    buffer_load_dwordx4 v1, s[52:55], s61 offen offset:1024 lds
    buffer_load_dwordx4 v1, s[52:55], s61 offen offset:2048 lds
    buffer_load_dwordx4 v1, s[52:55], s61 offen offset:3072 lds
    s_add_u32 s61, s60, 24576
    s_mov_b32 m0, s61
    s_nop 0
    buffer_load_dwordx4 v1, s[52:55], s61 offen offset:0 lds
    buffer_load_dwordx4 v1, s[52:55], s61 offen offset:1024 lds
    buffer_load_dwordx4 v1, s[52:55], s61 offen offset:2048 lds
    buffer_load_dwordx4 v1, s[52:55], s61 offen offset:3072 lds
    s_add_u32 s61, s60, 28672
    s_mov_b32 m0, s61
    s_nop 0
    buffer_load_dwordx4 v1, s[52:55], s61 offen offset:0 lds
    buffer_load_dwordx4 v1, s[52:55], s61 offen offset:1024 lds
    buffer_load_dwordx4 v1, s[52:55], s61 offen offset:2048 lds
    buffer_load_dwordx4 v1, s[52:55], s61 offen offset:3072 lds
    s_add_u32 s61, s60, 32768
    s_mov_b32 m0, s61
    s_nop 0
    buffer_load_dwordx4 v1, s[52:55], s61 offen offset:0 lds
    buffer_load_dwordx4 v1, s[52:55], s61 offen offset:1024 lds
    buffer_load_dwordx4 v1, s[52:55], s61 offen offset:2048 lds
    buffer_load_dwordx4 v1, s[52:55], s61 offen offset:3072 lds
    v_mov_b32 v26, 8
    v_mov_b32 v27, 16
    v_mov_b32 v28, 32
    s_branch L_enter
L_w0:
    s_waitcnt vmcnt(24)
    v_mov_b32 v30, 1048576
    ds_or_b32 v29, v30
    s_waitcnt vmcnt(22)
    ds_write_b64 v4, a[0:1] offset:0
    ds_write_b64 v4, a[2:3] offset:1024
    ds_write_b64 v4, a[4:5] offset:512
    ds_write_b64 v4, a[6:7] offset:1536
    ds_read2_b64 a[0:3], v5 offset0:0 offset1:128
    ds_read2_b64 a[4:7], v6 offset0:0 offset1:128
    s_waitcnt vmcnt(20)
    ds_or_b32 v29, v31
    ds_write_b64 v4, a[8:9] offset:0
    ds_write_b64 v4, a[10:11] offset:1024
    ds_write_b64 v4, a[12:13] offset:512
    ds_write_b64 v4, a[14:15] offset:1536
    ds_read2_b64 a[8:11], v5 offset0:0 offset1:128
    ds_read2_b64 a[12:15], v6 offset0:0 offset1:128
    s_waitcnt vmcnt(18)
    ds_write_b64 v4, a[16:17] offset:0
    ds_write_b64 v4, a[18:19] offset:1024
    ds_write_b64 v4, a[20:21] offset:512
    ds_write_b64 v4, a[22:23] offset:1536
    ds_read2_b64 a[16:19], v5 offset0:0 offset1:128
    ds_read2_b64 a[20:23], v6 offset0:0 offset1:128
    s_waitcnt vmcnt(16)
    ds_write_b64 v4, a[24:25] offset:0
    ds_write_b64 v4, a[26:27] offset:1024
    ds_write_b64 v4, a[28:29] offset:512
    ds_write_b64 v4, a[30:31] offset:1536
    ds_read2_b64 a[24:27], v5 offset0:0 offset1:128
    ds_read2_b64 a[28:31], v6 offset0:0 offset1:128
    s_waitcnt vmcnt(14)
    ds_write_b64 v4, a[32:33] offset:0
    ds_write_b64 v4, a[34:35] offset:1024
    ds_write_b64 v4, a[36:37] offset:512
    ds_write_b64 v4, a[38:39] offset:1536
    ds_read2_b64 a[32:35], v5 offset0:0 offset1:128
    ds_read2_b64 a[36:39], v6 offset0:0 offset1:128
    s_waitcnt vmcnt(12)
    ds_write_b64 v4, a[40:41] offset:0
    ds_write_b64 v4, a[42:43] offset:1024
    ds_write_b64 v4, a[44:45] offset:512
    ds_write_b64 v4, a[46:47] offset:1536
    ds_read2_b64 a[40:43], v5 offset0:0 offset1:128
    ds_read2_b64 a[44:47], v6 offset0:0 offset1:128
    s_waitcnt vmcnt(10)
    ds_write_b64 v4, a[48:49] offset:0
    ds_write_b64 v4, a[50:51] offset:1024
    ds_write_b64 v4, a[52:53] offset:512
    ds_write_b64 v4, a[54:55] offset:1536
    ds_read2_b64 a[48:51], v5 offset0:0 offset1:128
    ds_read2_b64 a[52:55], v6 offset0:0 offset1:128
    s_waitcnt vmcnt(8)
    ds_write_b64 v4, a[56:57] offset:0
    ds_write_b64 v4, a[58:59] offset:1024
    ds_write_b64 v4, a[60:61] offset:512
    ds_write_b64 v4, a[62:63] offset:1536
    ds_read2_b64 a[56:59], v5 offset0:0 offset1:128
    ds_read2_b64 a[60:63], v6 offset0:0 offset1:128
    s_waitcnt vmcnt(6)
    ds_write_b64 v4, a[64:65] offset:0
    ds_write_b64 v4, a[66:67] offset:1024
    ds_write_b64 v4, a[68:69] offset:512
    ds_write_b64 v4, a[70:71] offset:1536
    ds_read2_b64 a[64:67], v5 offset0:0 offset1:128
    ds_read2_b64 a[68:71], v6 offset0:0 offset1:128
    s_waitcnt vmcnt(4)
    ds_write_b64 v4, a[72:73] offset:0
    ds_write_b64 v4, a[74:75] offset:1024
    ds_write_b64 v4, a[76:77] offset:512
    ds_write_b64 v4, a[78:79] offset:1536
    ds_read2_b64 a[72:75], v5 offset0:0 offset1:128
    ds_read2_b64 a[76:79], v6 offset0:0 offset1:128
    s_waitcnt vmcnt(2)
    ds_write_b64 v4, a[80:81] offset:0
    ds_write_b64 v4, a[82:83] offset:1024
    ds_write_b64 v4, a[84:85] offset:512
    ds_write_b64 v4, a[86:87] offset:1536
    ds_read2_b64 a[80:83], v5 offset0:0 offset1:128
    ds_read2_b64 a[84:87], v6 offset0:0 offset1:128
    s_waitcnt vmcnt(0)
    ds_write_b64 v4, a[88:89] offset:0
    ds_write_b64 v4, a[90:91] offset:1024
    ds_write_b64 v4, a[92:93] offset:512
    ds_write_b64 v4, a[94:95] offset:1536
    ds_read2_b64 a[88:91], v5 offset0:0 offset1:128
    ds_read2_b64 a[92:95], v6 offset0:0 offset1:128
L_poll0:
    s_mov_b32 s61, 0
    v_min_u32 v33, 5, v0
    v_lshlrev_b32 v33, 2, v33
    s_mov_b32 s62, 0x01010101
L_poll:
    buffer_load_dword v34, v33, s[56:59], s48 offen nt
    s_add_u32 s61, s61, 1
    s_waitcnt vmcnt(0)
    v_cmp_ne_u32 vcc, s62, v34
    s_nop 4
    s_cbranch_vccz L_go
    s_sleep 2
    s_cmp_lt_u32 s61, 200
    s_cbranch_scc1 L_poll
    s_branch L_fb
L_go:
    s_mov_b32 s60, 0
    s_add_u32 s61, s60, 0
    s_mov_b32 m0, s61
    s_nop 0
    buffer_load_dwordx4 v1, s[52:55], s61 offen offset:0 lds
    buffer_load_dwordx4 v1, s[52:55], s61 offen offset:1024 lds
    buffer_load_dwordx4 v1, s[52:55], s61 offen offset:2048 lds
    buffer_load_dwordx4 v1, s[52:55], s61 offen offset:3072 lds
    s_add_u32 s61, s60, 4096
    s_mov_b32 m0, s61
    s_nop 0
    buffer_load_dwordx4 v1, s[52:55], s61 offen offset:0 lds
    buffer_load_dwordx4 v1, s[52:55], s61 offen offset:1024 lds
    buffer_load_dwordx4 v1, s[52:55], s61 offen offset:2048 lds
    buffer_load_dwordx4 v1, s[52:55], s61 offen offset:3072 lds
    s_add_u32 s61, s60, 8192
    s_mov_b32 m0, s61
    s_nop 0
    buffer_load_dwordx4 v1, s[52:55], s61 offen offset:0 lds
    buffer_load_dwordx4 v1, s[52:55], s61 offen offset:1024 lds
    buffer_load_dwordx4 v1, s[52:55], s61 offen offset:2048 lds
    buffer_load_dwordx4 v1, s[52:55], s61 offen offset:3072 lds
    v_mov_b32 v30, 2097152
    ds_or_b32 v29, v30
    s_add_u32 s61, s60, 12288
    s_mov_b32 m0, s61
    s_nop 0
    buffer_load_dwordx4 v1, s[52:55], s61 offen offset:0 lds
    buffer_load_dwordx4 v1, s[52:55], s61 offen offset:1024 lds
    buffer_load_dwordx4 v1, s[52:55], s61 offen offset:2048 lds
    buffer_load_dwordx4 v1, s[52:55], s61 offen offset:3072 lds
    s_add_u32 s61, s60, 16384
    s_mov_b32 m0, s61
    s_nop 0
    buffer_load_dwordx4 v1, s[52:55], s61 offen offset:0 lds
    buffer_load_dwordx4 v1, s[52:55], s61 offen offset:1024 lds
    buffer_load_dwordx4 v1, s[52:55], s61 offen offset:2048 lds
    buffer_load_dwordx4 v1, s[52:55], s61 offen offset:3072 lds
    s_add_u32 s61, s60, 20480
    s_mov_b32 m0, s61
    s_nop 0
    buffer_load_dwordx4 v1, s[52:55], s61 offen offset:0 lds
    buffer_load_dwordx4 v1, s[52:55], s61 offen offset:1024 lds
    buffer_load_dwordx4 v1, s[52:55], s61 offen offset:2048 lds
    buffer_load_dwordx4 v1, s[52:55], s61 offen offset:3072 lds
    s_add_u32 s61, s60, 24576
    s_mov_b32 m0, s61
    s_nop 0
    buffer_load_dwordx4 v1, s[52:55], s61 offen offset:0 lds
    buffer_load_dwordx4 v1, s[52:55], s61 offen offset:1024 lds
    buffer_load_dwordx4 v1, s[52:55], s61 offen offset:2048 lds
    buffer_load_dwordx4 v1, s[52:55], s61 offen offset:3072 lds
    s_add_u32 s61, s60, 28672
    s_mov_b32 m0, s61
    s_nop 0
    buffer_load_dwordx4 v1, s[52:55], s61 offen offset:0 lds
    buffer_load_dwordx4 v1, s[52:55], s61 offen offset:1024 lds
    buffer_load_dwordx4 v1, s[52:55], s61 offen offset:2048 lds
    buffer_load_dwordx4 v1, s[52:55], s61 offen offset:3072 lds
    s_add_u32 s61, s60, 32768
    s_mov_b32 m0, s61
    s_nop 0
    buffer_load_dwordx4 v1, s[52:55], s61 offen offset:0 lds
    buffer_load_dwordx4 v1, s[52:55], s61 offen offset:1024 lds
    buffer_load_dwordx4 v1, s[52:55], s61 offen offset:2048 lds
    buffer_load_dwordx4 v1, s[52:55], s61 offen offset:3072 lds
    v_mov_b32 v26, 2
    v_mov_b32 v27, 4
    s_waitcnt vmcnt(24)
    v_mov_b32 v30, 1
    ds_or_b32 v29, v30
L_enter:
    s_mul_i32 s60, s49, 18432
    s_add_u32 s60, s60, 73728
    v_add_u32 v24, s60, v1
    s_lshl_b32 s61, 64, s49
    v_mov_b32 v25, s61
    s_waitcnt lgkmcnt(0)
    s_mov_b32 s16, s3
    s_lshl_b32 s17, s49, 12
    ds_read_b32 v30, v29
    s_waitcnt lgkmcnt(0)
    v_readfirstlane_b32 s41, v30
    s_nop 1
    s_bitcmp1_b32 s41, 0
    s_cbranch_scc0 L_slow0
L_ok0:
    ds_read_b128 a[192:195], v1 offset:0
    ds_read_b128 a[196:199], v1 offset:1024
    ds_read_b128 a[200:203], v1 offset:2048
    ds_read_b128 a[204:207], v1 offset:3072
    ds_read_b128 a[208:211], v1 offset:4096
    ds_read_b128 a[212:215], v1 offset:5120
    ds_read_b128 a[216:219], v1 offset:6144
    ds_read_b128 a[220:223], v1 offset:7168
    s_waitcnt lgkmcnt(7)
L_win0:
    v_mfma_f32_16x16x32_bf16 v[96:99], a[192:195], a[0:3], 0
    s_add_u32 s24, s16, 3145728
    s_waitcnt lgkmcnt(6)
    v_mfma_f32_16x16x32_bf16 v[96:99], a[196:199], a[4:7], v[96:99]
    s_add_u32 s26, s16, 3538944
    s_waitcnt lgkmcnt(5)
    v_mfma_f32_16x16x32_bf16 v[96:99], a[200:203], a[8:11], v[96:99]
    ds_read_b128 a[224:227], v1 offset:8192
    s_waitcnt lgkmcnt(5)
    v_mfma_f32_16x16x32_bf16 v[96:99], a[204:207], a[12:15], v[96:99]
    s_add_u32 s28, s16, 3932160
    s_waitcnt lgkmcnt(4)
    v_mfma_f32_16x16x32_bf16 v[96:99], a[208:211], a[16:19], v[96:99]
    ds_read_b128 a[228:231], v1 offset:9216
    s_waitcnt lgkmcnt(2)
    v_mfma_f32_16x16x32_bf16 v[96:99], a[212:215], a[20:23], v[96:99]
    s_add_u32 s30, s16, 4325376
    s_add_u32 s32, s16, 0
    v_mfma_f32_16x16x32_bf16 v[100:103], a[192:195], a[24:27], 0
    ds_read_b128 a[232:235], v1 offset:10240
    s_add_u32 s34, s16, 393216
    v_mfma_f32_16x16x32_bf16 v[100:103], a[196:199], a[28:31], v[100:103]
    s_add_u32 s36, s16, 786432
    s_add_u32 s38, s16, 1179648
    v_mfma_f32_16x16x32_bf16 v[100:103], a[200:203], a[32:35], v[100:103]
    ds_read_b128 a[236:239], v1 offset:11264
    v_cvt_pk_bf16_f32 v192, v96, v97
    v_mfma_f32_16x16x32_bf16 v[100:103], a[204:207], a[36:39], v[100:103]
    v_cvt_pk_bf16_f32 v193, v98, v99
    s_add_u32 s33, s16, 3145728
    v_mfma_f32_16x16x32_bf16 v[100:103], a[208:211], a[40:43], v[100:103]
    s_cmp_eq_u32 s49, 0
    s_cbranch_scc0 L_pub0
    s_waitcnt vmcnt(12)
    ds_or_b32 v29, v26
L_pub0:
    v_mfma_f32_16x16x32_bf16 v[100:103], a[212:215], a[44:47], v[100:103]
    ds_read_b32 v30, v29
    s_add_u32 s35, s16, 3538944
    v_mfma_f32_16x16x32_bf16 v[104:107], a[192:195], a[48:51], 0
    s_add_u32 s37, s16, 3932160
    s_add_u32 s39, s16, 4325376
    v_mfma_f32_16x16x32_bf16 v[104:107], a[196:199], a[52:55], v[104:107]
    v_mfma_f32_16x16x32_bf16 v[104:107], a[200:203], a[56:59], v[104:107]
    v_cvt_pk_bf16_f32 v196, v100, v101
    v_cvt_pk_bf16_f32 v197, v102, v103
    v_mfma_f32_16x16x32_bf16 v[104:107], a[204:207], a[60:63], v[104:107]
    v_mfma_f32_16x16x32_bf16 v[104:107], a[208:211], a[64:67], v[104:107]
    v_mfma_f32_16x16x32_bf16 v[104:107], a[212:215], a[68:71], v[104:107]
    v_mfma_f32_16x16x32_bf16 v[108:111], a[192:195], a[72:75], 0
    v_mfma_f32_16x16x32_bf16 v[108:111], a[196:199], a[76:79], v[108:111]
    v_mfma_f32_16x16x32_bf16 v[108:111], a[200:203], a[80:83], v[108:111]
    s_waitcnt lgkmcnt(0)
    v_readfirstlane_b32 s41, v30
    v_mfma_f32_16x16x32_bf16 v[108:111], a[204:207], a[84:87], v[108:111]
    v_cvt_pk_bf16_f32 v200, v104, v105
    v_cvt_pk_bf16_f32 v201, v106, v107
    v_mfma_f32_16x16x32_bf16 v[108:111], a[208:211], a[88:91], v[108:111]
    s_bitcmp1_b32 s41, 1
    s_cbranch_scc0 L_slow1
L_ok1:
    v_mfma_f32_16x16x32_bf16 v[108:111], a[212:215], a[92:95], v[108:111]
    ds_read_b128 a[240:243], v1 offset:12288
    s_add_u32 s61, s60, 0
    v_mfma_f32_16x16x32_bf16 v[112:115], a[216:219], a[0:3], 0
    buffer_load_dwordx4 v[128:131], v1, s[52:55], s61 offen offset:0
    v_mfma_f32_16x16x32_bf16 v[112:115], a[220:223], a[4:7], v[112:115]
    ds_read_b128 a[244:247], v1 offset:13312
    v_mfma_f32_16x16x32_bf16 v[112:115], a[224:227], a[8:11], v[112:115]
    ds_read_b128 a[248:251], v1 offset:14336
    v_cvt_pk_bf16_f32 v204, v108, v109
    v_mfma_f32_16x16x32_bf16 v[112:115], a[228:231], a[12:15], v[112:115]
    v_cvt_pk_bf16_f32 v205, v110, v111
    v_mfma_f32_16x16x32_bf16 v[112:115], a[232:235], a[16:19], v[112:115]
    ds_read_b128 a[252:255], v1 offset:15360
    v_mfma_f32_16x16x32_bf16 v[112:115], a[236:239], a[20:23], v[112:115]
    v_mfma_f32_16x16x32_bf16 v[116:119], a[216:219], a[24:27], 0
    buffer_load_dwordx4 v[132:135], v1, s[52:55], s61 offen offset:1024
    v_mfma_f32_16x16x32_bf16 v[116:119], a[220:223], a[28:31], v[116:119]
    ds_read_b128 a[192:195], v1 offset:16384
    v_mfma_f32_16x16x32_bf16 v[116:119], a[224:227], a[32:35], v[116:119]
    ds_read_b128 a[196:199], v1 offset:17408
    v_cvt_pk_bf16_f32 v194, v112, v113
    v_mfma_f32_16x16x32_bf16 v[116:119], a[228:231], a[36:39], v[116:119]
    s_cmp_eq_u32 s49, 1
    s_cbranch_scc0 L_pub2
    s_waitcnt vmcnt(26)
    ds_or_b32 v29, v26
L_pub2:
    v_mfma_f32_16x16x32_bf16 v[116:119], a[232:235], a[40:43], v[116:119]
    v_cvt_pk_bf16_f32 v195, v114, v115
    v_mfma_f32_16x16x32_bf16 v[116:119], a[236:239], a[44:47], v[116:119]
    v_mfma_f32_16x16x32_bf16 v[120:123], a[216:219], a[48:51], 0
    buffer_load_dwordx4 v[136:139], v1, s[52:55], s61 offen offset:2048
    v_mfma_f32_16x16x32_bf16 v[120:123], a[220:223], a[52:55], v[120:123]
    v_mfma_f32_16x16x32_bf16 v[120:123], a[224:227], a[56:59], v[120:123]
    v_cvt_pk_bf16_f32 v198, v116, v117
    v_cvt_pk_bf16_f32 v199, v118, v119
    v_mfma_f32_16x16x32_bf16 v[120:123], a[228:231], a[60:63], v[120:123]
    v_mfma_f32_16x16x32_bf16 v[120:123], a[232:235], a[64:67], v[120:123]
    v_mfma_f32_16x16x32_bf16 v[120:123], a[236:239], a[68:71], v[120:123]
    v_mfma_f32_16x16x32_bf16 v[124:127], a[216:219], a[72:75], 0
    buffer_load_dwordx4 v[140:143], v1, s[52:55], s61 offen offset:3072
    v_mfma_f32_16x16x32_bf16 v[124:127], a[220:223], a[76:79], v[124:127]
    v_mfma_f32_16x16x32_bf16 v[124:127], a[224:227], a[80:83], v[124:127]
    v_cvt_pk_bf16_f32 v202, v120, v121
    v_cvt_pk_bf16_f32 v203, v122, v123
    v_mfma_f32_16x16x32_bf16 v[124:127], a[228:231], a[84:87], v[124:127]
    v_mfma_f32_16x16x32_bf16 v[124:127], a[232:235], a[88:91], v[124:127]
    ds_read_b128 a[200:203], v1 offset:18432
    s_add_u32 s61, s60, 4096
    v_mfma_f32_16x16x32_bf16 v[124:127], a[236:239], a[92:95], v[124:127]
    s_waitcnt lgkmcnt(1)
    v_mfma_f32_16x16x32_bf16 v[96:99], a[240:243], a[0:3], 0
    buffer_load_dwordx4 v[144:147], v1, s[52:55], s61 offen offset:0
    v_mfma_f32_16x16x32_bf16 v[96:99], a[244:247], a[4:7], v[96:99]
    ds_read_b128 a[204:207], v1 offset:19456
    v_mfma_f32_16x16x32_bf16 v[96:99], a[248:251], a[8:11], v[96:99]
    ds_read_b128 a[208:211], v1 offset:20480
    v_cvt_pk_bf16_f32 v206, v124, v125
    v_mfma_f32_16x16x32_bf16 v[96:99], a[252:255], a[12:15], v[96:99]
    v_cvt_pk_bf16_f32 v207, v126, v127
    v_mfma_f32_16x16x32_bf16 v[96:99], a[192:195], a[16:19], v[96:99]
    ds_read_b128 a[212:215], v1 offset:21504
    v_mfma_f32_16x16x32_bf16 v[96:99], a[196:199], a[20:23], v[96:99]
    v_mfma_f32_16x16x32_bf16 v[100:103], a[240:243], a[24:27], 0
    buffer_load_dwordx4 v[148:151], v1, s[52:55], s61 offen offset:1024
    v_mfma_f32_16x16x32_bf16 v[100:103], a[244:247], a[28:31], v[100:103]
    ds_read_b128 a[216:219], v1 offset:22528
    v_mfma_f32_16x16x32_bf16 v[100:103], a[248:251], a[32:35], v[100:103]
    ds_read_b128 a[220:223], v1 offset:23552
    v_cvt_pk_bf16_f32 v208, v96, v97
    v_mfma_f32_16x16x32_bf16 v[100:103], a[252:255], a[36:39], v[100:103]
    v_cvt_pk_bf16_f32 v209, v98, v99
    v_mfma_f32_16x16x32_bf16 v[100:103], a[192:195], a[40:43], v[100:103]
    v_mfma_f32_16x16x32_bf16 v[100:103], a[196:199], a[44:47], v[100:103]
    v_mfma_f32_16x16x32_bf16 v[104:107], a[240:243], a[48:51], 0
    buffer_load_dwordx4 v[152:155], v1, s[52:55], s61 offen offset:2048
    v_mfma_f32_16x16x32_bf16 v[104:107], a[244:247], a[52:55], v[104:107]
    s_cmp_eq_u32 s49, 0
    s_cbranch_scc0 L_pub1
    s_waitcnt vmcnt(7)
    ds_or_b32 v29, v27
L_pub1:
    v_mfma_f32_16x16x32_bf16 v[104:107], a[248:251], a[56:59], v[104:107]
    ds_read_b32 v30, v29
    v_cvt_pk_bf16_f32 v212, v100, v101
    v_mfma_f32_16x16x32_bf16 v[104:107], a[252:255], a[60:63], v[104:107]
    v_cvt_pk_bf16_f32 v213, v102, v103
    v_mfma_f32_16x16x32_bf16 v[104:107], a[192:195], a[64:67], v[104:107]
    v_mfma_f32_16x16x32_bf16 v[104:107], a[196:199], a[68:71], v[104:107]
    v_mfma_f32_16x16x32_bf16 v[108:111], a[240:243], a[72:75], 0
    buffer_load_dwordx4 v[156:159], v1, s[52:55], s61 offen offset:3072
    v_mfma_f32_16x16x32_bf16 v[108:111], a[244:247], a[76:79], v[108:111]
    v_mfma_f32_16x16x32_bf16 v[108:111], a[248:251], a[80:83], v[108:111]
    v_cvt_pk_bf16_f32 v216, v104, v105
    v_cvt_pk_bf16_f32 v217, v106, v107
    v_mfma_f32_16x16x32_bf16 v[108:111], a[252:255], a[84:87], v[108:111]
    v_mfma_f32_16x16x32_bf16 v[108:111], a[192:195], a[88:91], v[108:111]
    s_add_u32 s61, s60, 8192
    v_mfma_f32_16x16x32_bf16 v[108:111], a[196:199], a[92:95], v[108:111]
    s_waitcnt lgkmcnt(1)
    v_mfma_f32_16x16x32_bf16 v[112:115], a[200:203], a[0:3], 0
    buffer_load_dwordx4 v[160:163], v1, s[52:55], s61 offen offset:0
    v_mfma_f32_16x16x32_bf16 v[112:115], a[204:207], a[4:7], v[112:115]
    s_waitcnt lgkmcnt(0)
    v_readfirstlane_b32 s41, v30
    v_mfma_f32_16x16x32_bf16 v[112:115], a[208:211], a[8:11], v[112:115]
    v_cvt_pk_bf16_f32 v220, v108, v109
    v_cvt_pk_bf16_f32 v221, v110, v111
    v_mfma_f32_16x16x32_bf16 v[112:115], a[212:215], a[12:15], v[112:115]
    s_bitcmp1_b32 s41, 2
    s_cbranch_scc0 L_slow2
L_ok2:
    v_mfma_f32_16x16x32_bf16 v[112:115], a[216:219], a[16:19], v[112:115]
    ds_read_b128 a[224:227], v1 offset:24576
    v_mfma_f32_16x16x32_bf16 v[112:115], a[220:223], a[20:23], v[112:115]
    ds_read_b128 a[228:231], v1 offset:25600
    v_mfma_f32_16x16x32_bf16 v[116:119], a[200:203], a[24:27], 0
    ds_read_b128 a[232:235], v1 offset:26624
    v_mfma_f32_16x16x32_bf16 v[116:119], a[204:207], a[28:31], v[116:119]
    ds_read_b128 a[236:239], v1 offset:27648
    v_mfma_f32_16x16x32_bf16 v[116:119], a[208:211], a[32:35], v[116:119]
    buffer_load_dwordx4 v[164:167], v1, s[52:55], s61 offen offset:1024
    v_cvt_pk_bf16_f32 v210, v112, v113
    v_mfma_f32_16x16x32_bf16 v[116:119], a[212:215], a[36:39], v[116:119]
    ds_read_b128 a[240:243], v1 offset:28672
    v_cvt_pk_bf16_f32 v211, v114, v115
    v_mfma_f32_16x16x32_bf16 v[116:119], a[216:219], a[40:43], v[116:119]
    ds_read_b128 a[244:247], v1 offset:29696
    v_mfma_f32_16x16x32_bf16 v[116:119], a[220:223], a[44:47], v[116:119]
    s_cmp_eq_u32 s49, 1
    s_cbranch_scc0 L_pub3
    s_waitcnt vmcnt(22)
    ds_or_b32 v29, v27
L_pub3:
    v_mfma_f32_16x16x32_bf16 v[120:123], a[200:203], a[48:51], 0
    buffer_load_dwordx4 v[168:171], v1, s[52:55], s61 offen offset:2048
    v_mfma_f32_16x16x32_bf16 v[120:123], a[204:207], a[52:55], v[120:123]
    v_mfma_f32_16x16x32_bf16 v[120:123], a[208:211], a[56:59], v[120:123]
    v_cvt_pk_bf16_f32 v214, v116, v117
    v_cvt_pk_bf16_f32 v215, v118, v119
    v_mfma_f32_16x16x32_bf16 v[120:123], a[212:215], a[60:63], v[120:123]
    v_mfma_f32_16x16x32_bf16 v[120:123], a[216:219], a[64:67], v[120:123]
    v_mfma_f32_16x16x32_bf16 v[120:123], a[220:223], a[68:71], v[120:123]
    v_mfma_f32_16x16x32_bf16 v[124:127], a[200:203], a[72:75], 0
    buffer_load_dwordx4 v[172:175], v1, s[52:55], s61 offen offset:3072
    v_mfma_f32_16x16x32_bf16 v[124:127], a[204:207], a[76:79], v[124:127]
    v_mfma_f32_16x16x32_bf16 v[124:127], a[208:211], a[80:83], v[124:127]
    v_cvt_pk_bf16_f32 v218, v120, v121
    v_cvt_pk_bf16_f32 v219, v122, v123
    v_mfma_f32_16x16x32_bf16 v[124:127], a[212:215], a[84:87], v[124:127]
    v_mfma_f32_16x16x32_bf16 v[124:127], a[216:219], a[88:91], v[124:127]
    s_add_u32 s61, s60, 12288
    v_mfma_f32_16x16x32_bf16 v[124:127], a[220:223], a[92:95], v[124:127]
    s_waitcnt lgkmcnt(1)
    v_mfma_f32_16x16x32_bf16 v[96:99], a[224:227], a[0:3], 0
    buffer_load_dwordx4 v[176:179], v1, s[52:55], s61 offen offset:0
    v_mfma_f32_16x16x32_bf16 v[96:99], a[228:231], a[4:7], v[96:99]
    v_mfma_f32_16x16x32_bf16 v[96:99], a[232:235], a[8:11], v[96:99]
    v_cvt_pk_bf16_f32 v222, v124, v125
    v_cvt_pk_bf16_f32 v223, v126, v127
    v_mfma_f32_16x16x32_bf16 v[96:99], a[236:239], a[12:15], v[96:99]
    v_mfma_f32_16x16x32_bf16 v[96:99], a[240:243], a[16:19], v[96:99]
    s_waitcnt lgkmcnt(0)
    v_mfma_f32_16x16x32_bf16 v[96:99], a[244:247], a[20:23], v[96:99]
    v_mfma_f32_16x16x32_bf16 v[100:103], a[224:227], a[24:27], 0
    buffer_load_dwordx4 v[180:183], v1, s[52:55], s61 offen offset:1024
    v_mfma_f32_16x16x32_bf16 v[100:103], a[228:231], a[28:31], v[100:103]
    v_mfma_f32_16x16x32_bf16 v[100:103], a[232:235], a[32:35], v[100:103]
    s_waitcnt vmcnt(13)
    ds_write_b64 v24, v[128:129] offset:0
    v_mfma_f32_16x16x32_bf16 v[100:103], a[236:239], a[36:39], v[100:103]
    ds_write_b64 v24, v[130:131] offset:8
    v_mfma_f32_16x16x32_bf16 v[100:103], a[240:243], a[40:43], v[100:103]
    v_mfma_f32_16x16x32_bf16 v[100:103], a[244:247], a[44:47], v[100:103]
    v_mfma_f32_16x16x32_bf16 v[32:35], a[0:3], v[192:195], 0
    buffer_load_dwordx4 v[184:187], v1, s[52:55], s61 offen offset:2048
    v_mfma_f32_16x16x32_bf16 v[32:35], a[4:7], v[208:211], v[32:35]
    v_mfma_f32_16x16x32_bf16 v[36:39], a[24:27], v[192:195], 0
    s_waitcnt vmcnt(13)
    ds_write_b64 v24, v[132:133] offset:1024
    v_mfma_f32_16x16x32_bf16 v[36:39], a[28:31], v[208:211], v[36:39]
    ds_write_b64 v24, v[134:135] offset:1032
    v_mfma_f32_16x16x32_bf16 v[40:43], a[48:51], v[192:195], 0
    v_mfma_f32_16x16x32_bf16 v[40:43], a[52:55], v[208:211], v[40:43]
    v_mfma_f32_16x16x32_bf16 v[44:47], a[72:75], v[192:195], 0
    buffer_load_dwordx4 v[188:191], v1, s[52:55], s61 offen offset:3072
    v_cvt_pk_bf16_f32 v192, v96, v97
    v_mfma_f32_16x16x32_bf16 v[44:47], a[76:79], v[208:211], v[44:47]
    v_cvt_pk_bf16_f32 v193, v98, v99
    v_mfma_f32_16x16x32_bf16 v[48:51], a[0:3], v[196:199], 0
    s_waitcnt vmcnt(13)
    ds_write_b64 v24, v[136:137] offset:2048
    v_mfma_f32_16x16x32_bf16 v[48:51], a[4:7], v[212:215], v[48:51]
    ds_write_b64 v24, v[138:139] offset:2056
    v_mfma_f32_16x16x32_bf16 v[52:55], a[24:27], v[196:199], 0
    s_add_u32 s61, s60, 16384
    v_mfma_f32_16x16x32_bf16 v[52:55], a[28:31], v[212:215], v[52:55]
    v_mfma_f32_16x16x32_bf16 v[56:59], a[48:51], v[196:199], 0
    buffer_load_dwordx4 v[224:227], v1, s[52:55], s61 offen offset:0
    v_mfma_f32_16x16x32_bf16 v[56:59], a[52:55], v[212:215], v[56:59]
    v_mfma_f32_16x16x32_bf16 v[60:63], a[72:75], v[196:199], 0
    s_waitcnt vmcnt(13)
    ds_write_b64 v24, v[140:141] offset:3072
    v_mfma_f32_16x16x32_bf16 v[60:63], a[76:79], v[212:215], v[60:63]
    ds_write_b64 v24, v[142:143] offset:3080
    v_mfma_f32_16x16x32_bf16 v[64:67], a[0:3], v[200:203], 0
    v_cvt_pk_bf16_f32 v196, v100, v101
    v_cvt_pk_bf16_f32 v197, v102, v103
    v_mfma_f32_16x16x32_bf16 v[64:67], a[4:7], v[216:219], v[64:67]
    v_mfma_f32_16x16x32_bf16 v[68:71], a[24:27], v[200:203], 0
    buffer_load_dwordx4 v[228:231], v1, s[52:55], s61 offen offset:1024
    v_mfma_f32_16x16x32_bf16 v[68:71], a[28:31], v[216:219], v[68:71]
    ds_read_b128 a[248:251], v1 offset:30720
    v_mfma_f32_16x16x32_bf16 v[72:75], a[48:51], v[200:203], 0
    ds_read_b128 a[252:255], v1 offset:31744
    v_mfma_f32_16x16x32_bf16 v[72:75], a[52:55], v[216:219], v[72:75]
    s_waitcnt vmcnt(13)
    ds_write_b64 v24, v[144:145] offset:4096
    v_mfma_f32_16x16x32_bf16 v[76:79], a[72:75], v[200:203], 0
    ds_read_b128 a[192:195], v1 offset:32768
    v_mfma_f32_16x16x32_bf16 v[76:79], a[76:79], v[216:219], v[76:79]
    ds_write_b64 v24, v[146:147] offset:4104
    v_mfma_f32_16x16x32_bf16 v[80:83], a[0:3], v[204:207], 0
    ds_read_b128 a[196:199], v1 offset:33792
    v_mfma_f32_16x16x32_bf16 v[80:83], a[4:7], v[220:223], v[80:83]
    s_cmp_eq_u32 s49, 1
    s_cbranch_scc0 L_pub4
    s_waitcnt vmcnt(18)
    ds_or_b32 v29, v28
L_pub4:
    v_mfma_f32_16x16x32_bf16 v[84:87], a[24:27], v[204:207], 0
    ds_read_b128 a[200:203], v1 offset:34816
    v_mfma_f32_16x16x32_bf16 v[84:87], a[28:31], v[220:223], v[84:87]
    s_waitcnt vmcnt(12)
    ds_write_b64 v24, v[148:149] offset:5120
    v_mfma_f32_16x16x32_bf16 v[88:91], a[48:51], v[204:207], 0
    ds_read_b32 v30, v29
    v_mfma_f32_16x16x32_bf16 v[88:91], a[52:55], v[220:223], v[88:91]
    ds_read_b128 a[204:207], v1 offset:35840
    v_mfma_f32_16x16x32_bf16 v[92:95], a[72:75], v[204:207], 0
    ds_write_b64 v24, v[150:151] offset:5128
    v_mfma_f32_16x16x32_bf16 v[92:95], a[76:79], v[220:223], v[92:95]
    v_mfma_f32_16x16x32_bf16 v[104:107], a[224:227], a[48:51], 0
    s_waitcnt vmcnt(11)
    ds_write_b64 v24, v[152:153] offset:6144
    v_mfma_f32_16x16x32_bf16 v[104:107], a[228:231], a[52:55], v[104:107]
    ds_write_b64 v24, v[154:155] offset:6152
    v_mfma_f32_16x16x32_bf16 v[104:107], a[232:235], a[56:59], v[104:107]
    v_mfma_f32_16x16x32_bf16 v[104:107], a[236:239], a[60:63], v[104:107]
    v_mfma_f32_16x16x32_bf16 v[104:107], a[240:243], a[64:67], v[104:107]
    v_mfma_f32_16x16x32_bf16 v[104:107], a[244:247], a[68:71], v[104:107]
    s_waitcnt lgkmcnt(4)
    v_readfirstlane_b32 s41, v30
    v_mfma_f32_16x16x32_bf16 v[108:111], a[224:227], a[72:75], 0
    s_waitcnt vmcnt(10)
    ds_write_b64 v24, v[156:157] offset:7168
    v_mfma_f32_16x16x32_bf16 v[108:111], a[228:231], a[76:79], v[108:111]
    ds_write_b64 v24, v[158:159] offset:7176
    v_mfma_f32_16x16x32_bf16 v[108:111], a[232:235], a[80:83], v[108:111]
    s_bitcmp1_b32 s41, 3
    s_cbranch_scc0 L_slow3
L_ok3:
    v_mfma_f32_16x16x32_bf16 v[108:111], a[236:239], a[84:87], v[108:111]
    v_cvt_pk_bf16_f32 v200, v104, v105
    v_cvt_pk_bf16_f32 v201, v106, v107
    v_mfma_f32_16x16x32_bf16 v[108:111], a[240:243], a[88:91], v[108:111]
    ds_read_b128 a[208:211], v1 offset:36864
    v_mfma_f32_16x16x32_bf16 v[108:111], a[244:247], a[92:95], v[108:111]
    v_mfma_f32_16x16x32_bf16 v[112:115], a[248:251], a[0:3], 0
    ds_read_b128 a[212:215], v1 offset:37888
    v_mfma_f32_16x16x32_bf16 v[112:115], a[252:255], a[4:7], v[112:115]
    s_waitcnt vmcnt(9)
    ds_write_b64 v24, v[160:161] offset:8192
    v_mfma_f32_16x16x32_bf16 v[112:115], a[192:195], a[8:11], v[112:115]
    ds_read_b128 a[216:219], v1 offset:38912
    v_cvt_pk_bf16_f32 v204, v108, v109
    v_mfma_f32_16x16x32_bf16 v[112:115], a[196:199], a[12:15], v[112:115]
    ds_write_b64 v24, v[162:163] offset:8200
    v_mfma_f32_16x16x32_bf16 v[112:115], a[200:203], a[16:19], v[112:115]
    ds_read_b128 a[220:223], v1 offset:39936
    s_waitcnt lgkmcnt(8)
    v_mfma_f32_16x16x32_bf16 v[112:115], a[204:207], a[20:23], v[112:115]
    v_cvt_pk_bf16_f32 v205, v110, v111
    v_mfma_f32_16x16x32_bf16 v[116:119], a[248:251], a[24:27], 0
    ds_read_b128 a[224:227], v1 offset:40960
    v_mfma_f32_16x16x32_bf16 v[116:119], a[252:255], a[28:31], v[116:119]
    s_waitcnt vmcnt(8)
    ds_write_b64 v24, v[164:165] offset:9216
    v_mfma_f32_16x16x32_bf16 v[116:119], a[192:195], a[32:35], v[116:119]
    ds_read_b128 a[228:231], v1 offset:41984
    v_cvt_pk_bf16_f32 v194, v112, v113
    v_mfma_f32_16x16x32_bf16 v[116:119], a[196:199], a[36:39], v[116:119]
    ds_write_b64 v24, v[166:167] offset:9224
    v_mfma_f32_16x16x32_bf16 v[116:119], a[200:203], a[40:43], v[116:119]
    v_cvt_pk_bf16_f32 v195, v114, v115
    v_mfma_f32_16x16x32_bf16 v[116:119], a[204:207], a[44:47], v[116:119]
    v_mfma_f32_16x16x32_bf16 v[120:123], a[248:251], a[48:51], 0
    s_waitcnt vmcnt(7)
    ds_write_b64 v24, v[168:169] offset:10240
    v_mfma_f32_16x16x32_bf16 v[120:123], a[252:255], a[52:55], v[120:123]
    ds_write_b64 v24, v[170:171] offset:10248
    v_mfma_f32_16x16x32_bf16 v[120:123], a[192:195], a[56:59], v[120:123]
    v_cvt_pk_bf16_f32 v198, v116, v117
    v_cvt_pk_bf16_f32 v199, v118, v119
    v_mfma_f32_16x16x32_bf16 v[120:123], a[196:199], a[60:63], v[120:123]
    v_mfma_f32_16x16x32_bf16 v[120:123], a[200:203], a[64:67], v[120:123]
    v_mfma_f32_16x16x32_bf16 v[120:123], a[204:207], a[68:71], v[120:123]
    v_mfma_f32_16x16x32_bf16 v[124:127], a[248:251], a[72:75], 0
    buffer_load_dwordx4 a[96:99], v9, s[8:11], s24 offen offset:0 nt
    v_mfma_f32_16x16x32_bf16 v[124:127], a[252:255], a[76:79], v[124:127]
    buffer_load_dwordx4 a[100:103], v10, s[8:11], s24 offen offset:0 nt
    v_mfma_f32_16x16x32_bf16 v[124:127], a[192:195], a[80:83], v[124:127]
    s_waitcnt vmcnt(8)
    ds_write_b64 v24, v[172:173] offset:11264
    v_mfma_f32_16x16x32_bf16 v[124:127], a[196:199], a[84:87], v[124:127]
    ds_write_b64 v24, v[174:175] offset:11272
    v_mfma_f32_16x16x32_bf16 v[124:127], a[200:203], a[88:91], v[124:127]
    ds_read_b128 a[232:235], v1 offset:43008
    v_cvt_pk_bf16_f32 v202, v120, v121
    v_mfma_f32_16x16x32_bf16 v[124:127], a[204:207], a[92:95], v[124:127]
    v_cvt_pk_bf16_f32 v203, v122, v123
    s_waitcnt lgkmcnt(5)
    v_mfma_f32_16x16x32_bf16 v[96:99], a[208:211], a[0:3], 0
    ds_read_b128 a[236:239], v1 offset:44032
    v_mfma_f32_16x16x32_bf16 v[96:99], a[212:215], a[4:7], v[96:99]
    s_waitcnt vmcnt(7)
    ds_write_b64 v24, v[176:177] offset:12288
    v_mfma_f32_16x16x32_bf16 v[96:99], a[216:219], a[8:11], v[96:99]
    ds_read_b128 a[240:243], v1 offset:45056
    v_cvt_pk_bf16_f32 v206, v124, v125
    v_mfma_f32_16x16x32_bf16 v[96:99], a[220:223], a[12:15], v[96:99]
    ds_write_b64 v24, v[178:179] offset:12296
    v_mfma_f32_16x16x32_bf16 v[96:99], a[224:227], a[16:19], v[96:99]
    ds_read_b128 a[244:247], v1 offset:46080
    v_cvt_pk_bf16_f32 v207, v126, v127
    v_mfma_f32_16x16x32_bf16 v[96:99], a[228:231], a[20:23], v[96:99]
    v_mfma_f32_16x16x32_bf16 v[100:103], a[208:211], a[24:27], 0
    ds_read_b128 a[248:251], v1 offset:47104
    v_mfma_f32_16x16x32_bf16 v[100:103], a[212:215], a[28:31], v[100:103]
    s_waitcnt vmcnt(6)
    ds_write_b64 v24, v[180:181] offset:13312
    v_mfma_f32_16x16x32_bf16 v[100:103], a[216:219], a[32:35], v[100:103]
    ds_read_b32 v30, v29
    v_cvt_pk_bf16_f32 v208, v96, v97
    v_mfma_f32_16x16x32_bf16 v[100:103], a[220:223], a[36:39], v[100:103]
    ds_read_b128 a[252:255], v1 offset:48128
    v_cvt_pk_bf16_f32 v209, v98, v99
    v_mfma_f32_16x16x32_bf16 v[100:103], a[224:227], a[40:43], v[100:103]
    ds_write_b64 v24, v[182:183] offset:13320
    v_mfma_f32_16x16x32_bf16 v[100:103], a[228:231], a[44:47], v[100:103]
    v_mfma_f32_16x16x32_bf16 v[104:107], a[208:211], a[48:51], 0
    s_waitcnt vmcnt(5)
    ds_write_b64 v24, v[184:185] offset:14336
    v_mfma_f32_16x16x32_bf16 v[104:107], a[212:215], a[52:55], v[104:107]
    ds_write_b64 v24, v[186:187] offset:14344
    v_mfma_f32_16x16x32_bf16 v[104:107], a[216:219], a[56:59], v[104:107]
    v_cvt_pk_bf16_f32 v212, v100, v101
    v_cvt_pk_bf16_f32 v213, v102, v103
    v_mfma_f32_16x16x32_bf16 v[104:107], a[220:223], a[60:63], v[104:107]
    v_mfma_f32_16x16x32_bf16 v[104:107], a[224:227], a[64:67], v[104:107]
    v_mfma_f32_16x16x32_bf16 v[104:107], a[228:231], a[68:71], v[104:107]
    s_waitcnt lgkmcnt(4)
    v_readfirstlane_b32 s41, v30
    v_mfma_f32_16x16x32_bf16 v[108:111], a[208:211], a[72:75], 0
    s_waitcnt vmcnt(4)
    ds_write_b64 v24, v[188:189] offset:15360
    v_mfma_f32_16x16x32_bf16 v[108:111], a[212:215], a[76:79], v[108:111]
    buffer_load_dwordx4 a[104:107], v9, s[8:11], s24 offen offset:128 nt
    v_mfma_f32_16x16x32_bf16 v[108:111], a[216:219], a[80:83], v[108:111]
    buffer_load_dwordx4 a[108:111], v10, s[8:11], s24 offen offset:128 nt
    v_cvt_pk_bf16_f32 v216, v104, v105
    v_mfma_f32_16x16x32_bf16 v[108:111], a[220:223], a[84:87], v[108:111]
    ds_write_b64 v24, v[190:191] offset:15368
    v_mfma_f32_16x16x32_bf16 v[108:111], a[224:227], a[88:91], v[108:111]
    s_bitcmp1_b32 s41, 4
    s_cbranch_scc0 L_slow4
L_ok4:
    v_mfma_f32_16x16x32_bf16 v[108:111], a[228:231], a[92:95], v[108:111]
    ds_read_b128 a[192:195], v1 offset:49152
    v_cvt_pk_bf16_f32 v217, v106, v107
    v_mfma_f32_16x16x32_bf16 v[112:115], a[232:235], a[0:3], 0
    ds_read_b128 a[196:199], v1 offset:50176
    v_mfma_f32_16x16x32_bf16 v[112:115], a[236:239], a[4:7], v[112:115]
    s_waitcnt vmcnt(5)
    ds_write_b64 v24, v[224:225] offset:16384
    v_mfma_f32_16x16x32_bf16 v[112:115], a[240:243], a[8:11], v[112:115]
    ds_read_b128 a[200:203], v1 offset:51200
    v_cvt_pk_bf16_f32 v220, v108, v109
    v_mfma_f32_16x16x32_bf16 v[112:115], a[244:247], a[12:15], v[112:115]
    ds_write_b64 v24, v[226:227] offset:16392
    v_mfma_f32_16x16x32_bf16 v[112:115], a[248:251], a[16:19], v[112:115]
    ds_read_b128 a[204:207], v1 offset:52224
    s_waitcnt lgkmcnt(8)
    v_mfma_f32_16x16x32_bf16 v[112:115], a[252:255], a[20:23], v[112:115]
    v_cvt_pk_bf16_f32 v221, v110, v111
    v_mfma_f32_16x16x32_bf16 v[116:119], a[232:235], a[24:27], 0
    ds_read_b128 a[208:211], v1 offset:53248
    v_mfma_f32_16x16x32_bf16 v[116:119], a[236:239], a[28:31], v[116:119]
    s_waitcnt vmcnt(4)
    ds_write_b64 v24, v[228:229] offset:17408
    v_mfma_f32_16x16x32_bf16 v[116:119], a[240:243], a[32:35], v[116:119]
    ds_read_b128 a[212:215], v1 offset:54272
    v_cvt_pk_bf16_f32 v210, v112, v113
    v_mfma_f32_16x16x32_bf16 v[116:119], a[244:247], a[36:39], v[116:119]
    ds_write_b64 v24, v[230:231] offset:17416
    v_mfma_f32_16x16x32_bf16 v[116:119], a[248:251], a[40:43], v[116:119]
    ds_or_b32 v29, v25
    v_mfma_f32_16x16x32_bf16 v[116:119], a[252:255], a[44:47], v[116:119]
    v_cvt_pk_bf16_f32 v211, v114, v115
    v_mfma_f32_16x16x32_bf16 v[120:123], a[232:235], a[48:51], 0
    v_mfma_f32_16x16x32_bf16 v[120:123], a[236:239], a[52:55], v[120:123]
    v_mfma_f32_16x16x32_bf16 v[120:123], a[240:243], a[56:59], v[120:123]
    v_cvt_pk_bf16_f32 v214, v116, v117
    v_cvt_pk_bf16_f32 v215, v118, v119
    v_mfma_f32_16x16x32_bf16 v[120:123], a[244:247], a[60:63], v[120:123]
    v_mfma_f32_16x16x32_bf16 v[120:123], a[248:251], a[64:67], v[120:123]
    v_mfma_f32_16x16x32_bf16 v[120:123], a[252:255], a[68:71], v[120:123]
    v_mfma_f32_16x16x32_bf16 v[124:127], a[232:235], a[72:75], 0
    v_mfma_f32_16x16x32_bf16 v[124:127], a[236:239], a[76:79], v[124:127]
    v_mfma_f32_16x16x32_bf16 v[124:127], a[240:243], a[80:83], v[124:127]
    buffer_load_dwordx4 a[112:115], v9, s[8:11], s24 offen offset:256 nt
    v_cvt_pk_bf16_f32 v218, v120, v121
    v_mfma_f32_16x16x32_bf16 v[124:127], a[244:247], a[84:87], v[124:127]
    buffer_load_dwordx4 a[116:119], v10, s[8:11], s24 offen offset:256 nt
    v_cvt_pk_bf16_f32 v219, v122, v123
    v_mfma_f32_16x16x32_bf16 v[124:127], a[248:251], a[88:91], v[124:127]
    s_add_u32 s24, s16, 6291456
    v_mfma_f32_16x16x32_bf16 v[124:127], a[252:255], a[92:95], v[124:127]
    s_waitcnt lgkmcnt(1)
    v_mfma_f32_16x16x32_bf16 v[96:99], a[192:195], a[0:3], 0
    v_mfma_f32_16x16x32_bf16 v[96:99], a[196:199], a[4:7], v[96:99]
    v_mfma_f32_16x16x32_bf16 v[96:99], a[200:203], a[8:11], v[96:99]
    v_cvt_pk_bf16_f32 v222, v124, v125
    v_cvt_pk_bf16_f32 v223, v126, v127
    v_mfma_f32_16x16x32_bf16 v[96:99], a[204:207], a[12:15], v[96:99]
    v_mfma_f32_16x16x32_bf16 v[96:99], a[208:211], a[16:19], v[96:99]
    v_mfma_f32_16x16x32_bf16 v[96:99], a[212:215], a[20:23], v[96:99]
    v_mfma_f32_16x16x32_bf16 v[100:103], a[192:195], a[24:27], 0
    v_mfma_f32_16x16x32_bf16 v[100:103], a[196:199], a[28:31], v[100:103]
    v_mfma_f32_16x16x32_bf16 v[100:103], a[200:203], a[32:35], v[100:103]
    v_mfma_f32_16x16x32_bf16 v[100:103], a[204:207], a[36:39], v[100:103]
    v_mfma_f32_16x16x32_bf16 v[100:103], a[208:211], a[40:43], v[100:103]
    v_mfma_f32_16x16x32_bf16 v[100:103], a[212:215], a[44:47], v[100:103]
    v_mfma_f32_16x16x32_bf16 v[32:35], a[8:11], v[192:195], v[32:35]
    v_mfma_f32_16x16x32_bf16 v[32:35], a[12:15], v[208:211], v[32:35]
    v_mfma_f32_16x16x32_bf16 v[36:39], a[32:35], v[192:195], v[36:39]
    v_mfma_f32_16x16x32_bf16 v[36:39], a[36:39], v[208:211], v[36:39]
    v_mfma_f32_16x16x32_bf16 v[40:43], a[56:59], v[192:195], v[40:43]
    v_mfma_f32_16x16x32_bf16 v[40:43], a[60:63], v[208:211], v[40:43]
    v_mfma_f32_16x16x32_bf16 v[44:47], a[80:83], v[192:195], v[44:47]
    v_cvt_pk_bf16_f32 v192, v96, v97
    v_cvt_pk_bf16_f32 v193, v98, v99
    v_mfma_f32_16x16x32_bf16 v[44:47], a[84:87], v[208:211], v[44:47]
    v_mfma_f32_16x16x32_bf16 v[48:51], a[8:11], v[196:199], v[48:51]
    v_mfma_f32_16x16x32_bf16 v[48:51], a[12:15], v[212:215], v[48:51]
    buffer_load_dwordx4 a[120:123], v9, s[8:11], s26 offen offset:0 nt
    v_mfma_f32_16x16x32_bf16 v[52:55], a[32:35], v[196:199], v[52:55]
    buffer_load_dwordx4 a[124:127], v10, s[8:11], s26 offen offset:0 nt
    v_mfma_f32_16x16x32_bf16 v[52:55], a[36:39], v[212:215], v[52:55]
    v_mfma_f32_16x16x32_bf16 v[56:59], a[56:59], v[196:199], v[56:59]
    v_mfma_f32_16x16x32_bf16 v[56:59], a[60:63], v[212:215], v[56:59]
    v_mfma_f32_16x16x32_bf16 v[60:63], a[80:83], v[196:199], v[60:63]
    v_cvt_pk_bf16_f32 v196, v100, v101
    v_cvt_pk_bf16_f32 v197, v102, v103
    v_mfma_f32_16x16x32_bf16 v[60:63], a[84:87], v[212:215], v[60:63]
    v_mfma_f32_16x16x32_bf16 v[64:67], a[8:11], v[200:203], v[64:67]
    v_mfma_f32_16x16x32_bf16 v[64:67], a[12:15], v[216:219], v[64:67]
    v_mfma_f32_16x16x32_bf16 v[68:71], a[32:35], v[200:203], v[68:71]
    ds_read_b128 a[216:219], v1 offset:55296
    v_mfma_f32_16x16x32_bf16 v[68:71], a[36:39], v[216:219], v[68:71]
    v_mfma_f32_16x16x32_bf16 v[72:75], a[56:59], v[200:203], v[72:75]
    ds_read_b128 a[220:223], v1 offset:56320
    v_mfma_f32_16x16x32_bf16 v[72:75], a[60:63], v[216:219], v[72:75]
    v_mfma_f32_16x16x32_bf16 v[76:79], a[80:83], v[200:203], v[76:79]
    ds_read_b128 a[224:227], v1 offset:57344
    v_mfma_f32_16x16x32_bf16 v[76:79], a[84:87], v[216:219], v[76:79]
    v_mfma_f32_16x16x32_bf16 v[80:83], a[8:11], v[204:207], v[80:83]
    ds_read_b128 a[228:231], v1 offset:58368
    v_mfma_f32_16x16x32_bf16 v[80:83], a[12:15], v[220:223], v[80:83]
    v_mfma_f32_16x16x32_bf16 v[84:87], a[32:35], v[204:207], v[84:87]
    ds_read_b128 a[232:235], v1 offset:59392
    v_mfma_f32_16x16x32_bf16 v[84:87], a[36:39], v[220:223], v[84:87]
    v_mfma_f32_16x16x32_bf16 v[88:91], a[56:59], v[204:207], v[88:91]
    ds_read_b32 v30, v29
    v_mfma_f32_16x16x32_bf16 v[88:91], a[60:63], v[220:223], v[88:91]
    ds_read_b128 a[236:239], v1 offset:60416
    v_mfma_f32_16x16x32_bf16 v[92:95], a[80:83], v[204:207], v[92:95]
    v_mfma_f32_16x16x32_bf16 v[92:95], a[84:87], v[220:223], v[92:95]
    v_mfma_f32_16x16x32_bf16 v[104:107], a[192:195], a[48:51], 0
    v_mfma_f32_16x16x32_bf16 v[104:107], a[196:199], a[52:55], v[104:107]
    v_mfma_f32_16x16x32_bf16 v[104:107], a[200:203], a[56:59], v[104:107]
    buffer_load_dwordx4 a[128:131], v9, s[8:11], s26 offen offset:128 nt
    v_mfma_f32_16x16x32_bf16 v[104:107], a[204:207], a[60:63], v[104:107]
    buffer_load_dwordx4 a[132:135], v10, s[8:11], s26 offen offset:128 nt
    v_mfma_f32_16x16x32_bf16 v[104:107], a[208:211], a[64:67], v[104:107]
    v_mfma_f32_16x16x32_bf16 v[104:107], a[212:215], a[68:71], v[104:107]
    s_waitcnt lgkmcnt(1)
    v_readfirstlane_b32 s41, v30
    v_mfma_f32_16x16x32_bf16 v[108:111], a[192:195], a[72:75], 0
    v_mfma_f32_16x16x32_bf16 v[108:111], a[196:199], a[76:79], v[108:111]
    s_bitcmp1_b32 s41, 5
    s_cbranch_scc0 L_slow5
L_ok5:
    v_mfma_f32_16x16x32_bf16 v[108:111], a[200:203], a[80:83], v[108:111]
    v_cvt_pk_bf16_f32 v200, v104, v105
    v_cvt_pk_bf16_f32 v201, v106, v107
    v_mfma_f32_16x16x32_bf16 v[108:111], a[204:207], a[84:87], v[108:111]
    v_mfma_f32_16x16x32_bf16 v[108:111], a[208:211], a[88:91], v[108:111]
    ds_read_b128 a[240:243], v1 offset:61440
    v_mfma_f32_16x16x32_bf16 v[108:111], a[212:215], a[92:95], v[108:111]
    v_mfma_f32_16x16x32_bf16 v[112:115], a[216:219], a[0:3], 0
    ds_read_b128 a[244:247], v1 offset:62464
    v_mfma_f32_16x16x32_bf16 v[112:115], a[220:223], a[4:7], v[112:115]
    v_mfma_f32_16x16x32_bf16 v[112:115], a[224:227], a[8:11], v[112:115]
    ds_read_b128 a[248:251], v1 offset:63488
    v_cvt_pk_bf16_f32 v204, v108, v109
    v_mfma_f32_16x16x32_bf16 v[112:115], a[228:231], a[12:15], v[112:115]
    v_cvt_pk_bf16_f32 v205, v110, v111
    v_mfma_f32_16x16x32_bf16 v[112:115], a[232:235], a[16:19], v[112:115]
    ds_read_b128 a[252:255], v1 offset:64512
    s_waitcnt lgkmcnt(4)
    v_mfma_f32_16x16x32_bf16 v[112:115], a[236:239], a[20:23], v[112:115]
    v_mfma_f32_16x16x32_bf16 v[116:119], a[216:219], a[24:27], 0
    ds_read_b128 a[192:195], v2 offset:0
    v_mfma_f32_16x16x32_bf16 v[116:119], a[220:223], a[28:31], v[116:119]
    v_mfma_f32_16x16x32_bf16 v[116:119], a[224:227], a[32:35], v[116:119]
    ds_read_b128 a[196:199], v2 offset:1024
    v_cvt_pk_bf16_f32 v194, v112, v113
    v_mfma_f32_16x16x32_bf16 v[116:119], a[228:231], a[36:39], v[116:119]
    v_cvt_pk_bf16_f32 v195, v114, v115
    v_mfma_f32_16x16x32_bf16 v[116:119], a[232:235], a[40:43], v[116:119]
    v_mfma_f32_16x16x32_bf16 v[116:119], a[236:239], a[44:47], v[116:119]
    v_mfma_f32_16x16x32_bf16 v[120:123], a[216:219], a[48:51], 0
    v_mfma_f32_16x16x32_bf16 v[120:123], a[220:223], a[52:55], v[120:123]
    v_mfma_f32_16x16x32_bf16 v[120:123], a[224:227], a[56:59], v[120:123]
    v_cvt_pk_bf16_f32 v198, v116, v117
    v_cvt_pk_bf16_f32 v199, v118, v119
    v_mfma_f32_16x16x32_bf16 v[120:123], a[228:231], a[60:63], v[120:123]
    buffer_load_dwordx4 a[136:139], v9, s[8:11], s26 offen offset:256 nt
    v_mfma_f32_16x16x32_bf16 v[120:123], a[232:235], a[64:67], v[120:123]
    buffer_load_dwordx4 a[140:143], v10, s[8:11], s26 offen offset:256 nt
    s_add_u32 s26, s16, 6684672
    v_mfma_f32_16x16x32_bf16 v[120:123], a[236:239], a[68:71], v[120:123]
    v_mfma_f32_16x16x32_bf16 v[124:127], a[216:219], a[72:75], 0
    v_mfma_f32_16x16x32_bf16 v[124:127], a[220:223], a[76:79], v[124:127]
    v_mfma_f32_16x16x32_bf16 v[124:127], a[224:227], a[80:83], v[124:127]
    v_cvt_pk_bf16_f32 v202, v120, v121
    v_cvt_pk_bf16_f32 v203, v122, v123
    v_mfma_f32_16x16x32_bf16 v[124:127], a[228:231], a[84:87], v[124:127]
    v_mfma_f32_16x16x32_bf16 v[124:127], a[232:235], a[88:91], v[124:127]
    ds_read_b128 a[200:203], v2 offset:2048
    v_mfma_f32_16x16x32_bf16 v[124:127], a[236:239], a[92:95], v[124:127]
    s_waitcnt lgkmcnt(1)
    v_mfma_f32_16x16x32_bf16 v[96:99], a[240:243], a[0:3], 0
    ds_read_b128 a[204:207], v2 offset:3072
    v_mfma_f32_16x16x32_bf16 v[96:99], a[244:247], a[4:7], v[96:99]
    v_mfma_f32_16x16x32_bf16 v[96:99], a[248:251], a[8:11], v[96:99]
    ds_read_b128 a[208:211], v2 offset:4096
    v_cvt_pk_bf16_f32 v206, v124, v125
    v_mfma_f32_16x16x32_bf16 v[96:99], a[252:255], a[12:15], v[96:99]
    v_cvt_pk_bf16_f32 v207, v126, v127
    v_mfma_f32_16x16x32_bf16 v[96:99], a[192:195], a[16:19], v[96:99]
    ds_read_b128 a[212:215], v2 offset:5120
    v_mfma_f32_16x16x32_bf16 v[96:99], a[196:199], a[20:23], v[96:99]
    v_mfma_f32_16x16x32_bf16 v[100:103], a[240:243], a[24:27], 0
    ds_read_b128 a[216:219], v2 offset:6144
    v_mfma_f32_16x16x32_bf16 v[100:103], a[244:247], a[28:31], v[100:103]
    v_mfma_f32_16x16x32_bf16 v[100:103], a[248:251], a[32:35], v[100:103]
    ds_read_b32 v30, v29
    v_cvt_pk_bf16_f32 v208, v96, v97
    v_mfma_f32_16x16x32_bf16 v[100:103], a[252:255], a[36:39], v[100:103]
    ds_read_b128 a[220:223], v2 offset:7168
    v_cvt_pk_bf16_f32 v209, v98, v99
    v_mfma_f32_16x16x32_bf16 v[100:103], a[192:195], a[40:43], v[100:103]
    v_mfma_f32_16x16x32_bf16 v[100:103], a[196:199], a[44:47], v[100:103]
    v_mfma_f32_16x16x32_bf16 v[104:107], a[240:243], a[48:51], 0
    v_mfma_f32_16x16x32_bf16 v[104:107], a[244:247], a[52:55], v[104:107]
    v_mfma_f32_16x16x32_bf16 v[104:107], a[248:251], a[56:59], v[104:107]
    v_cvt_pk_bf16_f32 v212, v100, v101
    v_cvt_pk_bf16_f32 v213, v102, v103
    v_mfma_f32_16x16x32_bf16 v[104:107], a[252:255], a[60:63], v[104:107]
    v_mfma_f32_16x16x32_bf16 v[104:107], a[192:195], a[64:67], v[104:107]
    buffer_load_dwordx4 a[144:147], v9, s[8:11], s28 offen offset:0 nt
    v_mfma_f32_16x16x32_bf16 v[104:107], a[196:199], a[68:71], v[104:107]
    buffer_load_dwordx4 a[148:151], v10, s[8:11], s28 offen offset:0 nt
    v_mfma_f32_16x16x32_bf16 v[108:111], a[240:243], a[72:75], 0
    s_waitcnt vmcnt(13)
    ds_write_b64 v4, a[96:97] offset:0
    v_mfma_f32_16x16x32_bf16 v[108:111], a[244:247], a[76:79], v[108:111]
    ds_write_b64 v4, a[98:99] offset:1024
    v_mfma_f32_16x16x32_bf16 v[108:111], a[248:251], a[80:83], v[108:111]
    s_waitcnt vmcnt(12)
    ds_write_b64 v4, a[100:101] offset:512
    v_mfma_f32_16x16x32_bf16 v[108:111], a[252:255], a[84:87], v[108:111]
    ds_write_b64 v4, a[102:103] offset:1536
    v_mfma_f32_16x16x32_bf16 v[108:111], a[192:195], a[88:91], v[108:111]
    ds_read2_b64 a[96:99], v5 offset0:0 offset1:128
    v_cvt_pk_bf16_f32 v216, v104, v105
    v_mfma_f32_16x16x32_bf16 v[108:111], a[196:199], a[92:95], v[108:111]
    ds_read2_b64 a[100:103], v6 offset0:0 offset1:128
    s_waitcnt lgkmcnt(6)
    v_mfma_f32_16x16x32_bf16 v[112:115], a[200:203], a[0:3], 0
    v_readfirstlane_b32 s41, v30
    v_cvt_pk_bf16_f32 v217, v106, v107
    v_mfma_f32_16x16x32_bf16 v[112:115], a[204:207], a[4:7], v[112:115]
    s_andn2_b32 s41, 960, s41
    s_cbranch_scc1 L_slow6
L_ok6:
    v_mfma_f32_16x16x32_bf16 v[112:115], a[208:211], a[8:11], v[112:115]
    ds_read_b128 a[224:227], v2 offset:8192
    v_cvt_pk_bf16_f32 v220, v108, v109
    v_mfma_f32_16x16x32_bf16 v[112:115], a[212:215], a[12:15], v[112:115]
    ds_read_b128 a[228:231], v2 offset:9216
    v_cvt_pk_bf16_f32 v221, v110, v111
    v_mfma_f32_16x16x32_bf16 v[112:115], a[216:219], a[16:19], v[112:115]
    ds_read_b128 a[232:235], v2 offset:10240
    v_mfma_f32_16x16x32_bf16 v[112:115], a[220:223], a[20:23], v[112:115]
    ds_read_b128 a[236:239], v2 offset:11264
    v_mfma_f32_16x16x32_bf16 v[116:119], a[200:203], a[24:27], 0
    ds_read_b128 a[240:243], v2 offset:12288
    v_mfma_f32_16x16x32_bf16 v[116:119], a[204:207], a[28:31], v[116:119]
    v_mfma_f32_16x16x32_bf16 v[116:119], a[208:211], a[32:35], v[116:119]
    ds_read_b128 a[244:247], v2 offset:13312
    v_cvt_pk_bf16_f32 v210, v112, v113
    v_mfma_f32_16x16x32_bf16 v[116:119], a[212:215], a[36:39], v[116:119]
    v_cvt_pk_bf16_f32 v211, v114, v115
    v_mfma_f32_16x16x32_bf16 v[116:119], a[216:219], a[40:43], v[116:119]
    v_mfma_f32_16x16x32_bf16 v[116:119], a[220:223], a[44:47], v[116:119]
    v_mfma_f32_16x16x32_bf16 v[120:123], a[200:203], a[48:51], 0
    v_mfma_f32_16x16x32_bf16 v[120:123], a[204:207], a[52:55], v[120:123]
    v_mfma_f32_16x16x32_bf16 v[120:123], a[208:211], a[56:59], v[120:123]
    v_cvt_pk_bf16_f32 v214, v116, v117
    v_cvt_pk_bf16_f32 v215, v118, v119
    v_mfma_f32_16x16x32_bf16 v[120:123], a[212:215], a[60:63], v[120:123]
    v_mfma_f32_16x16x32_bf16 v[120:123], a[216:219], a[64:67], v[120:123]
    v_mfma_f32_16x16x32_bf16 v[120:123], a[220:223], a[68:71], v[120:123]
    buffer_load_dwordx4 a[152:155], v9, s[8:11], s28 offen offset:128 nt
    v_mfma_f32_16x16x32_bf16 v[124:127], a[200:203], a[72:75], 0
    buffer_load_dwordx4 a[156:159], v10, s[8:11], s28 offen offset:128 nt
    v_mfma_f32_16x16x32_bf16 v[124:127], a[204:207], a[76:79], v[124:127]
    s_waitcnt vmcnt(13)
    ds_write_b64 v4, a[104:105] offset:0
    v_mfma_f32_16x16x32_bf16 v[124:127], a[208:211], a[80:83], v[124:127]
    ds_write_b64 v4, a[106:107] offset:1024
    v_mfma_f32_16x16x32_bf16 v[124:127], a[212:215], a[84:87], v[124:127]
    s_waitcnt vmcnt(12)
    ds_write_b64 v4, a[108:109] offset:512
    v_mfma_f32_16x16x32_bf16 v[124:127], a[216:219], a[88:91], v[124:127]
    ds_write_b64 v4, a[110:111] offset:1536
    v_mfma_f32_16x16x32_bf16 v[124:127], a[220:223], a[92:95], v[124:127]
    ds_read2_b64 a[104:107], v5 offset0:0 offset1:128
    s_waitcnt lgkmcnt(5)
    v_mfma_f32_16x16x32_bf16 v[96:99], a[0:3], a[224:227], 0
    ds_read2_b64 a[108:111], v6 offset0:0 offset1:128
    v_cvt_pk_bf16_f32 v218, v120, v121
    v_mfma_f32_16x16x32_bf16 v[96:99], a[4:7], a[228:231], v[96:99]
    v_cvt_pk_bf16_f32 v219, v122, v123
    v_mfma_f32_16x16x32_bf16 v[96:99], a[8:11], a[232:235], v[96:99]
    v_cvt_pk_bf16_f32 v222, v124, v125
    v_cvt_pk_bf16_f32 v223, v126, v127
    v_mfma_f32_16x16x32_bf16 v[96:99], a[12:15], a[236:239], v[96:99]
    v_mfma_f32_16x16x32_bf16 v[96:99], a[16:19], a[240:243], v[96:99]
    v_mfma_f32_16x16x32_bf16 v[96:99], a[20:23], a[244:247], v[96:99]
    v_mfma_f32_16x16x32_bf16 v[100:103], a[24:27], a[224:227], 0
    v_mfma_f32_16x16x32_bf16 v[100:103], a[28:31], a[228:231], v[100:103]
    v_mfma_f32_16x16x32_bf16 v[100:103], a[32:35], a[232:235], v[100:103]
    v_cvt_pk_bf16_f32 v128, v96, v97
    v_cvt_pk_bf16_f32 v129, v98, v99
    v_mfma_f32_16x16x32_bf16 v[100:103], a[36:39], a[236:239], v[100:103]
    v_mfma_f32_16x16x32_bf16 v[100:103], a[40:43], a[240:243], v[100:103]
    v_mfma_f32_16x16x32_bf16 v[100:103], a[44:47], a[244:247], v[100:103]
    v_mfma_f32_16x16x32_bf16 v[32:35], a[16:19], v[192:195], v[32:35]
    v_mfma_f32_16x16x32_bf16 v[32:35], a[20:23], v[208:211], v[32:35]
    v_mfma_f32_16x16x32_bf16 v[36:39], a[40:43], v[192:195], v[36:39]
    v_cvt_pk_bf16_f32 v130, v100, v101
    v_cvt_pk_bf16_f32 v131, v102, v103
    v_mfma_f32_16x16x32_bf16 v[36:39], a[44:47], v[208:211], v[36:39]
    v_mfma_f32_16x16x32_bf16 v[40:43], a[64:67], v[192:195], v[40:43]
    v_max3_f32 v12, v32, v33, v34
    v_mfma_f32_16x16x32_bf16 v[40:43], a[68:71], v[208:211], v[40:43]
    v_mfma_f32_16x16x32_bf16 v[44:47], a[88:91], v[192:195], v[44:47]
    buffer_load_dwordx4 a[160:163], v9, s[8:11], s28 offen offset:256 nt
    v_max3_f32 v12, v12, v35, v36
    v_mfma_f32_16x16x32_bf16 v[44:47], a[92:95], v[208:211], v[44:47]
    buffer_load_dwordx4 a[164:167], v10, s[8:11], s28 offen offset:256 nt
    v_max3_f32 v12, v12, v37, v38
    v_mfma_f32_16x16x32_bf16 v[48:51], a[16:19], v[196:199], v[48:51]
    s_waitcnt vmcnt(13)
    ds_write_b64 v4, a[112:113] offset:0
    v_mfma_f32_16x16x32_bf16 v[48:51], a[20:23], v[212:215], v[48:51]
    ds_write_b64 v4, a[114:115] offset:1024
    v_mfma_f32_16x16x32_bf16 v[52:55], a[40:43], v[196:199], v[52:55]
    s_waitcnt vmcnt(12)
    ds_write_b64 v4, a[116:117] offset:512
    v_mfma_f32_16x16x32_bf16 v[52:55], a[44:47], v[212:215], v[52:55]
    ds_write_b64 v4, a[118:119] offset:1536
    v_mfma_f32_16x16x32_bf16 v[56:59], a[64:67], v[196:199], v[56:59]
    ds_read2_b64 a[112:115], v5 offset0:0 offset1:128
    v_max3_f32 v13, v48, v49, v50
    v_mfma_f32_16x16x32_bf16 v[56:59], a[68:71], v[212:215], v[56:59]
    ds_read2_b64 a[116:119], v6 offset0:0 offset1:128
    v_max3_f32 v12, v12, v39, v40
    v_mfma_f32_16x16x32_bf16 v[60:63], a[88:91], v[196:199], v[60:63]
    v_max3_f32 v13, v13, v51, v52
    v_max3_f32 v13, v13, v53, v54
    v_mfma_f32_16x16x32_bf16 v[60:63], a[92:95], v[212:215], v[60:63]
    v_max3_f32 v12, v12, v41, v42
    v_max3_f32 v12, v12, v43, v44
    v_mfma_f32_16x16x32_bf16 v[64:67], a[16:19], v[200:203], v[64:67]
    v_max3_f32 v13, v13, v55, v56
    v_max3_f32 v13, v13, v57, v58
    v_mfma_f32_16x16x32_bf16 v[64:67], a[20:23], v[216:219], v[64:67]
    v_max3_f32 v12, v12, v45, v46
    v_max_f32 v12, v12, v47
    v_mfma_f32_16x16x32_bf16 v[68:71], a[40:43], v[200:203], v[68:71]
    ds_read_b128 a[248:251], v2 offset:14336
    v_max3_f32 v13, v13, v59, v60
    v_mfma_f32_16x16x32_bf16 v[68:71], a[44:47], v[216:219], v[68:71]
    v_max3_f32 v13, v13, v61, v62
    v_max_f32 v13, v13, v63
    v_mfma_f32_16x16x32_bf16 v[72:75], a[64:67], v[200:203], v[72:75]
    ds_read_b128 a[252:255], v2 offset:15360
    v_max3_f32 v14, v64, v65, v66
    v_mfma_f32_16x16x32_bf16 v[72:75], a[68:71], v[216:219], v[72:75]
    v_permlane16_swap_b32 v12, v13
    v_max_f32 v12, v12, v13
    v_mfma_f32_16x16x32_bf16 v[76:79], a[88:91], v[200:203], v[76:79]
    ds_read_b128 a[192:195], v2 offset:16384
    v_max3_f32 v14, v14, v67, v68
    v_mfma_f32_16x16x32_bf16 v[76:79], a[92:95], v[216:219], v[76:79]
    v_max3_f32 v14, v14, v69, v70
    s_add_u32 s28, s16, 7077888
    v_mfma_f32_16x16x32_bf16 v[80:83], a[16:19], v[204:207], v[80:83]
    ds_read_b128 a[196:199], v2 offset:17408
    v_max3_f32 v14, v14, v71, v72
    v_mfma_f32_16x16x32_bf16 v[80:83], a[20:23], v[220:223], v[80:83]
    v_max3_f32 v14, v14, v73, v74
    v_mfma_f32_16x16x32_bf16 v[84:87], a[40:43], v[204:207], v[84:87]
    ds_read_b128 a[200:203], v2 offset:18432
    v_max3_f32 v14, v14, v75, v76
    v_mfma_f32_16x16x32_bf16 v[84:87], a[44:47], v[220:223], v[84:87]
    v_max3_f32 v14, v14, v77, v78
    v_max_f32 v14, v14, v79
    v_mfma_f32_16x16x32_bf16 v[88:91], a[64:67], v[204:207], v[88:91]
    ds_read_b128 a[204:207], v2 offset:19456
    v_max3_f32 v15, v80, v81, v82
    v_mfma_f32_16x16x32_bf16 v[88:91], a[68:71], v[220:223], v[88:91]
    v_mfma_f32_16x16x32_bf16 v[92:95], a[88:91], v[204:207], v[92:95]
    v_max3_f32 v15, v15, v83, v84
    v_max3_f32 v15, v15, v85, v86
    v_mfma_f32_16x16x32_bf16 v[92:95], a[92:95], v[220:223], v[92:95]
    buffer_load_dwordx4 a[168:171], v9, s[8:11], s30 offen offset:0 nt
    v_mfma_f32_16x16x32_bf16 v[104:107], a[48:51], a[224:227], 0
    buffer_load_dwordx4 a[172:175], v10, s[8:11], s30 offen offset:0 nt
    v_max3_f32 v15, v15, v87, v88
    v_mfma_f32_16x16x32_bf16 v[104:107], a[52:55], a[228:231], v[104:107]
    v_max3_f32 v15, v15, v89, v90
    v_mfma_f32_16x16x32_bf16 v[104:107], a[56:59], a[232:235], v[104:107]
    v_max3_f32 v15, v15, v91, v92
    v_max3_f32 v15, v15, v93, v94
    v_mfma_f32_16x16x32_bf16 v[104:107], a[60:63], a[236:239], v[104:107]
    v_max_f32 v15, v15, v95
    v_mfma_f32_16x16x32_bf16 v[104:107], a[64:67], a[240:243], v[104:107]
    v_mfma_f32_16x16x32_bf16 v[104:107], a[68:71], a[244:247], v[104:107]
    v_permlane16_swap_b32 v14, v15
    v_max_f32 v14, v14, v15
    v_mfma_f32_16x16x32_bf16 v[108:111], a[72:75], a[224:227], 0
    v_mfma_f32_16x16x32_bf16 v[108:111], a[76:79], a[228:231], v[108:111]
    v_permlane32_swap_b32 v12, v14
    v_max_f32 v12, v12, v14
    v_mfma_f32_16x16x32_bf16 v[108:111], a[80:83], a[232:235], v[108:111]
    v_cvt_pk_bf16_f32 v132, v104, v105
    v_cvt_pk_bf16_f32 v133, v106, v107
    v_mfma_f32_16x16x32_bf16 v[108:111], a[84:87], a[236:239], v[108:111]
    v_mov_b32 v14, v12
    v_mfma_f32_16x16x32_bf16 v[108:111], a[88:91], a[240:243], v[108:111]
    ds_read_b128 a[208:211], v2 offset:20480
    v_permlane32_swap_b32 v12, v14
    v_mfma_f32_16x16x32_bf16 v[108:111], a[92:95], a[244:247], v[108:111]
    v_mov_b32 v13, v12
    s_waitcnt lgkmcnt(1)
    v_mfma_f32_16x16x32_bf16 v[112:115], a[0:3], a[248:251], 0
    ds_read_b128 a[212:215], v2 offset:21504
    v_mov_b32 v15, v14
    v_mfma_f32_16x16x32_bf16 v[112:115], a[4:7], a[252:255], v[112:115]
    v_permlane16_swap_b32 v12, v13
    v_permlane16_swap_b32 v14, v15
    v_mfma_f32_16x16x32_bf16 v[112:115], a[8:11], a[192:195], v[112:115]
    ds_read_b128 a[216:219], v2 offset:22528
    v_cvt_pk_bf16_f32 v134, v108, v109
    v_mfma_f32_16x16x32_bf16 v[112:115], a[12:15], a[196:199], v[112:115]
    v_cvt_pk_bf16_f32 v135, v110, v111
    v_sub_f32 v32, v32, v12
    v_mfma_f32_16x16x32_bf16 v[112:115], a[16:19], a[200:203], v[112:115]
    ds_read_b128 a[220:223], v2 offset:23552
    v_sub_f32 v33, v33, v12
    v_mfma_f32_16x16x32_bf16 v[112:115], a[20:23], a[204:207], v[112:115]
    v_sub_f32 v48, v48, v13
    v_sub_f32 v49, v49, v13
    v_mfma_f32_16x16x32_bf16 v[116:119], a[24:27], a[248:251], 0
    ds_read_b128 a[224:227], v2 offset:24576
    v_sub_f32 v64, v64, v14
    v_mfma_f32_16x16x32_bf16 v[116:119], a[28:31], a[252:255], v[116:119]
    v_sub_f32 v65, v65, v14
    v_sub_f32 v80, v80, v15
    v_mfma_f32_16x16x32_bf16 v[116:119], a[32:35], a[192:195], v[116:119]
    ds_read_b128 a[228:231], v2 offset:25600
    v_cvt_pk_bf16_f32 v136, v112, v113
    v_mfma_f32_16x16x32_bf16 v[116:119], a[36:39], a[196:199], v[116:119]
    v_cvt_pk_bf16_f32 v137, v114, v115
    v_sub_f32 v81, v81, v15
    v_mfma_f32_16x16x32_bf16 v[116:119], a[40:43], a[200:203], v[116:119]
    v_exp_f32 v32, v32
    v_mfma_f32_16x16x32_bf16 v[116:119], a[44:47], a[204:207], v[116:119]
    v_exp_f32 v33, v33
    v_mfma_f32_16x16x32_bf16 v[120:123], a[48:51], a[248:251], 0
    buffer_load_dwordx4 a[176:179], v9, s[8:11], s30 offen offset:128 nt
    v_sub_f32 v34, v34, v12
    v_mfma_f32_16x16x32_bf16 v[120:123], a[52:55], a[252:255], v[120:123]
    buffer_load_dwordx4 a[180:183], v10, s[8:11], s30 offen offset:128 nt
    v_sub_f32 v50, v50, v13
    v_mfma_f32_16x16x32_bf16 v[120:123], a[56:59], a[192:195], v[120:123]
    v_cvt_pk_bf16_f32 v138, v116, v117
    v_cvt_pk_bf16_f32 v139, v118, v119
    v_mfma_f32_16x16x32_bf16 v[120:123], a[60:63], a[196:199], v[120:123]
    v_exp_f32 v48, v48
    v_mfma_f32_16x16x32_bf16 v[120:123], a[64:67], a[200:203], v[120:123]
    v_exp_f32 v49, v49
    v_mfma_f32_16x16x32_bf16 v[120:123], a[68:71], a[204:207], v[120:123]
    v_exp_f32 v64, v64
    v_mfma_f32_16x16x32_bf16 v[124:127], a[72:75], a[248:251], 0
    v_exp_f32 v65, v65
    v_mfma_f32_16x16x32_bf16 v[124:127], a[76:79], a[252:255], v[124:127]
    v_sub_f32 v66, v66, v14
    v_sub_f32 v82, v82, v15
    v_mfma_f32_16x16x32_bf16 v[124:127], a[80:83], a[192:195], v[124:127]
    v_cvt_pk_bf16_f32 v140, v120, v121
    v_cvt_pk_bf16_f32 v141, v122, v123
    v_mfma_f32_16x16x32_bf16 v[124:127], a[84:87], a[196:199], v[124:127]
    v_exp_f32 v80, v80
    v_mfma_f32_16x16x32_bf16 v[124:127], a[88:91], a[200:203], v[124:127]
    ds_read_b128 a[232:235], v2 offset:26624
    v_sub_f32 v35, v35, v12
    v_mfma_f32_16x16x32_bf16 v[124:127], a[92:95], a[204:207], v[124:127]
    v_sub_f32 v51, v51, v13
    s_waitcnt lgkmcnt(1)
    v_mfma_f32_16x16x32_bf16 v[96:99], a[0:3], a[208:211], 0
    ds_read_b128 a[236:239], v2 offset:27648
    v_sub_f32 v67, v67, v14
    v_mfma_f32_16x16x32_bf16 v[96:99], a[4:7], a[212:215], v[96:99]
    v_exp_f32 v81, v81
    v_mfma_f32_16x16x32_bf16 v[96:99], a[8:11], a[216:219], v[96:99]
    ds_read_b128 a[240:243], v2 offset:28672
    v_cvt_pk_bf16_f32 v142, v124, v125
    v_mfma_f32_16x16x32_bf16 v[96:99], a[12:15], a[220:223], v[96:99]
    v_cvt_pk_bf16_f32 v143, v126, v127
    v_sub_f32 v83, v83, v15
    v_mfma_f32_16x16x32_bf16 v[96:99], a[16:19], a[224:227], v[96:99]
    ds_read_b128 a[244:247], v2 offset:29696
    v_sub_f32 v36, v36, v12
    v_mfma_f32_16x16x32_bf16 v[96:99], a[20:23], a[228:231], v[96:99]
    v_exp_f32 v34, v34
    v_mfma_f32_16x16x32_bf16 v[100:103], a[24:27], a[208:211], 0
    ds_read_b128 a[248:251], v2 offset:30720
    v_sub_f32 v52, v52, v13
    v_mfma_f32_16x16x32_bf16 v[100:103], a[28:31], a[212:215], v[100:103]
    v_exp_f32 v50, v50
    v_mfma_f32_16x16x32_bf16 v[100:103], a[32:35], a[216:219], v[100:103]
    ds_read_b128 a[252:255], v2 offset:31744
    v_cvt_pk_bf16_f32 v144, v96, v97
    v_mfma_f32_16x16x32_bf16 v[100:103], a[36:39], a[220:223], v[100:103]
    v_cvt_pk_bf16_f32 v145, v98, v99
    v_sub_f32 v68, v68, v14
    v_mfma_f32_16x16x32_bf16 v[100:103], a[40:43], a[224:227], v[100:103]
    v_exp_f32 v66, v66
    v_mfma_f32_16x16x32_bf16 v[100:103], a[44:47], a[228:231], v[100:103]
    v_exp_f32 v82, v82
    v_mfma_f32_16x16x32_bf16 v[104:107], a[48:51], a[208:211], 0
    v_exp_f32 v35, v35
    v_mfma_f32_16x16x32_bf16 v[104:107], a[52:55], a[212:215], v[104:107]
    buffer_load_dwordx4 a[184:187], v9, s[8:11], s30 offen offset:256 nt
    v_sub_f32 v84, v84, v15
    v_mfma_f32_16x16x32_bf16 v[104:107], a[56:59], a[216:219], v[104:107]
    buffer_load_dwordx4 a[188:191], v10, s[8:11], s30 offen offset:256 nt
    v_cvt_pk_bf16_f32 v146, v100, v101
    v_mfma_f32_16x16x32_bf16 v[104:107], a[60:63], a[220:223], v[104:107]
    v_cvt_pk_bf16_f32 v147, v102, v103
    v_add_f32 v20, v32, v33
    v_mfma_f32_16x16x32_bf16 v[104:107], a[64:67], a[224:227], v[104:107]
    v_exp_f32 v51, v51
    v_mfma_f32_16x16x32_bf16 v[104:107], a[68:71], a[228:231], v[104:107]
    v_exp_f32 v67, v67
    v_mfma_f32_16x16x32_bf16 v[108:111], a[72:75], a[208:211], 0
    v_exp_f32 v83, v83
    v_mfma_f32_16x16x32_bf16 v[108:111], a[76:79], a[212:215], v[108:111]
    v_exp_f32 v36, v36
    v_mfma_f32_16x16x32_bf16 v[108:111], a[80:83], a[216:219], v[108:111]
    v_cvt_pk_bf16_f32 v148, v104, v105
    v_cvt_pk_bf16_f32 v149, v106, v107
    v_mfma_f32_16x16x32_bf16 v[108:111], a[84:87], a[220:223], v[108:111]
    v_sub_f32 v37, v37, v12
    v_add_f32 v21, v48, v49
    v_mfma_f32_16x16x32_bf16 v[108:111], a[88:91], a[224:227], v[108:111]
    ds_read_b128 a[192:195], v2 offset:32768
    v_sub_f32 v53, v53, v13
    v_mfma_f32_16x16x32_bf16 v[108:111], a[92:95], a[228:231], v[108:111]
    v_add_f32 v22, v64, v65
    s_waitcnt lgkmcnt(1)
    v_mfma_f32_16x16x32_bf16 v[112:115], a[0:3], a[232:235], 0
    ds_read_b128 a[196:199], v2 offset:33792
    v_sub_f32 v69, v69, v14
    v_mfma_f32_16x16x32_bf16 v[112:115], a[4:7], a[236:239], v[112:115]
    v_exp_f32 v52, v52
    v_mfma_f32_16x16x32_bf16 v[112:115], a[8:11], a[240:243], v[112:115]
    ds_read_b128 a[200:203], v2 offset:34816
    v_cvt_pk_bf16_f32 v150, v108, v109
    v_mfma_f32_16x16x32_bf16 v[112:115], a[12:15], a[244:247], v[112:115]
    v_cvt_pk_bf16_f32 v151, v110, v111
    v_add_f32 v23, v80, v81
    v_mfma_f32_16x16x32_bf16 v[112:115], a[16:19], a[248:251], v[112:115]
    ds_read_b128 a[204:207], v2 offset:35840
    v_sub_f32 v85, v85, v15
    v_mfma_f32_16x16x32_bf16 v[112:115], a[20:23], a[252:255], v[112:115]
    v_exp_f32 v68, v68
    v_mfma_f32_16x16x32_bf16 v[116:119], a[24:27], a[232:235], 0
    ds_read_b128 a[208:211], v2 offset:36864
    v_add_f32 v20, v20, v34
    v_mfma_f32_16x16x32_bf16 v[116:119], a[28:31], a[236:239], v[116:119]
    v_exp_f32 v84, v84
    v_mfma_f32_16x16x32_bf16 v[116:119], a[32:35], a[240:243], v[116:119]
    ds_read_b128 a[212:215], v2 offset:37888
    v_cvt_pk_bf16_f32 v152, v112, v113
    v_mfma_f32_16x16x32_bf16 v[116:119], a[36:39], a[244:247], v[116:119]
    v_cvt_pk_bf16_f32 v153, v114, v115
    v_sub_f32 v38, v38, v12
    v_mfma_f32_16x16x32_bf16 v[116:119], a[40:43], a[248:251], v[116:119]
    v_exp_f32 v37, v37
    v_mfma_f32_16x16x32_bf16 v[116:119], a[44:47], a[252:255], v[116:119]
    v_add_f32 v21, v21, v50
    v_sub_f32 v54, v54, v13
    v_mfma_f32_16x16x32_bf16 v[120:123], a[48:51], a[232:235], 0
    v_exp_f32 v53, v53
    v_mfma_f32_16x16x32_bf16 v[120:123], a[52:55], a[236:239], v[120:123]
    v_add_f32 v22, v22, v66
    v_sub_f32 v70, v70, v14
    v_mfma_f32_16x16x32_bf16 v[120:123], a[56:59], a[240:243], v[120:123]
    v_cvt_pk_bf16_f32 v154, v116, v117
    v_cvt_pk_bf16_f32 v155, v118, v119
    v_mfma_f32_16x16x32_bf16 v[120:123], a[60:63], a[244:247], v[120:123]
    v_exp_f32 v69, v69
    v_mfma_f32_16x16x32_bf16 v[120:123], a[64:67], a[248:251], v[120:123]
    v_add_f32 v23, v23, v82
    v_sub_f32 v86, v86, v15
    v_mfma_f32_16x16x32_bf16 v[120:123], a[68:71], a[252:255], v[120:123]
    v_exp_f32 v85, v85
    v_mfma_f32_16x16x32_bf16 v[124:127], a[72:75], a[232:235], 0
    v_add_f32 v20, v20, v35
    v_sub_f32 v39, v39, v12
    v_mfma_f32_16x16x32_bf16 v[124:127], a[76:79], a[236:239], v[124:127]
    v_exp_f32 v38, v38
    v_mfma_f32_16x16x32_bf16 v[124:127], a[80:83], a[240:243], v[124:127]
    v_cvt_pk_bf16_f32 v156, v120, v121
    v_cvt_pk_bf16_f32 v157, v122, v123
    v_mfma_f32_16x16x32_bf16 v[124:127], a[84:87], a[244:247], v[124:127]
    v_add_f32 v21, v21, v51
    v_sub_f32 v55, v55, v13
    v_mfma_f32_16x16x32_bf16 v[124:127], a[88:91], a[248:251], v[124:127]
    ds_read_b128 a[216:219], v2 offset:38912
    v_add_f32 v22, v22, v67
    v_mfma_f32_16x16x32_bf16 v[124:127], a[92:95], a[252:255], v[124:127]
    v_sub_f32 v71, v71, v14
    s_waitcnt lgkmcnt(1)
    v_mfma_f32_16x16x32_bf16 v[96:99], a[0:3], a[192:195], 0
    ds_read_b128 a[220:223], v2 offset:39936
    v_add_f32 v23, v23, v83
    v_mfma_f32_16x16x32_bf16 v[96:99], a[4:7], a[196:199], v[96:99]
    v_exp_f32 v54, v54
    v_mfma_f32_16x16x32_bf16 v[96:99], a[8:11], a[200:203], v[96:99]
    ds_read_b128 a[224:227], v2 offset:40960
    v_cvt_pk_bf16_f32 v158, v124, v125
    v_mfma_f32_16x16x32_bf16 v[96:99], a[12:15], a[204:207], v[96:99]
    v_cvt_pk_bf16_f32 v159, v126, v127
    v_sub_f32 v87, v87, v15
    v_mfma_f32_16x16x32_bf16 v[96:99], a[16:19], a[208:211], v[96:99]
    ds_read_b128 a[228:231], v2 offset:41984
    v_add_f32 v20, v20, v36
    v_mfma_f32_16x16x32_bf16 v[96:99], a[20:23], a[212:215], v[96:99]
    v_exp_f32 v70, v70
    v_mfma_f32_16x16x32_bf16 v[100:103], a[24:27], a[192:195], 0
    ds_read_b128 a[232:235], v2 offset:43008
    v_sub_f32 v40, v40, v12
    v_mfma_f32_16x16x32_bf16 v[100:103], a[28:31], a[196:199], v[100:103]
    v_exp_f32 v86, v86
    v_mfma_f32_16x16x32_bf16 v[100:103], a[32:35], a[200:203], v[100:103]
    ds_read_b128 a[236:239], v2 offset:44032
    v_cvt_pk_bf16_f32 v160, v96, v97
    v_mfma_f32_16x16x32_bf16 v[100:103], a[36:39], a[204:207], v[100:103]
    v_cvt_pk_bf16_f32 v161, v98, v99
    v_add_f32 v21, v21, v52
    v_mfma_f32_16x16x32_bf16 v[100:103], a[40:43], a[208:211], v[100:103]
    v_exp_f32 v39, v39
    v_mfma_f32_16x16x32_bf16 v[100:103], a[44:47], a[212:215], v[100:103]
    v_exp_f32 v55, v55
    v_mfma_f32_16x16x32_bf16 v[104:107], a[48:51], a[192:195], 0
    v_sub_f32 v56, v56, v13
    v_add_f32 v22, v22, v68
    v_mfma_f32_16x16x32_bf16 v[104:107], a[52:55], a[196:199], v[104:107]
    v_exp_f32 v71, v71
    v_mfma_f32_16x16x32_bf16 v[104:107], a[56:59], a[200:203], v[104:107]
    v_cvt_pk_bf16_f32 v162, v100, v101
    v_cvt_pk_bf16_f32 v163, v102, v103
    v_mfma_f32_16x16x32_bf16 v[104:107], a[60:63], a[204:207], v[104:107]
    v_sub_f32 v72, v72, v14
    v_add_f32 v23, v23, v84
    v_mfma_f32_16x16x32_bf16 v[104:107], a[64:67], a[208:211], v[104:107]
    v_exp_f32 v87, v87
    v_mfma_f32_16x16x32_bf16 v[104:107], a[68:71], a[212:215], v[104:107]
    v_sub_f32 v88, v88, v15
    v_add_f32 v20, v20, v37
    v_mfma_f32_16x16x32_bf16 v[108:111], a[72:75], a[192:195], 0
    v_exp_f32 v40, v40
    v_mfma_f32_16x16x32_bf16 v[108:111], a[76:79], a[196:199], v[108:111]
    v_sub_f32 v41, v41, v12
    v_add_f32 v21, v21, v53
    v_mfma_f32_16x16x32_bf16 v[108:111], a[80:83], a[200:203], v[108:111]
    v_cvt_pk_bf16_f32 v164, v104, v105
    v_cvt_pk_bf16_f32 v165, v106, v107
    v_mfma_f32_16x16x32_bf16 v[108:111], a[84:87], a[204:207], v[108:111]
    v_exp_f32 v56, v56
    v_mfma_f32_16x16x32_bf16 v[108:111], a[88:91], a[208:211], v[108:111]
    ds_read_b128 a[240:243], v2 offset:45056
    v_sub_f32 v57, v57, v13
    v_mfma_f32_16x16x32_bf16 v[108:111], a[92:95], a[212:215], v[108:111]
    v_add_f32 v22, v22, v69
    s_waitcnt lgkmcnt(1)
    v_mfma_f32_16x16x32_bf16 v[112:115], a[0:3], a[216:219], 0
    ds_read_b128 a[244:247], v2 offset:46080
    v_sub_f32 v73, v73, v14
    v_mfma_f32_16x16x32_bf16 v[112:115], a[4:7], a[220:223], v[112:115]
    v_exp_f32 v72, v72
    v_mfma_f32_16x16x32_bf16 v[112:115], a[8:11], a[224:227], v[112:115]
    ds_read_b128 a[248:251], v2 offset:47104
    v_cvt_pk_bf16_f32 v166, v108, v109
    v_mfma_f32_16x16x32_bf16 v[112:115], a[12:15], a[228:231], v[112:115]
    v_cvt_pk_bf16_f32 v167, v110, v111
    v_add_f32 v23, v23, v85
    v_mfma_f32_16x16x32_bf16 v[112:115], a[16:19], a[232:235], v[112:115]
    ds_read_b128 a[252:255], v2 offset:48128
    v_sub_f32 v89, v89, v15
    v_mfma_f32_16x16x32_bf16 v[112:115], a[20:23], a[236:239], v[112:115]
    v_exp_f32 v88, v88
    v_mfma_f32_16x16x32_bf16 v[116:119], a[24:27], a[216:219], 0
    ds_read_b128 a[192:195], v2 offset:49152
    v_add_f32 v20, v20, v38
    v_mfma_f32_16x16x32_bf16 v[116:119], a[28:31], a[220:223], v[116:119]
    v_exp_f32 v41, v41
    v_mfma_f32_16x16x32_bf16 v[116:119], a[32:35], a[224:227], v[116:119]
    ds_read_b128 a[196:199], v2 offset:50176
    v_cvt_pk_bf16_f32 v168, v112, v113
    v_mfma_f32_16x16x32_bf16 v[116:119], a[36:39], a[228:231], v[116:119]
    v_cvt_pk_bf16_f32 v169, v114, v115
    v_sub_f32 v42, v42, v12
    v_mfma_f32_16x16x32_bf16 v[116:119], a[40:43], a[232:235], v[116:119]
    v_add_f32 v21, v21, v54
    v_sub_f32 v58, v58, v13
    v_mfma_f32_16x16x32_bf16 v[116:119], a[44:47], a[236:239], v[116:119]
    v_exp_f32 v57, v57
    v_mfma_f32_16x16x32_bf16 v[120:123], a[48:51], a[216:219], 0
    v_add_f32 v22, v22, v70
    v_sub_f32 v74, v74, v14
    v_mfma_f32_16x16x32_bf16 v[120:123], a[52:55], a[220:223], v[120:123]
    v_exp_f32 v73, v73
    v_mfma_f32_16x16x32_bf16 v[120:123], a[56:59], a[224:227], v[120:123]
    v_cvt_pk_bf16_f32 v170, v116, v117
    v_cvt_pk_bf16_f32 v171, v118, v119
    v_mfma_f32_16x16x32_bf16 v[120:123], a[60:63], a[228:231], v[120:123]
    v_add_f32 v23, v23, v86
    v_sub_f32 v90, v90, v15
    v_mfma_f32_16x16x32_bf16 v[120:123], a[64:67], a[232:235], v[120:123]
    v_exp_f32 v89, v89
    v_mfma_f32_16x16x32_bf16 v[120:123], a[68:71], a[236:239], v[120:123]
    v_add_f32 v20, v20, v39
    v_sub_f32 v43, v43, v12
    v_mfma_f32_16x16x32_bf16 v[124:127], a[72:75], a[216:219], 0
    v_exp_f32 v42, v42
    v_mfma_f32_16x16x32_bf16 v[124:127], a[76:79], a[220:223], v[124:127]
    v_add_f32 v21, v21, v55
    v_sub_f32 v59, v59, v13
    v_mfma_f32_16x16x32_bf16 v[124:127], a[80:83], a[224:227], v[124:127]
    v_cvt_pk_bf16_f32 v172, v120, v121
    v_cvt_pk_bf16_f32 v173, v122, v123
    v_mfma_f32_16x16x32_bf16 v[124:127], a[84:87], a[228:231], v[124:127]
    v_exp_f32 v58, v58
    v_mfma_f32_16x16x32_bf16 v[124:127], a[88:91], a[232:235], v[124:127]
    ds_read_b128 a[200:203], v2 offset:51200
    v_add_f32 v22, v22, v71
    v_mfma_f32_16x16x32_bf16 v[124:127], a[92:95], a[236:239], v[124:127]
    v_sub_f32 v75, v75, v14
    s_waitcnt lgkmcnt(1)
    v_mfma_f32_16x16x32_bf16 v[96:99], a[0:3], a[240:243], 0
    ds_read_b128 a[204:207], v2 offset:52224
    v_add_f32 v23, v23, v87
    v_mfma_f32_16x16x32_bf16 v[96:99], a[4:7], a[244:247], v[96:99]
    v_exp_f32 v74, v74
    v_mfma_f32_16x16x32_bf16 v[96:99], a[8:11], a[248:251], v[96:99]
    ds_read_b128 a[208:211], v2 offset:53248
    v_cvt_pk_bf16_f32 v174, v124, v125
    v_mfma_f32_16x16x32_bf16 v[96:99], a[12:15], a[252:255], v[96:99]
    v_cvt_pk_bf16_f32 v175, v126, v127
    v_sub_f32 v91, v91, v15
    v_mfma_f32_16x16x32_bf16 v[96:99], a[16:19], a[192:195], v[96:99]
    ds_read_b128 a[212:215], v2 offset:54272
    v_add_f32 v20, v20, v40
    v_mfma_f32_16x16x32_bf16 v[96:99], a[20:23], a[196:199], v[96:99]
    v_exp_f32 v90, v90
    v_mfma_f32_16x16x32_bf16 v[100:103], a[24:27], a[240:243], 0
    ds_read_b128 a[216:219], v2 offset:55296
    v_sub_f32 v44, v44, v12
    v_mfma_f32_16x16x32_bf16 v[100:103], a[28:31], a[244:247], v[100:103]
    v_exp_f32 v43, v43
    v_mfma_f32_16x16x32_bf16 v[100:103], a[32:35], a[248:251], v[100:103]
    ds_read_b128 a[220:223], v2 offset:56320
    v_cvt_pk_bf16_f32 v176, v96, v97
    v_mfma_f32_16x16x32_bf16 v[100:103], a[36:39], a[252:255], v[100:103]
    v_cvt_pk_bf16_f32 v177, v98, v99
    v_add_f32 v21, v21, v56
    v_mfma_f32_16x16x32_bf16 v[100:103], a[40:43], a[192:195], v[100:103]
    v_exp_f32 v59, v59
    v_mfma_f32_16x16x32_bf16 v[100:103], a[44:47], a[196:199], v[100:103]
    v_sub_f32 v60, v60, v13
    v_add_f32 v22, v22, v72
    v_mfma_f32_16x16x32_bf16 v[104:107], a[48:51], a[240:243], 0
    v_exp_f32 v75, v75
    v_mfma_f32_16x16x32_bf16 v[104:107], a[52:55], a[244:247], v[104:107]
    v_sub_f32 v76, v76, v14
    v_add_f32 v23, v23, v88
    v_mfma_f32_16x16x32_bf16 v[104:107], a[56:59], a[248:251], v[104:107]
    v_cvt_pk_bf16_f32 v178, v100, v101
    v_cvt_pk_bf16_f32 v179, v102, v103
    v_mfma_f32_16x16x32_bf16 v[104:107], a[60:63], a[252:255], v[104:107]
    v_exp_f32 v91, v91
    v_mfma_f32_16x16x32_bf16 v[104:107], a[64:67], a[192:195], v[104:107]
    v_sub_f32 v92, v92, v15
    v_add_f32 v20, v20, v41
    v_mfma_f32_16x16x32_bf16 v[104:107], a[68:71], a[196:199], v[104:107]
    v_exp_f32 v44, v44
    v_mfma_f32_16x16x32_bf16 v[108:111], a[72:75], a[240:243], 0
    v_sub_f32 v45, v45, v12
    v_add_f32 v21, v21, v57
    v_mfma_f32_16x16x32_bf16 v[108:111], a[76:79], a[244:247], v[108:111]
    v_exp_f32 v60, v60
    v_mfma_f32_16x16x32_bf16 v[108:111], a[80:83], a[248:251], v[108:111]
    v_cvt_pk_bf16_f32 v180, v104, v105
    v_cvt_pk_bf16_f32 v181, v106, v107
    v_mfma_f32_16x16x32_bf16 v[108:111], a[84:87], a[252:255], v[108:111]
    v_sub_f32 v61, v61, v13
    v_add_f32 v22, v22, v73
    v_mfma_f32_16x16x32_bf16 v[108:111], a[88:91], a[192:195], v[108:111]
    ds_read_b128 a[224:227], v2 offset:57344
    v_sub_f32 v77, v77, v14
    v_mfma_f32_16x16x32_bf16 v[108:111], a[92:95], a[196:199], v[108:111]
    v_add_f32 v23, v23, v89
    s_waitcnt lgkmcnt(1)
    v_mfma_f32_16x16x32_bf16 v[112:115], a[0:3], a[200:203], 0
    ds_read_b128 a[228:231], v2 offset:58368
    v_sub_f32 v93, v93, v15
    v_mfma_f32_16x16x32_bf16 v[112:115], a[4:7], a[204:207], v[112:115]
    v_exp_f32 v76, v76
    v_mfma_f32_16x16x32_bf16 v[112:115], a[8:11], a[208:211], v[112:115]
    ds_read_b128 a[232:235], v2 offset:59392
    v_cvt_pk_bf16_f32 v182, v108, v109
    v_mfma_f32_16x16x32_bf16 v[112:115], a[12:15], a[212:215], v[112:115]
    v_cvt_pk_bf16_f32 v183, v110, v111
    v_add_f32 v20, v20, v42
    v_mfma_f32_16x16x32_bf16 v[112:115], a[16:19], a[216:219], v[112:115]
    ds_read_b128 a[236:239], v2 offset:60416
    v_sub_f32 v46, v46, v12
    v_mfma_f32_16x16x32_bf16 v[112:115], a[20:23], a[220:223], v[112:115]
    v_exp_f32 v92, v92
    v_mfma_f32_16x16x32_bf16 v[116:119], a[24:27], a[200:203], 0
    ds_read_b128 a[240:243], v2 offset:61440
    v_add_f32 v21, v21, v58
    v_mfma_f32_16x16x32_bf16 v[116:119], a[28:31], a[204:207], v[116:119]
    v_exp_f32 v45, v45
    v_mfma_f32_16x16x32_bf16 v[116:119], a[32:35], a[208:211], v[116:119]
    ds_read_b128 a[244:247], v2 offset:62464
    v_cvt_pk_bf16_f32 v184, v112, v113
    v_mfma_f32_16x16x32_bf16 v[116:119], a[36:39], a[212:215], v[116:119]
    v_cvt_pk_bf16_f32 v185, v114, v115
    v_sub_f32 v62, v62, v13
    v_mfma_f32_16x16x32_bf16 v[116:119], a[40:43], a[216:219], v[116:119]
    v_exp_f32 v61, v61
    v_mfma_f32_16x16x32_bf16 v[116:119], a[44:47], a[220:223], v[116:119]
    v_add_f32 v22, v22, v74
    v_sub_f32 v78, v78, v14
    v_mfma_f32_16x16x32_bf16 v[120:123], a[48:51], a[200:203], 0
    v_exp_f32 v77, v77
    v_mfma_f32_16x16x32_bf16 v[120:123], a[52:55], a[204:207], v[120:123]
    v_add_f32 v23, v23, v90
    v_sub_f32 v94, v94, v15
    v_mfma_f32_16x16x32_bf16 v[120:123], a[56:59], a[208:211], v[120:123]
    v_cvt_pk_bf16_f32 v186, v116, v117
    v_cvt_pk_bf16_f32 v187, v118, v119
    v_mfma_f32_16x16x32_bf16 v[120:123], a[60:63], a[212:215], v[120:123]
    v_exp_f32 v93, v93
    v_mfma_f32_16x16x32_bf16 v[120:123], a[64:67], a[216:219], v[120:123]
    v_add_f32 v20, v20, v43
    v_sub_f32 v47, v47, v12
    v_mfma_f32_16x16x32_bf16 v[120:123], a[68:71], a[220:223], v[120:123]
    v_exp_f32 v46, v46
    v_mfma_f32_16x16x32_bf16 v[124:127], a[72:75], a[200:203], 0
    v_add_f32 v21, v21, v59
    v_sub_f32 v63, v63, v13
    v_mfma_f32_16x16x32_bf16 v[124:127], a[76:79], a[204:207], v[124:127]
    v_exp_f32 v62, v62
    v_mfma_f32_16x16x32_bf16 v[124:127], a[80:83], a[208:211], v[124:127]
    v_cvt_pk_bf16_f32 v188, v120, v121
    v_cvt_pk_bf16_f32 v189, v122, v123
    v_mfma_f32_16x16x32_bf16 v[124:127], a[84:87], a[212:215], v[124:127]
    v_add_f32 v22, v22, v75
    v_sub_f32 v79, v79, v14
    v_mfma_f32_16x16x32_bf16 v[124:127], a[88:91], a[216:219], v[124:127]
    ds_read_b128 a[248:251], v2 offset:63488
    v_add_f32 v23, v23, v91
    v_mfma_f32_16x16x32_bf16 v[124:127], a[92:95], a[220:223], v[124:127]
    v_sub_f32 v95, v95, v15
    s_waitcnt lgkmcnt(1)
    v_mfma_f32_16x16x32_bf16 v[96:99], a[0:3], a[224:227], 0
    ds_read_b128 a[252:255], v2 offset:64512
    v_add_f32 v20, v20, v44
    v_mfma_f32_16x16x32_bf16 v[96:99], a[4:7], a[228:231], v[96:99]
    v_exp_f32 v78, v78
    v_mfma_f32_16x16x32_bf16 v[96:99], a[8:11], a[232:235], v[96:99]
    ds_read_b128 a[192:195], v3 offset:0
    v_cvt_pk_bf16_f32 v190, v124, v125
    v_mfma_f32_16x16x32_bf16 v[96:99], a[12:15], a[236:239], v[96:99]
    v_cvt_pk_bf16_f32 v191, v126, v127
    v_add_f32 v21, v21, v60
    v_mfma_f32_16x16x32_bf16 v[96:99], a[16:19], a[240:243], v[96:99]
    ds_read_b128 a[196:199], v3 offset:1024
    v_add_f32 v22, v22, v76
    v_mfma_f32_16x16x32_bf16 v[96:99], a[20:23], a[244:247], v[96:99]
    v_exp_f32 v94, v94
    v_mfma_f32_16x16x32_bf16 v[100:103], a[24:27], a[224:227], 0
    ds_read_b128 a[200:203], v3 offset:2048
    v_add_f32 v23, v23, v92
    v_mfma_f32_16x16x32_bf16 v[100:103], a[28:31], a[228:231], v[100:103]
    v_exp_f32 v47, v47
    v_mfma_f32_16x16x32_bf16 v[100:103], a[32:35], a[232:235], v[100:103]
    ds_read_b128 a[204:207], v3 offset:3072
    v_cvt_pk_bf16_f32 v192, v96, v97
    v_mfma_f32_16x16x32_bf16 v[100:103], a[36:39], a[236:239], v[100:103]
    v_cvt_pk_bf16_f32 v193, v98, v99
    v_add_f32 v20, v20, v45
    v_mfma_f32_16x16x32_bf16 v[100:103], a[40:43], a[240:243], v[100:103]
    v_exp_f32 v63, v63
    v_mfma_f32_16x16x32_bf16 v[100:103], a[44:47], a[244:247], v[100:103]
    v_exp_f32 v79, v79
    v_mfma_f32_16x16x32_bf16 v[104:107], a[48:51], a[224:227], 0
    v_exp_f32 v95, v95
    v_mfma_f32_16x16x32_bf16 v[104:107], a[52:55], a[228:231], v[104:107]
    v_add_f32 v21, v21, v61
    v_add_f32 v22, v22, v77
    v_mfma_f32_16x16x32_bf16 v[104:107], a[56:59], a[232:235], v[104:107]
    v_cvt_pk_bf16_f32 v194, v100, v101
    v_cvt_pk_bf16_f32 v195, v102, v103
    v_mfma_f32_16x16x32_bf16 v[104:107], a[60:63], a[236:239], v[104:107]
    v_add_f32 v23, v23, v93
    v_add_f32 v20, v20, v46
    v_mfma_f32_16x16x32_bf16 v[104:107], a[64:67], a[240:243], v[104:107]
    v_add_f32 v21, v21, v62
    v_add_f32 v22, v22, v78
    v_mfma_f32_16x16x32_bf16 v[104:107], a[68:71], a[244:247], v[104:107]
    v_add_f32 v23, v23, v94
    v_add_f32 v20, v20, v47
    v_mfma_f32_16x16x32_bf16 v[108:111], a[72:75], a[224:227], 0
    v_add_f32 v21, v21, v63
    v_add_f32 v22, v22, v79
    v_mfma_f32_16x16x32_bf16 v[108:111], a[76:79], a[228:231], v[108:111]
    v_add_f32 v23, v23, v95
    v_permlane16_swap_b32 v20, v21
    v_mfma_f32_16x16x32_bf16 v[108:111], a[80:83], a[232:235], v[108:111]
    v_cvt_pk_bf16_f32 v196, v104, v105
    v_cvt_pk_bf16_f32 v197, v106, v107
    v_mfma_f32_16x16x32_bf16 v[108:111], a[84:87], a[236:239], v[108:111]
    v_permlane16_swap_b32 v22, v23
    v_add_f32 v20, v20, v21
    v_mfma_f32_16x16x32_bf16 v[108:111], a[88:91], a[240:243], v[108:111]
    ds_read_b128 a[208:211], v3 offset:4096
    v_add_f32 v22, v22, v23
    v_mfma_f32_16x16x32_bf16 v[108:111], a[92:95], a[244:247], v[108:111]
    s_add_u32 s30, s16, 7471104
    s_waitcnt lgkmcnt(1)
    v_mfma_f32_16x16x32_bf16 v[112:115], a[0:3], a[248:251], 0
    ds_read_b128 a[212:215], v3 offset:5120
    v_permlane32_swap_b32 v20, v22
    v_mfma_f32_16x16x32_bf16 v[112:115], a[4:7], a[252:255], v[112:115]
    v_add_f32 v20, v20, v22
    v_mfma_f32_16x16x32_bf16 v[112:115], a[8:11], a[192:195], v[112:115]
    ds_read_b128 a[216:219], v3 offset:6144
    v_cvt_pk_bf16_f32 v198, v108, v109
    v_mfma_f32_16x16x32_bf16 v[112:115], a[12:15], a[196:199], v[112:115]
    v_cvt_pk_bf16_f32 v199, v110, v111
    v_mfma_f32_16x16x32_bf16 v[112:115], a[16:19], a[200:203], v[112:115]
    ds_read_b128 a[220:223], v3 offset:7168
    v_mfma_f32_16x16x32_bf16 v[112:115], a[20:23], a[204:207], v[112:115]
    v_rcp_f32 v20, v20
    v_mfma_f32_16x16x32_bf16 v[116:119], a[24:27], a[248:251], 0
    ds_read_b128 a[224:227], v3 offset:8192
    v_mov_b32 v22, v20
    v_mfma_f32_16x16x32_bf16 v[116:119], a[28:31], a[252:255], v[116:119]
    v_mfma_f32_16x16x32_bf16 v[116:119], a[32:35], a[192:195], v[116:119]
    ds_read_b128 a[228:231], v3 offset:9216
    v_cvt_pk_bf16_f32 v200, v112, v113
    v_mfma_f32_16x16x32_bf16 v[116:119], a[36:39], a[196:199], v[116:119]
    v_cvt_pk_bf16_f32 v201, v114, v115
    v_permlane32_swap_b32 v20, v22
    v_mfma_f32_16x16x32_bf16 v[116:119], a[40:43], a[200:203], v[116:119]
    v_mov_b32 v21, v20
    v_mov_b32 v23, v22
    v_mfma_f32_16x16x32_bf16 v[116:119], a[44:47], a[204:207], v[116:119]
    v_permlane16_swap_b32 v20, v21
    v_mul_f32 v32, v32, v20
    v_mfma_f32_16x16x32_bf16 v[120:123], a[48:51], a[248:251], 0
    v_mul_f32 v33, v33, v20
    v_cvt_pk_bf16_f32 v32, v32, v33
    v_mfma_f32_16x16x32_bf16 v[120:123], a[52:55], a[252:255], v[120:123]
    v_mul_f32 v34, v34, v20
    v_mul_f32 v35, v35, v20
    v_mfma_f32_16x16x32_bf16 v[120:123], a[56:59], a[192:195], v[120:123]
    v_cvt_pk_bf16_f32 v202, v116, v117
    v_cvt_pk_bf16_f32 v203, v118, v119
    v_mfma_f32_16x16x32_bf16 v[120:123], a[60:63], a[196:199], v[120:123]
    v_cvt_pk_bf16_f32 v33, v34, v35
    v_mul_f32 v36, v36, v20
    v_mfma_f32_16x16x32_bf16 v[120:123], a[64:67], a[200:203], v[120:123]
    v_mul_f32 v37, v37, v20
    v_cvt_pk_bf16_f32 v34, v36, v37
    v_mfma_f32_16x16x32_bf16 v[120:123], a[68:71], a[204:207], v[120:123]
    v_mul_f32 v38, v38, v20
    v_mul_f32 v39, v39, v20
    v_mfma_f32_16x16x32_bf16 v[124:127], a[72:75], a[248:251], 0
    s_add_u32 s42, s17, L_win1-L_pc_ref
    v_mul_f32 v40, v40, v20
    v_mfma_f32_16x16x32_bf16 v[124:127], a[76:79], a[252:255], v[124:127]
    v_mul_f32 v41, v41, v20
    v_permlane16_swap_b32 v22, v23
    v_mfma_f32_16x16x32_bf16 v[124:127], a[80:83], a[192:195], v[124:127]
    buffer_load_dword v8, v7, s[44:47], s42 offen
    v_cvt_pk_bf16_f32 v204, v120, v121
    v_mfma_f32_16x16x32_bf16 v[124:127], a[84:87], a[196:199], v[124:127]
    v_cvt_pk_bf16_f32 v205, v122, v123
    v_cvt_pk_bf16_f32 v35, v38, v39
    v_mfma_f32_16x16x32_bf16 v[124:127], a[88:91], a[200:203], v[124:127]
    ds_read_b128 a[232:235], v3 offset:10240
    v_cvt_pk_bf16_f32 v36, v40, v41
    v_mfma_f32_16x16x32_bf16 v[124:127], a[92:95], a[204:207], v[124:127]
    v_mul_f32 v48, v48, v21
    s_waitcnt lgkmcnt(1)
    v_mfma_f32_16x16x32_bf16 v[96:99], a[0:3], a[208:211], 0
    ds_read_b128 a[236:239], v3 offset:11264
    v_mul_f32 v49, v49, v21
    v_mfma_f32_16x16x32_bf16 v[96:99], a[4:7], a[212:215], v[96:99]
    v_cvt_pk_bf16_f32 v40, v48, v49
    v_mul_f32 v64, v64, v22
    v_mfma_f32_16x16x32_bf16 v[96:99], a[8:11], a[216:219], v[96:99]
    ds_read_b128 a[240:243], v3 offset:12288
    v_cvt_pk_bf16_f32 v206, v124, v125
    v_mfma_f32_16x16x32_bf16 v[96:99], a[12:15], a[220:223], v[96:99]
    v_cvt_pk_bf16_f32 v207, v126, v127
    v_mul_f32 v65, v65, v22
    v_mfma_f32_16x16x32_bf16 v[96:99], a[16:19], a[224:227], v[96:99]
    ds_read_b128 a[244:247], v3 offset:13312
    v_mul_f32 v66, v66, v22
    v_mfma_f32_16x16x32_bf16 v[96:99], a[20:23], a[228:231], v[96:99]
    v_mul_f32 v67, v67, v22
    v_cvt_pk_bf16_f32 v48, v64, v65
    v_mfma_f32_16x16x32_bf16 v[100:103], a[24:27], a[208:211], 0
    ds_read_b128 a[248:251], v3 offset:14336
    v_cvt_pk_bf16_f32 v49, v66, v67
    v_mfma_f32_16x16x32_bf16 v[100:103], a[28:31], a[212:215], v[100:103]
    v_mul_f32 v42, v42, v20
    v_mul_f32 v43, v43, v20
    v_mfma_f32_16x16x32_bf16 v[100:103], a[32:35], a[216:219], v[100:103]
    ds_read_b128 a[252:255], v3 offset:15360
    v_mul_f32 v44, v44, v20
    v_mfma_f32_16x16x32_bf16 v[100:103], a[36:39], a[220:223], v[100:103]
    v_mul_f32 v45, v45, v20
    v_mul_f32 v46, v46, v20
    v_mfma_f32_16x16x32_bf16 v[100:103], a[40:43], a[224:227], v[100:103]
    v_mul_f32 v47, v47, v20
    v_cvt_pk_bf16_f32 v37, v42, v43
    v_mfma_f32_16x16x32_bf16 v[100:103], a[44:47], a[228:231], v[100:103]
    v_cvt_pk_bf16_f32 v38, v44, v45
    v_cvt_pk_bf16_f32 v39, v46, v47
    v_mfma_f32_16x16x32_bf16 v[104:107], a[48:51], a[208:211], 0
    v_mul_f32 v50, v50, v21
    v_mul_f32 v51, v51, v21
    v_mfma_f32_16x16x32_bf16 v[104:107], a[52:55], a[212:215], v[104:107]
    v_cvt_pk_bf16_f32 v41, v50, v51
    v_mul_f32 v68, v68, v22
    v_mfma_f32_16x16x32_bf16 v[104:107], a[56:59], a[216:219], v[104:107]
    v_mul_f32 v69, v69, v22
    v_mul_f32 v70, v70, v22
    v_mfma_f32_16x16x32_bf16 v[104:107], a[60:63], a[220:223], v[104:107]
    v_mul_f32 v71, v71, v22
    v_cvt_pk_bf16_f32 v50, v68, v69
    v_mfma_f32_16x16x32_bf16 v[104:107], a[64:67], a[224:227], v[104:107]
    v_cvt_pk_bf16_f32 v51, v70, v71
    v_mul_f32 v52, v52, v21
    v_mfma_f32_16x16x32_bf16 v[104:107], a[68:71], a[228:231], v[104:107]
    v_mul_f32 v53, v53, v21
    v_cvt_pk_bf16_f32 v42, v52, v53
    v_mfma_f32_16x16x32_bf16 v[108:111], a[72:75], a[208:211], 0
    v_mul_f32 v72, v72, v22
    v_mul_f32 v73, v73, v22
    v_mfma_f32_16x16x32_bf16 v[108:111], a[76:79], a[212:215], v[108:111]
    v_mul_f32 v74, v74, v22
    v_mul_f32 v75, v75, v22
    v_mfma_f32_16x16x32_bf16 v[108:111], a[80:83], a[216:219], v[108:111]
    v_cvt_pk_bf16_f32 v52, v72, v73
    v_cvt_pk_bf16_f32 v53, v74, v75
    v_mfma_f32_16x16x32_bf16 v[108:111], a[84:87], a[220:223], v[108:111]
    v_mul_f32 v54, v54, v21
    v_mul_f32 v55, v55, v21
    v_mfma_f32_16x16x32_bf16 v[108:111], a[88:91], a[224:227], v[108:111]
    v_cvt_pk_bf16_f32 v43, v54, v55
    v_mul_f32 v76, v76, v22
    v_mfma_f32_16x16x32_bf16 v[108:111], a[92:95], a[228:231], v[108:111]
    v_mul_f32 v77, v77, v22
    s_waitcnt lgkmcnt(0)
    v_mfma_f32_16x16x32_bf16 v[112:115], a[0:3], a[232:235], 0
    v_mul_f32 v78, v78, v22
    v_mul_f32 v79, v79, v22
    v_mfma_f32_16x16x32_bf16 v[112:115], a[4:7], a[236:239], v[112:115]
    v_cvt_pk_bf16_f32 v54, v76, v77
    v_cvt_pk_bf16_f32 v55, v78, v79
    v_mfma_f32_16x16x32_bf16 v[112:115], a[8:11], a[240:243], v[112:115]
    v_mul_f32 v56, v56, v21
    v_mul_f32 v57, v57, v21
    v_mfma_f32_16x16x32_bf16 v[112:115], a[12:15], a[244:247], v[112:115]
    v_cvt_pk_bf16_f32 v44, v56, v57
    v_mul_f32 v80, v80, v23
    v_mfma_f32_16x16x32_bf16 v[112:115], a[16:19], a[248:251], v[112:115]
    v_mul_f32 v81, v81, v23
    v_mul_f32 v82, v82, v23
    v_mfma_f32_16x16x32_bf16 v[112:115], a[20:23], a[252:255], v[112:115]
    v_mul_f32 v83, v83, v23
    v_cvt_pk_bf16_f32 v56, v80, v81
    v_mfma_f32_16x16x32_bf16 v[116:119], a[24:27], a[232:235], 0
    v_cvt_pk_bf16_f32 v57, v82, v83
    v_mul_f32 v58, v58, v21
    v_mfma_f32_16x16x32_bf16 v[116:119], a[28:31], a[236:239], v[116:119]
    v_mul_f32 v59, v59, v21
    v_mul_f32 v60, v60, v21
    v_mfma_f32_16x16x32_bf16 v[116:119], a[32:35], a[240:243], v[116:119]
    v_mul_f32 v61, v61, v21
    v_mul_f32 v62, v62, v21
    v_mfma_f32_16x16x32_bf16 v[116:119], a[36:39], a[244:247], v[116:119]
    v_mul_f32 v63, v63, v21
    v_cvt_pk_bf16_f32 v45, v58, v59
    v_mfma_f32_16x16x32_bf16 v[116:119], a[40:43], a[248:251], v[116:119]
    v_cvt_pk_bf16_f32 v46, v60, v61
    v_cvt_pk_bf16_f32 v47, v62, v63
    v_mfma_f32_16x16x32_bf16 v[116:119], a[44:47], a[252:255], v[116:119]
    v_mul_f32 v84, v84, v23
    v_mul_f32 v85, v85, v23
    v_mfma_f32_16x16x32_bf16 v[120:123], a[48:51], a[232:235], 0
    v_mul_f32 v86, v86, v23
    v_mul_f32 v87, v87, v23
    v_mfma_f32_16x16x32_bf16 v[120:123], a[52:55], a[236:239], v[120:123]
    v_cvt_pk_bf16_f32 v58, v84, v85
    v_cvt_pk_bf16_f32 v59, v86, v87
    v_mfma_f32_16x16x32_bf16 v[120:123], a[56:59], a[240:243], v[120:123]
    v_mul_f32 v88, v88, v23
    v_mul_f32 v89, v89, v23
    v_mfma_f32_16x16x32_bf16 v[120:123], a[60:63], a[244:247], v[120:123]
    v_mul_f32 v90, v90, v23
    v_mul_f32 v91, v91, v23
    v_mfma_f32_16x16x32_bf16 v[120:123], a[64:67], a[248:251], v[120:123]
    v_cvt_pk_bf16_f32 v60, v88, v89
    v_cvt_pk_bf16_f32 v61, v90, v91
    v_mfma_f32_16x16x32_bf16 v[120:123], a[68:71], a[252:255], v[120:123]
    v_mul_f32 v92, v92, v23
    v_mul_f32 v93, v93, v23
    v_mfma_f32_16x16x32_bf16 v[124:127], a[72:75], a[232:235], 0
    v_mul_f32 v94, v94, v23
    v_mul_f32 v95, v95, v23
    v_mfma_f32_16x16x32_bf16 v[124:127], a[76:79], a[236:239], v[124:127]
    v_cvt_pk_bf16_f32 v62, v92, v93
    v_cvt_pk_bf16_f32 v63, v94, v95
    v_mfma_f32_16x16x32_bf16 v[124:127], a[80:83], a[240:243], v[124:127]
    v_cvt_pk_bf16_f32 v208, v96, v97
    v_cvt_pk_bf16_f32 v209, v98, v99
    v_mfma_f32_16x16x32_bf16 v[124:127], a[84:87], a[244:247], v[124:127]
    v_cvt_pk_bf16_f32 v210, v100, v101
    v_cvt_pk_bf16_f32 v211, v102, v103
    v_mfma_f32_16x16x32_bf16 v[124:127], a[88:91], a[248:251], v[124:127]
    v_cvt_pk_bf16_f32 v212, v104, v105
    v_cvt_pk_bf16_f32 v213, v106, v107
    v_mfma_f32_16x16x32_bf16 v[124:127], a[92:95], a[252:255], v[124:127]
    v_cvt_pk_bf16_f32 v214, v108, v109
    v_cvt_pk_bf16_f32 v215, v110, v111
    v_mfma_f32_16x16x32_bf16 v[64:67], v[32:35], v[128:131], 0
    v_cvt_pk_bf16_f32 v216, v112, v113
    v_cvt_pk_bf16_f32 v217, v114, v115
    v_mfma_f32_16x16x32_bf16 v[64:67], v[36:39], v[132:135], v[64:67]
    v_cvt_pk_bf16_f32 v218, v116, v117
    v_cvt_pk_bf16_f32 v219, v118, v119
    v_mfma_f32_16x16x32_bf16 v[68:71], v[32:35], v[136:139], 0
    v_cvt_pk_bf16_f32 v220, v120, v121
    v_cvt_pk_bf16_f32 v221, v122, v123
    v_mfma_f32_16x16x32_bf16 v[68:71], v[36:39], v[140:143], v[68:71]
    v_cvt_pk_bf16_f32 v222, v124, v125
    v_cvt_pk_bf16_f32 v223, v126, v127
    v_mfma_f32_16x16x32_bf16 v[72:75], v[32:35], v[144:147], 0
    buffer_load_dwordx4 a[0:3], v9, s[8:11], s24 offen offset:0 nt
    v_mfma_f32_16x16x32_bf16 v[72:75], v[36:39], v[148:151], v[72:75]
    buffer_load_dwordx4 a[4:7], v10, s[8:11], s24 offen offset:0 nt
    v_mfma_f32_16x16x32_bf16 v[76:79], v[32:35], v[152:155], 0
    v_cvt_pk_bf16_f32 v224, v64, v68
    v_cvt_pk_bf16_f32 v226, v65, v69
    v_mfma_f32_16x16x32_bf16 v[76:79], v[36:39], v[156:159], v[76:79]
    v_cvt_pk_bf16_f32 v228, v66, v70
    v_cvt_pk_bf16_f32 v230, v67, v71
    v_mfma_f32_16x16x32_bf16 v[80:83], v[40:43], v[128:131], 0
    v_mfma_f32_16x16x32_bf16 v[80:83], v[44:47], v[132:135], v[80:83]
    v_mfma_f32_16x16x32_bf16 v[84:87], v[40:43], v[136:139], 0
    v_cvt_pk_bf16_f32 v225, v72, v76
    v_cvt_pk_bf16_f32 v227, v73, v77
    v_mfma_f32_16x16x32_bf16 v[84:87], v[44:47], v[140:143], v[84:87]
    v_cvt_pk_bf16_f32 v229, v74, v78
    v_cvt_pk_bf16_f32 v231, v75, v79
    v_mfma_f32_16x16x32_bf16 v[88:91], v[40:43], v[144:147], 0
    v_mfma_f32_16x16x32_bf16 v[88:91], v[44:47], v[148:151], v[88:91]
    v_mfma_f32_16x16x32_bf16 v[92:95], v[40:43], v[152:155], 0
    v_cvt_pk_bf16_f32 v232, v80, v84
    v_cvt_pk_bf16_f32 v234, v81, v85
    v_mfma_f32_16x16x32_bf16 v[92:95], v[44:47], v[156:159], v[92:95]
    v_cvt_pk_bf16_f32 v236, v82, v86
    v_cvt_pk_bf16_f32 v238, v83, v87
    v_mfma_f32_16x16x32_bf16 v[96:99], v[48:51], v[128:131], 0
    v_mfma_f32_16x16x32_bf16 v[96:99], v[52:55], v[132:135], v[96:99]
    v_mfma_f32_16x16x32_bf16 v[100:103], v[48:51], v[136:139], 0
    s_waitcnt vmcnt(3)
    ds_write_b64 v4, a[120:121] offset:0
    v_mfma_f32_16x16x32_bf16 v[100:103], v[52:55], v[140:143], v[100:103]
    ds_write_b64 v4, a[122:123] offset:1024
    v_mfma_f32_16x16x32_bf16 v[104:107], v[48:51], v[144:147], 0
    ds_write_b64 v4, a[124:125] offset:512
    v_mfma_f32_16x16x32_bf16 v[104:107], v[52:55], v[148:151], v[104:107]
    ds_write_b64 v4, a[126:127] offset:1536
    v_mfma_f32_16x16x32_bf16 v[108:111], v[48:51], v[152:155], 0
    ds_read2_b64 a[120:123], v5 offset0:0 offset1:128
    v_cvt_pk_bf16_f32 v233, v88, v92
    v_mfma_f32_16x16x32_bf16 v[108:111], v[52:55], v[156:159], v[108:111]
    ds_read2_b64 a[124:127], v6 offset0:0 offset1:128
    v_cvt_pk_bf16_f32 v235, v89, v93
    v_mfma_f32_16x16x32_bf16 v[112:115], v[56:59], v[128:131], 0
    v_cvt_pk_bf16_f32 v237, v90, v94
    v_cvt_pk_bf16_f32 v239, v91, v95
    v_mfma_f32_16x16x32_bf16 v[112:115], v[60:63], v[132:135], v[112:115]
    v_cvt_pk_bf16_f32 v240, v96, v100
    v_cvt_pk_bf16_f32 v242, v97, v101
    v_mfma_f32_16x16x32_bf16 v[116:119], v[56:59], v[136:139], 0
    v_cvt_pk_bf16_f32 v244, v98, v102
    v_cvt_pk_bf16_f32 v246, v99, v103
    v_mfma_f32_16x16x32_bf16 v[116:119], v[60:63], v[140:143], v[116:119]
    v_cvt_pk_bf16_f32 v241, v104, v108
    v_cvt_pk_bf16_f32 v243, v105, v109
    v_mfma_f32_16x16x32_bf16 v[120:123], v[56:59], v[144:147], 0
    ds_write_b64 v4, a[128:129] offset:0
    v_mfma_f32_16x16x32_bf16 v[120:123], v[60:63], v[148:151], v[120:123]
    ds_write_b64 v4, a[130:131] offset:1024
    v_mfma_f32_16x16x32_bf16 v[124:127], v[56:59], v[152:155], 0
    ds_write_b64 v4, a[132:133] offset:512
    v_mfma_f32_16x16x32_bf16 v[124:127], v[60:63], v[156:159], v[124:127]
    ds_write_b64 v4, a[134:135] offset:1536
    v_mfma_f32_16x16x32_bf16 v[64:67], v[32:35], v[160:163], 0
    ds_read2_b64 a[128:131], v5 offset0:0 offset1:128
    v_cvt_pk_bf16_f32 v245, v106, v110
    v_mfma_f32_16x16x32_bf16 v[64:67], v[36:39], v[164:167], v[64:67]
    ds_read2_b64 a[132:135], v6 offset0:0 offset1:128
    v_cvt_pk_bf16_f32 v247, v107, v111
    v_mfma_f32_16x16x32_bf16 v[68:71], v[32:35], v[168:171], 0
    v_cvt_pk_bf16_f32 v248, v112, v116
    v_cvt_pk_bf16_f32 v250, v113, v117
    v_mfma_f32_16x16x32_bf16 v[68:71], v[36:39], v[172:175], v[68:71]
    v_cvt_pk_bf16_f32 v252, v114, v118
    v_cvt_pk_bf16_f32 v254, v115, v119
    v_mfma_f32_16x16x32_bf16 v[72:75], v[32:35], v[176:179], 0
    v_cvt_pk_bf16_f32 v249, v120, v124
    v_cvt_pk_bf16_f32 v251, v121, v125
    v_mfma_f32_16x16x32_bf16 v[72:75], v[36:39], v[180:183], v[72:75]
    v_cvt_pk_bf16_f32 v253, v122, v126
    v_cvt_pk_bf16_f32 v255, v123, v127
    v_mfma_f32_16x16x32_bf16 v[76:79], v[32:35], v[184:187], 0
    ds_write_b64 v4, a[136:137] offset:0
    v_mfma_f32_16x16x32_bf16 v[76:79], v[36:39], v[188:191], v[76:79]
    ds_write_b64 v4, a[138:139] offset:1024
    v_mfma_f32_16x16x32_bf16 v[80:83], v[40:43], v[160:163], 0
    ds_write_b64 v4, a[140:141] offset:512
    v_mfma_f32_16x16x32_bf16 v[80:83], v[44:47], v[164:167], v[80:83]
    ds_write_b64 v4, a[142:143] offset:1536
    v_mfma_f32_16x16x32_bf16 v[84:87], v[40:43], v[168:171], 0
    ds_read2_b64 a[136:139], v5 offset0:0 offset1:128
    v_cvt_pk_bf16_f32 v128, v64, v68
    v_mfma_f32_16x16x32_bf16 v[84:87], v[44:47], v[172:175], v[84:87]
    ds_read2_b64 a[140:143], v6 offset0:0 offset1:128
    v_cvt_pk_bf16_f32 v130, v65, v69
    v_mfma_f32_16x16x32_bf16 v[88:91], v[40:43], v[176:179], 0
    v_cvt_pk_bf16_f32 v132, v66, v70
    v_cvt_pk_bf16_f32 v134, v67, v71
    v_mfma_f32_16x16x32_bf16 v[88:91], v[44:47], v[180:183], v[88:91]
    v_cvt_pk_bf16_f32 v129, v72, v76
    v_cvt_pk_bf16_f32 v131, v73, v77
    v_mfma_f32_16x16x32_bf16 v[92:95], v[40:43], v[184:187], 0
    v_cvt_pk_bf16_f32 v133, v74, v78
    v_cvt_pk_bf16_f32 v135, v75, v79
    v_mfma_f32_16x16x32_bf16 v[92:95], v[44:47], v[188:191], v[92:95]
    v_cvt_pk_bf16_f32 v136, v80, v84
    v_cvt_pk_bf16_f32 v138, v81, v85
    v_mfma_f32_16x16x32_bf16 v[96:99], v[48:51], v[160:163], 0
    ds_write_b64 v4, a[144:145] offset:0
    v_mfma_f32_16x16x32_bf16 v[96:99], v[52:55], v[164:167], v[96:99]
    buffer_load_dwordx4 a[8:11], v9, s[8:11], s24 offen offset:128 nt
    v_cvt_pk_bf16_f32 v140, v82, v86
    v_mfma_f32_16x16x32_bf16 v[100:103], v[48:51], v[168:171], 0
    buffer_load_dwordx4 a[12:15], v10, s[8:11], s24 offen offset:128 nt
    v_cvt_pk_bf16_f32 v142, v83, v87
    v_mfma_f32_16x16x32_bf16 v[100:103], v[52:55], v[172:175], v[100:103]
    ds_write_b64 v4, a[146:147] offset:1024
    v_mfma_f32_16x16x32_bf16 v[104:107], v[48:51], v[176:179], 0
    ds_write_b64 v4, a[148:149] offset:512
    v_mfma_f32_16x16x32_bf16 v[104:107], v[52:55], v[180:183], v[104:107]
    ds_write_b64 v4, a[150:151] offset:1536
    v_mfma_f32_16x16x32_bf16 v[108:111], v[48:51], v[184:187], 0
    ds_read2_b64 a[144:147], v5 offset0:0 offset1:128
    v_cvt_pk_bf16_f32 v137, v88, v92
    v_mfma_f32_16x16x32_bf16 v[108:111], v[52:55], v[188:191], v[108:111]
    ds_read2_b64 a[148:151], v6 offset0:0 offset1:128
    v_cvt_pk_bf16_f32 v139, v89, v93
    v_mfma_f32_16x16x32_bf16 v[112:115], v[56:59], v[160:163], 0
    v_cvt_pk_bf16_f32 v141, v90, v94
    v_cvt_pk_bf16_f32 v143, v91, v95
    v_mfma_f32_16x16x32_bf16 v[112:115], v[60:63], v[164:167], v[112:115]
    v_cvt_pk_bf16_f32 v144, v96, v100
    v_cvt_pk_bf16_f32 v146, v97, v101
    v_mfma_f32_16x16x32_bf16 v[116:119], v[56:59], v[168:171], 0
    ds_write_b64 v4, a[152:153] offset:0
    v_mfma_f32_16x16x32_bf16 v[116:119], v[60:63], v[172:175], v[116:119]
    ds_write_b64 v4, a[154:155] offset:1024
    v_mfma_f32_16x16x32_bf16 v[120:123], v[56:59], v[176:179], 0
    ds_write_b64 v4, a[156:157] offset:512
    v_mfma_f32_16x16x32_bf16 v[120:123], v[60:63], v[180:183], v[120:123]
    ds_write_b64 v4, a[158:159] offset:1536
    v_mfma_f32_16x16x32_bf16 v[124:127], v[56:59], v[184:187], 0
    ds_read2_b64 a[152:155], v5 offset0:0 offset1:128
    v_cvt_pk_bf16_f32 v148, v98, v102
    v_mfma_f32_16x16x32_bf16 v[124:127], v[60:63], v[188:191], v[124:127]
    ds_read2_b64 a[156:159], v6 offset0:0 offset1:128
    v_cvt_pk_bf16_f32 v150, v99, v103
    v_mfma_f32_16x16x32_bf16 v[64:67], v[32:35], v[192:195], 0
    v_cvt_pk_bf16_f32 v145, v104, v108
    v_cvt_pk_bf16_f32 v147, v105, v109
    v_mfma_f32_16x16x32_bf16 v[64:67], v[36:39], v[196:199], v[64:67]
    v_cvt_pk_bf16_f32 v149, v106, v110
    v_cvt_pk_bf16_f32 v151, v107, v111
    v_mfma_f32_16x16x32_bf16 v[68:71], v[32:35], v[200:203], 0
    v_cvt_pk_bf16_f32 v152, v112, v116
    v_cvt_pk_bf16_f32 v154, v113, v117
    v_mfma_f32_16x16x32_bf16 v[68:71], v[36:39], v[204:207], v[68:71]
    v_cvt_pk_bf16_f32 v156, v114, v118
    v_cvt_pk_bf16_f32 v158, v115, v119
    v_mfma_f32_16x16x32_bf16 v[72:75], v[32:35], v[208:211], 0
    ds_write_b64 v4, a[160:161] offset:0
    v_mfma_f32_16x16x32_bf16 v[72:75], v[36:39], v[212:215], v[72:75]
    ds_write_b64 v4, a[162:163] offset:1024
    v_mfma_f32_16x16x32_bf16 v[76:79], v[32:35], v[216:219], 0
    ds_read_b128 a[192:195], v1 offset:0
    v_cvt_pk_bf16_f32 v153, v120, v124
    v_mfma_f32_16x16x32_bf16 v[76:79], v[36:39], v[220:223], v[76:79]
    ds_write_b64 v4, a[164:165] offset:512
    v_mfma_f32_16x16x32_bf16 v[80:83], v[40:43], v[192:195], 0
    ds_read_b128 a[196:199], v1 offset:1024
    v_cvt_pk_bf16_f32 v155, v121, v125
    v_mfma_f32_16x16x32_bf16 v[80:83], v[44:47], v[196:199], v[80:83]
    ds_write_b64 v4, a[166:167] offset:1536
    v_mfma_f32_16x16x32_bf16 v[84:87], v[40:43], v[200:203], 0
    ds_read_b128 a[200:203], v1 offset:2048
    v_cvt_pk_bf16_f32 v157, v122, v126
    v_mfma_f32_16x16x32_bf16 v[84:87], v[44:47], v[204:207], v[84:87]
    ds_read2_b64 a[160:163], v5 offset0:0 offset1:128
    v_cvt_pk_bf16_f32 v159, v123, v127
    v_mfma_f32_16x16x32_bf16 v[88:91], v[40:43], v[208:211], 0
    ds_read_b128 a[204:207], v1 offset:3072
    v_cvt_pk_bf16_f32 v160, v64, v68
    v_mfma_f32_16x16x32_bf16 v[88:91], v[44:47], v[212:215], v[88:91]
    ds_read2_b64 a[164:167], v6 offset0:0 offset1:128
    v_cvt_pk_bf16_f32 v162, v65, v69
    v_mfma_f32_16x16x32_bf16 v[92:95], v[40:43], v[216:219], 0
    ds_read_b128 a[208:211], v1 offset:4096
    v_cvt_pk_bf16_f32 v164, v66, v70
    v_mfma_f32_16x16x32_bf16 v[92:95], v[44:47], v[220:223], v[92:95]
    ds_write_b64 v4, a[168:169] offset:0
    v_mfma_f32_16x16x32_bf16 v[96:99], v[48:51], v[192:195], 0
    ds_read_b128 a[212:215], v1 offset:5120
    v_cvt_pk_bf16_f32 v166, v67, v71
    v_mfma_f32_16x16x32_bf16 v[96:99], v[52:55], v[196:199], v[96:99]
    ds_write_b64 v4, a[170:171] offset:1024
    v_mfma_f32_16x16x32_bf16 v[100:103], v[48:51], v[200:203], 0
    v_cvt_pk_bf16_f32 v161, v72, v76
    v_cvt_pk_bf16_f32 v163, v73, v77
    v_mfma_f32_16x16x32_bf16 v[100:103], v[52:55], v[204:207], v[100:103]
    ds_write_b64 v4, a[172:173] offset:512
    v_mfma_f32_16x16x32_bf16 v[104:107], v[48:51], v[208:211], 0
    ds_write_b64 v4, a[174:175] offset:1536
    v_mfma_f32_16x16x32_bf16 v[104:107], v[52:55], v[212:215], v[104:107]
    v_cvt_pk_bf16_f32 v165, v74, v78
    v_cvt_pk_bf16_f32 v167, v75, v79
    v_mfma_f32_16x16x32_bf16 v[108:111], v[48:51], v[216:219], 0
    ds_read2_b64 a[168:171], v5 offset0:0 offset1:128
    v_cvt_pk_bf16_f32 v176, v96, v100
    v_mfma_f32_16x16x32_bf16 v[108:111], v[52:55], v[220:223], v[108:111]
    ds_read2_b64 a[172:175], v6 offset0:0 offset1:128
    v_cvt_pk_bf16_f32 v178, v97, v101
    v_mfma_f32_16x16x32_bf16 v[112:115], v[56:59], v[192:195], 0
    buffer_store_dwordx2 v[128:129], v11, s[12:15], s32 offen offset:128 sc1
    v_mfma_f32_16x16x32_bf16 v[112:115], v[60:63], v[196:199], v[112:115]
    ds_write_b64 v4, a[176:177] offset:0
    v_mfma_f32_16x16x32_bf16 v[116:119], v[56:59], v[200:203], 0
    ds_write_b64 v4, a[178:179] offset:1024
    v_mfma_f32_16x16x32_bf16 v[116:119], v[60:63], v[204:207], v[116:119]
    ds_write_b64 v4, a[180:181] offset:512
    v_mfma_f32_16x16x32_bf16 v[120:123], v[56:59], v[208:211], 0
    ds_write_b64 v4, a[182:183] offset:1536
    v_mfma_f32_16x16x32_bf16 v[120:123], v[60:63], v[212:215], v[120:123]
    v_cvt_pk_bf16_f32 v180, v98, v102
    v_cvt_pk_bf16_f32 v182, v99, v103
    v_mfma_f32_16x16x32_bf16 v[124:127], v[56:59], v[216:219], 0
    buffer_load_dwordx4 a[16:19], v9, s[8:11], s24 offen offset:256 nt
    v_cvt_pk_bf16_f32 v177, v104, v108
    v_mfma_f32_16x16x32_bf16 v[124:127], v[60:63], v[220:223], v[124:127]
    buffer_load_dwordx4 a[20:23], v10, s[8:11], s24 offen offset:256 nt
    s_waitcnt lgkmcnt(8)
L_win1:
    v_mfma_f32_16x16x32_bf16 v[96:99], a[192:195], a[96:99], 0
    ds_read_b128 a[216:219], v1 offset:6144
    v_cvt_pk_bf16_f32 v179, v105, v109
    v_mfma_f32_16x16x32_bf16 v[96:99], a[196:199], a[100:103], v[96:99]
    ds_read_b128 a[220:223], v1 offset:7168
    v_cvt_pk_bf16_f32 v181, v106, v110
    v_mfma_f32_16x16x32_bf16 v[96:99], a[200:203], a[104:107], v[96:99]
    ds_read_b128 a[224:227], v1 offset:8192
    v_cvt_pk_bf16_f32 v183, v107, v111
    v_mfma_f32_16x16x32_bf16 v[96:99], a[204:207], a[108:111], v[96:99]
    ds_read2_b64 a[176:179], v5 offset0:0 offset1:128
    v_cvt_pk_bf16_f32 v184, v112, v116
    v_mfma_f32_16x16x32_bf16 v[96:99], a[208:211], a[112:115], v[96:99]
    ds_read_b128 a[228:231], v1 offset:9216
    v_cvt_pk_bf16_f32 v186, v113, v117
    v_mfma_f32_16x16x32_bf16 v[96:99], a[212:215], a[116:119], v[96:99]
    ds_read2_b64 a[180:183], v6 offset0:0 offset1:128
    v_cvt_pk_bf16_f32 v188, v114, v118
    v_mfma_f32_16x16x32_bf16 v[100:103], a[192:195], a[120:123], 0
    ds_read_b128 a[232:235], v1 offset:10240
    v_cvt_pk_bf16_f32 v190, v115, v119
    v_mfma_f32_16x16x32_bf16 v[100:103], a[196:199], a[124:127], v[100:103]
    ds_write_b64 v4, a[184:185] offset:0
    v_mfma_f32_16x16x32_bf16 v[100:103], a[200:203], a[128:131], v[100:103]
    ds_write_b64 v4, a[186:187] offset:1024
    v_mfma_f32_16x16x32_bf16 v[100:103], a[204:207], a[132:135], v[100:103]
    ds_write_b64 v4, a[188:189] offset:512
    v_mfma_f32_16x16x32_bf16 v[100:103], a[208:211], a[136:139], v[100:103]
    ds_write_b64 v4, a[190:191] offset:1536
    v_mfma_f32_16x16x32_bf16 v[100:103], a[212:215], a[140:143], v[100:103]
    ds_read2_b64 a[184:187], v5 offset0:0 offset1:128
    v_cvt_pk_bf16_f32 v185, v120, v124
    v_mfma_f32_16x16x32_bf16 v[104:107], a[192:195], a[144:147], 0
    ds_read_b128 a[236:239], v1 offset:11264
    v_cvt_pk_bf16_f32 v187, v121, v125
    v_mfma_f32_16x16x32_bf16 v[104:107], a[196:199], a[148:151], v[104:107]
    ds_read2_b64 a[188:191], v6 offset0:0 offset1:128
    v_cvt_pk_bf16_f32 v189, v122, v126
    v_mfma_f32_16x16x32_bf16 v[104:107], a[200:203], a[152:155], v[104:107]
    v_cvt_pk_bf16_f32 v191, v123, v127
    v_cvt_pk_bf16_f32 v192, v96, v97
    v_mfma_f32_16x16x32_bf16 v[104:107], a[204:207], a[156:159], v[104:107]
    v_cvt_pk_bf16_f32 v193, v98, v99
    v_cvt_pk_bf16_f32 v196, v100, v101
    v_mfma_f32_16x16x32_bf16 v[104:107], a[208:211], a[160:163], v[104:107]
    v_cvt_pk_bf16_f32 v197, v102, v103
    v_cvt_pk_bf16_f32 v168, v80, v84
    v_mfma_f32_16x16x32_bf16 v[104:107], a[212:215], a[164:167], v[104:107]
    v_cvt_pk_bf16_f32 v170, v81, v85
    s_waitcnt lgkmcnt(10)
    v_mfma_f32_16x16x32_bf16 v[108:111], a[192:195], a[168:171], 0
    v_cvt_pk_bf16_f32 v172, v82, v86
    v_cvt_pk_bf16_f32 v174, v83, v87
    v_mfma_f32_16x16x32_bf16 v[108:111], a[196:199], a[172:175], v[108:111]
    buffer_store_dwordx2 v[130:131], v11, s[12:15], s32 offen offset:512 sc1
    v_mfma_f32_16x16x32_bf16 v[108:111], a[200:203], a[176:179], v[108:111]
    v_cvt_pk_bf16_f32 v200, v104, v105
    s_waitcnt lgkmcnt(6)
    v_mfma_f32_16x16x32_bf16 v[108:111], a[204:207], a[180:183], v[108:111]
    v_cvt_pk_bf16_f32 v201, v106, v107
    s_waitcnt lgkmcnt(2)
    v_mfma_f32_16x16x32_bf16 v[108:111], a[208:211], a[184:187], v[108:111]
    ds_read_b128 a[240:243], v1 offset:12288
    s_waitcnt lgkmcnt(1)
    v_mfma_f32_16x16x32_bf16 v[108:111], a[212:215], a[188:191], v[108:111]
    v_cvt_pk_bf16_f32 v169, v88, v92
    v_cvt_pk_bf16_f32 v171, v89, v93
    v_mfma_f32_16x16x32_bf16 v[112:115], a[216:219], a[96:99], 0
    ds_read_b128 a[244:247], v1 offset:13312
    v_cvt_pk_bf16_f32 v173, v90, v94
    v_mfma_f32_16x16x32_bf16 v[112:115], a[220:223], a[100:103], v[112:115]
    v_cvt_pk_bf16_f32 v175, v91, v95
    s_add_u32 s24, s16, 9437184
    v_mfma_f32_16x16x32_bf16 v[112:115], a[224:227], a[104:107], v[112:115]
    ds_read_b128 a[248:251], v1 offset:14336
    v_cvt_pk_bf16_f32 v204, v108, v109
    v_mfma_f32_16x16x32_bf16 v[112:115], a[228:231], a[108:111], v[112:115]
    v_cvt_pk_bf16_f32 v205, v110, v111
    v_mfma_f32_16x16x32_bf16 v[112:115], a[232:235], a[112:115], v[112:115]
    ds_read_b128 a[252:255], v1 offset:15360
    v_mfma_f32_16x16x32_bf16 v[112:115], a[236:239], a[116:119], v[112:115]
    v_mfma_f32_16x16x32_bf16 v[116:119], a[216:219], a[120:123], 0
    ds_read_b128 a[192:195], v1 offset:16384
    v_mfma_f32_16x16x32_bf16 v[116:119], a[220:223], a[124:127], v[116:119]
    v_mfma_f32_16x16x32_bf16 v[116:119], a[224:227], a[128:131], v[116:119]
    ds_read_b128 a[196:199], v1 offset:17408
    v_cvt_pk_bf16_f32 v194, v112, v113
    v_mfma_f32_16x16x32_bf16 v[116:119], a[228:231], a[132:135], v[116:119]
    v_cvt_pk_bf16_f32 v195, v114, v115
    v_mfma_f32_16x16x32_bf16 v[116:119], a[232:235], a[136:139], v[116:119]
    v_mfma_f32_16x16x32_bf16 v[116:119], a[236:239], a[140:143], v[116:119]
    v_mfma_f32_16x16x32_bf16 v[120:123], a[216:219], a[144:147], 0
    v_mfma_f32_16x16x32_bf16 v[120:123], a[220:223], a[148:151], v[120:123]
    v_mfma_f32_16x16x32_bf16 v[120:123], a[224:227], a[152:155], v[120:123]
    v_cvt_pk_bf16_f32 v198, v116, v117
    v_cvt_pk_bf16_f32 v199, v118, v119
    v_mfma_f32_16x16x32_bf16 v[120:123], a[228:231], a[156:159], v[120:123]
    v_mfma_f32_16x16x32_bf16 v[120:123], a[232:235], a[160:163], v[120:123]
    v_mfma_f32_16x16x32_bf16 v[120:123], a[236:239], a[164:167], v[120:123]
    v_mfma_f32_16x16x32_bf16 v[124:127], a[216:219], a[168:171], 0
    v_mfma_f32_16x16x32_bf16 v[124:127], a[220:223], a[172:175], v[124:127]
    buffer_load_dwordx4 a[24:27], v9, s[8:11], s26 offen offset:0 nt
    v_mfma_f32_16x16x32_bf16 v[124:127], a[224:227], a[176:179], v[124:127]
    buffer_load_dwordx4 a[28:31], v10, s[8:11], s26 offen offset:0 nt
    v_cvt_pk_bf16_f32 v202, v120, v121
    v_mfma_f32_16x16x32_bf16 v[124:127], a[228:231], a[180:183], v[124:127]
    v_cvt_pk_bf16_f32 v203, v122, v123
    v_mfma_f32_16x16x32_bf16 v[124:127], a[232:235], a[184:187], v[124:127]
    buffer_store_dwordx2 v[132:133], v11, s[12:15], s32 offen offset:896 sc1
    v_mfma_f32_16x16x32_bf16 v[124:127], a[236:239], a[188:191], v[124:127]
    ds_read_b128 a[200:203], v1 offset:18432
    s_waitcnt lgkmcnt(1)
    v_mfma_f32_16x16x32_bf16 v[96:99], a[240:243], a[96:99], 0
    ds_read_b128 a[204:207], v1 offset:19456
    v_mfma_f32_16x16x32_bf16 v[96:99], a[244:247], a[100:103], v[96:99]
    v_mfma_f32_16x16x32_bf16 v[96:99], a[248:251], a[104:107], v[96:99]
    ds_read_b128 a[208:211], v1 offset:20480
    v_cvt_pk_bf16_f32 v206, v124, v125
    v_mfma_f32_16x16x32_bf16 v[96:99], a[252:255], a[108:111], v[96:99]
    v_cvt_pk_bf16_f32 v207, v126, v127
    v_mfma_f32_16x16x32_bf16 v[96:99], a[192:195], a[112:115], v[96:99]
    ds_read_b128 a[212:215], v1 offset:21504
    v_mfma_f32_16x16x32_bf16 v[96:99], a[196:199], a[116:119], v[96:99]
    v_mfma_f32_16x16x32_bf16 v[100:103], a[240:243], a[120:123], 0
    ds_read_b128 a[216:219], v1 offset:22528
    v_mfma_f32_16x16x32_bf16 v[100:103], a[244:247], a[124:127], v[100:103]
    v_mfma_f32_16x16x32_bf16 v[100:103], a[248:251], a[128:131], v[100:103]
    ds_read_b128 a[220:223], v1 offset:23552
    v_cvt_pk_bf16_f32 v208, v96, v97
    v_mfma_f32_16x16x32_bf16 v[100:103], a[252:255], a[132:135], v[100:103]
    v_cvt_pk_bf16_f32 v209, v98, v99
    v_mfma_f32_16x16x32_bf16 v[100:103], a[192:195], a[136:139], v[100:103]
    v_mfma_f32_16x16x32_bf16 v[100:103], a[196:199], a[140:143], v[100:103]
    v_mfma_f32_16x16x32_bf16 v[104:107], a[240:243], a[144:147], 0
    v_mfma_f32_16x16x32_bf16 v[104:107], a[244:247], a[148:151], v[104:107]
    v_mfma_f32_16x16x32_bf16 v[104:107], a[248:251], a[152:155], v[104:107]
    v_cvt_pk_bf16_f32 v212, v100, v101
    v_cvt_pk_bf16_f32 v213, v102, v103
    v_mfma_f32_16x16x32_bf16 v[104:107], a[252:255], a[156:159], v[104:107]
    v_mfma_f32_16x16x32_bf16 v[104:107], a[192:195], a[160:163], v[104:107]
    v_mfma_f32_16x16x32_bf16 v[104:107], a[196:199], a[164:167], v[104:107]
    v_mfma_f32_16x16x32_bf16 v[108:111], a[240:243], a[168:171], 0
    v_mfma_f32_16x16x32_bf16 v[108:111], a[244:247], a[172:175], v[108:111]
    v_mfma_f32_16x16x32_bf16 v[108:111], a[248:251], a[176:179], v[108:111]
    v_cvt_pk_bf16_f32 v216, v104, v105
    v_cvt_pk_bf16_f32 v217, v106, v107
    v_mfma_f32_16x16x32_bf16 v[108:111], a[252:255], a[180:183], v[108:111]
    v_mfma_f32_16x16x32_bf16 v[108:111], a[192:195], a[184:187], v[108:111]
    ds_read_b128 a[224:227], v1 offset:24576
    v_mfma_f32_16x16x32_bf16 v[108:111], a[196:199], a[188:191], v[108:111]
    s_waitcnt vmcnt(10)
    ds_write_b64 v4, a[0:1] offset:0
    s_waitcnt lgkmcnt(2)
    v_mfma_f32_16x16x32_bf16 v[112:115], a[200:203], a[96:99], 0
    ds_read_b128 a[228:231], v1 offset:25600
    v_mfma_f32_16x16x32_bf16 v[112:115], a[204:207], a[100:103], v[112:115]
    buffer_store_dwordx2 v[134:135], v11, s[12:15], s32 offen offset:1280 sc1
    v_mfma_f32_16x16x32_bf16 v[112:115], a[208:211], a[104:107], v[112:115]
    ds_read_b128 a[232:235], v1 offset:26624
    v_cvt_pk_bf16_f32 v220, v108, v109
    v_mfma_f32_16x16x32_bf16 v[112:115], a[212:215], a[108:111], v[112:115]
    ds_write_b64 v4, a[2:3] offset:1024
    v_mfma_f32_16x16x32_bf16 v[112:115], a[216:219], a[112:115], v[112:115]
    ds_read_b128 a[236:239], v1 offset:27648
    v_cvt_pk_bf16_f32 v221, v110, v111
    v_mfma_f32_16x16x32_bf16 v[112:115], a[220:223], a[116:119], v[112:115]
    s_waitcnt vmcnt(10)
    ds_write_b64 v4, a[4:5] offset:512
    v_mfma_f32_16x16x32_bf16 v[116:119], a[200:203], a[120:123], 0
    ds_read_b128 a[240:243], v1 offset:28672
    v_mfma_f32_16x16x32_bf16 v[116:119], a[204:207], a[124:127], v[116:119]
    ds_write_b64 v4, a[6:7] offset:1536
    v_mfma_f32_16x16x32_bf16 v[116:119], a[208:211], a[128:131], v[116:119]
    ds_read_b128 a[244:247], v1 offset:29696
    v_cvt_pk_bf16_f32 v210, v112, v113
    v_mfma_f32_16x16x32_bf16 v[116:119], a[212:215], a[132:135], v[116:119]
    ds_read2_b64 a[0:3], v5 offset0:0 offset1:128
    v_cvt_pk_bf16_f32 v211, v114, v115
    v_mfma_f32_16x16x32_bf16 v[116:119], a[216:219], a[136:139], v[116:119]
    ds_read2_b64 a[4:7], v6 offset0:0 offset1:128
    v_mfma_f32_16x16x32_bf16 v[116:119], a[220:223], a[140:143], v[116:119]
    v_mfma_f32_16x16x32_bf16 v[120:123], a[200:203], a[144:147], 0
    v_mfma_f32_16x16x32_bf16 v[120:123], a[204:207], a[148:151], v[120:123]
    v_mfma_f32_16x16x32_bf16 v[120:123], a[208:211], a[152:155], v[120:123]
    v_cvt_pk_bf16_f32 v214, v116, v117
    v_cvt_pk_bf16_f32 v215, v118, v119
    v_mfma_f32_16x16x32_bf16 v[120:123], a[212:215], a[156:159], v[120:123]
    v_mfma_f32_16x16x32_bf16 v[120:123], a[216:219], a[160:163], v[120:123]
    buffer_load_dwordx4 a[32:35], v9, s[8:11], s26 offen offset:128 nt
    v_mfma_f32_16x16x32_bf16 v[120:123], a[220:223], a[164:167], v[120:123]
    buffer_load_dwordx4 a[36:39], v10, s[8:11], s26 offen offset:128 nt
    v_mfma_f32_16x16x32_bf16 v[124:127], a[200:203], a[168:171], 0
    v_mfma_f32_16x16x32_bf16 v[124:127], a[204:207], a[172:175], v[124:127]
    v_mfma_f32_16x16x32_bf16 v[124:127], a[208:211], a[176:179], v[124:127]
    v_cvt_pk_bf16_f32 v218, v120, v121
    v_cvt_pk_bf16_f32 v219, v122, v123
    v_mfma_f32_16x16x32_bf16 v[124:127], a[212:215], a[180:183], v[124:127]
    v_mfma_f32_16x16x32_bf16 v[124:127], a[216:219], a[184:187], v[124:127]
    v_mfma_f32_16x16x32_bf16 v[124:127], a[220:223], a[188:191], v[124:127]
    s_waitcnt lgkmcnt(1)
    v_mfma_f32_16x16x32_bf16 v[96:99], a[224:227], a[96:99], 0
    v_mfma_f32_16x16x32_bf16 v[96:99], a[228:231], a[100:103], v[96:99]
    v_mfma_f32_16x16x32_bf16 v[96:99], a[232:235], a[104:107], v[96:99]
    v_cvt_pk_bf16_f32 v222, v124, v125
    v_cvt_pk_bf16_f32 v223, v126, v127
    v_mfma_f32_16x16x32_bf16 v[96:99], a[236:239], a[108:111], v[96:99]
    v_mfma_f32_16x16x32_bf16 v[96:99], a[240:243], a[112:115], v[96:99]
    buffer_store_dwordx2 v[136:137], v11, s[12:15], s34 offen offset:128 sc1
    v_mfma_f32_16x16x32_bf16 v[96:99], a[244:247], a[116:119], v[96:99]
    v_mfma_f32_16x16x32_bf16 v[100:103], a[224:227], a[120:123], 0
    v_mfma_f32_16x16x32_bf16 v[100:103], a[228:231], a[124:127], v[100:103]
    v_mfma_f32_16x16x32_bf16 v[100:103], a[232:235], a[128:131], v[100:103]
    v_mfma_f32_16x16x32_bf16 v[100:103], a[236:239], a[132:135], v[100:103]
    v_mfma_f32_16x16x32_bf16 v[100:103], a[240:243], a[136:139], v[100:103]
    v_mfma_f32_16x16x32_bf16 v[100:103], a[244:247], a[140:143], v[100:103]
    v_mfma_f32_16x16x32_bf16 v[32:35], a[96:99], v[192:195], 0
    v_mfma_f32_16x16x32_bf16 v[32:35], a[100:103], v[208:211], v[32:35]
    v_mfma_f32_16x16x32_bf16 v[36:39], a[120:123], v[192:195], 0
    v_mfma_f32_16x16x32_bf16 v[36:39], a[124:127], v[208:211], v[36:39]
    v_mfma_f32_16x16x32_bf16 v[40:43], a[144:147], v[192:195], 0
    v_mfma_f32_16x16x32_bf16 v[40:43], a[148:151], v[208:211], v[40:43]
    v_mfma_f32_16x16x32_bf16 v[44:47], a[168:171], v[192:195], 0
    v_cvt_pk_bf16_f32 v192, v96, v97
    v_cvt_pk_bf16_f32 v193, v98, v99
    v_mfma_f32_16x16x32_bf16 v[44:47], a[172:175], v[208:211], v[44:47]
    s_waitcnt vmcnt(12)
    ds_write_b64 v4, a[8:9] offset:0
    v_mfma_f32_16x16x32_bf16 v[48:51], a[96:99], v[196:199], 0
    ds_write_b64 v4, a[10:11] offset:1024
    v_mfma_f32_16x16x32_bf16 v[48:51], a[100:103], v[212:215], v[48:51]
    s_waitcnt vmcnt(11)
    ds_write_b64 v4, a[12:13] offset:512
    v_mfma_f32_16x16x32_bf16 v[52:55], a[120:123], v[196:199], 0
    ds_write_b64 v4, a[14:15] offset:1536
    v_mfma_f32_16x16x32_bf16 v[52:55], a[124:127], v[212:215], v[52:55]
    ds_read2_b64 a[8:11], v5 offset0:0 offset1:128
    v_mfma_f32_16x16x32_bf16 v[56:59], a[144:147], v[196:199], 0
    ds_read2_b64 a[12:15], v6 offset0:0 offset1:128
    v_mfma_f32_16x16x32_bf16 v[56:59], a[148:151], v[212:215], v[56:59]
    v_mfma_f32_16x16x32_bf16 v[60:63], a[168:171], v[196:199], 0
    v_cvt_pk_bf16_f32 v196, v100, v101
    v_cvt_pk_bf16_f32 v197, v102, v103
    v_mfma_f32_16x16x32_bf16 v[60:63], a[172:175], v[212:215], v[60:63]
    v_mfma_f32_16x16x32_bf16 v[64:67], a[96:99], v[200:203], 0
    v_mfma_f32_16x16x32_bf16 v[64:67], a[100:103], v[216:219], v[64:67]
    v_mfma_f32_16x16x32_bf16 v[68:71], a[120:123], v[200:203], 0
    ds_read_b128 a[248:251], v1 offset:30720
    v_mfma_f32_16x16x32_bf16 v[68:71], a[124:127], v[216:219], v[68:71]
    buffer_store_dwordx2 v[138:139], v11, s[12:15], s34 offen offset:512 sc1
    v_mfma_f32_16x16x32_bf16 v[72:75], a[144:147], v[200:203], 0
    ds_read_b128 a[252:255], v1 offset:31744
    v_mfma_f32_16x16x32_bf16 v[72:75], a[148:151], v[216:219], v[72:75]
    v_mfma_f32_16x16x32_bf16 v[76:79], a[168:171], v[200:203], 0
    ds_read_b128 a[192:195], v1 offset:32768
    v_mfma_f32_16x16x32_bf16 v[76:79], a[172:175], v[216:219], v[76:79]
    v_mfma_f32_16x16x32_bf16 v[80:83], a[96:99], v[204:207], 0
    ds_read_b128 a[196:199], v1 offset:33792
    v_mfma_f32_16x16x32_bf16 v[80:83], a[100:103], v[220:223], v[80:83]
    buffer_load_dwordx4 a[40:43], v9, s[8:11], s26 offen offset:256 nt
    v_mfma_f32_16x16x32_bf16 v[84:87], a[120:123], v[204:207], 0
    buffer_load_dwordx4 a[44:47], v10, s[8:11], s26 offen offset:256 nt
    s_add_u32 s26, s16, 9830400
    v_mfma_f32_16x16x32_bf16 v[84:87], a[124:127], v[220:223], v[84:87]
    ds_read_b128 a[200:203], v1 offset:34816
    v_mfma_f32_16x16x32_bf16 v[88:91], a[144:147], v[204:207], 0
    ds_read_b128 a[204:207], v1 offset:35840
    v_mfma_f32_16x16x32_bf16 v[88:91], a[148:151], v[220:223], v[88:91]
    v_mfma_f32_16x16x32_bf16 v[92:95], a[168:171], v[204:207], 0
    v_mfma_f32_16x16x32_bf16 v[92:95], a[172:175], v[220:223], v[92:95]
    v_mfma_f32_16x16x32_bf16 v[104:107], a[224:227], a[144:147], 0
    v_mfma_f32_16x16x32_bf16 v[104:107], a[228:231], a[148:151], v[104:107]
    v_mfma_f32_16x16x32_bf16 v[104:107], a[232:235], a[152:155], v[104:107]
    v_mfma_f32_16x16x32_bf16 v[104:107], a[236:239], a[156:159], v[104:107]
    v_mfma_f32_16x16x32_bf16 v[104:107], a[240:243], a[160:163], v[104:107]
    v_mfma_f32_16x16x32_bf16 v[104:107], a[244:247], a[164:167], v[104:107]
    v_mfma_f32_16x16x32_bf16 v[108:111], a[224:227], a[168:171], 0
    v_mfma_f32_16x16x32_bf16 v[108:111], a[228:231], a[172:175], v[108:111]
    v_mfma_f32_16x16x32_bf16 v[108:111], a[232:235], a[176:179], v[108:111]
    v_cvt_pk_bf16_f32 v200, v104, v105
    v_cvt_pk_bf16_f32 v201, v106, v107
    v_mfma_f32_16x16x32_bf16 v[108:111], a[236:239], a[180:183], v[108:111]
    v_mfma_f32_16x16x32_bf16 v[108:111], a[240:243], a[184:187], v[108:111]
    ds_read_b128 a[208:211], v1 offset:36864
    v_mfma_f32_16x16x32_bf16 v[108:111], a[244:247], a[188:191], v[108:111]
    s_waitcnt lgkmcnt(1)
    v_mfma_f32_16x16x32_bf16 v[112:115], a[248:251], a[96:99], 0
    ds_read_b128 a[212:215], v1 offset:37888
    v_mfma_f32_16x16x32_bf16 v[112:115], a[252:255], a[100:103], v[112:115]
    v_mfma_f32_16x16x32_bf16 v[112:115], a[192:195], a[104:107], v[112:115]
    buffer_store_dwordx2 v[140:141], v11, s[12:15], s34 offen offset:896 sc1
    v_mfma_f32_16x16x32_bf16 v[112:115], a[196:199], a[108:111], v[112:115]
    ds_read_b128 a[216:219], v1 offset:38912
    v_cvt_pk_bf16_f32 v204, v108, v109
    v_mfma_f32_16x16x32_bf16 v[112:115], a[200:203], a[112:115], v[112:115]
    ds_read_b128 a[220:223], v1 offset:39936
    v_cvt_pk_bf16_f32 v205, v110, v111
    v_mfma_f32_16x16x32_bf16 v[112:115], a[204:207], a[116:119], v[112:115]
    v_mfma_f32_16x16x32_bf16 v[116:119], a[248:251], a[120:123], 0
    ds_read_b128 a[224:227], v1 offset:40960
    v_mfma_f32_16x16x32_bf16 v[116:119], a[252:255], a[124:127], v[116:119]
    v_mfma_f32_16x16x32_bf16 v[116:119], a[192:195], a[128:131], v[116:119]
    ds_read_b128 a[228:231], v1 offset:41984
    v_cvt_pk_bf16_f32 v194, v112, v113
    v_mfma_f32_16x16x32_bf16 v[116:119], a[196:199], a[132:135], v[116:119]
    s_waitcnt vmcnt(13)
    ds_write_b64 v4, a[16:17] offset:0
    v_mfma_f32_16x16x32_bf16 v[116:119], a[200:203], a[136:139], v[116:119]
    ds_write_b64 v4, a[18:19] offset:1024
    v_mfma_f32_16x16x32_bf16 v[116:119], a[204:207], a[140:143], v[116:119]
    s_waitcnt vmcnt(12)
    ds_write_b64 v4, a[20:21] offset:512
    v_mfma_f32_16x16x32_bf16 v[120:123], a[248:251], a[144:147], 0
    ds_write_b64 v4, a[22:23] offset:1536
    v_mfma_f32_16x16x32_bf16 v[120:123], a[252:255], a[148:151], v[120:123]
    ds_read2_b64 a[16:19], v5 offset0:0 offset1:128
    v_cvt_pk_bf16_f32 v195, v114, v115
    v_mfma_f32_16x16x32_bf16 v[120:123], a[192:195], a[152:155], v[120:123]
    ds_read2_b64 a[20:23], v6 offset0:0 offset1:128
    v_cvt_pk_bf16_f32 v198, v116, v117
    v_mfma_f32_16x16x32_bf16 v[120:123], a[196:199], a[156:159], v[120:123]
    v_cvt_pk_bf16_f32 v199, v118, v119
    v_mfma_f32_16x16x32_bf16 v[120:123], a[200:203], a[160:163], v[120:123]
    v_mfma_f32_16x16x32_bf16 v[120:123], a[204:207], a[164:167], v[120:123]
    v_mfma_f32_16x16x32_bf16 v[124:127], a[248:251], a[168:171], 0
    v_mfma_f32_16x16x32_bf16 v[124:127], a[252:255], a[172:175], v[124:127]
    v_mfma_f32_16x16x32_bf16 v[124:127], a[192:195], a[176:179], v[124:127]
    v_cvt_pk_bf16_f32 v202, v120, v121
    v_cvt_pk_bf16_f32 v203, v122, v123
    v_mfma_f32_16x16x32_bf16 v[124:127], a[196:199], a[180:183], v[124:127]
    v_mfma_f32_16x16x32_bf16 v[124:127], a[200:203], a[184:187], v[124:127]
    ds_read_b128 a[232:235], v1 offset:43008
    v_mfma_f32_16x16x32_bf16 v[124:127], a[204:207], a[188:191], v[124:127]
    s_waitcnt lgkmcnt(5)
    v_mfma_f32_16x16x32_bf16 v[96:99], a[208:211], a[96:99], 0
    ds_read_b128 a[236:239], v1 offset:44032
    v_mfma_f32_16x16x32_bf16 v[96:99], a[212:215], a[100:103], v[96:99]
    v_mfma_f32_16x16x32_bf16 v[96:99], a[216:219], a[104:107], v[96:99]
    buffer_load_dwordx4 a[48:51], v9, s[8:11], s28 offen offset:0 nt
    v_cvt_pk_bf16_f32 v206, v124, v125
    v_mfma_f32_16x16x32_bf16 v[96:99], a[220:223], a[108:111], v[96:99]
    buffer_load_dwordx4 a[52:55], v10, s[8:11], s28 offen offset:0 nt
    v_cvt_pk_bf16_f32 v207, v126, v127
    v_mfma_f32_16x16x32_bf16 v[96:99], a[224:227], a[112:115], v[96:99]
    ds_read_b128 a[240:243], v1 offset:45056
    v_mfma_f32_16x16x32_bf16 v[96:99], a[228:231], a[116:119], v[96:99]
    ds_read_b128 a[244:247], v1 offset:46080
    v_mfma_f32_16x16x32_bf16 v[100:103], a[208:211], a[120:123], 0
    buffer_store_dwordx2 v[142:143], v11, s[12:15], s34 offen offset:1280 sc1
    v_mfma_f32_16x16x32_bf16 v[100:103], a[212:215], a[124:127], v[100:103]
    ds_read_b128 a[248:251], v1 offset:47104
    v_mfma_f32_16x16x32_bf16 v[100:103], a[216:219], a[128:131], v[100:103]
    ds_read_b128 a[252:255], v1 offset:48128
    v_cvt_pk_bf16_f32 v208, v96, v97
    v_mfma_f32_16x16x32_bf16 v[100:103], a[220:223], a[132:135], v[100:103]
    v_cvt_pk_bf16_f32 v209, v98, v99
    v_mfma_f32_16x16x32_bf16 v[100:103], a[224:227], a[136:139], v[100:103]
    v_mfma_f32_16x16x32_bf16 v[100:103], a[228:231], a[140:143], v[100:103]
    v_mfma_f32_16x16x32_bf16 v[104:107], a[208:211], a[144:147], 0
    v_mfma_f32_16x16x32_bf16 v[104:107], a[212:215], a[148:151], v[104:107]
    v_mfma_f32_16x16x32_bf16 v[104:107], a[216:219], a[152:155], v[104:107]
    v_cvt_pk_bf16_f32 v212, v100, v101
    v_cvt_pk_bf16_f32 v213, v102, v103
    v_mfma_f32_16x16x32_bf16 v[104:107], a[220:223], a[156:159], v[104:107]
    v_mfma_f32_16x16x32_bf16 v[104:107], a[224:227], a[160:163], v[104:107]
    v_mfma_f32_16x16x32_bf16 v[104:107], a[228:231], a[164:167], v[104:107]
    v_mfma_f32_16x16x32_bf16 v[108:111], a[208:211], a[168:171], 0
    v_mfma_f32_16x16x32_bf16 v[108:111], a[212:215], a[172:175], v[108:111]
    v_mfma_f32_16x16x32_bf16 v[108:111], a[216:219], a[176:179], v[108:111]
    v_cvt_pk_bf16_f32 v216, v104, v105
    v_cvt_pk_bf16_f32 v217, v106, v107
    v_mfma_f32_16x16x32_bf16 v[108:111], a[220:223], a[180:183], v[108:111]
    v_mfma_f32_16x16x32_bf16 v[108:111], a[224:227], a[184:187], v[108:111]
    ds_read_b128 a[192:195], v1 offset:49152
    v_mfma_f32_16x16x32_bf16 v[108:111], a[228:231], a[188:191], v[108:111]
    s_waitcnt lgkmcnt(1)
    v_mfma_f32_16x16x32_bf16 v[112:115], a[232:235], a[96:99], 0
    ds_read_b128 a[196:199], v1 offset:50176
    v_mfma_f32_16x16x32_bf16 v[112:115], a[236:239], a[100:103], v[112:115]
    v_mfma_f32_16x16x32_bf16 v[112:115], a[240:243], a[104:107], v[112:115]
    ds_read_b128 a[200:203], v1 offset:51200
    v_cvt_pk_bf16_f32 v220, v108, v109
    v_mfma_f32_16x16x32_bf16 v[112:115], a[244:247], a[108:111], v[112:115]
    v_cvt_pk_bf16_f32 v221, v110, v111
    v_mfma_f32_16x16x32_bf16 v[112:115], a[248:251], a[112:115], v[112:115]
    ds_read_b128 a[204:207], v1 offset:52224
    v_mfma_f32_16x16x32_bf16 v[112:115], a[252:255], a[116:119], v[112:115]
    s_waitcnt vmcnt(13)
    ds_write_b64 v4, a[24:25] offset:0
    v_mfma_f32_16x16x32_bf16 v[116:119], a[232:235], a[120:123], 0
    ds_read_b128 a[208:211], v1 offset:53248
    v_mfma_f32_16x16x32_bf16 v[116:119], a[236:239], a[124:127], v[116:119]
    ds_write_b64 v4, a[26:27] offset:1024
    v_mfma_f32_16x16x32_bf16 v[116:119], a[240:243], a[128:131], v[116:119]
    buffer_store_dwordx2 v[144:145], v11, s[12:15], s36 offen offset:128 sc1
    v_mfma_f32_16x16x32_bf16 v[116:119], a[244:247], a[132:135], v[116:119]
    ds_read_b128 a[212:215], v1 offset:54272
    v_cvt_pk_bf16_f32 v210, v112, v113
    v_mfma_f32_16x16x32_bf16 v[116:119], a[248:251], a[136:139], v[116:119]
    s_waitcnt vmcnt(13)
    ds_write_b64 v4, a[28:29] offset:512
    v_mfma_f32_16x16x32_bf16 v[116:119], a[252:255], a[140:143], v[116:119]
    ds_write_b64 v4, a[30:31] offset:1536
    v_mfma_f32_16x16x32_bf16 v[120:123], a[232:235], a[144:147], 0
    ds_read2_b64 a[24:27], v5 offset0:0 offset1:128
    v_cvt_pk_bf16_f32 v211, v114, v115
    v_mfma_f32_16x16x32_bf16 v[120:123], a[236:239], a[148:151], v[120:123]
    ds_read2_b64 a[28:31], v6 offset0:0 offset1:128
    v_mfma_f32_16x16x32_bf16 v[120:123], a[240:243], a[152:155], v[120:123]
    v_cvt_pk_bf16_f32 v214, v116, v117
    v_cvt_pk_bf16_f32 v215, v118, v119
    v_mfma_f32_16x16x32_bf16 v[120:123], a[244:247], a[156:159], v[120:123]
    v_mfma_f32_16x16x32_bf16 v[120:123], a[248:251], a[160:163], v[120:123]
    v_mfma_f32_16x16x32_bf16 v[120:123], a[252:255], a[164:167], v[120:123]
    v_mfma_f32_16x16x32_bf16 v[124:127], a[232:235], a[168:171], 0
    v_mfma_f32_16x16x32_bf16 v[124:127], a[236:239], a[172:175], v[124:127]
    v_mfma_f32_16x16x32_bf16 v[124:127], a[240:243], a[176:179], v[124:127]
    v_cvt_pk_bf16_f32 v218, v120, v121
    v_cvt_pk_bf16_f32 v219, v122, v123
    v_mfma_f32_16x16x32_bf16 v[124:127], a[244:247], a[180:183], v[124:127]
    v_mfma_f32_16x16x32_bf16 v[124:127], a[248:251], a[184:187], v[124:127]
    v_mfma_f32_16x16x32_bf16 v[124:127], a[252:255], a[188:191], v[124:127]
    buffer_load_dwordx4 a[56:59], v9, s[8:11], s28 offen offset:128 nt
    s_waitcnt lgkmcnt(4)
    v_mfma_f32_16x16x32_bf16 v[96:99], a[192:195], a[96:99], 0
    buffer_load_dwordx4 a[60:63], v10, s[8:11], s28 offen offset:128 nt
    v_mfma_f32_16x16x32_bf16 v[96:99], a[196:199], a[100:103], v[96:99]
    v_mfma_f32_16x16x32_bf16 v[96:99], a[200:203], a[104:107], v[96:99]
    v_cvt_pk_bf16_f32 v222, v124, v125
    v_cvt_pk_bf16_f32 v223, v126, v127
    v_mfma_f32_16x16x32_bf16 v[96:99], a[204:207], a[108:111], v[96:99]
    v_mfma_f32_16x16x32_bf16 v[96:99], a[208:211], a[112:115], v[96:99]
    v_mfma_f32_16x16x32_bf16 v[96:99], a[212:215], a[116:119], v[96:99]
    v_mfma_f32_16x16x32_bf16 v[100:103], a[192:195], a[120:123], 0
    v_mfma_f32_16x16x32_bf16 v[100:103], a[196:199], a[124:127], v[100:103]
    v_mfma_f32_16x16x32_bf16 v[100:103], a[200:203], a[128:131], v[100:103]
    v_mfma_f32_16x16x32_bf16 v[100:103], a[204:207], a[132:135], v[100:103]
    v_mfma_f32_16x16x32_bf16 v[100:103], a[208:211], a[136:139], v[100:103]
    v_mfma_f32_16x16x32_bf16 v[100:103], a[212:215], a[140:143], v[100:103]
    buffer_store_dwordx2 v[146:147], v11, s[12:15], s36 offen offset:512 sc1
    v_mfma_f32_16x16x32_bf16 v[32:35], a[104:107], v[192:195], v[32:35]
    v_mfma_f32_16x16x32_bf16 v[32:35], a[108:111], v[208:211], v[32:35]
    v_mfma_f32_16x16x32_bf16 v[36:39], a[128:131], v[192:195], v[36:39]
    v_mfma_f32_16x16x32_bf16 v[36:39], a[132:135], v[208:211], v[36:39]
    v_mfma_f32_16x16x32_bf16 v[40:43], a[152:155], v[192:195], v[40:43]
    v_mfma_f32_16x16x32_bf16 v[40:43], a[156:159], v[208:211], v[40:43]
    v_mfma_f32_16x16x32_bf16 v[44:47], a[176:179], v[192:195], v[44:47]
    v_cvt_pk_bf16_f32 v192, v96, v97
    v_cvt_pk_bf16_f32 v193, v98, v99
    v_mfma_f32_16x16x32_bf16 v[44:47], a[180:183], v[208:211], v[44:47]
    buffer_store_dwordx2 v[148:149], v11, s[12:15], s36 offen offset:896 sc1
    v_mfma_f32_16x16x32_bf16 v[48:51], a[104:107], v[196:199], v[48:51]
    v_mfma_f32_16x16x32_bf16 v[48:51], a[108:111], v[212:215], v[48:51]
    v_mfma_f32_16x16x32_bf16 v[52:55], a[128:131], v[196:199], v[52:55]
    v_mfma_f32_16x16x32_bf16 v[52:55], a[132:135], v[212:215], v[52:55]
    v_mfma_f32_16x16x32_bf16 v[56:59], a[152:155], v[196:199], v[56:59]
    v_mfma_f32_16x16x32_bf16 v[56:59], a[156:159], v[212:215], v[56:59]
    v_mfma_f32_16x16x32_bf16 v[60:63], a[176:179], v[196:199], v[60:63]
    s_waitcnt vmcnt(14)
    ds_write_b64 v4, a[32:33] offset:0
    v_mfma_f32_16x16x32_bf16 v[60:63], a[180:183], v[212:215], v[60:63]
    buffer_store_dwordx2 v[150:151], v11, s[12:15], s36 offen offset:1280 sc1
    v_mfma_f32_16x16x32_bf16 v[64:67], a[104:107], v[200:203], v[64:67]
    ds_write_b64 v4, a[34:35] offset:1024
    v_mfma_f32_16x16x32_bf16 v[64:67], a[108:111], v[216:219], v[64:67]
    s_waitcnt vmcnt(14)
    ds_write_b64 v4, a[36:37] offset:512
    v_mfma_f32_16x16x32_bf16 v[68:71], a[128:131], v[200:203], v[68:71]
    ds_read_b128 a[216:219], v1 offset:55296
    v_cvt_pk_bf16_f32 v196, v100, v101
    v_mfma_f32_16x16x32_bf16 v[68:71], a[132:135], v[216:219], v[68:71]
    ds_write_b64 v4, a[38:39] offset:1536
    v_mfma_f32_16x16x32_bf16 v[72:75], a[152:155], v[200:203], v[72:75]
    ds_read_b128 a[220:223], v1 offset:56320
    v_cvt_pk_bf16_f32 v197, v102, v103
    v_mfma_f32_16x16x32_bf16 v[72:75], a[156:159], v[216:219], v[72:75]
    ds_read2_b64 a[32:35], v5 offset0:0 offset1:128
    v_mfma_f32_16x16x32_bf16 v[76:79], a[176:179], v[200:203], v[76:79]
    ds_read_b128 a[224:227], v1 offset:57344
    v_mfma_f32_16x16x32_bf16 v[76:79], a[180:183], v[216:219], v[76:79]
    buffer_store_dwordx2 v[152:153], v11, s[12:15], s38 offen offset:128 sc1
    v_mfma_f32_16x16x32_bf16 v[80:83], a[104:107], v[204:207], v[80:83]
    ds_read_b128 a[228:231], v1 offset:58368
    v_mfma_f32_16x16x32_bf16 v[80:83], a[108:111], v[220:223], v[80:83]
    ds_read2_b64 a[36:39], v6 offset0:0 offset1:128
    v_mfma_f32_16x16x32_bf16 v[84:87], a[128:131], v[204:207], v[84:87]
    ds_read_b128 a[232:235], v1 offset:59392
    v_mfma_f32_16x16x32_bf16 v[84:87], a[132:135], v[220:223], v[84:87]
    v_mfma_f32_16x16x32_bf16 v[88:91], a[152:155], v[204:207], v[88:91]
    ds_read_b128 a[236:239], v1 offset:60416
    v_mfma_f32_16x16x32_bf16 v[88:91], a[156:159], v[220:223], v[88:91]
    v_mfma_f32_16x16x32_bf16 v[92:95], a[176:179], v[204:207], v[92:95]
    v_mfma_f32_16x16x32_bf16 v[92:95], a[180:183], v[220:223], v[92:95]
    buffer_store_dwordx2 v[154:155], v11, s[12:15], s38 offen offset:512 sc1
    v_mfma_f32_16x16x32_bf16 v[104:107], a[192:195], a[144:147], 0
    v_mfma_f32_16x16x32_bf16 v[104:107], a[196:199], a[148:151], v[104:107]
    v_mfma_f32_16x16x32_bf16 v[104:107], a[200:203], a[152:155], v[104:107]
    v_mfma_f32_16x16x32_bf16 v[104:107], a[204:207], a[156:159], v[104:107]
    v_mfma_f32_16x16x32_bf16 v[104:107], a[208:211], a[160:163], v[104:107]
    v_mfma_f32_16x16x32_bf16 v[104:107], a[212:215], a[164:167], v[104:107]
    v_mfma_f32_16x16x32_bf16 v[108:111], a[192:195], a[168:171], 0
    v_mfma_f32_16x16x32_bf16 v[108:111], a[196:199], a[172:175], v[108:111]
    buffer_store_dwordx2 v[156:157], v11, s[12:15], s38 offen offset:896 sc1
    v_mfma_f32_16x16x32_bf16 v[108:111], a[200:203], a[176:179], v[108:111]
    v_cvt_pk_bf16_f32 v200, v104, v105
    v_cvt_pk_bf16_f32 v201, v106, v107
    v_mfma_f32_16x16x32_bf16 v[108:111], a[204:207], a[180:183], v[108:111]
    v_mfma_f32_16x16x32_bf16 v[108:111], a[208:211], a[184:187], v[108:111]
    ds_read_b128 a[240:243], v1 offset:61440
    v_mfma_f32_16x16x32_bf16 v[108:111], a[212:215], a[188:191], v[108:111]
    s_waitcnt lgkmcnt(1)
    v_mfma_f32_16x16x32_bf16 v[112:115], a[216:219], a[96:99], 0
    ds_read_b128 a[244:247], v1 offset:62464
    v_mfma_f32_16x16x32_bf16 v[112:115], a[220:223], a[100:103], v[112:115]
    v_mfma_f32_16x16x32_bf16 v[112:115], a[224:227], a[104:107], v[112:115]
    ds_read_b128 a[248:251], v1 offset:63488
    v_cvt_pk_bf16_f32 v204, v108, v109
    v_mfma_f32_16x16x32_bf16 v[112:115], a[228:231], a[108:111], v[112:115]
    buffer_store_dwordx2 v[158:159], v11, s[12:15], s38 offen offset:1280 sc1
    v_mfma_f32_16x16x32_bf16 v[112:115], a[232:235], a[112:115], v[112:115]
    ds_read_b128 a[252:255], v1 offset:64512
    v_cvt_pk_bf16_f32 v205, v110, v111
    v_mfma_f32_16x16x32_bf16 v[112:115], a[236:239], a[116:119], v[112:115]
    v_mfma_f32_16x16x32_bf16 v[116:119], a[216:219], a[120:123], 0
    ds_read_b128 a[192:195], v2 offset:0
    v_mfma_f32_16x16x32_bf16 v[116:119], a[220:223], a[124:127], v[116:119]
    v_mfma_f32_16x16x32_bf16 v[116:119], a[224:227], a[128:131], v[116:119]
    ds_read_b128 a[196:199], v2 offset:1024
    v_cvt_pk_bf16_f32 v194, v112, v113
    v_mfma_f32_16x16x32_bf16 v[116:119], a[228:231], a[132:135], v[116:119]
    v_cvt_pk_bf16_f32 v195, v114, v115
    v_mfma_f32_16x16x32_bf16 v[116:119], a[232:235], a[136:139], v[116:119]
    v_mfma_f32_16x16x32_bf16 v[116:119], a[236:239], a[140:143], v[116:119]
    buffer_store_dwordx2 v[160:161], v11, s[12:15], s32 offen offset:256 sc1
    v_mfma_f32_16x16x32_bf16 v[120:123], a[216:219], a[144:147], 0
    v_mfma_f32_16x16x32_bf16 v[120:123], a[220:223], a[148:151], v[120:123]
    v_mfma_f32_16x16x32_bf16 v[120:123], a[224:227], a[152:155], v[120:123]
    v_cvt_pk_bf16_f32 v198, v116, v117
    v_cvt_pk_bf16_f32 v199, v118, v119
    v_mfma_f32_16x16x32_bf16 v[120:123], a[228:231], a[156:159], v[120:123]
    s_waitcnt vmcnt(16)
    ds_write_b64 v4, a[40:41] offset:0
    v_mfma_f32_16x16x32_bf16 v[120:123], a[232:235], a[160:163], v[120:123]
    ds_write_b64 v4, a[42:43] offset:1024
    v_mfma_f32_16x16x32_bf16 v[120:123], a[236:239], a[164:167], v[120:123]
    s_waitcnt vmcnt(15)
    ds_write_b64 v4, a[44:45] offset:512
    v_mfma_f32_16x16x32_bf16 v[124:127], a[216:219], a[168:171], 0
    ds_write_b64 v4, a[46:47] offset:1536
    v_mfma_f32_16x16x32_bf16 v[124:127], a[220:223], a[172:175], v[124:127]
    buffer_store_dwordx2 v[162:163], v11, s[12:15], s32 offen offset:640 sc1
    v_mfma_f32_16x16x32_bf16 v[124:127], a[224:227], a[176:179], v[124:127]
    ds_read2_b64 a[40:43], v5 offset0:0 offset1:128
    v_cvt_pk_bf16_f32 v202, v120, v121
    v_mfma_f32_16x16x32_bf16 v[124:127], a[228:231], a[180:183], v[124:127]
    ds_read2_b64 a[44:47], v6 offset0:0 offset1:128
    v_cvt_pk_bf16_f32 v203, v122, v123
    v_mfma_f32_16x16x32_bf16 v[124:127], a[232:235], a[184:187], v[124:127]
    ds_read_b128 a[200:203], v2 offset:2048
    v_mfma_f32_16x16x32_bf16 v[124:127], a[236:239], a[188:191], v[124:127]
    s_waitcnt lgkmcnt(7)
    v_mfma_f32_16x16x32_bf16 v[96:99], a[240:243], a[96:99], 0
    ds_read_b128 a[204:207], v2 offset:3072
    v_mfma_f32_16x16x32_bf16 v[96:99], a[244:247], a[100:103], v[96:99]
    v_mfma_f32_16x16x32_bf16 v[96:99], a[248:251], a[104:107], v[96:99]
    ds_read_b128 a[208:211], v2 offset:4096
    v_cvt_pk_bf16_f32 v206, v124, v125
    v_mfma_f32_16x16x32_bf16 v[96:99], a[252:255], a[108:111], v[96:99]
    buffer_store_dwordx2 v[164:165], v11, s[12:15], s32 offen offset:1024 sc1
    v_mfma_f32_16x16x32_bf16 v[96:99], a[192:195], a[112:115], v[96:99]
    ds_read_b128 a[212:215], v2 offset:5120
    v_cvt_pk_bf16_f32 v207, v126, v127
    v_mfma_f32_16x16x32_bf16 v[96:99], a[196:199], a[116:119], v[96:99]
    v_mfma_f32_16x16x32_bf16 v[100:103], a[240:243], a[120:123], 0
    ds_read_b128 a[216:219], v2 offset:6144
    v_mfma_f32_16x16x32_bf16 v[100:103], a[244:247], a[124:127], v[100:103]
    v_mfma_f32_16x16x32_bf16 v[100:103], a[248:251], a[128:131], v[100:103]
    ds_read_b128 a[220:223], v2 offset:7168
    v_cvt_pk_bf16_f32 v208, v96, v97
    v_mfma_f32_16x16x32_bf16 v[100:103], a[252:255], a[132:135], v[100:103]
    v_cvt_pk_bf16_f32 v209, v98, v99
    v_mfma_f32_16x16x32_bf16 v[100:103], a[192:195], a[136:139], v[100:103]
    v_mfma_f32_16x16x32_bf16 v[100:103], a[196:199], a[140:143], v[100:103]
    buffer_store_dwordx2 v[166:167], v11, s[12:15], s32 offen offset:1408 sc1
    v_mfma_f32_16x16x32_bf16 v[104:107], a[240:243], a[144:147], 0
    v_mfma_f32_16x16x32_bf16 v[104:107], a[244:247], a[148:151], v[104:107]
    v_mfma_f32_16x16x32_bf16 v[104:107], a[248:251], a[152:155], v[104:107]
    v_cvt_pk_bf16_f32 v212, v100, v101
    v_cvt_pk_bf16_f32 v213, v102, v103
    v_mfma_f32_16x16x32_bf16 v[104:107], a[252:255], a[156:159], v[104:107]
    v_mfma_f32_16x16x32_bf16 v[104:107], a[192:195], a[160:163], v[104:107]
    v_mfma_f32_16x16x32_bf16 v[104:107], a[196:199], a[164:167], v[104:107]
    v_mfma_f32_16x16x32_bf16 v[108:111], a[240:243], a[168:171], 0
    v_mfma_f32_16x16x32_bf16 v[108:111], a[244:247], a[172:175], v[108:111]
    buffer_store_dwordx2 v[168:169], v11, s[12:15], s34 offen offset:256 sc1
    v_mfma_f32_16x16x32_bf16 v[108:111], a[248:251], a[176:179], v[108:111]
    v_cvt_pk_bf16_f32 v216, v104, v105
    v_cvt_pk_bf16_f32 v217, v106, v107
    v_mfma_f32_16x16x32_bf16 v[108:111], a[252:255], a[180:183], v[108:111]
    v_mfma_f32_16x16x32_bf16 v[108:111], a[192:195], a[184:187], v[108:111]
    ds_read_b128 a[224:227], v2 offset:8192
    v_mfma_f32_16x16x32_bf16 v[108:111], a[196:199], a[188:191], v[108:111]
    s_waitcnt lgkmcnt(1)
    v_mfma_f32_16x16x32_bf16 v[112:115], a[200:203], a[96:99], 0
    ds_read_b128 a[228:231], v2 offset:9216
    v_mfma_f32_16x16x32_bf16 v[112:115], a[204:207], a[100:103], v[112:115]
    v_mfma_f32_16x16x32_bf16 v[112:115], a[208:211], a[104:107], v[112:115]
    ds_read_b128 a[232:235], v2 offset:10240
    v_cvt_pk_bf16_f32 v220, v108, v109
    v_mfma_f32_16x16x32_bf16 v[112:115], a[212:215], a[108:111], v[112:115]
    buffer_store_dwordx2 v[170:171], v11, s[12:15], s34 offen offset:640 sc1
    v_mfma_f32_16x16x32_bf16 v[112:115], a[216:219], a[112:115], v[112:115]
    ds_read_b128 a[236:239], v2 offset:11264
    v_cvt_pk_bf16_f32 v221, v110, v111
    v_mfma_f32_16x16x32_bf16 v[112:115], a[220:223], a[116:119], v[112:115]
    v_mfma_f32_16x16x32_bf16 v[116:119], a[200:203], a[120:123], 0
    ds_read_b128 a[240:243], v2 offset:12288
    v_mfma_f32_16x16x32_bf16 v[116:119], a[204:207], a[124:127], v[116:119]
    v_mfma_f32_16x16x32_bf16 v[116:119], a[208:211], a[128:131], v[116:119]
    ds_read_b128 a[244:247], v2 offset:13312
    v_cvt_pk_bf16_f32 v210, v112, v113
    v_mfma_f32_16x16x32_bf16 v[116:119], a[212:215], a[132:135], v[116:119]
    v_cvt_pk_bf16_f32 v211, v114, v115
    v_mfma_f32_16x16x32_bf16 v[116:119], a[216:219], a[136:139], v[116:119]
    v_mfma_f32_16x16x32_bf16 v[116:119], a[220:223], a[140:143], v[116:119]
    buffer_store_dwordx2 v[172:173], v11, s[12:15], s34 offen offset:1024 sc1
    v_mfma_f32_16x16x32_bf16 v[120:123], a[200:203], a[144:147], 0
    s_waitcnt vmcnt(19)
    ds_write_b64 v4, a[48:49] offset:0
    v_mfma_f32_16x16x32_bf16 v[120:123], a[204:207], a[148:151], v[120:123]
    ds_write_b64 v4, a[50:51] offset:1024
    v_mfma_f32_16x16x32_bf16 v[120:123], a[208:211], a[152:155], v[120:123]
    s_waitcnt vmcnt(18)
    ds_write_b64 v4, a[52:53] offset:512
    v_mfma_f32_16x16x32_bf16 v[120:123], a[212:215], a[156:159], v[120:123]
    ds_write_b64 v4, a[54:55] offset:1536
    v_mfma_f32_16x16x32_bf16 v[120:123], a[216:219], a[160:163], v[120:123]
    ds_read2_b64 a[48:51], v5 offset0:0 offset1:128
    v_cvt_pk_bf16_f32 v214, v116, v117
    v_mfma_f32_16x16x32_bf16 v[120:123], a[220:223], a[164:167], v[120:123]
    ds_read2_b64 a[52:55], v6 offset0:0 offset1:128
    v_cvt_pk_bf16_f32 v215, v118, v119
    v_mfma_f32_16x16x32_bf16 v[124:127], a[200:203], a[168:171], 0
    v_mfma_f32_16x16x32_bf16 v[124:127], a[204:207], a[172:175], v[124:127]
    buffer_store_dwordx2 v[174:175], v11, s[12:15], s34 offen offset:1408 sc1
    v_mfma_f32_16x16x32_bf16 v[124:127], a[208:211], a[176:179], v[124:127]
    v_cvt_pk_bf16_f32 v218, v120, v121
    v_cvt_pk_bf16_f32 v219, v122, v123
    v_mfma_f32_16x16x32_bf16 v[124:127], a[212:215], a[180:183], v[124:127]
    v_mfma_f32_16x16x32_bf16 v[124:127], a[216:219], a[184:187], v[124:127]
    v_mfma_f32_16x16x32_bf16 v[124:127], a[220:223], a[188:191], v[124:127]
    s_waitcnt lgkmcnt(6)
    v_mfma_f32_16x16x32_bf16 v[96:99], a[96:99], a[224:227], 0
    v_mfma_f32_16x16x32_bf16 v[96:99], a[100:103], a[228:231], v[96:99]
    v_mfma_f32_16x16x32_bf16 v[96:99], a[104:107], a[232:235], v[96:99]
    v_cvt_pk_bf16_f32 v222, v124, v125
    v_cvt_pk_bf16_f32 v223, v126, v127
    v_mfma_f32_16x16x32_bf16 v[96:99], a[108:111], a[236:239], v[96:99]
    buffer_store_dwordx2 v[176:177], v11, s[12:15], s36 offen offset:256 sc1
    v_mfma_f32_16x16x32_bf16 v[96:99], a[112:115], a[240:243], v[96:99]
    v_mfma_f32_16x16x32_bf16 v[96:99], a[116:119], a[244:247], v[96:99]
    v_mfma_f32_16x16x32_bf16 v[100:103], a[120:123], a[224:227], 0
    v_mfma_f32_16x16x32_bf16 v[100:103], a[124:127], a[228:231], v[100:103]
    v_mfma_f32_16x16x32_bf16 v[100:103], a[128:131], a[232:235], v[100:103]
    v_cvt_pk_bf16_f32 v128, v96, v97
    v_cvt_pk_bf16_f32 v129, v98, v99
    v_mfma_f32_16x16x32_bf16 v[100:103], a[132:135], a[236:239], v[100:103]
    v_mfma_f32_16x16x32_bf16 v[100:103], a[136:139], a[240:243], v[100:103]
    v_mfma_f32_16x16x32_bf16 v[100:103], a[140:143], a[244:247], v[100:103]
    buffer_store_dwordx2 v[178:179], v11, s[12:15], s36 offen offset:640 sc1
    v_mfma_f32_16x16x32_bf16 v[32:35], a[112:115], v[192:195], v[32:35]
    v_mfma_f32_16x16x32_bf16 v[32:35], a[116:119], v[208:211], v[32:35]
    v_mfma_f32_16x16x32_bf16 v[36:39], a[136:139], v[192:195], v[36:39]
    v_cvt_pk_bf16_f32 v130, v100, v101
    v_cvt_pk_bf16_f32 v131, v102, v103
    v_mfma_f32_16x16x32_bf16 v[36:39], a[140:143], v[208:211], v[36:39]
    v_mfma_f32_16x16x32_bf16 v[40:43], a[160:163], v[192:195], v[40:43]
    v_max3_f32 v12, v32, v33, v34
    v_mfma_f32_16x16x32_bf16 v[40:43], a[164:167], v[208:211], v[40:43]
    v_mfma_f32_16x16x32_bf16 v[44:47], a[184:187], v[192:195], v[44:47]
    v_max3_f32 v12, v12, v35, v36
    v_max3_f32 v12, v12, v37, v38
    v_mfma_f32_16x16x32_bf16 v[44:47], a[188:191], v[208:211], v[44:47]
    buffer_store_dwordx2 v[180:181], v11, s[12:15], s36 offen offset:1024 sc1
    v_mfma_f32_16x16x32_bf16 v[48:51], a[112:115], v[196:199], v[48:51]
    v_max3_f32 v12, v12, v39, v40
    v_max3_f32 v12, v12, v41, v42
    v_mfma_f32_16x16x32_bf16 v[48:51], a[116:119], v[212:215], v[48:51]
    v_mfma_f32_16x16x32_bf16 v[52:55], a[136:139], v[196:199], v[52:55]
    v_max3_f32 v12, v12, v43, v44
    v_max3_f32 v12, v12, v45, v46
    v_mfma_f32_16x16x32_bf16 v[52:55], a[140:143], v[212:215], v[52:55]
    v_max_f32 v12, v12, v47
    v_mfma_f32_16x16x32_bf16 v[56:59], a[160:163], v[196:199], v[56:59]
    v_max3_f32 v13, v48, v49, v50
    v_mfma_f32_16x16x32_bf16 v[56:59], a[164:167], v[212:215], v[56:59]
    v_mfma_f32_16x16x32_bf16 v[60:63], a[184:187], v[196:199], v[60:63]
    s_waitcnt vmcnt(19)
    ds_write_b64 v4, a[56:57] offset:0
    v_mfma_f32_16x16x32_bf16 v[60:63], a[188:191], v[212:215], v[60:63]
    buffer_store_dwordx2 v[182:183], v11, s[12:15], s36 offen offset:1408 sc1
    v_mfma_f32_16x16x32_bf16 v[64:67], a[112:115], v[200:203], v[64:67]
    ds_write_b64 v4, a[58:59] offset:1024
    v_mfma_f32_16x16x32_bf16 v[64:67], a[116:119], v[216:219], v[64:67]
    s_waitcnt vmcnt(19)
    ds_write_b64 v4, a[60:61] offset:512
    v_mfma_f32_16x16x32_bf16 v[68:71], a[136:139], v[200:203], v[68:71]
    ds_read_b128 a[248:251], v2 offset:14336
    v_max3_f32 v13, v13, v51, v52
    v_mfma_f32_16x16x32_bf16 v[68:71], a[140:143], v[216:219], v[68:71]
    ds_write_b64 v4, a[62:63] offset:1536
    v_mfma_f32_16x16x32_bf16 v[72:75], a[160:163], v[200:203], v[72:75]
    ds_read_b128 a[252:255], v2 offset:15360
    v_max3_f32 v14, v64, v65, v66
    v_mfma_f32_16x16x32_bf16 v[72:75], a[164:167], v[216:219], v[72:75]
    ds_read2_b64 a[56:59], v5 offset0:0 offset1:128
    v_max3_f32 v13, v13, v53, v54
    v_mfma_f32_16x16x32_bf16 v[76:79], a[184:187], v[200:203], v[76:79]
    ds_read_b128 a[192:195], v2 offset:16384
    v_max3_f32 v14, v14, v67, v68
    v_mfma_f32_16x16x32_bf16 v[76:79], a[188:191], v[216:219], v[76:79]
    buffer_store_dwordx2 v[184:185], v11, s[12:15], s38 offen offset:256 sc1
    v_mfma_f32_16x16x32_bf16 v[80:83], a[112:115], v[204:207], v[80:83]
    ds_read_b128 a[196:199], v2 offset:17408
    v_max3_f32 v14, v14, v69, v70
    v_mfma_f32_16x16x32_bf16 v[80:83], a[116:119], v[220:223], v[80:83]
    ds_read2_b64 a[60:63], v6 offset0:0 offset1:128
    v_max3_f32 v13, v13, v55, v56
    v_mfma_f32_16x16x32_bf16 v[84:87], a[136:139], v[204:207], v[84:87]
    ds_read_b128 a[200:203], v2 offset:18432
    v_max3_f32 v14, v14, v71, v72
    v_mfma_f32_16x16x32_bf16 v[84:87], a[140:143], v[220:223], v[84:87]
    v_max3_f32 v13, v13, v57, v58
    v_max3_f32 v14, v14, v73, v74
    v_mfma_f32_16x16x32_bf16 v[88:91], a[160:163], v[204:207], v[88:91]
    ds_read_b128 a[204:207], v2 offset:19456
    v_max3_f32 v15, v80, v81, v82
    v_mfma_f32_16x16x32_bf16 v[88:91], a[164:167], v[220:223], v[88:91]
    v_max3_f32 v13, v13, v59, v60
    v_max3_f32 v14, v14, v75, v76
    v_mfma_f32_16x16x32_bf16 v[92:95], a[184:187], v[204:207], v[92:95]
    v_max3_f32 v15, v15, v83, v84
    v_max3_f32 v15, v15, v85, v86
    v_mfma_f32_16x16x32_bf16 v[92:95], a[188:191], v[220:223], v[92:95]
    buffer_store_dwordx2 v[186:187], v11, s[12:15], s38 offen offset:640 sc1
    v_mfma_f32_16x16x32_bf16 v[104:107], a[144:147], a[224:227], 0
    v_max3_f32 v15, v15, v87, v88
    v_max3_f32 v15, v15, v89, v90
    v_mfma_f32_16x16x32_bf16 v[104:107], a[148:151], a[228:231], v[104:107]
    v_max3_f32 v13, v13, v61, v62
    v_max3_f32 v14, v14, v77, v78
    v_mfma_f32_16x16x32_bf16 v[104:107], a[152:155], a[232:235], v[104:107]
    v_max3_f32 v15, v15, v91, v92
    v_max3_f32 v15, v15, v93, v94
    v_mfma_f32_16x16x32_bf16 v[104:107], a[156:159], a[236:239], v[104:107]
    v_max_f32 v13, v13, v63
    v_max_f32 v14, v14, v79
    v_mfma_f32_16x16x32_bf16 v[104:107], a[160:163], a[240:243], v[104:107]
    v_max_f32 v15, v15, v95
    v_permlane16_swap_b32 v12, v13
    v_mfma_f32_16x16x32_bf16 v[104:107], a[164:167], a[244:247], v[104:107]
    v_permlane16_swap_b32 v14, v15
    v_max_f32 v12, v12, v13
    v_mfma_f32_16x16x32_bf16 v[108:111], a[168:171], a[224:227], 0
    v_max_f32 v14, v14, v15
    v_mfma_f32_16x16x32_bf16 v[108:111], a[172:175], a[228:231], v[108:111]
    buffer_store_dwordx2 v[188:189], v11, s[12:15], s38 offen offset:1024 sc1
    v_mfma_f32_16x16x32_bf16 v[108:111], a[176:179], a[232:235], v[108:111]
    v_cvt_pk_bf16_f32 v132, v104, v105
    v_cvt_pk_bf16_f32 v133, v106, v107
    v_mfma_f32_16x16x32_bf16 v[108:111], a[180:183], a[236:239], v[108:111]
    v_permlane32_swap_b32 v12, v14
    v_max_f32 v12, v12, v14
    v_mfma_f32_16x16x32_bf16 v[108:111], a[184:187], a[240:243], v[108:111]
    ds_read_b128 a[208:211], v2 offset:20480
    v_mov_b32 v14, v12
    v_mfma_f32_16x16x32_bf16 v[108:111], a[188:191], a[244:247], v[108:111]
    s_waitcnt lgkmcnt(1)
    v_mfma_f32_16x16x32_bf16 v[112:115], a[96:99], a[248:251], 0
    ds_read_b128 a[212:215], v2 offset:21504
    v_permlane32_swap_b32 v12, v14
    v_mfma_f32_16x16x32_bf16 v[112:115], a[100:103], a[252:255], v[112:115]
    v_mov_b32 v13, v12
    v_mov_b32 v15, v14
    v_mfma_f32_16x16x32_bf16 v[112:115], a[104:107], a[192:195], v[112:115]
    ds_read_b128 a[216:219], v2 offset:22528
    v_cvt_pk_bf16_f32 v134, v108, v109
    v_mfma_f32_16x16x32_bf16 v[112:115], a[108:111], a[196:199], v[112:115]
    v_cvt_pk_bf16_f32 v135, v110, v111
    v_permlane16_swap_b32 v12, v13
    v_mfma_f32_16x16x32_bf16 v[112:115], a[112:115], a[200:203], v[112:115]
    buffer_load_dwordx4 a[64:67], v9, s[8:11], s28 offen offset:256 nt
    v_permlane16_swap_b32 v14, v15
    v_mfma_f32_16x16x32_bf16 v[112:115], a[116:119], a[204:207], v[112:115]
    buffer_load_dwordx4 a[68:71], v10, s[8:11], s28 offen offset:256 nt
    v_sub_f32 v32, v32, v12
    v_mfma_f32_16x16x32_bf16 v[116:119], a[120:123], a[248:251], 0
    ds_read_b128 a[220:223], v2 offset:23552
    v_sub_f32 v33, v33, v12
    v_mfma_f32_16x16x32_bf16 v[116:119], a[124:127], a[252:255], v[116:119]
    ds_read_b128 a[224:227], v2 offset:24576
    v_sub_f32 v48, v48, v13
    v_mfma_f32_16x16x32_bf16 v[116:119], a[128:131], a[192:195], v[116:119]
    ds_read_b128 a[228:231], v2 offset:25600
    v_cvt_pk_bf16_f32 v136, v112, v113
    v_mfma_f32_16x16x32_bf16 v[116:119], a[132:135], a[196:199], v[116:119]
    v_cvt_pk_bf16_f32 v137, v114, v115
    v_sub_f32 v49, v49, v13
    v_mfma_f32_16x16x32_bf16 v[116:119], a[136:139], a[200:203], v[116:119]
    v_sub_f32 v64, v64, v14
    v_sub_f32 v65, v65, v14
    v_mfma_f32_16x16x32_bf16 v[116:119], a[140:143], a[204:207], v[116:119]
    v_sub_f32 v80, v80, v15
    v_sub_f32 v81, v81, v15
    v_mfma_f32_16x16x32_bf16 v[120:123], a[144:147], a[248:251], 0
    v_exp_f32 v32, v32
    v_mfma_f32_16x16x32_bf16 v[120:123], a[148:151], a[252:255], v[120:123]
    v_exp_f32 v33, v33
    v_mfma_f32_16x16x32_bf16 v[120:123], a[152:155], a[192:195], v[120:123]
    buffer_store_dwordx2 v[190:191], v11, s[12:15], s38 offen offset:1408 sc1
    v_mfma_f32_16x16x32_bf16 v[120:123], a[156:159], a[196:199], v[120:123]
    v_cvt_pk_bf16_f32 v138, v116, v117
    v_cvt_pk_bf16_f32 v139, v118, v119
    v_mfma_f32_16x16x32_bf16 v[120:123], a[160:163], a[200:203], v[120:123]
    v_sub_f32 v34, v34, v12
    v_sub_f32 v50, v50, v13
    v_mfma_f32_16x16x32_bf16 v[120:123], a[164:167], a[204:207], v[120:123]
    v_exp_f32 v48, v48
    v_mfma_f32_16x16x32_bf16 v[124:127], a[168:171], a[248:251], 0
    v_exp_f32 v49, v49
    v_mfma_f32_16x16x32_bf16 v[124:127], a[172:175], a[252:255], v[124:127]
    v_exp_f32 v64, v64
    v_mfma_f32_16x16x32_bf16 v[124:127], a[176:179], a[192:195], v[124:127]
    v_cvt_pk_bf16_f32 v140, v120, v121
    v_cvt_pk_bf16_f32 v141, v122, v123
    v_mfma_f32_16x16x32_bf16 v[124:127], a[180:183], a[196:199], v[124:127]
    v_exp_f32 v65, v65
    v_mfma_f32_16x16x32_bf16 v[124:127], a[184:187], a[200:203], v[124:127]
    ds_read_b128 a[232:235], v2 offset:26624
    v_sub_f32 v66, v66, v14
    v_mfma_f32_16x16x32_bf16 v[124:127], a[188:191], a[204:207], v[124:127]
    v_sub_f32 v82, v82, v15
    s_waitcnt lgkmcnt(1)
    v_mfma_f32_16x16x32_bf16 v[96:99], a[96:99], a[208:211], 0
    ds_read_b128 a[236:239], v2 offset:27648
    v_sub_f32 v35, v35, v12
    v_mfma_f32_16x16x32_bf16 v[96:99], a[100:103], a[212:215], v[96:99]
    v_exp_f32 v80, v80
    v_mfma_f32_16x16x32_bf16 v[96:99], a[104:107], a[216:219], v[96:99]
    ds_read_b128 a[240:243], v2 offset:28672
    v_cvt_pk_bf16_f32 v142, v124, v125
    v_mfma_f32_16x16x32_bf16 v[96:99], a[108:111], a[220:223], v[96:99]
    v_cvt_pk_bf16_f32 v143, v126, v127
    v_sub_f32 v51, v51, v13
    v_mfma_f32_16x16x32_bf16 v[96:99], a[112:115], a[224:227], v[96:99]
    ds_read_b128 a[244:247], v2 offset:29696
    v_sub_f32 v67, v67, v14
    v_mfma_f32_16x16x32_bf16 v[96:99], a[116:119], a[228:231], v[96:99]
    v_exp_f32 v81, v81
    v_mfma_f32_16x16x32_bf16 v[100:103], a[120:123], a[208:211], 0
    ds_read_b128 a[248:251], v2 offset:30720
    v_sub_f32 v83, v83, v15
    v_mfma_f32_16x16x32_bf16 v[100:103], a[124:127], a[212:215], v[100:103]
    v_exp_f32 v34, v34
    v_mfma_f32_16x16x32_bf16 v[100:103], a[128:131], a[216:219], v[100:103]
    ds_read_b128 a[252:255], v2 offset:31744
    v_cvt_pk_bf16_f32 v144, v96, v97
    v_mfma_f32_16x16x32_bf16 v[100:103], a[132:135], a[220:223], v[100:103]
    v_cvt_pk_bf16_f32 v145, v98, v99
    v_sub_f32 v36, v36, v12
    v_mfma_f32_16x16x32_bf16 v[100:103], a[136:139], a[224:227], v[100:103]
    v_exp_f32 v50, v50
    v_mfma_f32_16x16x32_bf16 v[100:103], a[140:143], a[228:231], v[100:103]
    v_exp_f32 v66, v66
    v_mfma_f32_16x16x32_bf16 v[104:107], a[144:147], a[208:211], 0
    v_exp_f32 v82, v82
    v_mfma_f32_16x16x32_bf16 v[104:107], a[148:151], a[212:215], v[104:107]
    v_exp_f32 v35, v35
    v_mfma_f32_16x16x32_bf16 v[104:107], a[152:155], a[216:219], v[104:107]
    v_cvt_pk_bf16_f32 v146, v100, v101
    v_cvt_pk_bf16_f32 v147, v102, v103
    v_mfma_f32_16x16x32_bf16 v[104:107], a[156:159], a[220:223], v[104:107]
    v_exp_f32 v51, v51
    v_mfma_f32_16x16x32_bf16 v[104:107], a[160:163], a[224:227], v[104:107]
    v_sub_f32 v52, v52, v13
    v_sub_f32 v68, v68, v14
    v_mfma_f32_16x16x32_bf16 v[104:107], a[164:167], a[228:231], v[104:107]
    v_exp_f32 v67, v67
    v_mfma_f32_16x16x32_bf16 v[108:111], a[168:171], a[208:211], 0
    v_exp_f32 v83, v83
    v_mfma_f32_16x16x32_bf16 v[108:111], a[172:175], a[212:215], v[108:111]
    v_sub_f32 v84, v84, v15
    v_add_f32 v20, v32, v33
    v_mfma_f32_16x16x32_bf16 v[108:111], a[176:179], a[216:219], v[108:111]
    buffer_store_dwordx2 v[224:225], v11, s[12:15], s32 offen offset:0 sc1
    v_mfma_f32_16x16x32_bf16 v[108:111], a[180:183], a[220:223], v[108:111]
    v_cvt_pk_bf16_f32 v148, v104, v105
    v_cvt_pk_bf16_f32 v149, v106, v107
    v_mfma_f32_16x16x32_bf16 v[108:111], a[184:187], a[224:227], v[108:111]
    ds_read_b128 a[192:195], v2 offset:32768
    v_sub_f32 v37, v37, v12
    v_mfma_f32_16x16x32_bf16 v[108:111], a[188:191], a[228:231], v[108:111]
    v_add_f32 v21, v48, v49
    s_waitcnt lgkmcnt(1)
    v_mfma_f32_16x16x32_bf16 v[112:115], a[96:99], a[232:235], 0
    ds_read_b128 a[196:199], v2 offset:33792
    v_sub_f32 v53, v53, v13
    v_mfma_f32_16x16x32_bf16 v[112:115], a[100:103], a[236:239], v[112:115]
    buffer_load_dwordx4 a[72:75], v9, s[8:11], s30 offen offset:0 nt
    v_add_f32 v22, v64, v65
    v_mfma_f32_16x16x32_bf16 v[112:115], a[104:107], a[240:243], v[112:115]
    buffer_load_dwordx4 a[76:79], v10, s[8:11], s30 offen offset:0 nt
    v_cvt_pk_bf16_f32 v150, v108, v109
    v_mfma_f32_16x16x32_bf16 v[112:115], a[108:111], a[244:247], v[112:115]
    ds_read_b128 a[200:203], v2 offset:34816
    v_cvt_pk_bf16_f32 v151, v110, v111
    v_mfma_f32_16x16x32_bf16 v[112:115], a[112:115], a[248:251], v[112:115]
    ds_read_b128 a[204:207], v2 offset:35840
    v_sub_f32 v69, v69, v14
    v_mfma_f32_16x16x32_bf16 v[112:115], a[116:119], a[252:255], v[112:115]
    v_exp_f32 v36, v36
    v_mfma_f32_16x16x32_bf16 v[116:119], a[120:123], a[232:235], 0
    ds_read_b128 a[208:211], v2 offset:36864
    v_add_f32 v23, v80, v81
    v_mfma_f32_16x16x32_bf16 v[116:119], a[124:127], a[236:239], v[116:119]
    v_exp_f32 v52, v52
    v_mfma_f32_16x16x32_bf16 v[116:119], a[128:131], a[240:243], v[116:119]
    ds_read_b128 a[212:215], v2 offset:37888
    v_cvt_pk_bf16_f32 v152, v112, v113
    v_mfma_f32_16x16x32_bf16 v[116:119], a[132:135], a[244:247], v[116:119]
    v_cvt_pk_bf16_f32 v153, v114, v115
    v_sub_f32 v85, v85, v15
    v_mfma_f32_16x16x32_bf16 v[116:119], a[136:139], a[248:251], v[116:119]
    v_exp_f32 v68, v68
    v_mfma_f32_16x16x32_bf16 v[116:119], a[140:143], a[252:255], v[116:119]
    v_exp_f32 v84, v84
    v_mfma_f32_16x16x32_bf16 v[120:123], a[144:147], a[232:235], 0
    v_add_f32 v20, v20, v34
    v_sub_f32 v38, v38, v12
    v_mfma_f32_16x16x32_bf16 v[120:123], a[148:151], a[236:239], v[120:123]
    v_exp_f32 v37, v37
    v_mfma_f32_16x16x32_bf16 v[120:123], a[152:155], a[240:243], v[120:123]
    v_cvt_pk_bf16_f32 v154, v116, v117
    v_cvt_pk_bf16_f32 v155, v118, v119
    v_mfma_f32_16x16x32_bf16 v[120:123], a[156:159], a[244:247], v[120:123]
    v_add_f32 v21, v21, v50
    v_sub_f32 v54, v54, v13
    v_mfma_f32_16x16x32_bf16 v[120:123], a[160:163], a[248:251], v[120:123]
    v_exp_f32 v53, v53
    v_mfma_f32_16x16x32_bf16 v[120:123], a[164:167], a[252:255], v[120:123]
    v_add_f32 v22, v22, v66
    v_sub_f32 v70, v70, v14
    v_mfma_f32_16x16x32_bf16 v[124:127], a[168:171], a[232:235], 0
    v_exp_f32 v69, v69
    v_mfma_f32_16x16x32_bf16 v[124:127], a[172:175], a[236:239], v[124:127]
    v_add_f32 v23, v23, v82
    v_sub_f32 v86, v86, v15
    v_mfma_f32_16x16x32_bf16 v[124:127], a[176:179], a[240:243], v[124:127]
    v_cvt_pk_bf16_f32 v156, v120, v121
    v_cvt_pk_bf16_f32 v157, v122, v123
    v_mfma_f32_16x16x32_bf16 v[124:127], a[180:183], a[244:247], v[124:127]
    v_exp_f32 v85, v85
    v_mfma_f32_16x16x32_bf16 v[124:127], a[184:187], a[248:251], v[124:127]
    ds_read_b128 a[216:219], v2 offset:38912
    v_add_f32 v20, v20, v35
    v_mfma_f32_16x16x32_bf16 v[124:127], a[188:191], a[252:255], v[124:127]
    v_sub_f32 v39, v39, v12
    s_waitcnt lgkmcnt(1)
    v_mfma_f32_16x16x32_bf16 v[96:99], a[96:99], a[192:195], 0
    ds_read_b128 a[220:223], v2 offset:39936
    v_add_f32 v21, v21, v51
    v_mfma_f32_16x16x32_bf16 v[96:99], a[100:103], a[196:199], v[96:99]
    v_exp_f32 v38, v38
    v_mfma_f32_16x16x32_bf16 v[96:99], a[104:107], a[200:203], v[96:99]
    buffer_store_dwordx2 v[226:227], v11, s[12:15], s32 offen offset:384 sc1
    v_mfma_f32_16x16x32_bf16 v[96:99], a[108:111], a[204:207], v[96:99]
    ds_read_b128 a[224:227], v2 offset:40960
    v_cvt_pk_bf16_f32 v158, v124, v125
    v_mfma_f32_16x16x32_bf16 v[96:99], a[112:115], a[208:211], v[96:99]
    ds_read_b128 a[228:231], v2 offset:41984
    v_cvt_pk_bf16_f32 v159, v126, v127
    v_mfma_f32_16x16x32_bf16 v[96:99], a[116:119], a[212:215], v[96:99]
    v_exp_f32 v54, v54
    v_mfma_f32_16x16x32_bf16 v[100:103], a[120:123], a[192:195], 0
    ds_read_b128 a[232:235], v2 offset:43008
    v_sub_f32 v55, v55, v13
    v_mfma_f32_16x16x32_bf16 v[100:103], a[124:127], a[196:199], v[100:103]
    v_add_f32 v22, v22, v67
    v_sub_f32 v71, v71, v14
    v_mfma_f32_16x16x32_bf16 v[100:103], a[128:131], a[200:203], v[100:103]
    ds_read_b128 a[236:239], v2 offset:44032
    v_cvt_pk_bf16_f32 v160, v96, v97
    v_mfma_f32_16x16x32_bf16 v[100:103], a[132:135], a[204:207], v[100:103]
    v_cvt_pk_bf16_f32 v161, v98, v99
    v_add_f32 v23, v23, v83
    v_mfma_f32_16x16x32_bf16 v[100:103], a[136:139], a[208:211], v[100:103]
    v_exp_f32 v70, v70
    v_mfma_f32_16x16x32_bf16 v[100:103], a[140:143], a[212:215], v[100:103]
    v_exp_f32 v86, v86
    v_mfma_f32_16x16x32_bf16 v[104:107], a[144:147], a[192:195], 0
    v_sub_f32 v87, v87, v15
    v_add_f32 v20, v20, v36
    v_mfma_f32_16x16x32_bf16 v[104:107], a[148:151], a[196:199], v[104:107]
    v_exp_f32 v39, v39
    v_mfma_f32_16x16x32_bf16 v[104:107], a[152:155], a[200:203], v[104:107]
    v_cvt_pk_bf16_f32 v162, v100, v101
    v_cvt_pk_bf16_f32 v163, v102, v103
    v_mfma_f32_16x16x32_bf16 v[104:107], a[156:159], a[204:207], v[104:107]
    v_sub_f32 v40, v40, v12
    v_add_f32 v21, v21, v52
    v_mfma_f32_16x16x32_bf16 v[104:107], a[160:163], a[208:211], v[104:107]
    v_exp_f32 v55, v55
    v_mfma_f32_16x16x32_bf16 v[104:107], a[164:167], a[212:215], v[104:107]
    v_sub_f32 v56, v56, v13
    v_add_f32 v22, v22, v68
    v_mfma_f32_16x16x32_bf16 v[108:111], a[168:171], a[192:195], 0
    v_exp_f32 v71, v71
    v_mfma_f32_16x16x32_bf16 v[108:111], a[172:175], a[196:199], v[108:111]
    v_sub_f32 v72, v72, v14
    v_add_f32 v23, v23, v84
    v_mfma_f32_16x16x32_bf16 v[108:111], a[176:179], a[200:203], v[108:111]
    v_cvt_pk_bf16_f32 v164, v104, v105
    v_cvt_pk_bf16_f32 v165, v106, v107
    v_mfma_f32_16x16x32_bf16 v[108:111], a[180:183], a[204:207], v[108:111]
    v_exp_f32 v87, v87
    v_mfma_f32_16x16x32_bf16 v[108:111], a[184:187], a[208:211], v[108:111]
    buffer_load_dwordx4 a[80:83], v9, s[8:11], s30 offen offset:128 nt
    v_sub_f32 v88, v88, v15
    v_mfma_f32_16x16x32_bf16 v[108:111], a[188:191], a[212:215], v[108:111]
    buffer_load_dwordx4 a[84:87], v10, s[8:11], s30 offen offset:128 nt
    s_waitcnt lgkmcnt(0)
    v_mfma_f32_16x16x32_bf16 v[112:115], a[96:99], a[216:219], 0
    ds_read_b128 a[240:243], v2 offset:45056
    v_add_f32 v20, v20, v37
    v_mfma_f32_16x16x32_bf16 v[112:115], a[100:103], a[220:223], v[112:115]
    ds_read_b128 a[244:247], v2 offset:46080
    v_sub_f32 v41, v41, v12
    v_mfma_f32_16x16x32_bf16 v[112:115], a[104:107], a[224:227], v[112:115]
    ds_read_b128 a[248:251], v2 offset:47104
    v_cvt_pk_bf16_f32 v166, v108, v109
    v_mfma_f32_16x16x32_bf16 v[112:115], a[108:111], a[228:231], v[112:115]
    v_cvt_pk_bf16_f32 v167, v110, v111
    v_add_f32 v21, v21, v53
    v_mfma_f32_16x16x32_bf16 v[112:115], a[112:115], a[232:235], v[112:115]
    ds_read_b128 a[252:255], v2 offset:48128
    v_sub_f32 v57, v57, v13
    v_mfma_f32_16x16x32_bf16 v[112:115], a[116:119], a[236:239], v[112:115]
    v_exp_f32 v40, v40
    v_mfma_f32_16x16x32_bf16 v[116:119], a[120:123], a[216:219], 0
    ds_read_b128 a[192:195], v2 offset:49152
    v_add_f32 v22, v22, v69
    v_mfma_f32_16x16x32_bf16 v[116:119], a[124:127], a[220:223], v[116:119]
    v_exp_f32 v56, v56
    v_mfma_f32_16x16x32_bf16 v[116:119], a[128:131], a[224:227], v[116:119]
    buffer_store_dwordx2 v[228:229], v11, s[12:15], s32 offen offset:768 sc1
    v_mfma_f32_16x16x32_bf16 v[116:119], a[132:135], a[228:231], v[116:119]
    ds_read_b128 a[196:199], v2 offset:50176
    v_cvt_pk_bf16_f32 v168, v112, v113
    v_mfma_f32_16x16x32_bf16 v[116:119], a[136:139], a[232:235], v[116:119]
    v_cvt_pk_bf16_f32 v169, v114, v115
    v_sub_f32 v73, v73, v14
    v_mfma_f32_16x16x32_bf16 v[116:119], a[140:143], a[236:239], v[116:119]
    v_exp_f32 v72, v72
    v_mfma_f32_16x16x32_bf16 v[120:123], a[144:147], a[216:219], 0
    v_add_f32 v23, v23, v85
    v_sub_f32 v89, v89, v15
    v_mfma_f32_16x16x32_bf16 v[120:123], a[148:151], a[220:223], v[120:123]
    v_exp_f32 v88, v88
    v_mfma_f32_16x16x32_bf16 v[120:123], a[152:155], a[224:227], v[120:123]
    v_cvt_pk_bf16_f32 v170, v116, v117
    v_cvt_pk_bf16_f32 v171, v118, v119
    v_mfma_f32_16x16x32_bf16 v[120:123], a[156:159], a[228:231], v[120:123]
    v_add_f32 v20, v20, v38
    v_sub_f32 v42, v42, v12
    v_mfma_f32_16x16x32_bf16 v[120:123], a[160:163], a[232:235], v[120:123]
    v_exp_f32 v41, v41
    v_mfma_f32_16x16x32_bf16 v[120:123], a[164:167], a[236:239], v[120:123]
    v_add_f32 v21, v21, v54
    v_sub_f32 v58, v58, v13
    v_mfma_f32_16x16x32_bf16 v[124:127], a[168:171], a[216:219], 0
    v_exp_f32 v57, v57
    v_mfma_f32_16x16x32_bf16 v[124:127], a[172:175], a[220:223], v[124:127]
    v_add_f32 v22, v22, v70
    v_sub_f32 v74, v74, v14
    v_mfma_f32_16x16x32_bf16 v[124:127], a[176:179], a[224:227], v[124:127]
    v_cvt_pk_bf16_f32 v172, v120, v121
    v_cvt_pk_bf16_f32 v173, v122, v123
    v_mfma_f32_16x16x32_bf16 v[124:127], a[180:183], a[228:231], v[124:127]
    v_exp_f32 v73, v73
    v_mfma_f32_16x16x32_bf16 v[124:127], a[184:187], a[232:235], v[124:127]
    ds_read_b128 a[200:203], v2 offset:51200
    v_add_f32 v23, v23, v86
    v_mfma_f32_16x16x32_bf16 v[124:127], a[188:191], a[236:239], v[124:127]
    v_sub_f32 v90, v90, v15
    s_waitcnt lgkmcnt(1)
    v_mfma_f32_16x16x32_bf16 v[96:99], a[96:99], a[240:243], 0
    ds_read_b128 a[204:207], v2 offset:52224
    v_add_f32 v20, v20, v39
    v_mfma_f32_16x16x32_bf16 v[96:99], a[100:103], a[244:247], v[96:99]
    v_exp_f32 v89, v89
    v_mfma_f32_16x16x32_bf16 v[96:99], a[104:107], a[248:251], v[96:99]
    ds_read_b128 a[208:211], v2 offset:53248
    v_cvt_pk_bf16_f32 v174, v124, v125
    v_mfma_f32_16x16x32_bf16 v[96:99], a[108:111], a[252:255], v[96:99]
    v_cvt_pk_bf16_f32 v175, v126, v127
    v_sub_f32 v43, v43, v12
    v_mfma_f32_16x16x32_bf16 v[96:99], a[112:115], a[192:195], v[96:99]
    ds_read_b128 a[212:215], v2 offset:54272
    v_add_f32 v21, v21, v55
    v_mfma_f32_16x16x32_bf16 v[96:99], a[116:119], a[196:199], v[96:99]
    v_exp_f32 v42, v42
    v_mfma_f32_16x16x32_bf16 v[100:103], a[120:123], a[240:243], 0
    ds_read_b128 a[216:219], v2 offset:55296
    v_sub_f32 v59, v59, v13
    v_mfma_f32_16x16x32_bf16 v[100:103], a[124:127], a[244:247], v[100:103]
    v_exp_f32 v58, v58
    v_mfma_f32_16x16x32_bf16 v[100:103], a[128:131], a[248:251], v[100:103]
    ds_read_b128 a[220:223], v2 offset:56320
    v_cvt_pk_bf16_f32 v176, v96, v97
    v_mfma_f32_16x16x32_bf16 v[100:103], a[132:135], a[252:255], v[100:103]
    v_cvt_pk_bf16_f32 v177, v98, v99
    v_add_f32 v22, v22, v71
    v_mfma_f32_16x16x32_bf16 v[100:103], a[136:139], a[192:195], v[100:103]
    v_exp_f32 v74, v74
    v_mfma_f32_16x16x32_bf16 v[100:103], a[140:143], a[196:199], v[100:103]
    v_sub_f32 v75, v75, v14
    v_add_f32 v23, v23, v87
    v_mfma_f32_16x16x32_bf16 v[104:107], a[144:147], a[240:243], 0
    v_exp_f32 v90, v90
    v_mfma_f32_16x16x32_bf16 v[104:107], a[148:151], a[244:247], v[104:107]
    v_sub_f32 v91, v91, v15
    v_add_f32 v20, v20, v40
    v_mfma_f32_16x16x32_bf16 v[104:107], a[152:155], a[248:251], v[104:107]
    buffer_store_dwordx2 v[230:231], v11, s[12:15], s32 offen offset:1152 sc1
    v_mfma_f32_16x16x32_bf16 v[104:107], a[156:159], a[252:255], v[104:107]
    v_cvt_pk_bf16_f32 v178, v100, v101
    v_cvt_pk_bf16_f32 v179, v102, v103
    v_mfma_f32_16x16x32_bf16 v[104:107], a[160:163], a[192:195], v[104:107]
    v_exp_f32 v43, v43
    v_mfma_f32_16x16x32_bf16 v[104:107], a[164:167], a[196:199], v[104:107]
    v_sub_f32 v44, v44, v12
    v_add_f32 v21, v21, v56
    v_mfma_f32_16x16x32_bf16 v[108:111], a[168:171], a[240:243], 0
    v_exp_f32 v59, v59
    v_mfma_f32_16x16x32_bf16 v[108:111], a[172:175], a[244:247], v[108:111]
    buffer_load_dwordx4 a[88:91], v9, s[8:11], s30 offen offset:256 nt
    v_sub_f32 v60, v60, v13
    v_mfma_f32_16x16x32_bf16 v[108:111], a[176:179], a[248:251], v[108:111]
    buffer_load_dwordx4 a[92:95], v10, s[8:11], s30 offen offset:256 nt
    v_cvt_pk_bf16_f32 v180, v104, v105
    v_mfma_f32_16x16x32_bf16 v[108:111], a[180:183], a[252:255], v[108:111]
    v_cvt_pk_bf16_f32 v181, v106, v107
    v_add_f32 v22, v22, v72
    v_mfma_f32_16x16x32_bf16 v[108:111], a[184:187], a[192:195], v[108:111]
    ds_read_b128 a[224:227], v2 offset:57344
    v_sub_f32 v76, v76, v14
    v_mfma_f32_16x16x32_bf16 v[108:111], a[188:191], a[196:199], v[108:111]
    v_add_f32 v23, v23, v88
    s_waitcnt lgkmcnt(1)
    v_mfma_f32_16x16x32_bf16 v[112:115], a[96:99], a[200:203], 0
    ds_read_b128 a[228:231], v2 offset:58368
    v_sub_f32 v92, v92, v15
    v_mfma_f32_16x16x32_bf16 v[112:115], a[100:103], a[204:207], v[112:115]
    v_exp_f32 v75, v75
    v_mfma_f32_16x16x32_bf16 v[112:115], a[104:107], a[208:211], v[112:115]
    ds_read_b128 a[232:235], v2 offset:59392
    v_cvt_pk_bf16_f32 v182, v108, v109
    v_mfma_f32_16x16x32_bf16 v[112:115], a[108:111], a[212:215], v[112:115]
    v_cvt_pk_bf16_f32 v183, v110, v111
    v_add_f32 v20, v20, v41
    v_mfma_f32_16x16x32_bf16 v[112:115], a[112:115], a[216:219], v[112:115]
    ds_read_b128 a[236:239], v2 offset:60416
    v_sub_f32 v45, v45, v12
    v_mfma_f32_16x16x32_bf16 v[112:115], a[116:119], a[220:223], v[112:115]
    v_exp_f32 v91, v91
    v_mfma_f32_16x16x32_bf16 v[116:119], a[120:123], a[200:203], 0
    ds_read_b128 a[240:243], v2 offset:61440
    v_add_f32 v21, v21, v57
    v_mfma_f32_16x16x32_bf16 v[116:119], a[124:127], a[204:207], v[116:119]
    v_exp_f32 v44, v44
    v_mfma_f32_16x16x32_bf16 v[116:119], a[128:131], a[208:211], v[116:119]
    ds_read_b128 a[244:247], v2 offset:62464
    v_cvt_pk_bf16_f32 v184, v112, v113
    v_mfma_f32_16x16x32_bf16 v[116:119], a[132:135], a[212:215], v[116:119]
    v_cvt_pk_bf16_f32 v185, v114, v115
    v_sub_f32 v61, v61, v13
    v_mfma_f32_16x16x32_bf16 v[116:119], a[136:139], a[216:219], v[116:119]
    v_exp_f32 v60, v60
    v_mfma_f32_16x16x32_bf16 v[116:119], a[140:143], a[220:223], v[116:119]
    v_add_f32 v22, v22, v73
    v_sub_f32 v77, v77, v14
    v_mfma_f32_16x16x32_bf16 v[120:123], a[144:147], a[200:203], 0
    v_exp_f32 v76, v76
    v_mfma_f32_16x16x32_bf16 v[120:123], a[148:151], a[204:207], v[120:123]
    v_add_f32 v23, v23, v89
    v_sub_f32 v93, v93, v15
    v_mfma_f32_16x16x32_bf16 v[120:123], a[152:155], a[208:211], v[120:123]
    v_cvt_pk_bf16_f32 v186, v116, v117
    v_cvt_pk_bf16_f32 v187, v118, v119
    v_mfma_f32_16x16x32_bf16 v[120:123], a[156:159], a[212:215], v[120:123]
    buffer_store_dwordx2 v[232:233], v11, s[12:15], s34 offen offset:0 sc1
    v_mfma_f32_16x16x32_bf16 v[120:123], a[160:163], a[216:219], v[120:123]
    v_exp_f32 v92, v92
    v_mfma_f32_16x16x32_bf16 v[120:123], a[164:167], a[220:223], v[120:123]
    v_add_f32 v20, v20, v42
    v_sub_f32 v46, v46, v12
    v_mfma_f32_16x16x32_bf16 v[124:127], a[168:171], a[200:203], 0
    v_exp_f32 v45, v45
    v_mfma_f32_16x16x32_bf16 v[124:127], a[172:175], a[204:207], v[124:127]
    v_add_f32 v21, v21, v58
    v_sub_f32 v62, v62, v13
    v_mfma_f32_16x16x32_bf16 v[124:127], a[176:179], a[208:211], v[124:127]
    v_cvt_pk_bf16_f32 v188, v120, v121
    v_cvt_pk_bf16_f32 v189, v122, v123
    v_mfma_f32_16x16x32_bf16 v[124:127], a[180:183], a[212:215], v[124:127]
    v_exp_f32 v61, v61
    v_mfma_f32_16x16x32_bf16 v[124:127], a[184:187], a[216:219], v[124:127]
    ds_read_b128 a[248:251], v2 offset:63488
    v_add_f32 v22, v22, v74
    v_mfma_f32_16x16x32_bf16 v[124:127], a[188:191], a[220:223], v[124:127]
    v_sub_f32 v78, v78, v14
    s_waitcnt lgkmcnt(1)
    v_mfma_f32_16x16x32_bf16 v[96:99], a[96:99], a[224:227], 0
    buffer_store_dwordx2 v[234:235], v11, s[12:15], s34 offen offset:384 sc1
    v_mfma_f32_16x16x32_bf16 v[96:99], a[100:103], a[228:231], v[96:99]
    ds_read_b128 a[252:255], v2 offset:64512
    v_add_f32 v23, v23, v90
    v_mfma_f32_16x16x32_bf16 v[96:99], a[104:107], a[232:235], v[96:99]
    ds_read_b128 a[192:195], v3 offset:0
    v_cvt_pk_bf16_f32 v190, v124, v125
    v_mfma_f32_16x16x32_bf16 v[96:99], a[108:111], a[236:239], v[96:99]
    v_cvt_pk_bf16_f32 v191, v126, v127
    v_sub_f32 v94, v94, v15
    v_mfma_f32_16x16x32_bf16 v[96:99], a[112:115], a[240:243], v[96:99]
    ds_read_b128 a[196:199], v3 offset:1024
    v_add_f32 v20, v20, v43
    v_mfma_f32_16x16x32_bf16 v[96:99], a[116:119], a[244:247], v[96:99]
    v_exp_f32 v77, v77
    v_mfma_f32_16x16x32_bf16 v[100:103], a[120:123], a[224:227], 0
    ds_read_b128 a[200:203], v3 offset:2048
    v_sub_f32 v47, v47, v12
    v_mfma_f32_16x16x32_bf16 v[100:103], a[124:127], a[228:231], v[100:103]
    v_exp_f32 v93, v93
    v_mfma_f32_16x16x32_bf16 v[100:103], a[128:131], a[232:235], v[100:103]
    ds_read_b128 a[204:207], v3 offset:3072
    v_cvt_pk_bf16_f32 v192, v96, v97
    v_mfma_f32_16x16x32_bf16 v[100:103], a[132:135], a[236:239], v[100:103]
    buffer_store_dwordx2 v[236:237], v11, s[12:15], s34 offen offset:768 sc1
    v_mfma_f32_16x16x32_bf16 v[100:103], a[136:139], a[240:243], v[100:103]
    v_cvt_pk_bf16_f32 v193, v98, v99
    v_add_f32 v21, v21, v59
    v_mfma_f32_16x16x32_bf16 v[100:103], a[140:143], a[244:247], v[100:103]
    v_exp_f32 v46, v46
    v_mfma_f32_16x16x32_bf16 v[104:107], a[144:147], a[224:227], 0
    v_exp_f32 v62, v62
    v_mfma_f32_16x16x32_bf16 v[104:107], a[148:151], a[228:231], v[104:107]
    v_sub_f32 v63, v63, v13
    v_add_f32 v22, v22, v75
    v_mfma_f32_16x16x32_bf16 v[104:107], a[152:155], a[232:235], v[104:107]
    v_cvt_pk_bf16_f32 v194, v100, v101
    v_cvt_pk_bf16_f32 v195, v102, v103
    v_mfma_f32_16x16x32_bf16 v[104:107], a[156:159], a[236:239], v[104:107]
    v_exp_f32 v78, v78
    v_mfma_f32_16x16x32_bf16 v[104:107], a[160:163], a[240:243], v[104:107]
    v_sub_f32 v79, v79, v14
    v_add_f32 v23, v23, v91
    v_mfma_f32_16x16x32_bf16 v[104:107], a[164:167], a[244:247], v[104:107]
    v_exp_f32 v94, v94
    v_mfma_f32_16x16x32_bf16 v[108:111], a[168:171], a[224:227], 0
    buffer_store_dwordx2 v[238:239], v11, s[12:15], s34 offen offset:1152 sc1
    v_mfma_f32_16x16x32_bf16 v[108:111], a[172:175], a[228:231], v[108:111]
    v_sub_f32 v95, v95, v15
    v_add_f32 v20, v20, v44
    v_mfma_f32_16x16x32_bf16 v[108:111], a[176:179], a[232:235], v[108:111]
    v_cvt_pk_bf16_f32 v196, v104, v105
    v_cvt_pk_bf16_f32 v197, v106, v107
    v_mfma_f32_16x16x32_bf16 v[108:111], a[180:183], a[236:239], v[108:111]
    v_exp_f32 v47, v47
    v_mfma_f32_16x16x32_bf16 v[108:111], a[184:187], a[240:243], v[108:111]
    ds_read_b128 a[208:211], v3 offset:4096
    v_add_f32 v21, v21, v60
    v_mfma_f32_16x16x32_bf16 v[108:111], a[188:191], a[244:247], v[108:111]
    v_add_f32 v22, v22, v76
    s_waitcnt lgkmcnt(1)
    v_mfma_f32_16x16x32_bf16 v[112:115], a[96:99], a[248:251], 0
    ds_read_b128 a[212:215], v3 offset:5120
    v_add_f32 v23, v23, v92
    v_mfma_f32_16x16x32_bf16 v[112:115], a[100:103], a[252:255], v[112:115]
    v_exp_f32 v63, v63
    v_mfma_f32_16x16x32_bf16 v[112:115], a[104:107], a[192:195], v[112:115]
    ds_read_b128 a[216:219], v3 offset:6144
    v_cvt_pk_bf16_f32 v198, v108, v109
    v_mfma_f32_16x16x32_bf16 v[112:115], a[108:111], a[196:199], v[112:115]
    buffer_store_dwordx2 v[240:241], v11, s[12:15], s36 offen offset:0 sc1
    v_mfma_f32_16x16x32_bf16 v[112:115], a[112:115], a[200:203], v[112:115]
    ds_read_b128 a[220:223], v3 offset:7168
    v_cvt_pk_bf16_f32 v199, v110, v111
    v_mfma_f32_16x16x32_bf16 v[112:115], a[116:119], a[204:207], v[112:115]
    v_exp_f32 v79, v79
    v_mfma_f32_16x16x32_bf16 v[116:119], a[120:123], a[248:251], 0
    ds_read_b128 a[224:227], v3 offset:8192
    v_add_f32 v20, v20, v45
    v_mfma_f32_16x16x32_bf16 v[116:119], a[124:127], a[252:255], v[116:119]
    v_exp_f32 v95, v95
    v_mfma_f32_16x16x32_bf16 v[116:119], a[128:131], a[192:195], v[116:119]
    ds_read_b128 a[228:231], v3 offset:9216
    v_cvt_pk_bf16_f32 v200, v112, v113
    v_mfma_f32_16x16x32_bf16 v[116:119], a[132:135], a[196:199], v[116:119]
    v_cvt_pk_bf16_f32 v201, v114, v115
    v_add_f32 v21, v21, v61
    v_mfma_f32_16x16x32_bf16 v[116:119], a[136:139], a[200:203], v[116:119]
    v_add_f32 v22, v22, v77
    v_add_f32 v23, v23, v93
    v_mfma_f32_16x16x32_bf16 v[116:119], a[140:143], a[204:207], v[116:119]
    v_add_f32 v20, v20, v46
    v_add_f32 v21, v21, v62
    v_mfma_f32_16x16x32_bf16 v[120:123], a[144:147], a[248:251], 0
    buffer_store_dwordx2 v[242:243], v11, s[12:15], s36 offen offset:384 sc1
    v_mfma_f32_16x16x32_bf16 v[120:123], a[148:151], a[252:255], v[120:123]
    v_add_f32 v22, v22, v78
    v_add_f32 v23, v23, v94
    v_mfma_f32_16x16x32_bf16 v[120:123], a[152:155], a[192:195], v[120:123]
    v_cvt_pk_bf16_f32 v202, v116, v117
    v_cvt_pk_bf16_f32 v203, v118, v119
    v_mfma_f32_16x16x32_bf16 v[120:123], a[156:159], a[196:199], v[120:123]
    v_add_f32 v20, v20, v47
    v_add_f32 v21, v21, v63
    v_mfma_f32_16x16x32_bf16 v[120:123], a[160:163], a[200:203], v[120:123]
    v_add_f32 v22, v22, v79
    v_add_f32 v23, v23, v95
    v_mfma_f32_16x16x32_bf16 v[120:123], a[164:167], a[204:207], v[120:123]
    v_permlane16_swap_b32 v20, v21
    v_permlane16_swap_b32 v22, v23
    v_mfma_f32_16x16x32_bf16 v[124:127], a[168:171], a[248:251], 0
    s_add_u32 s42, s17, L_win2-L_pc_ref
    v_add_f32 v20, v20, v21
    v_mfma_f32_16x16x32_bf16 v[124:127], a[172:175], a[252:255], v[124:127]
    v_add_f32 v22, v22, v23
    s_add_u32 s28, s16, 10223616
    v_mfma_f32_16x16x32_bf16 v[124:127], a[176:179], a[192:195], v[124:127]
    buffer_load_dword v8, v7, s[44:47], s42 offen
    v_cvt_pk_bf16_f32 v204, v120, v121
    v_mfma_f32_16x16x32_bf16 v[124:127], a[180:183], a[196:199], v[124:127]
    buffer_store_dwordx2 v[244:245], v11, s[12:15], s36 offen offset:768 sc1
    v_mfma_f32_16x16x32_bf16 v[124:127], a[184:187], a[200:203], v[124:127]
    ds_read_b128 a[232:235], v3 offset:10240
    v_cvt_pk_bf16_f32 v205, v122, v123
    v_mfma_f32_16x16x32_bf16 v[124:127], a[188:191], a[204:207], v[124:127]
    v_permlane32_swap_b32 v20, v22
    s_waitcnt lgkmcnt(1)
    v_mfma_f32_16x16x32_bf16 v[96:99], a[96:99], a[208:211], 0
    ds_read_b128 a[236:239], v3 offset:11264
    v_add_f32 v20, v20, v22
    v_mfma_f32_16x16x32_bf16 v[96:99], a[100:103], a[212:215], v[96:99]
    v_rcp_f32 v20, v20
    v_mfma_f32_16x16x32_bf16 v[96:99], a[104:107], a[216:219], v[96:99]
    ds_read_b128 a[240:243], v3 offset:12288
    v_cvt_pk_bf16_f32 v206, v124, v125
    v_mfma_f32_16x16x32_bf16 v[96:99], a[108:111], a[220:223], v[96:99]
    v_cvt_pk_bf16_f32 v207, v126, v127
    v_mov_b32 v22, v20
    v_mfma_f32_16x16x32_bf16 v[96:99], a[112:115], a[224:227], v[96:99]
    ds_read_b128 a[244:247], v3 offset:13312
    v_permlane32_swap_b32 v20, v22
    v_mfma_f32_16x16x32_bf16 v[96:99], a[116:119], a[228:231], v[96:99]
    v_mov_b32 v21, v20
    v_mov_b32 v23, v22
    v_mfma_f32_16x16x32_bf16 v[100:103], a[120:123], a[208:211], 0
    buffer_store_dwordx2 v[246:247], v11, s[12:15], s36 offen offset:1152 sc1
    v_mfma_f32_16x16x32_bf16 v[100:103], a[124:127], a[212:215], v[100:103]
    ds_read_b128 a[248:251], v3 offset:14336
    v_permlane16_swap_b32 v20, v21
    v_mfma_f32_16x16x32_bf16 v[100:103], a[128:131], a[216:219], v[100:103]
    ds_read_b128 a[252:255], v3 offset:15360
    v_mul_f32 v32, v32, v20
    v_mfma_f32_16x16x32_bf16 v[100:103], a[132:135], a[220:223], v[100:103]
    v_mul_f32 v33, v33, v20
    v_cvt_pk_bf16_f32 v32, v32, v33
    v_mfma_f32_16x16x32_bf16 v[100:103], a[136:139], a[224:227], v[100:103]
    v_mul_f32 v34, v34, v20
    v_mul_f32 v35, v35, v20
    v_mfma_f32_16x16x32_bf16 v[100:103], a[140:143], a[228:231], v[100:103]
    v_cvt_pk_bf16_f32 v33, v34, v35
    v_mul_f32 v36, v36, v20
    v_mfma_f32_16x16x32_bf16 v[104:107], a[144:147], a[208:211], 0
    v_mul_f32 v37, v37, v20
    v_cvt_pk_bf16_f32 v34, v36, v37
    v_mfma_f32_16x16x32_bf16 v[104:107], a[148:151], a[212:215], v[104:107]
    v_mul_f32 v38, v38, v20
    v_mul_f32 v39, v39, v20
    v_mfma_f32_16x16x32_bf16 v[104:107], a[152:155], a[216:219], v[104:107]
    v_mul_f32 v40, v40, v20
    v_mul_f32 v41, v41, v20
    v_mfma_f32_16x16x32_bf16 v[104:107], a[156:159], a[220:223], v[104:107]
    buffer_store_dwordx2 v[248:249], v11, s[12:15], s38 offen offset:0 sc1
    v_mfma_f32_16x16x32_bf16 v[104:107], a[160:163], a[224:227], v[104:107]
    v_permlane16_swap_b32 v22, v23
    v_cvt_pk_bf16_f32 v35, v38, v39
    v_mfma_f32_16x16x32_bf16 v[104:107], a[164:167], a[228:231], v[104:107]
    v_cvt_pk_bf16_f32 v36, v40, v41
    v_mul_f32 v48, v48, v21
    v_mfma_f32_16x16x32_bf16 v[108:111], a[168:171], a[208:211], 0
    v_mul_f32 v49, v49, v21
    v_cvt_pk_bf16_f32 v40, v48, v49
    v_mfma_f32_16x16x32_bf16 v[108:111], a[172:175], a[212:215], v[108:111]
    v_mul_f32 v64, v64, v22
    v_mul_f32 v65, v65, v22
    v_mfma_f32_16x16x32_bf16 v[108:111], a[176:179], a[216:219], v[108:111]
    v_mul_f32 v66, v66, v22
    v_mul_f32 v67, v67, v22
    v_mfma_f32_16x16x32_bf16 v[108:111], a[180:183], a[220:223], v[108:111]
    v_cvt_pk_bf16_f32 v48, v64, v65
    v_cvt_pk_bf16_f32 v49, v66, v67
    v_mfma_f32_16x16x32_bf16 v[108:111], a[184:187], a[224:227], v[108:111]
    v_mul_f32 v42, v42, v20
    v_mul_f32 v43, v43, v20
    v_mfma_f32_16x16x32_bf16 v[108:111], a[188:191], a[228:231], v[108:111]
    v_mul_f32 v44, v44, v20
    s_waitcnt lgkmcnt(0)
    v_mfma_f32_16x16x32_bf16 v[112:115], a[96:99], a[232:235], 0
    buffer_store_dwordx2 v[250:251], v11, s[12:15], s38 offen offset:384 sc1
    v_mfma_f32_16x16x32_bf16 v[112:115], a[100:103], a[236:239], v[112:115]
    v_mul_f32 v45, v45, v20
    v_mul_f32 v46, v46, v20
    v_mfma_f32_16x16x32_bf16 v[112:115], a[104:107], a[240:243], v[112:115]
    v_mul_f32 v47, v47, v20
    v_cvt_pk_bf16_f32 v37, v42, v43
    v_mfma_f32_16x16x32_bf16 v[112:115], a[108:111], a[244:247], v[112:115]
    v_cvt_pk_bf16_f32 v38, v44, v45
    v_cvt_pk_bf16_f32 v39, v46, v47
    v_mfma_f32_16x16x32_bf16 v[112:115], a[112:115], a[248:251], v[112:115]
    v_mul_f32 v50, v50, v21
    v_mul_f32 v51, v51, v21
    v_mfma_f32_16x16x32_bf16 v[112:115], a[116:119], a[252:255], v[112:115]
    v_cvt_pk_bf16_f32 v41, v50, v51
    v_mul_f32 v68, v68, v22
    v_mfma_f32_16x16x32_bf16 v[116:119], a[120:123], a[232:235], 0
    v_mul_f32 v69, v69, v22
    v_mul_f32 v70, v70, v22
    v_mfma_f32_16x16x32_bf16 v[116:119], a[124:127], a[236:239], v[116:119]
    v_mul_f32 v71, v71, v22
    v_cvt_pk_bf16_f32 v50, v68, v69
    v_mfma_f32_16x16x32_bf16 v[116:119], a[128:131], a[240:243], v[116:119]
    v_cvt_pk_bf16_f32 v51, v70, v71
    v_mul_f32 v52, v52, v21
    v_mfma_f32_16x16x32_bf16 v[116:119], a[132:135], a[244:247], v[116:119]
    buffer_store_dwordx2 v[252:253], v11, s[12:15], s38 offen offset:768 sc1
    v_mfma_f32_16x16x32_bf16 v[116:119], a[136:139], a[248:251], v[116:119]
    v_mul_f32 v53, v53, v21
    v_cvt_pk_bf16_f32 v42, v52, v53
    v_mfma_f32_16x16x32_bf16 v[116:119], a[140:143], a[252:255], v[116:119]
    v_mul_f32 v72, v72, v22
    v_mul_f32 v73, v73, v22
    v_mfma_f32_16x16x32_bf16 v[120:123], a[144:147], a[232:235], 0
    v_mul_f32 v74, v74, v22
    v_mul_f32 v75, v75, v22
    v_mfma_f32_16x16x32_bf16 v[120:123], a[148:151], a[236:239], v[120:123]
    v_cvt_pk_bf16_f32 v52, v72, v73
    v_cvt_pk_bf16_f32 v53, v74, v75
    v_mfma_f32_16x16x32_bf16 v[120:123], a[152:155], a[240:243], v[120:123]
    v_mul_f32 v54, v54, v21
    v_mul_f32 v55, v55, v21
    v_mfma_f32_16x16x32_bf16 v[120:123], a[156:159], a[244:247], v[120:123]
    v_cvt_pk_bf16_f32 v43, v54, v55
    v_mul_f32 v76, v76, v22
    v_mfma_f32_16x16x32_bf16 v[120:123], a[160:163], a[248:251], v[120:123]
    v_mul_f32 v77, v77, v22
    v_mul_f32 v78, v78, v22
    v_mfma_f32_16x16x32_bf16 v[120:123], a[164:167], a[252:255], v[120:123]
    v_mul_f32 v79, v79, v22
    v_cvt_pk_bf16_f32 v54, v76, v77
    v_mfma_f32_16x16x32_bf16 v[124:127], a[168:171], a[232:235], 0
    buffer_store_dwordx2 v[254:255], v11, s[12:15], s38 offen offset:1152 sc1
    v_mfma_f32_16x16x32_bf16 v[124:127], a[172:175], a[236:239], v[124:127]
    v_cvt_pk_bf16_f32 v55, v78, v79
    v_mul_f32 v56, v56, v21
    v_mfma_f32_16x16x32_bf16 v[124:127], a[176:179], a[240:243], v[124:127]
    v_mul_f32 v57, v57, v21
    v_cvt_pk_bf16_f32 v44, v56, v57
    v_mfma_f32_16x16x32_bf16 v[124:127], a[180:183], a[244:247], v[124:127]
    v_mul_f32 v80, v80, v23
    v_mul_f32 v81, v81, v23
    v_mfma_f32_16x16x32_bf16 v[124:127], a[184:187], a[248:251], v[124:127]
    v_mul_f32 v82, v82, v23
    v_mul_f32 v83, v83, v23
    v_mfma_f32_16x16x32_bf16 v[124:127], a[188:191], a[252:255], v[124:127]
    v_cvt_pk_bf16_f32 v56, v80, v81
    v_cvt_pk_bf16_f32 v57, v82, v83
    v_mfma_f32_16x16x32_bf16 v[64:67], v[32:35], v[128:131], 0
    v_mul_f32 v58, v58, v21
    v_mul_f32 v59, v59, v21
    v_mfma_f32_16x16x32_bf16 v[64:67], v[36:39], v[132:135], v[64:67]
    v_mul_f32 v60, v60, v21
    v_mul_f32 v61, v61, v21
    v_mfma_f32_16x16x32_bf16 v[68:71], v[32:35], v[136:139], 0
    v_mul_f32 v62, v62, v21
    v_mul_f32 v63, v63, v21
    v_mfma_f32_16x16x32_bf16 v[68:71], v[36:39], v[140:143], v[68:71]
    v_cvt_pk_bf16_f32 v45, v58, v59
    v_cvt_pk_bf16_f32 v46, v60, v61
    v_mfma_f32_16x16x32_bf16 v[72:75], v[32:35], v[144:147], 0
    buffer_load_dwordx4 a[96:99], v9, s[8:11], s24 offen offset:0 nt
    v_cvt_pk_bf16_f32 v47, v62, v63
    v_mfma_f32_16x16x32_bf16 v[72:75], v[36:39], v[148:151], v[72:75]
    buffer_load_dwordx4 a[100:103], v10, s[8:11], s24 offen offset:0 nt
    v_mul_f32 v84, v84, v23
    v_mfma_f32_16x16x32_bf16 v[76:79], v[32:35], v[152:155], 0
    v_mul_f32 v85, v85, v23
    v_mul_f32 v86, v86, v23
    v_mfma_f32_16x16x32_bf16 v[76:79], v[36:39], v[156:159], v[76:79]
    v_mul_f32 v87, v87, v23
    v_cvt_pk_bf16_f32 v58, v84, v85
    v_mfma_f32_16x16x32_bf16 v[80:83], v[40:43], v[128:131], 0
    v_cvt_pk_bf16_f32 v59, v86, v87
    v_mul_f32 v88, v88, v23
    v_mfma_f32_16x16x32_bf16 v[80:83], v[44:47], v[132:135], v[80:83]
    v_mul_f32 v89, v89, v23
    v_mul_f32 v90, v90, v23
    v_mfma_f32_16x16x32_bf16 v[84:87], v[40:43], v[136:139], 0
    v_mul_f32 v91, v91, v23
    v_cvt_pk_bf16_f32 v60, v88, v89
    v_mfma_f32_16x16x32_bf16 v[84:87], v[44:47], v[140:143], v[84:87]
    v_cvt_pk_bf16_f32 v61, v90, v91
    v_mul_f32 v92, v92, v23
    v_mfma_f32_16x16x32_bf16 v[88:91], v[40:43], v[144:147], 0
    v_mul_f32 v93, v93, v23
    v_mul_f32 v94, v94, v23
    v_mfma_f32_16x16x32_bf16 v[88:91], v[44:47], v[148:151], v[88:91]
    v_mul_f32 v95, v95, v23
    v_cvt_pk_bf16_f32 v62, v92, v93
    v_cvt_pk_bf16_f32 v63, v94, v95
    v_mfma_f32_16x16x32_bf16 v[92:95], v[40:43], v[152:155], 0
    v_cvt_pk_bf16_f32 v208, v96, v97
    v_cvt_pk_bf16_f32 v209, v98, v99
    v_mfma_f32_16x16x32_bf16 v[92:95], v[44:47], v[156:159], v[92:95]
    v_cvt_pk_bf16_f32 v210, v100, v101
    v_cvt_pk_bf16_f32 v211, v102, v103
    v_mfma_f32_16x16x32_bf16 v[96:99], v[48:51], v[128:131], 0
    v_cvt_pk_bf16_f32 v212, v104, v105
    v_cvt_pk_bf16_f32 v213, v106, v107
    v_mfma_f32_16x16x32_bf16 v[96:99], v[52:55], v[132:135], v[96:99]
    v_cvt_pk_bf16_f32 v214, v108, v109
    v_cvt_pk_bf16_f32 v215, v110, v111
    v_mfma_f32_16x16x32_bf16 v[100:103], v[48:51], v[136:139], 0
    v_cvt_pk_bf16_f32 v216, v112, v113
    v_cvt_pk_bf16_f32 v217, v114, v115
    v_mfma_f32_16x16x32_bf16 v[100:103], v[52:55], v[140:143], v[100:103]
    v_cvt_pk_bf16_f32 v218, v116, v117
    v_cvt_pk_bf16_f32 v219, v118, v119
    v_mfma_f32_16x16x32_bf16 v[104:107], v[48:51], v[144:147], 0
    v_cvt_pk_bf16_f32 v220, v120, v121
    v_cvt_pk_bf16_f32 v221, v122, v123
    v_mfma_f32_16x16x32_bf16 v[104:107], v[52:55], v[148:151], v[104:107]
    v_cvt_pk_bf16_f32 v222, v124, v125
    v_cvt_pk_bf16_f32 v223, v126, v127
    v_mfma_f32_16x16x32_bf16 v[108:111], v[48:51], v[152:155], 0
    v_cvt_pk_bf16_f32 v224, v64, v68
    v_cvt_pk_bf16_f32 v226, v65, v69
    v_mfma_f32_16x16x32_bf16 v[108:111], v[52:55], v[156:159], v[108:111]
    v_cvt_pk_bf16_f32 v228, v66, v70
    v_cvt_pk_bf16_f32 v230, v67, v71
    v_mfma_f32_16x16x32_bf16 v[112:115], v[56:59], v[128:131], 0
    v_cvt_pk_bf16_f32 v225, v72, v76
    v_cvt_pk_bf16_f32 v227, v73, v77
    v_mfma_f32_16x16x32_bf16 v[112:115], v[60:63], v[132:135], v[112:115]
    v_cvt_pk_bf16_f32 v229, v74, v78
    v_cvt_pk_bf16_f32 v231, v75, v79
    v_mfma_f32_16x16x32_bf16 v[116:119], v[56:59], v[136:139], 0
    v_cvt_pk_bf16_f32 v232, v80, v84
    v_cvt_pk_bf16_f32 v234, v81, v85
    v_mfma_f32_16x16x32_bf16 v[116:119], v[60:63], v[140:143], v[116:119]
    v_cvt_pk_bf16_f32 v236, v82, v86
    v_cvt_pk_bf16_f32 v238, v83, v87
    v_mfma_f32_16x16x32_bf16 v[120:123], v[56:59], v[144:147], 0
    v_cvt_pk_bf16_f32 v233, v88, v92
    v_cvt_pk_bf16_f32 v235, v89, v93
    v_mfma_f32_16x16x32_bf16 v[120:123], v[60:63], v[148:151], v[120:123]
    v_cvt_pk_bf16_f32 v237, v90, v94
    v_cvt_pk_bf16_f32 v239, v91, v95
    v_mfma_f32_16x16x32_bf16 v[124:127], v[56:59], v[152:155], 0
    v_cvt_pk_bf16_f32 v240, v96, v100
    v_cvt_pk_bf16_f32 v242, v97, v101
    v_mfma_f32_16x16x32_bf16 v[124:127], v[60:63], v[156:159], v[124:127]
    v_cvt_pk_bf16_f32 v244, v98, v102
    v_cvt_pk_bf16_f32 v246, v99, v103
    v_mfma_f32_16x16x32_bf16 v[64:67], v[32:35], v[160:163], 0
    v_cvt_pk_bf16_f32 v241, v104, v108
    v_cvt_pk_bf16_f32 v243, v105, v109
    v_mfma_f32_16x16x32_bf16 v[64:67], v[36:39], v[164:167], v[64:67]
    v_cvt_pk_bf16_f32 v245, v106, v110
    v_cvt_pk_bf16_f32 v247, v107, v111
    v_mfma_f32_16x16x32_bf16 v[68:71], v[32:35], v[168:171], 0
    v_cvt_pk_bf16_f32 v248, v112, v116
    v_cvt_pk_bf16_f32 v250, v113, v117
    v_mfma_f32_16x16x32_bf16 v[68:71], v[36:39], v[172:175], v[68:71]
    v_cvt_pk_bf16_f32 v252, v114, v118
    v_cvt_pk_bf16_f32 v254, v115, v119
    v_mfma_f32_16x16x32_bf16 v[72:75], v[32:35], v[176:179], 0
    v_cvt_pk_bf16_f32 v249, v120, v124
    v_cvt_pk_bf16_f32 v251, v121, v125
    v_mfma_f32_16x16x32_bf16 v[72:75], v[36:39], v[180:183], v[72:75]
    v_cvt_pk_bf16_f32 v253, v122, v126
    v_cvt_pk_bf16_f32 v255, v123, v127
    v_mfma_f32_16x16x32_bf16 v[76:79], v[32:35], v[184:187], 0
    v_cvt_pk_bf16_f32 v128, v64, v68
    v_cvt_pk_bf16_f32 v130, v65, v69
    v_mfma_f32_16x16x32_bf16 v[76:79], v[36:39], v[188:191], v[76:79]
    v_cvt_pk_bf16_f32 v132, v66, v70
    v_cvt_pk_bf16_f32 v134, v67, v71
    v_mfma_f32_16x16x32_bf16 v[80:83], v[40:43], v[160:163], 0
    s_add_u32 s30, s16, 10616832
    s_add_u32 s32, s16, 6291456
    v_mfma_f32_16x16x32_bf16 v[80:83], v[44:47], v[164:167], v[80:83]
    s_add_u32 s34, s16, 6684672
    s_add_u32 s36, s16, 7077888
    v_mfma_f32_16x16x32_bf16 v[84:87], v[40:43], v[168:171], 0
    v_cvt_pk_bf16_f32 v129, v72, v76
    v_cvt_pk_bf16_f32 v131, v73, v77
    v_mfma_f32_16x16x32_bf16 v[84:87], v[44:47], v[172:175], v[84:87]
    v_cvt_pk_bf16_f32 v133, v74, v78
    v_cvt_pk_bf16_f32 v135, v75, v79
    v_mfma_f32_16x16x32_bf16 v[88:91], v[40:43], v[176:179], 0
    s_waitcnt vmcnt(26)
    ds_write_b64 v4, a[64:65] offset:0
    v_mfma_f32_16x16x32_bf16 v[88:91], v[44:47], v[180:183], v[88:91]
    ds_write_b64 v4, a[66:67] offset:1024
    v_mfma_f32_16x16x32_bf16 v[92:95], v[40:43], v[184:187], 0
    ds_write_b64 v4, a[68:69] offset:512
    v_mfma_f32_16x16x32_bf16 v[92:95], v[44:47], v[188:191], v[92:95]
    ds_write_b64 v4, a[70:71] offset:1536
    v_mfma_f32_16x16x32_bf16 v[96:99], v[48:51], v[160:163], 0
    ds_read2_b64 a[64:67], v5 offset0:0 offset1:128
    v_cvt_pk_bf16_f32 v136, v80, v84
    v_mfma_f32_16x16x32_bf16 v[96:99], v[52:55], v[164:167], v[96:99]
    buffer_load_dwordx4 a[104:107], v9, s[8:11], s24 offen offset:128 nt
    v_cvt_pk_bf16_f32 v138, v81, v85
    v_mfma_f32_16x16x32_bf16 v[100:103], v[48:51], v[168:171], 0
    buffer_load_dwordx4 a[108:111], v10, s[8:11], s24 offen offset:128 nt
    v_cvt_pk_bf16_f32 v140, v82, v86
    v_mfma_f32_16x16x32_bf16 v[100:103], v[52:55], v[172:175], v[100:103]
    ds_read2_b64 a[68:71], v6 offset0:0 offset1:128
    v_cvt_pk_bf16_f32 v142, v83, v87
    v_mfma_f32_16x16x32_bf16 v[104:107], v[48:51], v[176:179], 0
    v_cvt_pk_bf16_f32 v137, v88, v92
    v_cvt_pk_bf16_f32 v139, v89, v93
    v_mfma_f32_16x16x32_bf16 v[104:107], v[52:55], v[180:183], v[104:107]
    v_cvt_pk_bf16_f32 v141, v90, v94
    v_cvt_pk_bf16_f32 v143, v91, v95
    v_mfma_f32_16x16x32_bf16 v[108:111], v[48:51], v[184:187], 0
    v_cvt_pk_bf16_f32 v144, v96, v100
    v_cvt_pk_bf16_f32 v146, v97, v101
    v_mfma_f32_16x16x32_bf16 v[108:111], v[52:55], v[188:191], v[108:111]
    v_cvt_pk_bf16_f32 v148, v98, v102
    v_cvt_pk_bf16_f32 v150, v99, v103
    v_mfma_f32_16x16x32_bf16 v[112:115], v[56:59], v[160:163], 0
    s_add_u32 s38, s16, 7471104
    v_mfma_f32_16x16x32_bf16 v[112:115], v[60:63], v[164:167], v[112:115]
    v_mfma_f32_16x16x32_bf16 v[116:119], v[56:59], v[168:171], 0
    s_waitcnt vmcnt(24)
    ds_write_b64 v4, a[72:73] offset:0
    v_mfma_f32_16x16x32_bf16 v[116:119], v[60:63], v[172:175], v[116:119]
    ds_write_b64 v4, a[74:75] offset:1024
    v_mfma_f32_16x16x32_bf16 v[120:123], v[56:59], v[176:179], 0
    ds_write_b64 v4, a[76:77] offset:512
    v_mfma_f32_16x16x32_bf16 v[120:123], v[60:63], v[180:183], v[120:123]
    ds_write_b64 v4, a[78:79] offset:1536
    v_mfma_f32_16x16x32_bf16 v[124:127], v[56:59], v[184:187], 0
    ds_read2_b64 a[72:75], v5 offset0:0 offset1:128
    v_cvt_pk_bf16_f32 v145, v104, v108
    v_mfma_f32_16x16x32_bf16 v[124:127], v[60:63], v[188:191], v[124:127]
    ds_read2_b64 a[76:79], v6 offset0:0 offset1:128
    v_cvt_pk_bf16_f32 v147, v105, v109
    v_mfma_f32_16x16x32_bf16 v[64:67], v[32:35], v[192:195], 0
    v_cvt_pk_bf16_f32 v149, v106, v110
    v_cvt_pk_bf16_f32 v151, v107, v111
    v_mfma_f32_16x16x32_bf16 v[64:67], v[36:39], v[196:199], v[64:67]
    v_cvt_pk_bf16_f32 v152, v112, v116
    v_cvt_pk_bf16_f32 v154, v113, v117
    v_mfma_f32_16x16x32_bf16 v[68:71], v[32:35], v[200:203], 0
    v_cvt_pk_bf16_f32 v156, v114, v118
    v_cvt_pk_bf16_f32 v158, v115, v119
    v_mfma_f32_16x16x32_bf16 v[68:71], v[36:39], v[204:207], v[68:71]
    v_cvt_pk_bf16_f32 v153, v120, v124
    v_cvt_pk_bf16_f32 v155, v121, v125
    v_mfma_f32_16x16x32_bf16 v[72:75], v[32:35], v[208:211], 0
    v_cvt_pk_bf16_f32 v157, v122, v126
    v_cvt_pk_bf16_f32 v159, v123, v127
    v_mfma_f32_16x16x32_bf16 v[72:75], v[36:39], v[212:215], v[72:75]
    v_mfma_f32_16x16x32_bf16 v[76:79], v[32:35], v[216:219], 0
    ds_read_b128 a[192:195], v1 offset:0
    v_cvt_pk_bf16_f32 v160, v64, v68
    v_mfma_f32_16x16x32_bf16 v[76:79], v[36:39], v[220:223], v[76:79]
    v_cvt_pk_bf16_f32 v162, v65, v69
    v_cvt_pk_bf16_f32 v164, v66, v70
    v_mfma_f32_16x16x32_bf16 v[80:83], v[40:43], v[192:195], 0
    ds_read_b128 a[196:199], v1 offset:1024
    v_cvt_pk_bf16_f32 v166, v67, v71
    v_mfma_f32_16x16x32_bf16 v[80:83], v[44:47], v[196:199], v[80:83]
    s_waitcnt vmcnt(21)
    ds_write_b64 v4, a[80:81] offset:0
    v_mfma_f32_16x16x32_bf16 v[84:87], v[40:43], v[200:203], 0
    ds_read_b128 a[200:203], v1 offset:2048
    v_cvt_pk_bf16_f32 v161, v72, v76
    v_mfma_f32_16x16x32_bf16 v[84:87], v[44:47], v[204:207], v[84:87]
    ds_write_b64 v4, a[82:83] offset:1024
    v_mfma_f32_16x16x32_bf16 v[88:91], v[40:43], v[208:211], 0
    ds_read_b128 a[204:207], v1 offset:3072
    v_cvt_pk_bf16_f32 v163, v73, v77
    v_mfma_f32_16x16x32_bf16 v[88:91], v[44:47], v[212:215], v[88:91]
    ds_write_b64 v4, a[84:85] offset:512
    v_mfma_f32_16x16x32_bf16 v[92:95], v[40:43], v[216:219], 0
    ds_read_b128 a[208:211], v1 offset:4096
    v_cvt_pk_bf16_f32 v165, v74, v78
    v_mfma_f32_16x16x32_bf16 v[92:95], v[44:47], v[220:223], v[92:95]
    ds_write_b64 v4, a[86:87] offset:1536
    v_mfma_f32_16x16x32_bf16 v[96:99], v[48:51], v[192:195], 0
    ds_read_b128 a[212:215], v1 offset:5120
    v_cvt_pk_bf16_f32 v167, v75, v79
    v_mfma_f32_16x16x32_bf16 v[96:99], v[52:55], v[196:199], v[96:99]
    ds_read2_b64 a[80:83], v5 offset0:0 offset1:128
    v_cvt_pk_bf16_f32 v168, v80, v84
    v_mfma_f32_16x16x32_bf16 v[100:103], v[48:51], v[200:203], 0
    ds_read2_b64 a[84:87], v6 offset0:0 offset1:128
    v_cvt_pk_bf16_f32 v170, v81, v85
    v_mfma_f32_16x16x32_bf16 v[100:103], v[52:55], v[204:207], v[100:103]
    v_cvt_pk_bf16_f32 v172, v82, v86
    v_cvt_pk_bf16_f32 v174, v83, v87
    v_mfma_f32_16x16x32_bf16 v[104:107], v[48:51], v[208:211], 0
    v_cvt_pk_bf16_f32 v169, v88, v92
    v_cvt_pk_bf16_f32 v171, v89, v93
    v_mfma_f32_16x16x32_bf16 v[104:107], v[52:55], v[212:215], v[104:107]
    v_cvt_pk_bf16_f32 v173, v90, v94
    v_cvt_pk_bf16_f32 v175, v91, v95
    v_mfma_f32_16x16x32_bf16 v[108:111], v[48:51], v[216:219], 0
    s_waitcnt vmcnt(17)
    ds_write_b64 v4, a[88:89] offset:0
    v_mfma_f32_16x16x32_bf16 v[108:111], v[52:55], v[220:223], v[108:111]
    ds_write_b64 v4, a[90:91] offset:1024
    v_mfma_f32_16x16x32_bf16 v[112:115], v[56:59], v[192:195], 0
    buffer_store_dwordx2 v[128:129], v11, s[12:15], s33 offen offset:128 sc1
    v_mfma_f32_16x16x32_bf16 v[112:115], v[60:63], v[196:199], v[112:115]
    ds_write_b64 v4, a[92:93] offset:512
    v_mfma_f32_16x16x32_bf16 v[116:119], v[56:59], v[200:203], 0
    ds_write_b64 v4, a[94:95] offset:1536
    v_mfma_f32_16x16x32_bf16 v[116:119], v[60:63], v[204:207], v[116:119]
    ds_read2_b64 a[88:91], v5 offset0:0 offset1:128
    v_cvt_pk_bf16_f32 v176, v96, v100
    v_mfma_f32_16x16x32_bf16 v[120:123], v[56:59], v[208:211], 0
    ds_read2_b64 a[92:95], v6 offset0:0 offset1:128
    v_cvt_pk_bf16_f32 v178, v97, v101
    v_mfma_f32_16x16x32_bf16 v[120:123], v[60:63], v[212:215], v[120:123]
    v_cvt_pk_bf16_f32 v180, v98, v102
    v_cvt_pk_bf16_f32 v182, v99, v103
    v_mfma_f32_16x16x32_bf16 v[124:127], v[56:59], v[216:219], 0
    buffer_load_dwordx4 a[112:115], v9, s[8:11], s24 offen offset:256 nt
    v_cvt_pk_bf16_f32 v177, v104, v108
    v_mfma_f32_16x16x32_bf16 v[124:127], v[60:63], v[220:223], v[124:127]
    buffer_load_dwordx4 a[116:119], v10, s[8:11], s24 offen offset:256 nt
    s_waitcnt lgkmcnt(6)
L_win2:
    v_mfma_f32_16x16x32_bf16 v[96:99], a[192:195], a[0:3], 0
    ds_read_b128 a[216:219], v1 offset:6144
    v_cvt_pk_bf16_f32 v179, v105, v109
    v_mfma_f32_16x16x32_bf16 v[96:99], a[196:199], a[4:7], v[96:99]
    ds_read_b128 a[220:223], v1 offset:7168
    v_cvt_pk_bf16_f32 v181, v106, v110
    v_mfma_f32_16x16x32_bf16 v[96:99], a[200:203], a[8:11], v[96:99]
    ds_read_b128 a[224:227], v1 offset:8192
    v_cvt_pk_bf16_f32 v183, v107, v111
    v_mfma_f32_16x16x32_bf16 v[96:99], a[204:207], a[12:15], v[96:99]
    v_cvt_pk_bf16_f32 v184, v112, v116
    v_cvt_pk_bf16_f32 v186, v113, v117
    v_mfma_f32_16x16x32_bf16 v[96:99], a[208:211], a[16:19], v[96:99]
    ds_read_b128 a[228:231], v1 offset:9216
    v_cvt_pk_bf16_f32 v188, v114, v118
    v_mfma_f32_16x16x32_bf16 v[96:99], a[212:215], a[20:23], v[96:99]
    v_cvt_pk_bf16_f32 v190, v115, v119
    v_cvt_pk_bf16_f32 v185, v120, v124
    v_mfma_f32_16x16x32_bf16 v[100:103], a[192:195], a[24:27], 0
    ds_read_b128 a[232:235], v1 offset:10240
    v_cvt_pk_bf16_f32 v187, v121, v125
    v_mfma_f32_16x16x32_bf16 v[100:103], a[196:199], a[28:31], v[100:103]
    v_cvt_pk_bf16_f32 v189, v122, v126
    v_cvt_pk_bf16_f32 v191, v123, v127
    v_mfma_f32_16x16x32_bf16 v[100:103], a[200:203], a[32:35], v[100:103]
    ds_read_b128 a[236:239], v1 offset:11264
    v_cvt_pk_bf16_f32 v192, v96, v97
    v_mfma_f32_16x16x32_bf16 v[100:103], a[204:207], a[36:39], v[100:103]
    v_cvt_pk_bf16_f32 v193, v98, v99
    v_mfma_f32_16x16x32_bf16 v[100:103], a[208:211], a[40:43], v[100:103]
    v_mfma_f32_16x16x32_bf16 v[100:103], a[212:215], a[44:47], v[100:103]
    v_mfma_f32_16x16x32_bf16 v[104:107], a[192:195], a[48:51], 0
    v_mfma_f32_16x16x32_bf16 v[104:107], a[196:199], a[52:55], v[104:107]
    v_mfma_f32_16x16x32_bf16 v[104:107], a[200:203], a[56:59], v[104:107]
    v_cvt_pk_bf16_f32 v196, v100, v101
    v_cvt_pk_bf16_f32 v197, v102, v103
    v_mfma_f32_16x16x32_bf16 v[104:107], a[204:207], a[60:63], v[104:107]
    v_mfma_f32_16x16x32_bf16 v[104:107], a[208:211], a[64:67], v[104:107]
    v_mfma_f32_16x16x32_bf16 v[104:107], a[212:215], a[68:71], v[104:107]
    v_mfma_f32_16x16x32_bf16 v[108:111], a[192:195], a[72:75], 0
    v_mfma_f32_16x16x32_bf16 v[108:111], a[196:199], a[76:79], v[108:111]
    buffer_store_dwordx2 v[130:131], v11, s[12:15], s33 offen offset:512 sc1
    v_mfma_f32_16x16x32_bf16 v[108:111], a[200:203], a[80:83], v[108:111]
    v_cvt_pk_bf16_f32 v200, v104, v105
    v_cvt_pk_bf16_f32 v201, v106, v107
    v_mfma_f32_16x16x32_bf16 v[108:111], a[204:207], a[84:87], v[108:111]
    s_waitcnt lgkmcnt(0)
    v_mfma_f32_16x16x32_bf16 v[108:111], a[208:211], a[88:91], v[108:111]
    ds_read_b128 a[240:243], v1 offset:12288
    v_mfma_f32_16x16x32_bf16 v[108:111], a[212:215], a[92:95], v[108:111]
    v_mfma_f32_16x16x32_bf16 v[112:115], a[216:219], a[0:3], 0
    ds_read_b128 a[244:247], v1 offset:13312
    v_mfma_f32_16x16x32_bf16 v[112:115], a[220:223], a[4:7], v[112:115]
    v_mfma_f32_16x16x32_bf16 v[112:115], a[224:227], a[8:11], v[112:115]
    ds_read_b128 a[248:251], v1 offset:14336
    v_cvt_pk_bf16_f32 v204, v108, v109
    v_mfma_f32_16x16x32_bf16 v[112:115], a[228:231], a[12:15], v[112:115]
    v_cvt_pk_bf16_f32 v205, v110, v111
    v_mfma_f32_16x16x32_bf16 v[112:115], a[232:235], a[16:19], v[112:115]
    ds_read_b128 a[252:255], v1 offset:15360
    v_mfma_f32_16x16x32_bf16 v[112:115], a[236:239], a[20:23], v[112:115]
    v_mfma_f32_16x16x32_bf16 v[116:119], a[216:219], a[24:27], 0
    ds_read_b128 a[192:195], v1 offset:16384
    v_mfma_f32_16x16x32_bf16 v[116:119], a[220:223], a[28:31], v[116:119]
    v_mfma_f32_16x16x32_bf16 v[116:119], a[224:227], a[32:35], v[116:119]
    ds_read_b128 a[196:199], v1 offset:17408
    v_cvt_pk_bf16_f32 v194, v112, v113
    v_mfma_f32_16x16x32_bf16 v[116:119], a[228:231], a[36:39], v[116:119]
    v_cvt_pk_bf16_f32 v195, v114, v115
    v_mfma_f32_16x16x32_bf16 v[116:119], a[232:235], a[40:43], v[116:119]
    v_mfma_f32_16x16x32_bf16 v[116:119], a[236:239], a[44:47], v[116:119]
    v_mfma_f32_16x16x32_bf16 v[120:123], a[216:219], a[48:51], 0
    v_mfma_f32_16x16x32_bf16 v[120:123], a[220:223], a[52:55], v[120:123]
    v_mfma_f32_16x16x32_bf16 v[120:123], a[224:227], a[56:59], v[120:123]
    v_cvt_pk_bf16_f32 v198, v116, v117
    v_cvt_pk_bf16_f32 v199, v118, v119
    v_mfma_f32_16x16x32_bf16 v[120:123], a[228:231], a[60:63], v[120:123]
    v_mfma_f32_16x16x32_bf16 v[120:123], a[232:235], a[64:67], v[120:123]
    v_mfma_f32_16x16x32_bf16 v[120:123], a[236:239], a[68:71], v[120:123]
    v_mfma_f32_16x16x32_bf16 v[124:127], a[216:219], a[72:75], 0
    v_mfma_f32_16x16x32_bf16 v[124:127], a[220:223], a[76:79], v[124:127]
    buffer_load_dwordx4 a[120:123], v9, s[8:11], s26 offen offset:0 nt
    v_mfma_f32_16x16x32_bf16 v[124:127], a[224:227], a[80:83], v[124:127]
    buffer_load_dwordx4 a[124:127], v10, s[8:11], s26 offen offset:0 nt
    v_cvt_pk_bf16_f32 v202, v120, v121
    v_mfma_f32_16x16x32_bf16 v[124:127], a[228:231], a[84:87], v[124:127]
    v_cvt_pk_bf16_f32 v203, v122, v123
    v_mfma_f32_16x16x32_bf16 v[124:127], a[232:235], a[88:91], v[124:127]
    buffer_store_dwordx2 v[132:133], v11, s[12:15], s33 offen offset:896 sc1
    v_mfma_f32_16x16x32_bf16 v[124:127], a[236:239], a[92:95], v[124:127]
    ds_read_b128 a[200:203], v1 offset:18432
    s_waitcnt lgkmcnt(1)
    v_mfma_f32_16x16x32_bf16 v[96:99], a[240:243], a[0:3], 0
    ds_read_b128 a[204:207], v1 offset:19456
    v_mfma_f32_16x16x32_bf16 v[96:99], a[244:247], a[4:7], v[96:99]
    v_mfma_f32_16x16x32_bf16 v[96:99], a[248:251], a[8:11], v[96:99]
    ds_read_b128 a[208:211], v1 offset:20480
    v_cvt_pk_bf16_f32 v206, v124, v125
    v_mfma_f32_16x16x32_bf16 v[96:99], a[252:255], a[12:15], v[96:99]
    v_cvt_pk_bf16_f32 v207, v126, v127
    v_mfma_f32_16x16x32_bf16 v[96:99], a[192:195], a[16:19], v[96:99]
    ds_read_b128 a[212:215], v1 offset:21504
    v_mfma_f32_16x16x32_bf16 v[96:99], a[196:199], a[20:23], v[96:99]
    v_mfma_f32_16x16x32_bf16 v[100:103], a[240:243], a[24:27], 0
    ds_read_b128 a[216:219], v1 offset:22528
    v_mfma_f32_16x16x32_bf16 v[100:103], a[244:247], a[28:31], v[100:103]
    v_mfma_f32_16x16x32_bf16 v[100:103], a[248:251], a[32:35], v[100:103]
    ds_read_b128 a[220:223], v1 offset:23552
    v_cvt_pk_bf16_f32 v208, v96, v97
    v_mfma_f32_16x16x32_bf16 v[100:103], a[252:255], a[36:39], v[100:103]
    v_cvt_pk_bf16_f32 v209, v98, v99
    v_mfma_f32_16x16x32_bf16 v[100:103], a[192:195], a[40:43], v[100:103]
    v_mfma_f32_16x16x32_bf16 v[100:103], a[196:199], a[44:47], v[100:103]
    v_mfma_f32_16x16x32_bf16 v[104:107], a[240:243], a[48:51], 0
    v_mfma_f32_16x16x32_bf16 v[104:107], a[244:247], a[52:55], v[104:107]
    v_mfma_f32_16x16x32_bf16 v[104:107], a[248:251], a[56:59], v[104:107]
    v_cvt_pk_bf16_f32 v212, v100, v101
    v_cvt_pk_bf16_f32 v213, v102, v103
    v_mfma_f32_16x16x32_bf16 v[104:107], a[252:255], a[60:63], v[104:107]
    v_mfma_f32_16x16x32_bf16 v[104:107], a[192:195], a[64:67], v[104:107]
    v_mfma_f32_16x16x32_bf16 v[104:107], a[196:199], a[68:71], v[104:107]
    v_mfma_f32_16x16x32_bf16 v[108:111], a[240:243], a[72:75], 0
    v_mfma_f32_16x16x32_bf16 v[108:111], a[244:247], a[76:79], v[108:111]
    v_mfma_f32_16x16x32_bf16 v[108:111], a[248:251], a[80:83], v[108:111]
    v_cvt_pk_bf16_f32 v216, v104, v105
    v_cvt_pk_bf16_f32 v217, v106, v107
    v_mfma_f32_16x16x32_bf16 v[108:111], a[252:255], a[84:87], v[108:111]
    v_mfma_f32_16x16x32_bf16 v[108:111], a[192:195], a[88:91], v[108:111]
    ds_read_b128 a[224:227], v1 offset:24576
    v_mfma_f32_16x16x32_bf16 v[108:111], a[196:199], a[92:95], v[108:111]
    s_waitcnt vmcnt(10)
    ds_write_b64 v4, a[96:97] offset:0
    s_waitcnt lgkmcnt(2)
    v_mfma_f32_16x16x32_bf16 v[112:115], a[200:203], a[0:3], 0
    ds_read_b128 a[228:231], v1 offset:25600
    v_mfma_f32_16x16x32_bf16 v[112:115], a[204:207], a[4:7], v[112:115]
    buffer_store_dwordx2 v[134:135], v11, s[12:15], s33 offen offset:1280 sc1
    v_mfma_f32_16x16x32_bf16 v[112:115], a[208:211], a[8:11], v[112:115]
    ds_read_b128 a[232:235], v1 offset:26624
    v_cvt_pk_bf16_f32 v220, v108, v109
    v_mfma_f32_16x16x32_bf16 v[112:115], a[212:215], a[12:15], v[112:115]
    ds_write_b64 v4, a[98:99] offset:1024
    v_mfma_f32_16x16x32_bf16 v[112:115], a[216:219], a[16:19], v[112:115]
    ds_read_b128 a[236:239], v1 offset:27648
    v_cvt_pk_bf16_f32 v221, v110, v111
    v_mfma_f32_16x16x32_bf16 v[112:115], a[220:223], a[20:23], v[112:115]
    s_waitcnt vmcnt(10)
    ds_write_b64 v4, a[100:101] offset:512
    v_mfma_f32_16x16x32_bf16 v[116:119], a[200:203], a[24:27], 0
    ds_read_b128 a[240:243], v1 offset:28672
    v_mfma_f32_16x16x32_bf16 v[116:119], a[204:207], a[28:31], v[116:119]
    ds_write_b64 v4, a[102:103] offset:1536
    v_mfma_f32_16x16x32_bf16 v[116:119], a[208:211], a[32:35], v[116:119]
    ds_read_b128 a[244:247], v1 offset:29696
    v_cvt_pk_bf16_f32 v210, v112, v113
    v_mfma_f32_16x16x32_bf16 v[116:119], a[212:215], a[36:39], v[116:119]
    ds_read2_b64 a[96:99], v5 offset0:0 offset1:128
    v_cvt_pk_bf16_f32 v211, v114, v115
    v_mfma_f32_16x16x32_bf16 v[116:119], a[216:219], a[40:43], v[116:119]
    ds_read2_b64 a[100:103], v6 offset0:0 offset1:128
    v_mfma_f32_16x16x32_bf16 v[116:119], a[220:223], a[44:47], v[116:119]
    v_mfma_f32_16x16x32_bf16 v[120:123], a[200:203], a[48:51], 0
    v_mfma_f32_16x16x32_bf16 v[120:123], a[204:207], a[52:55], v[120:123]
    v_mfma_f32_16x16x32_bf16 v[120:123], a[208:211], a[56:59], v[120:123]
    v_cvt_pk_bf16_f32 v214, v116, v117
    v_cvt_pk_bf16_f32 v215, v118, v119
    v_mfma_f32_16x16x32_bf16 v[120:123], a[212:215], a[60:63], v[120:123]
    v_mfma_f32_16x16x32_bf16 v[120:123], a[216:219], a[64:67], v[120:123]
    buffer_load_dwordx4 a[128:131], v9, s[8:11], s26 offen offset:128 nt
    v_mfma_f32_16x16x32_bf16 v[120:123], a[220:223], a[68:71], v[120:123]
    buffer_load_dwordx4 a[132:135], v10, s[8:11], s26 offen offset:128 nt
    v_mfma_f32_16x16x32_bf16 v[124:127], a[200:203], a[72:75], 0
    v_mfma_f32_16x16x32_bf16 v[124:127], a[204:207], a[76:79], v[124:127]
    v_mfma_f32_16x16x32_bf16 v[124:127], a[208:211], a[80:83], v[124:127]
    v_cvt_pk_bf16_f32 v218, v120, v121
    v_cvt_pk_bf16_f32 v219, v122, v123
    v_mfma_f32_16x16x32_bf16 v[124:127], a[212:215], a[84:87], v[124:127]
    v_mfma_f32_16x16x32_bf16 v[124:127], a[216:219], a[88:91], v[124:127]
    v_mfma_f32_16x16x32_bf16 v[124:127], a[220:223], a[92:95], v[124:127]
    s_waitcnt lgkmcnt(1)
    v_mfma_f32_16x16x32_bf16 v[96:99], a[224:227], a[0:3], 0
    v_mfma_f32_16x16x32_bf16 v[96:99], a[228:231], a[4:7], v[96:99]
    v_mfma_f32_16x16x32_bf16 v[96:99], a[232:235], a[8:11], v[96:99]
    v_cvt_pk_bf16_f32 v222, v124, v125
    v_cvt_pk_bf16_f32 v223, v126, v127
    v_mfma_f32_16x16x32_bf16 v[96:99], a[236:239], a[12:15], v[96:99]
    v_mfma_f32_16x16x32_bf16 v[96:99], a[240:243], a[16:19], v[96:99]
    buffer_store_dwordx2 v[136:137], v11, s[12:15], s35 offen offset:128 sc1
    v_mfma_f32_16x16x32_bf16 v[96:99], a[244:247], a[20:23], v[96:99]
    v_mfma_f32_16x16x32_bf16 v[100:103], a[224:227], a[24:27], 0
    v_mfma_f32_16x16x32_bf16 v[100:103], a[228:231], a[28:31], v[100:103]
    v_mfma_f32_16x16x32_bf16 v[100:103], a[232:235], a[32:35], v[100:103]
    v_mfma_f32_16x16x32_bf16 v[100:103], a[236:239], a[36:39], v[100:103]
    v_mfma_f32_16x16x32_bf16 v[100:103], a[240:243], a[40:43], v[100:103]
    v_mfma_f32_16x16x32_bf16 v[100:103], a[244:247], a[44:47], v[100:103]
    v_mfma_f32_16x16x32_bf16 v[32:35], a[0:3], v[192:195], 0
    v_mfma_f32_16x16x32_bf16 v[32:35], a[4:7], v[208:211], v[32:35]
    v_mfma_f32_16x16x32_bf16 v[36:39], a[24:27], v[192:195], 0
    v_mfma_f32_16x16x32_bf16 v[36:39], a[28:31], v[208:211], v[36:39]
    v_mfma_f32_16x16x32_bf16 v[40:43], a[48:51], v[192:195], 0
    v_mfma_f32_16x16x32_bf16 v[40:43], a[52:55], v[208:211], v[40:43]
    v_mfma_f32_16x16x32_bf16 v[44:47], a[72:75], v[192:195], 0
    v_cvt_pk_bf16_f32 v192, v96, v97
    v_cvt_pk_bf16_f32 v193, v98, v99
    v_mfma_f32_16x16x32_bf16 v[44:47], a[76:79], v[208:211], v[44:47]
    s_waitcnt vmcnt(12)
    ds_write_b64 v4, a[104:105] offset:0
    v_mfma_f32_16x16x32_bf16 v[48:51], a[0:3], v[196:199], 0
    ds_write_b64 v4, a[106:107] offset:1024
    v_mfma_f32_16x16x32_bf16 v[48:51], a[4:7], v[212:215], v[48:51]
    s_waitcnt vmcnt(11)
    ds_write_b64 v4, a[108:109] offset:512
    v_mfma_f32_16x16x32_bf16 v[52:55], a[24:27], v[196:199], 0
    ds_write_b64 v4, a[110:111] offset:1536
    v_mfma_f32_16x16x32_bf16 v[52:55], a[28:31], v[212:215], v[52:55]
    ds_read2_b64 a[104:107], v5 offset0:0 offset1:128
    v_mfma_f32_16x16x32_bf16 v[56:59], a[48:51], v[196:199], 0
    ds_read2_b64 a[108:111], v6 offset0:0 offset1:128
    v_mfma_f32_16x16x32_bf16 v[56:59], a[52:55], v[212:215], v[56:59]
    v_mfma_f32_16x16x32_bf16 v[60:63], a[72:75], v[196:199], 0
    v_cvt_pk_bf16_f32 v196, v100, v101
    v_cvt_pk_bf16_f32 v197, v102, v103
    v_mfma_f32_16x16x32_bf16 v[60:63], a[76:79], v[212:215], v[60:63]
    v_mfma_f32_16x16x32_bf16 v[64:67], a[0:3], v[200:203], 0
    v_mfma_f32_16x16x32_bf16 v[64:67], a[4:7], v[216:219], v[64:67]
    v_mfma_f32_16x16x32_bf16 v[68:71], a[24:27], v[200:203], 0
    ds_read_b128 a[248:251], v1 offset:30720
    v_mfma_f32_16x16x32_bf16 v[68:71], a[28:31], v[216:219], v[68:71]
    buffer_store_dwordx2 v[138:139], v11, s[12:15], s35 offen offset:512 sc1
    v_mfma_f32_16x16x32_bf16 v[72:75], a[48:51], v[200:203], 0
    ds_read_b128 a[252:255], v1 offset:31744
    v_mfma_f32_16x16x32_bf16 v[72:75], a[52:55], v[216:219], v[72:75]
    v_mfma_f32_16x16x32_bf16 v[76:79], a[72:75], v[200:203], 0
    ds_read_b128 a[192:195], v1 offset:32768
    v_mfma_f32_16x16x32_bf16 v[76:79], a[76:79], v[216:219], v[76:79]
    v_mfma_f32_16x16x32_bf16 v[80:83], a[0:3], v[204:207], 0
    ds_read_b128 a[196:199], v1 offset:33792
    v_mfma_f32_16x16x32_bf16 v[80:83], a[4:7], v[220:223], v[80:83]
    buffer_load_dwordx4 a[136:139], v9, s[8:11], s26 offen offset:256 nt
    v_mfma_f32_16x16x32_bf16 v[84:87], a[24:27], v[204:207], 0
    buffer_load_dwordx4 a[140:143], v10, s[8:11], s26 offen offset:256 nt
    v_mfma_f32_16x16x32_bf16 v[84:87], a[28:31], v[220:223], v[84:87]
    ds_read_b128 a[200:203], v1 offset:34816
    v_mfma_f32_16x16x32_bf16 v[88:91], a[48:51], v[204:207], 0
    ds_read_b128 a[204:207], v1 offset:35840
    v_mfma_f32_16x16x32_bf16 v[88:91], a[52:55], v[220:223], v[88:91]
    v_mfma_f32_16x16x32_bf16 v[92:95], a[72:75], v[204:207], 0
    v_mfma_f32_16x16x32_bf16 v[92:95], a[76:79], v[220:223], v[92:95]
    v_mfma_f32_16x16x32_bf16 v[104:107], a[224:227], a[48:51], 0
    v_mfma_f32_16x16x32_bf16 v[104:107], a[228:231], a[52:55], v[104:107]
    v_mfma_f32_16x16x32_bf16 v[104:107], a[232:235], a[56:59], v[104:107]
    v_mfma_f32_16x16x32_bf16 v[104:107], a[236:239], a[60:63], v[104:107]
    v_mfma_f32_16x16x32_bf16 v[104:107], a[240:243], a[64:67], v[104:107]
    v_mfma_f32_16x16x32_bf16 v[104:107], a[244:247], a[68:71], v[104:107]
    v_mfma_f32_16x16x32_bf16 v[108:111], a[224:227], a[72:75], 0
    v_mfma_f32_16x16x32_bf16 v[108:111], a[228:231], a[76:79], v[108:111]
    v_mfma_f32_16x16x32_bf16 v[108:111], a[232:235], a[80:83], v[108:111]
    v_cvt_pk_bf16_f32 v200, v104, v105
    v_cvt_pk_bf16_f32 v201, v106, v107
    v_mfma_f32_16x16x32_bf16 v[108:111], a[236:239], a[84:87], v[108:111]
    v_mfma_f32_16x16x32_bf16 v[108:111], a[240:243], a[88:91], v[108:111]
    ds_read_b128 a[208:211], v1 offset:36864
    v_mfma_f32_16x16x32_bf16 v[108:111], a[244:247], a[92:95], v[108:111]
    s_waitcnt lgkmcnt(1)
    v_mfma_f32_16x16x32_bf16 v[112:115], a[248:251], a[0:3], 0
    ds_read_b128 a[212:215], v1 offset:37888
    v_mfma_f32_16x16x32_bf16 v[112:115], a[252:255], a[4:7], v[112:115]
    v_mfma_f32_16x16x32_bf16 v[112:115], a[192:195], a[8:11], v[112:115]
    buffer_store_dwordx2 v[140:141], v11, s[12:15], s35 offen offset:896 sc1
    v_mfma_f32_16x16x32_bf16 v[112:115], a[196:199], a[12:15], v[112:115]
    ds_read_b128 a[216:219], v1 offset:38912
    v_cvt_pk_bf16_f32 v204, v108, v109
    v_mfma_f32_16x16x32_bf16 v[112:115], a[200:203], a[16:19], v[112:115]
    ds_read_b128 a[220:223], v1 offset:39936
    v_cvt_pk_bf16_f32 v205, v110, v111
    v_mfma_f32_16x16x32_bf16 v[112:115], a[204:207], a[20:23], v[112:115]
    v_mfma_f32_16x16x32_bf16 v[116:119], a[248:251], a[24:27], 0
    ds_read_b128 a[224:227], v1 offset:40960
    v_mfma_f32_16x16x32_bf16 v[116:119], a[252:255], a[28:31], v[116:119]
    v_mfma_f32_16x16x32_bf16 v[116:119], a[192:195], a[32:35], v[116:119]
    ds_read_b128 a[228:231], v1 offset:41984
    v_cvt_pk_bf16_f32 v194, v112, v113
    v_mfma_f32_16x16x32_bf16 v[116:119], a[196:199], a[36:39], v[116:119]
    s_waitcnt vmcnt(13)
    ds_write_b64 v4, a[112:113] offset:0
    v_mfma_f32_16x16x32_bf16 v[116:119], a[200:203], a[40:43], v[116:119]
    ds_write_b64 v4, a[114:115] offset:1024
    v_mfma_f32_16x16x32_bf16 v[116:119], a[204:207], a[44:47], v[116:119]
    s_waitcnt vmcnt(12)
    ds_write_b64 v4, a[116:117] offset:512
    v_mfma_f32_16x16x32_bf16 v[120:123], a[248:251], a[48:51], 0
    ds_write_b64 v4, a[118:119] offset:1536
    v_mfma_f32_16x16x32_bf16 v[120:123], a[252:255], a[52:55], v[120:123]
    ds_read2_b64 a[112:115], v5 offset0:0 offset1:128
    v_cvt_pk_bf16_f32 v195, v114, v115
    v_mfma_f32_16x16x32_bf16 v[120:123], a[192:195], a[56:59], v[120:123]
    ds_read2_b64 a[116:119], v6 offset0:0 offset1:128
    v_cvt_pk_bf16_f32 v198, v116, v117
    v_mfma_f32_16x16x32_bf16 v[120:123], a[196:199], a[60:63], v[120:123]
    v_cvt_pk_bf16_f32 v199, v118, v119
    v_mfma_f32_16x16x32_bf16 v[120:123], a[200:203], a[64:67], v[120:123]
    v_mfma_f32_16x16x32_bf16 v[120:123], a[204:207], a[68:71], v[120:123]
    v_mfma_f32_16x16x32_bf16 v[124:127], a[248:251], a[72:75], 0
    v_mfma_f32_16x16x32_bf16 v[124:127], a[252:255], a[76:79], v[124:127]
    v_mfma_f32_16x16x32_bf16 v[124:127], a[192:195], a[80:83], v[124:127]
    v_cvt_pk_bf16_f32 v202, v120, v121
    v_cvt_pk_bf16_f32 v203, v122, v123
    v_mfma_f32_16x16x32_bf16 v[124:127], a[196:199], a[84:87], v[124:127]
    v_mfma_f32_16x16x32_bf16 v[124:127], a[200:203], a[88:91], v[124:127]
    ds_read_b128 a[232:235], v1 offset:43008
    v_mfma_f32_16x16x32_bf16 v[124:127], a[204:207], a[92:95], v[124:127]
    s_waitcnt lgkmcnt(5)
    v_mfma_f32_16x16x32_bf16 v[96:99], a[208:211], a[0:3], 0
    ds_read_b128 a[236:239], v1 offset:44032
    v_mfma_f32_16x16x32_bf16 v[96:99], a[212:215], a[4:7], v[96:99]
    v_mfma_f32_16x16x32_bf16 v[96:99], a[216:219], a[8:11], v[96:99]
    buffer_load_dwordx4 a[144:147], v9, s[8:11], s28 offen offset:0 nt
    v_cvt_pk_bf16_f32 v206, v124, v125
    v_mfma_f32_16x16x32_bf16 v[96:99], a[220:223], a[12:15], v[96:99]
    buffer_load_dwordx4 a[148:151], v10, s[8:11], s28 offen offset:0 nt
    v_cvt_pk_bf16_f32 v207, v126, v127
    v_mfma_f32_16x16x32_bf16 v[96:99], a[224:227], a[16:19], v[96:99]
    ds_read_b128 a[240:243], v1 offset:45056
    v_mfma_f32_16x16x32_bf16 v[96:99], a[228:231], a[20:23], v[96:99]
    ds_read_b128 a[244:247], v1 offset:46080
    v_mfma_f32_16x16x32_bf16 v[100:103], a[208:211], a[24:27], 0
    buffer_store_dwordx2 v[142:143], v11, s[12:15], s35 offen offset:1280 sc1
    v_mfma_f32_16x16x32_bf16 v[100:103], a[212:215], a[28:31], v[100:103]
    ds_read_b128 a[248:251], v1 offset:47104
    v_mfma_f32_16x16x32_bf16 v[100:103], a[216:219], a[32:35], v[100:103]
    ds_read_b128 a[252:255], v1 offset:48128
    v_cvt_pk_bf16_f32 v208, v96, v97
    v_mfma_f32_16x16x32_bf16 v[100:103], a[220:223], a[36:39], v[100:103]
    v_cvt_pk_bf16_f32 v209, v98, v99
    v_mfma_f32_16x16x32_bf16 v[100:103], a[224:227], a[40:43], v[100:103]
    v_mfma_f32_16x16x32_bf16 v[100:103], a[228:231], a[44:47], v[100:103]
    v_mfma_f32_16x16x32_bf16 v[104:107], a[208:211], a[48:51], 0
    v_mfma_f32_16x16x32_bf16 v[104:107], a[212:215], a[52:55], v[104:107]
    v_mfma_f32_16x16x32_bf16 v[104:107], a[216:219], a[56:59], v[104:107]
    v_cvt_pk_bf16_f32 v212, v100, v101
    v_cvt_pk_bf16_f32 v213, v102, v103
    v_mfma_f32_16x16x32_bf16 v[104:107], a[220:223], a[60:63], v[104:107]
    v_mfma_f32_16x16x32_bf16 v[104:107], a[224:227], a[64:67], v[104:107]
    v_mfma_f32_16x16x32_bf16 v[104:107], a[228:231], a[68:71], v[104:107]
    v_mfma_f32_16x16x32_bf16 v[108:111], a[208:211], a[72:75], 0
    v_mfma_f32_16x16x32_bf16 v[108:111], a[212:215], a[76:79], v[108:111]
    v_mfma_f32_16x16x32_bf16 v[108:111], a[216:219], a[80:83], v[108:111]
    v_cvt_pk_bf16_f32 v216, v104, v105
    v_cvt_pk_bf16_f32 v217, v106, v107
    v_mfma_f32_16x16x32_bf16 v[108:111], a[220:223], a[84:87], v[108:111]
    v_mfma_f32_16x16x32_bf16 v[108:111], a[224:227], a[88:91], v[108:111]
    ds_read_b128 a[192:195], v1 offset:49152
    v_mfma_f32_16x16x32_bf16 v[108:111], a[228:231], a[92:95], v[108:111]
    s_waitcnt lgkmcnt(1)
    v_mfma_f32_16x16x32_bf16 v[112:115], a[232:235], a[0:3], 0
    ds_read_b128 a[196:199], v1 offset:50176
    v_mfma_f32_16x16x32_bf16 v[112:115], a[236:239], a[4:7], v[112:115]
    v_mfma_f32_16x16x32_bf16 v[112:115], a[240:243], a[8:11], v[112:115]
    ds_read_b128 a[200:203], v1 offset:51200
    v_cvt_pk_bf16_f32 v220, v108, v109
    v_mfma_f32_16x16x32_bf16 v[112:115], a[244:247], a[12:15], v[112:115]
    v_cvt_pk_bf16_f32 v221, v110, v111
    v_mfma_f32_16x16x32_bf16 v[112:115], a[248:251], a[16:19], v[112:115]
    ds_read_b128 a[204:207], v1 offset:52224
    v_mfma_f32_16x16x32_bf16 v[112:115], a[252:255], a[20:23], v[112:115]
    s_waitcnt vmcnt(13)
    ds_write_b64 v4, a[120:121] offset:0
    v_mfma_f32_16x16x32_bf16 v[116:119], a[232:235], a[24:27], 0
    ds_read_b128 a[208:211], v1 offset:53248
    v_mfma_f32_16x16x32_bf16 v[116:119], a[236:239], a[28:31], v[116:119]
    ds_write_b64 v4, a[122:123] offset:1024
    v_mfma_f32_16x16x32_bf16 v[116:119], a[240:243], a[32:35], v[116:119]
    buffer_store_dwordx2 v[144:145], v11, s[12:15], s37 offen offset:128 sc1
    v_mfma_f32_16x16x32_bf16 v[116:119], a[244:247], a[36:39], v[116:119]
    ds_read_b128 a[212:215], v1 offset:54272
    v_cvt_pk_bf16_f32 v210, v112, v113
    v_mfma_f32_16x16x32_bf16 v[116:119], a[248:251], a[40:43], v[116:119]
    s_waitcnt vmcnt(13)
    ds_write_b64 v4, a[124:125] offset:512
    v_mfma_f32_16x16x32_bf16 v[116:119], a[252:255], a[44:47], v[116:119]
    ds_write_b64 v4, a[126:127] offset:1536
    v_mfma_f32_16x16x32_bf16 v[120:123], a[232:235], a[48:51], 0
    ds_read2_b64 a[120:123], v5 offset0:0 offset1:128
    v_cvt_pk_bf16_f32 v211, v114, v115
    v_mfma_f32_16x16x32_bf16 v[120:123], a[236:239], a[52:55], v[120:123]
    ds_read2_b64 a[124:127], v6 offset0:0 offset1:128
    v_mfma_f32_16x16x32_bf16 v[120:123], a[240:243], a[56:59], v[120:123]
    v_cvt_pk_bf16_f32 v214, v116, v117
    v_cvt_pk_bf16_f32 v215, v118, v119
    v_mfma_f32_16x16x32_bf16 v[120:123], a[244:247], a[60:63], v[120:123]
    v_mfma_f32_16x16x32_bf16 v[120:123], a[248:251], a[64:67], v[120:123]
    v_mfma_f32_16x16x32_bf16 v[120:123], a[252:255], a[68:71], v[120:123]
    v_mfma_f32_16x16x32_bf16 v[124:127], a[232:235], a[72:75], 0
    v_mfma_f32_16x16x32_bf16 v[124:127], a[236:239], a[76:79], v[124:127]
    v_mfma_f32_16x16x32_bf16 v[124:127], a[240:243], a[80:83], v[124:127]
    v_cvt_pk_bf16_f32 v218, v120, v121
    v_cvt_pk_bf16_f32 v219, v122, v123
    v_mfma_f32_16x16x32_bf16 v[124:127], a[244:247], a[84:87], v[124:127]
    v_mfma_f32_16x16x32_bf16 v[124:127], a[248:251], a[88:91], v[124:127]
    v_mfma_f32_16x16x32_bf16 v[124:127], a[252:255], a[92:95], v[124:127]
    buffer_load_dwordx4 a[152:155], v9, s[8:11], s28 offen offset:128 nt
    s_waitcnt lgkmcnt(4)
    v_mfma_f32_16x16x32_bf16 v[96:99], a[192:195], a[0:3], 0
    buffer_load_dwordx4 a[156:159], v10, s[8:11], s28 offen offset:128 nt
    v_mfma_f32_16x16x32_bf16 v[96:99], a[196:199], a[4:7], v[96:99]
    v_mfma_f32_16x16x32_bf16 v[96:99], a[200:203], a[8:11], v[96:99]
    v_cvt_pk_bf16_f32 v222, v124, v125
    v_cvt_pk_bf16_f32 v223, v126, v127
    v_mfma_f32_16x16x32_bf16 v[96:99], a[204:207], a[12:15], v[96:99]
    v_mfma_f32_16x16x32_bf16 v[96:99], a[208:211], a[16:19], v[96:99]
    v_mfma_f32_16x16x32_bf16 v[96:99], a[212:215], a[20:23], v[96:99]
    v_mfma_f32_16x16x32_bf16 v[100:103], a[192:195], a[24:27], 0
    v_mfma_f32_16x16x32_bf16 v[100:103], a[196:199], a[28:31], v[100:103]
    v_mfma_f32_16x16x32_bf16 v[100:103], a[200:203], a[32:35], v[100:103]
    v_mfma_f32_16x16x32_bf16 v[100:103], a[204:207], a[36:39], v[100:103]
    v_mfma_f32_16x16x32_bf16 v[100:103], a[208:211], a[40:43], v[100:103]
    v_mfma_f32_16x16x32_bf16 v[100:103], a[212:215], a[44:47], v[100:103]
    buffer_store_dwordx2 v[146:147], v11, s[12:15], s37 offen offset:512 sc1
    v_mfma_f32_16x16x32_bf16 v[32:35], a[8:11], v[192:195], v[32:35]
    v_mfma_f32_16x16x32_bf16 v[32:35], a[12:15], v[208:211], v[32:35]
    v_mfma_f32_16x16x32_bf16 v[36:39], a[32:35], v[192:195], v[36:39]
    v_mfma_f32_16x16x32_bf16 v[36:39], a[36:39], v[208:211], v[36:39]
    v_mfma_f32_16x16x32_bf16 v[40:43], a[56:59], v[192:195], v[40:43]
    v_mfma_f32_16x16x32_bf16 v[40:43], a[60:63], v[208:211], v[40:43]
    v_mfma_f32_16x16x32_bf16 v[44:47], a[80:83], v[192:195], v[44:47]
    v_cvt_pk_bf16_f32 v192, v96, v97
    v_cvt_pk_bf16_f32 v193, v98, v99
    v_mfma_f32_16x16x32_bf16 v[44:47], a[84:87], v[208:211], v[44:47]
    buffer_store_dwordx2 v[148:149], v11, s[12:15], s37 offen offset:896 sc1
    v_mfma_f32_16x16x32_bf16 v[48:51], a[8:11], v[196:199], v[48:51]
    v_mfma_f32_16x16x32_bf16 v[48:51], a[12:15], v[212:215], v[48:51]
    v_mfma_f32_16x16x32_bf16 v[52:55], a[32:35], v[196:199], v[52:55]
    v_mfma_f32_16x16x32_bf16 v[52:55], a[36:39], v[212:215], v[52:55]
    v_mfma_f32_16x16x32_bf16 v[56:59], a[56:59], v[196:199], v[56:59]
    v_mfma_f32_16x16x32_bf16 v[56:59], a[60:63], v[212:215], v[56:59]
    v_mfma_f32_16x16x32_bf16 v[60:63], a[80:83], v[196:199], v[60:63]
    s_waitcnt vmcnt(14)
    ds_write_b64 v4, a[128:129] offset:0
    v_mfma_f32_16x16x32_bf16 v[60:63], a[84:87], v[212:215], v[60:63]
    buffer_store_dwordx2 v[150:151], v11, s[12:15], s37 offen offset:1280 sc1
    v_mfma_f32_16x16x32_bf16 v[64:67], a[8:11], v[200:203], v[64:67]
    ds_write_b64 v4, a[130:131] offset:1024
    v_mfma_f32_16x16x32_bf16 v[64:67], a[12:15], v[216:219], v[64:67]
    s_waitcnt vmcnt(14)
    ds_write_b64 v4, a[132:133] offset:512
    v_mfma_f32_16x16x32_bf16 v[68:71], a[32:35], v[200:203], v[68:71]
    ds_read_b128 a[216:219], v1 offset:55296
    v_cvt_pk_bf16_f32 v196, v100, v101
    v_mfma_f32_16x16x32_bf16 v[68:71], a[36:39], v[216:219], v[68:71]
    ds_write_b64 v4, a[134:135] offset:1536
    v_mfma_f32_16x16x32_bf16 v[72:75], a[56:59], v[200:203], v[72:75]
    ds_read_b128 a[220:223], v1 offset:56320
    v_cvt_pk_bf16_f32 v197, v102, v103
    v_mfma_f32_16x16x32_bf16 v[72:75], a[60:63], v[216:219], v[72:75]
    ds_read2_b64 a[128:131], v5 offset0:0 offset1:128
    v_mfma_f32_16x16x32_bf16 v[76:79], a[80:83], v[200:203], v[76:79]
    ds_read_b128 a[224:227], v1 offset:57344
    v_mfma_f32_16x16x32_bf16 v[76:79], a[84:87], v[216:219], v[76:79]
    buffer_store_dwordx2 v[152:153], v11, s[12:15], s39 offen offset:128 sc1
    v_mfma_f32_16x16x32_bf16 v[80:83], a[8:11], v[204:207], v[80:83]
    ds_read_b128 a[228:231], v1 offset:58368
    v_mfma_f32_16x16x32_bf16 v[80:83], a[12:15], v[220:223], v[80:83]
    ds_read2_b64 a[132:135], v6 offset0:0 offset1:128
    v_mfma_f32_16x16x32_bf16 v[84:87], a[32:35], v[204:207], v[84:87]
    ds_read_b128 a[232:235], v1 offset:59392
    v_mfma_f32_16x16x32_bf16 v[84:87], a[36:39], v[220:223], v[84:87]
    v_mfma_f32_16x16x32_bf16 v[88:91], a[56:59], v[204:207], v[88:91]
    ds_read_b128 a[236:239], v1 offset:60416
    v_mfma_f32_16x16x32_bf16 v[88:91], a[60:63], v[220:223], v[88:91]
    v_mfma_f32_16x16x32_bf16 v[92:95], a[80:83], v[204:207], v[92:95]
    v_mfma_f32_16x16x32_bf16 v[92:95], a[84:87], v[220:223], v[92:95]
    buffer_store_dwordx2 v[154:155], v11, s[12:15], s39 offen offset:512 sc1
    v_mfma_f32_16x16x32_bf16 v[104:107], a[192:195], a[48:51], 0
    v_mfma_f32_16x16x32_bf16 v[104:107], a[196:199], a[52:55], v[104:107]
    v_mfma_f32_16x16x32_bf16 v[104:107], a[200:203], a[56:59], v[104:107]
    v_mfma_f32_16x16x32_bf16 v[104:107], a[204:207], a[60:63], v[104:107]
    v_mfma_f32_16x16x32_bf16 v[104:107], a[208:211], a[64:67], v[104:107]
    v_mfma_f32_16x16x32_bf16 v[104:107], a[212:215], a[68:71], v[104:107]
    v_mfma_f32_16x16x32_bf16 v[108:111], a[192:195], a[72:75], 0
    v_mfma_f32_16x16x32_bf16 v[108:111], a[196:199], a[76:79], v[108:111]
    buffer_store_dwordx2 v[156:157], v11, s[12:15], s39 offen offset:896 sc1
    v_mfma_f32_16x16x32_bf16 v[108:111], a[200:203], a[80:83], v[108:111]
    v_cvt_pk_bf16_f32 v200, v104, v105
    v_cvt_pk_bf16_f32 v201, v106, v107
    v_mfma_f32_16x16x32_bf16 v[108:111], a[204:207], a[84:87], v[108:111]
    v_mfma_f32_16x16x32_bf16 v[108:111], a[208:211], a[88:91], v[108:111]
    ds_read_b128 a[240:243], v1 offset:61440
    v_mfma_f32_16x16x32_bf16 v[108:111], a[212:215], a[92:95], v[108:111]
    s_waitcnt lgkmcnt(1)
    v_mfma_f32_16x16x32_bf16 v[112:115], a[216:219], a[0:3], 0
    ds_read_b128 a[244:247], v1 offset:62464
    v_mfma_f32_16x16x32_bf16 v[112:115], a[220:223], a[4:7], v[112:115]
    v_mfma_f32_16x16x32_bf16 v[112:115], a[224:227], a[8:11], v[112:115]
    ds_read_b128 a[248:251], v1 offset:63488
    v_cvt_pk_bf16_f32 v204, v108, v109
    v_mfma_f32_16x16x32_bf16 v[112:115], a[228:231], a[12:15], v[112:115]
    buffer_store_dwordx2 v[158:159], v11, s[12:15], s39 offen offset:1280 sc1
    v_mfma_f32_16x16x32_bf16 v[112:115], a[232:235], a[16:19], v[112:115]
    ds_read_b128 a[252:255], v1 offset:64512
    v_cvt_pk_bf16_f32 v205, v110, v111
    v_mfma_f32_16x16x32_bf16 v[112:115], a[236:239], a[20:23], v[112:115]
    v_mfma_f32_16x16x32_bf16 v[116:119], a[216:219], a[24:27], 0
    ds_read_b128 a[192:195], v2 offset:0
    v_mfma_f32_16x16x32_bf16 v[116:119], a[220:223], a[28:31], v[116:119]
    v_mfma_f32_16x16x32_bf16 v[116:119], a[224:227], a[32:35], v[116:119]
    ds_read_b128 a[196:199], v2 offset:1024
    v_cvt_pk_bf16_f32 v194, v112, v113
    v_mfma_f32_16x16x32_bf16 v[116:119], a[228:231], a[36:39], v[116:119]
    v_cvt_pk_bf16_f32 v195, v114, v115
    v_mfma_f32_16x16x32_bf16 v[116:119], a[232:235], a[40:43], v[116:119]
    v_mfma_f32_16x16x32_bf16 v[116:119], a[236:239], a[44:47], v[116:119]
    buffer_store_dwordx2 v[160:161], v11, s[12:15], s33 offen offset:256 sc1
    v_mfma_f32_16x16x32_bf16 v[120:123], a[216:219], a[48:51], 0
    v_mfma_f32_16x16x32_bf16 v[120:123], a[220:223], a[52:55], v[120:123]
    v_mfma_f32_16x16x32_bf16 v[120:123], a[224:227], a[56:59], v[120:123]
    v_cvt_pk_bf16_f32 v198, v116, v117
    v_cvt_pk_bf16_f32 v199, v118, v119
    v_mfma_f32_16x16x32_bf16 v[120:123], a[228:231], a[60:63], v[120:123]
    s_waitcnt vmcnt(16)
    ds_write_b64 v4, a[136:137] offset:0
    v_mfma_f32_16x16x32_bf16 v[120:123], a[232:235], a[64:67], v[120:123]
    ds_write_b64 v4, a[138:139] offset:1024
    v_mfma_f32_16x16x32_bf16 v[120:123], a[236:239], a[68:71], v[120:123]
    s_waitcnt vmcnt(15)
    ds_write_b64 v4, a[140:141] offset:512
    v_mfma_f32_16x16x32_bf16 v[124:127], a[216:219], a[72:75], 0
    ds_write_b64 v4, a[142:143] offset:1536
    v_mfma_f32_16x16x32_bf16 v[124:127], a[220:223], a[76:79], v[124:127]
    buffer_store_dwordx2 v[162:163], v11, s[12:15], s33 offen offset:640 sc1
    v_mfma_f32_16x16x32_bf16 v[124:127], a[224:227], a[80:83], v[124:127]
    ds_read2_b64 a[136:139], v5 offset0:0 offset1:128
    v_cvt_pk_bf16_f32 v202, v120, v121
    v_mfma_f32_16x16x32_bf16 v[124:127], a[228:231], a[84:87], v[124:127]
    ds_read2_b64 a[140:143], v6 offset0:0 offset1:128
    v_cvt_pk_bf16_f32 v203, v122, v123
    v_mfma_f32_16x16x32_bf16 v[124:127], a[232:235], a[88:91], v[124:127]
    ds_read_b128 a[200:203], v2 offset:2048
    v_mfma_f32_16x16x32_bf16 v[124:127], a[236:239], a[92:95], v[124:127]
    s_waitcnt lgkmcnt(7)
    v_mfma_f32_16x16x32_bf16 v[96:99], a[240:243], a[0:3], 0
    ds_read_b128 a[204:207], v2 offset:3072
    v_mfma_f32_16x16x32_bf16 v[96:99], a[244:247], a[4:7], v[96:99]
    v_mfma_f32_16x16x32_bf16 v[96:99], a[248:251], a[8:11], v[96:99]
    ds_read_b128 a[208:211], v2 offset:4096
    v_cvt_pk_bf16_f32 v206, v124, v125
    v_mfma_f32_16x16x32_bf16 v[96:99], a[252:255], a[12:15], v[96:99]
    buffer_store_dwordx2 v[164:165], v11, s[12:15], s33 offen offset:1024 sc1
    v_mfma_f32_16x16x32_bf16 v[96:99], a[192:195], a[16:19], v[96:99]
    ds_read_b128 a[212:215], v2 offset:5120
    v_cvt_pk_bf16_f32 v207, v126, v127
    v_mfma_f32_16x16x32_bf16 v[96:99], a[196:199], a[20:23], v[96:99]
    v_mfma_f32_16x16x32_bf16 v[100:103], a[240:243], a[24:27], 0
    ds_read_b128 a[216:219], v2 offset:6144
    v_mfma_f32_16x16x32_bf16 v[100:103], a[244:247], a[28:31], v[100:103]
    v_mfma_f32_16x16x32_bf16 v[100:103], a[248:251], a[32:35], v[100:103]
    ds_read_b128 a[220:223], v2 offset:7168
    v_cvt_pk_bf16_f32 v208, v96, v97
    v_mfma_f32_16x16x32_bf16 v[100:103], a[252:255], a[36:39], v[100:103]
    v_cvt_pk_bf16_f32 v209, v98, v99
    v_mfma_f32_16x16x32_bf16 v[100:103], a[192:195], a[40:43], v[100:103]
    v_mfma_f32_16x16x32_bf16 v[100:103], a[196:199], a[44:47], v[100:103]
    buffer_store_dwordx2 v[166:167], v11, s[12:15], s33 offen offset:1408 sc1
    v_mfma_f32_16x16x32_bf16 v[104:107], a[240:243], a[48:51], 0
    v_mfma_f32_16x16x32_bf16 v[104:107], a[244:247], a[52:55], v[104:107]
    v_mfma_f32_16x16x32_bf16 v[104:107], a[248:251], a[56:59], v[104:107]
    v_cvt_pk_bf16_f32 v212, v100, v101
    v_cvt_pk_bf16_f32 v213, v102, v103
    v_mfma_f32_16x16x32_bf16 v[104:107], a[252:255], a[60:63], v[104:107]
    v_mfma_f32_16x16x32_bf16 v[104:107], a[192:195], a[64:67], v[104:107]
    v_mfma_f32_16x16x32_bf16 v[104:107], a[196:199], a[68:71], v[104:107]
    v_mfma_f32_16x16x32_bf16 v[108:111], a[240:243], a[72:75], 0
    v_mfma_f32_16x16x32_bf16 v[108:111], a[244:247], a[76:79], v[108:111]
    buffer_store_dwordx2 v[168:169], v11, s[12:15], s35 offen offset:256 sc1
    v_mfma_f32_16x16x32_bf16 v[108:111], a[248:251], a[80:83], v[108:111]
    v_cvt_pk_bf16_f32 v216, v104, v105
    v_cvt_pk_bf16_f32 v217, v106, v107
    v_mfma_f32_16x16x32_bf16 v[108:111], a[252:255], a[84:87], v[108:111]
    v_mfma_f32_16x16x32_bf16 v[108:111], a[192:195], a[88:91], v[108:111]
    ds_read_b128 a[224:227], v2 offset:8192
    v_mfma_f32_16x16x32_bf16 v[108:111], a[196:199], a[92:95], v[108:111]
    s_waitcnt lgkmcnt(1)
    v_mfma_f32_16x16x32_bf16 v[112:115], a[200:203], a[0:3], 0
    ds_read_b128 a[228:231], v2 offset:9216
    v_mfma_f32_16x16x32_bf16 v[112:115], a[204:207], a[4:7], v[112:115]
    v_mfma_f32_16x16x32_bf16 v[112:115], a[208:211], a[8:11], v[112:115]
    ds_read_b128 a[232:235], v2 offset:10240
    v_cvt_pk_bf16_f32 v220, v108, v109
    v_mfma_f32_16x16x32_bf16 v[112:115], a[212:215], a[12:15], v[112:115]
    buffer_store_dwordx2 v[170:171], v11, s[12:15], s35 offen offset:640 sc1
    v_mfma_f32_16x16x32_bf16 v[112:115], a[216:219], a[16:19], v[112:115]
    ds_read_b128 a[236:239], v2 offset:11264
    v_cvt_pk_bf16_f32 v221, v110, v111
    v_mfma_f32_16x16x32_bf16 v[112:115], a[220:223], a[20:23], v[112:115]
    v_mfma_f32_16x16x32_bf16 v[116:119], a[200:203], a[24:27], 0
    ds_read_b128 a[240:243], v2 offset:12288
    v_mfma_f32_16x16x32_bf16 v[116:119], a[204:207], a[28:31], v[116:119]
    v_mfma_f32_16x16x32_bf16 v[116:119], a[208:211], a[32:35], v[116:119]
    ds_read_b128 a[244:247], v2 offset:13312
    v_cvt_pk_bf16_f32 v210, v112, v113
    v_mfma_f32_16x16x32_bf16 v[116:119], a[212:215], a[36:39], v[116:119]
    v_cvt_pk_bf16_f32 v211, v114, v115
    v_mfma_f32_16x16x32_bf16 v[116:119], a[216:219], a[40:43], v[116:119]
    v_mfma_f32_16x16x32_bf16 v[116:119], a[220:223], a[44:47], v[116:119]
    buffer_store_dwordx2 v[172:173], v11, s[12:15], s35 offen offset:1024 sc1
    v_mfma_f32_16x16x32_bf16 v[120:123], a[200:203], a[48:51], 0
    s_waitcnt vmcnt(19)
    ds_write_b64 v4, a[144:145] offset:0
    v_mfma_f32_16x16x32_bf16 v[120:123], a[204:207], a[52:55], v[120:123]
    ds_write_b64 v4, a[146:147] offset:1024
    v_mfma_f32_16x16x32_bf16 v[120:123], a[208:211], a[56:59], v[120:123]
    s_waitcnt vmcnt(18)
    ds_write_b64 v4, a[148:149] offset:512
    v_mfma_f32_16x16x32_bf16 v[120:123], a[212:215], a[60:63], v[120:123]
    ds_write_b64 v4, a[150:151] offset:1536
    v_mfma_f32_16x16x32_bf16 v[120:123], a[216:219], a[64:67], v[120:123]
    ds_read2_b64 a[144:147], v5 offset0:0 offset1:128
    v_cvt_pk_bf16_f32 v214, v116, v117
    v_mfma_f32_16x16x32_bf16 v[120:123], a[220:223], a[68:71], v[120:123]
    ds_read2_b64 a[148:151], v6 offset0:0 offset1:128
    v_cvt_pk_bf16_f32 v215, v118, v119
    v_mfma_f32_16x16x32_bf16 v[124:127], a[200:203], a[72:75], 0
    v_mfma_f32_16x16x32_bf16 v[124:127], a[204:207], a[76:79], v[124:127]
    buffer_store_dwordx2 v[174:175], v11, s[12:15], s35 offen offset:1408 sc1
    v_mfma_f32_16x16x32_bf16 v[124:127], a[208:211], a[80:83], v[124:127]
    v_cvt_pk_bf16_f32 v218, v120, v121
    v_cvt_pk_bf16_f32 v219, v122, v123
    v_mfma_f32_16x16x32_bf16 v[124:127], a[212:215], a[84:87], v[124:127]
    v_mfma_f32_16x16x32_bf16 v[124:127], a[216:219], a[88:91], v[124:127]
    v_mfma_f32_16x16x32_bf16 v[124:127], a[220:223], a[92:95], v[124:127]
    s_waitcnt lgkmcnt(6)
    v_mfma_f32_16x16x32_bf16 v[96:99], a[0:3], a[224:227], 0
    v_mfma_f32_16x16x32_bf16 v[96:99], a[4:7], a[228:231], v[96:99]
    v_mfma_f32_16x16x32_bf16 v[96:99], a[8:11], a[232:235], v[96:99]
    v_cvt_pk_bf16_f32 v222, v124, v125
    v_cvt_pk_bf16_f32 v223, v126, v127
    v_mfma_f32_16x16x32_bf16 v[96:99], a[12:15], a[236:239], v[96:99]
    buffer_store_dwordx2 v[176:177], v11, s[12:15], s37 offen offset:256 sc1
    v_mfma_f32_16x16x32_bf16 v[96:99], a[16:19], a[240:243], v[96:99]
    v_mfma_f32_16x16x32_bf16 v[96:99], a[20:23], a[244:247], v[96:99]
    v_mfma_f32_16x16x32_bf16 v[100:103], a[24:27], a[224:227], 0
    v_mfma_f32_16x16x32_bf16 v[100:103], a[28:31], a[228:231], v[100:103]
    v_mfma_f32_16x16x32_bf16 v[100:103], a[32:35], a[232:235], v[100:103]
    v_cvt_pk_bf16_f32 v128, v96, v97
    v_cvt_pk_bf16_f32 v129, v98, v99
    v_mfma_f32_16x16x32_bf16 v[100:103], a[36:39], a[236:239], v[100:103]
    v_mfma_f32_16x16x32_bf16 v[100:103], a[40:43], a[240:243], v[100:103]
    v_mfma_f32_16x16x32_bf16 v[100:103], a[44:47], a[244:247], v[100:103]
    buffer_store_dwordx2 v[178:179], v11, s[12:15], s37 offen offset:640 sc1
    v_mfma_f32_16x16x32_bf16 v[32:35], a[16:19], v[192:195], v[32:35]
    v_mfma_f32_16x16x32_bf16 v[32:35], a[20:23], v[208:211], v[32:35]
    v_mfma_f32_16x16x32_bf16 v[36:39], a[40:43], v[192:195], v[36:39]
    v_cvt_pk_bf16_f32 v130, v100, v101
    v_cvt_pk_bf16_f32 v131, v102, v103
    v_mfma_f32_16x16x32_bf16 v[36:39], a[44:47], v[208:211], v[36:39]
    v_mfma_f32_16x16x32_bf16 v[40:43], a[64:67], v[192:195], v[40:43]
    v_max3_f32 v12, v32, v33, v34
    v_mfma_f32_16x16x32_bf16 v[40:43], a[68:71], v[208:211], v[40:43]
    v_mfma_f32_16x16x32_bf16 v[44:47], a[88:91], v[192:195], v[44:47]
    v_max3_f32 v12, v12, v35, v36
    v_max3_f32 v12, v12, v37, v38
    v_mfma_f32_16x16x32_bf16 v[44:47], a[92:95], v[208:211], v[44:47]
    buffer_store_dwordx2 v[180:181], v11, s[12:15], s37 offen offset:1024 sc1
    v_mfma_f32_16x16x32_bf16 v[48:51], a[16:19], v[196:199], v[48:51]
    v_max3_f32 v12, v12, v39, v40
    v_max3_f32 v12, v12, v41, v42
    v_mfma_f32_16x16x32_bf16 v[48:51], a[20:23], v[212:215], v[48:51]
    v_mfma_f32_16x16x32_bf16 v[52:55], a[40:43], v[196:199], v[52:55]
    v_max3_f32 v12, v12, v43, v44
    v_max3_f32 v12, v12, v45, v46
    v_mfma_f32_16x16x32_bf16 v[52:55], a[44:47], v[212:215], v[52:55]
    v_max_f32 v12, v12, v47
    v_mfma_f32_16x16x32_bf16 v[56:59], a[64:67], v[196:199], v[56:59]
    v_max3_f32 v13, v48, v49, v50
    v_mfma_f32_16x16x32_bf16 v[56:59], a[68:71], v[212:215], v[56:59]
    v_mfma_f32_16x16x32_bf16 v[60:63], a[88:91], v[196:199], v[60:63]
    s_waitcnt vmcnt(19)
    ds_write_b64 v4, a[152:153] offset:0
    v_mfma_f32_16x16x32_bf16 v[60:63], a[92:95], v[212:215], v[60:63]
    buffer_store_dwordx2 v[182:183], v11, s[12:15], s37 offen offset:1408 sc1
    v_mfma_f32_16x16x32_bf16 v[64:67], a[16:19], v[200:203], v[64:67]
    ds_write_b64 v4, a[154:155] offset:1024
    v_mfma_f32_16x16x32_bf16 v[64:67], a[20:23], v[216:219], v[64:67]
    s_waitcnt vmcnt(19)
    ds_write_b64 v4, a[156:157] offset:512
    v_mfma_f32_16x16x32_bf16 v[68:71], a[40:43], v[200:203], v[68:71]
    ds_read_b128 a[248:251], v2 offset:14336
    v_max3_f32 v13, v13, v51, v52
    v_mfma_f32_16x16x32_bf16 v[68:71], a[44:47], v[216:219], v[68:71]
    ds_write_b64 v4, a[158:159] offset:1536
    v_mfma_f32_16x16x32_bf16 v[72:75], a[64:67], v[200:203], v[72:75]
    ds_read_b128 a[252:255], v2 offset:15360
    v_max3_f32 v14, v64, v65, v66
    v_mfma_f32_16x16x32_bf16 v[72:75], a[68:71], v[216:219], v[72:75]
    ds_read2_b64 a[152:155], v5 offset0:0 offset1:128
    v_max3_f32 v13, v13, v53, v54
    v_mfma_f32_16x16x32_bf16 v[76:79], a[88:91], v[200:203], v[76:79]
    ds_read_b128 a[192:195], v2 offset:16384
    v_max3_f32 v14, v14, v67, v68
    v_mfma_f32_16x16x32_bf16 v[76:79], a[92:95], v[216:219], v[76:79]
    buffer_store_dwordx2 v[184:185], v11, s[12:15], s39 offen offset:256 sc1
    v_mfma_f32_16x16x32_bf16 v[80:83], a[16:19], v[204:207], v[80:83]
    ds_read_b128 a[196:199], v2 offset:17408
    v_max3_f32 v14, v14, v69, v70
    v_mfma_f32_16x16x32_bf16 v[80:83], a[20:23], v[220:223], v[80:83]
    ds_read2_b64 a[156:159], v6 offset0:0 offset1:128
    v_max3_f32 v13, v13, v55, v56
    v_mfma_f32_16x16x32_bf16 v[84:87], a[40:43], v[204:207], v[84:87]
    ds_read_b128 a[200:203], v2 offset:18432
    v_max3_f32 v14, v14, v71, v72
    v_mfma_f32_16x16x32_bf16 v[84:87], a[44:47], v[220:223], v[84:87]
    v_max3_f32 v13, v13, v57, v58
    v_max3_f32 v14, v14, v73, v74
    v_mfma_f32_16x16x32_bf16 v[88:91], a[64:67], v[204:207], v[88:91]
    ds_read_b128 a[204:207], v2 offset:19456
    v_max3_f32 v15, v80, v81, v82
    v_mfma_f32_16x16x32_bf16 v[88:91], a[68:71], v[220:223], v[88:91]
    v_max3_f32 v13, v13, v59, v60
    v_max3_f32 v14, v14, v75, v76
    v_mfma_f32_16x16x32_bf16 v[92:95], a[88:91], v[204:207], v[92:95]
    v_max3_f32 v15, v15, v83, v84
    v_max3_f32 v15, v15, v85, v86
    v_mfma_f32_16x16x32_bf16 v[92:95], a[92:95], v[220:223], v[92:95]
    buffer_store_dwordx2 v[186:187], v11, s[12:15], s39 offen offset:640 sc1
    v_mfma_f32_16x16x32_bf16 v[104:107], a[48:51], a[224:227], 0
    v_max3_f32 v15, v15, v87, v88
    v_max3_f32 v15, v15, v89, v90
    v_mfma_f32_16x16x32_bf16 v[104:107], a[52:55], a[228:231], v[104:107]
    v_max3_f32 v13, v13, v61, v62
    v_max3_f32 v14, v14, v77, v78
    v_mfma_f32_16x16x32_bf16 v[104:107], a[56:59], a[232:235], v[104:107]
    v_max3_f32 v15, v15, v91, v92
    v_max3_f32 v15, v15, v93, v94
    v_mfma_f32_16x16x32_bf16 v[104:107], a[60:63], a[236:239], v[104:107]
    v_max_f32 v13, v13, v63
    v_max_f32 v14, v14, v79
    v_mfma_f32_16x16x32_bf16 v[104:107], a[64:67], a[240:243], v[104:107]
    v_max_f32 v15, v15, v95
    v_permlane16_swap_b32 v12, v13
    v_mfma_f32_16x16x32_bf16 v[104:107], a[68:71], a[244:247], v[104:107]
    v_permlane16_swap_b32 v14, v15
    v_max_f32 v12, v12, v13
    v_mfma_f32_16x16x32_bf16 v[108:111], a[72:75], a[224:227], 0
    v_max_f32 v14, v14, v15
    v_mfma_f32_16x16x32_bf16 v[108:111], a[76:79], a[228:231], v[108:111]
    buffer_store_dwordx2 v[188:189], v11, s[12:15], s39 offen offset:1024 sc1
    v_mfma_f32_16x16x32_bf16 v[108:111], a[80:83], a[232:235], v[108:111]
    v_cvt_pk_bf16_f32 v132, v104, v105
    v_cvt_pk_bf16_f32 v133, v106, v107
    v_mfma_f32_16x16x32_bf16 v[108:111], a[84:87], a[236:239], v[108:111]
    v_permlane32_swap_b32 v12, v14
    v_max_f32 v12, v12, v14
    v_mfma_f32_16x16x32_bf16 v[108:111], a[88:91], a[240:243], v[108:111]
    ds_read_b128 a[208:211], v2 offset:20480
    v_mov_b32 v14, v12
    v_mfma_f32_16x16x32_bf16 v[108:111], a[92:95], a[244:247], v[108:111]
    s_waitcnt lgkmcnt(1)
    v_mfma_f32_16x16x32_bf16 v[112:115], a[0:3], a[248:251], 0
    ds_read_b128 a[212:215], v2 offset:21504
    v_permlane32_swap_b32 v12, v14
    v_mfma_f32_16x16x32_bf16 v[112:115], a[4:7], a[252:255], v[112:115]
    v_mov_b32 v13, v12
    v_mov_b32 v15, v14
    v_mfma_f32_16x16x32_bf16 v[112:115], a[8:11], a[192:195], v[112:115]
    ds_read_b128 a[216:219], v2 offset:22528
    v_cvt_pk_bf16_f32 v134, v108, v109
    v_mfma_f32_16x16x32_bf16 v[112:115], a[12:15], a[196:199], v[112:115]
    v_cvt_pk_bf16_f32 v135, v110, v111
    v_permlane16_swap_b32 v12, v13
    v_mfma_f32_16x16x32_bf16 v[112:115], a[16:19], a[200:203], v[112:115]
    buffer_load_dwordx4 a[160:163], v9, s[8:11], s28 offen offset:256 nt
    v_permlane16_swap_b32 v14, v15
    v_mfma_f32_16x16x32_bf16 v[112:115], a[20:23], a[204:207], v[112:115]
    buffer_load_dwordx4 a[164:167], v10, s[8:11], s28 offen offset:256 nt
    v_sub_f32 v32, v32, v12
    v_mfma_f32_16x16x32_bf16 v[116:119], a[24:27], a[248:251], 0
    ds_read_b128 a[220:223], v2 offset:23552
    v_sub_f32 v33, v33, v12
    v_mfma_f32_16x16x32_bf16 v[116:119], a[28:31], a[252:255], v[116:119]
    ds_read_b128 a[224:227], v2 offset:24576
    v_sub_f32 v48, v48, v13
    v_mfma_f32_16x16x32_bf16 v[116:119], a[32:35], a[192:195], v[116:119]
    ds_read_b128 a[228:231], v2 offset:25600
    v_cvt_pk_bf16_f32 v136, v112, v113
    v_mfma_f32_16x16x32_bf16 v[116:119], a[36:39], a[196:199], v[116:119]
    v_cvt_pk_bf16_f32 v137, v114, v115
    v_sub_f32 v49, v49, v13
    v_mfma_f32_16x16x32_bf16 v[116:119], a[40:43], a[200:203], v[116:119]
    v_sub_f32 v64, v64, v14
    v_sub_f32 v65, v65, v14
    v_mfma_f32_16x16x32_bf16 v[116:119], a[44:47], a[204:207], v[116:119]
    v_sub_f32 v80, v80, v15
    v_sub_f32 v81, v81, v15
    v_mfma_f32_16x16x32_bf16 v[120:123], a[48:51], a[248:251], 0
    v_exp_f32 v32, v32
    v_mfma_f32_16x16x32_bf16 v[120:123], a[52:55], a[252:255], v[120:123]
    v_exp_f32 v33, v33
    v_mfma_f32_16x16x32_bf16 v[120:123], a[56:59], a[192:195], v[120:123]
    buffer_store_dwordx2 v[190:191], v11, s[12:15], s39 offen offset:1408 sc1
    v_mfma_f32_16x16x32_bf16 v[120:123], a[60:63], a[196:199], v[120:123]
    v_cvt_pk_bf16_f32 v138, v116, v117
    v_cvt_pk_bf16_f32 v139, v118, v119
    v_mfma_f32_16x16x32_bf16 v[120:123], a[64:67], a[200:203], v[120:123]
    v_sub_f32 v34, v34, v12
    v_sub_f32 v50, v50, v13
    v_mfma_f32_16x16x32_bf16 v[120:123], a[68:71], a[204:207], v[120:123]
    v_exp_f32 v48, v48
    v_mfma_f32_16x16x32_bf16 v[124:127], a[72:75], a[248:251], 0
    v_exp_f32 v49, v49
    v_mfma_f32_16x16x32_bf16 v[124:127], a[76:79], a[252:255], v[124:127]
    v_exp_f32 v64, v64
    v_mfma_f32_16x16x32_bf16 v[124:127], a[80:83], a[192:195], v[124:127]
    v_cvt_pk_bf16_f32 v140, v120, v121
    v_cvt_pk_bf16_f32 v141, v122, v123
    v_mfma_f32_16x16x32_bf16 v[124:127], a[84:87], a[196:199], v[124:127]
    v_exp_f32 v65, v65
    v_mfma_f32_16x16x32_bf16 v[124:127], a[88:91], a[200:203], v[124:127]
    ds_read_b128 a[232:235], v2 offset:26624
    v_sub_f32 v66, v66, v14
    v_mfma_f32_16x16x32_bf16 v[124:127], a[92:95], a[204:207], v[124:127]
    v_sub_f32 v82, v82, v15
    s_waitcnt lgkmcnt(1)
    v_mfma_f32_16x16x32_bf16 v[96:99], a[0:3], a[208:211], 0
    ds_read_b128 a[236:239], v2 offset:27648
    v_sub_f32 v35, v35, v12
    v_mfma_f32_16x16x32_bf16 v[96:99], a[4:7], a[212:215], v[96:99]
    v_exp_f32 v80, v80
    v_mfma_f32_16x16x32_bf16 v[96:99], a[8:11], a[216:219], v[96:99]
    ds_read_b128 a[240:243], v2 offset:28672
    v_cvt_pk_bf16_f32 v142, v124, v125
    v_mfma_f32_16x16x32_bf16 v[96:99], a[12:15], a[220:223], v[96:99]
    v_cvt_pk_bf16_f32 v143, v126, v127
    v_sub_f32 v51, v51, v13
    v_mfma_f32_16x16x32_bf16 v[96:99], a[16:19], a[224:227], v[96:99]
    ds_read_b128 a[244:247], v2 offset:29696
    v_sub_f32 v67, v67, v14
    v_mfma_f32_16x16x32_bf16 v[96:99], a[20:23], a[228:231], v[96:99]
    v_exp_f32 v81, v81
    v_mfma_f32_16x16x32_bf16 v[100:103], a[24:27], a[208:211], 0
    ds_read_b128 a[248:251], v2 offset:30720
    v_sub_f32 v83, v83, v15
    v_mfma_f32_16x16x32_bf16 v[100:103], a[28:31], a[212:215], v[100:103]
    v_exp_f32 v34, v34
    v_mfma_f32_16x16x32_bf16 v[100:103], a[32:35], a[216:219], v[100:103]
    ds_read_b128 a[252:255], v2 offset:31744
    v_cvt_pk_bf16_f32 v144, v96, v97
    v_mfma_f32_16x16x32_bf16 v[100:103], a[36:39], a[220:223], v[100:103]
    v_cvt_pk_bf16_f32 v145, v98, v99
    v_sub_f32 v36, v36, v12
    v_mfma_f32_16x16x32_bf16 v[100:103], a[40:43], a[224:227], v[100:103]
    v_exp_f32 v50, v50
    v_mfma_f32_16x16x32_bf16 v[100:103], a[44:47], a[228:231], v[100:103]
    v_exp_f32 v66, v66
    v_mfma_f32_16x16x32_bf16 v[104:107], a[48:51], a[208:211], 0
    v_exp_f32 v82, v82
    v_mfma_f32_16x16x32_bf16 v[104:107], a[52:55], a[212:215], v[104:107]
    v_exp_f32 v35, v35
    v_mfma_f32_16x16x32_bf16 v[104:107], a[56:59], a[216:219], v[104:107]
    v_cvt_pk_bf16_f32 v146, v100, v101
    v_cvt_pk_bf16_f32 v147, v102, v103
    v_mfma_f32_16x16x32_bf16 v[104:107], a[60:63], a[220:223], v[104:107]
    v_exp_f32 v51, v51
    v_mfma_f32_16x16x32_bf16 v[104:107], a[64:67], a[224:227], v[104:107]
    v_sub_f32 v52, v52, v13
    v_sub_f32 v68, v68, v14
    v_mfma_f32_16x16x32_bf16 v[104:107], a[68:71], a[228:231], v[104:107]
    v_exp_f32 v67, v67
    v_mfma_f32_16x16x32_bf16 v[108:111], a[72:75], a[208:211], 0
    v_exp_f32 v83, v83
    v_mfma_f32_16x16x32_bf16 v[108:111], a[76:79], a[212:215], v[108:111]
    v_sub_f32 v84, v84, v15
    v_add_f32 v20, v32, v33
    v_mfma_f32_16x16x32_bf16 v[108:111], a[80:83], a[216:219], v[108:111]
    buffer_store_dwordx2 v[224:225], v11, s[12:15], s33 offen offset:0 sc1
    v_mfma_f32_16x16x32_bf16 v[108:111], a[84:87], a[220:223], v[108:111]
    v_cvt_pk_bf16_f32 v148, v104, v105
    v_cvt_pk_bf16_f32 v149, v106, v107
    v_mfma_f32_16x16x32_bf16 v[108:111], a[88:91], a[224:227], v[108:111]
    ds_read_b128 a[192:195], v2 offset:32768
    v_sub_f32 v37, v37, v12
    v_mfma_f32_16x16x32_bf16 v[108:111], a[92:95], a[228:231], v[108:111]
    v_add_f32 v21, v48, v49
    s_waitcnt lgkmcnt(1)
    v_mfma_f32_16x16x32_bf16 v[112:115], a[0:3], a[232:235], 0
    ds_read_b128 a[196:199], v2 offset:33792
    v_sub_f32 v53, v53, v13
    v_mfma_f32_16x16x32_bf16 v[112:115], a[4:7], a[236:239], v[112:115]
    buffer_load_dwordx4 a[168:171], v9, s[8:11], s30 offen offset:0 nt
    v_add_f32 v22, v64, v65
    v_mfma_f32_16x16x32_bf16 v[112:115], a[8:11], a[240:243], v[112:115]
    buffer_load_dwordx4 a[172:175], v10, s[8:11], s30 offen offset:0 nt
    v_cvt_pk_bf16_f32 v150, v108, v109
    v_mfma_f32_16x16x32_bf16 v[112:115], a[12:15], a[244:247], v[112:115]
    ds_read_b128 a[200:203], v2 offset:34816
    v_cvt_pk_bf16_f32 v151, v110, v111
    v_mfma_f32_16x16x32_bf16 v[112:115], a[16:19], a[248:251], v[112:115]
    ds_read_b128 a[204:207], v2 offset:35840
    v_sub_f32 v69, v69, v14
    v_mfma_f32_16x16x32_bf16 v[112:115], a[20:23], a[252:255], v[112:115]
    v_exp_f32 v36, v36
    v_mfma_f32_16x16x32_bf16 v[116:119], a[24:27], a[232:235], 0
    ds_read_b128 a[208:211], v2 offset:36864
    v_add_f32 v23, v80, v81
    v_mfma_f32_16x16x32_bf16 v[116:119], a[28:31], a[236:239], v[116:119]
    v_exp_f32 v52, v52
    v_mfma_f32_16x16x32_bf16 v[116:119], a[32:35], a[240:243], v[116:119]
    ds_read_b128 a[212:215], v2 offset:37888
    v_cvt_pk_bf16_f32 v152, v112, v113
    v_mfma_f32_16x16x32_bf16 v[116:119], a[36:39], a[244:247], v[116:119]
    v_cvt_pk_bf16_f32 v153, v114, v115
    v_sub_f32 v85, v85, v15
    v_mfma_f32_16x16x32_bf16 v[116:119], a[40:43], a[248:251], v[116:119]
    v_exp_f32 v68, v68
    v_mfma_f32_16x16x32_bf16 v[116:119], a[44:47], a[252:255], v[116:119]
    v_exp_f32 v84, v84
    v_mfma_f32_16x16x32_bf16 v[120:123], a[48:51], a[232:235], 0
    v_add_f32 v20, v20, v34
    v_sub_f32 v38, v38, v12
    v_mfma_f32_16x16x32_bf16 v[120:123], a[52:55], a[236:239], v[120:123]
    v_exp_f32 v37, v37
    v_mfma_f32_16x16x32_bf16 v[120:123], a[56:59], a[240:243], v[120:123]
    v_cvt_pk_bf16_f32 v154, v116, v117
    v_cvt_pk_bf16_f32 v155, v118, v119
    v_mfma_f32_16x16x32_bf16 v[120:123], a[60:63], a[244:247], v[120:123]
    v_add_f32 v21, v21, v50
    v_sub_f32 v54, v54, v13
    v_mfma_f32_16x16x32_bf16 v[120:123], a[64:67], a[248:251], v[120:123]
    v_exp_f32 v53, v53
    v_mfma_f32_16x16x32_bf16 v[120:123], a[68:71], a[252:255], v[120:123]
    v_add_f32 v22, v22, v66
    v_sub_f32 v70, v70, v14
    v_mfma_f32_16x16x32_bf16 v[124:127], a[72:75], a[232:235], 0
    v_exp_f32 v69, v69
    v_mfma_f32_16x16x32_bf16 v[124:127], a[76:79], a[236:239], v[124:127]
    v_add_f32 v23, v23, v82
    v_sub_f32 v86, v86, v15
    v_mfma_f32_16x16x32_bf16 v[124:127], a[80:83], a[240:243], v[124:127]
    v_cvt_pk_bf16_f32 v156, v120, v121
    v_cvt_pk_bf16_f32 v157, v122, v123
    v_mfma_f32_16x16x32_bf16 v[124:127], a[84:87], a[244:247], v[124:127]
    v_exp_f32 v85, v85
    v_mfma_f32_16x16x32_bf16 v[124:127], a[88:91], a[248:251], v[124:127]
    ds_read_b128 a[216:219], v2 offset:38912
    v_add_f32 v20, v20, v35
    v_mfma_f32_16x16x32_bf16 v[124:127], a[92:95], a[252:255], v[124:127]
    v_sub_f32 v39, v39, v12
    s_waitcnt lgkmcnt(1)
    v_mfma_f32_16x16x32_bf16 v[96:99], a[0:3], a[192:195], 0
    ds_read_b128 a[220:223], v2 offset:39936
    v_add_f32 v21, v21, v51
    v_mfma_f32_16x16x32_bf16 v[96:99], a[4:7], a[196:199], v[96:99]
    v_exp_f32 v38, v38
    v_mfma_f32_16x16x32_bf16 v[96:99], a[8:11], a[200:203], v[96:99]
    buffer_store_dwordx2 v[226:227], v11, s[12:15], s33 offen offset:384 sc1
    v_mfma_f32_16x16x32_bf16 v[96:99], a[12:15], a[204:207], v[96:99]
    ds_read_b128 a[224:227], v2 offset:40960
    v_cvt_pk_bf16_f32 v158, v124, v125
    v_mfma_f32_16x16x32_bf16 v[96:99], a[16:19], a[208:211], v[96:99]
    ds_read_b128 a[228:231], v2 offset:41984
    v_cvt_pk_bf16_f32 v159, v126, v127
    v_mfma_f32_16x16x32_bf16 v[96:99], a[20:23], a[212:215], v[96:99]
    v_exp_f32 v54, v54
    v_mfma_f32_16x16x32_bf16 v[100:103], a[24:27], a[192:195], 0
    ds_read_b128 a[232:235], v2 offset:43008
    v_sub_f32 v55, v55, v13
    v_mfma_f32_16x16x32_bf16 v[100:103], a[28:31], a[196:199], v[100:103]
    v_add_f32 v22, v22, v67
    v_sub_f32 v71, v71, v14
    v_mfma_f32_16x16x32_bf16 v[100:103], a[32:35], a[200:203], v[100:103]
    ds_read_b128 a[236:239], v2 offset:44032
    v_cvt_pk_bf16_f32 v160, v96, v97
    v_mfma_f32_16x16x32_bf16 v[100:103], a[36:39], a[204:207], v[100:103]
    v_cvt_pk_bf16_f32 v161, v98, v99
    v_add_f32 v23, v23, v83
    v_mfma_f32_16x16x32_bf16 v[100:103], a[40:43], a[208:211], v[100:103]
    v_exp_f32 v70, v70
    v_mfma_f32_16x16x32_bf16 v[100:103], a[44:47], a[212:215], v[100:103]
    v_exp_f32 v86, v86
    v_mfma_f32_16x16x32_bf16 v[104:107], a[48:51], a[192:195], 0
    v_sub_f32 v87, v87, v15
    v_add_f32 v20, v20, v36
    v_mfma_f32_16x16x32_bf16 v[104:107], a[52:55], a[196:199], v[104:107]
    v_exp_f32 v39, v39
    v_mfma_f32_16x16x32_bf16 v[104:107], a[56:59], a[200:203], v[104:107]
    v_cvt_pk_bf16_f32 v162, v100, v101
    v_cvt_pk_bf16_f32 v163, v102, v103
    v_mfma_f32_16x16x32_bf16 v[104:107], a[60:63], a[204:207], v[104:107]
    v_sub_f32 v40, v40, v12
    v_add_f32 v21, v21, v52
    v_mfma_f32_16x16x32_bf16 v[104:107], a[64:67], a[208:211], v[104:107]
    v_exp_f32 v55, v55
    v_mfma_f32_16x16x32_bf16 v[104:107], a[68:71], a[212:215], v[104:107]
    v_sub_f32 v56, v56, v13
    v_add_f32 v22, v22, v68
    v_mfma_f32_16x16x32_bf16 v[108:111], a[72:75], a[192:195], 0
    v_exp_f32 v71, v71
    v_mfma_f32_16x16x32_bf16 v[108:111], a[76:79], a[196:199], v[108:111]
    v_sub_f32 v72, v72, v14
    v_add_f32 v23, v23, v84
    v_mfma_f32_16x16x32_bf16 v[108:111], a[80:83], a[200:203], v[108:111]
    v_cvt_pk_bf16_f32 v164, v104, v105
    v_cvt_pk_bf16_f32 v165, v106, v107
    v_mfma_f32_16x16x32_bf16 v[108:111], a[84:87], a[204:207], v[108:111]
    v_exp_f32 v87, v87
    v_mfma_f32_16x16x32_bf16 v[108:111], a[88:91], a[208:211], v[108:111]
    buffer_load_dwordx4 a[176:179], v9, s[8:11], s30 offen offset:128 nt
    v_sub_f32 v88, v88, v15
    v_mfma_f32_16x16x32_bf16 v[108:111], a[92:95], a[212:215], v[108:111]
    buffer_load_dwordx4 a[180:183], v10, s[8:11], s30 offen offset:128 nt
    s_waitcnt lgkmcnt(0)
    v_mfma_f32_16x16x32_bf16 v[112:115], a[0:3], a[216:219], 0
    ds_read_b128 a[240:243], v2 offset:45056
    v_add_f32 v20, v20, v37
    v_mfma_f32_16x16x32_bf16 v[112:115], a[4:7], a[220:223], v[112:115]
    ds_read_b128 a[244:247], v2 offset:46080
    v_sub_f32 v41, v41, v12
    v_mfma_f32_16x16x32_bf16 v[112:115], a[8:11], a[224:227], v[112:115]
    ds_read_b128 a[248:251], v2 offset:47104
    v_cvt_pk_bf16_f32 v166, v108, v109
    v_mfma_f32_16x16x32_bf16 v[112:115], a[12:15], a[228:231], v[112:115]
    v_cvt_pk_bf16_f32 v167, v110, v111
    v_add_f32 v21, v21, v53
    v_mfma_f32_16x16x32_bf16 v[112:115], a[16:19], a[232:235], v[112:115]
    ds_read_b128 a[252:255], v2 offset:48128
    v_sub_f32 v57, v57, v13
    v_mfma_f32_16x16x32_bf16 v[112:115], a[20:23], a[236:239], v[112:115]
    v_exp_f32 v40, v40
    v_mfma_f32_16x16x32_bf16 v[116:119], a[24:27], a[216:219], 0
    ds_read_b128 a[192:195], v2 offset:49152
    v_add_f32 v22, v22, v69
    v_mfma_f32_16x16x32_bf16 v[116:119], a[28:31], a[220:223], v[116:119]
    v_exp_f32 v56, v56
    v_mfma_f32_16x16x32_bf16 v[116:119], a[32:35], a[224:227], v[116:119]
    buffer_store_dwordx2 v[228:229], v11, s[12:15], s33 offen offset:768 sc1
    v_mfma_f32_16x16x32_bf16 v[116:119], a[36:39], a[228:231], v[116:119]
    ds_read_b128 a[196:199], v2 offset:50176
    v_cvt_pk_bf16_f32 v168, v112, v113
    v_mfma_f32_16x16x32_bf16 v[116:119], a[40:43], a[232:235], v[116:119]
    v_cvt_pk_bf16_f32 v169, v114, v115
    v_sub_f32 v73, v73, v14
    v_mfma_f32_16x16x32_bf16 v[116:119], a[44:47], a[236:239], v[116:119]
    v_exp_f32 v72, v72
    v_mfma_f32_16x16x32_bf16 v[120:123], a[48:51], a[216:219], 0
    v_add_f32 v23, v23, v85
    v_sub_f32 v89, v89, v15
    v_mfma_f32_16x16x32_bf16 v[120:123], a[52:55], a[220:223], v[120:123]
    v_exp_f32 v88, v88
    v_mfma_f32_16x16x32_bf16 v[120:123], a[56:59], a[224:227], v[120:123]
    v_cvt_pk_bf16_f32 v170, v116, v117
    v_cvt_pk_bf16_f32 v171, v118, v119
    v_mfma_f32_16x16x32_bf16 v[120:123], a[60:63], a[228:231], v[120:123]
    v_add_f32 v20, v20, v38
    v_sub_f32 v42, v42, v12
    v_mfma_f32_16x16x32_bf16 v[120:123], a[64:67], a[232:235], v[120:123]
    v_exp_f32 v41, v41
    v_mfma_f32_16x16x32_bf16 v[120:123], a[68:71], a[236:239], v[120:123]
    v_add_f32 v21, v21, v54
    v_sub_f32 v58, v58, v13
    v_mfma_f32_16x16x32_bf16 v[124:127], a[72:75], a[216:219], 0
    v_exp_f32 v57, v57
    v_mfma_f32_16x16x32_bf16 v[124:127], a[76:79], a[220:223], v[124:127]
    v_add_f32 v22, v22, v70
    v_sub_f32 v74, v74, v14
    v_mfma_f32_16x16x32_bf16 v[124:127], a[80:83], a[224:227], v[124:127]
    v_cvt_pk_bf16_f32 v172, v120, v121
    v_cvt_pk_bf16_f32 v173, v122, v123
    v_mfma_f32_16x16x32_bf16 v[124:127], a[84:87], a[228:231], v[124:127]
    v_exp_f32 v73, v73
    v_mfma_f32_16x16x32_bf16 v[124:127], a[88:91], a[232:235], v[124:127]
    ds_read_b128 a[200:203], v2 offset:51200
    v_add_f32 v23, v23, v86
    v_mfma_f32_16x16x32_bf16 v[124:127], a[92:95], a[236:239], v[124:127]
    v_sub_f32 v90, v90, v15
    s_waitcnt lgkmcnt(1)
    v_mfma_f32_16x16x32_bf16 v[96:99], a[0:3], a[240:243], 0
    ds_read_b128 a[204:207], v2 offset:52224
    v_add_f32 v20, v20, v39
    v_mfma_f32_16x16x32_bf16 v[96:99], a[4:7], a[244:247], v[96:99]
    v_exp_f32 v89, v89
    v_mfma_f32_16x16x32_bf16 v[96:99], a[8:11], a[248:251], v[96:99]
    ds_read_b128 a[208:211], v2 offset:53248
    v_cvt_pk_bf16_f32 v174, v124, v125
    v_mfma_f32_16x16x32_bf16 v[96:99], a[12:15], a[252:255], v[96:99]
    v_cvt_pk_bf16_f32 v175, v126, v127
    v_sub_f32 v43, v43, v12
    v_mfma_f32_16x16x32_bf16 v[96:99], a[16:19], a[192:195], v[96:99]
    ds_read_b128 a[212:215], v2 offset:54272
    v_add_f32 v21, v21, v55
    v_mfma_f32_16x16x32_bf16 v[96:99], a[20:23], a[196:199], v[96:99]
    v_exp_f32 v42, v42
    v_mfma_f32_16x16x32_bf16 v[100:103], a[24:27], a[240:243], 0
    ds_read_b128 a[216:219], v2 offset:55296
    v_sub_f32 v59, v59, v13
    v_mfma_f32_16x16x32_bf16 v[100:103], a[28:31], a[244:247], v[100:103]
    v_exp_f32 v58, v58
    v_mfma_f32_16x16x32_bf16 v[100:103], a[32:35], a[248:251], v[100:103]
    ds_read_b128 a[220:223], v2 offset:56320
    v_cvt_pk_bf16_f32 v176, v96, v97
    v_mfma_f32_16x16x32_bf16 v[100:103], a[36:39], a[252:255], v[100:103]
    v_cvt_pk_bf16_f32 v177, v98, v99
    v_add_f32 v22, v22, v71
    v_mfma_f32_16x16x32_bf16 v[100:103], a[40:43], a[192:195], v[100:103]
    v_exp_f32 v74, v74
    v_mfma_f32_16x16x32_bf16 v[100:103], a[44:47], a[196:199], v[100:103]
    v_sub_f32 v75, v75, v14
    v_add_f32 v23, v23, v87
    v_mfma_f32_16x16x32_bf16 v[104:107], a[48:51], a[240:243], 0
    v_exp_f32 v90, v90
    v_mfma_f32_16x16x32_bf16 v[104:107], a[52:55], a[244:247], v[104:107]
    v_sub_f32 v91, v91, v15
    v_add_f32 v20, v20, v40
    v_mfma_f32_16x16x32_bf16 v[104:107], a[56:59], a[248:251], v[104:107]
    buffer_store_dwordx2 v[230:231], v11, s[12:15], s33 offen offset:1152 sc1
    v_mfma_f32_16x16x32_bf16 v[104:107], a[60:63], a[252:255], v[104:107]
    v_cvt_pk_bf16_f32 v178, v100, v101
    v_cvt_pk_bf16_f32 v179, v102, v103
    v_mfma_f32_16x16x32_bf16 v[104:107], a[64:67], a[192:195], v[104:107]
    v_exp_f32 v43, v43
    v_mfma_f32_16x16x32_bf16 v[104:107], a[68:71], a[196:199], v[104:107]
    v_sub_f32 v44, v44, v12
    v_add_f32 v21, v21, v56
    v_mfma_f32_16x16x32_bf16 v[108:111], a[72:75], a[240:243], 0
    v_exp_f32 v59, v59
    v_mfma_f32_16x16x32_bf16 v[108:111], a[76:79], a[244:247], v[108:111]
    buffer_load_dwordx4 a[184:187], v9, s[8:11], s30 offen offset:256 nt
    v_sub_f32 v60, v60, v13
    v_mfma_f32_16x16x32_bf16 v[108:111], a[80:83], a[248:251], v[108:111]
    buffer_load_dwordx4 a[188:191], v10, s[8:11], s30 offen offset:256 nt
    v_cvt_pk_bf16_f32 v180, v104, v105
    v_mfma_f32_16x16x32_bf16 v[108:111], a[84:87], a[252:255], v[108:111]
    v_cvt_pk_bf16_f32 v181, v106, v107
    v_add_f32 v22, v22, v72
    v_mfma_f32_16x16x32_bf16 v[108:111], a[88:91], a[192:195], v[108:111]
    ds_read_b128 a[224:227], v2 offset:57344
    v_sub_f32 v76, v76, v14
    v_mfma_f32_16x16x32_bf16 v[108:111], a[92:95], a[196:199], v[108:111]
    v_add_f32 v23, v23, v88
    s_waitcnt lgkmcnt(1)
    v_mfma_f32_16x16x32_bf16 v[112:115], a[0:3], a[200:203], 0
    ds_read_b128 a[228:231], v2 offset:58368
    v_sub_f32 v92, v92, v15
    v_mfma_f32_16x16x32_bf16 v[112:115], a[4:7], a[204:207], v[112:115]
    v_exp_f32 v75, v75
    v_mfma_f32_16x16x32_bf16 v[112:115], a[8:11], a[208:211], v[112:115]
    ds_read_b128 a[232:235], v2 offset:59392
    v_cvt_pk_bf16_f32 v182, v108, v109
    v_mfma_f32_16x16x32_bf16 v[112:115], a[12:15], a[212:215], v[112:115]
    v_cvt_pk_bf16_f32 v183, v110, v111
    v_add_f32 v20, v20, v41
    v_mfma_f32_16x16x32_bf16 v[112:115], a[16:19], a[216:219], v[112:115]
    ds_read_b128 a[236:239], v2 offset:60416
    v_sub_f32 v45, v45, v12
    v_mfma_f32_16x16x32_bf16 v[112:115], a[20:23], a[220:223], v[112:115]
    v_exp_f32 v91, v91
    v_mfma_f32_16x16x32_bf16 v[116:119], a[24:27], a[200:203], 0
    ds_read_b128 a[240:243], v2 offset:61440
    v_add_f32 v21, v21, v57
    v_mfma_f32_16x16x32_bf16 v[116:119], a[28:31], a[204:207], v[116:119]
    v_exp_f32 v44, v44
    v_mfma_f32_16x16x32_bf16 v[116:119], a[32:35], a[208:211], v[116:119]
    ds_read_b128 a[244:247], v2 offset:62464
    v_cvt_pk_bf16_f32 v184, v112, v113
    v_mfma_f32_16x16x32_bf16 v[116:119], a[36:39], a[212:215], v[116:119]
    v_cvt_pk_bf16_f32 v185, v114, v115
    v_sub_f32 v61, v61, v13
    v_mfma_f32_16x16x32_bf16 v[116:119], a[40:43], a[216:219], v[116:119]
    v_exp_f32 v60, v60
    v_mfma_f32_16x16x32_bf16 v[116:119], a[44:47], a[220:223], v[116:119]
    v_add_f32 v22, v22, v73
    v_sub_f32 v77, v77, v14
    v_mfma_f32_16x16x32_bf16 v[120:123], a[48:51], a[200:203], 0
    v_exp_f32 v76, v76
    v_mfma_f32_16x16x32_bf16 v[120:123], a[52:55], a[204:207], v[120:123]
    v_add_f32 v23, v23, v89
    v_sub_f32 v93, v93, v15
    v_mfma_f32_16x16x32_bf16 v[120:123], a[56:59], a[208:211], v[120:123]
    v_cvt_pk_bf16_f32 v186, v116, v117
    v_cvt_pk_bf16_f32 v187, v118, v119
    v_mfma_f32_16x16x32_bf16 v[120:123], a[60:63], a[212:215], v[120:123]
    buffer_store_dwordx2 v[232:233], v11, s[12:15], s35 offen offset:0 sc1
    v_mfma_f32_16x16x32_bf16 v[120:123], a[64:67], a[216:219], v[120:123]
    v_exp_f32 v92, v92
    v_mfma_f32_16x16x32_bf16 v[120:123], a[68:71], a[220:223], v[120:123]
    v_add_f32 v20, v20, v42
    v_sub_f32 v46, v46, v12
    v_mfma_f32_16x16x32_bf16 v[124:127], a[72:75], a[200:203], 0
    v_exp_f32 v45, v45
    v_mfma_f32_16x16x32_bf16 v[124:127], a[76:79], a[204:207], v[124:127]
    v_add_f32 v21, v21, v58
    v_sub_f32 v62, v62, v13
    v_mfma_f32_16x16x32_bf16 v[124:127], a[80:83], a[208:211], v[124:127]
    v_cvt_pk_bf16_f32 v188, v120, v121
    v_cvt_pk_bf16_f32 v189, v122, v123
    v_mfma_f32_16x16x32_bf16 v[124:127], a[84:87], a[212:215], v[124:127]
    v_exp_f32 v61, v61
    v_mfma_f32_16x16x32_bf16 v[124:127], a[88:91], a[216:219], v[124:127]
    ds_read_b128 a[248:251], v2 offset:63488
    v_add_f32 v22, v22, v74
    v_mfma_f32_16x16x32_bf16 v[124:127], a[92:95], a[220:223], v[124:127]
    v_sub_f32 v78, v78, v14
    s_waitcnt lgkmcnt(1)
    v_mfma_f32_16x16x32_bf16 v[96:99], a[0:3], a[224:227], 0
    buffer_store_dwordx2 v[234:235], v11, s[12:15], s35 offen offset:384 sc1
    v_mfma_f32_16x16x32_bf16 v[96:99], a[4:7], a[228:231], v[96:99]
    ds_read_b128 a[252:255], v2 offset:64512
    v_add_f32 v23, v23, v90
    v_mfma_f32_16x16x32_bf16 v[96:99], a[8:11], a[232:235], v[96:99]
    ds_read_b128 a[192:195], v3 offset:0
    v_cvt_pk_bf16_f32 v190, v124, v125
    v_mfma_f32_16x16x32_bf16 v[96:99], a[12:15], a[236:239], v[96:99]
    v_cvt_pk_bf16_f32 v191, v126, v127
    v_sub_f32 v94, v94, v15
    v_mfma_f32_16x16x32_bf16 v[96:99], a[16:19], a[240:243], v[96:99]
    ds_read_b128 a[196:199], v3 offset:1024
    v_add_f32 v20, v20, v43
    v_mfma_f32_16x16x32_bf16 v[96:99], a[20:23], a[244:247], v[96:99]
    v_exp_f32 v77, v77
    v_mfma_f32_16x16x32_bf16 v[100:103], a[24:27], a[224:227], 0
    ds_read_b128 a[200:203], v3 offset:2048
    v_sub_f32 v47, v47, v12
    v_mfma_f32_16x16x32_bf16 v[100:103], a[28:31], a[228:231], v[100:103]
    v_exp_f32 v93, v93
    v_mfma_f32_16x16x32_bf16 v[100:103], a[32:35], a[232:235], v[100:103]
    ds_read_b128 a[204:207], v3 offset:3072
    v_cvt_pk_bf16_f32 v192, v96, v97
    v_mfma_f32_16x16x32_bf16 v[100:103], a[36:39], a[236:239], v[100:103]
    buffer_store_dwordx2 v[236:237], v11, s[12:15], s35 offen offset:768 sc1
    v_mfma_f32_16x16x32_bf16 v[100:103], a[40:43], a[240:243], v[100:103]
    v_cvt_pk_bf16_f32 v193, v98, v99
    v_add_f32 v21, v21, v59
    v_mfma_f32_16x16x32_bf16 v[100:103], a[44:47], a[244:247], v[100:103]
    v_exp_f32 v46, v46
    v_mfma_f32_16x16x32_bf16 v[104:107], a[48:51], a[224:227], 0
    v_exp_f32 v62, v62
    v_mfma_f32_16x16x32_bf16 v[104:107], a[52:55], a[228:231], v[104:107]
    v_sub_f32 v63, v63, v13
    v_add_f32 v22, v22, v75
    v_mfma_f32_16x16x32_bf16 v[104:107], a[56:59], a[232:235], v[104:107]
    v_cvt_pk_bf16_f32 v194, v100, v101
    v_cvt_pk_bf16_f32 v195, v102, v103
    v_mfma_f32_16x16x32_bf16 v[104:107], a[60:63], a[236:239], v[104:107]
    v_exp_f32 v78, v78
    v_mfma_f32_16x16x32_bf16 v[104:107], a[64:67], a[240:243], v[104:107]
    v_sub_f32 v79, v79, v14
    v_add_f32 v23, v23, v91
    v_mfma_f32_16x16x32_bf16 v[104:107], a[68:71], a[244:247], v[104:107]
    v_exp_f32 v94, v94
    v_mfma_f32_16x16x32_bf16 v[108:111], a[72:75], a[224:227], 0
    buffer_store_dwordx2 v[238:239], v11, s[12:15], s35 offen offset:1152 sc1
    v_mfma_f32_16x16x32_bf16 v[108:111], a[76:79], a[228:231], v[108:111]
    v_sub_f32 v95, v95, v15
    v_add_f32 v20, v20, v44
    v_mfma_f32_16x16x32_bf16 v[108:111], a[80:83], a[232:235], v[108:111]
    v_cvt_pk_bf16_f32 v196, v104, v105
    v_cvt_pk_bf16_f32 v197, v106, v107
    v_mfma_f32_16x16x32_bf16 v[108:111], a[84:87], a[236:239], v[108:111]
    v_exp_f32 v47, v47
    v_mfma_f32_16x16x32_bf16 v[108:111], a[88:91], a[240:243], v[108:111]
    ds_read_b128 a[208:211], v3 offset:4096
    v_add_f32 v21, v21, v60
    v_mfma_f32_16x16x32_bf16 v[108:111], a[92:95], a[244:247], v[108:111]
    v_add_f32 v22, v22, v76
    s_waitcnt lgkmcnt(1)
    v_mfma_f32_16x16x32_bf16 v[112:115], a[0:3], a[248:251], 0
    ds_read_b128 a[212:215], v3 offset:5120
    v_add_f32 v23, v23, v92
    v_mfma_f32_16x16x32_bf16 v[112:115], a[4:7], a[252:255], v[112:115]
    v_exp_f32 v63, v63
    v_mfma_f32_16x16x32_bf16 v[112:115], a[8:11], a[192:195], v[112:115]
    ds_read_b128 a[216:219], v3 offset:6144
    v_cvt_pk_bf16_f32 v198, v108, v109
    v_mfma_f32_16x16x32_bf16 v[112:115], a[12:15], a[196:199], v[112:115]
    buffer_store_dwordx2 v[240:241], v11, s[12:15], s37 offen offset:0 sc1
    v_mfma_f32_16x16x32_bf16 v[112:115], a[16:19], a[200:203], v[112:115]
    ds_read_b128 a[220:223], v3 offset:7168
    v_cvt_pk_bf16_f32 v199, v110, v111
    v_mfma_f32_16x16x32_bf16 v[112:115], a[20:23], a[204:207], v[112:115]
    v_exp_f32 v79, v79
    v_mfma_f32_16x16x32_bf16 v[116:119], a[24:27], a[248:251], 0
    ds_read_b128 a[224:227], v3 offset:8192
    v_add_f32 v20, v20, v45
    v_mfma_f32_16x16x32_bf16 v[116:119], a[28:31], a[252:255], v[116:119]
    v_exp_f32 v95, v95
    v_mfma_f32_16x16x32_bf16 v[116:119], a[32:35], a[192:195], v[116:119]
    ds_read_b128 a[228:231], v3 offset:9216
    v_cvt_pk_bf16_f32 v200, v112, v113
    v_mfma_f32_16x16x32_bf16 v[116:119], a[36:39], a[196:199], v[116:119]
    v_cvt_pk_bf16_f32 v201, v114, v115
    v_add_f32 v21, v21, v61
    v_mfma_f32_16x16x32_bf16 v[116:119], a[40:43], a[200:203], v[116:119]
    v_add_f32 v22, v22, v77
    v_add_f32 v23, v23, v93
    v_mfma_f32_16x16x32_bf16 v[116:119], a[44:47], a[204:207], v[116:119]
    v_add_f32 v20, v20, v46
    v_add_f32 v21, v21, v62
    v_mfma_f32_16x16x32_bf16 v[120:123], a[48:51], a[248:251], 0
    buffer_store_dwordx2 v[242:243], v11, s[12:15], s37 offen offset:384 sc1
    v_mfma_f32_16x16x32_bf16 v[120:123], a[52:55], a[252:255], v[120:123]
    v_add_f32 v22, v22, v78
    v_add_f32 v23, v23, v94
    v_mfma_f32_16x16x32_bf16 v[120:123], a[56:59], a[192:195], v[120:123]
    v_cvt_pk_bf16_f32 v202, v116, v117
    v_cvt_pk_bf16_f32 v203, v118, v119
    v_mfma_f32_16x16x32_bf16 v[120:123], a[60:63], a[196:199], v[120:123]
    v_add_f32 v20, v20, v47
    v_add_f32 v21, v21, v63
    v_mfma_f32_16x16x32_bf16 v[120:123], a[64:67], a[200:203], v[120:123]
    v_add_f32 v22, v22, v79
    v_add_f32 v23, v23, v95
    v_mfma_f32_16x16x32_bf16 v[120:123], a[68:71], a[204:207], v[120:123]
    v_permlane16_swap_b32 v20, v21
    v_permlane16_swap_b32 v22, v23
    v_mfma_f32_16x16x32_bf16 v[124:127], a[72:75], a[248:251], 0
    s_add_u32 s42, s17, L_win3-L_pc_ref
    v_add_f32 v20, v20, v21
    v_mfma_f32_16x16x32_bf16 v[124:127], a[76:79], a[252:255], v[124:127]
    v_add_f32 v22, v22, v23
    s_add_u32 s33, s16, 9437184
    v_mfma_f32_16x16x32_bf16 v[124:127], a[80:83], a[192:195], v[124:127]
    buffer_load_dword v8, v7, s[44:47], s42 offen
    v_cvt_pk_bf16_f32 v204, v120, v121
    v_mfma_f32_16x16x32_bf16 v[124:127], a[84:87], a[196:199], v[124:127]
    buffer_store_dwordx2 v[244:245], v11, s[12:15], s37 offen offset:768 sc1
    v_mfma_f32_16x16x32_bf16 v[124:127], a[88:91], a[200:203], v[124:127]
    ds_read_b128 a[232:235], v3 offset:10240
    v_cvt_pk_bf16_f32 v205, v122, v123
    v_mfma_f32_16x16x32_bf16 v[124:127], a[92:95], a[204:207], v[124:127]
    v_permlane32_swap_b32 v20, v22
    s_waitcnt lgkmcnt(1)
    v_mfma_f32_16x16x32_bf16 v[96:99], a[0:3], a[208:211], 0
    ds_read_b128 a[236:239], v3 offset:11264
    v_add_f32 v20, v20, v22
    v_mfma_f32_16x16x32_bf16 v[96:99], a[4:7], a[212:215], v[96:99]
    v_rcp_f32 v20, v20
    v_mfma_f32_16x16x32_bf16 v[96:99], a[8:11], a[216:219], v[96:99]
    ds_read_b128 a[240:243], v3 offset:12288
    v_cvt_pk_bf16_f32 v206, v124, v125
    v_mfma_f32_16x16x32_bf16 v[96:99], a[12:15], a[220:223], v[96:99]
    v_cvt_pk_bf16_f32 v207, v126, v127
    v_mov_b32 v22, v20
    v_mfma_f32_16x16x32_bf16 v[96:99], a[16:19], a[224:227], v[96:99]
    ds_read_b128 a[244:247], v3 offset:13312
    v_permlane32_swap_b32 v20, v22
    v_mfma_f32_16x16x32_bf16 v[96:99], a[20:23], a[228:231], v[96:99]
    v_mov_b32 v21, v20
    v_mov_b32 v23, v22
    v_mfma_f32_16x16x32_bf16 v[100:103], a[24:27], a[208:211], 0
    buffer_store_dwordx2 v[246:247], v11, s[12:15], s37 offen offset:1152 sc1
    v_mfma_f32_16x16x32_bf16 v[100:103], a[28:31], a[212:215], v[100:103]
    ds_read_b128 a[248:251], v3 offset:14336
    v_permlane16_swap_b32 v20, v21
    v_mfma_f32_16x16x32_bf16 v[100:103], a[32:35], a[216:219], v[100:103]
    ds_read_b128 a[252:255], v3 offset:15360
    v_mul_f32 v32, v32, v20
    v_mfma_f32_16x16x32_bf16 v[100:103], a[36:39], a[220:223], v[100:103]
    v_mul_f32 v33, v33, v20
    v_cvt_pk_bf16_f32 v32, v32, v33
    v_mfma_f32_16x16x32_bf16 v[100:103], a[40:43], a[224:227], v[100:103]
    v_mul_f32 v34, v34, v20
    v_mul_f32 v35, v35, v20
    v_mfma_f32_16x16x32_bf16 v[100:103], a[44:47], a[228:231], v[100:103]
    v_cvt_pk_bf16_f32 v33, v34, v35
    v_mul_f32 v36, v36, v20
    v_mfma_f32_16x16x32_bf16 v[104:107], a[48:51], a[208:211], 0
    v_mul_f32 v37, v37, v20
    v_cvt_pk_bf16_f32 v34, v36, v37
    v_mfma_f32_16x16x32_bf16 v[104:107], a[52:55], a[212:215], v[104:107]
    v_mul_f32 v38, v38, v20
    v_mul_f32 v39, v39, v20
    v_mfma_f32_16x16x32_bf16 v[104:107], a[56:59], a[216:219], v[104:107]
    v_mul_f32 v40, v40, v20
    v_mul_f32 v41, v41, v20
    v_mfma_f32_16x16x32_bf16 v[104:107], a[60:63], a[220:223], v[104:107]
    buffer_store_dwordx2 v[248:249], v11, s[12:15], s39 offen offset:0 sc1
    v_mfma_f32_16x16x32_bf16 v[104:107], a[64:67], a[224:227], v[104:107]
    v_permlane16_swap_b32 v22, v23
    v_cvt_pk_bf16_f32 v35, v38, v39
    v_mfma_f32_16x16x32_bf16 v[104:107], a[68:71], a[228:231], v[104:107]
    v_cvt_pk_bf16_f32 v36, v40, v41
    v_mul_f32 v48, v48, v21
    v_mfma_f32_16x16x32_bf16 v[108:111], a[72:75], a[208:211], 0
    v_mul_f32 v49, v49, v21
    v_cvt_pk_bf16_f32 v40, v48, v49
    v_mfma_f32_16x16x32_bf16 v[108:111], a[76:79], a[212:215], v[108:111]
    v_mul_f32 v64, v64, v22
    v_mul_f32 v65, v65, v22
    v_mfma_f32_16x16x32_bf16 v[108:111], a[80:83], a[216:219], v[108:111]
    v_mul_f32 v66, v66, v22
    v_mul_f32 v67, v67, v22
    v_mfma_f32_16x16x32_bf16 v[108:111], a[84:87], a[220:223], v[108:111]
    v_cvt_pk_bf16_f32 v48, v64, v65
    v_cvt_pk_bf16_f32 v49, v66, v67
    v_mfma_f32_16x16x32_bf16 v[108:111], a[88:91], a[224:227], v[108:111]
    v_mul_f32 v42, v42, v20
    v_mul_f32 v43, v43, v20
    v_mfma_f32_16x16x32_bf16 v[108:111], a[92:95], a[228:231], v[108:111]
    v_mul_f32 v44, v44, v20
    s_waitcnt lgkmcnt(0)
    v_mfma_f32_16x16x32_bf16 v[112:115], a[0:3], a[232:235], 0
    buffer_store_dwordx2 v[250:251], v11, s[12:15], s39 offen offset:384 sc1
    v_mfma_f32_16x16x32_bf16 v[112:115], a[4:7], a[236:239], v[112:115]
    v_mul_f32 v45, v45, v20
    v_mul_f32 v46, v46, v20
    v_mfma_f32_16x16x32_bf16 v[112:115], a[8:11], a[240:243], v[112:115]
    v_mul_f32 v47, v47, v20
    v_cvt_pk_bf16_f32 v37, v42, v43
    v_mfma_f32_16x16x32_bf16 v[112:115], a[12:15], a[244:247], v[112:115]
    v_cvt_pk_bf16_f32 v38, v44, v45
    v_cvt_pk_bf16_f32 v39, v46, v47
    v_mfma_f32_16x16x32_bf16 v[112:115], a[16:19], a[248:251], v[112:115]
    v_mul_f32 v50, v50, v21
    v_mul_f32 v51, v51, v21
    v_mfma_f32_16x16x32_bf16 v[112:115], a[20:23], a[252:255], v[112:115]
    v_cvt_pk_bf16_f32 v41, v50, v51
    v_mul_f32 v68, v68, v22
    v_mfma_f32_16x16x32_bf16 v[116:119], a[24:27], a[232:235], 0
    v_mul_f32 v69, v69, v22
    v_mul_f32 v70, v70, v22
    v_mfma_f32_16x16x32_bf16 v[116:119], a[28:31], a[236:239], v[116:119]
    v_mul_f32 v71, v71, v22
    v_cvt_pk_bf16_f32 v50, v68, v69
    v_mfma_f32_16x16x32_bf16 v[116:119], a[32:35], a[240:243], v[116:119]
    v_cvt_pk_bf16_f32 v51, v70, v71
    v_mul_f32 v52, v52, v21
    v_mfma_f32_16x16x32_bf16 v[116:119], a[36:39], a[244:247], v[116:119]
    buffer_store_dwordx2 v[252:253], v11, s[12:15], s39 offen offset:768 sc1
    v_mfma_f32_16x16x32_bf16 v[116:119], a[40:43], a[248:251], v[116:119]
    v_mul_f32 v53, v53, v21
    v_cvt_pk_bf16_f32 v42, v52, v53
    v_mfma_f32_16x16x32_bf16 v[116:119], a[44:47], a[252:255], v[116:119]
    v_mul_f32 v72, v72, v22
    v_mul_f32 v73, v73, v22
    v_mfma_f32_16x16x32_bf16 v[120:123], a[48:51], a[232:235], 0
    v_mul_f32 v74, v74, v22
    v_mul_f32 v75, v75, v22
    v_mfma_f32_16x16x32_bf16 v[120:123], a[52:55], a[236:239], v[120:123]
    v_cvt_pk_bf16_f32 v52, v72, v73
    v_cvt_pk_bf16_f32 v53, v74, v75
    v_mfma_f32_16x16x32_bf16 v[120:123], a[56:59], a[240:243], v[120:123]
    v_mul_f32 v54, v54, v21
    v_mul_f32 v55, v55, v21
    v_mfma_f32_16x16x32_bf16 v[120:123], a[60:63], a[244:247], v[120:123]
    v_cvt_pk_bf16_f32 v43, v54, v55
    v_mul_f32 v76, v76, v22
    v_mfma_f32_16x16x32_bf16 v[120:123], a[64:67], a[248:251], v[120:123]
    v_mul_f32 v77, v77, v22
    v_mul_f32 v78, v78, v22
    v_mfma_f32_16x16x32_bf16 v[120:123], a[68:71], a[252:255], v[120:123]
    v_mul_f32 v79, v79, v22
    v_cvt_pk_bf16_f32 v54, v76, v77
    v_mfma_f32_16x16x32_bf16 v[124:127], a[72:75], a[232:235], 0
    buffer_store_dwordx2 v[254:255], v11, s[12:15], s39 offen offset:1152 sc1
    v_mfma_f32_16x16x32_bf16 v[124:127], a[76:79], a[236:239], v[124:127]
    v_cvt_pk_bf16_f32 v55, v78, v79
    v_mul_f32 v56, v56, v21
    v_mfma_f32_16x16x32_bf16 v[124:127], a[80:83], a[240:243], v[124:127]
    v_mul_f32 v57, v57, v21
    v_cvt_pk_bf16_f32 v44, v56, v57
    v_mfma_f32_16x16x32_bf16 v[124:127], a[84:87], a[244:247], v[124:127]
    v_mul_f32 v80, v80, v23
    v_mul_f32 v81, v81, v23
    v_mfma_f32_16x16x32_bf16 v[124:127], a[88:91], a[248:251], v[124:127]
    v_mul_f32 v82, v82, v23
    v_mul_f32 v83, v83, v23
    v_mfma_f32_16x16x32_bf16 v[124:127], a[92:95], a[252:255], v[124:127]
    v_cvt_pk_bf16_f32 v56, v80, v81
    v_cvt_pk_bf16_f32 v57, v82, v83
    v_mfma_f32_16x16x32_bf16 v[64:67], v[32:35], v[128:131], 0
    v_mul_f32 v58, v58, v21
    v_mul_f32 v59, v59, v21
    v_mfma_f32_16x16x32_bf16 v[64:67], v[36:39], v[132:135], v[64:67]
    v_mul_f32 v60, v60, v21
    v_mul_f32 v61, v61, v21
    v_mfma_f32_16x16x32_bf16 v[68:71], v[32:35], v[136:139], 0
    v_mul_f32 v62, v62, v21
    v_mul_f32 v63, v63, v21
    v_mfma_f32_16x16x32_bf16 v[68:71], v[36:39], v[140:143], v[68:71]
    v_cvt_pk_bf16_f32 v45, v58, v59
    v_cvt_pk_bf16_f32 v46, v60, v61
    v_mfma_f32_16x16x32_bf16 v[72:75], v[32:35], v[144:147], 0
    v_cvt_pk_bf16_f32 v47, v62, v63
    v_mul_f32 v84, v84, v23
    v_mfma_f32_16x16x32_bf16 v[72:75], v[36:39], v[148:151], v[72:75]
    v_mul_f32 v85, v85, v23
    v_mul_f32 v86, v86, v23
    v_mfma_f32_16x16x32_bf16 v[76:79], v[32:35], v[152:155], 0
    v_mul_f32 v87, v87, v23
    v_cvt_pk_bf16_f32 v58, v84, v85
    v_mfma_f32_16x16x32_bf16 v[76:79], v[36:39], v[156:159], v[76:79]
    v_cvt_pk_bf16_f32 v59, v86, v87
    v_mul_f32 v88, v88, v23
    v_mfma_f32_16x16x32_bf16 v[80:83], v[40:43], v[128:131], 0
    v_mul_f32 v89, v89, v23
    v_mul_f32 v90, v90, v23
    v_mfma_f32_16x16x32_bf16 v[80:83], v[44:47], v[132:135], v[80:83]
    v_mul_f32 v91, v91, v23
    v_cvt_pk_bf16_f32 v60, v88, v89
    v_mfma_f32_16x16x32_bf16 v[84:87], v[40:43], v[136:139], 0
    v_cvt_pk_bf16_f32 v61, v90, v91
    v_mul_f32 v92, v92, v23
    v_mfma_f32_16x16x32_bf16 v[84:87], v[44:47], v[140:143], v[84:87]
    v_mul_f32 v93, v93, v23
    v_mul_f32 v94, v94, v23
    v_mfma_f32_16x16x32_bf16 v[88:91], v[40:43], v[144:147], 0
    v_mul_f32 v95, v95, v23
    v_cvt_pk_bf16_f32 v62, v92, v93
    v_mfma_f32_16x16x32_bf16 v[88:91], v[44:47], v[148:151], v[88:91]
    v_cvt_pk_bf16_f32 v63, v94, v95
    v_cvt_pk_bf16_f32 v208, v96, v97
    v_mfma_f32_16x16x32_bf16 v[92:95], v[40:43], v[152:155], 0
    v_cvt_pk_bf16_f32 v209, v98, v99
    v_cvt_pk_bf16_f32 v210, v100, v101
    v_mfma_f32_16x16x32_bf16 v[92:95], v[44:47], v[156:159], v[92:95]
    v_cvt_pk_bf16_f32 v211, v102, v103
    v_cvt_pk_bf16_f32 v212, v104, v105
    v_mfma_f32_16x16x32_bf16 v[96:99], v[48:51], v[128:131], 0
    v_cvt_pk_bf16_f32 v213, v106, v107
    v_cvt_pk_bf16_f32 v214, v108, v109
    v_mfma_f32_16x16x32_bf16 v[96:99], v[52:55], v[132:135], v[96:99]
    v_cvt_pk_bf16_f32 v215, v110, v111
    v_cvt_pk_bf16_f32 v216, v112, v113
    v_mfma_f32_16x16x32_bf16 v[100:103], v[48:51], v[136:139], 0
    v_cvt_pk_bf16_f32 v217, v114, v115
    v_cvt_pk_bf16_f32 v218, v116, v117
    v_mfma_f32_16x16x32_bf16 v[100:103], v[52:55], v[140:143], v[100:103]
    v_cvt_pk_bf16_f32 v219, v118, v119
    v_cvt_pk_bf16_f32 v220, v120, v121
    v_mfma_f32_16x16x32_bf16 v[104:107], v[48:51], v[144:147], 0
    v_cvt_pk_bf16_f32 v221, v122, v123
    v_cvt_pk_bf16_f32 v222, v124, v125
    v_mfma_f32_16x16x32_bf16 v[104:107], v[52:55], v[148:151], v[104:107]
    v_cvt_pk_bf16_f32 v223, v126, v127
    v_cvt_pk_bf16_f32 v224, v64, v68
    v_mfma_f32_16x16x32_bf16 v[108:111], v[48:51], v[152:155], 0
    v_cvt_pk_bf16_f32 v226, v65, v69
    v_cvt_pk_bf16_f32 v228, v66, v70
    v_mfma_f32_16x16x32_bf16 v[108:111], v[52:55], v[156:159], v[108:111]
    v_cvt_pk_bf16_f32 v230, v67, v71
    v_cvt_pk_bf16_f32 v225, v72, v76
    v_mfma_f32_16x16x32_bf16 v[112:115], v[56:59], v[128:131], 0
    v_cvt_pk_bf16_f32 v227, v73, v77
    v_cvt_pk_bf16_f32 v229, v74, v78
    v_mfma_f32_16x16x32_bf16 v[112:115], v[60:63], v[132:135], v[112:115]
    v_cvt_pk_bf16_f32 v231, v75, v79
    v_cvt_pk_bf16_f32 v232, v80, v84
    v_mfma_f32_16x16x32_bf16 v[116:119], v[56:59], v[136:139], 0
    v_cvt_pk_bf16_f32 v234, v81, v85
    v_cvt_pk_bf16_f32 v236, v82, v86
    v_mfma_f32_16x16x32_bf16 v[116:119], v[60:63], v[140:143], v[116:119]
    v_cvt_pk_bf16_f32 v238, v83, v87
    v_cvt_pk_bf16_f32 v233, v88, v92
    v_mfma_f32_16x16x32_bf16 v[120:123], v[56:59], v[144:147], 0
    v_cvt_pk_bf16_f32 v235, v89, v93
    v_cvt_pk_bf16_f32 v237, v90, v94
    v_mfma_f32_16x16x32_bf16 v[120:123], v[60:63], v[148:151], v[120:123]
    v_cvt_pk_bf16_f32 v239, v91, v95
    v_cvt_pk_bf16_f32 v240, v96, v100
    v_mfma_f32_16x16x32_bf16 v[124:127], v[56:59], v[152:155], 0
    v_cvt_pk_bf16_f32 v242, v97, v101
    v_cvt_pk_bf16_f32 v244, v98, v102
    v_mfma_f32_16x16x32_bf16 v[124:127], v[60:63], v[156:159], v[124:127]
    v_cvt_pk_bf16_f32 v246, v99, v103
    v_cvt_pk_bf16_f32 v241, v104, v108
    v_mfma_f32_16x16x32_bf16 v[64:67], v[32:35], v[160:163], 0
    v_cvt_pk_bf16_f32 v243, v105, v109
    v_cvt_pk_bf16_f32 v245, v106, v110
    v_mfma_f32_16x16x32_bf16 v[64:67], v[36:39], v[164:167], v[64:67]
    v_cvt_pk_bf16_f32 v247, v107, v111
    v_cvt_pk_bf16_f32 v248, v112, v116
    v_mfma_f32_16x16x32_bf16 v[68:71], v[32:35], v[168:171], 0
    v_cvt_pk_bf16_f32 v250, v113, v117
    v_cvt_pk_bf16_f32 v252, v114, v118
    v_mfma_f32_16x16x32_bf16 v[68:71], v[36:39], v[172:175], v[68:71]
    v_cvt_pk_bf16_f32 v254, v115, v119
    v_cvt_pk_bf16_f32 v249, v120, v124
    v_mfma_f32_16x16x32_bf16 v[72:75], v[32:35], v[176:179], 0
    v_cvt_pk_bf16_f32 v251, v121, v125
    v_cvt_pk_bf16_f32 v253, v122, v126
    v_mfma_f32_16x16x32_bf16 v[72:75], v[36:39], v[180:183], v[72:75]
    v_cvt_pk_bf16_f32 v255, v123, v127
    s_add_u32 s35, s16, 9830400
    v_mfma_f32_16x16x32_bf16 v[76:79], v[32:35], v[184:187], 0
    v_cvt_pk_bf16_f32 v128, v64, v68
    v_cvt_pk_bf16_f32 v130, v65, v69
    v_mfma_f32_16x16x32_bf16 v[76:79], v[36:39], v[188:191], v[76:79]
    v_cvt_pk_bf16_f32 v132, v66, v70
    v_cvt_pk_bf16_f32 v134, v67, v71
    v_mfma_f32_16x16x32_bf16 v[80:83], v[40:43], v[160:163], 0
    s_add_u32 s37, s16, 10223616
    s_add_u32 s39, s16, 10616832
    v_mfma_f32_16x16x32_bf16 v[80:83], v[44:47], v[164:167], v[80:83]
    v_mfma_f32_16x16x32_bf16 v[84:87], v[40:43], v[168:171], 0
    v_cvt_pk_bf16_f32 v129, v72, v76
    v_cvt_pk_bf16_f32 v131, v73, v77
    v_mfma_f32_16x16x32_bf16 v[84:87], v[44:47], v[172:175], v[84:87]
    v_cvt_pk_bf16_f32 v133, v74, v78
    v_cvt_pk_bf16_f32 v135, v75, v79
    v_mfma_f32_16x16x32_bf16 v[88:91], v[40:43], v[176:179], 0
    s_waitcnt vmcnt(24)
    ds_write_b64 v4, a[160:161] offset:0
    v_mfma_f32_16x16x32_bf16 v[88:91], v[44:47], v[180:183], v[88:91]
    ds_write_b64 v4, a[162:163] offset:1024
    v_mfma_f32_16x16x32_bf16 v[92:95], v[40:43], v[184:187], 0
    ds_write_b64 v4, a[164:165] offset:512
    v_mfma_f32_16x16x32_bf16 v[92:95], v[44:47], v[188:191], v[92:95]
    ds_write_b64 v4, a[166:167] offset:1536
    v_mfma_f32_16x16x32_bf16 v[96:99], v[48:51], v[160:163], 0
    ds_read2_b64 a[160:163], v5 offset0:0 offset1:128
    v_cvt_pk_bf16_f32 v136, v80, v84
    v_mfma_f32_16x16x32_bf16 v[96:99], v[52:55], v[164:167], v[96:99]
    ds_read2_b64 a[164:167], v6 offset0:0 offset1:128
    v_cvt_pk_bf16_f32 v138, v81, v85
    v_mfma_f32_16x16x32_bf16 v[100:103], v[48:51], v[168:171], 0
    v_cvt_pk_bf16_f32 v140, v82, v86
    v_cvt_pk_bf16_f32 v142, v83, v87
    v_mfma_f32_16x16x32_bf16 v[100:103], v[52:55], v[172:175], v[100:103]
    v_cvt_pk_bf16_f32 v137, v88, v92
    v_cvt_pk_bf16_f32 v139, v89, v93
    v_mfma_f32_16x16x32_bf16 v[104:107], v[48:51], v[176:179], 0
    v_cvt_pk_bf16_f32 v141, v90, v94
    v_cvt_pk_bf16_f32 v143, v91, v95
    v_mfma_f32_16x16x32_bf16 v[104:107], v[52:55], v[180:183], v[104:107]
    v_mfma_f32_16x16x32_bf16 v[108:111], v[48:51], v[184:187], 0
    v_cvt_pk_bf16_f32 v144, v96, v100
    v_cvt_pk_bf16_f32 v146, v97, v101
    v_mfma_f32_16x16x32_bf16 v[108:111], v[52:55], v[188:191], v[108:111]
    v_cvt_pk_bf16_f32 v148, v98, v102
    v_cvt_pk_bf16_f32 v150, v99, v103
    v_mfma_f32_16x16x32_bf16 v[112:115], v[56:59], v[160:163], 0
    v_mfma_f32_16x16x32_bf16 v[112:115], v[60:63], v[164:167], v[112:115]
    v_mfma_f32_16x16x32_bf16 v[116:119], v[56:59], v[168:171], 0
    s_waitcnt vmcnt(20)
    ds_write_b64 v4, a[168:169] offset:0
    v_mfma_f32_16x16x32_bf16 v[116:119], v[60:63], v[172:175], v[116:119]
    ds_write_b64 v4, a[170:171] offset:1024
    v_mfma_f32_16x16x32_bf16 v[120:123], v[56:59], v[176:179], 0
    ds_write_b64 v4, a[172:173] offset:512
    v_mfma_f32_16x16x32_bf16 v[120:123], v[60:63], v[180:183], v[120:123]
    ds_write_b64 v4, a[174:175] offset:1536
    v_mfma_f32_16x16x32_bf16 v[124:127], v[56:59], v[184:187], 0
    ds_read2_b64 a[168:171], v5 offset0:0 offset1:128
    v_cvt_pk_bf16_f32 v145, v104, v108
    v_mfma_f32_16x16x32_bf16 v[124:127], v[60:63], v[188:191], v[124:127]
    ds_read2_b64 a[172:175], v6 offset0:0 offset1:128
    v_cvt_pk_bf16_f32 v147, v105, v109
    v_mfma_f32_16x16x32_bf16 v[64:67], v[32:35], v[192:195], 0
    v_cvt_pk_bf16_f32 v149, v106, v110
    v_cvt_pk_bf16_f32 v151, v107, v111
    v_mfma_f32_16x16x32_bf16 v[64:67], v[36:39], v[196:199], v[64:67]
    v_cvt_pk_bf16_f32 v152, v112, v116
    v_cvt_pk_bf16_f32 v154, v113, v117
    v_mfma_f32_16x16x32_bf16 v[68:71], v[32:35], v[200:203], 0
    v_cvt_pk_bf16_f32 v156, v114, v118
    v_cvt_pk_bf16_f32 v158, v115, v119
    v_mfma_f32_16x16x32_bf16 v[68:71], v[36:39], v[204:207], v[68:71]
    v_cvt_pk_bf16_f32 v153, v120, v124
    v_cvt_pk_bf16_f32 v155, v121, v125
    v_mfma_f32_16x16x32_bf16 v[72:75], v[32:35], v[208:211], 0
    v_cvt_pk_bf16_f32 v157, v122, v126
    v_cvt_pk_bf16_f32 v159, v123, v127
    v_mfma_f32_16x16x32_bf16 v[72:75], v[36:39], v[212:215], v[72:75]
    v_mfma_f32_16x16x32_bf16 v[76:79], v[32:35], v[216:219], 0
    ds_read_b128 a[192:195], v1 offset:0
    v_cvt_pk_bf16_f32 v160, v64, v68
    v_mfma_f32_16x16x32_bf16 v[76:79], v[36:39], v[220:223], v[76:79]
    v_cvt_pk_bf16_f32 v162, v65, v69
    v_cvt_pk_bf16_f32 v164, v66, v70
    v_mfma_f32_16x16x32_bf16 v[80:83], v[40:43], v[192:195], 0
    ds_read_b128 a[196:199], v1 offset:1024
    v_cvt_pk_bf16_f32 v166, v67, v71
    v_mfma_f32_16x16x32_bf16 v[80:83], v[44:47], v[196:199], v[80:83]
    s_waitcnt vmcnt(17)
    ds_write_b64 v4, a[176:177] offset:0
    v_mfma_f32_16x16x32_bf16 v[84:87], v[40:43], v[200:203], 0
    ds_read_b128 a[200:203], v1 offset:2048
    v_cvt_pk_bf16_f32 v161, v72, v76
    v_mfma_f32_16x16x32_bf16 v[84:87], v[44:47], v[204:207], v[84:87]
    ds_write_b64 v4, a[178:179] offset:1024
    v_mfma_f32_16x16x32_bf16 v[88:91], v[40:43], v[208:211], 0
    ds_read_b128 a[204:207], v1 offset:3072
    v_cvt_pk_bf16_f32 v163, v73, v77
    v_mfma_f32_16x16x32_bf16 v[88:91], v[44:47], v[212:215], v[88:91]
    ds_write_b64 v4, a[180:181] offset:512
    v_mfma_f32_16x16x32_bf16 v[92:95], v[40:43], v[216:219], 0
    buffer_store_dwordx2 v[128:129], v11, s[12:15], s32 offen offset:128 sc1
    v_mfma_f32_16x16x32_bf16 v[92:95], v[44:47], v[220:223], v[92:95]
    ds_read_b128 a[208:211], v1 offset:4096
    v_cvt_pk_bf16_f32 v165, v74, v78
    v_mfma_f32_16x16x32_bf16 v[96:99], v[48:51], v[192:195], 0
    ds_read_b128 a[212:215], v1 offset:5120
    v_cvt_pk_bf16_f32 v167, v75, v79
    v_mfma_f32_16x16x32_bf16 v[96:99], v[52:55], v[196:199], v[96:99]
    ds_write_b64 v4, a[182:183] offset:1536
    v_mfma_f32_16x16x32_bf16 v[100:103], v[48:51], v[200:203], 0
    ds_read_b128 a[216:219], v1 offset:6144
    v_cvt_pk_bf16_f32 v168, v80, v84
    v_mfma_f32_16x16x32_bf16 v[100:103], v[52:55], v[204:207], v[100:103]
    ds_read2_b64 a[176:179], v5 offset0:0 offset1:128
    v_cvt_pk_bf16_f32 v169, v88, v92
    v_mfma_f32_16x16x32_bf16 v[104:107], v[48:51], v[208:211], 0
    ds_read_b128 a[220:223], v1 offset:7168
    v_cvt_pk_bf16_f32 v170, v81, v85
    v_mfma_f32_16x16x32_bf16 v[104:107], v[52:55], v[212:215], v[104:107]
    ds_read2_b64 a[180:183], v6 offset0:0 offset1:128
    v_cvt_pk_bf16_f32 v171, v89, v93
    v_mfma_f32_16x16x32_bf16 v[108:111], v[48:51], v[216:219], 0
    buffer_store_dwordx2 v[130:131], v11, s[12:15], s32 offen offset:512 sc1
    v_mfma_f32_16x16x32_bf16 v[108:111], v[52:55], v[220:223], v[108:111]
    ds_read_b128 a[224:227], v1 offset:8192
    v_cvt_pk_bf16_f32 v176, v96, v100
    v_mfma_f32_16x16x32_bf16 v[112:115], v[56:59], v[192:195], 0
    ds_read_b128 a[228:231], v1 offset:9216
    v_cvt_pk_bf16_f32 v178, v97, v101
    v_mfma_f32_16x16x32_bf16 v[112:115], v[60:63], v[196:199], v[112:115]
    s_waitcnt vmcnt(15)
    ds_write_b64 v4, a[184:185] offset:0
    v_mfma_f32_16x16x32_bf16 v[116:119], v[56:59], v[200:203], 0
    ds_read_b128 a[232:235], v1 offset:10240
    v_cvt_pk_bf16_f32 v180, v98, v102
    v_mfma_f32_16x16x32_bf16 v[116:119], v[60:63], v[204:207], v[116:119]
    ds_write_b64 v4, a[186:187] offset:1024
    v_mfma_f32_16x16x32_bf16 v[120:123], v[56:59], v[208:211], 0
    ds_read_b128 a[236:239], v1 offset:11264
    v_cvt_pk_bf16_f32 v182, v99, v103
    v_mfma_f32_16x16x32_bf16 v[120:123], v[60:63], v[212:215], v[120:123]
    ds_write_b64 v4, a[188:189] offset:512
    v_mfma_f32_16x16x32_bf16 v[124:127], v[56:59], v[216:219], 0
    buffer_store_dwordx2 v[132:133], v11, s[12:15], s32 offen offset:896 sc1
    v_mfma_f32_16x16x32_bf16 v[124:127], v[60:63], v[220:223], v[124:127]
    ds_read_b128 a[240:243], v1 offset:12288
    s_waitcnt lgkmcnt(11)
L_win3:
    v_mfma_f32_16x16x32_bf16 v[96:99], a[192:195], a[96:99], 0
    ds_read_b128 a[244:247], v1 offset:13312
    v_cvt_pk_bf16_f32 v184, v112, v116
    v_mfma_f32_16x16x32_bf16 v[96:99], a[196:199], a[100:103], v[96:99]
    ds_write_b64 v4, a[190:191] offset:1536
    v_mfma_f32_16x16x32_bf16 v[96:99], a[200:203], a[104:107], v[96:99]
    ds_read_b128 a[248:251], v1 offset:14336
    v_cvt_pk_bf16_f32 v186, v113, v117
    v_mfma_f32_16x16x32_bf16 v[96:99], a[204:207], a[108:111], v[96:99]
    ds_read2_b64 a[184:187], v5 offset0:0 offset1:128
    v_cvt_pk_bf16_f32 v188, v114, v118
    v_mfma_f32_16x16x32_bf16 v[96:99], a[208:211], a[112:115], v[96:99]
    ds_read_b128 a[252:255], v1 offset:15360
    v_cvt_pk_bf16_f32 v190, v115, v119
    v_mfma_f32_16x16x32_bf16 v[96:99], a[212:215], a[116:119], v[96:99]
    ds_read2_b64 a[188:191], v6 offset0:0 offset1:128
    v_cvt_pk_bf16_f32 v172, v82, v86
    v_mfma_f32_16x16x32_bf16 v[100:103], a[192:195], a[120:123], 0
    buffer_store_dwordx2 v[134:135], v11, s[12:15], s32 offen offset:1280 sc1
    v_mfma_f32_16x16x32_bf16 v[100:103], a[196:199], a[124:127], v[100:103]
    ds_read_b128 a[192:195], v1 offset:16384
    v_cvt_pk_bf16_f32 v173, v90, v94
    v_mfma_f32_16x16x32_bf16 v[100:103], a[200:203], a[128:131], v[100:103]
    ds_read_b128 a[196:199], v1 offset:17408
    v_cvt_pk_bf16_f32 v192, v96, v97
    v_mfma_f32_16x16x32_bf16 v[100:103], a[204:207], a[132:135], v[100:103]
    v_cvt_pk_bf16_f32 v193, v98, v99
    v_cvt_pk_bf16_f32 v174, v83, v87
    v_mfma_f32_16x16x32_bf16 v[100:103], a[208:211], a[136:139], v[100:103]
    ds_read_b128 a[200:203], v1 offset:18432
    v_cvt_pk_bf16_f32 v175, v91, v95
    v_mfma_f32_16x16x32_bf16 v[100:103], a[212:215], a[140:143], v[100:103]
    v_cvt_pk_bf16_f32 v177, v104, v108
    v_cvt_pk_bf16_f32 v179, v105, v109
    v_mfma_f32_16x16x32_bf16 v[112:115], a[216:219], a[96:99], 0
    ds_read_b128 a[204:207], v1 offset:19456
    s_waitcnt lgkmcnt(10)
    v_mfma_f32_16x16x32_bf16 v[112:115], a[220:223], a[100:103], v[112:115]
    v_cvt_pk_bf16_f32 v181, v106, v110
    v_cvt_pk_bf16_f32 v183, v107, v111
    v_mfma_f32_16x16x32_bf16 v[112:115], a[224:227], a[104:107], v[112:115]
    buffer_store_dwordx2 v[136:137], v11, s[12:15], s34 offen offset:128 sc1
    v_mfma_f32_16x16x32_bf16 v[112:115], a[228:231], a[108:111], v[112:115]
    ds_read_b128 a[208:211], v1 offset:20480
    v_cvt_pk_bf16_f32 v196, v100, v101
    v_mfma_f32_16x16x32_bf16 v[112:115], a[232:235], a[112:115], v[112:115]
    ds_read_b128 a[212:215], v1 offset:21504
    v_cvt_pk_bf16_f32 v197, v102, v103
    v_mfma_f32_16x16x32_bf16 v[112:115], a[236:239], a[116:119], v[112:115]
    v_cvt_pk_bf16_f32 v185, v120, v124
    v_cvt_pk_bf16_f32 v187, v121, v125
    v_mfma_f32_16x16x32_bf16 v[116:119], a[216:219], a[120:123], 0
    v_cvt_pk_bf16_f32 v189, v122, v126
    v_cvt_pk_bf16_f32 v191, v123, v127
    v_mfma_f32_16x16x32_bf16 v[116:119], a[220:223], a[124:127], v[116:119]
    ds_read_b128 a[216:219], v1 offset:22528
    v_mfma_f32_16x16x32_bf16 v[116:119], a[224:227], a[128:131], v[116:119]
    ds_read_b128 a[220:223], v1 offset:23552
    v_cvt_pk_bf16_f32 v194, v112, v113
    v_mfma_f32_16x16x32_bf16 v[116:119], a[228:231], a[132:135], v[116:119]
    v_cvt_pk_bf16_f32 v195, v114, v115
    v_mfma_f32_16x16x32_bf16 v[116:119], a[232:235], a[136:139], v[116:119]
    buffer_store_dwordx2 v[138:139], v11, s[12:15], s34 offen offset:512 sc1
    v_mfma_f32_16x16x32_bf16 v[116:119], a[236:239], a[140:143], v[116:119]
    ds_read_b128 a[224:227], v1 offset:24576
    v_mfma_f32_16x16x32_bf16 v[96:99], a[240:243], a[96:99], 0
    ds_read_b128 a[228:231], v1 offset:25600
    s_waitcnt lgkmcnt(7)
    v_mfma_f32_16x16x32_bf16 v[96:99], a[244:247], a[100:103], v[96:99]
    v_mfma_f32_16x16x32_bf16 v[96:99], a[248:251], a[104:107], v[96:99]
    ds_read_b128 a[232:235], v1 offset:26624
    v_cvt_pk_bf16_f32 v198, v116, v117
    v_mfma_f32_16x16x32_bf16 v[96:99], a[252:255], a[108:111], v[96:99]
    v_cvt_pk_bf16_f32 v199, v118, v119
    v_mfma_f32_16x16x32_bf16 v[96:99], a[192:195], a[112:115], v[96:99]
    ds_read_b128 a[236:239], v1 offset:27648
    v_mfma_f32_16x16x32_bf16 v[96:99], a[196:199], a[116:119], v[96:99]
    v_mfma_f32_16x16x32_bf16 v[100:103], a[240:243], a[120:123], 0
    buffer_store_dwordx2 v[140:141], v11, s[12:15], s34 offen offset:896 sc1
    v_mfma_f32_16x16x32_bf16 v[100:103], a[244:247], a[124:127], v[100:103]
    ds_read_b128 a[240:243], v1 offset:28672
    v_mfma_f32_16x16x32_bf16 v[100:103], a[248:251], a[128:131], v[100:103]
    ds_read_b128 a[244:247], v1 offset:29696
    v_cvt_pk_bf16_f32 v208, v96, v97
    v_mfma_f32_16x16x32_bf16 v[100:103], a[252:255], a[132:135], v[100:103]
    v_cvt_pk_bf16_f32 v209, v98, v99
    v_mfma_f32_16x16x32_bf16 v[100:103], a[192:195], a[136:139], v[100:103]
    v_mfma_f32_16x16x32_bf16 v[100:103], a[196:199], a[140:143], v[100:103]
    v_mfma_f32_16x16x32_bf16 v[112:115], a[200:203], a[96:99], 0
    s_waitcnt lgkmcnt(5)
    v_mfma_f32_16x16x32_bf16 v[112:115], a[204:207], a[100:103], v[112:115]
    v_mfma_f32_16x16x32_bf16 v[112:115], a[208:211], a[104:107], v[112:115]
    buffer_store_dwordx2 v[142:143], v11, s[12:15], s34 offen offset:1280 sc1
    v_mfma_f32_16x16x32_bf16 v[112:115], a[212:215], a[108:111], v[112:115]
    v_cvt_pk_bf16_f32 v212, v100, v101
    v_cvt_pk_bf16_f32 v213, v102, v103
    v_mfma_f32_16x16x32_bf16 v[112:115], a[216:219], a[112:115], v[112:115]
    v_mfma_f32_16x16x32_bf16 v[112:115], a[220:223], a[116:119], v[112:115]
    v_mfma_f32_16x16x32_bf16 v[116:119], a[200:203], a[120:123], 0
    v_mfma_f32_16x16x32_bf16 v[116:119], a[204:207], a[124:127], v[116:119]
    v_mfma_f32_16x16x32_bf16 v[116:119], a[208:211], a[128:131], v[116:119]
    v_cvt_pk_bf16_f32 v210, v112, v113
    v_cvt_pk_bf16_f32 v211, v114, v115
    v_mfma_f32_16x16x32_bf16 v[116:119], a[212:215], a[132:135], v[116:119]
    v_mfma_f32_16x16x32_bf16 v[116:119], a[216:219], a[136:139], v[116:119]
    buffer_store_dwordx2 v[144:145], v11, s[12:15], s36 offen offset:128 sc1
    v_mfma_f32_16x16x32_bf16 v[116:119], a[220:223], a[140:143], v[116:119]
    v_mfma_f32_16x16x32_bf16 v[96:99], a[224:227], a[96:99], 0
    s_waitcnt lgkmcnt(0)
    v_mfma_f32_16x16x32_bf16 v[96:99], a[228:231], a[100:103], v[96:99]
    v_mfma_f32_16x16x32_bf16 v[96:99], a[232:235], a[104:107], v[96:99]
    ds_read_b128 a[248:251], v1 offset:30720
    v_cvt_pk_bf16_f32 v214, v116, v117
    v_mfma_f32_16x16x32_bf16 v[96:99], a[236:239], a[108:111], v[96:99]
    v_cvt_pk_bf16_f32 v215, v118, v119
    v_mfma_f32_16x16x32_bf16 v[96:99], a[240:243], a[112:115], v[96:99]
    ds_read_b128 a[252:255], v1 offset:31744
    v_mfma_f32_16x16x32_bf16 v[96:99], a[244:247], a[116:119], v[96:99]
    v_mfma_f32_16x16x32_bf16 v[100:103], a[224:227], a[120:123], 0
    buffer_store_dwordx2 v[146:147], v11, s[12:15], s36 offen offset:512 sc1
    v_mfma_f32_16x16x32_bf16 v[100:103], a[228:231], a[124:127], v[100:103]
    ds_read_b128 a[192:195], v1 offset:32768
    v_mfma_f32_16x16x32_bf16 v[100:103], a[232:235], a[128:131], v[100:103]
    ds_read_b128 a[196:199], v1 offset:33792
    v_mfma_f32_16x16x32_bf16 v[100:103], a[236:239], a[132:135], v[100:103]
    v_mfma_f32_16x16x32_bf16 v[100:103], a[240:243], a[136:139], v[100:103]
    ds_read_b128 a[200:203], v1 offset:34816
    v_mfma_f32_16x16x32_bf16 v[100:103], a[244:247], a[140:143], v[100:103]
    v_mfma_f32_16x16x32_bf16 v[32:35], a[96:99], v[192:195], 0
    ds_read_b128 a[204:207], v1 offset:35840
    v_mfma_f32_16x16x32_bf16 v[32:35], a[100:103], v[208:211], v[32:35]
    v_mfma_f32_16x16x32_bf16 v[36:39], a[120:123], v[192:195], 0
    buffer_store_dwordx2 v[148:149], v11, s[12:15], s36 offen offset:896 sc1
    v_mfma_f32_16x16x32_bf16 v[36:39], a[124:127], v[208:211], v[36:39]
    ds_read_b128 a[208:211], v1 offset:36864
    v_mfma_f32_16x16x32_bf16 v[40:43], a[144:147], v[192:195], 0
    ds_read_b128 a[212:215], v1 offset:37888
    v_mfma_f32_16x16x32_bf16 v[40:43], a[148:151], v[208:211], v[40:43]
    v_mfma_f32_16x16x32_bf16 v[44:47], a[168:171], v[192:195], 0
    ds_read_b128 a[216:219], v1 offset:38912
    v_cvt_pk_bf16_f32 v192, v96, v97
    v_mfma_f32_16x16x32_bf16 v[44:47], a[172:175], v[208:211], v[44:47]
    v_cvt_pk_bf16_f32 v193, v98, v99
    v_mfma_f32_16x16x32_bf16 v[48:51], a[96:99], v[196:199], 0
    ds_read_b128 a[220:223], v1 offset:39936
    v_mfma_f32_16x16x32_bf16 v[48:51], a[100:103], v[212:215], v[48:51]
    v_mfma_f32_16x16x32_bf16 v[52:55], a[120:123], v[196:199], 0
    buffer_store_dwordx2 v[150:151], v11, s[12:15], s36 offen offset:1280 sc1
    v_mfma_f32_16x16x32_bf16 v[52:55], a[124:127], v[212:215], v[52:55]
    ds_read_b128 a[224:227], v1 offset:40960
    v_mfma_f32_16x16x32_bf16 v[56:59], a[144:147], v[196:199], 0
    ds_read_b128 a[228:231], v1 offset:41984
    v_mfma_f32_16x16x32_bf16 v[56:59], a[148:151], v[212:215], v[56:59]
    v_mfma_f32_16x16x32_bf16 v[60:63], a[168:171], v[196:199], 0
    ds_read_b128 a[232:235], v1 offset:43008
    v_cvt_pk_bf16_f32 v196, v100, v101
    v_mfma_f32_16x16x32_bf16 v[60:63], a[172:175], v[212:215], v[60:63]
    v_cvt_pk_bf16_f32 v197, v102, v103
    s_waitcnt lgkmcnt(7)
    v_mfma_f32_16x16x32_bf16 v[112:115], a[248:251], a[96:99], 0
    ds_read_b128 a[236:239], v1 offset:44032
    v_mfma_f32_16x16x32_bf16 v[112:115], a[252:255], a[100:103], v[112:115]
    v_mfma_f32_16x16x32_bf16 v[112:115], a[192:195], a[104:107], v[112:115]
    buffer_store_dwordx2 v[152:153], v11, s[12:15], s38 offen offset:128 sc1
    v_mfma_f32_16x16x32_bf16 v[112:115], a[196:199], a[108:111], v[112:115]
    ds_read_b128 a[240:243], v1 offset:45056
    v_mfma_f32_16x16x32_bf16 v[112:115], a[200:203], a[112:115], v[112:115]
    ds_read_b128 a[244:247], v1 offset:46080
    v_mfma_f32_16x16x32_bf16 v[112:115], a[204:207], a[116:119], v[112:115]
    v_mfma_f32_16x16x32_bf16 v[116:119], a[248:251], a[120:123], 0
    v_mfma_f32_16x16x32_bf16 v[116:119], a[252:255], a[124:127], v[116:119]
    ds_read_b128 a[248:251], v1 offset:47104
    v_mfma_f32_16x16x32_bf16 v[116:119], a[192:195], a[128:131], v[116:119]
    ds_read_b128 a[252:255], v1 offset:48128
    v_cvt_pk_bf16_f32 v194, v112, v113
    v_mfma_f32_16x16x32_bf16 v[116:119], a[196:199], a[132:135], v[116:119]
    v_cvt_pk_bf16_f32 v195, v114, v115
    v_mfma_f32_16x16x32_bf16 v[116:119], a[200:203], a[136:139], v[116:119]
    buffer_store_dwordx2 v[154:155], v11, s[12:15], s38 offen offset:512 sc1
    v_mfma_f32_16x16x32_bf16 v[116:119], a[204:207], a[140:143], v[116:119]
    ds_read_b128 a[192:195], v1 offset:49152
    s_waitcnt lgkmcnt(6)
    v_mfma_f32_16x16x32_bf16 v[96:99], a[208:211], a[96:99], 0
    ds_read_b128 a[196:199], v1 offset:50176
    v_mfma_f32_16x16x32_bf16 v[96:99], a[212:215], a[100:103], v[96:99]
    v_mfma_f32_16x16x32_bf16 v[96:99], a[216:219], a[104:107], v[96:99]
    ds_read_b128 a[200:203], v1 offset:51200
    v_cvt_pk_bf16_f32 v198, v116, v117
    v_mfma_f32_16x16x32_bf16 v[96:99], a[220:223], a[108:111], v[96:99]
    v_cvt_pk_bf16_f32 v199, v118, v119
    v_mfma_f32_16x16x32_bf16 v[96:99], a[224:227], a[112:115], v[96:99]
    ds_read_b128 a[204:207], v1 offset:52224
    v_mfma_f32_16x16x32_bf16 v[96:99], a[228:231], a[116:119], v[96:99]
    v_mfma_f32_16x16x32_bf16 v[100:103], a[208:211], a[120:123], 0
    buffer_store_dwordx2 v[156:157], v11, s[12:15], s38 offen offset:896 sc1
    v_mfma_f32_16x16x32_bf16 v[100:103], a[212:215], a[124:127], v[100:103]
    ds_read_b128 a[208:211], v1 offset:53248
    v_mfma_f32_16x16x32_bf16 v[100:103], a[216:219], a[128:131], v[100:103]
    ds_read_b128 a[212:215], v1 offset:54272
    v_cvt_pk_bf16_f32 v208, v96, v97
    v_mfma_f32_16x16x32_bf16 v[100:103], a[220:223], a[132:135], v[100:103]
    v_cvt_pk_bf16_f32 v209, v98, v99
    v_mfma_f32_16x16x32_bf16 v[100:103], a[224:227], a[136:139], v[100:103]
    v_mfma_f32_16x16x32_bf16 v[100:103], a[228:231], a[140:143], v[100:103]
    v_mfma_f32_16x16x32_bf16 v[112:115], a[232:235], a[96:99], 0
    s_waitcnt lgkmcnt(5)
    v_mfma_f32_16x16x32_bf16 v[112:115], a[236:239], a[100:103], v[112:115]
    v_mfma_f32_16x16x32_bf16 v[112:115], a[240:243], a[104:107], v[112:115]
    buffer_store_dwordx2 v[158:159], v11, s[12:15], s38 offen offset:1280 sc1
    v_mfma_f32_16x16x32_bf16 v[112:115], a[244:247], a[108:111], v[112:115]
    v_cvt_pk_bf16_f32 v212, v100, v101
    v_cvt_pk_bf16_f32 v213, v102, v103
    v_mfma_f32_16x16x32_bf16 v[112:115], a[248:251], a[112:115], v[112:115]
    v_mfma_f32_16x16x32_bf16 v[112:115], a[252:255], a[116:119], v[112:115]
    v_mfma_f32_16x16x32_bf16 v[116:119], a[232:235], a[120:123], 0
    v_mfma_f32_16x16x32_bf16 v[116:119], a[236:239], a[124:127], v[116:119]
    v_mfma_f32_16x16x32_bf16 v[116:119], a[240:243], a[128:131], v[116:119]
    v_cvt_pk_bf16_f32 v210, v112, v113
    v_cvt_pk_bf16_f32 v211, v114, v115
    v_mfma_f32_16x16x32_bf16 v[116:119], a[244:247], a[132:135], v[116:119]
    v_mfma_f32_16x16x32_bf16 v[116:119], a[248:251], a[136:139], v[116:119]
    buffer_store_dwordx2 v[160:161], v11, s[12:15], s32 offen offset:256 sc1
    v_mfma_f32_16x16x32_bf16 v[116:119], a[252:255], a[140:143], v[116:119]
    v_mfma_f32_16x16x32_bf16 v[96:99], a[192:195], a[96:99], 0
    s_waitcnt lgkmcnt(0)
    v_mfma_f32_16x16x32_bf16 v[96:99], a[196:199], a[100:103], v[96:99]
    v_mfma_f32_16x16x32_bf16 v[96:99], a[200:203], a[104:107], v[96:99]
    ds_read_b128 a[216:219], v1 offset:55296
    v_cvt_pk_bf16_f32 v214, v116, v117
    v_mfma_f32_16x16x32_bf16 v[96:99], a[204:207], a[108:111], v[96:99]
    v_cvt_pk_bf16_f32 v215, v118, v119
    v_mfma_f32_16x16x32_bf16 v[96:99], a[208:211], a[112:115], v[96:99]
    ds_read_b128 a[220:223], v1 offset:56320
    v_mfma_f32_16x16x32_bf16 v[96:99], a[212:215], a[116:119], v[96:99]
    v_mfma_f32_16x16x32_bf16 v[100:103], a[192:195], a[120:123], 0
    buffer_store_dwordx2 v[162:163], v11, s[12:15], s32 offen offset:640 sc1
    v_mfma_f32_16x16x32_bf16 v[100:103], a[196:199], a[124:127], v[100:103]
    ds_read_b128 a[224:227], v1 offset:57344
    v_mfma_f32_16x16x32_bf16 v[100:103], a[200:203], a[128:131], v[100:103]
    ds_read_b128 a[228:231], v1 offset:58368
    v_mfma_f32_16x16x32_bf16 v[100:103], a[204:207], a[132:135], v[100:103]
    v_mfma_f32_16x16x32_bf16 v[100:103], a[208:211], a[136:139], v[100:103]
    ds_read_b128 a[232:235], v1 offset:59392
    v_mfma_f32_16x16x32_bf16 v[100:103], a[212:215], a[140:143], v[100:103]
    v_mfma_f32_16x16x32_bf16 v[32:35], a[104:107], v[192:195], v[32:35]
    ds_read_b128 a[236:239], v1 offset:60416
    v_mfma_f32_16x16x32_bf16 v[32:35], a[108:111], v[208:211], v[32:35]
    v_mfma_f32_16x16x32_bf16 v[36:39], a[128:131], v[192:195], v[36:39]
    buffer_store_dwordx2 v[164:165], v11, s[12:15], s32 offen offset:1024 sc1
    v_mfma_f32_16x16x32_bf16 v[36:39], a[132:135], v[208:211], v[36:39]
    ds_read_b128 a[240:243], v1 offset:61440
    v_mfma_f32_16x16x32_bf16 v[40:43], a[152:155], v[192:195], v[40:43]
    ds_read_b128 a[244:247], v1 offset:62464
    v_mfma_f32_16x16x32_bf16 v[40:43], a[156:159], v[208:211], v[40:43]
    v_mfma_f32_16x16x32_bf16 v[44:47], a[176:179], v[192:195], v[44:47]
    ds_read_b128 a[248:251], v1 offset:63488
    v_cvt_pk_bf16_f32 v192, v96, v97
    v_mfma_f32_16x16x32_bf16 v[44:47], a[180:183], v[208:211], v[44:47]
    v_cvt_pk_bf16_f32 v193, v98, v99
    v_mfma_f32_16x16x32_bf16 v[48:51], a[104:107], v[196:199], v[48:51]
    ds_read_b128 a[252:255], v1 offset:64512
    v_mfma_f32_16x16x32_bf16 v[48:51], a[108:111], v[212:215], v[48:51]
    v_mfma_f32_16x16x32_bf16 v[52:55], a[128:131], v[196:199], v[52:55]
    buffer_store_dwordx2 v[166:167], v11, s[12:15], s32 offen offset:1408 sc1
    v_mfma_f32_16x16x32_bf16 v[52:55], a[132:135], v[212:215], v[52:55]
    ds_read_b128 a[192:195], v2 offset:0
    v_mfma_f32_16x16x32_bf16 v[56:59], a[152:155], v[196:199], v[56:59]
    ds_read_b128 a[196:199], v2 offset:1024
    v_mfma_f32_16x16x32_bf16 v[56:59], a[156:159], v[212:215], v[56:59]
    v_mfma_f32_16x16x32_bf16 v[60:63], a[176:179], v[196:199], v[60:63]
    ds_read_b128 a[200:203], v2 offset:2048
    v_cvt_pk_bf16_f32 v196, v100, v101
    v_mfma_f32_16x16x32_bf16 v[60:63], a[180:183], v[212:215], v[60:63]
    v_cvt_pk_bf16_f32 v197, v102, v103
    s_waitcnt lgkmcnt(7)
    v_mfma_f32_16x16x32_bf16 v[112:115], a[216:219], a[96:99], 0
    ds_read_b128 a[204:207], v2 offset:3072
    v_mfma_f32_16x16x32_bf16 v[112:115], a[220:223], a[100:103], v[112:115]
    v_mfma_f32_16x16x32_bf16 v[112:115], a[224:227], a[104:107], v[112:115]
    buffer_store_dwordx2 v[168:169], v11, s[12:15], s34 offen offset:256 sc1
    v_mfma_f32_16x16x32_bf16 v[112:115], a[228:231], a[108:111], v[112:115]
    ds_read_b128 a[208:211], v2 offset:4096
    v_mfma_f32_16x16x32_bf16 v[112:115], a[232:235], a[112:115], v[112:115]
    ds_read_b128 a[212:215], v2 offset:5120
    v_mfma_f32_16x16x32_bf16 v[112:115], a[236:239], a[116:119], v[112:115]
    v_mfma_f32_16x16x32_bf16 v[116:119], a[216:219], a[120:123], 0
    v_mfma_f32_16x16x32_bf16 v[116:119], a[220:223], a[124:127], v[116:119]
    ds_read_b128 a[216:219], v2 offset:6144
    v_mfma_f32_16x16x32_bf16 v[116:119], a[224:227], a[128:131], v[116:119]
    ds_read_b128 a[220:223], v2 offset:7168
    v_cvt_pk_bf16_f32 v194, v112, v113
    v_mfma_f32_16x16x32_bf16 v[116:119], a[228:231], a[132:135], v[116:119]
    v_cvt_pk_bf16_f32 v195, v114, v115
    v_mfma_f32_16x16x32_bf16 v[116:119], a[232:235], a[136:139], v[116:119]
    buffer_store_dwordx2 v[170:171], v11, s[12:15], s34 offen offset:640 sc1
    v_mfma_f32_16x16x32_bf16 v[116:119], a[236:239], a[140:143], v[116:119]
    ds_read_b128 a[224:227], v1 offset:0
    s_waitcnt lgkmcnt(6)
    v_mfma_f32_16x16x32_bf16 v[96:99], a[240:243], a[96:99], 0
    ds_read_b128 a[228:231], v1 offset:1024
    v_mfma_f32_16x16x32_bf16 v[96:99], a[244:247], a[100:103], v[96:99]
    v_mfma_f32_16x16x32_bf16 v[96:99], a[248:251], a[104:107], v[96:99]
    ds_read_b128 a[232:235], v1 offset:2048
    v_cvt_pk_bf16_f32 v198, v116, v117
    v_mfma_f32_16x16x32_bf16 v[96:99], a[252:255], a[108:111], v[96:99]
    v_cvt_pk_bf16_f32 v199, v118, v119
    v_mfma_f32_16x16x32_bf16 v[96:99], a[192:195], a[112:115], v[96:99]
    ds_read_b128 a[236:239], v1 offset:3072
    v_mfma_f32_16x16x32_bf16 v[96:99], a[196:199], a[116:119], v[96:99]
    v_mfma_f32_16x16x32_bf16 v[100:103], a[240:243], a[120:123], 0
    buffer_store_dwordx2 v[172:173], v11, s[12:15], s34 offen offset:1024 sc1
    v_mfma_f32_16x16x32_bf16 v[100:103], a[244:247], a[124:127], v[100:103]
    ds_read_b128 a[240:243], v1 offset:4096
    v_mfma_f32_16x16x32_bf16 v[100:103], a[248:251], a[128:131], v[100:103]
    ds_read_b128 a[244:247], v1 offset:5120
    v_cvt_pk_bf16_f32 v208, v96, v97
    v_mfma_f32_16x16x32_bf16 v[100:103], a[252:255], a[132:135], v[100:103]
    v_cvt_pk_bf16_f32 v209, v98, v99
    v_mfma_f32_16x16x32_bf16 v[100:103], a[192:195], a[136:139], v[100:103]
    v_mfma_f32_16x16x32_bf16 v[100:103], a[196:199], a[140:143], v[100:103]
    v_mfma_f32_16x16x32_bf16 v[112:115], a[200:203], a[96:99], 0
    s_waitcnt lgkmcnt(5)
    v_mfma_f32_16x16x32_bf16 v[112:115], a[204:207], a[100:103], v[112:115]
    v_mfma_f32_16x16x32_bf16 v[112:115], a[208:211], a[104:107], v[112:115]
    buffer_store_dwordx2 v[174:175], v11, s[12:15], s34 offen offset:1408 sc1
    v_mfma_f32_16x16x32_bf16 v[112:115], a[212:215], a[108:111], v[112:115]
    v_cvt_pk_bf16_f32 v212, v100, v101
    v_cvt_pk_bf16_f32 v213, v102, v103
    v_mfma_f32_16x16x32_bf16 v[112:115], a[216:219], a[112:115], v[112:115]
    v_mfma_f32_16x16x32_bf16 v[112:115], a[220:223], a[116:119], v[112:115]
    v_mfma_f32_16x16x32_bf16 v[116:119], a[200:203], a[120:123], 0
    v_mfma_f32_16x16x32_bf16 v[116:119], a[204:207], a[124:127], v[116:119]
    v_mfma_f32_16x16x32_bf16 v[116:119], a[208:211], a[128:131], v[116:119]
    v_cvt_pk_bf16_f32 v210, v112, v113
    v_cvt_pk_bf16_f32 v211, v114, v115
    v_mfma_f32_16x16x32_bf16 v[116:119], a[212:215], a[132:135], v[116:119]
    v_mfma_f32_16x16x32_bf16 v[116:119], a[216:219], a[136:139], v[116:119]
    buffer_store_dwordx2 v[176:177], v11, s[12:15], s36 offen offset:256 sc1
    v_mfma_f32_16x16x32_bf16 v[116:119], a[220:223], a[140:143], v[116:119]
    v_mfma_f32_16x16x32_bf16 v[104:107], a[224:227], a[144:147], 0
    s_waitcnt lgkmcnt(0)
    v_mfma_f32_16x16x32_bf16 v[104:107], a[228:231], a[148:151], v[104:107]
    v_mfma_f32_16x16x32_bf16 v[104:107], a[232:235], a[152:155], v[104:107]
    ds_read_b128 a[248:251], v1 offset:6144
    v_cvt_pk_bf16_f32 v214, v116, v117
    v_mfma_f32_16x16x32_bf16 v[104:107], a[236:239], a[156:159], v[104:107]
    v_cvt_pk_bf16_f32 v215, v118, v119
    v_mfma_f32_16x16x32_bf16 v[104:107], a[240:243], a[160:163], v[104:107]
    ds_read_b128 a[252:255], v1 offset:7168
    v_mfma_f32_16x16x32_bf16 v[104:107], a[244:247], a[164:167], v[104:107]
    v_mfma_f32_16x16x32_bf16 v[108:111], a[224:227], a[168:171], 0
    buffer_store_dwordx2 v[178:179], v11, s[12:15], s36 offen offset:640 sc1
    v_mfma_f32_16x16x32_bf16 v[108:111], a[228:231], a[172:175], v[108:111]
    ds_read_b128 a[192:195], v1 offset:8192
    v_mfma_f32_16x16x32_bf16 v[108:111], a[232:235], a[176:179], v[108:111]
    ds_read_b128 a[196:199], v1 offset:9216
    v_cvt_pk_bf16_f32 v200, v104, v105
    v_mfma_f32_16x16x32_bf16 v[108:111], a[236:239], a[180:183], v[108:111]
    v_cvt_pk_bf16_f32 v201, v106, v107
    v_mfma_f32_16x16x32_bf16 v[108:111], a[240:243], a[184:187], v[108:111]
    ds_read_b128 a[200:203], v1 offset:10240
    v_mfma_f32_16x16x32_bf16 v[108:111], a[244:247], a[188:191], v[108:111]
    v_mfma_f32_16x16x32_bf16 v[32:35], a[112:115], v[192:195], v[32:35]
    ds_read_b128 a[204:207], v1 offset:11264
    v_mfma_f32_16x16x32_bf16 v[32:35], a[116:119], v[208:211], v[32:35]
    v_mfma_f32_16x16x32_bf16 v[36:39], a[136:139], v[192:195], v[36:39]
    buffer_store_dwordx2 v[180:181], v11, s[12:15], s36 offen offset:1024 sc1
    v_mfma_f32_16x16x32_bf16 v[36:39], a[140:143], v[208:211], v[36:39]
    ds_read_b128 a[208:211], v1 offset:12288
    v_cvt_pk_bf16_f32 v204, v108, v109
    v_mfma_f32_16x16x32_bf16 v[40:43], a[160:163], v[192:195], v[40:43]
    ds_read_b128 a[212:215], v1 offset:13312
    v_cvt_pk_bf16_f32 v205, v110, v111
    v_mfma_f32_16x16x32_bf16 v[40:43], a[164:167], v[208:211], v[40:43]
    v_max3_f32 v12, v32, v33, v34
    v_mfma_f32_16x16x32_bf16 v[44:47], a[184:187], v[192:195], v[44:47]
    ds_read_b128 a[216:219], v1 offset:14336
    v_max3_f32 v12, v12, v35, v36
    v_mfma_f32_16x16x32_bf16 v[44:47], a[188:191], v[208:211], v[44:47]
    v_max3_f32 v12, v12, v37, v38
    v_mfma_f32_16x16x32_bf16 v[48:51], a[112:115], v[196:199], v[48:51]
    ds_read_b128 a[220:223], v1 offset:15360
    v_max3_f32 v12, v12, v39, v40
    v_mfma_f32_16x16x32_bf16 v[48:51], a[116:119], v[212:215], v[48:51]
    v_max3_f32 v12, v12, v41, v42
    v_mfma_f32_16x16x32_bf16 v[52:55], a[136:139], v[196:199], v[52:55]
    buffer_store_dwordx2 v[182:183], v11, s[12:15], s36 offen offset:1408 sc1
    v_mfma_f32_16x16x32_bf16 v[52:55], a[140:143], v[212:215], v[52:55]
    ds_read_b128 a[224:227], v1 offset:16384
    v_max3_f32 v12, v12, v43, v44
    v_mfma_f32_16x16x32_bf16 v[56:59], a[160:163], v[196:199], v[56:59]
    ds_read_b128 a[228:231], v1 offset:17408
    v_max3_f32 v13, v48, v49, v50
    v_mfma_f32_16x16x32_bf16 v[56:59], a[164:167], v[212:215], v[56:59]
    v_max3_f32 v12, v12, v45, v46
    v_max_f32 v12, v12, v47
    v_mfma_f32_16x16x32_bf16 v[60:63], a[184:187], v[196:199], v[60:63]
    ds_read_b128 a[232:235], v1 offset:18432
    v_max3_f32 v13, v13, v51, v52
    v_mfma_f32_16x16x32_bf16 v[60:63], a[188:191], v[212:215], v[60:63]
    v_max3_f32 v13, v13, v53, v54
    s_waitcnt lgkmcnt(7)
    v_mfma_f32_16x16x32_bf16 v[120:123], a[248:251], a[144:147], 0
    ds_read_b128 a[236:239], v1 offset:19456
    v_max3_f32 v13, v13, v55, v56
    v_mfma_f32_16x16x32_bf16 v[120:123], a[252:255], a[148:151], v[120:123]
    v_max3_f32 v13, v13, v57, v58
    v_mfma_f32_16x16x32_bf16 v[120:123], a[192:195], a[152:155], v[120:123]
    buffer_store_dwordx2 v[184:185], v11, s[12:15], s38 offen offset:256 sc1
    v_mfma_f32_16x16x32_bf16 v[120:123], a[196:199], a[156:159], v[120:123]
    ds_read_b128 a[240:243], v1 offset:20480
    v_max3_f32 v13, v13, v59, v60
    v_mfma_f32_16x16x32_bf16 v[120:123], a[200:203], a[160:163], v[120:123]
    ds_read_b128 a[244:247], v1 offset:21504
    v_max3_f32 v13, v13, v61, v62
    v_mfma_f32_16x16x32_bf16 v[120:123], a[204:207], a[164:167], v[120:123]
    v_max_f32 v13, v13, v63
    v_mfma_f32_16x16x32_bf16 v[124:127], a[248:251], a[168:171], 0
    v_mfma_f32_16x16x32_bf16 v[124:127], a[252:255], a[172:175], v[124:127]
    ds_read_b128 a[248:251], v1 offset:22528
    v_permlane16_swap_b32 v12, v13
    v_mfma_f32_16x16x32_bf16 v[124:127], a[192:195], a[176:179], v[124:127]
    ds_read_b128 a[252:255], v1 offset:23552
    v_cvt_pk_bf16_f32 v202, v120, v121
    v_mfma_f32_16x16x32_bf16 v[124:127], a[196:199], a[180:183], v[124:127]
    v_cvt_pk_bf16_f32 v203, v122, v123
    v_max_f32 v12, v12, v13
    v_mfma_f32_16x16x32_bf16 v[124:127], a[200:203], a[184:187], v[124:127]
    buffer_store_dwordx2 v[186:187], v11, s[12:15], s38 offen offset:640 sc1
    v_mfma_f32_16x16x32_bf16 v[124:127], a[204:207], a[188:191], v[124:127]
    ds_read_b128 a[192:195], v1 offset:24576
    s_waitcnt lgkmcnt(6)
    v_mfma_f32_16x16x32_bf16 v[104:107], a[208:211], a[144:147], 0
    ds_read_b128 a[196:199], v1 offset:25600
    v_mov_b32 v13, v12
    v_mfma_f32_16x16x32_bf16 v[104:107], a[212:215], a[148:151], v[104:107]
    v_mfma_f32_16x16x32_bf16 v[104:107], a[216:219], a[152:155], v[104:107]
    ds_read_b128 a[200:203], v1 offset:26624
    v_cvt_pk_bf16_f32 v206, v124, v125
    v_mfma_f32_16x16x32_bf16 v[104:107], a[220:223], a[156:159], v[104:107]
    v_cvt_pk_bf16_f32 v207, v126, v127
    v_permlane32_swap_b32 v12, v13
    v_mfma_f32_16x16x32_bf16 v[104:107], a[224:227], a[160:163], v[104:107]
    ds_read_b128 a[204:207], v1 offset:27648
    v_max_f32 v12, v12, v13
    v_mfma_f32_16x16x32_bf16 v[104:107], a[228:231], a[164:167], v[104:107]
    v_mov_b32 v13, v12
    v_mfma_f32_16x16x32_bf16 v[108:111], a[208:211], a[168:171], 0
    buffer_store_dwordx2 v[188:189], v11, s[12:15], s38 offen offset:1024 sc1
    v_mfma_f32_16x16x32_bf16 v[108:111], a[212:215], a[172:175], v[108:111]
    ds_read_b128 a[208:211], v1 offset:28672
    v_permlane16_swap_b32 v12, v13
    v_mfma_f32_16x16x32_bf16 v[108:111], a[216:219], a[176:179], v[108:111]
    ds_read_b128 a[212:215], v1 offset:29696
    v_cvt_pk_bf16_f32 v216, v104, v105
    v_mfma_f32_16x16x32_bf16 v[108:111], a[220:223], a[180:183], v[108:111]
    v_cvt_pk_bf16_f32 v217, v106, v107
    v_sub_f32 v32, v32, v12
    v_mfma_f32_16x16x32_bf16 v[108:111], a[224:227], a[184:187], v[108:111]
    v_sub_f32 v33, v33, v12
    v_sub_f32 v48, v48, v13
    v_mfma_f32_16x16x32_bf16 v[108:111], a[228:231], a[188:191], v[108:111]
    v_sub_f32 v49, v49, v13
    v_sub_f32 v34, v34, v12
    v_mfma_f32_16x16x32_bf16 v[120:123], a[232:235], a[144:147], 0
    v_sub_f32 v50, v50, v13
    s_waitcnt lgkmcnt(5)
    v_mfma_f32_16x16x32_bf16 v[120:123], a[236:239], a[148:151], v[120:123]
    v_exp_f32 v32, v32
    v_mfma_f32_16x16x32_bf16 v[120:123], a[240:243], a[152:155], v[120:123]
    buffer_store_dwordx2 v[190:191], v11, s[12:15], s38 offen offset:1408 sc1
    v_mfma_f32_16x16x32_bf16 v[120:123], a[244:247], a[156:159], v[120:123]
    v_cvt_pk_bf16_f32 v220, v108, v109
    v_cvt_pk_bf16_f32 v221, v110, v111
    v_mfma_f32_16x16x32_bf16 v[120:123], a[248:251], a[160:163], v[120:123]
    v_exp_f32 v33, v33
    v_mfma_f32_16x16x32_bf16 v[120:123], a[252:255], a[164:167], v[120:123]
    v_exp_f32 v48, v48
    v_mfma_f32_16x16x32_bf16 v[124:127], a[232:235], a[168:171], 0
    v_exp_f32 v49, v49
    v_mfma_f32_16x16x32_bf16 v[124:127], a[236:239], a[172:175], v[124:127]
    v_exp_f32 v34, v34
    v_mfma_f32_16x16x32_bf16 v[124:127], a[240:243], a[176:179], v[124:127]
    v_cvt_pk_bf16_f32 v218, v120, v121
    v_cvt_pk_bf16_f32 v219, v122, v123
    v_mfma_f32_16x16x32_bf16 v[124:127], a[244:247], a[180:183], v[124:127]
    v_sub_f32 v35, v35, v12
    v_sub_f32 v51, v51, v13
    v_mfma_f32_16x16x32_bf16 v[124:127], a[248:251], a[184:187], v[124:127]
    buffer_store_dwordx2 v[224:225], v11, s[12:15], s32 offen offset:0 sc1
    v_mfma_f32_16x16x32_bf16 v[124:127], a[252:255], a[188:191], v[124:127]
    v_exp_f32 v50, v50
    v_mfma_f32_16x16x32_bf16 v[104:107], a[192:195], a[144:147], 0
    v_sub_f32 v36, v36, v12
    s_waitcnt lgkmcnt(0)
    v_mfma_f32_16x16x32_bf16 v[104:107], a[196:199], a[148:151], v[104:107]
    v_exp_f32 v35, v35
    v_mfma_f32_16x16x32_bf16 v[104:107], a[200:203], a[152:155], v[104:107]
    ds_read_b128 a[216:219], v1 offset:30720
    v_cvt_pk_bf16_f32 v222, v124, v125
    v_mfma_f32_16x16x32_bf16 v[104:107], a[204:207], a[156:159], v[104:107]
    v_cvt_pk_bf16_f32 v223, v126, v127
    v_sub_f32 v52, v52, v13
    v_mfma_f32_16x16x32_bf16 v[104:107], a[208:211], a[160:163], v[104:107]
    ds_read_b128 a[220:223], v1 offset:31744
    v_add_f32 v20, v32, v33
    v_mfma_f32_16x16x32_bf16 v[104:107], a[212:215], a[164:167], v[104:107]
    v_exp_f32 v51, v51
    v_mfma_f32_16x16x32_bf16 v[108:111], a[192:195], a[168:171], 0
    buffer_store_dwordx2 v[226:227], v11, s[12:15], s32 offen offset:384 sc1
    v_mfma_f32_16x16x32_bf16 v[108:111], a[196:199], a[172:175], v[108:111]
    ds_read_b128 a[224:227], v1 offset:32768
    v_sub_f32 v37, v37, v12
    v_mfma_f32_16x16x32_bf16 v[108:111], a[200:203], a[176:179], v[108:111]
    ds_read_b128 a[228:231], v1 offset:33792
    v_add_f32 v21, v48, v49
    v_mfma_f32_16x16x32_bf16 v[108:111], a[204:207], a[180:183], v[108:111]
    v_exp_f32 v36, v36
    v_mfma_f32_16x16x32_bf16 v[108:111], a[208:211], a[184:187], v[108:111]
    ds_read_b128 a[232:235], v1 offset:34816
    v_sub_f32 v53, v53, v13
    v_mfma_f32_16x16x32_bf16 v[108:111], a[212:215], a[188:191], v[108:111]
    v_exp_f32 v52, v52
    v_mfma_f32_16x16x32_bf16 v[64:67], a[96:99], v[200:203], 0
    ds_read_b128 a[236:239], v1 offset:35840
    v_add_f32 v20, v20, v34
    v_mfma_f32_16x16x32_bf16 v[64:67], a[100:103], v[216:219], v[64:67]
    v_exp_f32 v37, v37
    v_mfma_f32_16x16x32_bf16 v[68:71], a[120:123], v[200:203], 0
    buffer_store_dwordx2 v[228:229], v11, s[12:15], s32 offen offset:768 sc1
    v_mfma_f32_16x16x32_bf16 v[68:71], a[124:127], v[216:219], v[68:71]
    ds_read_b128 a[240:243], v1 offset:36864
    v_sub_f32 v38, v38, v12
    v_mfma_f32_16x16x32_bf16 v[72:75], a[144:147], v[200:203], 0
    ds_read_b128 a[244:247], v1 offset:37888
    v_add_f32 v21, v21, v50
    v_mfma_f32_16x16x32_bf16 v[72:75], a[148:151], v[216:219], v[72:75]
    v_exp_f32 v53, v53
    v_mfma_f32_16x16x32_bf16 v[76:79], a[168:171], v[200:203], 0
    ds_read_b128 a[248:251], v1 offset:38912
    v_cvt_pk_bf16_f32 v200, v104, v105
    v_mfma_f32_16x16x32_bf16 v[76:79], a[172:175], v[216:219], v[76:79]
    v_cvt_pk_bf16_f32 v201, v106, v107
    v_sub_f32 v54, v54, v13
    v_mfma_f32_16x16x32_bf16 v[80:83], a[96:99], v[204:207], 0
    ds_read_b128 a[252:255], v1 offset:39936
    v_add_f32 v20, v20, v35
    v_mfma_f32_16x16x32_bf16 v[80:83], a[100:103], v[220:223], v[80:83]
    v_exp_f32 v38, v38
    v_mfma_f32_16x16x32_bf16 v[84:87], a[120:123], v[204:207], 0
    buffer_store_dwordx2 v[230:231], v11, s[12:15], s32 offen offset:1152 sc1
    v_mfma_f32_16x16x32_bf16 v[84:87], a[124:127], v[220:223], v[84:87]
    ds_read_b128 a[192:195], v1 offset:40960
    v_sub_f32 v39, v39, v12
    v_mfma_f32_16x16x32_bf16 v[88:91], a[144:147], v[204:207], 0
    ds_read_b128 a[196:199], v1 offset:41984
    v_add_f32 v21, v21, v51
    v_mfma_f32_16x16x32_bf16 v[88:91], a[148:151], v[220:223], v[88:91]
    v_exp_f32 v54, v54
    v_mfma_f32_16x16x32_bf16 v[92:95], a[168:171], v[204:207], 0
    ds_read_b128 a[200:203], v1 offset:43008
    v_cvt_pk_bf16_f32 v204, v108, v109
    v_mfma_f32_16x16x32_bf16 v[92:95], a[172:175], v[220:223], v[92:95]
    v_cvt_pk_bf16_f32 v205, v110, v111
    s_waitcnt lgkmcnt(7)
    v_mfma_f32_16x16x32_bf16 v[120:123], a[216:219], a[144:147], 0
    ds_read_b128 a[204:207], v1 offset:44032
    v_sub_f32 v55, v55, v13
    v_mfma_f32_16x16x32_bf16 v[120:123], a[220:223], a[148:151], v[120:123]
    v_add_f32 v20, v20, v36
    v_sub_f32 v40, v40, v12
    v_mfma_f32_16x16x32_bf16 v[120:123], a[224:227], a[152:155], v[120:123]
    buffer_store_dwordx2 v[232:233], v11, s[12:15], s34 offen offset:0 sc1
    v_mfma_f32_16x16x32_bf16 v[120:123], a[228:231], a[156:159], v[120:123]
    ds_read_b128 a[208:211], v1 offset:45056
    v_add_f32 v21, v21, v52
    v_mfma_f32_16x16x32_bf16 v[120:123], a[232:235], a[160:163], v[120:123]
    ds_read_b128 a[212:215], v1 offset:46080
    v_sub_f32 v56, v56, v13
    v_mfma_f32_16x16x32_bf16 v[120:123], a[236:239], a[164:167], v[120:123]
    v_exp_f32 v39, v39
    v_mfma_f32_16x16x32_bf16 v[124:127], a[216:219], a[168:171], 0
    v_exp_f32 v55, v55
    v_mfma_f32_16x16x32_bf16 v[124:127], a[220:223], a[172:175], v[124:127]
    ds_read_b128 a[216:219], v1 offset:47104
    v_add_f32 v20, v20, v37
    v_mfma_f32_16x16x32_bf16 v[124:127], a[224:227], a[176:179], v[124:127]
    ds_read_b128 a[220:223], v1 offset:48128
    v_cvt_pk_bf16_f32 v202, v120, v121
    v_mfma_f32_16x16x32_bf16 v[124:127], a[228:231], a[180:183], v[124:127]
    v_cvt_pk_bf16_f32 v203, v122, v123
    v_sub_f32 v41, v41, v12
    v_mfma_f32_16x16x32_bf16 v[124:127], a[232:235], a[184:187], v[124:127]
    buffer_store_dwordx2 v[234:235], v11, s[12:15], s34 offen offset:384 sc1
    v_mfma_f32_16x16x32_bf16 v[124:127], a[236:239], a[188:191], v[124:127]
    ds_read_b128 a[224:227], v1 offset:49152
    s_waitcnt lgkmcnt(6)
    v_mfma_f32_16x16x32_bf16 v[104:107], a[240:243], a[144:147], 0
    ds_read_b128 a[228:231], v1 offset:50176
    v_add_f32 v21, v21, v53
    v_mfma_f32_16x16x32_bf16 v[104:107], a[244:247], a[148:151], v[104:107]
    v_exp_f32 v40, v40
    v_mfma_f32_16x16x32_bf16 v[104:107], a[248:251], a[152:155], v[104:107]
    ds_read_b128 a[232:235], v1 offset:51200
    v_cvt_pk_bf16_f32 v206, v124, v125
    v_mfma_f32_16x16x32_bf16 v[104:107], a[252:255], a[156:159], v[104:107]
    v_cvt_pk_bf16_f32 v207, v126, v127
    v_sub_f32 v57, v57, v13
    v_mfma_f32_16x16x32_bf16 v[104:107], a[192:195], a[160:163], v[104:107]
    ds_read_b128 a[236:239], v1 offset:52224
    v_add_f32 v20, v20, v38
    v_mfma_f32_16x16x32_bf16 v[104:107], a[196:199], a[164:167], v[104:107]
    v_exp_f32 v56, v56
    v_mfma_f32_16x16x32_bf16 v[108:111], a[240:243], a[168:171], 0
    buffer_store_dwordx2 v[236:237], v11, s[12:15], s34 offen offset:768 sc1
    v_mfma_f32_16x16x32_bf16 v[108:111], a[244:247], a[172:175], v[108:111]
    ds_read_b128 a[240:243], v1 offset:53248
    v_sub_f32 v42, v42, v12
    v_mfma_f32_16x16x32_bf16 v[108:111], a[248:251], a[176:179], v[108:111]
    ds_read_b128 a[244:247], v1 offset:54272
    v_cvt_pk_bf16_f32 v216, v104, v105
    v_mfma_f32_16x16x32_bf16 v[108:111], a[252:255], a[180:183], v[108:111]
    v_cvt_pk_bf16_f32 v217, v106, v107
    v_add_f32 v21, v21, v54
    v_mfma_f32_16x16x32_bf16 v[108:111], a[192:195], a[184:187], v[108:111]
    v_exp_f32 v41, v41
    v_mfma_f32_16x16x32_bf16 v[108:111], a[196:199], a[188:191], v[108:111]
    v_exp_f32 v57, v57
    v_mfma_f32_16x16x32_bf16 v[120:123], a[200:203], a[144:147], 0
    v_sub_f32 v58, v58, v13
    s_waitcnt lgkmcnt(5)
    v_mfma_f32_16x16x32_bf16 v[120:123], a[204:207], a[148:151], v[120:123]
    v_add_f32 v20, v20, v39
    v_sub_f32 v43, v43, v12
    v_mfma_f32_16x16x32_bf16 v[120:123], a[208:211], a[152:155], v[120:123]
    buffer_store_dwordx2 v[238:239], v11, s[12:15], s34 offen offset:1152 sc1
    v_mfma_f32_16x16x32_bf16 v[120:123], a[212:215], a[156:159], v[120:123]
    v_cvt_pk_bf16_f32 v220, v108, v109
    v_cvt_pk_bf16_f32 v221, v110, v111
    v_mfma_f32_16x16x32_bf16 v[120:123], a[216:219], a[160:163], v[120:123]
    v_exp_f32 v42, v42
    v_mfma_f32_16x16x32_bf16 v[120:123], a[220:223], a[164:167], v[120:123]
    v_add_f32 v21, v21, v55
    v_sub_f32 v59, v59, v13
    v_mfma_f32_16x16x32_bf16 v[124:127], a[200:203], a[168:171], 0
    v_exp_f32 v58, v58
    v_mfma_f32_16x16x32_bf16 v[124:127], a[204:207], a[172:175], v[124:127]
    v_add_f32 v20, v20, v40
    v_sub_f32 v44, v44, v12
    v_mfma_f32_16x16x32_bf16 v[124:127], a[208:211], a[176:179], v[124:127]
    v_cvt_pk_bf16_f32 v218, v120, v121
    v_cvt_pk_bf16_f32 v219, v122, v123
    v_mfma_f32_16x16x32_bf16 v[124:127], a[212:215], a[180:183], v[124:127]
    v_exp_f32 v43, v43
    v_mfma_f32_16x16x32_bf16 v[124:127], a[216:219], a[184:187], v[124:127]
    buffer_store_dwordx2 v[240:241], v11, s[12:15], s36 offen offset:0 sc1
    v_mfma_f32_16x16x32_bf16 v[124:127], a[220:223], a[188:191], v[124:127]
    v_add_f32 v21, v21, v56
    v_sub_f32 v60, v60, v13
    v_mfma_f32_16x16x32_bf16 v[104:107], a[224:227], a[144:147], 0
    v_add_f32 v20, v20, v41
    s_waitcnt lgkmcnt(0)
    v_mfma_f32_16x16x32_bf16 v[104:107], a[228:231], a[148:151], v[104:107]
    v_exp_f32 v59, v59
    v_mfma_f32_16x16x32_bf16 v[104:107], a[232:235], a[152:155], v[104:107]
    ds_read_b128 a[248:251], v1 offset:55296
    v_cvt_pk_bf16_f32 v222, v124, v125
    v_mfma_f32_16x16x32_bf16 v[104:107], a[236:239], a[156:159], v[104:107]
    v_cvt_pk_bf16_f32 v223, v126, v127
    v_sub_f32 v45, v45, v12
    v_mfma_f32_16x16x32_bf16 v[104:107], a[240:243], a[160:163], v[104:107]
    ds_read_b128 a[252:255], v1 offset:56320
    v_add_f32 v21, v21, v57
    v_mfma_f32_16x16x32_bf16 v[104:107], a[244:247], a[164:167], v[104:107]
    v_exp_f32 v44, v44
    v_mfma_f32_16x16x32_bf16 v[108:111], a[224:227], a[168:171], 0
    buffer_store_dwordx2 v[242:243], v11, s[12:15], s36 offen offset:384 sc1
    v_mfma_f32_16x16x32_bf16 v[108:111], a[228:231], a[172:175], v[108:111]
    ds_read_b128 a[192:195], v1 offset:57344
    v_sub_f32 v61, v61, v13
    v_mfma_f32_16x16x32_bf16 v[108:111], a[232:235], a[176:179], v[108:111]
    ds_read_b128 a[196:199], v1 offset:58368
    v_add_f32 v20, v20, v42
    v_mfma_f32_16x16x32_bf16 v[108:111], a[236:239], a[180:183], v[108:111]
    v_exp_f32 v60, v60
    v_mfma_f32_16x16x32_bf16 v[108:111], a[240:243], a[184:187], v[108:111]
    ds_read_b128 a[200:203], v1 offset:59392
    v_sub_f32 v46, v46, v12
    v_mfma_f32_16x16x32_bf16 v[108:111], a[244:247], a[188:191], v[108:111]
    v_exp_f32 v45, v45
    v_mfma_f32_16x16x32_bf16 v[64:67], a[104:107], v[200:203], v[64:67]
    ds_read_b128 a[204:207], v1 offset:60416
    v_add_f32 v21, v21, v58
    v_mfma_f32_16x16x32_bf16 v[64:67], a[108:111], v[216:219], v[64:67]
    v_exp_f32 v61, v61
    v_mfma_f32_16x16x32_bf16 v[68:71], a[128:131], v[200:203], v[68:71]
    buffer_store_dwordx2 v[244:245], v11, s[12:15], s36 offen offset:768 sc1
    v_mfma_f32_16x16x32_bf16 v[68:71], a[132:135], v[216:219], v[68:71]
    ds_read_b128 a[208:211], v1 offset:61440
    v_sub_f32 v62, v62, v13
    v_mfma_f32_16x16x32_bf16 v[72:75], a[152:155], v[200:203], v[72:75]
    ds_read_b128 a[212:215], v1 offset:62464
    v_add_f32 v20, v20, v43
    v_mfma_f32_16x16x32_bf16 v[72:75], a[156:159], v[216:219], v[72:75]
    v_exp_f32 v46, v46
    v_mfma_f32_16x16x32_bf16 v[76:79], a[176:179], v[200:203], v[76:79]
    ds_read_b128 a[216:219], v1 offset:63488
    v_cvt_pk_bf16_f32 v200, v104, v105
    v_mfma_f32_16x16x32_bf16 v[76:79], a[180:183], v[216:219], v[76:79]
    v_cvt_pk_bf16_f32 v201, v106, v107
    v_sub_f32 v47, v47, v12
    v_mfma_f32_16x16x32_bf16 v[80:83], a[104:107], v[204:207], v[80:83]
    ds_read_b128 a[220:223], v1 offset:64512
    v_add_f32 v21, v21, v59
    v_mfma_f32_16x16x32_bf16 v[80:83], a[108:111], v[220:223], v[80:83]
    v_exp_f32 v62, v62
    v_mfma_f32_16x16x32_bf16 v[84:87], a[128:131], v[204:207], v[84:87]
    buffer_store_dwordx2 v[246:247], v11, s[12:15], s36 offen offset:1152 sc1
    v_mfma_f32_16x16x32_bf16 v[84:87], a[132:135], v[220:223], v[84:87]
    ds_read_b128 a[224:227], v2 offset:0
    v_sub_f32 v63, v63, v13
    v_mfma_f32_16x16x32_bf16 v[88:91], a[152:155], v[204:207], v[88:91]
    ds_read_b128 a[228:231], v2 offset:1024
    v_add_f32 v20, v20, v44
    v_mfma_f32_16x16x32_bf16 v[88:91], a[156:159], v[220:223], v[88:91]
    v_exp_f32 v47, v47
    v_mfma_f32_16x16x32_bf16 v[92:95], a[176:179], v[204:207], v[92:95]
    ds_read_b128 a[232:235], v2 offset:2048
    v_cvt_pk_bf16_f32 v204, v108, v109
    v_mfma_f32_16x16x32_bf16 v[92:95], a[180:183], v[220:223], v[92:95]
    v_cvt_pk_bf16_f32 v205, v110, v111
    s_waitcnt lgkmcnt(7)
    v_mfma_f32_16x16x32_bf16 v[120:123], a[248:251], a[144:147], 0
    ds_read_b128 a[236:239], v2 offset:3072
    v_add_f32 v21, v21, v60
    v_mfma_f32_16x16x32_bf16 v[120:123], a[252:255], a[148:151], v[120:123]
    v_exp_f32 v63, v63
    v_mfma_f32_16x16x32_bf16 v[120:123], a[192:195], a[152:155], v[120:123]
    buffer_store_dwordx2 v[248:249], v11, s[12:15], s38 offen offset:0 sc1
    v_mfma_f32_16x16x32_bf16 v[120:123], a[196:199], a[156:159], v[120:123]
    ds_read_b128 a[240:243], v2 offset:4096
    v_add_f32 v20, v20, v45
    v_mfma_f32_16x16x32_bf16 v[120:123], a[200:203], a[160:163], v[120:123]
    ds_read_b128 a[244:247], v2 offset:5120
    v_add_f32 v21, v21, v61
    v_mfma_f32_16x16x32_bf16 v[120:123], a[204:207], a[164:167], v[120:123]
    v_add_f32 v20, v20, v46
    v_add_f32 v21, v21, v62
    v_mfma_f32_16x16x32_bf16 v[124:127], a[248:251], a[168:171], 0
    v_add_f32 v20, v20, v47
    v_add_f32 v21, v21, v63
    v_mfma_f32_16x16x32_bf16 v[124:127], a[252:255], a[172:175], v[124:127]
    ds_read_b128 a[248:251], v2 offset:6144
    v_permlane16_swap_b32 v20, v21
    v_mfma_f32_16x16x32_bf16 v[124:127], a[192:195], a[176:179], v[124:127]
    ds_read_b128 a[252:255], v2 offset:7168
    v_cvt_pk_bf16_f32 v202, v120, v121
    v_mfma_f32_16x16x32_bf16 v[124:127], a[196:199], a[180:183], v[124:127]
    v_cvt_pk_bf16_f32 v203, v122, v123
    v_add_f32 v20, v20, v21
    v_mfma_f32_16x16x32_bf16 v[124:127], a[200:203], a[184:187], v[124:127]
    buffer_store_dwordx2 v[250:251], v11, s[12:15], s38 offen offset:384 sc1
    v_mfma_f32_16x16x32_bf16 v[124:127], a[204:207], a[188:191], v[124:127]
    ds_read_b128 a[192:195], v2 offset:8192
    s_waitcnt lgkmcnt(6)
    v_mfma_f32_16x16x32_bf16 v[104:107], a[208:211], a[144:147], 0
    ds_read_b128 a[196:199], v2 offset:9216
    v_mov_b32 v21, v20
    v_mfma_f32_16x16x32_bf16 v[104:107], a[212:215], a[148:151], v[104:107]
    v_mfma_f32_16x16x32_bf16 v[104:107], a[216:219], a[152:155], v[104:107]
    ds_read_b128 a[200:203], v2 offset:10240
    v_cvt_pk_bf16_f32 v206, v124, v125
    v_mfma_f32_16x16x32_bf16 v[104:107], a[220:223], a[156:159], v[104:107]
    v_cvt_pk_bf16_f32 v207, v126, v127
    v_permlane32_swap_b32 v20, v21
    v_mfma_f32_16x16x32_bf16 v[104:107], a[224:227], a[160:163], v[104:107]
    ds_read_b128 a[204:207], v2 offset:11264
    v_add_f32 v20, v20, v21
    v_mfma_f32_16x16x32_bf16 v[104:107], a[228:231], a[164:167], v[104:107]
    v_rcp_f32 v20, v20
    v_mfma_f32_16x16x32_bf16 v[108:111], a[208:211], a[168:171], 0
    buffer_store_dwordx2 v[252:253], v11, s[12:15], s38 offen offset:768 sc1
    v_mfma_f32_16x16x32_bf16 v[108:111], a[212:215], a[172:175], v[108:111]
    ds_read_b128 a[208:211], v2 offset:12288
    v_mov_b32 v21, v20
    v_mfma_f32_16x16x32_bf16 v[108:111], a[216:219], a[176:179], v[108:111]
    ds_read_b128 a[212:215], v2 offset:13312
    v_cvt_pk_bf16_f32 v216, v104, v105
    v_mfma_f32_16x16x32_bf16 v[108:111], a[220:223], a[180:183], v[108:111]
    v_cvt_pk_bf16_f32 v217, v106, v107
    v_permlane16_swap_b32 v20, v21
    v_mfma_f32_16x16x32_bf16 v[108:111], a[224:227], a[184:187], v[108:111]
    v_mul_f32 v32, v32, v20
    v_mul_f32 v33, v33, v20
    v_mfma_f32_16x16x32_bf16 v[108:111], a[228:231], a[188:191], v[108:111]
    v_cvt_pk_bf16_f32 v32, v32, v33
    v_mul_f32 v34, v34, v20
    v_mfma_f32_16x16x32_bf16 v[120:123], a[232:235], a[144:147], 0
    v_mul_f32 v35, v35, v20
    s_waitcnt lgkmcnt(5)
    v_mfma_f32_16x16x32_bf16 v[120:123], a[236:239], a[148:151], v[120:123]
    v_cvt_pk_bf16_f32 v33, v34, v35
    v_mul_f32 v36, v36, v20
    v_mfma_f32_16x16x32_bf16 v[120:123], a[240:243], a[152:155], v[120:123]
    buffer_store_dwordx2 v[254:255], v11, s[12:15], s38 offen offset:1152 sc1
    v_mfma_f32_16x16x32_bf16 v[120:123], a[244:247], a[156:159], v[120:123]
    v_cvt_pk_bf16_f32 v220, v108, v109
    v_cvt_pk_bf16_f32 v221, v110, v111
    v_mfma_f32_16x16x32_bf16 v[120:123], a[248:251], a[160:163], v[120:123]
    v_mul_f32 v37, v37, v20
    v_mul_f32 v38, v38, v20
    v_mfma_f32_16x16x32_bf16 v[120:123], a[252:255], a[164:167], v[120:123]
    v_mul_f32 v39, v39, v20
    v_cvt_pk_bf16_f32 v34, v36, v37
    v_mfma_f32_16x16x32_bf16 v[124:127], a[232:235], a[168:171], 0
    v_cvt_pk_bf16_f32 v35, v38, v39
    v_mul_f32 v40, v40, v20
    v_mfma_f32_16x16x32_bf16 v[124:127], a[236:239], a[172:175], v[124:127]
    v_mul_f32 v41, v41, v20
    v_mul_f32 v42, v42, v20
    v_mfma_f32_16x16x32_bf16 v[124:127], a[240:243], a[176:179], v[124:127]
    v_cvt_pk_bf16_f32 v218, v120, v121
    v_cvt_pk_bf16_f32 v219, v122, v123
    v_mfma_f32_16x16x32_bf16 v[124:127], a[244:247], a[180:183], v[124:127]
    v_mul_f32 v43, v43, v20
    v_mul_f32 v44, v44, v20
    v_mfma_f32_16x16x32_bf16 v[124:127], a[248:251], a[184:187], v[124:127]
    v_mul_f32 v45, v45, v20
    v_mul_f32 v46, v46, v20
    v_mfma_f32_16x16x32_bf16 v[124:127], a[252:255], a[188:191], v[124:127]
    v_mul_f32 v47, v47, v20
    v_cvt_pk_bf16_f32 v36, v40, v41
    v_mfma_f32_16x16x32_bf16 v[96:99], a[96:99], a[192:195], 0
    v_cvt_pk_bf16_f32 v37, v42, v43
    s_waitcnt lgkmcnt(0)
    v_mfma_f32_16x16x32_bf16 v[96:99], a[100:103], a[196:199], v[96:99]
    v_cvt_pk_bf16_f32 v38, v44, v45
    v_cvt_pk_bf16_f32 v39, v46, v47
    v_mfma_f32_16x16x32_bf16 v[96:99], a[104:107], a[200:203], v[96:99]
    v_cvt_pk_bf16_f32 v222, v124, v125
    v_cvt_pk_bf16_f32 v223, v126, v127
    v_mfma_f32_16x16x32_bf16 v[96:99], a[108:111], a[204:207], v[96:99]
    v_mul_f32 v48, v48, v21
    v_mul_f32 v49, v49, v21
    v_mfma_f32_16x16x32_bf16 v[96:99], a[112:115], a[208:211], v[96:99]
    v_mul_f32 v50, v50, v21
    v_mul_f32 v51, v51, v21
    v_mfma_f32_16x16x32_bf16 v[96:99], a[116:119], a[212:215], v[96:99]
    v_mul_f32 v52, v52, v21
    v_mul_f32 v53, v53, v21
    v_mfma_f32_16x16x32_bf16 v[100:103], a[120:123], a[192:195], 0
    v_mul_f32 v54, v54, v21
    v_mul_f32 v55, v55, v21
    v_mfma_f32_16x16x32_bf16 v[100:103], a[124:127], a[196:199], v[100:103]
    v_cvt_pk_bf16_f32 v40, v48, v49
    v_cvt_pk_bf16_f32 v41, v50, v51
    v_mfma_f32_16x16x32_bf16 v[100:103], a[128:131], a[200:203], v[100:103]
    v_cvt_pk_bf16_f32 v128, v96, v97
    v_cvt_pk_bf16_f32 v129, v98, v99
    v_mfma_f32_16x16x32_bf16 v[100:103], a[132:135], a[204:207], v[100:103]
    v_cvt_pk_bf16_f32 v42, v52, v53
    v_cvt_pk_bf16_f32 v43, v54, v55
    v_mfma_f32_16x16x32_bf16 v[100:103], a[136:139], a[208:211], v[100:103]
    v_mul_f32 v56, v56, v21
    v_mul_f32 v57, v57, v21
    v_mfma_f32_16x16x32_bf16 v[100:103], a[140:143], a[212:215], v[100:103]
    v_mul_f32 v58, v58, v21
    v_mul_f32 v59, v59, v21
    v_mfma_f32_16x16x32_bf16 v[64:67], a[112:115], v[200:203], v[64:67]
    v_mul_f32 v60, v60, v21
    v_mul_f32 v61, v61, v21
    v_mfma_f32_16x16x32_bf16 v[64:67], a[116:119], v[216:219], v[64:67]
    v_mul_f32 v62, v62, v21
    v_mul_f32 v63, v63, v21
    v_mfma_f32_16x16x32_bf16 v[68:71], a[136:139], v[200:203], v[68:71]
    ds_read_b128 a[216:219], v2 offset:14336
    v_cvt_pk_bf16_f32 v130, v100, v101
    v_mfma_f32_16x16x32_bf16 v[68:71], a[140:143], v[216:219], v[68:71]
    v_cvt_pk_bf16_f32 v131, v102, v103
    v_cvt_pk_bf16_f32 v44, v56, v57
    v_mfma_f32_16x16x32_bf16 v[72:75], a[160:163], v[200:203], v[72:75]
    ds_read_b128 a[220:223], v2 offset:15360
    v_cvt_pk_bf16_f32 v45, v58, v59
    v_mfma_f32_16x16x32_bf16 v[72:75], a[164:167], v[216:219], v[72:75]
    v_cvt_pk_bf16_f32 v46, v60, v61
    v_cvt_pk_bf16_f32 v47, v62, v63
    v_mfma_f32_16x16x32_bf16 v[76:79], a[184:187], v[200:203], v[76:79]
    ds_read_b128 a[224:227], v2 offset:16384
    v_max3_f32 v14, v64, v65, v66
    v_mfma_f32_16x16x32_bf16 v[76:79], a[188:191], v[216:219], v[76:79]
    v_max3_f32 v14, v14, v67, v68
    v_max3_f32 v14, v14, v69, v70
    v_mfma_f32_16x16x32_bf16 v[80:83], a[112:115], v[204:207], v[80:83]
    ds_read_b128 a[228:231], v2 offset:17408
    v_max3_f32 v14, v14, v71, v72
    v_mfma_f32_16x16x32_bf16 v[80:83], a[116:119], v[220:223], v[80:83]
    v_max3_f32 v14, v14, v73, v74
    v_mfma_f32_16x16x32_bf16 v[84:87], a[136:139], v[204:207], v[84:87]
    ds_read_b128 a[232:235], v2 offset:18432
    v_max3_f32 v14, v14, v75, v76
    v_mfma_f32_16x16x32_bf16 v[84:87], a[140:143], v[220:223], v[84:87]
    v_max3_f32 v14, v14, v77, v78
    v_max_f32 v14, v14, v79
    v_mfma_f32_16x16x32_bf16 v[88:91], a[160:163], v[204:207], v[88:91]
    ds_read_b128 a[236:239], v2 offset:19456
    v_max3_f32 v15, v80, v81, v82
    v_mfma_f32_16x16x32_bf16 v[88:91], a[164:167], v[220:223], v[88:91]
    v_mfma_f32_16x16x32_bf16 v[92:95], a[184:187], v[204:207], v[92:95]
    v_max3_f32 v15, v15, v83, v84
    v_max3_f32 v15, v15, v85, v86
    v_mfma_f32_16x16x32_bf16 v[92:95], a[188:191], v[220:223], v[92:95]
    v_mfma_f32_16x16x32_bf16 v[104:107], a[144:147], a[192:195], 0
    v_max3_f32 v15, v15, v87, v88
    v_max3_f32 v15, v15, v89, v90
    v_mfma_f32_16x16x32_bf16 v[104:107], a[148:151], a[196:199], v[104:107]
    v_mfma_f32_16x16x32_bf16 v[104:107], a[152:155], a[200:203], v[104:107]
    v_max3_f32 v15, v15, v91, v92
    v_max3_f32 v15, v15, v93, v94
    v_mfma_f32_16x16x32_bf16 v[104:107], a[156:159], a[204:207], v[104:107]
    v_max_f32 v15, v15, v95
    v_mfma_f32_16x16x32_bf16 v[104:107], a[160:163], a[208:211], v[104:107]
    v_mfma_f32_16x16x32_bf16 v[104:107], a[164:167], a[212:215], v[104:107]
    v_permlane16_swap_b32 v14, v15
    v_max_f32 v14, v14, v15
    v_mfma_f32_16x16x32_bf16 v[108:111], a[168:171], a[192:195], 0
    v_mov_b32 v15, v14
    v_mfma_f32_16x16x32_bf16 v[108:111], a[172:175], a[196:199], v[108:111]
    v_mfma_f32_16x16x32_bf16 v[108:111], a[176:179], a[200:203], v[108:111]
    v_cvt_pk_bf16_f32 v132, v104, v105
    v_cvt_pk_bf16_f32 v133, v106, v107
    v_mfma_f32_16x16x32_bf16 v[108:111], a[180:183], a[204:207], v[108:111]
    v_permlane32_swap_b32 v14, v15
    v_max_f32 v14, v14, v15
    v_mfma_f32_16x16x32_bf16 v[108:111], a[184:187], a[208:211], v[108:111]
    ds_read_b128 a[240:243], v2 offset:20480
    v_mov_b32 v15, v14
    v_mfma_f32_16x16x32_bf16 v[108:111], a[188:191], a[212:215], v[108:111]
    s_waitcnt lgkmcnt(1)
    v_mfma_f32_16x16x32_bf16 v[112:115], a[96:99], a[216:219], 0
    ds_read_b128 a[244:247], v2 offset:21504
    v_permlane16_swap_b32 v14, v15
    v_mfma_f32_16x16x32_bf16 v[112:115], a[100:103], a[220:223], v[112:115]
    v_sub_f32 v64, v64, v14
    v_sub_f32 v65, v65, v14
    v_mfma_f32_16x16x32_bf16 v[112:115], a[104:107], a[224:227], v[112:115]
    ds_read_b128 a[248:251], v2 offset:22528
    v_cvt_pk_bf16_f32 v134, v108, v109
    v_mfma_f32_16x16x32_bf16 v[112:115], a[108:111], a[228:231], v[112:115]
    v_cvt_pk_bf16_f32 v135, v110, v111
    v_sub_f32 v80, v80, v15
    v_mfma_f32_16x16x32_bf16 v[112:115], a[112:115], a[232:235], v[112:115]
    ds_read_b128 a[252:255], v2 offset:23552
    v_sub_f32 v81, v81, v15
    v_mfma_f32_16x16x32_bf16 v[112:115], a[116:119], a[236:239], v[112:115]
    v_exp_f32 v64, v64
    v_mfma_f32_16x16x32_bf16 v[116:119], a[120:123], a[216:219], 0
    ds_read_b128 a[192:195], v2 offset:24576
    v_sub_f32 v66, v66, v14
    v_mfma_f32_16x16x32_bf16 v[116:119], a[124:127], a[220:223], v[116:119]
    v_exp_f32 v65, v65
    v_mfma_f32_16x16x32_bf16 v[116:119], a[128:131], a[224:227], v[116:119]
    ds_read_b128 a[196:199], v2 offset:25600
    v_cvt_pk_bf16_f32 v136, v112, v113
    v_mfma_f32_16x16x32_bf16 v[116:119], a[132:135], a[228:231], v[116:119]
    v_cvt_pk_bf16_f32 v137, v114, v115
    v_sub_f32 v82, v82, v15
    v_mfma_f32_16x16x32_bf16 v[116:119], a[136:139], a[232:235], v[116:119]
    v_exp_f32 v80, v80
    v_mfma_f32_16x16x32_bf16 v[116:119], a[140:143], a[236:239], v[116:119]
    v_exp_f32 v81, v81
    v_mfma_f32_16x16x32_bf16 v[120:123], a[144:147], a[216:219], 0
    v_exp_f32 v66, v66
    v_mfma_f32_16x16x32_bf16 v[120:123], a[148:151], a[220:223], v[120:123]
    v_sub_f32 v67, v67, v14
    v_sub_f32 v83, v83, v15
    v_mfma_f32_16x16x32_bf16 v[120:123], a[152:155], a[224:227], v[120:123]
    v_cvt_pk_bf16_f32 v138, v116, v117
    v_cvt_pk_bf16_f32 v139, v118, v119
    v_mfma_f32_16x16x32_bf16 v[120:123], a[156:159], a[228:231], v[120:123]
    v_exp_f32 v82, v82
    v_mfma_f32_16x16x32_bf16 v[120:123], a[160:163], a[232:235], v[120:123]
    v_exp_f32 v67, v67
    v_mfma_f32_16x16x32_bf16 v[120:123], a[164:167], a[236:239], v[120:123]
    v_sub_f32 v68, v68, v14
    v_sub_f32 v84, v84, v15
    v_mfma_f32_16x16x32_bf16 v[124:127], a[168:171], a[216:219], 0
    v_exp_f32 v83, v83
    v_mfma_f32_16x16x32_bf16 v[124:127], a[172:175], a[220:223], v[124:127]
    v_add_f32 v22, v64, v65
    v_sub_f32 v69, v69, v14
    v_mfma_f32_16x16x32_bf16 v[124:127], a[176:179], a[224:227], v[124:127]
    v_cvt_pk_bf16_f32 v140, v120, v121
    v_cvt_pk_bf16_f32 v141, v122, v123
    v_mfma_f32_16x16x32_bf16 v[124:127], a[180:183], a[228:231], v[124:127]
    v_exp_f32 v68, v68
    v_mfma_f32_16x16x32_bf16 v[124:127], a[184:187], a[232:235], v[124:127]
    ds_read_b128 a[200:203], v2 offset:26624
    v_add_f32 v23, v80, v81
    v_mfma_f32_16x16x32_bf16 v[124:127], a[188:191], a[236:239], v[124:127]
    v_sub_f32 v85, v85, v15
    s_waitcnt lgkmcnt(1)
    v_mfma_f32_16x16x32_bf16 v[96:99], a[96:99], a[240:243], 0
    ds_read_b128 a[204:207], v2 offset:27648
    v_add_f32 v22, v22, v66
    v_mfma_f32_16x16x32_bf16 v[96:99], a[100:103], a[244:247], v[96:99]
    v_exp_f32 v84, v84
    v_mfma_f32_16x16x32_bf16 v[96:99], a[104:107], a[248:251], v[96:99]
    ds_read_b128 a[208:211], v2 offset:28672
    v_cvt_pk_bf16_f32 v142, v124, v125
    v_mfma_f32_16x16x32_bf16 v[96:99], a[108:111], a[252:255], v[96:99]
    v_cvt_pk_bf16_f32 v143, v126, v127
    v_sub_f32 v70, v70, v14
    v_mfma_f32_16x16x32_bf16 v[96:99], a[112:115], a[192:195], v[96:99]
    ds_read_b128 a[212:215], v2 offset:29696
    v_add_f32 v23, v23, v82
    v_mfma_f32_16x16x32_bf16 v[96:99], a[116:119], a[196:199], v[96:99]
    v_exp_f32 v69, v69
    v_mfma_f32_16x16x32_bf16 v[100:103], a[120:123], a[240:243], 0
    ds_read_b128 a[216:219], v2 offset:30720
    v_sub_f32 v86, v86, v15
    v_mfma_f32_16x16x32_bf16 v[100:103], a[124:127], a[244:247], v[100:103]
    v_exp_f32 v85, v85
    v_mfma_f32_16x16x32_bf16 v[100:103], a[128:131], a[248:251], v[100:103]
    ds_read_b128 a[220:223], v2 offset:31744
    v_cvt_pk_bf16_f32 v144, v96, v97
    v_mfma_f32_16x16x32_bf16 v[100:103], a[132:135], a[252:255], v[100:103]
    v_cvt_pk_bf16_f32 v145, v98, v99
    v_add_f32 v22, v22, v67
    v_mfma_f32_16x16x32_bf16 v[100:103], a[136:139], a[192:195], v[100:103]
    v_exp_f32 v70, v70
    v_mfma_f32_16x16x32_bf16 v[100:103], a[140:143], a[196:199], v[100:103]
    v_sub_f32 v71, v71, v14
    v_add_f32 v23, v23, v83
    v_mfma_f32_16x16x32_bf16 v[104:107], a[144:147], a[240:243], 0
    v_exp_f32 v86, v86
    v_mfma_f32_16x16x32_bf16 v[104:107], a[148:151], a[244:247], v[104:107]
    v_sub_f32 v87, v87, v15
    v_add_f32 v22, v22, v68
    v_mfma_f32_16x16x32_bf16 v[104:107], a[152:155], a[248:251], v[104:107]
    v_cvt_pk_bf16_f32 v146, v100, v101
    v_cvt_pk_bf16_f32 v147, v102, v103
    v_mfma_f32_16x16x32_bf16 v[104:107], a[156:159], a[252:255], v[104:107]
    v_exp_f32 v71, v71
    v_mfma_f32_16x16x32_bf16 v[104:107], a[160:163], a[192:195], v[104:107]
    v_sub_f32 v72, v72, v14
    v_add_f32 v23, v23, v84
    v_mfma_f32_16x16x32_bf16 v[104:107], a[164:167], a[196:199], v[104:107]
    v_exp_f32 v87, v87
    v_mfma_f32_16x16x32_bf16 v[108:111], a[168:171], a[240:243], 0
    v_sub_f32 v88, v88, v15
    v_add_f32 v22, v22, v69
    v_mfma_f32_16x16x32_bf16 v[108:111], a[172:175], a[244:247], v[108:111]
    v_exp_f32 v72, v72
    v_mfma_f32_16x16x32_bf16 v[108:111], a[176:179], a[248:251], v[108:111]
    v_cvt_pk_bf16_f32 v148, v104, v105
    v_cvt_pk_bf16_f32 v149, v106, v107
    v_mfma_f32_16x16x32_bf16 v[108:111], a[180:183], a[252:255], v[108:111]
    v_sub_f32 v73, v73, v14
    v_add_f32 v23, v23, v85
    v_mfma_f32_16x16x32_bf16 v[108:111], a[184:187], a[192:195], v[108:111]
    v_exp_f32 v88, v88
    v_mfma_f32_16x16x32_bf16 v[108:111], a[188:191], a[196:199], v[108:111]
    v_sub_f32 v89, v89, v15
    s_waitcnt lgkmcnt(0)
    v_mfma_f32_16x16x32_bf16 v[112:115], a[96:99], a[200:203], 0
    v_add_f32 v22, v22, v70
    v_sub_f32 v74, v74, v14
    v_mfma_f32_16x16x32_bf16 v[112:115], a[100:103], a[204:207], v[112:115]
    v_exp_f32 v73, v73
    v_mfma_f32_16x16x32_bf16 v[112:115], a[104:107], a[208:211], v[112:115]
    v_cvt_pk_bf16_f32 v150, v108, v109
    v_cvt_pk_bf16_f32 v151, v110, v111
    v_mfma_f32_16x16x32_bf16 v[112:115], a[108:111], a[212:215], v[112:115]
    v_add_f32 v23, v23, v86
    v_sub_f32 v90, v90, v15
    v_mfma_f32_16x16x32_bf16 v[112:115], a[112:115], a[216:219], v[112:115]
    v_exp_f32 v89, v89
    v_mfma_f32_16x16x32_bf16 v[112:115], a[116:119], a[220:223], v[112:115]
    v_add_f32 v22, v22, v71
    v_sub_f32 v75, v75, v14
    v_mfma_f32_16x16x32_bf16 v[116:119], a[120:123], a[200:203], 0
    v_exp_f32 v74, v74
    v_mfma_f32_16x16x32_bf16 v[116:119], a[124:127], a[204:207], v[116:119]
    v_add_f32 v23, v23, v87
    v_sub_f32 v91, v91, v15
    v_mfma_f32_16x16x32_bf16 v[116:119], a[128:131], a[208:211], v[116:119]
    v_cvt_pk_bf16_f32 v152, v112, v113
    v_cvt_pk_bf16_f32 v153, v114, v115
    v_mfma_f32_16x16x32_bf16 v[116:119], a[132:135], a[212:215], v[116:119]
    v_exp_f32 v90, v90
    v_mfma_f32_16x16x32_bf16 v[116:119], a[136:139], a[216:219], v[116:119]
    v_add_f32 v22, v22, v72
    v_sub_f32 v76, v76, v14
    v_mfma_f32_16x16x32_bf16 v[116:119], a[140:143], a[220:223], v[116:119]
    v_exp_f32 v75, v75
    v_mfma_f32_16x16x32_bf16 v[120:123], a[144:147], a[200:203], 0
    v_add_f32 v23, v23, v88
    v_sub_f32 v92, v92, v15
    v_mfma_f32_16x16x32_bf16 v[120:123], a[148:151], a[204:207], v[120:123]
    v_exp_f32 v91, v91
    v_mfma_f32_16x16x32_bf16 v[120:123], a[152:155], a[208:211], v[120:123]
    ds_read_b128 a[224:227], v2 offset:32768
    v_cvt_pk_bf16_f32 v154, v116, v117
    v_mfma_f32_16x16x32_bf16 v[120:123], a[156:159], a[212:215], v[120:123]
    v_cvt_pk_bf16_f32 v155, v118, v119
    v_add_f32 v22, v22, v73
    v_mfma_f32_16x16x32_bf16 v[120:123], a[160:163], a[216:219], v[120:123]
    ds_read_b128 a[228:231], v2 offset:33792
    v_sub_f32 v77, v77, v14
    v_mfma_f32_16x16x32_bf16 v[120:123], a[164:167], a[220:223], v[120:123]
    v_exp_f32 v76, v76
    v_mfma_f32_16x16x32_bf16 v[124:127], a[168:171], a[200:203], 0
    ds_read_b128 a[232:235], v2 offset:34816
    v_add_f32 v23, v23, v89
    v_mfma_f32_16x16x32_bf16 v[124:127], a[172:175], a[204:207], v[124:127]
    v_exp_f32 v92, v92
    v_mfma_f32_16x16x32_bf16 v[124:127], a[176:179], a[208:211], v[124:127]
    ds_read_b128 a[236:239], v2 offset:35840
    v_cvt_pk_bf16_f32 v156, v120, v121
    v_mfma_f32_16x16x32_bf16 v[124:127], a[180:183], a[212:215], v[124:127]
    v_cvt_pk_bf16_f32 v157, v122, v123
    v_sub_f32 v93, v93, v15
    v_mfma_f32_16x16x32_bf16 v[124:127], a[184:187], a[216:219], v[124:127]
    ds_read_b128 a[240:243], v2 offset:36864
    v_add_f32 v22, v22, v74
    v_mfma_f32_16x16x32_bf16 v[124:127], a[188:191], a[220:223], v[124:127]
    v_exp_f32 v77, v77
    v_mfma_f32_16x16x32_bf16 v[192:195], v[32:35], v[128:131], 0
    ds_read_b128 a[244:247], v2 offset:37888
    v_sub_f32 v78, v78, v14
    v_mfma_f32_16x16x32_bf16 v[192:195], v[36:39], v[132:135], v[192:195]
    v_add_f32 v23, v23, v90
    v_sub_f32 v94, v94, v15
    v_mfma_f32_16x16x32_bf16 v[196:199], v[32:35], v[136:139], 0
    v_cvt_pk_bf16_f32 v158, v124, v125
    v_cvt_pk_bf16_f32 v159, v126, v127
    v_mfma_f32_16x16x32_bf16 v[196:199], v[36:39], v[140:143], v[196:199]
    v_exp_f32 v93, v93
    v_mfma_f32_16x16x32_bf16 v[200:203], v[32:35], v[144:147], 0
    v_add_f32 v22, v22, v75
    v_sub_f32 v79, v79, v14
    v_mfma_f32_16x16x32_bf16 v[200:203], v[36:39], v[148:151], v[200:203]
    v_exp_f32 v78, v78
    v_mfma_f32_16x16x32_bf16 v[204:207], v[32:35], v[152:155], 0
    v_cvt_pk_bf16_f32 v224, v192, v196
    v_cvt_pk_bf16_f32 v226, v193, v197
    v_mfma_f32_16x16x32_bf16 v[204:207], v[36:39], v[156:159], v[204:207]
    v_cvt_pk_bf16_f32 v228, v194, v198
    v_cvt_pk_bf16_f32 v230, v195, v199
    v_mfma_f32_16x16x32_bf16 v[208:211], v[40:43], v[128:131], 0
    v_add_f32 v23, v23, v91
    v_sub_f32 v95, v95, v15
    v_mfma_f32_16x16x32_bf16 v[208:211], v[44:47], v[132:135], v[208:211]
    v_exp_f32 v94, v94
    v_mfma_f32_16x16x32_bf16 v[212:215], v[40:43], v[136:139], 0
    v_cvt_pk_bf16_f32 v225, v200, v204
    v_cvt_pk_bf16_f32 v227, v201, v205
    v_mfma_f32_16x16x32_bf16 v[212:215], v[44:47], v[140:143], v[212:215]
    buffer_store_dwordx2 v[224:225], v11, s[12:15], s33 offen offset:0 sc1
    v_mfma_f32_16x16x32_bf16 v[216:219], v[40:43], v[144:147], 0
    v_cvt_pk_bf16_f32 v229, v202, v206
    v_cvt_pk_bf16_f32 v231, v203, v207
    v_mfma_f32_16x16x32_bf16 v[216:219], v[44:47], v[148:151], v[216:219]
    buffer_store_dwordx2 v[226:227], v11, s[12:15], s33 offen offset:384 sc1
    v_mfma_f32_16x16x32_bf16 v[220:223], v[40:43], v[152:155], 0
    ds_read_b128 a[248:251], v2 offset:38912
    v_cvt_pk_bf16_f32 v232, v208, v212
    v_mfma_f32_16x16x32_bf16 v[220:223], v[44:47], v[156:159], v[220:223]
    buffer_store_dwordx2 v[228:229], v11, s[12:15], s33 offen offset:768 sc1
    s_waitcnt lgkmcnt(1)
    v_mfma_f32_16x16x32_bf16 v[96:99], a[96:99], a[224:227], 0
    ds_read_b128 a[252:255], v2 offset:39936
    v_cvt_pk_bf16_f32 v234, v209, v213
    v_mfma_f32_16x16x32_bf16 v[96:99], a[100:103], a[228:231], v[96:99]
    buffer_store_dwordx2 v[230:231], v11, s[12:15], s33 offen offset:1152 sc1
    v_mfma_f32_16x16x32_bf16 v[96:99], a[104:107], a[232:235], v[96:99]
    ds_read_b128 a[192:195], v2 offset:40960
    v_cvt_pk_bf16_f32 v233, v216, v220
    v_mfma_f32_16x16x32_bf16 v[96:99], a[108:111], a[236:239], v[96:99]
    buffer_store_dwordx2 v[232:233], v11, s[12:15], s35 offen offset:0 sc1
    v_mfma_f32_16x16x32_bf16 v[96:99], a[112:115], a[240:243], v[96:99]
    ds_read_b128 a[196:199], v2 offset:41984
    v_cvt_pk_bf16_f32 v235, v217, v221
    v_mfma_f32_16x16x32_bf16 v[96:99], a[116:119], a[244:247], v[96:99]
    buffer_store_dwordx2 v[234:235], v11, s[12:15], s35 offen offset:384 sc1
    v_mfma_f32_16x16x32_bf16 v[100:103], a[120:123], a[224:227], 0
    ds_read_b128 a[200:203], v2 offset:43008
    v_cvt_pk_bf16_f32 v236, v210, v214
    v_mfma_f32_16x16x32_bf16 v[100:103], a[124:127], a[228:231], v[100:103]
    v_cvt_pk_bf16_f32 v237, v218, v222
    v_cvt_pk_bf16_f32 v238, v211, v215
    v_mfma_f32_16x16x32_bf16 v[100:103], a[128:131], a[232:235], v[100:103]
    buffer_store_dwordx2 v[236:237], v11, s[12:15], s35 offen offset:768 sc1
    v_mfma_f32_16x16x32_bf16 v[100:103], a[132:135], a[236:239], v[100:103]
    ds_read_b128 a[204:207], v2 offset:44032
    v_cvt_pk_bf16_f32 v239, v219, v223
    v_mfma_f32_16x16x32_bf16 v[100:103], a[136:139], a[240:243], v[100:103]
    buffer_store_dwordx2 v[238:239], v11, s[12:15], s35 offen offset:1152 sc1
    v_mfma_f32_16x16x32_bf16 v[100:103], a[140:143], a[244:247], v[100:103]
    v_add_f32 v22, v22, v76
    v_add_f32 v23, v23, v92
    v_mfma_f32_16x16x32_bf16 v[104:107], a[144:147], a[224:227], 0
    v_exp_f32 v79, v79
    v_mfma_f32_16x16x32_bf16 v[104:107], a[148:151], a[228:231], v[104:107]
    v_exp_f32 v95, v95
    v_mfma_f32_16x16x32_bf16 v[104:107], a[152:155], a[232:235], v[104:107]
    v_add_f32 v22, v22, v77
    v_add_f32 v23, v23, v93
    v_mfma_f32_16x16x32_bf16 v[104:107], a[156:159], a[236:239], v[104:107]
    v_add_f32 v22, v22, v78
    v_add_f32 v23, v23, v94
    v_mfma_f32_16x16x32_bf16 v[104:107], a[160:163], a[240:243], v[104:107]
    v_add_f32 v22, v22, v79
    v_add_f32 v23, v23, v95
    v_mfma_f32_16x16x32_bf16 v[104:107], a[164:167], a[244:247], v[104:107]
    v_cvt_pk_bf16_f32 v160, v96, v97
    v_permlane16_swap_b32 v22, v23
    v_mfma_f32_16x16x32_bf16 v[108:111], a[168:171], a[224:227], 0
    v_add_f32 v22, v22, v23
    v_mov_b32 v23, v22
    v_mfma_f32_16x16x32_bf16 v[108:111], a[172:175], a[228:231], v[108:111]
    v_cvt_pk_bf16_f32 v161, v98, v99
    v_permlane32_swap_b32 v22, v23
    v_mfma_f32_16x16x32_bf16 v[108:111], a[176:179], a[232:235], v[108:111]
    v_add_f32 v22, v22, v23
    v_cvt_pk_bf16_f32 v162, v100, v101
    v_mfma_f32_16x16x32_bf16 v[108:111], a[180:183], a[236:239], v[108:111]
    v_rcp_f32 v22, v22
    v_mfma_f32_16x16x32_bf16 v[108:111], a[184:187], a[240:243], v[108:111]
    v_mov_b32 v23, v22
    v_cvt_pk_bf16_f32 v163, v102, v103
    v_mfma_f32_16x16x32_bf16 v[108:111], a[188:191], a[244:247], v[108:111]
    v_permlane16_swap_b32 v22, v23
    s_waitcnt lgkmcnt(0)
    v_mfma_f32_16x16x32_bf16 v[112:115], a[96:99], a[248:251], 0
    v_mul_f32 v64, v64, v22
    v_mul_f32 v65, v65, v22
    v_mfma_f32_16x16x32_bf16 v[112:115], a[100:103], a[252:255], v[112:115]
    v_mul_f32 v66, v66, v22
    v_mul_f32 v67, v67, v22
    v_mfma_f32_16x16x32_bf16 v[112:115], a[104:107], a[192:195], v[112:115]
    v_mul_f32 v68, v68, v22
    v_mul_f32 v69, v69, v22
    v_mfma_f32_16x16x32_bf16 v[112:115], a[108:111], a[196:199], v[112:115]
    v_mul_f32 v70, v70, v22
    v_mul_f32 v71, v71, v22
    v_mfma_f32_16x16x32_bf16 v[112:115], a[112:115], a[200:203], v[112:115]
    v_cvt_pk_bf16_f32 v48, v64, v65
    v_cvt_pk_bf16_f32 v49, v66, v67
    v_mfma_f32_16x16x32_bf16 v[112:115], a[116:119], a[204:207], v[112:115]
    v_cvt_pk_bf16_f32 v50, v68, v69
    v_cvt_pk_bf16_f32 v51, v70, v71
    v_mfma_f32_16x16x32_bf16 v[116:119], a[120:123], a[248:251], 0
    v_mul_f32 v72, v72, v22
    v_mul_f32 v73, v73, v22
    v_mfma_f32_16x16x32_bf16 v[116:119], a[124:127], a[252:255], v[116:119]
    v_mul_f32 v74, v74, v22
    v_mul_f32 v75, v75, v22
    v_mfma_f32_16x16x32_bf16 v[116:119], a[128:131], a[192:195], v[116:119]
    v_mul_f32 v76, v76, v22
    v_mul_f32 v77, v77, v22
    v_mfma_f32_16x16x32_bf16 v[116:119], a[132:135], a[196:199], v[116:119]
    v_mul_f32 v78, v78, v22
    v_mul_f32 v79, v79, v22
    v_mfma_f32_16x16x32_bf16 v[116:119], a[136:139], a[200:203], v[116:119]
    v_cvt_pk_bf16_f32 v52, v72, v73
    v_cvt_pk_bf16_f32 v53, v74, v75
    v_mfma_f32_16x16x32_bf16 v[116:119], a[140:143], a[204:207], v[116:119]
    v_cvt_pk_bf16_f32 v54, v76, v77
    v_cvt_pk_bf16_f32 v55, v78, v79
    v_mfma_f32_16x16x32_bf16 v[120:123], a[144:147], a[248:251], 0
    v_mul_f32 v80, v80, v23
    v_mul_f32 v81, v81, v23
    v_mfma_f32_16x16x32_bf16 v[120:123], a[148:151], a[252:255], v[120:123]
    v_mul_f32 v82, v82, v23
    v_mul_f32 v83, v83, v23
    v_mfma_f32_16x16x32_bf16 v[120:123], a[152:155], a[192:195], v[120:123]
    ds_read_b128 a[208:211], v2 offset:45056
    v_mul_f32 v84, v84, v23
    v_mfma_f32_16x16x32_bf16 v[120:123], a[156:159], a[196:199], v[120:123]
    v_mul_f32 v85, v85, v23
    v_mul_f32 v86, v86, v23
    v_mfma_f32_16x16x32_bf16 v[120:123], a[160:163], a[200:203], v[120:123]
    ds_read_b128 a[212:215], v2 offset:46080
    v_mul_f32 v87, v87, v23
    v_mfma_f32_16x16x32_bf16 v[120:123], a[164:167], a[204:207], v[120:123]
    v_cvt_pk_bf16_f32 v56, v80, v81
    v_cvt_pk_bf16_f32 v57, v82, v83
    v_mfma_f32_16x16x32_bf16 v[124:127], a[168:171], a[248:251], 0
    ds_read_b128 a[216:219], v2 offset:47104
    v_cvt_pk_bf16_f32 v58, v84, v85
    v_mfma_f32_16x16x32_bf16 v[124:127], a[172:175], a[252:255], v[124:127]
    v_cvt_pk_bf16_f32 v59, v86, v87
    v_mul_f32 v88, v88, v23
    v_mfma_f32_16x16x32_bf16 v[124:127], a[176:179], a[192:195], v[124:127]
    ds_read_b128 a[220:223], v2 offset:48128
    v_mul_f32 v89, v89, v23
    v_mfma_f32_16x16x32_bf16 v[124:127], a[180:183], a[196:199], v[124:127]
    v_mul_f32 v90, v90, v23
    v_mul_f32 v91, v91, v23
    v_mfma_f32_16x16x32_bf16 v[124:127], a[184:187], a[200:203], v[124:127]
    ds_read_b128 a[224:227], v2 offset:49152
    v_mul_f32 v92, v92, v23
    v_mfma_f32_16x16x32_bf16 v[124:127], a[188:191], a[204:207], v[124:127]
    v_mul_f32 v93, v93, v23
    v_mul_f32 v94, v94, v23
    v_mfma_f32_16x16x32_bf16 v[64:67], v[48:51], v[128:131], 0
    ds_read_b128 a[228:231], v2 offset:50176
    v_mul_f32 v95, v95, v23
    v_mfma_f32_16x16x32_bf16 v[64:67], v[52:55], v[132:135], v[64:67]
    v_cvt_pk_bf16_f32 v60, v88, v89
    v_cvt_pk_bf16_f32 v61, v90, v91
    v_mfma_f32_16x16x32_bf16 v[68:71], v[48:51], v[136:139], 0
    v_cvt_pk_bf16_f32 v62, v92, v93
    v_cvt_pk_bf16_f32 v63, v94, v95
    v_mfma_f32_16x16x32_bf16 v[68:71], v[52:55], v[140:143], v[68:71]
    v_cvt_pk_bf16_f32 v164, v104, v105
    v_cvt_pk_bf16_f32 v165, v106, v107
    v_mfma_f32_16x16x32_bf16 v[72:75], v[48:51], v[144:147], 0
    v_cvt_pk_bf16_f32 v166, v108, v109
    v_cvt_pk_bf16_f32 v167, v110, v111
    v_mfma_f32_16x16x32_bf16 v[72:75], v[52:55], v[148:151], v[72:75]
    v_cvt_pk_bf16_f32 v168, v112, v113
    v_cvt_pk_bf16_f32 v169, v114, v115
    v_mfma_f32_16x16x32_bf16 v[76:79], v[48:51], v[152:155], 0
    v_cvt_pk_bf16_f32 v240, v64, v68
    v_cvt_pk_bf16_f32 v242, v65, v69
    v_mfma_f32_16x16x32_bf16 v[76:79], v[52:55], v[156:159], v[76:79]
    v_cvt_pk_bf16_f32 v244, v66, v70
    v_cvt_pk_bf16_f32 v246, v67, v71
    v_mfma_f32_16x16x32_bf16 v[80:83], v[56:59], v[128:131], 0
    v_cvt_pk_bf16_f32 v170, v116, v117
    v_cvt_pk_bf16_f32 v171, v118, v119
    v_mfma_f32_16x16x32_bf16 v[80:83], v[60:63], v[132:135], v[80:83]
    v_cvt_pk_bf16_f32 v172, v120, v121
    v_cvt_pk_bf16_f32 v173, v122, v123
    v_mfma_f32_16x16x32_bf16 v[84:87], v[56:59], v[136:139], 0
    v_cvt_pk_bf16_f32 v241, v72, v76
    v_cvt_pk_bf16_f32 v243, v73, v77
    v_mfma_f32_16x16x32_bf16 v[84:87], v[60:63], v[140:143], v[84:87]
    buffer_store_dwordx2 v[240:241], v11, s[12:15], s37 offen offset:0 sc1
    v_mfma_f32_16x16x32_bf16 v[88:91], v[56:59], v[144:147], 0
    v_cvt_pk_bf16_f32 v245, v74, v78
    v_cvt_pk_bf16_f32 v247, v75, v79
    v_mfma_f32_16x16x32_bf16 v[88:91], v[60:63], v[148:151], v[88:91]
    buffer_store_dwordx2 v[242:243], v11, s[12:15], s37 offen offset:384 sc1
    v_mfma_f32_16x16x32_bf16 v[92:95], v[56:59], v[152:155], 0
    ds_read_b128 a[232:235], v2 offset:51200
    v_cvt_pk_bf16_f32 v248, v80, v84
    v_mfma_f32_16x16x32_bf16 v[92:95], v[60:63], v[156:159], v[92:95]
    buffer_store_dwordx2 v[244:245], v11, s[12:15], s37 offen offset:768 sc1
    s_waitcnt lgkmcnt(1)
    v_mfma_f32_16x16x32_bf16 v[96:99], a[96:99], a[208:211], 0
    ds_read_b128 a[236:239], v2 offset:52224
    v_cvt_pk_bf16_f32 v250, v81, v85
    v_mfma_f32_16x16x32_bf16 v[96:99], a[100:103], a[212:215], v[96:99]
    buffer_store_dwordx2 v[246:247], v11, s[12:15], s37 offen offset:1152 sc1
    v_mfma_f32_16x16x32_bf16 v[96:99], a[104:107], a[216:219], v[96:99]
    ds_read_b128 a[240:243], v2 offset:53248
    v_cvt_pk_bf16_f32 v249, v88, v92
    v_mfma_f32_16x16x32_bf16 v[96:99], a[108:111], a[220:223], v[96:99]
    buffer_store_dwordx2 v[248:249], v11, s[12:15], s39 offen offset:0 sc1
    v_mfma_f32_16x16x32_bf16 v[96:99], a[112:115], a[224:227], v[96:99]
    ds_read_b128 a[244:247], v2 offset:54272
    v_cvt_pk_bf16_f32 v251, v89, v93
    v_mfma_f32_16x16x32_bf16 v[96:99], a[116:119], a[228:231], v[96:99]
    buffer_store_dwordx2 v[250:251], v11, s[12:15], s39 offen offset:384 sc1
    v_mfma_f32_16x16x32_bf16 v[100:103], a[120:123], a[208:211], 0
    ds_read_b128 a[248:251], v2 offset:55296
    v_cvt_pk_bf16_f32 v252, v82, v86
    v_mfma_f32_16x16x32_bf16 v[100:103], a[124:127], a[212:215], v[100:103]
    v_cvt_pk_bf16_f32 v253, v90, v94
    v_cvt_pk_bf16_f32 v254, v83, v87
    v_mfma_f32_16x16x32_bf16 v[100:103], a[128:131], a[216:219], v[100:103]
    buffer_store_dwordx2 v[252:253], v11, s[12:15], s39 offen offset:768 sc1
    v_mfma_f32_16x16x32_bf16 v[100:103], a[132:135], a[220:223], v[100:103]
    ds_read_b128 a[252:255], v2 offset:56320
    v_cvt_pk_bf16_f32 v255, v91, v95
    v_mfma_f32_16x16x32_bf16 v[100:103], a[136:139], a[224:227], v[100:103]
    buffer_store_dwordx2 v[254:255], v11, s[12:15], s39 offen offset:1152 sc1
    v_mfma_f32_16x16x32_bf16 v[100:103], a[140:143], a[228:231], v[100:103]
    v_cvt_pk_bf16_f32 v174, v124, v125
    v_cvt_pk_bf16_f32 v175, v126, v127
    v_mfma_f32_16x16x32_bf16 v[104:107], a[144:147], a[208:211], 0
    v_cvt_pk_bf16_f32 v176, v96, v97
    v_cvt_pk_bf16_f32 v177, v98, v99
    v_mfma_f32_16x16x32_bf16 v[104:107], a[148:151], a[212:215], v[104:107]
    v_mfma_f32_16x16x32_bf16 v[104:107], a[152:155], a[216:219], v[104:107]
    v_cvt_pk_bf16_f32 v178, v100, v101
    v_cvt_pk_bf16_f32 v179, v102, v103
    v_mfma_f32_16x16x32_bf16 v[104:107], a[156:159], a[220:223], v[104:107]
    v_mfma_f32_16x16x32_bf16 v[104:107], a[160:163], a[224:227], v[104:107]
    v_mfma_f32_16x16x32_bf16 v[104:107], a[164:167], a[228:231], v[104:107]
    v_mfma_f32_16x16x32_bf16 v[108:111], a[168:171], a[208:211], 0
    v_mfma_f32_16x16x32_bf16 v[108:111], a[172:175], a[212:215], v[108:111]
    v_mfma_f32_16x16x32_bf16 v[108:111], a[176:179], a[216:219], v[108:111]
    v_cvt_pk_bf16_f32 v180, v104, v105
    v_cvt_pk_bf16_f32 v181, v106, v107
    v_mfma_f32_16x16x32_bf16 v[108:111], a[180:183], a[220:223], v[108:111]
    v_mfma_f32_16x16x32_bf16 v[108:111], a[184:187], a[224:227], v[108:111]
    v_mfma_f32_16x16x32_bf16 v[108:111], a[188:191], a[228:231], v[108:111]
    s_waitcnt lgkmcnt(0)
    v_mfma_f32_16x16x32_bf16 v[112:115], a[96:99], a[232:235], 0
    v_mfma_f32_16x16x32_bf16 v[112:115], a[100:103], a[236:239], v[112:115]
    v_mfma_f32_16x16x32_bf16 v[112:115], a[104:107], a[240:243], v[112:115]
    v_cvt_pk_bf16_f32 v182, v108, v109
    v_cvt_pk_bf16_f32 v183, v110, v111
    v_mfma_f32_16x16x32_bf16 v[112:115], a[108:111], a[244:247], v[112:115]
    v_mfma_f32_16x16x32_bf16 v[112:115], a[112:115], a[248:251], v[112:115]
    v_mfma_f32_16x16x32_bf16 v[112:115], a[116:119], a[252:255], v[112:115]
    v_mfma_f32_16x16x32_bf16 v[116:119], a[120:123], a[232:235], 0
    v_mfma_f32_16x16x32_bf16 v[116:119], a[124:127], a[236:239], v[116:119]
    v_mfma_f32_16x16x32_bf16 v[116:119], a[128:131], a[240:243], v[116:119]
    v_cvt_pk_bf16_f32 v184, v112, v113
    v_cvt_pk_bf16_f32 v185, v114, v115
    v_mfma_f32_16x16x32_bf16 v[116:119], a[132:135], a[244:247], v[116:119]
    v_mfma_f32_16x16x32_bf16 v[116:119], a[136:139], a[248:251], v[116:119]
    v_mfma_f32_16x16x32_bf16 v[116:119], a[140:143], a[252:255], v[116:119]
    v_mfma_f32_16x16x32_bf16 v[120:123], a[144:147], a[232:235], 0
    v_mfma_f32_16x16x32_bf16 v[120:123], a[148:151], a[236:239], v[120:123]
    v_mfma_f32_16x16x32_bf16 v[120:123], a[152:155], a[240:243], v[120:123]
    v_cvt_pk_bf16_f32 v186, v116, v117
    v_cvt_pk_bf16_f32 v187, v118, v119
    v_mfma_f32_16x16x32_bf16 v[120:123], a[156:159], a[244:247], v[120:123]
    v_mfma_f32_16x16x32_bf16 v[120:123], a[160:163], a[248:251], v[120:123]
    v_mfma_f32_16x16x32_bf16 v[120:123], a[164:167], a[252:255], v[120:123]
    v_mfma_f32_16x16x32_bf16 v[124:127], a[168:171], a[232:235], 0
    v_mfma_f32_16x16x32_bf16 v[124:127], a[172:175], a[236:239], v[124:127]
    v_mfma_f32_16x16x32_bf16 v[124:127], a[176:179], a[240:243], v[124:127]
    v_cvt_pk_bf16_f32 v188, v120, v121
    v_cvt_pk_bf16_f32 v189, v122, v123
    v_mfma_f32_16x16x32_bf16 v[124:127], a[180:183], a[244:247], v[124:127]
    v_mfma_f32_16x16x32_bf16 v[124:127], a[184:187], a[248:251], v[124:127]
    v_mfma_f32_16x16x32_bf16 v[124:127], a[188:191], a[252:255], v[124:127]
    v_mfma_f32_16x16x32_bf16 v[64:67], v[32:35], v[160:163], 0
    v_mfma_f32_16x16x32_bf16 v[64:67], v[36:39], v[164:167], v[64:67]
    v_mfma_f32_16x16x32_bf16 v[68:71], v[32:35], v[168:171], 0
    v_cvt_pk_bf16_f32 v190, v124, v125
    v_cvt_pk_bf16_f32 v191, v126, v127
    v_mfma_f32_16x16x32_bf16 v[68:71], v[36:39], v[172:175], v[68:71]
    v_mfma_f32_16x16x32_bf16 v[72:75], v[32:35], v[176:179], 0
    v_mfma_f32_16x16x32_bf16 v[72:75], v[36:39], v[180:183], v[72:75]
    v_mfma_f32_16x16x32_bf16 v[76:79], v[32:35], v[184:187], 0
    ds_read_b128 a[192:195], v2 offset:57344
    v_cvt_pk_bf16_f32 v128, v64, v68
    v_mfma_f32_16x16x32_bf16 v[76:79], v[36:39], v[188:191], v[76:79]
    v_cvt_pk_bf16_f32 v130, v65, v69
    v_cvt_pk_bf16_f32 v132, v66, v70
    v_mfma_f32_16x16x32_bf16 v[80:83], v[40:43], v[160:163], 0
    ds_read_b128 a[196:199], v2 offset:58368
    v_cvt_pk_bf16_f32 v134, v67, v71
    v_mfma_f32_16x16x32_bf16 v[80:83], v[44:47], v[164:167], v[80:83]
    v_mfma_f32_16x16x32_bf16 v[84:87], v[40:43], v[168:171], 0
    ds_read_b128 a[200:203], v2 offset:59392
    v_cvt_pk_bf16_f32 v129, v72, v76
    v_mfma_f32_16x16x32_bf16 v[84:87], v[44:47], v[172:175], v[84:87]
    buffer_store_dwordx2 v[128:129], v11, s[12:15], s33 offen offset:128 sc1
    v_mfma_f32_16x16x32_bf16 v[88:91], v[40:43], v[176:179], 0
    ds_read_b128 a[204:207], v2 offset:60416
    v_cvt_pk_bf16_f32 v131, v73, v77
    v_mfma_f32_16x16x32_bf16 v[88:91], v[44:47], v[180:183], v[88:91]
    buffer_store_dwordx2 v[130:131], v11, s[12:15], s33 offen offset:512 sc1
    v_mfma_f32_16x16x32_bf16 v[92:95], v[40:43], v[184:187], 0
    ds_read_b128 a[208:211], v2 offset:61440
    v_cvt_pk_bf16_f32 v133, v74, v78
    v_mfma_f32_16x16x32_bf16 v[92:95], v[44:47], v[188:191], v[92:95]
    buffer_store_dwordx2 v[132:133], v11, s[12:15], s33 offen offset:896 sc1
    v_mfma_f32_16x16x32_bf16 v[192:195], v[48:51], v[160:163], 0
    ds_read_b128 a[212:215], v2 offset:62464
    v_cvt_pk_bf16_f32 v135, v75, v79
    v_mfma_f32_16x16x32_bf16 v[192:195], v[52:55], v[164:167], v[192:195]
    buffer_store_dwordx2 v[134:135], v11, s[12:15], s33 offen offset:1280 sc1
    v_mfma_f32_16x16x32_bf16 v[196:199], v[48:51], v[168:171], 0
    v_cvt_pk_bf16_f32 v136, v80, v84
    v_cvt_pk_bf16_f32 v137, v88, v92
    v_mfma_f32_16x16x32_bf16 v[196:199], v[52:55], v[172:175], v[196:199]
    buffer_store_dwordx2 v[136:137], v11, s[12:15], s35 offen offset:128 sc1
    v_mfma_f32_16x16x32_bf16 v[200:203], v[48:51], v[176:179], 0
    v_cvt_pk_bf16_f32 v138, v81, v85
    v_cvt_pk_bf16_f32 v139, v89, v93
    v_mfma_f32_16x16x32_bf16 v[200:203], v[52:55], v[180:183], v[200:203]
    buffer_store_dwordx2 v[138:139], v11, s[12:15], s35 offen offset:512 sc1
    v_mfma_f32_16x16x32_bf16 v[204:207], v[48:51], v[184:187], 0
    v_cvt_pk_bf16_f32 v140, v82, v86
    v_cvt_pk_bf16_f32 v141, v90, v94
    v_mfma_f32_16x16x32_bf16 v[204:207], v[52:55], v[188:191], v[204:207]
    buffer_store_dwordx2 v[140:141], v11, s[12:15], s35 offen offset:896 sc1
    v_mfma_f32_16x16x32_bf16 v[208:211], v[56:59], v[160:163], 0
    v_cvt_pk_bf16_f32 v142, v83, v87
    v_cvt_pk_bf16_f32 v143, v91, v95
    v_mfma_f32_16x16x32_bf16 v[208:211], v[60:63], v[164:167], v[208:211]
    buffer_store_dwordx2 v[142:143], v11, s[12:15], s35 offen offset:1280 sc1
    v_mfma_f32_16x16x32_bf16 v[212:215], v[56:59], v[168:171], 0
    v_cvt_pk_bf16_f32 v144, v192, v196
    v_cvt_pk_bf16_f32 v145, v200, v204
    v_mfma_f32_16x16x32_bf16 v[212:215], v[60:63], v[172:175], v[212:215]
    buffer_store_dwordx2 v[144:145], v11, s[12:15], s37 offen offset:128 sc1
    v_mfma_f32_16x16x32_bf16 v[216:219], v[56:59], v[176:179], 0
    v_cvt_pk_bf16_f32 v146, v193, v197
    v_cvt_pk_bf16_f32 v147, v201, v205
    v_mfma_f32_16x16x32_bf16 v[216:219], v[60:63], v[180:183], v[216:219]
    buffer_store_dwordx2 v[146:147], v11, s[12:15], s37 offen offset:512 sc1
    v_mfma_f32_16x16x32_bf16 v[220:223], v[56:59], v[184:187], 0
    ds_read_b128 a[216:219], v2 offset:63488
    v_cvt_pk_bf16_f32 v148, v194, v198
    v_mfma_f32_16x16x32_bf16 v[220:223], v[60:63], v[188:191], v[220:223]
    v_cvt_pk_bf16_f32 v149, v202, v206
    s_waitcnt lgkmcnt(1)
    v_mfma_f32_16x16x32_bf16 v[96:99], a[96:99], a[192:195], 0
    buffer_store_dwordx2 v[148:149], v11, s[12:15], s37 offen offset:896 sc1
    v_mfma_f32_16x16x32_bf16 v[96:99], a[100:103], a[196:199], v[96:99]
    ds_read_b128 a[220:223], v2 offset:64512
    v_cvt_pk_bf16_f32 v150, v195, v199
    v_mfma_f32_16x16x32_bf16 v[96:99], a[104:107], a[200:203], v[96:99]
    ds_read_b128 a[224:227], v3 offset:0
    v_cvt_pk_bf16_f32 v151, v203, v207
    v_mfma_f32_16x16x32_bf16 v[96:99], a[108:111], a[204:207], v[96:99]
    buffer_store_dwordx2 v[150:151], v11, s[12:15], s37 offen offset:1280 sc1
    v_mfma_f32_16x16x32_bf16 v[96:99], a[112:115], a[208:211], v[96:99]
    ds_read_b128 a[228:231], v3 offset:1024
    v_cvt_pk_bf16_f32 v152, v208, v212
    v_mfma_f32_16x16x32_bf16 v[96:99], a[116:119], a[212:215], v[96:99]
    v_cvt_pk_bf16_f32 v153, v216, v220
    v_cvt_pk_bf16_f32 v154, v209, v213
    v_mfma_f32_16x16x32_bf16 v[100:103], a[120:123], a[192:195], 0
    buffer_store_dwordx2 v[152:153], v11, s[12:15], s39 offen offset:128 sc1
    v_mfma_f32_16x16x32_bf16 v[100:103], a[124:127], a[196:199], v[100:103]
    ds_read_b128 a[232:235], v3 offset:2048
    v_cvt_pk_bf16_f32 v155, v217, v221
    v_mfma_f32_16x16x32_bf16 v[100:103], a[128:131], a[200:203], v[100:103]
    buffer_store_dwordx2 v[154:155], v11, s[12:15], s39 offen offset:512 sc1
    v_mfma_f32_16x16x32_bf16 v[100:103], a[132:135], a[204:207], v[100:103]
    ds_read_b128 a[236:239], v3 offset:3072
    v_cvt_pk_bf16_f32 v156, v210, v214
    v_mfma_f32_16x16x32_bf16 v[100:103], a[136:139], a[208:211], v[100:103]
    v_cvt_pk_bf16_f32 v157, v218, v222
    v_cvt_pk_bf16_f32 v158, v211, v215
    v_mfma_f32_16x16x32_bf16 v[100:103], a[140:143], a[212:215], v[100:103]
    buffer_store_dwordx2 v[156:157], v11, s[12:15], s39 offen offset:896 sc1
    v_mfma_f32_16x16x32_bf16 v[104:107], a[144:147], a[192:195], 0
    v_cvt_pk_bf16_f32 v159, v219, v223
    v_cvt_pk_bf16_f32 v192, v96, v97
    v_mfma_f32_16x16x32_bf16 v[104:107], a[148:151], a[196:199], v[104:107]
    buffer_store_dwordx2 v[158:159], v11, s[12:15], s39 offen offset:1280 sc1
    v_mfma_f32_16x16x32_bf16 v[104:107], a[152:155], a[200:203], v[104:107]
    v_cvt_pk_bf16_f32 v193, v98, v99
    v_cvt_pk_bf16_f32 v194, v100, v101
    v_mfma_f32_16x16x32_bf16 v[104:107], a[156:159], a[204:207], v[104:107]
    v_cvt_pk_bf16_f32 v195, v102, v103
    v_mfma_f32_16x16x32_bf16 v[104:107], a[160:163], a[208:211], v[104:107]
    v_mfma_f32_16x16x32_bf16 v[104:107], a[164:167], a[212:215], v[104:107]
    v_mfma_f32_16x16x32_bf16 v[108:111], a[168:171], a[192:195], 0
    v_mfma_f32_16x16x32_bf16 v[108:111], a[172:175], a[196:199], v[108:111]
    v_mfma_f32_16x16x32_bf16 v[108:111], a[176:179], a[200:203], v[108:111]
    v_cvt_pk_bf16_f32 v196, v104, v105
    v_cvt_pk_bf16_f32 v197, v106, v107
    v_mfma_f32_16x16x32_bf16 v[108:111], a[180:183], a[204:207], v[108:111]
    v_mfma_f32_16x16x32_bf16 v[108:111], a[184:187], a[208:211], v[108:111]
    ds_read_b128 a[240:243], v3 offset:4096
    v_mfma_f32_16x16x32_bf16 v[108:111], a[188:191], a[212:215], v[108:111]
    s_waitcnt lgkmcnt(1)
    v_mfma_f32_16x16x32_bf16 v[112:115], a[96:99], a[216:219], 0
    ds_read_b128 a[244:247], v3 offset:5120
    v_mfma_f32_16x16x32_bf16 v[112:115], a[100:103], a[220:223], v[112:115]
    v_mfma_f32_16x16x32_bf16 v[112:115], a[104:107], a[224:227], v[112:115]
    ds_read_b128 a[248:251], v3 offset:6144
    v_cvt_pk_bf16_f32 v198, v108, v109
    v_mfma_f32_16x16x32_bf16 v[112:115], a[108:111], a[228:231], v[112:115]
    v_cvt_pk_bf16_f32 v199, v110, v111
    v_mfma_f32_16x16x32_bf16 v[112:115], a[112:115], a[232:235], v[112:115]
    ds_read_b128 a[252:255], v3 offset:7168
    v_mfma_f32_16x16x32_bf16 v[112:115], a[116:119], a[236:239], v[112:115]
    v_mfma_f32_16x16x32_bf16 v[116:119], a[120:123], a[216:219], 0
    ds_read_b128 a[192:195], v3 offset:8192
    v_mfma_f32_16x16x32_bf16 v[116:119], a[124:127], a[220:223], v[116:119]
    v_mfma_f32_16x16x32_bf16 v[116:119], a[128:131], a[224:227], v[116:119]
    ds_read_b128 a[196:199], v3 offset:9216
    v_cvt_pk_bf16_f32 v200, v112, v113
    v_mfma_f32_16x16x32_bf16 v[116:119], a[132:135], a[228:231], v[116:119]
    v_cvt_pk_bf16_f32 v201, v114, v115
    v_mfma_f32_16x16x32_bf16 v[116:119], a[136:139], a[232:235], v[116:119]
    v_mfma_f32_16x16x32_bf16 v[116:119], a[140:143], a[236:239], v[116:119]
    v_mfma_f32_16x16x32_bf16 v[120:123], a[144:147], a[216:219], 0
    v_mfma_f32_16x16x32_bf16 v[120:123], a[148:151], a[220:223], v[120:123]
    v_mfma_f32_16x16x32_bf16 v[120:123], a[152:155], a[224:227], v[120:123]
    v_cvt_pk_bf16_f32 v202, v116, v117
    v_cvt_pk_bf16_f32 v203, v118, v119
    v_mfma_f32_16x16x32_bf16 v[120:123], a[156:159], a[228:231], v[120:123]
    v_mfma_f32_16x16x32_bf16 v[120:123], a[160:163], a[232:235], v[120:123]
    v_mfma_f32_16x16x32_bf16 v[120:123], a[164:167], a[236:239], v[120:123]
    v_mfma_f32_16x16x32_bf16 v[124:127], a[168:171], a[216:219], 0
    v_mfma_f32_16x16x32_bf16 v[124:127], a[172:175], a[220:223], v[124:127]
    v_mfma_f32_16x16x32_bf16 v[124:127], a[176:179], a[224:227], v[124:127]
    v_cvt_pk_bf16_f32 v204, v120, v121
    v_cvt_pk_bf16_f32 v205, v122, v123
    v_mfma_f32_16x16x32_bf16 v[124:127], a[180:183], a[228:231], v[124:127]
    v_mfma_f32_16x16x32_bf16 v[124:127], a[184:187], a[232:235], v[124:127]
    ds_read_b128 a[200:203], v3 offset:10240
    v_mfma_f32_16x16x32_bf16 v[124:127], a[188:191], a[236:239], v[124:127]
    s_waitcnt lgkmcnt(1)
    v_mfma_f32_16x16x32_bf16 v[96:99], a[96:99], a[240:243], 0
    ds_read_b128 a[204:207], v3 offset:11264
    v_mfma_f32_16x16x32_bf16 v[96:99], a[100:103], a[244:247], v[96:99]
    v_mfma_f32_16x16x32_bf16 v[96:99], a[104:107], a[248:251], v[96:99]
    ds_read_b128 a[208:211], v3 offset:12288
    v_cvt_pk_bf16_f32 v206, v124, v125
    v_mfma_f32_16x16x32_bf16 v[96:99], a[108:111], a[252:255], v[96:99]
    v_cvt_pk_bf16_f32 v207, v126, v127
    v_mfma_f32_16x16x32_bf16 v[96:99], a[112:115], a[192:195], v[96:99]
    ds_read_b128 a[212:215], v3 offset:13312
    v_mfma_f32_16x16x32_bf16 v[96:99], a[116:119], a[196:199], v[96:99]
    v_mfma_f32_16x16x32_bf16 v[100:103], a[120:123], a[240:243], 0
    ds_read_b128 a[216:219], v3 offset:14336
    v_mfma_f32_16x16x32_bf16 v[100:103], a[124:127], a[244:247], v[100:103]
    v_mfma_f32_16x16x32_bf16 v[100:103], a[128:131], a[248:251], v[100:103]
    ds_read_b128 a[220:223], v3 offset:15360
    v_cvt_pk_bf16_f32 v208, v96, v97
    v_mfma_f32_16x16x32_bf16 v[100:103], a[132:135], a[252:255], v[100:103]
    v_cvt_pk_bf16_f32 v209, v98, v99
    v_mfma_f32_16x16x32_bf16 v[100:103], a[136:139], a[192:195], v[100:103]
    v_mfma_f32_16x16x32_bf16 v[100:103], a[140:143], a[196:199], v[100:103]
    v_mfma_f32_16x16x32_bf16 v[104:107], a[144:147], a[240:243], 0
    v_mfma_f32_16x16x32_bf16 v[104:107], a[148:151], a[244:247], v[104:107]
    v_mfma_f32_16x16x32_bf16 v[104:107], a[152:155], a[248:251], v[104:107]
    v_cvt_pk_bf16_f32 v210, v100, v101
    v_cvt_pk_bf16_f32 v211, v102, v103
    v_mfma_f32_16x16x32_bf16 v[104:107], a[156:159], a[252:255], v[104:107]
    v_mfma_f32_16x16x32_bf16 v[104:107], a[160:163], a[192:195], v[104:107]
    v_mfma_f32_16x16x32_bf16 v[104:107], a[164:167], a[196:199], v[104:107]
    v_mfma_f32_16x16x32_bf16 v[108:111], a[168:171], a[240:243], 0
    v_mfma_f32_16x16x32_bf16 v[108:111], a[172:175], a[244:247], v[108:111]
    v_mfma_f32_16x16x32_bf16 v[108:111], a[176:179], a[248:251], v[108:111]
    v_cvt_pk_bf16_f32 v212, v104, v105
    v_cvt_pk_bf16_f32 v213, v106, v107
    v_mfma_f32_16x16x32_bf16 v[108:111], a[180:183], a[252:255], v[108:111]
    v_mfma_f32_16x16x32_bf16 v[108:111], a[184:187], a[192:195], v[108:111]
    v_mfma_f32_16x16x32_bf16 v[108:111], a[188:191], a[196:199], v[108:111]
    s_waitcnt lgkmcnt(0)
    v_mfma_f32_16x16x32_bf16 v[112:115], a[96:99], a[200:203], 0
    v_mfma_f32_16x16x32_bf16 v[112:115], a[100:103], a[204:207], v[112:115]
    v_mfma_f32_16x16x32_bf16 v[112:115], a[104:107], a[208:211], v[112:115]
    v_cvt_pk_bf16_f32 v214, v108, v109
    v_cvt_pk_bf16_f32 v215, v110, v111
    v_mfma_f32_16x16x32_bf16 v[112:115], a[108:111], a[212:215], v[112:115]
    v_mfma_f32_16x16x32_bf16 v[112:115], a[112:115], a[216:219], v[112:115]
    v_mfma_f32_16x16x32_bf16 v[112:115], a[116:119], a[220:223], v[112:115]
    v_mfma_f32_16x16x32_bf16 v[116:119], a[120:123], a[200:203], 0
    v_mfma_f32_16x16x32_bf16 v[116:119], a[124:127], a[204:207], v[116:119]
    v_mfma_f32_16x16x32_bf16 v[116:119], a[128:131], a[208:211], v[116:119]
    v_cvt_pk_bf16_f32 v216, v112, v113
    v_cvt_pk_bf16_f32 v217, v114, v115
    v_mfma_f32_16x16x32_bf16 v[116:119], a[132:135], a[212:215], v[116:119]
    v_mfma_f32_16x16x32_bf16 v[116:119], a[136:139], a[216:219], v[116:119]
    v_mfma_f32_16x16x32_bf16 v[116:119], a[140:143], a[220:223], v[116:119]
    v_mfma_f32_16x16x32_bf16 v[120:123], a[144:147], a[200:203], 0
    v_mfma_f32_16x16x32_bf16 v[120:123], a[148:151], a[204:207], v[120:123]
    v_mfma_f32_16x16x32_bf16 v[120:123], a[152:155], a[208:211], v[120:123]
    v_cvt_pk_bf16_f32 v218, v116, v117
    v_cvt_pk_bf16_f32 v219, v118, v119
    v_mfma_f32_16x16x32_bf16 v[120:123], a[156:159], a[212:215], v[120:123]
    v_mfma_f32_16x16x32_bf16 v[120:123], a[160:163], a[216:219], v[120:123]
    v_mfma_f32_16x16x32_bf16 v[120:123], a[164:167], a[220:223], v[120:123]
    v_mfma_f32_16x16x32_bf16 v[124:127], a[168:171], a[200:203], 0
    v_mfma_f32_16x16x32_bf16 v[124:127], a[172:175], a[204:207], v[124:127]
    v_mfma_f32_16x16x32_bf16 v[124:127], a[176:179], a[208:211], v[124:127]
    v_cvt_pk_bf16_f32 v220, v120, v121
    v_cvt_pk_bf16_f32 v221, v122, v123
    v_mfma_f32_16x16x32_bf16 v[124:127], a[180:183], a[212:215], v[124:127]
    v_mfma_f32_16x16x32_bf16 v[124:127], a[184:187], a[216:219], v[124:127]
    v_mfma_f32_16x16x32_bf16 v[124:127], a[188:191], a[220:223], v[124:127]
    v_mfma_f32_16x16x32_bf16 v[64:67], v[32:35], v[192:195], 0
    v_mfma_f32_16x16x32_bf16 v[64:67], v[36:39], v[196:199], v[64:67]
    v_mfma_f32_16x16x32_bf16 v[68:71], v[32:35], v[200:203], 0
    v_cvt_pk_bf16_f32 v222, v124, v125
    v_cvt_pk_bf16_f32 v223, v126, v127
    v_mfma_f32_16x16x32_bf16 v[68:71], v[36:39], v[204:207], v[68:71]
    v_mfma_f32_16x16x32_bf16 v[72:75], v[32:35], v[208:211], 0
    v_mfma_f32_16x16x32_bf16 v[72:75], v[36:39], v[212:215], v[72:75]
    v_mfma_f32_16x16x32_bf16 v[76:79], v[32:35], v[216:219], 0
    v_cvt_pk_bf16_f32 v160, v64, v68
    v_cvt_pk_bf16_f32 v162, v65, v69
    v_mfma_f32_16x16x32_bf16 v[76:79], v[36:39], v[220:223], v[76:79]
    v_cvt_pk_bf16_f32 v164, v66, v70
    v_cvt_pk_bf16_f32 v166, v67, v71
    v_mfma_f32_16x16x32_bf16 v[80:83], v[40:43], v[192:195], 0
    v_mfma_f32_16x16x32_bf16 v[80:83], v[44:47], v[196:199], v[80:83]
    v_mfma_f32_16x16x32_bf16 v[84:87], v[40:43], v[200:203], 0
    v_cvt_pk_bf16_f32 v161, v72, v76
    v_cvt_pk_bf16_f32 v163, v73, v77
    v_mfma_f32_16x16x32_bf16 v[84:87], v[44:47], v[204:207], v[84:87]
    buffer_store_dwordx2 v[160:161], v11, s[12:15], s33 offen offset:256 sc1
    v_mfma_f32_16x16x32_bf16 v[88:91], v[40:43], v[208:211], 0
    v_cvt_pk_bf16_f32 v165, v74, v78
    v_cvt_pk_bf16_f32 v167, v75, v79
    v_mfma_f32_16x16x32_bf16 v[88:91], v[44:47], v[212:215], v[88:91]
    buffer_store_dwordx2 v[162:163], v11, s[12:15], s33 offen offset:640 sc1
    v_mfma_f32_16x16x32_bf16 v[92:95], v[40:43], v[216:219], 0
    v_cvt_pk_bf16_f32 v168, v80, v84
    v_cvt_pk_bf16_f32 v170, v81, v85
    v_mfma_f32_16x16x32_bf16 v[92:95], v[44:47], v[220:223], v[92:95]
    buffer_store_dwordx2 v[164:165], v11, s[12:15], s33 offen offset:1024 sc1
    v_mfma_f32_16x16x32_bf16 v[96:99], v[48:51], v[192:195], 0
    v_cvt_pk_bf16_f32 v172, v82, v86
    v_cvt_pk_bf16_f32 v174, v83, v87
    v_mfma_f32_16x16x32_bf16 v[96:99], v[52:55], v[196:199], v[96:99]
    buffer_store_dwordx2 v[166:167], v11, s[12:15], s33 offen offset:1408 sc1
    v_mfma_f32_16x16x32_bf16 v[100:103], v[48:51], v[200:203], 0
    v_cvt_pk_bf16_f32 v169, v88, v92
    v_cvt_pk_bf16_f32 v171, v89, v93
    v_mfma_f32_16x16x32_bf16 v[100:103], v[52:55], v[204:207], v[100:103]
    buffer_store_dwordx2 v[168:169], v11, s[12:15], s35 offen offset:256 sc1
    v_mfma_f32_16x16x32_bf16 v[104:107], v[48:51], v[208:211], 0
    v_cvt_pk_bf16_f32 v173, v90, v94
    v_cvt_pk_bf16_f32 v175, v91, v95
    v_mfma_f32_16x16x32_bf16 v[104:107], v[52:55], v[212:215], v[104:107]
    buffer_store_dwordx2 v[170:171], v11, s[12:15], s35 offen offset:640 sc1
    v_mfma_f32_16x16x32_bf16 v[108:111], v[48:51], v[216:219], 0
    v_cvt_pk_bf16_f32 v176, v96, v100
    v_cvt_pk_bf16_f32 v178, v97, v101
    v_mfma_f32_16x16x32_bf16 v[108:111], v[52:55], v[220:223], v[108:111]
    buffer_store_dwordx2 v[172:173], v11, s[12:15], s35 offen offset:1024 sc1
    v_mfma_f32_16x16x32_bf16 v[112:115], v[56:59], v[192:195], 0
    v_cvt_pk_bf16_f32 v180, v98, v102
    v_cvt_pk_bf16_f32 v182, v99, v103
    v_mfma_f32_16x16x32_bf16 v[112:115], v[60:63], v[196:199], v[112:115]
    buffer_store_dwordx2 v[174:175], v11, s[12:15], s35 offen offset:1408 sc1
    v_mfma_f32_16x16x32_bf16 v[116:119], v[56:59], v[200:203], 0
    v_cvt_pk_bf16_f32 v177, v104, v108
    v_cvt_pk_bf16_f32 v179, v105, v109
    v_mfma_f32_16x16x32_bf16 v[116:119], v[60:63], v[204:207], v[116:119]
    buffer_store_dwordx2 v[176:177], v11, s[12:15], s37 offen offset:256 sc1
    v_mfma_f32_16x16x32_bf16 v[120:123], v[56:59], v[208:211], 0
    v_cvt_pk_bf16_f32 v181, v106, v110
    v_cvt_pk_bf16_f32 v183, v107, v111
    v_mfma_f32_16x16x32_bf16 v[120:123], v[60:63], v[212:215], v[120:123]
    buffer_store_dwordx2 v[178:179], v11, s[12:15], s37 offen offset:640 sc1
    v_mfma_f32_16x16x32_bf16 v[124:127], v[56:59], v[216:219], 0
    v_cvt_pk_bf16_f32 v184, v112, v116
    v_cvt_pk_bf16_f32 v186, v113, v117
    v_mfma_f32_16x16x32_bf16 v[124:127], v[60:63], v[220:223], v[124:127]
    buffer_store_dwordx2 v[180:181], v11, s[12:15], s37 offen offset:1024 sc1
    s_nop 6
    v_cvt_pk_bf16_f32 v185, v120, v124
    v_cvt_pk_bf16_f32 v187, v121, v125
    v_cvt_pk_bf16_f32 v188, v114, v118
    v_cvt_pk_bf16_f32 v189, v122, v126
    v_cvt_pk_bf16_f32 v190, v115, v119
    v_cvt_pk_bf16_f32 v191, v123, v127
    buffer_store_dwordx2 v[182:183], v11, s[12:15], s37 offen offset:1408 sc1
    buffer_store_dwordx2 v[184:185], v11, s[12:15], s39 offen offset:256 sc1
    buffer_store_dwordx2 v[186:187], v11, s[12:15], s39 offen offset:640 sc1
    buffer_store_dwordx2 v[188:189], v11, s[12:15], s39 offen offset:1024 sc1
    buffer_store_dwordx2 v[190:191], v11, s[12:15], s39 offen offset:1408 sc1
L_end:
    s_endpgm
L_slow0:
    s_sub_u32 s43, s43, 1
    s_cbranch_scc1 L_end
    ds_read_b32 v30, v29
    s_waitcnt lgkmcnt(0)
    v_readfirstlane_b32 s41, v30
    s_nop 1
    s_andn2_b32 s41, 1, s41
    s_cbranch_scc1 L_slow0
    s_branch L_ok0
L_slow1:
    s_sub_u32 s43, s43, 1
    s_cbranch_scc1 L_end
    ds_read_b32 v30, v29
    s_waitcnt lgkmcnt(0)
    v_readfirstlane_b32 s41, v30
    s_nop 1
    s_andn2_b32 s41, 2, s41
    s_cbranch_scc1 L_slow1
    s_branch L_ok1
L_slow2:
    s_sub_u32 s43, s43, 1
    s_cbranch_scc1 L_end
    ds_read_b32 v30, v29
    s_waitcnt lgkmcnt(0)
    v_readfirstlane_b32 s41, v30
    s_nop 1
    s_andn2_b32 s41, 4, s41
    s_cbranch_scc1 L_slow2
    s_branch L_ok2
L_slow3:
    s_sub_u32 s43, s43, 1
    s_cbranch_scc1 L_end
    ds_read_b32 v30, v29
    s_waitcnt lgkmcnt(0)
    v_readfirstlane_b32 s41, v30
    s_nop 1
    s_andn2_b32 s41, 8, s41
    s_cbranch_scc1 L_slow3
    s_branch L_ok3
L_slow4:
    s_sub_u32 s43, s43, 1
    s_cbranch_scc1 L_end
    ds_read_b32 v30, v29
    s_waitcnt lgkmcnt(0)
    v_readfirstlane_b32 s41, v30
    s_nop 1
    s_andn2_b32 s41, 16, s41
    s_cbranch_scc1 L_slow4
    s_branch L_ok4
L_slow5:
    s_sub_u32 s43, s43, 1
    s_cbranch_scc1 L_end
    ds_read_b32 v30, v29
    s_waitcnt lgkmcnt(0)
    v_readfirstlane_b32 s41, v30
    s_nop 1
    s_andn2_b32 s41, 32, s41
    s_cbranch_scc1 L_slow5
    s_branch L_ok5
L_slow6:
    s_sub_u32 s43, s43, 1
    s_cbranch_scc1 L_end
    ds_read_b32 v30, v29
    s_waitcnt lgkmcnt(0)
    v_readfirstlane_b32 s41, v30
    s_nop 1
    s_andn2_b32 s41, 960, s41
    s_cbranch_scc1 L_slow6
    s_branch L_ok6
L_fb:
    s_mov_b32 s60, 0
    s_cmp_lt_u32 s2, 192
    s_cbranch_scc0 L_fb_task
L_fbw:
    s_sub_u32 s43, s43, 1
    s_cbranch_scc1 L_end
    ds_read_b32 v34, v29 offset:4
    s_waitcnt lgkmcnt(0)
    v_readfirstlane_b32 s61, v34
    s_nop 1
    s_cmp_eq_u32 s61, 3
    s_cbranch_scc0 L_fbw
L_fb_task:
    s_mov_b32 s63, 3
    s_branch L_raw
L_fb_raw:
    s_bitcmp1_b32 s63, 1
    s_mov_b32 s63, 1
    s_cbranch_scc1 L_raw
    s_branch L_prod
L_fb_next:
    s_waitcnt vmcnt(0)
    s_add_u32 s60, s60, 1
    s_cmp_lt_u32 s60, 72
    s_cbranch_scc1 L_fb_task
    s_branch L_go
L_code_end:
.section .rodata,"a"
.p2align 6
.amdhsa_kernel standalone__swin_window_attn__vision_kernel
  .amdhsa_next_free_vgpr 512
  .amdhsa_next_free_sgpr 102
  .amdhsa_accum_offset 256
  .amdhsa_group_segment_fixed_size 0
  .amdhsa_kernarg_size 48
  .amdhsa_user_sgpr_count 2
  .amdhsa_user_sgpr_kernarg_segment_ptr 1
  .amdhsa_system_sgpr_workgroup_id_x 1
.end_amdhsa_kernel
```

```asm
; @launch grid=(256,1,1) block=(256,1,1) lds=163840
.amdgcn_target "amdgcn-amd-amdhsa--gfx950"
.text
.globl standalone__swin_window_attn__vision_kernel
.p2align 8
.type standalone__swin_window_attn__vision_kernel,@function
standalone__swin_window_attn__vision_kernel:
    s_cmp_ge_u32 s2, 256
    s_cbranch_scc1 L_end
    s_load_dwordx4 s[4:7], s[0:1], 0
    s_load_dwordx4 s[20:23], s[0:1], 16
    s_load_dwordx4 s[56:59], s[0:1], 32
    v_lshrrev_b32 v16, 6, v0
    v_and_b32 v0, 63, v0
    s_getpc_b64 s[44:45]
L_pc_ref:
    v_readfirstlane_b32 s49, v16
    s_mov_b32 s46, L_code_end-L_pc_ref
    s_mov_b32 s47, 0x00020000
    v_lshlrev_b32 v7, 6, v0
    s_lshr_b32 s60, s2, 3

    s_lshl_b32 s42, s60, 2
    s_add_u32 s42, s42, s49
    s_lshl_b32 s42, s42, 7
    v_lshrrev_b32 v8, 1, v0
    v_and_b32 v7, 1, v0
    v_lshlrev_b32 v7, 6, v7
    v_lshl_add_u32 v8, v8, 14, v7
    buffer_load_dword v8, v8, s[44:47], s42 offen
    s_cmp_lt_u32 s60, 24
    s_cbranch_scc0 L_setup
    s_cmp_ge_u32 s60, 12
    s_cselect_b32 s61, 12, 0
    s_cselect_b32 s62, 36, 0
    s_sub_u32 s61, s60, s61
    s_and_b32 s64, s61, 1
    s_mul_i32 s64, s64, 3
    s_max_u32 s65, s49, 1
    s_add_u32 s64, s64, s65
    s_sub_u32 s64, s64, 1
    s_mul_i32 s64, s64, 6
    s_lshr_b32 s61, s61, 1
    s_add_u32 s60, s64, s61
    s_add_u32 s60, s60, s62
    s_cmp_eq_u32 s49, 0
    s_cselect_b32 s63, 2, 0
L_raw:
    s_cmp_ge_u32 s60, 36
    s_cselect_b32 s65, 36, 0
    s_cselect_b32 s97, 768, 0
    s_sub_u32 s65, s60, s65
    s_mul_i32 s66, s65, 43
    s_lshr_b32 s66, s66, 8
    s_mul_i32 s67, s66, 6
    s_sub_u32 s67, s65, s67
    s_max_u32 s64, s49, 1
    s_mul_i32 s64, s64, 12288
    s_mul_i32 s61, s66, 36864
    s_add_u32 s61, s61, 384
    s_mul_i32 s62, s67, 36864
    s_add_u32 s62, s62, s97
    s_bitcmp1_b32 s63, 1
    s_cselect_b32 s61, s62, s61
    s_cselect_b32 s64, 0, s64
    s_cselect_b32 s97, 0, s97
    s_movk_i32 s62, 128
    s_movk_i32 s65, 9216
    s_mov_b32 s96, 32
    v_lshrrev_b32 v16, 3, v0
    v_and_b32 v17, 7, v0
    v_bfe_u32 v18, v0, 4, 1
    v_xor_b32 v17, v17, v18
    v_lshlrev_b32 v17, 4, v17
    v_mul_u32_u24 v16, 1152, v16
    s_cmp_eq_u32 s97, 0
    s_mov_b32 s18, 221184
    s_cbranch_scc1 L_raw_rows
    s_mov_b32 s18, 73728
    s_lshl_b32 s61, s66, 6
    s_movk_i32 s62, 6144
    s_movk_i32 s65, 18432
    s_mov_b32 s96, 0
    v_lshrrev_b32 v16, 2, v0
    v_mul_u32_u24 v16, 384, v16
    v_and_b32 v17, 3, v0
    v_lshlrev_b32 v17, 4, v17
L_raw_rows:
    s_waitcnt lgkmcnt(0)
    s_cmp_eq_u32 s97, 0
    s_cselect_b32 s16, s6, s20
    s_cselect_b32 s17, s7, s21
    s_mov_b32 s19, 0x00020000
    s_mov_b32 m0, s64
    s_mov_b32 s97, 4
L_raw_lp:
    v_add_u32 v18, v16, v17
    s_add_u32 s42, s61, s62
    buffer_load_dwordx4 v18, s[16:19], s61 offen lds
    s_add_u32 m0, m0, 1024
    s_add_u32 s41, s42, s62
    buffer_load_dwordx4 v18, s[16:19], s42 offen lds
    s_add_u32 m0, m0, 1024
    s_add_u32 s61, s61, s65
    buffer_load_dwordx4 v18, s[16:19], s41 offen lds
    s_add_u32 m0, m0, 1024
    s_and_b32 s42, s97, 1
    s_mul_i32 s42, s42, s96
    s_lshl_b32 s42, s42, 1
    s_add_u32 s42, s42, s96
    v_xor_b32 v17, s42, v17
    s_sub_u32 s97, s97, 1
    s_cmp_lg_u32 s97, 0
    s_cbranch_scc1 L_raw_lp
    s_bitcmp1_b32 s63, 0
    s_cbranch_scc1 L_fb_raw
L_setup:
    s_mov_b32 s43, 0x400000
    v_lshlrev_b32 v1, 4, v0
    v_add_u32 v2, 0x10000, v1
    v_add_u32 v3, 0x20000, v1
    v_lshrrev_b32 v16, 3, v0
    v_and_b32 v17, 7, v0
    v_lshrrev_b32 v18, 4, v0
    v_xor_b32 v17, v17, v18
    v_lshlrev_b32 v17, 4, v17
    v_mul_u32_u24 v16, 384, v16
    v_add_u32 v9, v16, v17
    v_xor_b32 v10, 64, v9
    v_add_u32 v10, 196608, v10
    s_lshl_b32 s52, s49, 11
    s_add_u32 s52, s52, 147456
    v_lshlrev_b32 v16, 3, v0
    v_add_u32 v4, s52, v16
    v_and_b32 v16, 15, v0
    v_lshrrev_b32 v17, 4, v0
    v_lshrrev_b32 v18, 1, v16
    v_xor_b32 v18, v18, v17
    v_lshlrev_b32 v18, 3, v18
    v_lshl_add_u32 v18, v16, 6, v18
    v_add_u32 v5, s52, v18
    v_xor_b32 v6, 32, v5
    v_lshrrev_b32 v16, 5, v0
    v_mul_u32_u24 v16, 196608, v16
    v_lshrrev_b32 v17, 4, v0
    v_and_b32 v17, 1, v17
    v_mul_u32_u24 v17, 1536, v17
    v_and_b32 v18, 15, v0
    v_lshlrev_b32 v18, 3, v18
    v_add3_u32 v11, v16, v17, v18
    s_nop 0
    s_and_b32 s53, s2, 7
    s_lshl_b32 s53, s53, 3
    s_lshr_b32 s54, s2, 7
    s_add_u32 s53, s53, s54
    s_lshr_b32 s54, s2, 3
    s_and_b32 s54, s54, 15
    s_mul_i32 s53, s53, 1572864
    s_lshl_b32 s54, s54, 2
    s_add_u32 s54, s54, s49
    s_mul_i32 s54, s54, 3072
    s_add_u32 s53, s53, s54
    s_add_u32 s24, s53, 0
    s_add_u32 s26, s53, 393216
    s_add_u32 s28, s53, 786432
    s_add_u32 s30, s53, 1179648
    v_mov_b32 v29, 155648
    v_mov_b32 v30, 0
    v_mov_b32 v31, 0
    ds_write_b64 v29, v[30:31]
    s_getreg_b32 s48, hwreg(HW_REG_XCC_ID, 0, 3)
    s_waitcnt lgkmcnt(0)
    s_mov_b32 s8, s4
    s_mov_b32 s9, s5
    s_mov_b32 s10, 100663296
    s_mov_b32 s11, 0x00020000
    s_barrier
    s_cmp_eq_u32 s49, 0
    s_cbranch_scc0 L_nox0
    buffer_load_dwordx4 a[0:3], v9, s[8:11], s24 offen offset:0 nt
    buffer_load_dwordx4 a[4:7], v10, s[8:11], s24 offen offset:0 nt
    buffer_load_dwordx4 a[8:11], v9, s[8:11], s24 offen offset:128 nt
    buffer_load_dwordx4 a[12:15], v10, s[8:11], s24 offen offset:128 nt
    buffer_load_dwordx4 a[16:19], v9, s[8:11], s24 offen offset:256 nt
    buffer_load_dwordx4 a[20:23], v10, s[8:11], s24 offen offset:256 nt
    buffer_load_dwordx4 a[24:27], v9, s[8:11], s26 offen offset:0 nt
    buffer_load_dwordx4 a[28:31], v10, s[8:11], s26 offen offset:0 nt
    buffer_load_dwordx4 a[32:35], v9, s[8:11], s26 offen offset:128 nt
    buffer_load_dwordx4 a[36:39], v10, s[8:11], s26 offen offset:128 nt
    buffer_load_dwordx4 a[40:43], v9, s[8:11], s26 offen offset:256 nt
    buffer_load_dwordx4 a[44:47], v10, s[8:11], s26 offen offset:256 nt
    buffer_load_dwordx4 a[48:51], v9, s[8:11], s28 offen offset:0 nt
    buffer_load_dwordx4 a[52:55], v10, s[8:11], s28 offen offset:0 nt
    buffer_load_dwordx4 a[56:59], v9, s[8:11], s28 offen offset:128 nt
    buffer_load_dwordx4 a[60:63], v10, s[8:11], s28 offen offset:128 nt
    buffer_load_dwordx4 a[64:67], v9, s[8:11], s28 offen offset:256 nt
    buffer_load_dwordx4 a[68:71], v10, s[8:11], s28 offen offset:256 nt
    buffer_load_dwordx4 a[72:75], v9, s[8:11], s30 offen offset:0 nt
    buffer_load_dwordx4 a[76:79], v10, s[8:11], s30 offen offset:0 nt
    buffer_load_dwordx4 a[80:83], v9, s[8:11], s30 offen offset:128 nt
    buffer_load_dwordx4 a[84:87], v10, s[8:11], s30 offen offset:128 nt
    buffer_load_dwordx4 a[88:91], v9, s[8:11], s30 offen offset:256 nt
    buffer_load_dwordx4 a[92:95], v10, s[8:11], s30 offen offset:256 nt
L_nox0:
    s_mov_b32 s3, s53
    s_mov_b32 s12, s22
    s_mov_b32 s13, s23
    s_mov_b32 s14, 100663296
    s_mov_b32 s15, 0x00020000
    s_mov_b32 s40, 0x3dd53b95
    s_mov_b32 s50, s58
    s_mov_b32 s51, s59
    s_mov_b32 s58, 256
    s_mov_b32 s59, 0x00020000
    s_mul_i32 s52, s48, 147456
    s_add_u32 s52, s50, s52
    s_addc_u32 s53, s51, 0
    s_mov_b32 s54, 147456
    s_mov_b32 s55, 0x00020000
    s_lshl_b32 s48, s48, 5
    s_lshl_b32 s42, 4096, s49
    v_mov_b32 v31, s42
    s_cmp_eq_u32 s49, 0
    s_cbranch_scc1 L_w0
    s_cmp_lt_u32 s2, 192
    s_cbranch_scc0 L_noprod
L_prod:
    s_mul_i32 s61, s66, 12
    s_add_u32 s61, s61, s67
    s_lshl_b32 s61, s61, 10
    s_add_u32 s62, s61, 6144
    v_mov_b32 v27, v1
    v_bfe_u32 v22, v0, 2, 2
    v_and_b32 v23, 3, v0
    v_lshrrev_b32 v26, 4, v0
    s_cmp_ge_u32 s60, 36
    s_cbranch_scc0 L_prod_A
    v_mul_u32_u24 v27, 6144, v23
    v_lshlrev_b32 v24, 8, v26
    v_lshlrev_b32 v25, 4, v22
    v_add3_u32 v27, v27, v24, v25
    s_lshr_b32 s61, s66, 1
    s_mul_i32 s61, s61, 24576
    s_and_b32 s62, s66, 1
    s_lshl_b32 s62, s62, 7
    s_add_u32 s61, s61, s62
    s_lshl_b32 s62, s67, 10
    s_add_u32 s61, s61, s62
    s_add_u32 s61, s61, 73728
    s_add_u32 s62, s61, 64
L_prod_A:
    v_mul_u32_u24 v24, 3072, v22
    v_lshl_add_u32 v24, v23, 7, v24
    v_bfe_u32 v25, v0, 1, 1
    v_lshl_add_u32 v25, v22, 1, v25
    v_xor_b32 v25, v25, v26
    v_lshl_add_u32 v24, v25, 4, v24
    v_xor_b32 v25, 64, v24
    v_lshl_add_u32 v26, v26, 3, v22
    v_lshlrev_b32 v26, 6, v26
    v_lshl_add_u32 v26, v23, 3, v26
    v_add_u32 v26, s64, v26
    s_waitcnt vmcnt(0)
    s_bitcmp1_b32 s63, 0
    s_cbranch_scc1 L_gotA
L_wA:
    s_sub_u32 s43, s43, 1
    s_cbranch_scc1 L_end
    ds_read_b32 v30, v29
    s_waitcnt lgkmcnt(0)
    v_readfirstlane_b32 s41, v30
    s_nop 1
    s_and_b32 s42, s41, 0x100000
    s_cmp_eq_u32 s42, 0x100000
    s_cbranch_scc0 L_wA
L_gotA:
    ds_read_b128 v[32:35], v24 offset:0
    ds_read_b128 v[56:59], v24 offset:512
    ds_read_b128 v[36:39], v25 offset:0
    ds_read_b128 v[60:63], v25 offset:512
    ds_read_b128 v[40:43], v24 offset:1024
    ds_read_b128 v[64:67], v24 offset:1536
    ds_read_b128 v[44:47], v25 offset:1024
    ds_read_b128 v[68:71], v25 offset:1536
    ds_read_b128 v[48:51], v24 offset:2048
    ds_read_b128 v[72:75], v24 offset:2560
    ds_read_b128 v[52:55], v25 offset:2048
    ds_read_b128 v[76:79], v25 offset:2560
    s_cmp_ge_u32 s60, 36
    s_cbranch_scc1 L_prod_N2
    v_add_u32 v24, s64, v24
    v_add_u32 v25, s64, v25
    ds_read_b128 v[80:83], v24 offset:0
    ds_read_b128 v[104:107], v24 offset:512
    ds_read_b128 v[84:87], v25 offset:0
    ds_read_b128 v[108:111], v25 offset:512
    ds_read_b128 v[88:91], v24 offset:1024
    ds_read_b128 v[112:115], v24 offset:1536
    ds_read_b128 v[92:95], v25 offset:1024
    ds_read_b128 v[116:119], v25 offset:1536
    ds_read_b128 v[96:99], v24 offset:2048
    ds_read_b128 v[120:123], v24 offset:2560
    ds_read_b128 v[100:103], v25 offset:2048
    ds_read_b128 v[124:127], v25 offset:2560
    s_branch L_prod_mm
L_prod_N2:
    ds_read_b64_tr_b16 v[80:81], v26 offset:0
    ds_read_b64_tr_b16 v[82:83], v26 offset:256
    ds_read_b64_tr_b16 v[104:105], v26 offset:32
    ds_read_b64_tr_b16 v[106:107], v26 offset:288
    ds_read_b64_tr_b16 v[84:85], v26 offset:2048
    ds_read_b64_tr_b16 v[86:87], v26 offset:2304
    ds_read_b64_tr_b16 v[108:109], v26 offset:2080
    ds_read_b64_tr_b16 v[110:111], v26 offset:2336
    ds_read_b64_tr_b16 v[88:89], v26 offset:4096
    ds_read_b64_tr_b16 v[90:91], v26 offset:4352
    ds_read_b64_tr_b16 v[112:113], v26 offset:4128
    ds_read_b64_tr_b16 v[114:115], v26 offset:4384
    ds_read_b64_tr_b16 v[92:93], v26 offset:6144
    ds_read_b64_tr_b16 v[94:95], v26 offset:6400
    ds_read_b64_tr_b16 v[116:117], v26 offset:6176
    ds_read_b64_tr_b16 v[118:119], v26 offset:6432
    ds_read_b64_tr_b16 v[96:97], v26 offset:8192
    ds_read_b64_tr_b16 v[98:99], v26 offset:8448
    ds_read_b64_tr_b16 v[120:121], v26 offset:8224
    ds_read_b64_tr_b16 v[122:123], v26 offset:8480
    ds_read_b64_tr_b16 v[100:101], v26 offset:10240
    ds_read_b64_tr_b16 v[102:103], v26 offset:10496
    ds_read_b64_tr_b16 v[124:125], v26 offset:10272
    ds_read_b64_tr_b16 v[126:127], v26 offset:10528
L_prod_mm:
    s_cmp_ge_u32 s60, 36
    s_cselect_b32 s65, 1.0, s40
    s_waitcnt lgkmcnt(0)
    v_mfma_f32_16x16x32_bf16 v[128:131], v[32:35], v[80:83], 0
    v_mfma_f32_16x16x32_bf16 v[132:135], v[56:59], v[80:83], 0
    v_mfma_f32_16x16x32_bf16 v[128:131], v[36:39], v[84:87], v[128:131]
    v_mfma_f32_16x16x32_bf16 v[132:135], v[60:63], v[84:87], v[132:135]
    v_mfma_f32_16x16x32_bf16 v[128:131], v[40:43], v[88:91], v[128:131]
    v_mfma_f32_16x16x32_bf16 v[132:135], v[64:67], v[88:91], v[132:135]
    v_mfma_f32_16x16x32_bf16 v[128:131], v[44:47], v[92:95], v[128:131]
    v_mfma_f32_16x16x32_bf16 v[132:135], v[68:71], v[92:95], v[132:135]
    v_mfma_f32_16x16x32_bf16 v[128:131], v[48:51], v[96:99], v[128:131]
    v_mfma_f32_16x16x32_bf16 v[132:135], v[72:75], v[96:99], v[132:135]
    v_mfma_f32_16x16x32_bf16 v[128:131], v[52:55], v[100:103], v[128:131]
    v_mfma_f32_16x16x32_bf16 v[132:135], v[76:79], v[100:103], v[132:135]
    v_mfma_f32_16x16x32_bf16 v[136:139], v[32:35], v[104:107], 0
    v_mfma_f32_16x16x32_bf16 v[140:143], v[56:59], v[104:107], 0
    v_mfma_f32_16x16x32_bf16 v[136:139], v[36:39], v[108:111], v[136:139]
    v_mfma_f32_16x16x32_bf16 v[140:143], v[60:63], v[108:111], v[140:143]
    v_mfma_f32_16x16x32_bf16 v[136:139], v[40:43], v[112:115], v[136:139]
    v_mfma_f32_16x16x32_bf16 v[140:143], v[64:67], v[112:115], v[140:143]
    v_mfma_f32_16x16x32_bf16 v[136:139], v[44:47], v[116:119], v[136:139]
    v_mfma_f32_16x16x32_bf16 v[140:143], v[68:71], v[116:119], v[140:143]
    v_mfma_f32_16x16x32_bf16 v[136:139], v[48:51], v[120:123], v[136:139]
    v_mfma_f32_16x16x32_bf16 v[140:143], v[72:75], v[120:123], v[140:143]
    v_mfma_f32_16x16x32_bf16 v[136:139], v[52:55], v[124:127], v[136:139]
    v_mfma_f32_16x16x32_bf16 v[140:143], v[76:79], v[124:127], v[140:143]
    v_mul_f32 v128, s65, v128
    v_mul_f32 v129, s65, v129
    v_mul_f32 v130, s65, v130
    v_mul_f32 v131, s65, v131
    v_mul_f32 v132, s65, v132
    v_mul_f32 v133, s65, v133
    v_mul_f32 v134, s65, v134
    v_mul_f32 v135, s65, v135
    v_cvt_pk_bf16_f32 v144, v128, v129
    v_cvt_pk_bf16_f32 v145, v130, v131
    v_cvt_pk_bf16_f32 v146, v132, v133
    v_cvt_pk_bf16_f32 v147, v134, v135
    buffer_store_dwordx4 v[144:147], v27, s[52:55], s61 offen
    s_nop 7
    v_mul_f32 v136, s65, v136
    v_mul_f32 v137, s65, v137
    v_mul_f32 v138, s65, v138
    v_mul_f32 v139, s65, v139
    v_mul_f32 v140, s65, v140
    v_mul_f32 v141, s65, v141
    v_mul_f32 v142, s65, v142
    v_mul_f32 v143, s65, v143
    v_cvt_pk_bf16_f32 v148, v136, v137
    v_cvt_pk_bf16_f32 v149, v138, v139
    v_cvt_pk_bf16_f32 v150, v140, v141
    v_cvt_pk_bf16_f32 v151, v142, v143
    buffer_store_dwordx4 v[148:151], v27, s[52:55], s62 offen
    s_bitcmp1_b32 s63, 0
    s_cbranch_scc1 L_fb_next
    s_cmp_eq_u32 s49, 1
    s_cbranch_scc0 L_p23
    buffer_load_dwordx4 a[0:3], v9, s[8:11], s24 offen offset:0 nt
    buffer_load_dwordx4 a[4:7], v10, s[8:11], s24 offen offset:0 nt
    buffer_load_dwordx4 a[8:11], v9, s[8:11], s24 offen offset:128 nt
    buffer_load_dwordx4 a[12:15], v10, s[8:11], s24 offen offset:128 nt
    buffer_load_dwordx4 a[16:19], v9, s[8:11], s24 offen offset:256 nt
    buffer_load_dwordx4 a[20:23], v10, s[8:11], s24 offen offset:256 nt
    buffer_load_dwordx4 a[24:27], v9, s[8:11], s26 offen offset:0 nt
    buffer_load_dwordx4 a[28:31], v10, s[8:11], s26 offen offset:0 nt
    buffer_load_dwordx4 a[32:35], v9, s[8:11], s26 offen offset:128 nt
    buffer_load_dwordx4 a[36:39], v10, s[8:11], s26 offen offset:128 nt
    buffer_load_dwordx4 a[40:43], v9, s[8:11], s26 offen offset:256 nt
    buffer_load_dwordx4 a[44:47], v10, s[8:11], s26 offen offset:256 nt
    buffer_load_dwordx4 a[48:51], v9, s[8:11], s28 offen offset:0 nt
    buffer_load_dwordx4 a[52:55], v10, s[8:11], s28 offen offset:0 nt
    buffer_load_dwordx4 a[56:59], v9, s[8:11], s28 offen offset:128 nt
    buffer_load_dwordx4 a[60:63], v10, s[8:11], s28 offen offset:128 nt
    buffer_load_dwordx4 a[64:67], v9, s[8:11], s28 offen offset:256 nt
    buffer_load_dwordx4 a[68:71], v10, s[8:11], s28 offen offset:256 nt
    buffer_load_dwordx4 a[72:75], v9, s[8:11], s30 offen offset:0 nt
    buffer_load_dwordx4 a[76:79], v10, s[8:11], s30 offen offset:0 nt
    buffer_load_dwordx4 a[80:83], v9, s[8:11], s30 offen offset:128 nt
    buffer_load_dwordx4 a[84:87], v10, s[8:11], s30 offen offset:128 nt
    buffer_load_dwordx4 a[88:91], v9, s[8:11], s30 offen offset:256 nt
    buffer_load_dwordx4 a[92:95], v10, s[8:11], s30 offen offset:256 nt
    s_waitcnt vmcnt(24)
    v_mov_b32 v32, 1
    s_lshr_b32 s60, s2, 3
    s_add_u32 s60, s60, s48
    v_mov_b32 v33, s60
    s_mov_b64 exec, 1
    ds_add_rtn_u32 v34, v29, v32 offset:4
    s_waitcnt lgkmcnt(0)
    v_readfirstlane_b32 s61, v34
    s_nop 1
    s_cmp_eq_u32 s61, 2
    s_cbranch_scc0 L_nl1
    buffer_store_byte v32, v33, s[56:59], 0 offen
    v_mov_b32 v32, 0x400000
    ds_or_b32 v29, v32
L_nl1:
    s_mov_b64 exec, -1
    s_waitcnt vmcnt(22)
    ds_write_b64 v4, a[0:1] offset:0
    ds_write_b64 v4, a[2:3] offset:1024
    ds_write_b64 v4, a[4:5] offset:512
    ds_write_b64 v4, a[6:7] offset:1536
    ds_read2_b64 a[0:3], v5 offset0:0 offset1:128
    ds_read2_b64 a[4:7], v6 offset0:0 offset1:128
    s_waitcnt vmcnt(20)
    ds_or_b32 v29, v31
    ds_write_b64 v4, a[8:9] offset:0
    ds_write_b64 v4, a[10:11] offset:1024
    ds_write_b64 v4, a[12:13] offset:512
    ds_write_b64 v4, a[14:15] offset:1536
    ds_read2_b64 a[8:11], v5 offset0:0 offset1:128
    ds_read2_b64 a[12:15], v6 offset0:0 offset1:128
    s_waitcnt vmcnt(18)
    ds_write_b64 v4, a[16:17] offset:0
    ds_write_b64 v4, a[18:19] offset:1024
    ds_write_b64 v4, a[20:21] offset:512
    ds_write_b64 v4, a[22:23] offset:1536
    ds_read2_b64 a[16:19], v5 offset0:0 offset1:128
    ds_read2_b64 a[20:23], v6 offset0:0 offset1:128
    s_waitcnt vmcnt(16)
    ds_write_b64 v4, a[24:25] offset:0
    ds_write_b64 v4, a[26:27] offset:1024
    ds_write_b64 v4, a[28:29] offset:512
    ds_write_b64 v4, a[30:31] offset:1536
    ds_read2_b64 a[24:27], v5 offset0:0 offset1:128
    ds_read2_b64 a[28:31], v6 offset0:0 offset1:128
    s_waitcnt vmcnt(14)
    ds_write_b64 v4, a[32:33] offset:0
    ds_write_b64 v4, a[34:35] offset:1024
    ds_write_b64 v4, a[36:37] offset:512
    ds_write_b64 v4, a[38:39] offset:1536
    ds_read2_b64 a[32:35], v5 offset0:0 offset1:128
    ds_read2_b64 a[36:39], v6 offset0:0 offset1:128
    s_waitcnt vmcnt(12)
    ds_write_b64 v4, a[40:41] offset:0
    ds_write_b64 v4, a[42:43] offset:1024
    ds_write_b64 v4, a[44:45] offset:512
    ds_write_b64 v4, a[46:47] offset:1536
    ds_read2_b64 a[40:43], v5 offset0:0 offset1:128
    ds_read2_b64 a[44:47], v6 offset0:0 offset1:128
    s_waitcnt vmcnt(10)
    ds_write_b64 v4, a[48:49] offset:0
    ds_write_b64 v4, a[50:51] offset:1024
    ds_write_b64 v4, a[52:53] offset:512
    ds_write_b64 v4, a[54:55] offset:1536
    ds_read2_b64 a[48:51], v5 offset0:0 offset1:128
    ds_read2_b64 a[52:55], v6 offset0:0 offset1:128
    s_waitcnt vmcnt(8)
    ds_write_b64 v4, a[56:57] offset:0
    ds_write_b64 v4, a[58:59] offset:1024
    ds_write_b64 v4, a[60:61] offset:512
    ds_write_b64 v4, a[62:63] offset:1536
    ds_read2_b64 a[56:59], v5 offset0:0 offset1:128
    ds_read2_b64 a[60:63], v6 offset0:0 offset1:128
    s_waitcnt vmcnt(6)
    ds_write_b64 v4, a[64:65] offset:0
    ds_write_b64 v4, a[66:67] offset:1024
    ds_write_b64 v4, a[68:69] offset:512
    ds_write_b64 v4, a[70:71] offset:1536
    ds_read2_b64 a[64:67], v5 offset0:0 offset1:128
    ds_read2_b64 a[68:71], v6 offset0:0 offset1:128
    s_waitcnt vmcnt(4)
    ds_write_b64 v4, a[72:73] offset:0
    ds_write_b64 v4, a[74:75] offset:1024
    ds_write_b64 v4, a[76:77] offset:512
    ds_write_b64 v4, a[78:79] offset:1536
    ds_read2_b64 a[72:75], v5 offset0:0 offset1:128
    ds_read2_b64 a[76:79], v6 offset0:0 offset1:128
    s_waitcnt vmcnt(2)
    ds_write_b64 v4, a[80:81] offset:0
    ds_write_b64 v4, a[82:83] offset:1024
    ds_write_b64 v4, a[84:85] offset:512
    ds_write_b64 v4, a[86:87] offset:1536
    ds_read2_b64 a[80:83], v5 offset0:0 offset1:128
    ds_read2_b64 a[84:87], v6 offset0:0 offset1:128
    s_waitcnt vmcnt(0)
    ds_write_b64 v4, a[88:89] offset:0
    ds_write_b64 v4, a[90:91] offset:1024
    ds_write_b64 v4, a[92:93] offset:512
    ds_write_b64 v4, a[94:95] offset:1536
    ds_read2_b64 a[88:91], v5 offset0:0 offset1:128
    ds_read2_b64 a[92:95], v6 offset0:0 offset1:128
    s_branch L_w1go
L_p23:
    s_waitcnt vmcnt(0)
    v_mov_b32 v32, 1
    s_lshr_b32 s60, s2, 3
    s_add_u32 s60, s60, s48
    v_mov_b32 v33, s60
    s_mov_b64 exec, 1
    ds_add_rtn_u32 v34, v29, v32 offset:4
    s_waitcnt lgkmcnt(0)
    v_readfirstlane_b32 s61, v34
    s_nop 1
    s_cmp_eq_u32 s61, 2
    s_cbranch_scc0 L_nl2
    buffer_store_byte v32, v33, s[56:59], 0 offen
    v_mov_b32 v32, 0x400000
    ds_or_b32 v29, v32
L_nl2:
    s_mov_b64 exec, -1
L_noprod:
    s_lshl_b32 s60, 2048, s49
    s_cmp_lt_u32 s2, 192
    s_cselect_b32 s61, 0x400000, 0
    s_or_b32 s60, s60, s61
L_wpace:
    s_sub_u32 s43, s43, 1
    s_cbranch_scc1 L_end
    ds_read_b32 v30, v29
    s_waitcnt lgkmcnt(0)
    v_readfirstlane_b32 s41, v30
    s_nop 1
    s_and_b32 s42, s41, s60
    s_cmp_eq_u32 s42, s60
    s_cbranch_scc0 L_wpace
    buffer_load_dwordx4 a[0:3], v9, s[8:11], s24 offen offset:0 nt
    buffer_load_dwordx4 a[4:7], v10, s[8:11], s24 offen offset:0 nt
    buffer_load_dwordx4 a[8:11], v9, s[8:11], s24 offen offset:128 nt
    buffer_load_dwordx4 a[12:15], v10, s[8:11], s24 offen offset:128 nt
    buffer_load_dwordx4 a[16:19], v9, s[8:11], s24 offen offset:256 nt
    buffer_load_dwordx4 a[20:23], v10, s[8:11], s24 offen offset:256 nt
    buffer_load_dwordx4 a[24:27], v9, s[8:11], s26 offen offset:0 nt
    buffer_load_dwordx4 a[28:31], v10, s[8:11], s26 offen offset:0 nt
    buffer_load_dwordx4 a[32:35], v9, s[8:11], s26 offen offset:128 nt
    buffer_load_dwordx4 a[36:39], v10, s[8:11], s26 offen offset:128 nt
    buffer_load_dwordx4 a[40:43], v9, s[8:11], s26 offen offset:256 nt
    buffer_load_dwordx4 a[44:47], v10, s[8:11], s26 offen offset:256 nt
    buffer_load_dwordx4 a[48:51], v9, s[8:11], s28 offen offset:0 nt
    buffer_load_dwordx4 a[52:55], v10, s[8:11], s28 offen offset:0 nt
    buffer_load_dwordx4 a[56:59], v9, s[8:11], s28 offen offset:128 nt
    buffer_load_dwordx4 a[60:63], v10, s[8:11], s28 offen offset:128 nt
    buffer_load_dwordx4 a[64:67], v9, s[8:11], s28 offen offset:256 nt
    buffer_load_dwordx4 a[68:71], v10, s[8:11], s28 offen offset:256 nt
    buffer_load_dwordx4 a[72:75], v9, s[8:11], s30 offen offset:0 nt
    buffer_load_dwordx4 a[76:79], v10, s[8:11], s30 offen offset:0 nt
    buffer_load_dwordx4 a[80:83], v9, s[8:11], s30 offen offset:128 nt
    buffer_load_dwordx4 a[84:87], v10, s[8:11], s30 offen offset:128 nt
    buffer_load_dwordx4 a[88:91], v9, s[8:11], s30 offen offset:256 nt
    buffer_load_dwordx4 a[92:95], v10, s[8:11], s30 offen offset:256 nt
    s_waitcnt vmcnt(22)
    ds_write_b64 v4, a[0:1] offset:0
    ds_write_b64 v4, a[2:3] offset:1024
    ds_write_b64 v4, a[4:5] offset:512
    ds_write_b64 v4, a[6:7] offset:1536
    ds_read2_b64 a[0:3], v5 offset0:0 offset1:128
    ds_read2_b64 a[4:7], v6 offset0:0 offset1:128
    s_waitcnt vmcnt(20)
    ds_or_b32 v29, v31
    ds_write_b64 v4, a[8:9] offset:0
    ds_write_b64 v4, a[10:11] offset:1024
    ds_write_b64 v4, a[12:13] offset:512
    ds_write_b64 v4, a[14:15] offset:1536
    ds_read2_b64 a[8:11], v5 offset0:0 offset1:128
    ds_read2_b64 a[12:15], v6 offset0:0 offset1:128
    s_waitcnt vmcnt(18)
    ds_write_b64 v4, a[16:17] offset:0
    ds_write_b64 v4, a[18:19] offset:1024
    ds_write_b64 v4, a[20:21] offset:512
    ds_write_b64 v4, a[22:23] offset:1536
    ds_read2_b64 a[16:19], v5 offset0:0 offset1:128
    ds_read2_b64 a[20:23], v6 offset0:0 offset1:128
    s_waitcnt vmcnt(16)
    ds_write_b64 v4, a[24:25] offset:0
    ds_write_b64 v4, a[26:27] offset:1024
    ds_write_b64 v4, a[28:29] offset:512
    ds_write_b64 v4, a[30:31] offset:1536
    ds_read2_b64 a[24:27], v5 offset0:0 offset1:128
    ds_read2_b64 a[28:31], v6 offset0:0 offset1:128
    s_waitcnt vmcnt(14)
    ds_write_b64 v4, a[32:33] offset:0
    ds_write_b64 v4, a[34:35] offset:1024
    ds_write_b64 v4, a[36:37] offset:512
    ds_write_b64 v4, a[38:39] offset:1536
    ds_read2_b64 a[32:35], v5 offset0:0 offset1:128
    ds_read2_b64 a[36:39], v6 offset0:0 offset1:128
    s_waitcnt vmcnt(12)
    ds_write_b64 v4, a[40:41] offset:0
    ds_write_b64 v4, a[42:43] offset:1024
    ds_write_b64 v4, a[44:45] offset:512
    ds_write_b64 v4, a[46:47] offset:1536
    ds_read2_b64 a[40:43], v5 offset0:0 offset1:128
    ds_read2_b64 a[44:47], v6 offset0:0 offset1:128
    s_waitcnt vmcnt(10)
    ds_write_b64 v4, a[48:49] offset:0
    ds_write_b64 v4, a[50:51] offset:1024
    ds_write_b64 v4, a[52:53] offset:512
    ds_write_b64 v4, a[54:55] offset:1536
    ds_read2_b64 a[48:51], v5 offset0:0 offset1:128
    ds_read2_b64 a[52:55], v6 offset0:0 offset1:128
    s_waitcnt vmcnt(8)
    ds_write_b64 v4, a[56:57] offset:0
    ds_write_b64 v4, a[58:59] offset:1024
    ds_write_b64 v4, a[60:61] offset:512
    ds_write_b64 v4, a[62:63] offset:1536
    ds_read2_b64 a[56:59], v5 offset0:0 offset1:128
    ds_read2_b64 a[60:63], v6 offset0:0 offset1:128
    s_waitcnt vmcnt(6)
    ds_write_b64 v4, a[64:65] offset:0
    ds_write_b64 v4, a[66:67] offset:1024
    ds_write_b64 v4, a[68:69] offset:512
    ds_write_b64 v4, a[70:71] offset:1536
    ds_read2_b64 a[64:67], v5 offset0:0 offset1:128
    ds_read2_b64 a[68:71], v6 offset0:0 offset1:128
    s_waitcnt vmcnt(4)
    ds_write_b64 v4, a[72:73] offset:0
    ds_write_b64 v4, a[74:75] offset:1024
    ds_write_b64 v4, a[76:77] offset:512
    ds_write_b64 v4, a[78:79] offset:1536
    ds_read2_b64 a[72:75], v5 offset0:0 offset1:128
    ds_read2_b64 a[76:79], v6 offset0:0 offset1:128
    s_waitcnt vmcnt(2)
    ds_write_b64 v4, a[80:81] offset:0
    ds_write_b64 v4, a[82:83] offset:1024
    ds_write_b64 v4, a[84:85] offset:512
    ds_write_b64 v4, a[86:87] offset:1536
    ds_read2_b64 a[80:83], v5 offset0:0 offset1:128
    ds_read2_b64 a[84:87], v6 offset0:0 offset1:128
    s_waitcnt vmcnt(0)
    ds_write_b64 v4, a[88:89] offset:0
    ds_write_b64 v4, a[90:91] offset:1024
    ds_write_b64 v4, a[92:93] offset:512
    ds_write_b64 v4, a[94:95] offset:1536
    ds_read2_b64 a[88:91], v5 offset0:0 offset1:128
    ds_read2_b64 a[92:95], v6 offset0:0 offset1:128
L_w1go:
    s_cmp_eq_u32 s49, 1
    s_cbranch_scc0 L_enter
L_wgo:
    s_sub_u32 s43, s43, 1
    s_cbranch_scc1 L_end
    ds_read_b32 v30, v29
    s_waitcnt lgkmcnt(0)
    v_readfirstlane_b32 s41, v30
    s_nop 1
    s_and_b32 s42, s41, 0x200000
    s_cmp_eq_u32 s42, 0x200000
    s_cbranch_scc0 L_wgo
    s_mov_b32 s60, 36864
    s_add_u32 s61, s60, 0
    s_mov_b32 m0, s61
    s_nop 0
    buffer_load_dwordx4 v1, s[52:55], s61 offen offset:0 lds
    buffer_load_dwordx4 v1, s[52:55], s61 offen offset:1024 lds
    buffer_load_dwordx4 v1, s[52:55], s61 offen offset:2048 lds
    buffer_load_dwordx4 v1, s[52:55], s61 offen offset:3072 lds
    s_add_u32 s61, s60, 4096
    s_mov_b32 m0, s61
    s_nop 0
    buffer_load_dwordx4 v1, s[52:55], s61 offen offset:0 lds
    buffer_load_dwordx4 v1, s[52:55], s61 offen offset:1024 lds
    buffer_load_dwordx4 v1, s[52:55], s61 offen offset:2048 lds
    buffer_load_dwordx4 v1, s[52:55], s61 offen offset:3072 lds
    s_add_u32 s61, s60, 8192
    s_mov_b32 m0, s61
    s_nop 0
    buffer_load_dwordx4 v1, s[52:55], s61 offen offset:0 lds
    buffer_load_dwordx4 v1, s[52:55], s61 offen offset:1024 lds
    buffer_load_dwordx4 v1, s[52:55], s61 offen offset:2048 lds
    buffer_load_dwordx4 v1, s[52:55], s61 offen offset:3072 lds
    s_add_u32 s61, s60, 12288
    s_mov_b32 m0, s61
    s_nop 0
    buffer_load_dwordx4 v1, s[52:55], s61 offen offset:0 lds
    buffer_load_dwordx4 v1, s[52:55], s61 offen offset:1024 lds
    buffer_load_dwordx4 v1, s[52:55], s61 offen offset:2048 lds
    buffer_load_dwordx4 v1, s[52:55], s61 offen offset:3072 lds
    s_add_u32 s61, s60, 16384
    s_mov_b32 m0, s61
    s_nop 0
    buffer_load_dwordx4 v1, s[52:55], s61 offen offset:0 lds
    buffer_load_dwordx4 v1, s[52:55], s61 offen offset:1024 lds
    buffer_load_dwordx4 v1, s[52:55], s61 offen offset:2048 lds
    buffer_load_dwordx4 v1, s[52:55], s61 offen offset:3072 lds
    s_add_u32 s61, s60, 20480
    s_mov_b32 m0, s61
    s_nop 0
    buffer_load_dwordx4 v1, s[52:55], s61 offen offset:0 lds
    buffer_load_dwordx4 v1, s[52:55], s61 offen offset:1024 lds
    buffer_load_dwordx4 v1, s[52:55], s61 offen offset:2048 lds
    buffer_load_dwordx4 v1, s[52:55], s61 offen offset:3072 lds
    s_add_u32 s61, s60, 24576
    s_mov_b32 m0, s61
    s_nop 0
    buffer_load_dwordx4 v1, s[52:55], s61 offen offset:0 lds
    buffer_load_dwordx4 v1, s[52:55], s61 offen offset:1024 lds
    buffer_load_dwordx4 v1, s[52:55], s61 offen offset:2048 lds
    buffer_load_dwordx4 v1, s[52:55], s61 offen offset:3072 lds
    s_add_u32 s61, s60, 28672
    s_mov_b32 m0, s61
    s_nop 0
    buffer_load_dwordx4 v1, s[52:55], s61 offen offset:0 lds
    buffer_load_dwordx4 v1, s[52:55], s61 offen offset:1024 lds
    buffer_load_dwordx4 v1, s[52:55], s61 offen offset:2048 lds
    buffer_load_dwordx4 v1, s[52:55], s61 offen offset:3072 lds
    s_add_u32 s61, s60, 32768
    s_mov_b32 m0, s61
    s_nop 0
    buffer_load_dwordx4 v1, s[52:55], s61 offen offset:0 lds
    buffer_load_dwordx4 v1, s[52:55], s61 offen offset:1024 lds
    buffer_load_dwordx4 v1, s[52:55], s61 offen offset:2048 lds
    buffer_load_dwordx4 v1, s[52:55], s61 offen offset:3072 lds
    v_mov_b32 v26, 8
    v_mov_b32 v27, 16
    v_mov_b32 v28, 32
    s_branch L_enter
L_w0:
    s_waitcnt vmcnt(24)
    v_mov_b32 v30, 1048576
    ds_or_b32 v29, v30
    s_waitcnt vmcnt(22)
    ds_write_b64 v4, a[0:1] offset:0
    ds_write_b64 v4, a[2:3] offset:1024
    ds_write_b64 v4, a[4:5] offset:512
    ds_write_b64 v4, a[6:7] offset:1536
    ds_read2_b64 a[0:3], v5 offset0:0 offset1:128
    ds_read2_b64 a[4:7], v6 offset0:0 offset1:128
    s_waitcnt vmcnt(20)
    ds_or_b32 v29, v31
    ds_write_b64 v4, a[8:9] offset:0
    ds_write_b64 v4, a[10:11] offset:1024
    ds_write_b64 v4, a[12:13] offset:512
    ds_write_b64 v4, a[14:15] offset:1536
    ds_read2_b64 a[8:11], v5 offset0:0 offset1:128
    ds_read2_b64 a[12:15], v6 offset0:0 offset1:128
    s_waitcnt vmcnt(18)
    ds_write_b64 v4, a[16:17] offset:0
    ds_write_b64 v4, a[18:19] offset:1024
    ds_write_b64 v4, a[20:21] offset:512
    ds_write_b64 v4, a[22:23] offset:1536
    ds_read2_b64 a[16:19], v5 offset0:0 offset1:128
    ds_read2_b64 a[20:23], v6 offset0:0 offset1:128
    s_waitcnt vmcnt(16)
    ds_write_b64 v4, a[24:25] offset:0
    ds_write_b64 v4, a[26:27] offset:1024
    ds_write_b64 v4, a[28:29] offset:512
    ds_write_b64 v4, a[30:31] offset:1536
    ds_read2_b64 a[24:27], v5 offset0:0 offset1:128
    ds_read2_b64 a[28:31], v6 offset0:0 offset1:128
    s_waitcnt vmcnt(14)
    ds_write_b64 v4, a[32:33] offset:0
    ds_write_b64 v4, a[34:35] offset:1024
    ds_write_b64 v4, a[36:37] offset:512
    ds_write_b64 v4, a[38:39] offset:1536
    ds_read2_b64 a[32:35], v5 offset0:0 offset1:128
    ds_read2_b64 a[36:39], v6 offset0:0 offset1:128
    s_waitcnt vmcnt(12)
    ds_write_b64 v4, a[40:41] offset:0
    ds_write_b64 v4, a[42:43] offset:1024
    ds_write_b64 v4, a[44:45] offset:512
    ds_write_b64 v4, a[46:47] offset:1536
    ds_read2_b64 a[40:43], v5 offset0:0 offset1:128
    ds_read2_b64 a[44:47], v6 offset0:0 offset1:128
    s_waitcnt vmcnt(10)
    ds_write_b64 v4, a[48:49] offset:0
    ds_write_b64 v4, a[50:51] offset:1024
    ds_write_b64 v4, a[52:53] offset:512
    ds_write_b64 v4, a[54:55] offset:1536
    ds_read2_b64 a[48:51], v5 offset0:0 offset1:128
    ds_read2_b64 a[52:55], v6 offset0:0 offset1:128
    s_waitcnt vmcnt(8)
    ds_write_b64 v4, a[56:57] offset:0
    ds_write_b64 v4, a[58:59] offset:1024
    ds_write_b64 v4, a[60:61] offset:512
    ds_write_b64 v4, a[62:63] offset:1536
    ds_read2_b64 a[56:59], v5 offset0:0 offset1:128
    ds_read2_b64 a[60:63], v6 offset0:0 offset1:128
    s_waitcnt vmcnt(6)
    ds_write_b64 v4, a[64:65] offset:0
    ds_write_b64 v4, a[66:67] offset:1024
    ds_write_b64 v4, a[68:69] offset:512
    ds_write_b64 v4, a[70:71] offset:1536
    ds_read2_b64 a[64:67], v5 offset0:0 offset1:128
    ds_read2_b64 a[68:71], v6 offset0:0 offset1:128
    s_waitcnt vmcnt(4)
    ds_write_b64 v4, a[72:73] offset:0
    ds_write_b64 v4, a[74:75] offset:1024
    ds_write_b64 v4, a[76:77] offset:512
    ds_write_b64 v4, a[78:79] offset:1536
    ds_read2_b64 a[72:75], v5 offset0:0 offset1:128
    ds_read2_b64 a[76:79], v6 offset0:0 offset1:128
    s_waitcnt vmcnt(2)
    ds_write_b64 v4, a[80:81] offset:0
    ds_write_b64 v4, a[82:83] offset:1024
    ds_write_b64 v4, a[84:85] offset:512
    ds_write_b64 v4, a[86:87] offset:1536
    ds_read2_b64 a[80:83], v5 offset0:0 offset1:128
    ds_read2_b64 a[84:87], v6 offset0:0 offset1:128
    s_waitcnt vmcnt(0)
    ds_write_b64 v4, a[88:89] offset:0
    ds_write_b64 v4, a[90:91] offset:1024
    ds_write_b64 v4, a[92:93] offset:512
    ds_write_b64 v4, a[94:95] offset:1536
    ds_read2_b64 a[88:91], v5 offset0:0 offset1:128
    ds_read2_b64 a[92:95], v6 offset0:0 offset1:128
L_poll0:
    s_mov_b32 s61, 0
    v_min_u32 v33, 5, v0
    v_lshlrev_b32 v33, 2, v33
    s_mov_b32 s62, 0x01010101
    v_mov_b32 v34, 0
L_poll:
    buffer_load_dword v34, v33, s[56:59], s48 offen nt
    s_add_u32 s61, s61, 1
    s_sleep 4
    v_cmp_ne_u32 vcc, s62, v34
    s_nop 4
    s_cbranch_vccz L_go
    s_cmp_lt_u32 s61, 400
    s_cbranch_scc1 L_poll
    s_waitcnt vmcnt(0)
    s_branch L_fb
L_go:
    s_mov_b32 s60, 0
    s_add_u32 s61, s60, 0
    s_mov_b32 m0, s61
    s_nop 0
    buffer_load_dwordx4 v1, s[52:55], s61 offen offset:0 lds
    buffer_load_dwordx4 v1, s[52:55], s61 offen offset:1024 lds
    buffer_load_dwordx4 v1, s[52:55], s61 offen offset:2048 lds
    buffer_load_dwordx4 v1, s[52:55], s61 offen offset:3072 lds
    s_add_u32 s61, s60, 4096
    s_mov_b32 m0, s61
    s_nop 0
    buffer_load_dwordx4 v1, s[52:55], s61 offen offset:0 lds
    buffer_load_dwordx4 v1, s[52:55], s61 offen offset:1024 lds
    buffer_load_dwordx4 v1, s[52:55], s61 offen offset:2048 lds
    buffer_load_dwordx4 v1, s[52:55], s61 offen offset:3072 lds
    s_add_u32 s61, s60, 8192
    s_mov_b32 m0, s61
    s_nop 0
    buffer_load_dwordx4 v1, s[52:55], s61 offen offset:0 lds
    buffer_load_dwordx4 v1, s[52:55], s61 offen offset:1024 lds
    buffer_load_dwordx4 v1, s[52:55], s61 offen offset:2048 lds
    buffer_load_dwordx4 v1, s[52:55], s61 offen offset:3072 lds
    v_mov_b32 v30, 2097152
    ds_or_b32 v29, v30
    s_add_u32 s61, s60, 12288
    s_mov_b32 m0, s61
    s_nop 0
    buffer_load_dwordx4 v1, s[52:55], s61 offen offset:0 lds
    buffer_load_dwordx4 v1, s[52:55], s61 offen offset:1024 lds
    buffer_load_dwordx4 v1, s[52:55], s61 offen offset:2048 lds
    buffer_load_dwordx4 v1, s[52:55], s61 offen offset:3072 lds
    s_add_u32 s61, s60, 16384
    s_mov_b32 m0, s61
    s_nop 0
    buffer_load_dwordx4 v1, s[52:55], s61 offen offset:0 lds
    buffer_load_dwordx4 v1, s[52:55], s61 offen offset:1024 lds
    buffer_load_dwordx4 v1, s[52:55], s61 offen offset:2048 lds
    buffer_load_dwordx4 v1, s[52:55], s61 offen offset:3072 lds
    s_add_u32 s61, s60, 20480
    s_mov_b32 m0, s61
    s_nop 0
    buffer_load_dwordx4 v1, s[52:55], s61 offen offset:0 lds
    buffer_load_dwordx4 v1, s[52:55], s61 offen offset:1024 lds
    buffer_load_dwordx4 v1, s[52:55], s61 offen offset:2048 lds
    buffer_load_dwordx4 v1, s[52:55], s61 offen offset:3072 lds
    s_add_u32 s61, s60, 24576
    s_mov_b32 m0, s61
    s_nop 0
    buffer_load_dwordx4 v1, s[52:55], s61 offen offset:0 lds
    buffer_load_dwordx4 v1, s[52:55], s61 offen offset:1024 lds
    buffer_load_dwordx4 v1, s[52:55], s61 offen offset:2048 lds
    buffer_load_dwordx4 v1, s[52:55], s61 offen offset:3072 lds
    s_add_u32 s61, s60, 28672
    s_mov_b32 m0, s61
    s_nop 0
    buffer_load_dwordx4 v1, s[52:55], s61 offen offset:0 lds
    buffer_load_dwordx4 v1, s[52:55], s61 offen offset:1024 lds
    buffer_load_dwordx4 v1, s[52:55], s61 offen offset:2048 lds
    buffer_load_dwordx4 v1, s[52:55], s61 offen offset:3072 lds
    s_add_u32 s61, s60, 32768
    s_mov_b32 m0, s61
    s_nop 0
    buffer_load_dwordx4 v1, s[52:55], s61 offen offset:0 lds
    buffer_load_dwordx4 v1, s[52:55], s61 offen offset:1024 lds
    buffer_load_dwordx4 v1, s[52:55], s61 offen offset:2048 lds
    buffer_load_dwordx4 v1, s[52:55], s61 offen offset:3072 lds
    v_mov_b32 v26, 2
    v_mov_b32 v27, 4
    s_waitcnt vmcnt(24)
    v_mov_b32 v30, 1
    ds_or_b32 v29, v30
L_enter:
    s_mul_i32 s60, s49, 18432
    s_add_u32 s60, s60, 73728
    v_add_u32 v24, s60, v1
    s_lshl_b32 s61, 64, s49
    v_mov_b32 v25, s61
    s_waitcnt lgkmcnt(0)
    s_sub_u32 s16, s3, 6291456
    s_mov_b32 s19, 100663296
    s_mov_b32 s18, 0
    s_mov_b32 s33, 100663296
    s_mov_b32 s35, 100663296
    s_mov_b32 s37, 100663296
    s_mov_b32 s39, 100663296
    ds_read_b32 v30, v29
    s_waitcnt lgkmcnt(0)
    v_readfirstlane_b32 s41, v30
    s_nop 1
    s_bitcmp1_b32 s41, 0
    s_cbranch_scc0 L_slow0
L_ok0:
    ds_read_b128 a[192:195], v1 offset:0
    ds_read_b128 a[196:199], v1 offset:1024
    ds_read_b128 a[200:203], v1 offset:2048
    ds_read_b128 a[204:207], v1 offset:3072
    ds_read_b128 a[208:211], v1 offset:4096
    ds_read_b128 a[212:215], v1 offset:5120
    ds_read_b128 a[216:219], v1 offset:6144
    ds_read_b128 a[220:223], v1 offset:7168
    s_waitcnt lgkmcnt(7)
    v_mfma_f32_16x16x32_bf16 v[96:99], a[192:195], a[0:3], 0
    s_add_u32 s16, s16, 6291456
    s_waitcnt lgkmcnt(6)
    v_mfma_f32_16x16x32_bf16 v[96:99], a[196:199], a[4:7], v[96:99]
    s_add_u32 s24, s16, 3145728
    s_waitcnt lgkmcnt(5)
    v_mfma_f32_16x16x32_bf16 v[96:99], a[200:203], a[8:11], v[96:99]
    ds_read_b128 a[224:227], v1 offset:8192
    s_waitcnt lgkmcnt(5)
    v_mfma_f32_16x16x32_bf16 v[96:99], a[204:207], a[12:15], v[96:99]
    s_add_u32 s26, s16, 3538944
    s_waitcnt lgkmcnt(4)
    v_mfma_f32_16x16x32_bf16 v[96:99], a[208:211], a[16:19], v[96:99]
    ds_read_b128 a[228:231], v1 offset:9216
    s_waitcnt lgkmcnt(2)
    v_mfma_f32_16x16x32_bf16 v[96:99], a[212:215], a[20:23], v[96:99]
    s_add_u32 s28, s16, 3932160
    s_add_u32 s30, s16, 4325376
    v_mfma_f32_16x16x32_bf16 v[100:103], a[192:195], a[24:27], 0
    ds_read_b128 a[232:235], v1 offset:10240
    s_add_u32 s32, s16, 0
    v_mfma_f32_16x16x32_bf16 v[100:103], a[196:199], a[28:31], v[100:103]
    s_add_u32 s34, s16, 393216
    s_add_u32 s36, s16, 786432
    v_mfma_f32_16x16x32_bf16 v[100:103], a[200:203], a[32:35], v[100:103]
    ds_read_b128 a[236:239], v1 offset:11264
    v_cvt_pk_bf16_f32 v192, v96, v97
    v_mfma_f32_16x16x32_bf16 v[100:103], a[204:207], a[36:39], v[100:103]
    v_cvt_pk_bf16_f32 v193, v98, v99
    s_add_u32 s38, s16, 1179648
    v_mfma_f32_16x16x32_bf16 v[100:103], a[208:211], a[40:43], v[100:103]
    s_cmp_eq_u32 s49, 0
    s_cbranch_scc0 L_pub0
    s_waitcnt vmcnt(12)
    ds_or_b32 v29, v26
L_pub0:
    v_mfma_f32_16x16x32_bf16 v[100:103], a[212:215], a[44:47], v[100:103]
    ds_read_b32 v30, v29
    s_add_u32 s33, s16, 3145728
    v_mfma_f32_16x16x32_bf16 v[104:107], a[192:195], a[48:51], 0
    s_add_u32 s35, s16, 3538944
    s_add_u32 s37, s16, 3932160
    v_mfma_f32_16x16x32_bf16 v[104:107], a[196:199], a[52:55], v[104:107]
    s_add_u32 s39, s16, 4325376
    v_mfma_f32_16x16x32_bf16 v[104:107], a[200:203], a[56:59], v[104:107]
    v_cvt_pk_bf16_f32 v196, v100, v101
    v_cvt_pk_bf16_f32 v197, v102, v103
    v_mfma_f32_16x16x32_bf16 v[104:107], a[204:207], a[60:63], v[104:107]
    v_mfma_f32_16x16x32_bf16 v[104:107], a[208:211], a[64:67], v[104:107]
    v_mfma_f32_16x16x32_bf16 v[104:107], a[212:215], a[68:71], v[104:107]
    v_mfma_f32_16x16x32_bf16 v[108:111], a[192:195], a[72:75], 0
    v_mfma_f32_16x16x32_bf16 v[108:111], a[196:199], a[76:79], v[108:111]
    v_mfma_f32_16x16x32_bf16 v[108:111], a[200:203], a[80:83], v[108:111]
    s_waitcnt lgkmcnt(0)
    v_readfirstlane_b32 s41, v30
    v_mfma_f32_16x16x32_bf16 v[108:111], a[204:207], a[84:87], v[108:111]
    v_cvt_pk_bf16_f32 v200, v104, v105
    v_cvt_pk_bf16_f32 v201, v106, v107
    v_mfma_f32_16x16x32_bf16 v[108:111], a[208:211], a[88:91], v[108:111]
    s_bitcmp1_b32 s41, 1
    s_cbranch_scc0 L_slow1
L_ok1:
    v_mfma_f32_16x16x32_bf16 v[108:111], a[212:215], a[92:95], v[108:111]
    ds_read_b128 a[240:243], v1 offset:12288
    s_add_u32 s61, s60, 0
    v_mfma_f32_16x16x32_bf16 v[112:115], a[216:219], a[0:3], 0
    buffer_load_dwordx4 v[128:131], v1, s[52:55], s61 offen offset:0
    v_mfma_f32_16x16x32_bf16 v[112:115], a[220:223], a[4:7], v[112:115]
    ds_read_b128 a[244:247], v1 offset:13312
    v_mfma_f32_16x16x32_bf16 v[112:115], a[224:227], a[8:11], v[112:115]
    ds_read_b128 a[248:251], v1 offset:14336
    v_cvt_pk_bf16_f32 v204, v108, v109
    v_mfma_f32_16x16x32_bf16 v[112:115], a[228:231], a[12:15], v[112:115]
    v_cvt_pk_bf16_f32 v205, v110, v111
    v_mfma_f32_16x16x32_bf16 v[112:115], a[232:235], a[16:19], v[112:115]
    ds_read_b128 a[192:195], v1 offset:15360
    v_mfma_f32_16x16x32_bf16 v[112:115], a[236:239], a[20:23], v[112:115]
    v_mfma_f32_16x16x32_bf16 v[116:119], a[216:219], a[24:27], 0
    buffer_load_dwordx4 v[132:135], v1, s[52:55], s61 offen offset:1024
    v_mfma_f32_16x16x32_bf16 v[116:119], a[220:223], a[28:31], v[116:119]
    ds_read_b128 a[196:199], v1 offset:16384
    v_mfma_f32_16x16x32_bf16 v[116:119], a[224:227], a[32:35], v[116:119]
    ds_read_b128 a[200:203], v1 offset:17408
    v_cvt_pk_bf16_f32 v194, v112, v113
    v_mfma_f32_16x16x32_bf16 v[116:119], a[228:231], a[36:39], v[116:119]
    s_cmp_eq_u32 s49, 1
    s_cbranch_scc0 L_pub2
    s_waitcnt vmcnt(26)
    ds_or_b32 v29, v26
L_pub2:
    v_mfma_f32_16x16x32_bf16 v[116:119], a[232:235], a[40:43], v[116:119]
    v_cvt_pk_bf16_f32 v195, v114, v115
    v_mfma_f32_16x16x32_bf16 v[116:119], a[236:239], a[44:47], v[116:119]
    v_mfma_f32_16x16x32_bf16 v[120:123], a[216:219], a[48:51], 0
    buffer_load_dwordx4 v[136:139], v1, s[52:55], s61 offen offset:2048
    v_mfma_f32_16x16x32_bf16 v[120:123], a[220:223], a[52:55], v[120:123]
    v_mfma_f32_16x16x32_bf16 v[120:123], a[224:227], a[56:59], v[120:123]
    v_cvt_pk_bf16_f32 v198, v116, v117
    v_cvt_pk_bf16_f32 v199, v118, v119
    v_mfma_f32_16x16x32_bf16 v[120:123], a[228:231], a[60:63], v[120:123]
    v_mfma_f32_16x16x32_bf16 v[120:123], a[232:235], a[64:67], v[120:123]
    v_mfma_f32_16x16x32_bf16 v[120:123], a[236:239], a[68:71], v[120:123]
    v_mfma_f32_16x16x32_bf16 v[124:127], a[216:219], a[72:75], 0
    buffer_load_dwordx4 v[140:143], v1, s[52:55], s61 offen offset:3072
    v_mfma_f32_16x16x32_bf16 v[124:127], a[220:223], a[76:79], v[124:127]
    v_mfma_f32_16x16x32_bf16 v[124:127], a[224:227], a[80:83], v[124:127]
    v_cvt_pk_bf16_f32 v202, v120, v121
    v_cvt_pk_bf16_f32 v203, v122, v123
    v_mfma_f32_16x16x32_bf16 v[124:127], a[228:231], a[84:87], v[124:127]
    v_mfma_f32_16x16x32_bf16 v[124:127], a[232:235], a[88:91], v[124:127]
    ds_read_b128 a[204:207], v1 offset:18432
    s_add_u32 s61, s60, 4096
    v_mfma_f32_16x16x32_bf16 v[124:127], a[236:239], a[92:95], v[124:127]
    s_waitcnt lgkmcnt(1)
    v_mfma_f32_16x16x32_bf16 v[96:99], a[240:243], a[0:3], 0
    buffer_load_dwordx4 v[144:147], v1, s[52:55], s61 offen offset:0
    v_mfma_f32_16x16x32_bf16 v[96:99], a[244:247], a[4:7], v[96:99]
    ds_read_b128 a[208:211], v1 offset:19456
    v_mfma_f32_16x16x32_bf16 v[96:99], a[248:251], a[8:11], v[96:99]
    ds_read_b128 a[212:215], v1 offset:20480
    v_cvt_pk_bf16_f32 v206, v124, v125
    v_mfma_f32_16x16x32_bf16 v[96:99], a[192:195], a[12:15], v[96:99]
    v_cvt_pk_bf16_f32 v207, v126, v127
    v_mfma_f32_16x16x32_bf16 v[96:99], a[196:199], a[16:19], v[96:99]
    ds_read_b128 a[216:219], v1 offset:21504
    v_mfma_f32_16x16x32_bf16 v[96:99], a[200:203], a[20:23], v[96:99]
    v_mfma_f32_16x16x32_bf16 v[100:103], a[240:243], a[24:27], 0
    buffer_load_dwordx4 v[148:151], v1, s[52:55], s61 offen offset:1024
    v_mfma_f32_16x16x32_bf16 v[100:103], a[244:247], a[28:31], v[100:103]
    ds_read_b128 a[220:223], v1 offset:22528
    v_mfma_f32_16x16x32_bf16 v[100:103], a[248:251], a[32:35], v[100:103]
    ds_read_b128 a[224:227], v1 offset:23552
    v_cvt_pk_bf16_f32 v208, v96, v97
    v_mfma_f32_16x16x32_bf16 v[100:103], a[192:195], a[36:39], v[100:103]
    v_cvt_pk_bf16_f32 v209, v98, v99
    v_mfma_f32_16x16x32_bf16 v[100:103], a[196:199], a[40:43], v[100:103]
    v_mfma_f32_16x16x32_bf16 v[100:103], a[200:203], a[44:47], v[100:103]
    v_mfma_f32_16x16x32_bf16 v[104:107], a[240:243], a[48:51], 0
    buffer_load_dwordx4 v[152:155], v1, s[52:55], s61 offen offset:2048
    v_mfma_f32_16x16x32_bf16 v[104:107], a[244:247], a[52:55], v[104:107]
    s_cmp_eq_u32 s49, 0
    s_cbranch_scc0 L_pub1
    s_waitcnt vmcnt(7)
    ds_or_b32 v29, v27
L_pub1:
    v_mfma_f32_16x16x32_bf16 v[104:107], a[248:251], a[56:59], v[104:107]
    ds_read_b32 v30, v29
    v_cvt_pk_bf16_f32 v212, v100, v101
    v_mfma_f32_16x16x32_bf16 v[104:107], a[192:195], a[60:63], v[104:107]
    v_cvt_pk_bf16_f32 v213, v102, v103
    v_mfma_f32_16x16x32_bf16 v[104:107], a[196:199], a[64:67], v[104:107]
    v_mfma_f32_16x16x32_bf16 v[104:107], a[200:203], a[68:71], v[104:107]
    v_mfma_f32_16x16x32_bf16 v[108:111], a[240:243], a[72:75], 0
    buffer_load_dwordx4 v[156:159], v1, s[52:55], s61 offen offset:3072
    v_mfma_f32_16x16x32_bf16 v[108:111], a[244:247], a[76:79], v[108:111]
    v_mfma_f32_16x16x32_bf16 v[108:111], a[248:251], a[80:83], v[108:111]
    v_cvt_pk_bf16_f32 v216, v104, v105
    v_cvt_pk_bf16_f32 v217, v106, v107
    v_mfma_f32_16x16x32_bf16 v[108:111], a[192:195], a[84:87], v[108:111]
    v_mfma_f32_16x16x32_bf16 v[108:111], a[196:199], a[88:91], v[108:111]
    s_add_u32 s61, s60, 8192
    v_mfma_f32_16x16x32_bf16 v[108:111], a[200:203], a[92:95], v[108:111]
    s_waitcnt lgkmcnt(1)
    v_mfma_f32_16x16x32_bf16 v[112:115], a[204:207], a[0:3], 0
    buffer_load_dwordx4 v[160:163], v1, s[52:55], s61 offen offset:0
    v_mfma_f32_16x16x32_bf16 v[112:115], a[208:211], a[4:7], v[112:115]
    s_waitcnt lgkmcnt(0)
    v_readfirstlane_b32 s41, v30
    v_mfma_f32_16x16x32_bf16 v[112:115], a[212:215], a[8:11], v[112:115]
    v_cvt_pk_bf16_f32 v220, v108, v109
    v_cvt_pk_bf16_f32 v221, v110, v111
    v_mfma_f32_16x16x32_bf16 v[112:115], a[216:219], a[12:15], v[112:115]
    s_bitcmp1_b32 s41, 2
    s_cbranch_scc0 L_slow2
L_ok2:
    v_mfma_f32_16x16x32_bf16 v[112:115], a[220:223], a[16:19], v[112:115]
    ds_read_b128 a[228:231], v1 offset:24576
    v_mfma_f32_16x16x32_bf16 v[112:115], a[224:227], a[20:23], v[112:115]
    ds_read_b128 a[232:235], v1 offset:25600
    v_mfma_f32_16x16x32_bf16 v[116:119], a[204:207], a[24:27], 0
    ds_read_b128 a[236:239], v1 offset:26624
    v_mfma_f32_16x16x32_bf16 v[116:119], a[208:211], a[28:31], v[116:119]
    ds_read_b128 a[240:243], v1 offset:27648
    v_mfma_f32_16x16x32_bf16 v[116:119], a[212:215], a[32:35], v[116:119]
    buffer_load_dwordx4 v[164:167], v1, s[52:55], s61 offen offset:1024
    v_cvt_pk_bf16_f32 v210, v112, v113
    v_mfma_f32_16x16x32_bf16 v[116:119], a[216:219], a[36:39], v[116:119]
    ds_read_b128 a[244:247], v1 offset:28672
    v_cvt_pk_bf16_f32 v211, v114, v115
    v_mfma_f32_16x16x32_bf16 v[116:119], a[220:223], a[40:43], v[116:119]
    ds_read_b128 a[248:251], v1 offset:29696
    v_mfma_f32_16x16x32_bf16 v[116:119], a[224:227], a[44:47], v[116:119]
    s_cmp_eq_u32 s49, 1
    s_cbranch_scc0 L_pub3
    s_waitcnt vmcnt(22)
    ds_or_b32 v29, v27
L_pub3:
    v_mfma_f32_16x16x32_bf16 v[120:123], a[204:207], a[48:51], 0
    buffer_load_dwordx4 v[168:171], v1, s[52:55], s61 offen offset:2048
    v_mfma_f32_16x16x32_bf16 v[120:123], a[208:211], a[52:55], v[120:123]
    v_mfma_f32_16x16x32_bf16 v[120:123], a[212:215], a[56:59], v[120:123]
    v_cvt_pk_bf16_f32 v214, v116, v117
    v_cvt_pk_bf16_f32 v215, v118, v119
    v_mfma_f32_16x16x32_bf16 v[120:123], a[216:219], a[60:63], v[120:123]
    v_mfma_f32_16x16x32_bf16 v[120:123], a[220:223], a[64:67], v[120:123]
    v_mfma_f32_16x16x32_bf16 v[120:123], a[224:227], a[68:71], v[120:123]
    v_mfma_f32_16x16x32_bf16 v[124:127], a[204:207], a[72:75], 0
    buffer_load_dwordx4 v[172:175], v1, s[52:55], s61 offen offset:3072
    v_mfma_f32_16x16x32_bf16 v[124:127], a[208:211], a[76:79], v[124:127]
    v_mfma_f32_16x16x32_bf16 v[124:127], a[212:215], a[80:83], v[124:127]
    v_cvt_pk_bf16_f32 v218, v120, v121
    v_cvt_pk_bf16_f32 v219, v122, v123
    v_mfma_f32_16x16x32_bf16 v[124:127], a[216:219], a[84:87], v[124:127]
    v_mfma_f32_16x16x32_bf16 v[124:127], a[220:223], a[88:91], v[124:127]
    s_add_u32 s61, s60, 12288
    v_mfma_f32_16x16x32_bf16 v[124:127], a[224:227], a[92:95], v[124:127]
    s_waitcnt lgkmcnt(1)
    v_mfma_f32_16x16x32_bf16 v[96:99], a[228:231], a[0:3], 0
    buffer_load_dwordx4 v[176:179], v1, s[52:55], s61 offen offset:0
    v_mfma_f32_16x16x32_bf16 v[96:99], a[232:235], a[4:7], v[96:99]
    v_mfma_f32_16x16x32_bf16 v[96:99], a[236:239], a[8:11], v[96:99]
    v_cvt_pk_bf16_f32 v222, v124, v125
    v_cvt_pk_bf16_f32 v223, v126, v127
    v_mfma_f32_16x16x32_bf16 v[96:99], a[240:243], a[12:15], v[96:99]
    v_mfma_f32_16x16x32_bf16 v[96:99], a[244:247], a[16:19], v[96:99]
    s_waitcnt lgkmcnt(0)
    v_mfma_f32_16x16x32_bf16 v[96:99], a[248:251], a[20:23], v[96:99]
    v_mfma_f32_16x16x32_bf16 v[100:103], a[228:231], a[24:27], 0
    buffer_load_dwordx4 v[180:183], v1, s[52:55], s61 offen offset:1024
    v_mfma_f32_16x16x32_bf16 v[100:103], a[232:235], a[28:31], v[100:103]
    v_mfma_f32_16x16x32_bf16 v[100:103], a[236:239], a[32:35], v[100:103]
    s_waitcnt vmcnt(13)
    ds_write_b64 v24, v[128:129] offset:0
    v_mfma_f32_16x16x32_bf16 v[100:103], a[240:243], a[36:39], v[100:103]
    ds_write_b64 v24, v[130:131] offset:8
    v_mfma_f32_16x16x32_bf16 v[100:103], a[244:247], a[40:43], v[100:103]
    v_mfma_f32_16x16x32_bf16 v[100:103], a[248:251], a[44:47], v[100:103]
    v_mfma_f32_16x16x32_bf16 v[32:35], a[0:3], v[192:195], 0
    buffer_load_dwordx4 v[184:187], v1, s[52:55], s61 offen offset:2048
    v_mfma_f32_16x16x32_bf16 v[32:35], a[4:7], v[208:211], v[32:35]
    v_mfma_f32_16x16x32_bf16 v[36:39], a[24:27], v[192:195], 0
    s_waitcnt vmcnt(13)
    ds_write_b64 v24, v[132:133] offset:1024
    v_mfma_f32_16x16x32_bf16 v[36:39], a[28:31], v[208:211], v[36:39]
    ds_write_b64 v24, v[134:135] offset:1032
    v_mfma_f32_16x16x32_bf16 v[40:43], a[48:51], v[192:195], 0
    v_mfma_f32_16x16x32_bf16 v[40:43], a[52:55], v[208:211], v[40:43]
    v_mfma_f32_16x16x32_bf16 v[44:47], a[72:75], v[192:195], 0
    buffer_load_dwordx4 v[188:191], v1, s[52:55], s61 offen offset:3072
    v_cvt_pk_bf16_f32 v192, v96, v97
    v_mfma_f32_16x16x32_bf16 v[44:47], a[76:79], v[208:211], v[44:47]
    v_cvt_pk_bf16_f32 v193, v98, v99
    v_mfma_f32_16x16x32_bf16 v[48:51], a[0:3], v[196:199], 0
    s_waitcnt vmcnt(13)
    ds_write_b64 v24, v[136:137] offset:2048
    v_mfma_f32_16x16x32_bf16 v[48:51], a[4:7], v[212:215], v[48:51]
    ds_write_b64 v24, v[138:139] offset:2056
    v_mfma_f32_16x16x32_bf16 v[52:55], a[24:27], v[196:199], 0
    s_add_u32 s61, s60, 16384
    v_mfma_f32_16x16x32_bf16 v[52:55], a[28:31], v[212:215], v[52:55]
    v_mfma_f32_16x16x32_bf16 v[56:59], a[48:51], v[196:199], 0
    buffer_load_dwordx4 v[224:227], v1, s[52:55], s61 offen offset:0
    v_mfma_f32_16x16x32_bf16 v[56:59], a[52:55], v[212:215], v[56:59]
    v_mfma_f32_16x16x32_bf16 v[60:63], a[72:75], v[196:199], 0
    s_waitcnt vmcnt(13)
    ds_write_b64 v24, v[140:141] offset:3072
    v_mfma_f32_16x16x32_bf16 v[60:63], a[76:79], v[212:215], v[60:63]
    ds_write_b64 v24, v[142:143] offset:3080
    v_mfma_f32_16x16x32_bf16 v[64:67], a[0:3], v[200:203], 0
    v_cvt_pk_bf16_f32 v196, v100, v101
    v_cvt_pk_bf16_f32 v197, v102, v103
    v_mfma_f32_16x16x32_bf16 v[64:67], a[4:7], v[216:219], v[64:67]
    v_mfma_f32_16x16x32_bf16 v[68:71], a[24:27], v[200:203], 0
    buffer_load_dwordx4 v[228:231], v1, s[52:55], s61 offen offset:1024
    v_mfma_f32_16x16x32_bf16 v[68:71], a[28:31], v[216:219], v[68:71]
    ds_read_b128 a[192:195], v1 offset:30720
    v_mfma_f32_16x16x32_bf16 v[72:75], a[48:51], v[200:203], 0
    ds_read_b128 a[196:199], v1 offset:31744
    v_mfma_f32_16x16x32_bf16 v[72:75], a[52:55], v[216:219], v[72:75]
    s_waitcnt vmcnt(13)
    ds_write_b64 v24, v[144:145] offset:4096
    v_mfma_f32_16x16x32_bf16 v[76:79], a[72:75], v[200:203], 0
    ds_read_b128 a[200:203], v1 offset:32768
    v_mfma_f32_16x16x32_bf16 v[76:79], a[76:79], v[216:219], v[76:79]
    ds_write_b64 v24, v[146:147] offset:4104
    v_mfma_f32_16x16x32_bf16 v[80:83], a[0:3], v[204:207], 0
    ds_read_b128 a[204:207], v1 offset:33792
    v_mfma_f32_16x16x32_bf16 v[80:83], a[4:7], v[220:223], v[80:83]
    s_cmp_eq_u32 s49, 1
    s_cbranch_scc0 L_pub4
    s_waitcnt vmcnt(18)
    ds_or_b32 v29, v28
L_pub4:
    v_mfma_f32_16x16x32_bf16 v[84:87], a[24:27], v[204:207], 0
    ds_read_b128 a[208:211], v1 offset:34816
    v_mfma_f32_16x16x32_bf16 v[84:87], a[28:31], v[220:223], v[84:87]
    s_waitcnt vmcnt(12)
    ds_write_b64 v24, v[148:149] offset:5120
    v_mfma_f32_16x16x32_bf16 v[88:91], a[48:51], v[204:207], 0
    ds_read_b32 v30, v29
    v_mfma_f32_16x16x32_bf16 v[88:91], a[52:55], v[220:223], v[88:91]
    ds_read_b128 a[212:215], v1 offset:35840
    v_mfma_f32_16x16x32_bf16 v[92:95], a[72:75], v[204:207], 0
    ds_write_b64 v24, v[150:151] offset:5128
    v_mfma_f32_16x16x32_bf16 v[92:95], a[76:79], v[220:223], v[92:95]
    v_mfma_f32_16x16x32_bf16 v[104:107], a[228:231], a[48:51], 0
    s_waitcnt vmcnt(11)
    ds_write_b64 v24, v[152:153] offset:6144
    v_mfma_f32_16x16x32_bf16 v[104:107], a[232:235], a[52:55], v[104:107]
    ds_write_b64 v24, v[154:155] offset:6152
    v_mfma_f32_16x16x32_bf16 v[104:107], a[236:239], a[56:59], v[104:107]
    v_mfma_f32_16x16x32_bf16 v[104:107], a[240:243], a[60:63], v[104:107]
    v_mfma_f32_16x16x32_bf16 v[104:107], a[244:247], a[64:67], v[104:107]
    v_mfma_f32_16x16x32_bf16 v[104:107], a[248:251], a[68:71], v[104:107]
    s_waitcnt lgkmcnt(4)
    v_readfirstlane_b32 s41, v30
    v_mfma_f32_16x16x32_bf16 v[108:111], a[228:231], a[72:75], 0
    s_waitcnt vmcnt(10)
    ds_write_b64 v24, v[156:157] offset:7168
    v_mfma_f32_16x16x32_bf16 v[108:111], a[232:235], a[76:79], v[108:111]
    ds_write_b64 v24, v[158:159] offset:7176
    v_mfma_f32_16x16x32_bf16 v[108:111], a[236:239], a[80:83], v[108:111]
    s_bitcmp1_b32 s41, 3
    s_cbranch_scc0 L_slow3
L_ok3:
    v_mfma_f32_16x16x32_bf16 v[108:111], a[240:243], a[84:87], v[108:111]
    v_cvt_pk_bf16_f32 v200, v104, v105
    v_cvt_pk_bf16_f32 v201, v106, v107
    v_mfma_f32_16x16x32_bf16 v[108:111], a[244:247], a[88:91], v[108:111]
    buffer_load_dwordx4 a[96:99], v9, s[8:11], s24 offen offset:0 nt
    v_mfma_f32_16x16x32_bf16 v[108:111], a[248:251], a[92:95], v[108:111]
    buffer_load_dwordx4 a[100:103], v10, s[8:11], s24 offen offset:0 nt
    v_mfma_f32_16x16x32_bf16 v[112:115], a[192:195], a[0:3], 0
    ds_read_b128 a[216:219], v1 offset:36864
    v_mfma_f32_16x16x32_bf16 v[112:115], a[196:199], a[4:7], v[112:115]
    ds_read_b128 a[220:223], v1 offset:37888
    v_mfma_f32_16x16x32_bf16 v[112:115], a[200:203], a[8:11], v[112:115]
    ds_read_b128 a[224:227], v1 offset:38912
    v_cvt_pk_bf16_f32 v204, v108, v109
    v_mfma_f32_16x16x32_bf16 v[112:115], a[204:207], a[12:15], v[112:115]
    s_waitcnt vmcnt(11)
    ds_write_b64 v24, v[160:161] offset:8192
    v_mfma_f32_16x16x32_bf16 v[112:115], a[208:211], a[16:19], v[112:115]
    ds_read_b128 a[228:231], v1 offset:39936
    s_waitcnt lgkmcnt(7)
    v_mfma_f32_16x16x32_bf16 v[112:115], a[212:215], a[20:23], v[112:115]
    ds_write_b64 v24, v[162:163] offset:8200
    v_mfma_f32_16x16x32_bf16 v[116:119], a[192:195], a[24:27], 0
    ds_read_b128 a[232:235], v1 offset:40960
    v_cvt_pk_bf16_f32 v205, v110, v111
    v_mfma_f32_16x16x32_bf16 v[116:119], a[196:199], a[28:31], v[116:119]
    s_waitcnt vmcnt(10)
    ds_write_b64 v24, v[164:165] offset:9216
    v_mfma_f32_16x16x32_bf16 v[116:119], a[200:203], a[32:35], v[116:119]
    ds_read_b128 a[236:239], v1 offset:41984
    v_cvt_pk_bf16_f32 v194, v112, v113
    v_mfma_f32_16x16x32_bf16 v[116:119], a[204:207], a[36:39], v[116:119]
    ds_write_b64 v24, v[166:167] offset:9224
    v_mfma_f32_16x16x32_bf16 v[116:119], a[208:211], a[40:43], v[116:119]
    v_cvt_pk_bf16_f32 v195, v114, v115
    v_mfma_f32_16x16x32_bf16 v[116:119], a[212:215], a[44:47], v[116:119]
    v_mfma_f32_16x16x32_bf16 v[120:123], a[192:195], a[48:51], 0
    s_waitcnt vmcnt(9)
    ds_write_b64 v24, v[168:169] offset:10240
    v_mfma_f32_16x16x32_bf16 v[120:123], a[196:199], a[52:55], v[120:123]
    ds_write_b64 v24, v[170:171] offset:10248
    v_mfma_f32_16x16x32_bf16 v[120:123], a[200:203], a[56:59], v[120:123]
    v_cvt_pk_bf16_f32 v198, v116, v117
    v_cvt_pk_bf16_f32 v199, v118, v119
    v_mfma_f32_16x16x32_bf16 v[120:123], a[204:207], a[60:63], v[120:123]
    v_mfma_f32_16x16x32_bf16 v[120:123], a[208:211], a[64:67], v[120:123]
    v_mfma_f32_16x16x32_bf16 v[120:123], a[212:215], a[68:71], v[120:123]
    v_mfma_f32_16x16x32_bf16 v[124:127], a[192:195], a[72:75], 0
    s_waitcnt vmcnt(8)
    ds_write_b64 v24, v[172:173] offset:11264
    v_mfma_f32_16x16x32_bf16 v[124:127], a[196:199], a[76:79], v[124:127]
    ds_write_b64 v24, v[174:175] offset:11272
    v_mfma_f32_16x16x32_bf16 v[124:127], a[200:203], a[80:83], v[124:127]
    buffer_load_dwordx4 a[104:107], v9, s[8:11], s24 offen offset:128 nt
    v_cvt_pk_bf16_f32 v202, v120, v121
    v_mfma_f32_16x16x32_bf16 v[124:127], a[204:207], a[84:87], v[124:127]
    buffer_load_dwordx4 a[108:111], v10, s[8:11], s24 offen offset:128 nt
    v_cvt_pk_bf16_f32 v203, v122, v123
    v_mfma_f32_16x16x32_bf16 v[124:127], a[208:211], a[88:91], v[124:127]
    ds_read_b128 a[240:243], v1 offset:43008
    v_mfma_f32_16x16x32_bf16 v[124:127], a[212:215], a[92:95], v[124:127]
    s_waitcnt lgkmcnt(5)
    v_mfma_f32_16x16x32_bf16 v[96:99], a[216:219], a[0:3], 0
    ds_read_b128 a[244:247], v1 offset:44032
    v_mfma_f32_16x16x32_bf16 v[96:99], a[220:223], a[4:7], v[96:99]
    s_waitcnt vmcnt(9)
    ds_write_b64 v24, v[176:177] offset:12288
    v_mfma_f32_16x16x32_bf16 v[96:99], a[224:227], a[8:11], v[96:99]
    ds_read_b128 a[248:251], v1 offset:45056
    v_cvt_pk_bf16_f32 v206, v124, v125
    v_mfma_f32_16x16x32_bf16 v[96:99], a[228:231], a[12:15], v[96:99]
    ds_write_b64 v24, v[178:179] offset:12296
    v_mfma_f32_16x16x32_bf16 v[96:99], a[232:235], a[16:19], v[96:99]
    ds_read_b128 a[192:195], v1 offset:46080
    v_cvt_pk_bf16_f32 v207, v126, v127
    v_mfma_f32_16x16x32_bf16 v[96:99], a[236:239], a[20:23], v[96:99]
    v_mfma_f32_16x16x32_bf16 v[100:103], a[216:219], a[24:27], 0
    ds_read_b128 a[196:199], v1 offset:47104
    v_mfma_f32_16x16x32_bf16 v[100:103], a[220:223], a[28:31], v[100:103]
    s_waitcnt vmcnt(8)
    ds_write_b64 v24, v[180:181] offset:13312
    v_mfma_f32_16x16x32_bf16 v[100:103], a[224:227], a[32:35], v[100:103]
    ds_read_b32 v30, v29
    v_cvt_pk_bf16_f32 v208, v96, v97
    v_mfma_f32_16x16x32_bf16 v[100:103], a[228:231], a[36:39], v[100:103]
    ds_read_b128 a[200:203], v1 offset:48128
    v_cvt_pk_bf16_f32 v209, v98, v99
    v_mfma_f32_16x16x32_bf16 v[100:103], a[232:235], a[40:43], v[100:103]
    ds_write_b64 v24, v[182:183] offset:13320
    v_mfma_f32_16x16x32_bf16 v[100:103], a[236:239], a[44:47], v[100:103]
    v_mfma_f32_16x16x32_bf16 v[104:107], a[216:219], a[48:51], 0
    s_waitcnt vmcnt(7)
    ds_write_b64 v24, v[184:185] offset:14336
    v_mfma_f32_16x16x32_bf16 v[104:107], a[220:223], a[52:55], v[104:107]
    ds_write_b64 v24, v[186:187] offset:14344
    v_mfma_f32_16x16x32_bf16 v[104:107], a[224:227], a[56:59], v[104:107]
    v_cvt_pk_bf16_f32 v212, v100, v101
    v_cvt_pk_bf16_f32 v213, v102, v103
    v_mfma_f32_16x16x32_bf16 v[104:107], a[228:231], a[60:63], v[104:107]
    v_mfma_f32_16x16x32_bf16 v[104:107], a[232:235], a[64:67], v[104:107]
    v_mfma_f32_16x16x32_bf16 v[104:107], a[236:239], a[68:71], v[104:107]
    s_waitcnt lgkmcnt(4)
    v_readfirstlane_b32 s41, v30
    v_mfma_f32_16x16x32_bf16 v[108:111], a[216:219], a[72:75], 0
    buffer_load_dwordx4 a[112:115], v9, s[8:11], s24 offen offset:256 nt
    v_mfma_f32_16x16x32_bf16 v[108:111], a[220:223], a[76:79], v[108:111]
    buffer_load_dwordx4 a[116:119], v10, s[8:11], s24 offen offset:256 nt
    s_add_u32 s24, s16, 6291456
    v_mfma_f32_16x16x32_bf16 v[108:111], a[224:227], a[80:83], v[108:111]
    s_waitcnt vmcnt(8)
    ds_write_b64 v24, v[188:189] offset:15360
    v_mfma_f32_16x16x32_bf16 v[108:111], a[228:231], a[84:87], v[108:111]
    ds_write_b64 v24, v[190:191] offset:15368
    v_mfma_f32_16x16x32_bf16 v[108:111], a[232:235], a[88:91], v[108:111]
    s_bitcmp1_b32 s41, 4
    s_cbranch_scc0 L_slow4
L_ok4:
    v_mfma_f32_16x16x32_bf16 v[108:111], a[236:239], a[92:95], v[108:111]
    ds_read_b128 a[204:207], v1 offset:49152
    v_cvt_pk_bf16_f32 v216, v104, v105
    v_mfma_f32_16x16x32_bf16 v[112:115], a[240:243], a[0:3], 0
    ds_read_b128 a[208:211], v1 offset:50176
    v_cvt_pk_bf16_f32 v217, v106, v107
    v_mfma_f32_16x16x32_bf16 v[112:115], a[244:247], a[4:7], v[112:115]
    s_waitcnt vmcnt(7)
    ds_write_b64 v24, v[224:225] offset:16384
    v_mfma_f32_16x16x32_bf16 v[112:115], a[248:251], a[8:11], v[112:115]
    ds_read_b128 a[212:215], v1 offset:51200
    v_cvt_pk_bf16_f32 v220, v108, v109
    v_mfma_f32_16x16x32_bf16 v[112:115], a[192:195], a[12:15], v[112:115]
    ds_write_b64 v24, v[226:227] offset:16392
    v_mfma_f32_16x16x32_bf16 v[112:115], a[196:199], a[16:19], v[112:115]
    ds_read_b128 a[216:219], v1 offset:52224
    s_waitcnt lgkmcnt(8)
    v_mfma_f32_16x16x32_bf16 v[112:115], a[200:203], a[20:23], v[112:115]
    v_cvt_pk_bf16_f32 v221, v110, v111
    v_mfma_f32_16x16x32_bf16 v[116:119], a[240:243], a[24:27], 0
    ds_read_b128 a[220:223], v1 offset:53248
    v_mfma_f32_16x16x32_bf16 v[116:119], a[244:247], a[28:31], v[116:119]
    s_waitcnt vmcnt(6)
    ds_write_b64 v24, v[228:229] offset:17408
    v_mfma_f32_16x16x32_bf16 v[116:119], a[248:251], a[32:35], v[116:119]
    ds_read_b128 a[224:227], v1 offset:54272
    v_cvt_pk_bf16_f32 v210, v112, v113
    v_mfma_f32_16x16x32_bf16 v[116:119], a[192:195], a[36:39], v[116:119]
    ds_write_b64 v24, v[230:231] offset:17416
    v_mfma_f32_16x16x32_bf16 v[116:119], a[196:199], a[40:43], v[116:119]
    ds_or_b32 v29, v25
    v_mfma_f32_16x16x32_bf16 v[116:119], a[200:203], a[44:47], v[116:119]
    v_cvt_pk_bf16_f32 v211, v114, v115
    v_mfma_f32_16x16x32_bf16 v[120:123], a[240:243], a[48:51], 0
    v_mfma_f32_16x16x32_bf16 v[120:123], a[244:247], a[52:55], v[120:123]
    v_mfma_f32_16x16x32_bf16 v[120:123], a[248:251], a[56:59], v[120:123]
    v_cvt_pk_bf16_f32 v214, v116, v117
    v_cvt_pk_bf16_f32 v215, v118, v119
    v_mfma_f32_16x16x32_bf16 v[120:123], a[192:195], a[60:63], v[120:123]
    v_mfma_f32_16x16x32_bf16 v[120:123], a[196:199], a[64:67], v[120:123]
    buffer_load_dwordx4 a[120:123], v9, s[8:11], s26 offen offset:0 nt
    v_mfma_f32_16x16x32_bf16 v[120:123], a[200:203], a[68:71], v[120:123]
    buffer_load_dwordx4 a[124:127], v10, s[8:11], s26 offen offset:0 nt
    v_mfma_f32_16x16x32_bf16 v[124:127], a[240:243], a[72:75], 0
    v_mfma_f32_16x16x32_bf16 v[124:127], a[244:247], a[76:79], v[124:127]
    v_mfma_f32_16x16x32_bf16 v[124:127], a[248:251], a[80:83], v[124:127]
    v_cvt_pk_bf16_f32 v218, v120, v121
    v_cvt_pk_bf16_f32 v219, v122, v123
    v_mfma_f32_16x16x32_bf16 v[124:127], a[192:195], a[84:87], v[124:127]
    v_mfma_f32_16x16x32_bf16 v[124:127], a[196:199], a[88:91], v[124:127]
    v_mfma_f32_16x16x32_bf16 v[124:127], a[200:203], a[92:95], v[124:127]
    s_waitcnt lgkmcnt(1)
    v_mfma_f32_16x16x32_bf16 v[96:99], a[204:207], a[0:3], 0
    v_mfma_f32_16x16x32_bf16 v[96:99], a[208:211], a[4:7], v[96:99]
    v_mfma_f32_16x16x32_bf16 v[96:99], a[212:215], a[8:11], v[96:99]
    v_cvt_pk_bf16_f32 v222, v124, v125
    v_cvt_pk_bf16_f32 v223, v126, v127
    v_mfma_f32_16x16x32_bf16 v[96:99], a[216:219], a[12:15], v[96:99]
    v_mfma_f32_16x16x32_bf16 v[96:99], a[220:223], a[16:19], v[96:99]
    v_mfma_f32_16x16x32_bf16 v[96:99], a[224:227], a[20:23], v[96:99]
    v_mfma_f32_16x16x32_bf16 v[100:103], a[204:207], a[24:27], 0
    v_mfma_f32_16x16x32_bf16 v[100:103], a[208:211], a[28:31], v[100:103]
    v_mfma_f32_16x16x32_bf16 v[100:103], a[212:215], a[32:35], v[100:103]
    v_mfma_f32_16x16x32_bf16 v[100:103], a[216:219], a[36:39], v[100:103]
    v_mfma_f32_16x16x32_bf16 v[100:103], a[220:223], a[40:43], v[100:103]
    v_mfma_f32_16x16x32_bf16 v[100:103], a[224:227], a[44:47], v[100:103]
    v_mfma_f32_16x16x32_bf16 v[32:35], a[8:11], v[192:195], v[32:35]
    v_mfma_f32_16x16x32_bf16 v[32:35], a[12:15], v[208:211], v[32:35]
    v_mfma_f32_16x16x32_bf16 v[36:39], a[32:35], v[192:195], v[36:39]
    buffer_load_dwordx4 a[128:131], v9, s[8:11], s26 offen offset:128 nt
    v_mfma_f32_16x16x32_bf16 v[36:39], a[36:39], v[208:211], v[36:39]
    buffer_load_dwordx4 a[132:135], v10, s[8:11], s26 offen offset:128 nt
    v_mfma_f32_16x16x32_bf16 v[40:43], a[56:59], v[192:195], v[40:43]
    v_mfma_f32_16x16x32_bf16 v[40:43], a[60:63], v[208:211], v[40:43]
    v_mfma_f32_16x16x32_bf16 v[44:47], a[80:83], v[192:195], v[44:47]
    v_cvt_pk_bf16_f32 v192, v96, v97
    v_cvt_pk_bf16_f32 v193, v98, v99
    v_mfma_f32_16x16x32_bf16 v[44:47], a[84:87], v[208:211], v[44:47]
    v_mfma_f32_16x16x32_bf16 v[48:51], a[8:11], v[196:199], v[48:51]
    v_mfma_f32_16x16x32_bf16 v[48:51], a[12:15], v[212:215], v[48:51]
    v_mfma_f32_16x16x32_bf16 v[52:55], a[32:35], v[196:199], v[52:55]
    v_mfma_f32_16x16x32_bf16 v[52:55], a[36:39], v[212:215], v[52:55]
    v_mfma_f32_16x16x32_bf16 v[56:59], a[56:59], v[196:199], v[56:59]
    v_mfma_f32_16x16x32_bf16 v[56:59], a[60:63], v[212:215], v[56:59]
    v_mfma_f32_16x16x32_bf16 v[60:63], a[80:83], v[196:199], v[60:63]
    v_cvt_pk_bf16_f32 v196, v100, v101
    v_cvt_pk_bf16_f32 v197, v102, v103
    v_mfma_f32_16x16x32_bf16 v[60:63], a[84:87], v[212:215], v[60:63]
    v_mfma_f32_16x16x32_bf16 v[64:67], a[8:11], v[200:203], v[64:67]
    v_mfma_f32_16x16x32_bf16 v[64:67], a[12:15], v[216:219], v[64:67]
    v_mfma_f32_16x16x32_bf16 v[68:71], a[32:35], v[200:203], v[68:71]
    ds_read_b128 a[228:231], v1 offset:55296
    v_mfma_f32_16x16x32_bf16 v[68:71], a[36:39], v[216:219], v[68:71]
    v_mfma_f32_16x16x32_bf16 v[72:75], a[56:59], v[200:203], v[72:75]
    ds_read_b128 a[232:235], v1 offset:56320
    v_mfma_f32_16x16x32_bf16 v[72:75], a[60:63], v[216:219], v[72:75]
    v_mfma_f32_16x16x32_bf16 v[76:79], a[80:83], v[200:203], v[76:79]
    ds_read_b128 a[236:239], v1 offset:57344
    v_mfma_f32_16x16x32_bf16 v[76:79], a[84:87], v[216:219], v[76:79]
    v_mfma_f32_16x16x32_bf16 v[80:83], a[8:11], v[204:207], v[80:83]
    buffer_load_dwordx4 a[136:139], v9, s[8:11], s26 offen offset:256 nt
    v_mfma_f32_16x16x32_bf16 v[80:83], a[12:15], v[220:223], v[80:83]
    buffer_load_dwordx4 a[140:143], v10, s[8:11], s26 offen offset:256 nt
    s_add_u32 s26, s16, 6684672
    v_mfma_f32_16x16x32_bf16 v[84:87], a[32:35], v[204:207], v[84:87]
    ds_read_b128 a[240:243], v1 offset:58368
    v_mfma_f32_16x16x32_bf16 v[84:87], a[36:39], v[220:223], v[84:87]
    ds_read_b128 a[244:247], v1 offset:59392
    v_mfma_f32_16x16x32_bf16 v[88:91], a[56:59], v[204:207], v[88:91]
    ds_read_b32 v30, v29
    v_mfma_f32_16x16x32_bf16 v[88:91], a[60:63], v[220:223], v[88:91]
    ds_read_b128 a[248:251], v1 offset:60416
    v_mfma_f32_16x16x32_bf16 v[92:95], a[80:83], v[204:207], v[92:95]
    v_mfma_f32_16x16x32_bf16 v[92:95], a[84:87], v[220:223], v[92:95]
    v_mfma_f32_16x16x32_bf16 v[104:107], a[204:207], a[48:51], 0
    v_mfma_f32_16x16x32_bf16 v[104:107], a[208:211], a[52:55], v[104:107]
    v_mfma_f32_16x16x32_bf16 v[104:107], a[212:215], a[56:59], v[104:107]
    v_mfma_f32_16x16x32_bf16 v[104:107], a[216:219], a[60:63], v[104:107]
    v_mfma_f32_16x16x32_bf16 v[104:107], a[220:223], a[64:67], v[104:107]
    v_mfma_f32_16x16x32_bf16 v[104:107], a[224:227], a[68:71], v[104:107]
    s_waitcnt lgkmcnt(1)
    v_readfirstlane_b32 s41, v30
    v_mfma_f32_16x16x32_bf16 v[108:111], a[204:207], a[72:75], 0
    v_mfma_f32_16x16x32_bf16 v[108:111], a[208:211], a[76:79], v[108:111]
    s_bitcmp1_b32 s41, 5
    s_cbranch_scc0 L_slow5
L_ok5:
    v_mfma_f32_16x16x32_bf16 v[108:111], a[212:215], a[80:83], v[108:111]
    v_cvt_pk_bf16_f32 v200, v104, v105
    v_cvt_pk_bf16_f32 v201, v106, v107
    v_mfma_f32_16x16x32_bf16 v[108:111], a[216:219], a[84:87], v[108:111]
    v_mfma_f32_16x16x32_bf16 v[108:111], a[220:223], a[88:91], v[108:111]
    ds_read_b128 a[192:195], v1 offset:61440
    v_mfma_f32_16x16x32_bf16 v[108:111], a[224:227], a[92:95], v[108:111]
    v_mfma_f32_16x16x32_bf16 v[112:115], a[228:231], a[0:3], 0
    ds_read_b128 a[196:199], v1 offset:62464
    v_mfma_f32_16x16x32_bf16 v[112:115], a[232:235], a[4:7], v[112:115]
    v_mfma_f32_16x16x32_bf16 v[112:115], a[236:239], a[8:11], v[112:115]
    buffer_load_dwordx4 a[144:147], v9, s[8:11], s28 offen offset:0 nt
    v_cvt_pk_bf16_f32 v204, v108, v109
    v_mfma_f32_16x16x32_bf16 v[112:115], a[240:243], a[12:15], v[112:115]
    buffer_load_dwordx4 a[148:151], v10, s[8:11], s28 offen offset:0 nt
    v_cvt_pk_bf16_f32 v205, v110, v111
    v_mfma_f32_16x16x32_bf16 v[112:115], a[244:247], a[16:19], v[112:115]
    ds_read_b128 a[200:203], v1 offset:63488
    s_waitcnt lgkmcnt(3)
    v_mfma_f32_16x16x32_bf16 v[112:115], a[248:251], a[20:23], v[112:115]
    ds_read_b128 a[204:207], v1 offset:64512
    v_mfma_f32_16x16x32_bf16 v[116:119], a[228:231], a[24:27], 0
    ds_read_b128 a[208:211], v2 offset:0
    v_mfma_f32_16x16x32_bf16 v[116:119], a[232:235], a[28:31], v[116:119]
    v_mfma_f32_16x16x32_bf16 v[116:119], a[236:239], a[32:35], v[116:119]
    ds_read_b128 a[212:215], v2 offset:1024
    v_cvt_pk_bf16_f32 v194, v112, v113
    v_mfma_f32_16x16x32_bf16 v[116:119], a[240:243], a[36:39], v[116:119]
    v_cvt_pk_bf16_f32 v195, v114, v115
    v_mfma_f32_16x16x32_bf16 v[116:119], a[244:247], a[40:43], v[116:119]
    v_mfma_f32_16x16x32_bf16 v[116:119], a[248:251], a[44:47], v[116:119]
    v_mfma_f32_16x16x32_bf16 v[120:123], a[228:231], a[48:51], 0
    v_mfma_f32_16x16x32_bf16 v[120:123], a[232:235], a[52:55], v[120:123]
    v_mfma_f32_16x16x32_bf16 v[120:123], a[236:239], a[56:59], v[120:123]
    v_cvt_pk_bf16_f32 v198, v116, v117
    v_cvt_pk_bf16_f32 v199, v118, v119
    v_mfma_f32_16x16x32_bf16 v[120:123], a[240:243], a[60:63], v[120:123]
    v_mfma_f32_16x16x32_bf16 v[120:123], a[244:247], a[64:67], v[120:123]
    v_mfma_f32_16x16x32_bf16 v[120:123], a[248:251], a[68:71], v[120:123]
    v_mfma_f32_16x16x32_bf16 v[124:127], a[228:231], a[72:75], 0
    v_mfma_f32_16x16x32_bf16 v[124:127], a[232:235], a[76:79], v[124:127]
    v_mfma_f32_16x16x32_bf16 v[124:127], a[236:239], a[80:83], v[124:127]
    v_cvt_pk_bf16_f32 v202, v120, v121
    v_cvt_pk_bf16_f32 v203, v122, v123
    v_mfma_f32_16x16x32_bf16 v[124:127], a[240:243], a[84:87], v[124:127]
    v_mfma_f32_16x16x32_bf16 v[124:127], a[244:247], a[88:91], v[124:127]
    ds_read_b128 a[216:219], v2 offset:2048
    v_mfma_f32_16x16x32_bf16 v[124:127], a[248:251], a[92:95], v[124:127]
    s_waitcnt lgkmcnt(1)
    v_mfma_f32_16x16x32_bf16 v[96:99], a[192:195], a[0:3], 0
    buffer_load_dwordx4 a[168:171], v9, s[8:11], s30 offen offset:0 nt
    v_mfma_f32_16x16x32_bf16 v[96:99], a[196:199], a[4:7], v[96:99]
    buffer_load_dwordx4 a[172:175], v10, s[8:11], s30 offen offset:0 nt
    v_mfma_f32_16x16x32_bf16 v[96:99], a[200:203], a[8:11], v[96:99]
    ds_read_b128 a[220:223], v2 offset:3072
    v_cvt_pk_bf16_f32 v206, v124, v125
    v_mfma_f32_16x16x32_bf16 v[96:99], a[204:207], a[12:15], v[96:99]
    ds_read_b128 a[224:227], v2 offset:4096
    v_cvt_pk_bf16_f32 v207, v126, v127
    v_mfma_f32_16x16x32_bf16 v[96:99], a[208:211], a[16:19], v[96:99]
    ds_read_b128 a[228:231], v2 offset:5120
    v_mfma_f32_16x16x32_bf16 v[96:99], a[212:215], a[20:23], v[96:99]
    v_mfma_f32_16x16x32_bf16 v[100:103], a[192:195], a[24:27], 0
    ds_read_b128 a[232:235], v2 offset:6144
    v_mfma_f32_16x16x32_bf16 v[100:103], a[196:199], a[28:31], v[100:103]
    s_waitcnt vmcnt(15)
    ds_write_b64 v4, a[96:97] offset:0
    v_mfma_f32_16x16x32_bf16 v[100:103], a[200:203], a[32:35], v[100:103]
    ds_read_b32 v30, v29
    v_cvt_pk_bf16_f32 v208, v96, v97
    v_mfma_f32_16x16x32_bf16 v[100:103], a[204:207], a[36:39], v[100:103]
    ds_read_b128 a[236:239], v2 offset:7168
    v_cvt_pk_bf16_f32 v209, v98, v99
    v_mfma_f32_16x16x32_bf16 v[100:103], a[208:211], a[40:43], v[100:103]
    ds_write_b64 v4, a[98:99] offset:1024
    v_mfma_f32_16x16x32_bf16 v[100:103], a[212:215], a[44:47], v[100:103]
    s_waitcnt vmcnt(14)
    ds_write_b64 v4, a[100:101] offset:512
    v_mfma_f32_16x16x32_bf16 v[104:107], a[192:195], a[48:51], 0
    ds_write_b64 v4, a[102:103] offset:1536
    v_mfma_f32_16x16x32_bf16 v[104:107], a[196:199], a[52:55], v[104:107]
    ds_read2_b64 a[96:99], v5 offset0:0 offset1:128
    v_mfma_f32_16x16x32_bf16 v[104:107], a[200:203], a[56:59], v[104:107]
    ds_read2_b64 a[100:103], v6 offset0:0 offset1:128
    v_cvt_pk_bf16_f32 v212, v100, v101
    v_mfma_f32_16x16x32_bf16 v[104:107], a[204:207], a[60:63], v[104:107]
    v_cvt_pk_bf16_f32 v213, v102, v103
    v_mfma_f32_16x16x32_bf16 v[104:107], a[208:211], a[64:67], v[104:107]
    v_mfma_f32_16x16x32_bf16 v[104:107], a[212:215], a[68:71], v[104:107]
    s_waitcnt lgkmcnt(6)
    v_readfirstlane_b32 s41, v30
    v_mfma_f32_16x16x32_bf16 v[108:111], a[192:195], a[72:75], 0
    v_mfma_f32_16x16x32_bf16 v[108:111], a[196:199], a[76:79], v[108:111]
    s_andn2_b32 s41, 960, s41
    s_cbranch_scc1 L_slow6
L_ok6:
    v_mfma_f32_16x16x32_bf16 v[108:111], a[200:203], a[80:83], v[108:111]
    v_cvt_pk_bf16_f32 v216, v104, v105
    v_cvt_pk_bf16_f32 v217, v106, v107
    v_mfma_f32_16x16x32_bf16 v[108:111], a[204:207], a[84:87], v[108:111]
    v_mfma_f32_16x16x32_bf16 v[108:111], a[208:211], a[88:91], v[108:111]
    ds_read_b128 a[240:243], v2 offset:8192
    v_mfma_f32_16x16x32_bf16 v[108:111], a[212:215], a[92:95], v[108:111]
    v_mfma_f32_16x16x32_bf16 v[112:115], a[216:219], a[0:3], 0
    ds_read_b128 a[244:247], v2 offset:9216
    v_mfma_f32_16x16x32_bf16 v[112:115], a[220:223], a[4:7], v[112:115]
    v_mfma_f32_16x16x32_bf16 v[112:115], a[224:227], a[8:11], v[112:115]
    ds_read_b128 a[248:251], v2 offset:10240
    v_cvt_pk_bf16_f32 v220, v108, v109
    v_mfma_f32_16x16x32_bf16 v[112:115], a[228:231], a[12:15], v[112:115]
    v_cvt_pk_bf16_f32 v221, v110, v111
    v_mfma_f32_16x16x32_bf16 v[112:115], a[232:235], a[16:19], v[112:115]
    ds_read_b128 a[192:195], v2 offset:11264
    s_waitcnt lgkmcnt(4)
    v_mfma_f32_16x16x32_bf16 v[112:115], a[236:239], a[20:23], v[112:115]
    v_mfma_f32_16x16x32_bf16 v[116:119], a[216:219], a[24:27], 0
    ds_read_b128 a[196:199], v2 offset:12288
    v_mfma_f32_16x16x32_bf16 v[116:119], a[220:223], a[28:31], v[116:119]
    s_waitcnt vmcnt(13)
    ds_write_b64 v4, a[104:105] offset:0
    v_mfma_f32_16x16x32_bf16 v[116:119], a[224:227], a[32:35], v[116:119]
    ds_read_b128 a[200:203], v2 offset:13312
    v_cvt_pk_bf16_f32 v210, v112, v113
    v_mfma_f32_16x16x32_bf16 v[116:119], a[228:231], a[36:39], v[116:119]
    ds_write_b64 v4, a[106:107] offset:1024
    v_mfma_f32_16x16x32_bf16 v[116:119], a[232:235], a[40:43], v[116:119]
    s_waitcnt vmcnt(12)
    ds_write_b64 v4, a[108:109] offset:512
    v_mfma_f32_16x16x32_bf16 v[116:119], a[236:239], a[44:47], v[116:119]
    ds_write_b64 v4, a[110:111] offset:1536
    v_mfma_f32_16x16x32_bf16 v[120:123], a[216:219], a[48:51], 0
    ds_read2_b64 a[104:107], v5 offset0:0 offset1:128
    v_cvt_pk_bf16_f32 v211, v114, v115
    v_mfma_f32_16x16x32_bf16 v[120:123], a[220:223], a[52:55], v[120:123]
    ds_read2_b64 a[108:111], v6 offset0:0 offset1:128
    v_mfma_f32_16x16x32_bf16 v[120:123], a[224:227], a[56:59], v[120:123]
    v_cvt_pk_bf16_f32 v214, v116, v117
    v_cvt_pk_bf16_f32 v215, v118, v119
    v_mfma_f32_16x16x32_bf16 v[120:123], a[228:231], a[60:63], v[120:123]
    v_mfma_f32_16x16x32_bf16 v[120:123], a[232:235], a[64:67], v[120:123]
    v_mfma_f32_16x16x32_bf16 v[120:123], a[236:239], a[68:71], v[120:123]
    v_mfma_f32_16x16x32_bf16 v[124:127], a[216:219], a[72:75], 0
    v_mfma_f32_16x16x32_bf16 v[124:127], a[220:223], a[76:79], v[124:127]
    v_mfma_f32_16x16x32_bf16 v[124:127], a[224:227], a[80:83], v[124:127]
    v_cvt_pk_bf16_f32 v218, v120, v121
    v_cvt_pk_bf16_f32 v219, v122, v123
    v_mfma_f32_16x16x32_bf16 v[124:127], a[228:231], a[84:87], v[124:127]
    v_mfma_f32_16x16x32_bf16 v[124:127], a[232:235], a[88:91], v[124:127]
    v_mfma_f32_16x16x32_bf16 v[124:127], a[236:239], a[92:95], v[124:127]
    s_waitcnt lgkmcnt(4)
    v_mfma_f32_16x16x32_bf16 v[96:99], a[0:3], a[240:243], 0
    v_mfma_f32_16x16x32_bf16 v[96:99], a[4:7], a[244:247], v[96:99]
    v_mfma_f32_16x16x32_bf16 v[96:99], a[8:11], a[248:251], v[96:99]
    v_cvt_pk_bf16_f32 v222, v124, v125
    v_cvt_pk_bf16_f32 v223, v126, v127
    v_mfma_f32_16x16x32_bf16 v[96:99], a[12:15], a[192:195], v[96:99]
    v_mfma_f32_16x16x32_bf16 v[96:99], a[16:19], a[196:199], v[96:99]
    v_mfma_f32_16x16x32_bf16 v[96:99], a[20:23], a[200:203], v[96:99]
    v_mfma_f32_16x16x32_bf16 v[100:103], a[24:27], a[240:243], 0
    v_mfma_f32_16x16x32_bf16 v[100:103], a[28:31], a[244:247], v[100:103]
    v_mfma_f32_16x16x32_bf16 v[100:103], a[32:35], a[248:251], v[100:103]
    s_waitcnt vmcnt(11)
    ds_write_b64 v4, a[112:113] offset:0
    v_mfma_f32_16x16x32_bf16 v[100:103], a[36:39], a[192:195], v[100:103]
    ds_write_b64 v4, a[114:115] offset:1024
    v_mfma_f32_16x16x32_bf16 v[100:103], a[40:43], a[196:199], v[100:103]
    s_waitcnt vmcnt(10)
    ds_write_b64 v4, a[116:117] offset:512
    v_mfma_f32_16x16x32_bf16 v[100:103], a[44:47], a[200:203], v[100:103]
    ds_write_b64 v4, a[118:119] offset:1536
    v_mfma_f32_16x16x32_bf16 v[32:35], a[16:19], v[192:195], v[32:35]
    ds_read2_b64 a[112:115], v5 offset0:0 offset1:128
    v_cvt_pk_bf16_f32 v128, v96, v97
    v_mfma_f32_16x16x32_bf16 v[32:35], a[20:23], v[208:211], v[32:35]
    ds_read2_b64 a[116:119], v6 offset0:0 offset1:128
    v_cvt_pk_bf16_f32 v129, v98, v99
    v_mfma_f32_16x16x32_bf16 v[36:39], a[40:43], v[192:195], v[36:39]
    v_cvt_pk_bf16_f32 v130, v100, v101
    v_cvt_pk_bf16_f32 v131, v102, v103
    v_mfma_f32_16x16x32_bf16 v[36:39], a[44:47], v[208:211], v[36:39]
L_loop:
    v_mfma_f32_16x16x32_bf16 v[40:43], a[64:67], v[192:195], v[40:43]
    v_max3_f32 v12, v32, v33, v34
    v_mfma_f32_16x16x32_bf16 v[40:43], a[68:71], v[208:211], v[40:43]
    v_mfma_f32_16x16x32_bf16 v[44:47], a[88:91], v[192:195], v[44:47]
    v_max3_f32 v12, v12, v35, v36
    v_max3_f32 v12, v12, v37, v38
    v_mfma_f32_16x16x32_bf16 v[44:47], a[92:95], v[208:211], v[44:47]
    v_mfma_f32_16x16x32_bf16 v[48:51], a[16:19], v[196:199], v[48:51]
    v_max3_f32 v12, v12, v39, v40
    v_max3_f32 v12, v12, v41, v42
    v_mfma_f32_16x16x32_bf16 v[48:51], a[20:23], v[212:215], v[48:51]
    v_mfma_f32_16x16x32_bf16 v[52:55], a[40:43], v[196:199], v[52:55]
    v_max3_f32 v12, v12, v43, v44
    v_max3_f32 v12, v12, v45, v46
    v_mfma_f32_16x16x32_bf16 v[52:55], a[44:47], v[212:215], v[52:55]
    v_max_f32 v12, v12, v47
    v_mfma_f32_16x16x32_bf16 v[56:59], a[64:67], v[196:199], v[56:59]
    v_max3_f32 v13, v48, v49, v50
    v_mfma_f32_16x16x32_bf16 v[56:59], a[68:71], v[212:215], v[56:59]
    v_mfma_f32_16x16x32_bf16 v[60:63], a[88:91], v[196:199], v[60:63]
    v_max3_f32 v13, v13, v51, v52
    v_max3_f32 v13, v13, v53, v54
    v_mfma_f32_16x16x32_bf16 v[60:63], a[92:95], v[212:215], v[60:63]
    v_mfma_f32_16x16x32_bf16 v[64:67], a[16:19], v[200:203], v[64:67]
    v_max3_f32 v13, v13, v55, v56
    v_max3_f32 v13, v13, v57, v58
    v_mfma_f32_16x16x32_bf16 v[64:67], a[20:23], v[216:219], v[64:67]
    v_mfma_f32_16x16x32_bf16 v[68:71], a[40:43], v[200:203], v[68:71]
    ds_read_b128 a[204:207], v2 offset:14336
    v_max3_f32 v13, v13, v59, v60
    v_mfma_f32_16x16x32_bf16 v[68:71], a[44:47], v[216:219], v[68:71]
    v_max3_f32 v13, v13, v61, v62
    v_max_f32 v13, v13, v63
    v_mfma_f32_16x16x32_bf16 v[72:75], a[64:67], v[200:203], v[72:75]
    ds_read_b128 a[208:211], v2 offset:15360
    v_max3_f32 v14, v64, v65, v66
    v_mfma_f32_16x16x32_bf16 v[72:75], a[68:71], v[216:219], v[72:75]
    v_permlane16_swap_b32 v12, v13
    v_max_f32 v12, v12, v13
    v_mfma_f32_16x16x32_bf16 v[76:79], a[88:91], v[200:203], v[76:79]
    ds_read_b128 a[212:215], v2 offset:16384
    v_max3_f32 v14, v14, v67, v68
    v_mfma_f32_16x16x32_bf16 v[76:79], a[92:95], v[216:219], v[76:79]
    v_max3_f32 v14, v14, v69, v70
    v_mfma_f32_16x16x32_bf16 v[80:83], a[16:19], v[204:207], v[80:83]
    ds_read_b128 a[216:219], v2 offset:17408
    v_max3_f32 v14, v14, v71, v72
    v_mfma_f32_16x16x32_bf16 v[80:83], a[20:23], v[220:223], v[80:83]
    v_max3_f32 v14, v14, v73, v74
    v_mfma_f32_16x16x32_bf16 v[84:87], a[40:43], v[204:207], v[84:87]
    ds_read_b128 a[220:223], v2 offset:18432
    v_max3_f32 v14, v14, v75, v76
    v_mfma_f32_16x16x32_bf16 v[84:87], a[44:47], v[220:223], v[84:87]
    v_max3_f32 v14, v14, v77, v78
    v_max_f32 v14, v14, v79
    v_mfma_f32_16x16x32_bf16 v[88:91], a[64:67], v[204:207], v[88:91]
    ds_read_b128 a[224:227], v2 offset:19456
    v_max3_f32 v15, v80, v81, v82
    v_mfma_f32_16x16x32_bf16 v[88:91], a[68:71], v[220:223], v[88:91]
    v_mfma_f32_16x16x32_bf16 v[92:95], a[88:91], v[204:207], v[92:95]
    v_max3_f32 v15, v15, v83, v84
    v_max3_f32 v15, v15, v85, v86
    v_mfma_f32_16x16x32_bf16 v[92:95], a[92:95], v[220:223], v[92:95]
    v_mfma_f32_16x16x32_bf16 v[104:107], a[48:51], a[240:243], 0
    v_max3_f32 v15, v15, v87, v88
    v_max3_f32 v15, v15, v89, v90
    v_mfma_f32_16x16x32_bf16 v[104:107], a[52:55], a[244:247], v[104:107]
    v_mfma_f32_16x16x32_bf16 v[104:107], a[56:59], a[248:251], v[104:107]
    v_max3_f32 v15, v15, v91, v92
    v_max3_f32 v15, v15, v93, v94
    v_mfma_f32_16x16x32_bf16 v[104:107], a[60:63], a[192:195], v[104:107]
    v_max_f32 v15, v15, v95
    v_mfma_f32_16x16x32_bf16 v[104:107], a[64:67], a[196:199], v[104:107]
    v_mfma_f32_16x16x32_bf16 v[104:107], a[68:71], a[200:203], v[104:107]
    v_permlane16_swap_b32 v14, v15
    v_max_f32 v14, v14, v15
    v_mfma_f32_16x16x32_bf16 v[108:111], a[72:75], a[240:243], 0
    v_mfma_f32_16x16x32_bf16 v[108:111], a[76:79], a[244:247], v[108:111]
    v_permlane32_swap_b32 v12, v14
    v_max_f32 v12, v12, v14
    v_mfma_f32_16x16x32_bf16 v[108:111], a[80:83], a[248:251], v[108:111]
    v_cvt_pk_bf16_f32 v132, v104, v105
    v_cvt_pk_bf16_f32 v133, v106, v107
    v_mfma_f32_16x16x32_bf16 v[108:111], a[84:87], a[192:195], v[108:111]
    v_mov_b32 v14, v12
    v_mfma_f32_16x16x32_bf16 v[108:111], a[88:91], a[196:199], v[108:111]
    ds_read_b128 a[228:231], v2 offset:20480
    v_permlane32_swap_b32 v12, v14
    v_mfma_f32_16x16x32_bf16 v[108:111], a[92:95], a[200:203], v[108:111]
    v_mov_b32 v13, v12
    s_waitcnt lgkmcnt(1)
    v_mfma_f32_16x16x32_bf16 v[112:115], a[0:3], a[204:207], 0
    ds_read_b128 a[232:235], v2 offset:21504
    v_mov_b32 v15, v14
    v_mfma_f32_16x16x32_bf16 v[112:115], a[4:7], a[208:211], v[112:115]
    v_permlane16_swap_b32 v12, v13
    v_permlane16_swap_b32 v14, v15
    v_mfma_f32_16x16x32_bf16 v[112:115], a[8:11], a[212:215], v[112:115]
    ds_read_b128 a[236:239], v2 offset:22528
    v_cvt_pk_bf16_f32 v134, v108, v109
    v_mfma_f32_16x16x32_bf16 v[112:115], a[12:15], a[216:219], v[112:115]
    v_cvt_pk_bf16_f32 v135, v110, v111
    v_sub_f32 v32, v32, v12
    v_mfma_f32_16x16x32_bf16 v[112:115], a[16:19], a[220:223], v[112:115]
    ds_read_b128 a[240:243], v2 offset:23552
    v_sub_f32 v33, v33, v12
    v_mfma_f32_16x16x32_bf16 v[112:115], a[20:23], a[224:227], v[112:115]
    v_sub_f32 v48, v48, v13
    v_sub_f32 v49, v49, v13
    v_mfma_f32_16x16x32_bf16 v[116:119], a[24:27], a[204:207], 0
    ds_read_b128 a[244:247], v2 offset:24576
    v_sub_f32 v64, v64, v14
    v_mfma_f32_16x16x32_bf16 v[116:119], a[28:31], a[208:211], v[116:119]
    v_sub_f32 v65, v65, v14
    v_sub_f32 v80, v80, v15
    v_mfma_f32_16x16x32_bf16 v[116:119], a[32:35], a[212:215], v[116:119]
    ds_read_b128 a[248:251], v2 offset:25600
    v_cvt_pk_bf16_f32 v136, v112, v113
    v_mfma_f32_16x16x32_bf16 v[116:119], a[36:39], a[216:219], v[116:119]
    v_cvt_pk_bf16_f32 v137, v114, v115
    v_sub_f32 v81, v81, v15
    v_mfma_f32_16x16x32_bf16 v[116:119], a[40:43], a[220:223], v[116:119]
    v_exp_f32 v32, v32
    v_mfma_f32_16x16x32_bf16 v[116:119], a[44:47], a[224:227], v[116:119]
    v_exp_f32 v33, v33
    v_mfma_f32_16x16x32_bf16 v[120:123], a[48:51], a[204:207], 0
    v_sub_f32 v34, v34, v12
    v_sub_f32 v50, v50, v13
    v_mfma_f32_16x16x32_bf16 v[120:123], a[52:55], a[208:211], v[120:123]
    v_exp_f32 v48, v48
    v_mfma_f32_16x16x32_bf16 v[120:123], a[56:59], a[212:215], v[120:123]
    buffer_load_dwordx4 a[152:155], v9, s[8:11], s28 offen offset:128 nt
    v_cvt_pk_bf16_f32 v138, v116, v117
    v_mfma_f32_16x16x32_bf16 v[120:123], a[60:63], a[216:219], v[120:123]
    buffer_load_dwordx4 a[156:159], v10, s[8:11], s28 offen offset:128 nt
    v_cvt_pk_bf16_f32 v139, v118, v119
    v_mfma_f32_16x16x32_bf16 v[120:123], a[64:67], a[220:223], v[120:123]
    v_exp_f32 v49, v49
    v_mfma_f32_16x16x32_bf16 v[120:123], a[68:71], a[224:227], v[120:123]
    v_exp_f32 v64, v64
    v_mfma_f32_16x16x32_bf16 v[124:127], a[72:75], a[204:207], 0
    v_exp_f32 v65, v65
    v_mfma_f32_16x16x32_bf16 v[124:127], a[76:79], a[208:211], v[124:127]
    v_sub_f32 v66, v66, v14
    v_sub_f32 v82, v82, v15
    v_mfma_f32_16x16x32_bf16 v[124:127], a[80:83], a[212:215], v[124:127]
    v_cvt_pk_bf16_f32 v140, v120, v121
    v_cvt_pk_bf16_f32 v141, v122, v123
    v_mfma_f32_16x16x32_bf16 v[124:127], a[84:87], a[216:219], v[124:127]
    v_exp_f32 v80, v80
    v_mfma_f32_16x16x32_bf16 v[124:127], a[88:91], a[220:223], v[124:127]
    ds_read_b128 a[192:195], v2 offset:26624
    v_sub_f32 v35, v35, v12
    v_mfma_f32_16x16x32_bf16 v[124:127], a[92:95], a[224:227], v[124:127]
    v_sub_f32 v51, v51, v13
    s_waitcnt lgkmcnt(1)
    v_mfma_f32_16x16x32_bf16 v[96:99], a[0:3], a[228:231], 0
    ds_read_b128 a[196:199], v2 offset:27648
    v_sub_f32 v67, v67, v14
    v_mfma_f32_16x16x32_bf16 v[96:99], a[4:7], a[232:235], v[96:99]
    v_exp_f32 v81, v81
    v_mfma_f32_16x16x32_bf16 v[96:99], a[8:11], a[236:239], v[96:99]
    ds_read_b128 a[200:203], v2 offset:28672
    v_cvt_pk_bf16_f32 v142, v124, v125
    v_mfma_f32_16x16x32_bf16 v[96:99], a[12:15], a[240:243], v[96:99]
    v_cvt_pk_bf16_f32 v143, v126, v127
    v_sub_f32 v83, v83, v15
    v_mfma_f32_16x16x32_bf16 v[96:99], a[16:19], a[244:247], v[96:99]
    ds_read_b128 a[204:207], v2 offset:29696
    v_sub_f32 v36, v36, v12
    v_mfma_f32_16x16x32_bf16 v[96:99], a[20:23], a[248:251], v[96:99]
    v_exp_f32 v34, v34
    v_mfma_f32_16x16x32_bf16 v[100:103], a[24:27], a[228:231], 0
    ds_read_b128 a[208:211], v2 offset:30720
    v_sub_f32 v52, v52, v13
    v_mfma_f32_16x16x32_bf16 v[100:103], a[28:31], a[232:235], v[100:103]
    v_exp_f32 v50, v50
    v_mfma_f32_16x16x32_bf16 v[100:103], a[32:35], a[236:239], v[100:103]
    ds_read_b128 a[212:215], v2 offset:31744
    v_cvt_pk_bf16_f32 v144, v96, v97
    v_mfma_f32_16x16x32_bf16 v[100:103], a[36:39], a[240:243], v[100:103]
    v_cvt_pk_bf16_f32 v145, v98, v99
    v_sub_f32 v68, v68, v14
    v_mfma_f32_16x16x32_bf16 v[100:103], a[40:43], a[244:247], v[100:103]
    v_exp_f32 v66, v66
    v_mfma_f32_16x16x32_bf16 v[100:103], a[44:47], a[248:251], v[100:103]
    v_exp_f32 v82, v82
    v_mfma_f32_16x16x32_bf16 v[104:107], a[48:51], a[228:231], 0
    v_exp_f32 v35, v35
    v_mfma_f32_16x16x32_bf16 v[104:107], a[52:55], a[232:235], v[104:107]
    v_exp_f32 v51, v51
    v_mfma_f32_16x16x32_bf16 v[104:107], a[56:59], a[236:239], v[104:107]
    v_cvt_pk_bf16_f32 v146, v100, v101
    v_cvt_pk_bf16_f32 v147, v102, v103
    v_mfma_f32_16x16x32_bf16 v[104:107], a[60:63], a[240:243], v[104:107]
    v_exp_f32 v67, v67
    v_mfma_f32_16x16x32_bf16 v[104:107], a[64:67], a[244:247], v[104:107]
    v_exp_f32 v83, v83
    v_mfma_f32_16x16x32_bf16 v[104:107], a[68:71], a[248:251], v[104:107]
    v_sub_f32 v84, v84, v15
    v_add_f32 v20, v32, v33
    v_mfma_f32_16x16x32_bf16 v[108:111], a[72:75], a[228:231], 0
    v_exp_f32 v36, v36
    v_mfma_f32_16x16x32_bf16 v[108:111], a[76:79], a[232:235], v[108:111]
    v_sub_f32 v37, v37, v12
    v_add_f32 v21, v48, v49
    v_mfma_f32_16x16x32_bf16 v[108:111], a[80:83], a[236:239], v[108:111]
    v_cvt_pk_bf16_f32 v148, v104, v105
    v_cvt_pk_bf16_f32 v149, v106, v107
    v_mfma_f32_16x16x32_bf16 v[108:111], a[84:87], a[240:243], v[108:111]
    v_exp_f32 v52, v52
    v_mfma_f32_16x16x32_bf16 v[108:111], a[88:91], a[244:247], v[108:111]
    ds_read_b128 a[216:219], v2 offset:32768
    v_sub_f32 v53, v53, v13
    v_mfma_f32_16x16x32_bf16 v[108:111], a[92:95], a[248:251], v[108:111]
    v_add_f32 v22, v64, v65
    s_waitcnt lgkmcnt(1)
    v_mfma_f32_16x16x32_bf16 v[112:115], a[0:3], a[192:195], 0
    ds_read_b128 a[220:223], v2 offset:33792
    v_sub_f32 v69, v69, v14
    v_mfma_f32_16x16x32_bf16 v[112:115], a[4:7], a[196:199], v[112:115]
    v_exp_f32 v68, v68
    v_mfma_f32_16x16x32_bf16 v[112:115], a[8:11], a[200:203], v[112:115]
    ds_read_b128 a[224:227], v2 offset:34816
    v_cvt_pk_bf16_f32 v150, v108, v109
    v_mfma_f32_16x16x32_bf16 v[112:115], a[12:15], a[204:207], v[112:115]
    v_cvt_pk_bf16_f32 v151, v110, v111
    v_add_f32 v23, v80, v81
    v_mfma_f32_16x16x32_bf16 v[112:115], a[16:19], a[208:211], v[112:115]
    ds_read_b128 a[228:231], v2 offset:35840
    v_sub_f32 v85, v85, v15
    v_mfma_f32_16x16x32_bf16 v[112:115], a[20:23], a[212:215], v[112:115]
    v_exp_f32 v84, v84
    v_mfma_f32_16x16x32_bf16 v[116:119], a[24:27], a[192:195], 0
    ds_read_b128 a[232:235], v2 offset:36864
    v_add_f32 v20, v20, v34
    v_mfma_f32_16x16x32_bf16 v[116:119], a[28:31], a[196:199], v[116:119]
    v_exp_f32 v37, v37
    v_mfma_f32_16x16x32_bf16 v[116:119], a[32:35], a[200:203], v[116:119]
    ds_read_b128 a[236:239], v2 offset:37888
    v_cvt_pk_bf16_f32 v152, v112, v113
    v_mfma_f32_16x16x32_bf16 v[116:119], a[36:39], a[204:207], v[116:119]
    v_cvt_pk_bf16_f32 v153, v114, v115
    v_sub_f32 v38, v38, v12
    v_mfma_f32_16x16x32_bf16 v[116:119], a[40:43], a[208:211], v[116:119]
    v_add_f32 v21, v21, v50
    v_sub_f32 v54, v54, v13
    v_mfma_f32_16x16x32_bf16 v[116:119], a[44:47], a[212:215], v[116:119]
    v_exp_f32 v53, v53
    v_mfma_f32_16x16x32_bf16 v[120:123], a[48:51], a[192:195], 0
    v_add_f32 v22, v22, v66
    v_sub_f32 v70, v70, v14
    v_mfma_f32_16x16x32_bf16 v[120:123], a[52:55], a[196:199], v[120:123]
    v_exp_f32 v69, v69
    v_mfma_f32_16x16x32_bf16 v[120:123], a[56:59], a[200:203], v[120:123]
    v_cvt_pk_bf16_f32 v154, v116, v117
    v_cvt_pk_bf16_f32 v155, v118, v119
    v_mfma_f32_16x16x32_bf16 v[120:123], a[60:63], a[204:207], v[120:123]
    v_add_f32 v23, v23, v82
    v_sub_f32 v86, v86, v15
    v_mfma_f32_16x16x32_bf16 v[120:123], a[64:67], a[208:211], v[120:123]
    v_exp_f32 v85, v85
    v_mfma_f32_16x16x32_bf16 v[120:123], a[68:71], a[212:215], v[120:123]
    v_add_f32 v20, v20, v35
    v_sub_f32 v39, v39, v12
    v_mfma_f32_16x16x32_bf16 v[124:127], a[72:75], a[192:195], 0
    v_exp_f32 v38, v38
    v_mfma_f32_16x16x32_bf16 v[124:127], a[76:79], a[196:199], v[124:127]
    v_add_f32 v21, v21, v51
    v_sub_f32 v55, v55, v13
    v_mfma_f32_16x16x32_bf16 v[124:127], a[80:83], a[200:203], v[124:127]
    v_cvt_pk_bf16_f32 v156, v120, v121
    v_cvt_pk_bf16_f32 v157, v122, v123
    v_mfma_f32_16x16x32_bf16 v[124:127], a[84:87], a[204:207], v[124:127]
    v_exp_f32 v54, v54
    v_mfma_f32_16x16x32_bf16 v[124:127], a[88:91], a[208:211], v[124:127]
    buffer_load_dwordx4 a[176:179], v9, s[8:11], s30 offen offset:128 nt
    v_add_f32 v22, v22, v67
    v_mfma_f32_16x16x32_bf16 v[124:127], a[92:95], a[212:215], v[124:127]
    buffer_load_dwordx4 a[180:183], v10, s[8:11], s30 offen offset:128 nt
    s_waitcnt lgkmcnt(0)
    v_mfma_f32_16x16x32_bf16 v[96:99], a[0:3], a[216:219], 0
    ds_read_b128 a[240:243], v2 offset:38912
    v_sub_f32 v71, v71, v14
    v_mfma_f32_16x16x32_bf16 v[96:99], a[4:7], a[220:223], v[96:99]
    ds_read_b128 a[244:247], v2 offset:39936
    v_add_f32 v23, v23, v83
    v_mfma_f32_16x16x32_bf16 v[96:99], a[8:11], a[224:227], v[96:99]
    ds_read_b128 a[248:251], v2 offset:40960
    v_cvt_pk_bf16_f32 v158, v124, v125
    v_mfma_f32_16x16x32_bf16 v[96:99], a[12:15], a[228:231], v[96:99]
    v_cvt_pk_bf16_f32 v159, v126, v127
    v_sub_f32 v87, v87, v15
    v_mfma_f32_16x16x32_bf16 v[96:99], a[16:19], a[232:235], v[96:99]
    ds_read_b128 a[192:195], v2 offset:41984
    v_add_f32 v20, v20, v36
    v_mfma_f32_16x16x32_bf16 v[96:99], a[20:23], a[236:239], v[96:99]
    v_exp_f32 v70, v70
    v_mfma_f32_16x16x32_bf16 v[100:103], a[24:27], a[216:219], 0
    ds_read_b128 a[196:199], v2 offset:43008
    v_sub_f32 v40, v40, v12
    v_mfma_f32_16x16x32_bf16 v[100:103], a[28:31], a[220:223], v[100:103]
    v_exp_f32 v86, v86
    v_mfma_f32_16x16x32_bf16 v[100:103], a[32:35], a[224:227], v[100:103]
    ds_read_b128 a[200:203], v2 offset:44032
    v_cvt_pk_bf16_f32 v160, v96, v97
    v_mfma_f32_16x16x32_bf16 v[100:103], a[36:39], a[228:231], v[100:103]
    v_cvt_pk_bf16_f32 v161, v98, v99
    v_add_f32 v21, v21, v52
    v_mfma_f32_16x16x32_bf16 v[100:103], a[40:43], a[232:235], v[100:103]
    v_exp_f32 v39, v39
    v_mfma_f32_16x16x32_bf16 v[100:103], a[44:47], a[236:239], v[100:103]
    v_exp_f32 v55, v55
    v_mfma_f32_16x16x32_bf16 v[104:107], a[48:51], a[216:219], 0
    v_sub_f32 v56, v56, v13
    v_add_f32 v22, v22, v68
    v_mfma_f32_16x16x32_bf16 v[104:107], a[52:55], a[220:223], v[104:107]
    v_exp_f32 v71, v71
    v_mfma_f32_16x16x32_bf16 v[104:107], a[56:59], a[224:227], v[104:107]
    v_cvt_pk_bf16_f32 v162, v100, v101
    v_cvt_pk_bf16_f32 v163, v102, v103
    v_mfma_f32_16x16x32_bf16 v[104:107], a[60:63], a[228:231], v[104:107]
    v_sub_f32 v72, v72, v14
    v_add_f32 v23, v23, v84
    v_mfma_f32_16x16x32_bf16 v[104:107], a[64:67], a[232:235], v[104:107]
    v_exp_f32 v87, v87
    v_mfma_f32_16x16x32_bf16 v[104:107], a[68:71], a[236:239], v[104:107]
    v_sub_f32 v88, v88, v15
    v_add_f32 v20, v20, v37
    v_mfma_f32_16x16x32_bf16 v[108:111], a[72:75], a[216:219], 0
    v_exp_f32 v40, v40
    v_mfma_f32_16x16x32_bf16 v[108:111], a[76:79], a[220:223], v[108:111]
    v_sub_f32 v41, v41, v12
    v_add_f32 v21, v21, v53
    v_mfma_f32_16x16x32_bf16 v[108:111], a[80:83], a[224:227], v[108:111]
    v_cvt_pk_bf16_f32 v164, v104, v105
    v_cvt_pk_bf16_f32 v165, v106, v107
    v_mfma_f32_16x16x32_bf16 v[108:111], a[84:87], a[228:231], v[108:111]
    v_exp_f32 v56, v56
    v_mfma_f32_16x16x32_bf16 v[108:111], a[88:91], a[232:235], v[108:111]
    ds_read_b128 a[204:207], v2 offset:45056
    v_sub_f32 v57, v57, v13
    v_mfma_f32_16x16x32_bf16 v[108:111], a[92:95], a[236:239], v[108:111]
    v_add_f32 v22, v22, v69
    s_waitcnt lgkmcnt(1)
    v_mfma_f32_16x16x32_bf16 v[112:115], a[0:3], a[240:243], 0
    ds_read_b128 a[208:211], v2 offset:46080
    v_sub_f32 v73, v73, v14
    v_mfma_f32_16x16x32_bf16 v[112:115], a[4:7], a[244:247], v[112:115]
    v_exp_f32 v72, v72
    v_mfma_f32_16x16x32_bf16 v[112:115], a[8:11], a[248:251], v[112:115]
    ds_read_b128 a[212:215], v2 offset:47104
    v_cvt_pk_bf16_f32 v166, v108, v109
    v_mfma_f32_16x16x32_bf16 v[112:115], a[12:15], a[192:195], v[112:115]
    v_cvt_pk_bf16_f32 v167, v110, v111
    v_add_f32 v23, v23, v85
    v_mfma_f32_16x16x32_bf16 v[112:115], a[16:19], a[196:199], v[112:115]
    ds_read_b128 a[216:219], v2 offset:48128
    v_sub_f32 v89, v89, v15
    v_mfma_f32_16x16x32_bf16 v[112:115], a[20:23], a[200:203], v[112:115]
    v_exp_f32 v88, v88
    v_mfma_f32_16x16x32_bf16 v[116:119], a[24:27], a[240:243], 0
    ds_read_b128 a[220:223], v2 offset:49152
    v_add_f32 v20, v20, v38
    v_mfma_f32_16x16x32_bf16 v[116:119], a[28:31], a[244:247], v[116:119]
    v_exp_f32 v41, v41
    v_mfma_f32_16x16x32_bf16 v[116:119], a[32:35], a[248:251], v[116:119]
    ds_read_b128 a[224:227], v2 offset:50176
    v_cvt_pk_bf16_f32 v168, v112, v113
    v_mfma_f32_16x16x32_bf16 v[116:119], a[36:39], a[192:195], v[116:119]
    v_cvt_pk_bf16_f32 v169, v114, v115
    v_sub_f32 v42, v42, v12
    v_mfma_f32_16x16x32_bf16 v[116:119], a[40:43], a[196:199], v[116:119]
    v_add_f32 v21, v21, v54
    v_sub_f32 v58, v58, v13
    v_mfma_f32_16x16x32_bf16 v[116:119], a[44:47], a[200:203], v[116:119]
    v_exp_f32 v57, v57
    v_mfma_f32_16x16x32_bf16 v[120:123], a[48:51], a[240:243], 0
    v_add_f32 v22, v22, v70
    v_sub_f32 v74, v74, v14
    v_mfma_f32_16x16x32_bf16 v[120:123], a[52:55], a[244:247], v[120:123]
    v_exp_f32 v73, v73
    v_mfma_f32_16x16x32_bf16 v[120:123], a[56:59], a[248:251], v[120:123]
    v_cvt_pk_bf16_f32 v170, v116, v117
    v_cvt_pk_bf16_f32 v171, v118, v119
    v_mfma_f32_16x16x32_bf16 v[120:123], a[60:63], a[192:195], v[120:123]
    v_add_f32 v23, v23, v86
    v_sub_f32 v90, v90, v15
    v_mfma_f32_16x16x32_bf16 v[120:123], a[64:67], a[196:199], v[120:123]
    v_exp_f32 v89, v89
    v_mfma_f32_16x16x32_bf16 v[120:123], a[68:71], a[200:203], v[120:123]
    v_add_f32 v20, v20, v39
    v_sub_f32 v43, v43, v12
    v_mfma_f32_16x16x32_bf16 v[124:127], a[72:75], a[240:243], 0
    v_exp_f32 v42, v42
    v_mfma_f32_16x16x32_bf16 v[124:127], a[76:79], a[244:247], v[124:127]
    v_add_f32 v21, v21, v55
    v_sub_f32 v59, v59, v13
    v_mfma_f32_16x16x32_bf16 v[124:127], a[80:83], a[248:251], v[124:127]
    v_cvt_pk_bf16_f32 v172, v120, v121
    v_cvt_pk_bf16_f32 v173, v122, v123
    v_mfma_f32_16x16x32_bf16 v[124:127], a[84:87], a[192:195], v[124:127]
    v_exp_f32 v58, v58
    v_mfma_f32_16x16x32_bf16 v[124:127], a[88:91], a[196:199], v[124:127]
    ds_read_b128 a[228:231], v2 offset:51200
    v_add_f32 v22, v22, v71
    v_mfma_f32_16x16x32_bf16 v[124:127], a[92:95], a[200:203], v[124:127]
    v_sub_f32 v75, v75, v14
    s_waitcnt lgkmcnt(1)
    v_mfma_f32_16x16x32_bf16 v[96:99], a[0:3], a[204:207], 0
    ds_read_b128 a[232:235], v2 offset:52224
    v_add_f32 v23, v23, v87
    v_mfma_f32_16x16x32_bf16 v[96:99], a[4:7], a[208:211], v[96:99]
    v_exp_f32 v74, v74
    v_mfma_f32_16x16x32_bf16 v[96:99], a[8:11], a[212:215], v[96:99]
    ds_read_b128 a[236:239], v2 offset:53248
    v_cvt_pk_bf16_f32 v174, v124, v125
    v_mfma_f32_16x16x32_bf16 v[96:99], a[12:15], a[216:219], v[96:99]
    v_cvt_pk_bf16_f32 v175, v126, v127
    v_sub_f32 v91, v91, v15
    v_mfma_f32_16x16x32_bf16 v[96:99], a[16:19], a[220:223], v[96:99]
    ds_read_b128 a[240:243], v2 offset:54272
    v_add_f32 v20, v20, v40
    v_mfma_f32_16x16x32_bf16 v[96:99], a[20:23], a[224:227], v[96:99]
    v_exp_f32 v90, v90
    v_mfma_f32_16x16x32_bf16 v[100:103], a[24:27], a[204:207], 0
    buffer_load_dwordx4 a[160:163], v9, s[8:11], s28 offen offset:256 nt
    v_sub_f32 v44, v44, v12
    v_mfma_f32_16x16x32_bf16 v[100:103], a[28:31], a[208:211], v[100:103]
    buffer_load_dwordx4 a[164:167], v10, s[8:11], s28 offen offset:256 nt
    v_add_f32 v21, v21, v56
    v_mfma_f32_16x16x32_bf16 v[100:103], a[32:35], a[212:215], v[100:103]
    ds_read_b128 a[244:247], v2 offset:55296
    v_cvt_pk_bf16_f32 v176, v96, v97
    v_mfma_f32_16x16x32_bf16 v[100:103], a[36:39], a[216:219], v[100:103]
    ds_read_b128 a[248:251], v2 offset:56320
    v_cvt_pk_bf16_f32 v177, v98, v99
    v_mfma_f32_16x16x32_bf16 v[100:103], a[40:43], a[220:223], v[100:103]
    v_exp_f32 v43, v43
    v_mfma_f32_16x16x32_bf16 v[100:103], a[44:47], a[224:227], v[100:103]
    v_exp_f32 v59, v59
    v_mfma_f32_16x16x32_bf16 v[104:107], a[48:51], a[204:207], 0
    v_sub_f32 v60, v60, v13
    v_add_f32 v22, v22, v72
    v_mfma_f32_16x16x32_bf16 v[104:107], a[52:55], a[208:211], v[104:107]
    v_exp_f32 v75, v75
    v_mfma_f32_16x16x32_bf16 v[104:107], a[56:59], a[212:215], v[104:107]
    v_cvt_pk_bf16_f32 v178, v100, v101
    v_cvt_pk_bf16_f32 v179, v102, v103
    v_mfma_f32_16x16x32_bf16 v[104:107], a[60:63], a[216:219], v[104:107]
    v_sub_f32 v76, v76, v14
    v_add_f32 v23, v23, v88
    v_mfma_f32_16x16x32_bf16 v[104:107], a[64:67], a[220:223], v[104:107]
    v_exp_f32 v91, v91
    v_mfma_f32_16x16x32_bf16 v[104:107], a[68:71], a[224:227], v[104:107]
    v_sub_f32 v92, v92, v15
    v_add_f32 v20, v20, v41
    v_mfma_f32_16x16x32_bf16 v[108:111], a[72:75], a[204:207], 0
    v_exp_f32 v44, v44
    v_mfma_f32_16x16x32_bf16 v[108:111], a[76:79], a[208:211], v[108:111]
    v_sub_f32 v45, v45, v12
    v_add_f32 v21, v21, v57
    v_mfma_f32_16x16x32_bf16 v[108:111], a[80:83], a[212:215], v[108:111]
    v_cvt_pk_bf16_f32 v180, v104, v105
    v_cvt_pk_bf16_f32 v181, v106, v107
    v_mfma_f32_16x16x32_bf16 v[108:111], a[84:87], a[216:219], v[108:111]
    v_exp_f32 v60, v60
    v_mfma_f32_16x16x32_bf16 v[108:111], a[88:91], a[220:223], v[108:111]
    ds_read_b128 a[192:195], v2 offset:57344
    v_sub_f32 v61, v61, v13
    v_mfma_f32_16x16x32_bf16 v[108:111], a[92:95], a[224:227], v[108:111]
    v_add_f32 v22, v22, v73
    s_waitcnt lgkmcnt(1)
    v_mfma_f32_16x16x32_bf16 v[112:115], a[0:3], a[228:231], 0
    ds_read_b128 a[196:199], v2 offset:58368
    v_sub_f32 v77, v77, v14
    v_mfma_f32_16x16x32_bf16 v[112:115], a[4:7], a[232:235], v[112:115]
    v_exp_f32 v76, v76
    v_mfma_f32_16x16x32_bf16 v[112:115], a[8:11], a[236:239], v[112:115]
    ds_read_b128 a[200:203], v2 offset:59392
    v_cvt_pk_bf16_f32 v182, v108, v109
    v_mfma_f32_16x16x32_bf16 v[112:115], a[12:15], a[240:243], v[112:115]
    v_cvt_pk_bf16_f32 v183, v110, v111
    v_add_f32 v23, v23, v89
    v_mfma_f32_16x16x32_bf16 v[112:115], a[16:19], a[244:247], v[112:115]
    ds_read_b128 a[204:207], v2 offset:60416
    v_sub_f32 v93, v93, v15
    v_mfma_f32_16x16x32_bf16 v[112:115], a[20:23], a[248:251], v[112:115]
    v_exp_f32 v92, v92
    v_mfma_f32_16x16x32_bf16 v[116:119], a[24:27], a[228:231], 0
    ds_read_b128 a[208:211], v2 offset:61440
    v_add_f32 v20, v20, v42
    v_mfma_f32_16x16x32_bf16 v[116:119], a[28:31], a[232:235], v[116:119]
    v_exp_f32 v45, v45
    v_mfma_f32_16x16x32_bf16 v[116:119], a[32:35], a[236:239], v[116:119]
    ds_read_b128 a[212:215], v2 offset:62464
    v_cvt_pk_bf16_f32 v184, v112, v113
    v_mfma_f32_16x16x32_bf16 v[116:119], a[36:39], a[240:243], v[116:119]
    v_cvt_pk_bf16_f32 v185, v114, v115
    v_sub_f32 v46, v46, v12
    v_mfma_f32_16x16x32_bf16 v[116:119], a[40:43], a[244:247], v[116:119]
    v_add_f32 v21, v21, v58
    v_sub_f32 v62, v62, v13
    v_mfma_f32_16x16x32_bf16 v[116:119], a[44:47], a[248:251], v[116:119]
    v_exp_f32 v61, v61
    v_mfma_f32_16x16x32_bf16 v[120:123], a[48:51], a[228:231], 0
    v_add_f32 v22, v22, v74
    v_sub_f32 v78, v78, v14
    v_mfma_f32_16x16x32_bf16 v[120:123], a[52:55], a[232:235], v[120:123]
    v_exp_f32 v77, v77
    v_mfma_f32_16x16x32_bf16 v[120:123], a[56:59], a[236:239], v[120:123]
    v_cvt_pk_bf16_f32 v186, v116, v117
    v_cvt_pk_bf16_f32 v187, v118, v119
    v_mfma_f32_16x16x32_bf16 v[120:123], a[60:63], a[240:243], v[120:123]
    v_add_f32 v23, v23, v90
    v_sub_f32 v94, v94, v15
    v_mfma_f32_16x16x32_bf16 v[120:123], a[64:67], a[244:247], v[120:123]
    v_exp_f32 v93, v93
    v_mfma_f32_16x16x32_bf16 v[120:123], a[68:71], a[248:251], v[120:123]
    v_add_f32 v20, v20, v43
    v_sub_f32 v47, v47, v12
    v_mfma_f32_16x16x32_bf16 v[124:127], a[72:75], a[228:231], 0
    v_exp_f32 v46, v46
    v_mfma_f32_16x16x32_bf16 v[124:127], a[76:79], a[232:235], v[124:127]
    v_add_f32 v21, v21, v59
    v_sub_f32 v63, v63, v13
    v_mfma_f32_16x16x32_bf16 v[124:127], a[80:83], a[236:239], v[124:127]
    v_cvt_pk_bf16_f32 v188, v120, v121
    v_cvt_pk_bf16_f32 v189, v122, v123
    v_mfma_f32_16x16x32_bf16 v[124:127], a[84:87], a[240:243], v[124:127]
    v_exp_f32 v62, v62
    v_mfma_f32_16x16x32_bf16 v[124:127], a[88:91], a[244:247], v[124:127]
    ds_read_b128 a[216:219], v2 offset:63488
    v_add_f32 v22, v22, v75
    v_mfma_f32_16x16x32_bf16 v[124:127], a[92:95], a[248:251], v[124:127]
    v_sub_f32 v79, v79, v14
    s_waitcnt lgkmcnt(1)
    v_mfma_f32_16x16x32_bf16 v[96:99], a[0:3], a[192:195], 0
    ds_read_b128 a[220:223], v2 offset:64512
    v_add_f32 v23, v23, v91
    v_mfma_f32_16x16x32_bf16 v[96:99], a[4:7], a[196:199], v[96:99]
    v_exp_f32 v78, v78
    v_mfma_f32_16x16x32_bf16 v[96:99], a[8:11], a[200:203], v[96:99]
    ds_read_b128 a[224:227], v3 offset:0
    v_cvt_pk_bf16_f32 v190, v124, v125
    v_mfma_f32_16x16x32_bf16 v[96:99], a[12:15], a[204:207], v[96:99]
    v_cvt_pk_bf16_f32 v191, v126, v127
    v_sub_f32 v95, v95, v15
    v_mfma_f32_16x16x32_bf16 v[96:99], a[16:19], a[208:211], v[96:99]
    ds_read_b128 a[228:231], v3 offset:1024
    v_add_f32 v20, v20, v44
    v_mfma_f32_16x16x32_bf16 v[96:99], a[20:23], a[212:215], v[96:99]
    v_exp_f32 v94, v94
    v_mfma_f32_16x16x32_bf16 v[100:103], a[24:27], a[192:195], 0
    ds_read_b128 a[232:235], v3 offset:2048
    v_add_f32 v21, v21, v60
    v_mfma_f32_16x16x32_bf16 v[100:103], a[28:31], a[196:199], v[100:103]
    v_exp_f32 v47, v47
    v_mfma_f32_16x16x32_bf16 v[100:103], a[32:35], a[200:203], v[100:103]
    ds_read_b128 a[236:239], v3 offset:3072
    v_cvt_pk_bf16_f32 v192, v96, v97
    v_mfma_f32_16x16x32_bf16 v[100:103], a[36:39], a[204:207], v[100:103]
    v_cvt_pk_bf16_f32 v193, v98, v99
    v_add_f32 v22, v22, v76
    v_mfma_f32_16x16x32_bf16 v[100:103], a[40:43], a[208:211], v[100:103]
    v_exp_f32 v63, v63
    v_mfma_f32_16x16x32_bf16 v[100:103], a[44:47], a[212:215], v[100:103]
    v_exp_f32 v79, v79
    v_mfma_f32_16x16x32_bf16 v[104:107], a[48:51], a[192:195], 0
    v_add_f32 v23, v23, v92
    v_add_f32 v20, v20, v45
    v_mfma_f32_16x16x32_bf16 v[104:107], a[52:55], a[196:199], v[104:107]
    v_exp_f32 v95, v95
    v_mfma_f32_16x16x32_bf16 v[104:107], a[56:59], a[200:203], v[104:107]
    buffer_load_dwordx4 a[184:187], v9, s[8:11], s30 offen offset:256 nt
    v_cvt_pk_bf16_f32 v194, v100, v101
    v_mfma_f32_16x16x32_bf16 v[104:107], a[60:63], a[204:207], v[104:107]
    buffer_load_dwordx4 a[188:191], v10, s[8:11], s30 offen offset:256 nt
    v_cvt_pk_bf16_f32 v195, v102, v103
    v_mfma_f32_16x16x32_bf16 v[104:107], a[64:67], a[208:211], v[104:107]
    v_add_f32 v21, v21, v61
    v_add_f32 v22, v22, v77
    v_mfma_f32_16x16x32_bf16 v[104:107], a[68:71], a[212:215], v[104:107]
    v_add_f32 v23, v23, v93
    v_add_f32 v20, v20, v46
    v_mfma_f32_16x16x32_bf16 v[108:111], a[72:75], a[192:195], 0
    v_add_f32 v21, v21, v62
    v_add_f32 v22, v22, v78
    v_mfma_f32_16x16x32_bf16 v[108:111], a[76:79], a[196:199], v[108:111]
    v_add_f32 v23, v23, v94
    v_add_f32 v20, v20, v47
    v_mfma_f32_16x16x32_bf16 v[108:111], a[80:83], a[200:203], v[108:111]
    v_cvt_pk_bf16_f32 v196, v104, v105
    v_cvt_pk_bf16_f32 v197, v106, v107
    v_mfma_f32_16x16x32_bf16 v[108:111], a[84:87], a[204:207], v[108:111]
    v_add_f32 v21, v21, v63
    v_add_f32 v22, v22, v79
    v_mfma_f32_16x16x32_bf16 v[108:111], a[88:91], a[208:211], v[108:111]
    ds_read_b128 a[240:243], v3 offset:4096
    v_add_f32 v23, v23, v95
    v_mfma_f32_16x16x32_bf16 v[108:111], a[92:95], a[212:215], v[108:111]
    v_permlane16_swap_b32 v20, v21
    s_waitcnt lgkmcnt(1)
    v_mfma_f32_16x16x32_bf16 v[112:115], a[0:3], a[216:219], 0
    ds_read_b128 a[244:247], v3 offset:5120
    v_permlane16_swap_b32 v22, v23
    v_mfma_f32_16x16x32_bf16 v[112:115], a[4:7], a[220:223], v[112:115]
    v_add_f32 v20, v20, v21
    v_add_f32 v22, v22, v23
    v_mfma_f32_16x16x32_bf16 v[112:115], a[8:11], a[224:227], v[112:115]
    ds_read_b128 a[248:251], v3 offset:6144
    v_cvt_pk_bf16_f32 v198, v108, v109
    v_mfma_f32_16x16x32_bf16 v[112:115], a[12:15], a[228:231], v[112:115]
    v_cvt_pk_bf16_f32 v199, v110, v111
    v_permlane32_swap_b32 v20, v22
    v_mfma_f32_16x16x32_bf16 v[112:115], a[16:19], a[232:235], v[112:115]
    ds_read_b128 a[192:195], v3 offset:7168
    v_add_f32 v20, v20, v22
    v_mfma_f32_16x16x32_bf16 v[112:115], a[20:23], a[236:239], v[112:115]
    v_rcp_f32 v20, v20
    v_mfma_f32_16x16x32_bf16 v[116:119], a[24:27], a[216:219], 0
    ds_read_b128 a[196:199], v3 offset:8192
    v_mov_b32 v22, v20
    v_mfma_f32_16x16x32_bf16 v[116:119], a[28:31], a[220:223], v[116:119]
    s_add_u32 s28, s16, 7077888
    v_permlane32_swap_b32 v20, v22
    v_mfma_f32_16x16x32_bf16 v[116:119], a[32:35], a[224:227], v[116:119]
    ds_read_b128 a[200:203], v3 offset:9216
    v_cvt_pk_bf16_f32 v200, v112, v113
    v_mfma_f32_16x16x32_bf16 v[116:119], a[36:39], a[228:231], v[116:119]
    v_cvt_pk_bf16_f32 v201, v114, v115
    v_mov_b32 v21, v20
    v_mfma_f32_16x16x32_bf16 v[116:119], a[40:43], a[232:235], v[116:119]
    v_mov_b32 v23, v22
    v_permlane16_swap_b32 v20, v21
    v_mfma_f32_16x16x32_bf16 v[116:119], a[44:47], a[236:239], v[116:119]
    v_mul_f32 v32, v32, v20
    v_mul_f32 v33, v33, v20
    v_mfma_f32_16x16x32_bf16 v[120:123], a[48:51], a[216:219], 0
    v_cvt_pk_bf16_f32 v32, v32, v33
    v_mul_f32 v34, v34, v20
    v_mfma_f32_16x16x32_bf16 v[120:123], a[52:55], a[220:223], v[120:123]
    v_mul_f32 v35, v35, v20
    v_cvt_pk_bf16_f32 v33, v34, v35
    v_mfma_f32_16x16x32_bf16 v[120:123], a[56:59], a[224:227], v[120:123]
    v_cvt_pk_bf16_f32 v202, v116, v117
    v_cvt_pk_bf16_f32 v203, v118, v119
    v_mfma_f32_16x16x32_bf16 v[120:123], a[60:63], a[228:231], v[120:123]
    v_mul_f32 v36, v36, v20
    v_mul_f32 v37, v37, v20
    v_mfma_f32_16x16x32_bf16 v[120:123], a[64:67], a[232:235], v[120:123]
    v_cvt_pk_bf16_f32 v34, v36, v37
    v_mul_f32 v38, v38, v20
    v_mfma_f32_16x16x32_bf16 v[120:123], a[68:71], a[236:239], v[120:123]
    v_mul_f32 v39, v39, v20
    v_mul_f32 v40, v40, v20
    v_mfma_f32_16x16x32_bf16 v[124:127], a[72:75], a[216:219], 0
    v_mul_f32 v41, v41, v20
    v_permlane16_swap_b32 v22, v23
    v_mfma_f32_16x16x32_bf16 v[124:127], a[76:79], a[220:223], v[124:127]
    v_cvt_pk_bf16_f32 v35, v38, v39
    v_cvt_pk_bf16_f32 v36, v40, v41
    v_mfma_f32_16x16x32_bf16 v[124:127], a[80:83], a[224:227], v[124:127]
    v_cvt_pk_bf16_f32 v204, v120, v121
    v_cvt_pk_bf16_f32 v205, v122, v123
    v_mfma_f32_16x16x32_bf16 v[124:127], a[84:87], a[228:231], v[124:127]
    v_mul_f32 v48, v48, v21
    v_mul_f32 v49, v49, v21
    v_mfma_f32_16x16x32_bf16 v[124:127], a[88:91], a[232:235], v[124:127]
    ds_read_b128 a[204:207], v3 offset:10240
    v_cvt_pk_bf16_f32 v40, v48, v49
    v_mfma_f32_16x16x32_bf16 v[124:127], a[92:95], a[236:239], v[124:127]
    v_mul_f32 v64, v64, v22
    s_waitcnt lgkmcnt(1)
    v_mfma_f32_16x16x32_bf16 v[96:99], a[0:3], a[240:243], 0
    ds_read_b128 a[208:211], v3 offset:11264
    v_mul_f32 v65, v65, v22
    v_mfma_f32_16x16x32_bf16 v[96:99], a[4:7], a[244:247], v[96:99]
    v_mul_f32 v66, v66, v22
    v_mul_f32 v67, v67, v22
    v_mfma_f32_16x16x32_bf16 v[96:99], a[8:11], a[248:251], v[96:99]
    ds_read_b128 a[212:215], v3 offset:12288
    v_cvt_pk_bf16_f32 v206, v124, v125
    v_mfma_f32_16x16x32_bf16 v[96:99], a[12:15], a[192:195], v[96:99]
    v_cvt_pk_bf16_f32 v207, v126, v127
    v_cvt_pk_bf16_f32 v48, v64, v65
    v_mfma_f32_16x16x32_bf16 v[96:99], a[16:19], a[196:199], v[96:99]
    ds_read_b128 a[216:219], v3 offset:13312
    v_cvt_pk_bf16_f32 v49, v66, v67
    v_mfma_f32_16x16x32_bf16 v[96:99], a[20:23], a[200:203], v[96:99]
    v_mul_f32 v42, v42, v20
    v_mul_f32 v43, v43, v20
    v_mfma_f32_16x16x32_bf16 v[100:103], a[24:27], a[240:243], 0
    ds_read_b128 a[220:223], v3 offset:14336
    v_mul_f32 v44, v44, v20
    v_mfma_f32_16x16x32_bf16 v[100:103], a[28:31], a[244:247], v[100:103]
    v_mul_f32 v45, v45, v20
    v_mul_f32 v46, v46, v20
    v_mfma_f32_16x16x32_bf16 v[100:103], a[32:35], a[248:251], v[100:103]
    ds_read_b128 a[224:227], v3 offset:15360
    v_mul_f32 v47, v47, v20
    v_mfma_f32_16x16x32_bf16 v[100:103], a[36:39], a[192:195], v[100:103]
    v_cvt_pk_bf16_f32 v37, v42, v43
    v_cvt_pk_bf16_f32 v38, v44, v45
    v_mfma_f32_16x16x32_bf16 v[100:103], a[40:43], a[196:199], v[100:103]
    v_cvt_pk_bf16_f32 v39, v46, v47
    v_mul_f32 v50, v50, v21
    v_mfma_f32_16x16x32_bf16 v[100:103], a[44:47], a[200:203], v[100:103]
    v_mul_f32 v51, v51, v21
    v_cvt_pk_bf16_f32 v41, v50, v51
    v_mfma_f32_16x16x32_bf16 v[104:107], a[48:51], a[240:243], 0
    v_mul_f32 v68, v68, v22
    v_mul_f32 v69, v69, v22
    v_mfma_f32_16x16x32_bf16 v[104:107], a[52:55], a[244:247], v[104:107]
    v_mul_f32 v70, v70, v22
    v_mul_f32 v71, v71, v22
    v_mfma_f32_16x16x32_bf16 v[104:107], a[56:59], a[248:251], v[104:107]
    v_cvt_pk_bf16_f32 v50, v68, v69
    v_cvt_pk_bf16_f32 v51, v70, v71
    v_mfma_f32_16x16x32_bf16 v[104:107], a[60:63], a[192:195], v[104:107]
    v_mul_f32 v52, v52, v21
    v_mul_f32 v53, v53, v21
    v_mfma_f32_16x16x32_bf16 v[104:107], a[64:67], a[196:199], v[104:107]
    v_cvt_pk_bf16_f32 v42, v52, v53
    v_mul_f32 v72, v72, v22
    v_mfma_f32_16x16x32_bf16 v[104:107], a[68:71], a[200:203], v[104:107]
    v_mul_f32 v73, v73, v22
    v_mul_f32 v74, v74, v22
    v_mfma_f32_16x16x32_bf16 v[108:111], a[72:75], a[240:243], 0
    v_mul_f32 v75, v75, v22
    v_cvt_pk_bf16_f32 v52, v72, v73
    v_mfma_f32_16x16x32_bf16 v[108:111], a[76:79], a[244:247], v[108:111]
    v_cvt_pk_bf16_f32 v53, v74, v75
    v_mul_f32 v54, v54, v21
    v_mfma_f32_16x16x32_bf16 v[108:111], a[80:83], a[248:251], v[108:111]
    v_mul_f32 v55, v55, v21
    v_cvt_pk_bf16_f32 v43, v54, v55
    v_mfma_f32_16x16x32_bf16 v[108:111], a[84:87], a[192:195], v[108:111]
    v_mul_f32 v76, v76, v22
    v_mul_f32 v77, v77, v22
    v_mfma_f32_16x16x32_bf16 v[108:111], a[88:91], a[196:199], v[108:111]
    v_mul_f32 v78, v78, v22
    v_mul_f32 v79, v79, v22
    v_mfma_f32_16x16x32_bf16 v[108:111], a[92:95], a[200:203], v[108:111]
    v_cvt_pk_bf16_f32 v54, v76, v77
    s_waitcnt lgkmcnt(0)
    v_mfma_f32_16x16x32_bf16 v[112:115], a[0:3], a[204:207], 0
    v_cvt_pk_bf16_f32 v55, v78, v79
    v_mul_f32 v56, v56, v21
    v_mfma_f32_16x16x32_bf16 v[112:115], a[4:7], a[208:211], v[112:115]
    v_mul_f32 v57, v57, v21
    v_cvt_pk_bf16_f32 v44, v56, v57
    v_mfma_f32_16x16x32_bf16 v[112:115], a[8:11], a[212:215], v[112:115]
    v_mul_f32 v80, v80, v23
    v_mul_f32 v81, v81, v23
    v_mfma_f32_16x16x32_bf16 v[112:115], a[12:15], a[216:219], v[112:115]
    v_mul_f32 v82, v82, v23
    v_mul_f32 v83, v83, v23
    v_mfma_f32_16x16x32_bf16 v[112:115], a[16:19], a[220:223], v[112:115]
    v_cvt_pk_bf16_f32 v56, v80, v81
    v_cvt_pk_bf16_f32 v57, v82, v83
    v_mfma_f32_16x16x32_bf16 v[112:115], a[20:23], a[224:227], v[112:115]
    v_mul_f32 v58, v58, v21
    v_mul_f32 v59, v59, v21
    v_mfma_f32_16x16x32_bf16 v[116:119], a[24:27], a[204:207], 0
    v_mul_f32 v60, v60, v21
    v_mul_f32 v61, v61, v21
    v_mfma_f32_16x16x32_bf16 v[116:119], a[28:31], a[208:211], v[116:119]
    v_mul_f32 v62, v62, v21
    v_mul_f32 v63, v63, v21
    v_mfma_f32_16x16x32_bf16 v[116:119], a[32:35], a[212:215], v[116:119]
    v_cvt_pk_bf16_f32 v45, v58, v59
    v_cvt_pk_bf16_f32 v46, v60, v61
    v_mfma_f32_16x16x32_bf16 v[116:119], a[36:39], a[216:219], v[116:119]
    v_cvt_pk_bf16_f32 v47, v62, v63
    v_mul_f32 v84, v84, v23
    v_mfma_f32_16x16x32_bf16 v[116:119], a[40:43], a[220:223], v[116:119]
    v_mul_f32 v85, v85, v23
    v_mul_f32 v86, v86, v23
    v_mfma_f32_16x16x32_bf16 v[116:119], a[44:47], a[224:227], v[116:119]
    v_mul_f32 v87, v87, v23
    v_cvt_pk_bf16_f32 v58, v84, v85
    v_mfma_f32_16x16x32_bf16 v[120:123], a[48:51], a[204:207], 0
    s_mov_b32 s10, s19
    v_cvt_pk_bf16_f32 v59, v86, v87
    v_mfma_f32_16x16x32_bf16 v[120:123], a[52:55], a[208:211], v[120:123]
    v_mul_f32 v88, v88, v23
    v_mul_f32 v89, v89, v23
    v_mfma_f32_16x16x32_bf16 v[120:123], a[56:59], a[212:215], v[120:123]
    v_mul_f32 v90, v90, v23
    v_mul_f32 v91, v91, v23
    v_mfma_f32_16x16x32_bf16 v[120:123], a[60:63], a[216:219], v[120:123]
    v_cvt_pk_bf16_f32 v60, v88, v89
    v_cvt_pk_bf16_f32 v61, v90, v91
    v_mfma_f32_16x16x32_bf16 v[120:123], a[64:67], a[220:223], v[120:123]
    v_mul_f32 v92, v92, v23
    v_mul_f32 v93, v93, v23
    v_mfma_f32_16x16x32_bf16 v[120:123], a[68:71], a[224:227], v[120:123]
    v_mul_f32 v94, v94, v23
    v_mul_f32 v95, v95, v23
    v_mfma_f32_16x16x32_bf16 v[124:127], a[72:75], a[204:207], 0
    v_cvt_pk_bf16_f32 v62, v92, v93
    v_cvt_pk_bf16_f32 v63, v94, v95
    v_mfma_f32_16x16x32_bf16 v[124:127], a[76:79], a[208:211], v[124:127]
    v_cvt_pk_bf16_f32 v208, v96, v97
    v_cvt_pk_bf16_f32 v209, v98, v99
    v_mfma_f32_16x16x32_bf16 v[124:127], a[80:83], a[212:215], v[124:127]
    v_cvt_pk_bf16_f32 v210, v100, v101
    v_cvt_pk_bf16_f32 v211, v102, v103
    v_mfma_f32_16x16x32_bf16 v[124:127], a[84:87], a[216:219], v[124:127]
    v_cvt_pk_bf16_f32 v212, v104, v105
    v_cvt_pk_bf16_f32 v213, v106, v107
    v_mfma_f32_16x16x32_bf16 v[124:127], a[88:91], a[220:223], v[124:127]
    v_cvt_pk_bf16_f32 v214, v108, v109
    v_cvt_pk_bf16_f32 v215, v110, v111
    v_mfma_f32_16x16x32_bf16 v[124:127], a[92:95], a[224:227], v[124:127]
    v_cvt_pk_bf16_f32 v216, v112, v113
    v_cvt_pk_bf16_f32 v217, v114, v115
    v_mfma_f32_16x16x32_bf16 v[64:67], v[32:35], v[128:131], 0
    v_cvt_pk_bf16_f32 v218, v116, v117
    v_cvt_pk_bf16_f32 v219, v118, v119
    v_mfma_f32_16x16x32_bf16 v[64:67], v[36:39], v[132:135], v[64:67]
    v_cvt_pk_bf16_f32 v220, v120, v121
    v_cvt_pk_bf16_f32 v221, v122, v123
    v_mfma_f32_16x16x32_bf16 v[68:71], v[32:35], v[136:139], 0
    v_cvt_pk_bf16_f32 v222, v124, v125
    v_cvt_pk_bf16_f32 v223, v126, v127
    v_mfma_f32_16x16x32_bf16 v[68:71], v[36:39], v[140:143], v[68:71]
    s_add_u32 s30, s16, 7471104
    v_mfma_f32_16x16x32_bf16 v[72:75], v[32:35], v[144:147], 0
    buffer_load_dwordx4 a[0:3], v9, s[8:11], s24 offen offset:0 nt
    v_mfma_f32_16x16x32_bf16 v[72:75], v[36:39], v[148:151], v[72:75]
    buffer_load_dwordx4 a[4:7], v10, s[8:11], s24 offen offset:0 nt
    v_mfma_f32_16x16x32_bf16 v[76:79], v[32:35], v[152:155], 0
    v_cvt_pk_bf16_f32 v224, v64, v68
    v_cvt_pk_bf16_f32 v226, v65, v69
    v_mfma_f32_16x16x32_bf16 v[76:79], v[36:39], v[156:159], v[76:79]
    v_cvt_pk_bf16_f32 v228, v66, v70
    v_cvt_pk_bf16_f32 v230, v67, v71
    v_mfma_f32_16x16x32_bf16 v[80:83], v[40:43], v[128:131], 0
    v_mfma_f32_16x16x32_bf16 v[80:83], v[44:47], v[132:135], v[80:83]
    v_mfma_f32_16x16x32_bf16 v[84:87], v[40:43], v[136:139], 0
    v_cvt_pk_bf16_f32 v225, v72, v76
    v_cvt_pk_bf16_f32 v227, v73, v77
    v_mfma_f32_16x16x32_bf16 v[84:87], v[44:47], v[140:143], v[84:87]
    v_cvt_pk_bf16_f32 v229, v74, v78
    v_cvt_pk_bf16_f32 v231, v75, v79
    v_mfma_f32_16x16x32_bf16 v[88:91], v[40:43], v[144:147], 0
    v_mfma_f32_16x16x32_bf16 v[88:91], v[44:47], v[148:151], v[88:91]
    v_mfma_f32_16x16x32_bf16 v[92:95], v[40:43], v[152:155], 0
    v_cvt_pk_bf16_f32 v232, v80, v84
    v_cvt_pk_bf16_f32 v234, v81, v85
    v_mfma_f32_16x16x32_bf16 v[92:95], v[44:47], v[156:159], v[92:95]
    v_cvt_pk_bf16_f32 v236, v82, v86
    v_cvt_pk_bf16_f32 v238, v83, v87
    v_mfma_f32_16x16x32_bf16 v[96:99], v[48:51], v[128:131], 0
    v_mfma_f32_16x16x32_bf16 v[96:99], v[52:55], v[132:135], v[96:99]
    v_mfma_f32_16x16x32_bf16 v[100:103], v[48:51], v[136:139], 0
    v_cvt_pk_bf16_f32 v233, v88, v92
    v_cvt_pk_bf16_f32 v235, v89, v93
    v_mfma_f32_16x16x32_bf16 v[100:103], v[52:55], v[140:143], v[100:103]
    v_cvt_pk_bf16_f32 v237, v90, v94
    v_cvt_pk_bf16_f32 v239, v91, v95
    v_mfma_f32_16x16x32_bf16 v[104:107], v[48:51], v[144:147], 0
    v_mfma_f32_16x16x32_bf16 v[104:107], v[52:55], v[148:151], v[104:107]
    v_mfma_f32_16x16x32_bf16 v[108:111], v[48:51], v[152:155], 0
    v_cvt_pk_bf16_f32 v240, v96, v100
    v_cvt_pk_bf16_f32 v242, v97, v101
    v_mfma_f32_16x16x32_bf16 v[108:111], v[52:55], v[156:159], v[108:111]
    v_cvt_pk_bf16_f32 v244, v98, v102
    v_cvt_pk_bf16_f32 v246, v99, v103
    v_mfma_f32_16x16x32_bf16 v[112:115], v[56:59], v[128:131], 0
    v_mfma_f32_16x16x32_bf16 v[112:115], v[60:63], v[132:135], v[112:115]
    v_mfma_f32_16x16x32_bf16 v[116:119], v[56:59], v[136:139], 0
    v_cvt_pk_bf16_f32 v241, v104, v108
    v_cvt_pk_bf16_f32 v243, v105, v109
    v_mfma_f32_16x16x32_bf16 v[116:119], v[60:63], v[140:143], v[116:119]
    v_cvt_pk_bf16_f32 v245, v106, v110
    v_cvt_pk_bf16_f32 v247, v107, v111
    v_mfma_f32_16x16x32_bf16 v[120:123], v[56:59], v[144:147], 0
    v_mfma_f32_16x16x32_bf16 v[120:123], v[60:63], v[148:151], v[120:123]
    v_mfma_f32_16x16x32_bf16 v[124:127], v[56:59], v[152:155], 0
    v_cvt_pk_bf16_f32 v248, v112, v116
    v_cvt_pk_bf16_f32 v250, v113, v117
    v_mfma_f32_16x16x32_bf16 v[124:127], v[60:63], v[156:159], v[124:127]
    v_cvt_pk_bf16_f32 v252, v114, v118
    v_cvt_pk_bf16_f32 v254, v115, v119
    v_mfma_f32_16x16x32_bf16 v[64:67], v[32:35], v[160:163], 0
    v_mfma_f32_16x16x32_bf16 v[64:67], v[36:39], v[164:167], v[64:67]
    v_mfma_f32_16x16x32_bf16 v[68:71], v[32:35], v[168:171], 0
    v_cvt_pk_bf16_f32 v249, v120, v124
    v_cvt_pk_bf16_f32 v251, v121, v125
    v_mfma_f32_16x16x32_bf16 v[68:71], v[36:39], v[172:175], v[68:71]
    v_cvt_pk_bf16_f32 v253, v122, v126
    v_cvt_pk_bf16_f32 v255, v123, v127
    v_mfma_f32_16x16x32_bf16 v[72:75], v[32:35], v[176:179], 0
    v_mfma_f32_16x16x32_bf16 v[72:75], v[36:39], v[180:183], v[72:75]
    v_mfma_f32_16x16x32_bf16 v[76:79], v[32:35], v[184:187], 0
    v_cvt_pk_bf16_f32 v128, v64, v68
    v_cvt_pk_bf16_f32 v130, v65, v69
    v_mfma_f32_16x16x32_bf16 v[76:79], v[36:39], v[188:191], v[76:79]
    v_cvt_pk_bf16_f32 v132, v66, v70
    v_cvt_pk_bf16_f32 v134, v67, v71
    v_mfma_f32_16x16x32_bf16 v[80:83], v[40:43], v[160:163], 0
    v_mfma_f32_16x16x32_bf16 v[80:83], v[44:47], v[164:167], v[80:83]
    v_mfma_f32_16x16x32_bf16 v[84:87], v[40:43], v[168:171], 0
    v_cvt_pk_bf16_f32 v129, v72, v76
    v_cvt_pk_bf16_f32 v131, v73, v77
    v_mfma_f32_16x16x32_bf16 v[84:87], v[44:47], v[172:175], v[84:87]
    v_cvt_pk_bf16_f32 v133, v74, v78
    v_cvt_pk_bf16_f32 v135, v75, v79
    v_mfma_f32_16x16x32_bf16 v[88:91], v[40:43], v[176:179], 0
    v_mfma_f32_16x16x32_bf16 v[88:91], v[44:47], v[180:183], v[88:91]
    v_mfma_f32_16x16x32_bf16 v[92:95], v[40:43], v[184:187], 0
    v_cvt_pk_bf16_f32 v136, v80, v84
    v_cvt_pk_bf16_f32 v138, v81, v85
    v_mfma_f32_16x16x32_bf16 v[92:95], v[44:47], v[188:191], v[92:95]
    v_cvt_pk_bf16_f32 v140, v82, v86
    v_cvt_pk_bf16_f32 v142, v83, v87
    v_mfma_f32_16x16x32_bf16 v[96:99], v[48:51], v[160:163], 0
    s_waitcnt vmcnt(6)
    ds_write_b64 v4, a[120:121] offset:0
    v_mfma_f32_16x16x32_bf16 v[96:99], v[52:55], v[164:167], v[96:99]
    ds_write_b64 v4, a[122:123] offset:1024
    v_mfma_f32_16x16x32_bf16 v[100:103], v[48:51], v[168:171], 0
    ds_write_b64 v4, a[124:125] offset:512
    v_mfma_f32_16x16x32_bf16 v[100:103], v[52:55], v[172:175], v[100:103]
    ds_write_b64 v4, a[126:127] offset:1536
    v_mfma_f32_16x16x32_bf16 v[104:107], v[48:51], v[176:179], 0
    ds_read2_b64 a[120:123], v5 offset0:0 offset1:128
    v_cvt_pk_bf16_f32 v137, v88, v92
    v_mfma_f32_16x16x32_bf16 v[104:107], v[52:55], v[180:183], v[104:107]
    ds_read2_b64 a[124:127], v6 offset0:0 offset1:128
    v_cvt_pk_bf16_f32 v139, v89, v93
    v_mfma_f32_16x16x32_bf16 v[108:111], v[48:51], v[184:187], 0
    v_cvt_pk_bf16_f32 v141, v90, v94
    v_cvt_pk_bf16_f32 v143, v91, v95
    v_mfma_f32_16x16x32_bf16 v[108:111], v[52:55], v[188:191], v[108:111]
    v_cvt_pk_bf16_f32 v144, v96, v100
    v_cvt_pk_bf16_f32 v146, v97, v101
    v_mfma_f32_16x16x32_bf16 v[112:115], v[56:59], v[160:163], 0
    v_cvt_pk_bf16_f32 v148, v98, v102
    v_cvt_pk_bf16_f32 v150, v99, v103
    v_mfma_f32_16x16x32_bf16 v[112:115], v[60:63], v[164:167], v[112:115]
    v_mfma_f32_16x16x32_bf16 v[116:119], v[56:59], v[168:171], 0
    v_cvt_pk_bf16_f32 v145, v104, v108
    v_cvt_pk_bf16_f32 v147, v105, v109
    v_mfma_f32_16x16x32_bf16 v[116:119], v[60:63], v[172:175], v[116:119]
    v_cvt_pk_bf16_f32 v149, v106, v110
    v_cvt_pk_bf16_f32 v151, v107, v111
    v_mfma_f32_16x16x32_bf16 v[120:123], v[56:59], v[176:179], 0
    buffer_load_dwordx4 a[8:11], v9, s[8:11], s24 offen offset:128 nt
    v_mfma_f32_16x16x32_bf16 v[120:123], v[60:63], v[180:183], v[120:123]
    buffer_load_dwordx4 a[12:15], v10, s[8:11], s24 offen offset:128 nt
    v_mfma_f32_16x16x32_bf16 v[124:127], v[56:59], v[184:187], 0
    v_cvt_pk_bf16_f32 v152, v112, v116
    v_cvt_pk_bf16_f32 v154, v113, v117
    v_mfma_f32_16x16x32_bf16 v[124:127], v[60:63], v[188:191], v[124:127]
    s_waitcnt vmcnt(25)
    ds_write_b64 v4, a[128:129] offset:0
    v_mfma_f32_16x16x32_bf16 v[64:67], v[32:35], v[192:195], 0
    ds_write_b64 v4, a[130:131] offset:1024
    v_mfma_f32_16x16x32_bf16 v[64:67], v[36:39], v[196:199], v[64:67]
    ds_write_b64 v4, a[132:133] offset:512
    v_mfma_f32_16x16x32_bf16 v[68:71], v[32:35], v[200:203], 0
    ds_write_b64 v4, a[134:135] offset:1536
    v_mfma_f32_16x16x32_bf16 v[68:71], v[36:39], v[204:207], v[68:71]
    ds_read2_b64 a[128:131], v5 offset0:0 offset1:128
    v_cvt_pk_bf16_f32 v156, v114, v118
    v_mfma_f32_16x16x32_bf16 v[72:75], v[32:35], v[208:211], 0
    ds_read2_b64 a[132:135], v6 offset0:0 offset1:128
    v_cvt_pk_bf16_f32 v158, v115, v119
    v_mfma_f32_16x16x32_bf16 v[72:75], v[36:39], v[212:215], v[72:75]
    v_cvt_pk_bf16_f32 v153, v120, v124
    v_cvt_pk_bf16_f32 v155, v121, v125
    v_mfma_f32_16x16x32_bf16 v[76:79], v[32:35], v[216:219], 0
    ds_read_b128 a[228:231], v1 offset:0
    v_cvt_pk_bf16_f32 v157, v122, v126
    v_mfma_f32_16x16x32_bf16 v[76:79], v[36:39], v[220:223], v[76:79]
    v_cvt_pk_bf16_f32 v159, v123, v127
    v_cvt_pk_bf16_f32 v160, v64, v68
    v_mfma_f32_16x16x32_bf16 v[80:83], v[40:43], v[192:195], 0
    ds_read_b128 a[232:235], v1 offset:1024
    v_cvt_pk_bf16_f32 v162, v65, v69
    v_mfma_f32_16x16x32_bf16 v[80:83], v[44:47], v[196:199], v[80:83]
    v_cvt_pk_bf16_f32 v164, v66, v70
    v_cvt_pk_bf16_f32 v166, v67, v71
    v_mfma_f32_16x16x32_bf16 v[84:87], v[40:43], v[200:203], 0
    ds_read_b128 a[236:239], v1 offset:2048
    v_cvt_pk_bf16_f32 v161, v72, v76
    v_mfma_f32_16x16x32_bf16 v[84:87], v[44:47], v[204:207], v[84:87]
    v_cvt_pk_bf16_f32 v163, v73, v77
    v_cvt_pk_bf16_f32 v165, v74, v78
    v_mfma_f32_16x16x32_bf16 v[88:91], v[40:43], v[208:211], 0
    ds_read_b128 a[240:243], v1 offset:3072
    v_cvt_pk_bf16_f32 v167, v75, v79
    v_mfma_f32_16x16x32_bf16 v[88:91], v[44:47], v[212:215], v[88:91]
    v_mfma_f32_16x16x32_bf16 v[92:95], v[40:43], v[216:219], 0
    buffer_store_dwordx2 v[128:129], v11, s[12:15], s32 offen offset:128 sc1
    v_mfma_f32_16x16x32_bf16 v[92:95], v[44:47], v[220:223], v[92:95]
    ds_read_b128 a[244:247], v1 offset:4096
    v_cvt_pk_bf16_f32 v168, v80, v84
    v_mfma_f32_16x16x32_bf16 v[96:99], v[48:51], v[192:195], 0
    ds_read_b128 a[248:251], v1 offset:5120
    v_cvt_pk_bf16_f32 v170, v81, v85
    v_mfma_f32_16x16x32_bf16 v[96:99], v[52:55], v[196:199], v[96:99]
    s_waitcnt vmcnt(22)
    ds_write_b64 v4, a[136:137] offset:0
    v_mfma_f32_16x16x32_bf16 v[100:103], v[48:51], v[200:203], 0
    ds_read_b128 a[192:195], v1 offset:6144
    v_cvt_pk_bf16_f32 v172, v82, v86
    v_mfma_f32_16x16x32_bf16 v[100:103], v[52:55], v[204:207], v[100:103]
    ds_write_b64 v4, a[138:139] offset:1024
    v_mfma_f32_16x16x32_bf16 v[104:107], v[48:51], v[208:211], 0
    ds_read_b128 a[196:199], v1 offset:7168
    v_cvt_pk_bf16_f32 v174, v83, v87
    v_mfma_f32_16x16x32_bf16 v[104:107], v[52:55], v[212:215], v[104:107]
    ds_write_b64 v4, a[140:141] offset:512
    v_mfma_f32_16x16x32_bf16 v[108:111], v[48:51], v[216:219], 0
    ds_read_b128 a[200:203], v1 offset:8192
    v_cvt_pk_bf16_f32 v176, v96, v100
    v_mfma_f32_16x16x32_bf16 v[108:111], v[52:55], v[220:223], v[108:111]
    ds_write_b64 v4, a[142:143] offset:1536
    v_mfma_f32_16x16x32_bf16 v[112:115], v[56:59], v[192:195], 0
    buffer_store_dwordx2 v[130:131], v11, s[12:15], s32 offen offset:512 sc1
    v_mfma_f32_16x16x32_bf16 v[112:115], v[60:63], v[196:199], v[112:115]
    ds_read_b128 a[204:207], v1 offset:9216
    v_cvt_pk_bf16_f32 v178, v97, v101
    v_mfma_f32_16x16x32_bf16 v[116:119], v[56:59], v[200:203], 0
    ds_read_b128 a[208:211], v1 offset:10240
    v_cvt_pk_bf16_f32 v180, v98, v102
    v_mfma_f32_16x16x32_bf16 v[116:119], v[60:63], v[204:207], v[116:119]
    ds_read2_b64 a[136:139], v5 offset0:0 offset1:128
    v_cvt_pk_bf16_f32 v182, v99, v103
    v_mfma_f32_16x16x32_bf16 v[120:123], v[56:59], v[208:211], 0
    ds_read_b128 a[212:215], v1 offset:11264
    v_cvt_pk_bf16_f32 v177, v104, v108
    v_mfma_f32_16x16x32_bf16 v[120:123], v[60:63], v[212:215], v[120:123]
    ds_read2_b64 a[140:143], v6 offset0:0 offset1:128
    v_cvt_pk_bf16_f32 v179, v105, v109
    v_mfma_f32_16x16x32_bf16 v[124:127], v[56:59], v[216:219], 0
    ds_read_b128 a[216:219], v1 offset:12288
    v_cvt_pk_bf16_f32 v184, v112, v116
    v_mfma_f32_16x16x32_bf16 v[124:127], v[60:63], v[220:223], v[124:127]
    v_cvt_pk_bf16_f32 v186, v113, v117
    s_waitcnt lgkmcnt(11)
    v_mfma_f32_16x16x32_bf16 v[96:99], a[228:231], a[96:99], 0
    ds_read_b128 a[220:223], v1 offset:13312
    v_cvt_pk_bf16_f32 v188, v114, v118
    v_mfma_f32_16x16x32_bf16 v[96:99], a[232:235], a[100:103], v[96:99]
    v_cvt_pk_bf16_f32 v190, v115, v119
    v_cvt_pk_bf16_f32 v181, v106, v110
    v_mfma_f32_16x16x32_bf16 v[96:99], a[236:239], a[104:107], v[96:99]
    ds_read_b128 a[224:227], v1 offset:14336
    v_cvt_pk_bf16_f32 v183, v107, v111
    v_mfma_f32_16x16x32_bf16 v[96:99], a[240:243], a[108:111], v[96:99]
    buffer_store_dwordx2 v[132:133], v11, s[12:15], s32 offen offset:896 sc1
    v_mfma_f32_16x16x32_bf16 v[96:99], a[244:247], a[112:115], v[96:99]
    s_waitcnt vmcnt(19)
    ds_write_b64 v4, a[144:145] offset:0
    v_mfma_f32_16x16x32_bf16 v[96:99], a[248:251], a[116:119], v[96:99]
    ds_write_b64 v4, a[146:147] offset:1024
    v_mfma_f32_16x16x32_bf16 v[100:103], a[228:231], a[120:123], 0
    ds_write_b64 v4, a[148:149] offset:512
    v_mfma_f32_16x16x32_bf16 v[100:103], a[232:235], a[124:127], v[100:103]
    ds_read_b128 a[228:231], v1 offset:15360
    v_cvt_pk_bf16_f32 v185, v120, v124
    v_mfma_f32_16x16x32_bf16 v[100:103], a[236:239], a[128:131], v[100:103]
    ds_read_b128 a[232:235], v1 offset:16384
    v_cvt_pk_bf16_f32 v192, v96, v97
    v_mfma_f32_16x16x32_bf16 v[100:103], a[240:243], a[132:135], v[100:103]
    ds_read_b128 a[236:239], v1 offset:17408
    s_waitcnt lgkmcnt(10)
    v_mfma_f32_16x16x32_bf16 v[100:103], a[244:247], a[136:139], v[100:103]
    ds_read_b128 a[240:243], v1 offset:18432
    s_waitcnt lgkmcnt(10)
    v_mfma_f32_16x16x32_bf16 v[100:103], a[248:251], a[140:143], v[100:103]
    ds_write_b64 v4, a[150:151] offset:1536
    v_mfma_f32_16x16x32_bf16 v[112:115], a[192:195], a[96:99], 0
    ds_read_b128 a[244:247], v1 offset:19456
    v_cvt_pk_bf16_f32 v193, v98, v99
    v_mfma_f32_16x16x32_bf16 v[112:115], a[196:199], a[100:103], v[112:115]
    buffer_store_dwordx2 v[134:135], v11, s[12:15], s32 offen offset:1280 sc1
    v_mfma_f32_16x16x32_bf16 v[112:115], a[200:203], a[104:107], v[112:115]
    ds_read_b128 a[248:251], v1 offset:20480
    v_cvt_pk_bf16_f32 v196, v100, v101
    v_mfma_f32_16x16x32_bf16 v[112:115], a[204:207], a[108:111], v[112:115]
    ds_read2_b64 a[144:147], v5 offset0:0 offset1:128
    v_cvt_pk_bf16_f32 v197, v102, v103
    v_mfma_f32_16x16x32_bf16 v[112:115], a[208:211], a[112:115], v[112:115]
    ds_read2_b64 a[148:151], v6 offset0:0 offset1:128
    v_cvt_pk_bf16_f32 v187, v121, v125
    v_mfma_f32_16x16x32_bf16 v[112:115], a[212:215], a[116:119], v[112:115]
    v_cvt_pk_bf16_f32 v189, v122, v126
    v_cvt_pk_bf16_f32 v191, v123, v127
    v_mfma_f32_16x16x32_bf16 v[116:119], a[192:195], a[120:123], 0
    s_waitcnt vmcnt(8)
    ds_write_b64 v4, a[168:169] offset:0
    v_mfma_f32_16x16x32_bf16 v[116:119], a[196:199], a[124:127], v[116:119]
    ds_read_b128 a[192:195], v1 offset:21504
    v_cvt_pk_bf16_f32 v169, v88, v92
    v_mfma_f32_16x16x32_bf16 v[116:119], a[200:203], a[128:131], v[116:119]
    buffer_load_dwordx4 a[16:19], v9, s[8:11], s24 offen offset:256 nt
    v_cvt_pk_bf16_f32 v194, v112, v113
    v_mfma_f32_16x16x32_bf16 v[116:119], a[204:207], a[132:135], v[116:119]
    buffer_load_dwordx4 a[20:23], v10, s[8:11], s24 offen offset:256 nt
    v_cvt_pk_bf16_f32 v195, v114, v115
    v_mfma_f32_16x16x32_bf16 v[116:119], a[208:211], a[136:139], v[116:119]
    ds_read_b128 a[196:199], v1 offset:22528
    v_cvt_pk_bf16_f32 v171, v89, v93
    v_mfma_f32_16x16x32_bf16 v[116:119], a[212:215], a[140:143], v[116:119]
    ds_read_b128 a[200:203], v1 offset:23552
    s_waitcnt lgkmcnt(9)
    v_mfma_f32_16x16x32_bf16 v[96:99], a[216:219], a[96:99], 0
    ds_read_b128 a[204:207], v1 offset:24576
    v_cvt_pk_bf16_f32 v173, v90, v94
    v_mfma_f32_16x16x32_bf16 v[96:99], a[220:223], a[100:103], v[96:99]
    buffer_store_dwordx2 v[136:137], v11, s[12:15], s34 offen offset:128 sc1
    v_mfma_f32_16x16x32_bf16 v[96:99], a[224:227], a[104:107], v[96:99]
    ds_read_b128 a[208:211], v1 offset:25600
    v_cvt_pk_bf16_f32 v198, v116, v117
    v_mfma_f32_16x16x32_bf16 v[96:99], a[228:231], a[108:111], v[96:99]
    ds_read_b128 a[212:215], v1 offset:26624
    v_cvt_pk_bf16_f32 v199, v118, v119
    v_mfma_f32_16x16x32_bf16 v[96:99], a[232:235], a[112:115], v[96:99]
    ds_write_b64 v4, a[170:171] offset:1024
    v_mfma_f32_16x16x32_bf16 v[96:99], a[236:239], a[116:119], v[96:99]
    ds_write_b64 v4, a[172:173] offset:512
    v_mfma_f32_16x16x32_bf16 v[100:103], a[216:219], a[120:123], 0
    ds_write_b64 v4, a[174:175] offset:1536
    v_mfma_f32_16x16x32_bf16 v[100:103], a[220:223], a[124:127], v[100:103]
    ds_read_b128 a[216:219], v1 offset:27648
    v_cvt_pk_bf16_f32 v175, v91, v95
    v_mfma_f32_16x16x32_bf16 v[100:103], a[224:227], a[128:131], v[100:103]
    ds_read_b128 a[220:223], v1 offset:28672
    v_cvt_pk_bf16_f32 v208, v96, v97
    v_mfma_f32_16x16x32_bf16 v[100:103], a[228:231], a[132:135], v[100:103]
    ds_read_b128 a[224:227], v1 offset:29696
    v_cvt_pk_bf16_f32 v209, v98, v99
    v_mfma_f32_16x16x32_bf16 v[100:103], a[232:235], a[136:139], v[100:103]
    buffer_store_dwordx2 v[138:139], v11, s[12:15], s34 offen offset:512 sc1
    v_mfma_f32_16x16x32_bf16 v[100:103], a[236:239], a[140:143], v[100:103]
    ds_read2_b64 a[168:171], v5 offset0:0 offset1:128
    s_add_u32 s24, s16, 9437184
    v_mfma_f32_16x16x32_bf16 v[112:115], a[240:243], a[96:99], 0
    ds_read2_b64 a[172:175], v6 offset0:0 offset1:128
    s_waitcnt lgkmcnt(11)
    v_mfma_f32_16x16x32_bf16 v[112:115], a[244:247], a[100:103], v[112:115]
    v_mfma_f32_16x16x32_bf16 v[112:115], a[248:251], a[104:107], v[112:115]
    v_cvt_pk_bf16_f32 v212, v100, v101
    v_cvt_pk_bf16_f32 v213, v102, v103
    v_mfma_f32_16x16x32_bf16 v[112:115], a[192:195], a[108:111], v[112:115]
    v_mfma_f32_16x16x32_bf16 v[112:115], a[196:199], a[112:115], v[112:115]
    v_mfma_f32_16x16x32_bf16 v[112:115], a[200:203], a[116:119], v[112:115]
    v_mfma_f32_16x16x32_bf16 v[116:119], a[240:243], a[120:123], 0
    ds_write_b64 v4, a[152:153] offset:0
    v_mfma_f32_16x16x32_bf16 v[116:119], a[244:247], a[124:127], v[116:119]
    ds_write_b64 v4, a[154:155] offset:1024
    v_mfma_f32_16x16x32_bf16 v[116:119], a[248:251], a[128:131], v[116:119]
    ds_write_b64 v4, a[156:157] offset:512
    v_mfma_f32_16x16x32_bf16 v[116:119], a[192:195], a[132:135], v[116:119]
    buffer_store_dwordx2 v[140:141], v11, s[12:15], s34 offen offset:896 sc1
    v_mfma_f32_16x16x32_bf16 v[116:119], a[196:199], a[136:139], v[116:119]
    ds_write_b64 v4, a[158:159] offset:1536
    v_mfma_f32_16x16x32_bf16 v[116:119], a[200:203], a[140:143], v[116:119]
    ds_read2_b64 a[152:155], v5 offset0:0 offset1:128
    s_waitcnt lgkmcnt(7)
    v_mfma_f32_16x16x32_bf16 v[96:99], a[204:207], a[96:99], 0
    ds_read2_b64 a[156:159], v6 offset0:0 offset1:128
    v_cvt_pk_bf16_f32 v210, v112, v113
    v_mfma_f32_16x16x32_bf16 v[96:99], a[208:211], a[100:103], v[96:99]
    v_cvt_pk_bf16_f32 v211, v114, v115
    v_mfma_f32_16x16x32_bf16 v[96:99], a[212:215], a[104:107], v[96:99]
    ds_read_b128 a[228:231], v1 offset:30720
    v_cvt_pk_bf16_f32 v214, v116, v117
    v_mfma_f32_16x16x32_bf16 v[96:99], a[216:219], a[108:111], v[96:99]
    v_cvt_pk_bf16_f32 v215, v118, v119
    v_mfma_f32_16x16x32_bf16 v[96:99], a[220:223], a[112:115], v[96:99]
    ds_read_b128 a[232:235], v1 offset:31744
    v_mfma_f32_16x16x32_bf16 v[96:99], a[224:227], a[116:119], v[96:99]
    v_mfma_f32_16x16x32_bf16 v[100:103], a[204:207], a[120:123], 0
    ds_read_b128 a[236:239], v1 offset:32768
    v_mfma_f32_16x16x32_bf16 v[100:103], a[208:211], a[124:127], v[100:103]
    buffer_store_dwordx2 v[142:143], v11, s[12:15], s34 offen offset:1280 sc1
    v_mfma_f32_16x16x32_bf16 v[100:103], a[212:215], a[128:131], v[100:103]
    ds_read_b128 a[240:243], v1 offset:33792
    v_mfma_f32_16x16x32_bf16 v[100:103], a[216:219], a[132:135], v[100:103]
    v_mfma_f32_16x16x32_bf16 v[100:103], a[220:223], a[136:139], v[100:103]
    ds_read_b128 a[244:247], v1 offset:34816
    v_mfma_f32_16x16x32_bf16 v[100:103], a[224:227], a[140:143], v[100:103]
    v_mfma_f32_16x16x32_bf16 v[32:35], a[96:99], v[192:195], 0
    ds_read_b128 a[248:251], v1 offset:35840
    v_mfma_f32_16x16x32_bf16 v[32:35], a[100:103], v[208:211], v[32:35]
    s_waitcnt vmcnt(13)
    ds_write_b64 v4, a[0:1] offset:0
    v_mfma_f32_16x16x32_bf16 v[36:39], a[120:123], v[192:195], 0
    ds_read_b128 a[192:195], v1 offset:36864
    v_mfma_f32_16x16x32_bf16 v[36:39], a[124:127], v[208:211], v[36:39]
    ds_write_b64 v4, a[2:3] offset:1024
    v_mfma_f32_16x16x32_bf16 v[40:43], a[144:147], v[192:195], 0
    ds_read_b128 a[196:199], v1 offset:37888
    v_mfma_f32_16x16x32_bf16 v[40:43], a[148:151], v[208:211], v[40:43]
    s_waitcnt vmcnt(12)
    ds_write_b64 v4, a[4:5] offset:512
    s_waitcnt lgkmcnt(9)
    v_mfma_f32_16x16x32_bf16 v[44:47], a[168:171], v[192:195], 0
    buffer_store_dwordx2 v[144:145], v11, s[12:15], s36 offen offset:128 sc1
    v_mfma_f32_16x16x32_bf16 v[44:47], a[172:175], v[208:211], v[44:47]
    ds_read_b128 a[200:203], v1 offset:38912
    v_cvt_pk_bf16_f32 v192, v96, v97
    v_mfma_f32_16x16x32_bf16 v[48:51], a[96:99], v[196:199], 0
    ds_read_b128 a[204:207], v1 offset:39936
    v_cvt_pk_bf16_f32 v193, v98, v99
    v_mfma_f32_16x16x32_bf16 v[48:51], a[100:103], v[212:215], v[48:51]
    ds_write_b64 v4, a[6:7] offset:1536
    v_mfma_f32_16x16x32_bf16 v[52:55], a[120:123], v[196:199], 0
    ds_read_b128 a[208:211], v1 offset:40960
    v_mfma_f32_16x16x32_bf16 v[52:55], a[124:127], v[212:215], v[52:55]
    ds_read2_b64 a[0:3], v5 offset0:0 offset1:128
    v_mfma_f32_16x16x32_bf16 v[56:59], a[144:147], v[196:199], 0
    ds_read_b128 a[212:215], v1 offset:41984
    v_mfma_f32_16x16x32_bf16 v[56:59], a[148:151], v[212:215], v[56:59]
    ds_read2_b64 a[4:7], v6 offset0:0 offset1:128
    v_mfma_f32_16x16x32_bf16 v[60:63], a[168:171], v[196:199], 0
    ds_read_b128 a[216:219], v1 offset:43008
    v_cvt_pk_bf16_f32 v196, v100, v101
    v_mfma_f32_16x16x32_bf16 v[60:63], a[172:175], v[212:215], v[60:63]
    ds_write_b64 v4, a[176:177] offset:0
    v_mfma_f32_16x16x32_bf16 v[112:115], a[228:231], a[96:99], 0
    buffer_store_dwordx2 v[146:147], v11, s[12:15], s36 offen offset:512 sc1
    v_mfma_f32_16x16x32_bf16 v[112:115], a[232:235], a[100:103], v[112:115]
    buffer_load_dwordx4 a[24:27], v9, s[8:11], s26 offen offset:0 nt
    s_waitcnt lgkmcnt(10)
    v_mfma_f32_16x16x32_bf16 v[112:115], a[236:239], a[104:107], v[112:115]
    buffer_load_dwordx4 a[28:31], v10, s[8:11], s26 offen offset:0 nt
    v_cvt_pk_bf16_f32 v197, v102, v103
    v_mfma_f32_16x16x32_bf16 v[112:115], a[240:243], a[108:111], v[112:115]
    ds_read_b128 a[220:223], v1 offset:44032
    v_mfma_f32_16x16x32_bf16 v[112:115], a[244:247], a[112:115], v[112:115]
    ds_read_b128 a[224:227], v1 offset:45056
    v_mfma_f32_16x16x32_bf16 v[112:115], a[248:251], a[116:119], v[112:115]
    ds_write_b64 v4, a[178:179] offset:1024
    v_mfma_f32_16x16x32_bf16 v[116:119], a[228:231], a[120:123], 0
    ds_write_b64 v4, a[180:181] offset:512
    v_mfma_f32_16x16x32_bf16 v[116:119], a[232:235], a[124:127], v[116:119]
    ds_read_b128 a[228:231], v1 offset:46080
    v_mfma_f32_16x16x32_bf16 v[116:119], a[236:239], a[128:131], v[116:119]
    ds_read_b128 a[232:235], v1 offset:47104
    v_cvt_pk_bf16_f32 v194, v112, v113
    v_mfma_f32_16x16x32_bf16 v[116:119], a[240:243], a[132:135], v[116:119]
    ds_write_b64 v4, a[182:183] offset:1536
    v_mfma_f32_16x16x32_bf16 v[116:119], a[244:247], a[136:139], v[116:119]
    ds_read2_b64 a[176:179], v5 offset0:0 offset1:128
    v_cvt_pk_bf16_f32 v195, v114, v115
    v_mfma_f32_16x16x32_bf16 v[116:119], a[248:251], a[140:143], v[116:119]
    ds_read2_b64 a[180:183], v6 offset0:0 offset1:128
    v_mfma_f32_16x16x32_bf16 v[96:99], a[192:195], a[96:99], 0
    ds_read_b128 a[236:239], v1 offset:48128
    v_mfma_f32_16x16x32_bf16 v[96:99], a[196:199], a[100:103], v[96:99]
    ds_read_b128 a[240:243], v1 offset:49152
    s_waitcnt lgkmcnt(11)
    v_mfma_f32_16x16x32_bf16 v[96:99], a[200:203], a[104:107], v[96:99]
    buffer_store_dwordx2 v[148:149], v11, s[12:15], s36 offen offset:896 sc1
    v_mfma_f32_16x16x32_bf16 v[96:99], a[204:207], a[108:111], v[96:99]
    ds_read_b128 a[244:247], v1 offset:50176
    v_cvt_pk_bf16_f32 v198, v116, v117
    v_mfma_f32_16x16x32_bf16 v[96:99], a[208:211], a[112:115], v[96:99]
    ds_read_b128 a[248:251], v1 offset:51200
    v_cvt_pk_bf16_f32 v199, v118, v119
    v_mfma_f32_16x16x32_bf16 v[96:99], a[212:215], a[116:119], v[96:99]
    v_mfma_f32_16x16x32_bf16 v[100:103], a[192:195], a[120:123], 0
    v_mfma_f32_16x16x32_bf16 v[100:103], a[196:199], a[124:127], v[100:103]
    ds_read_b128 a[192:195], v1 offset:52224
    v_mfma_f32_16x16x32_bf16 v[100:103], a[200:203], a[128:131], v[100:103]
    ds_read_b128 a[196:199], v1 offset:53248
    v_cvt_pk_bf16_f32 v208, v96, v97
    v_mfma_f32_16x16x32_bf16 v[100:103], a[204:207], a[132:135], v[100:103]
    buffer_store_dwordx2 v[150:151], v11, s[12:15], s36 offen offset:1280 sc1
    v_mfma_f32_16x16x32_bf16 v[100:103], a[208:211], a[136:139], v[100:103]
    ds_read_b128 a[200:203], v1 offset:54272
    v_cvt_pk_bf16_f32 v209, v98, v99
    v_mfma_f32_16x16x32_bf16 v[100:103], a[212:215], a[140:143], v[100:103]
    v_mfma_f32_16x16x32_bf16 v[112:115], a[216:219], a[96:99], 0
    s_waitcnt lgkmcnt(7)
    v_mfma_f32_16x16x32_bf16 v[112:115], a[220:223], a[100:103], v[112:115]
    v_mfma_f32_16x16x32_bf16 v[112:115], a[224:227], a[104:107], v[112:115]
    ds_write_b64 v4, a[160:161] offset:0
    v_mfma_f32_16x16x32_bf16 v[112:115], a[228:231], a[108:111], v[112:115]
    ds_write_b64 v4, a[162:163] offset:1024
    v_mfma_f32_16x16x32_bf16 v[112:115], a[232:235], a[112:115], v[112:115]
    ds_write_b64 v4, a[164:165] offset:512
    s_waitcnt lgkmcnt(7)
    v_mfma_f32_16x16x32_bf16 v[112:115], a[236:239], a[116:119], v[112:115]
    ds_write_b64 v4, a[166:167] offset:1536
    v_mfma_f32_16x16x32_bf16 v[116:119], a[216:219], a[120:123], 0
    ds_read2_b64 a[160:163], v5 offset0:0 offset1:128
    v_cvt_pk_bf16_f32 v212, v100, v101
    v_mfma_f32_16x16x32_bf16 v[116:119], a[220:223], a[124:127], v[116:119]
    ds_read2_b64 a[164:167], v6 offset0:0 offset1:128
    v_cvt_pk_bf16_f32 v213, v102, v103
    v_mfma_f32_16x16x32_bf16 v[116:119], a[224:227], a[128:131], v[116:119]
    buffer_store_dwordx2 v[152:153], v11, s[12:15], s38 offen offset:128 sc1
    v_mfma_f32_16x16x32_bf16 v[116:119], a[228:231], a[132:135], v[116:119]
    v_cvt_pk_bf16_f32 v210, v112, v113
    v_cvt_pk_bf16_f32 v211, v114, v115
    v_mfma_f32_16x16x32_bf16 v[116:119], a[232:235], a[136:139], v[116:119]
    v_mfma_f32_16x16x32_bf16 v[116:119], a[236:239], a[140:143], v[116:119]
    s_waitcnt vmcnt(18)
    ds_write_b64 v4, a[8:9] offset:0
    v_mfma_f32_16x16x32_bf16 v[96:99], a[240:243], a[96:99], 0
    ds_write_b64 v4, a[10:11] offset:1024
    v_mfma_f32_16x16x32_bf16 v[96:99], a[244:247], a[100:103], v[96:99]
    s_waitcnt vmcnt(17)
    ds_write_b64 v4, a[12:13] offset:512
    s_waitcnt lgkmcnt(9)
    v_mfma_f32_16x16x32_bf16 v[96:99], a[248:251], a[104:107], v[96:99]
    ds_read_b128 a[204:207], v1 offset:55296
    v_cvt_pk_bf16_f32 v214, v116, v117
    v_mfma_f32_16x16x32_bf16 v[96:99], a[192:195], a[108:111], v[96:99]
    ds_write_b64 v4, a[14:15] offset:1536
    v_mfma_f32_16x16x32_bf16 v[96:99], a[196:199], a[112:115], v[96:99]
    ds_read_b128 a[208:211], v1 offset:56320
    v_cvt_pk_bf16_f32 v215, v118, v119
    v_mfma_f32_16x16x32_bf16 v[96:99], a[200:203], a[116:119], v[96:99]
    ds_read2_b64 a[8:11], v5 offset0:0 offset1:128
    v_mfma_f32_16x16x32_bf16 v[100:103], a[240:243], a[120:123], 0
    buffer_store_dwordx2 v[154:155], v11, s[12:15], s38 offen offset:512 sc1
    v_mfma_f32_16x16x32_bf16 v[100:103], a[244:247], a[124:127], v[100:103]
    ds_read_b128 a[212:215], v1 offset:57344
    v_mfma_f32_16x16x32_bf16 v[100:103], a[248:251], a[128:131], v[100:103]
    ds_read_b128 a[216:219], v1 offset:58368
    v_mfma_f32_16x16x32_bf16 v[100:103], a[192:195], a[132:135], v[100:103]
    ds_read2_b64 a[12:15], v6 offset0:0 offset1:128
    v_mfma_f32_16x16x32_bf16 v[100:103], a[196:199], a[136:139], v[100:103]
    ds_read_b128 a[220:223], v1 offset:59392
    v_mfma_f32_16x16x32_bf16 v[100:103], a[200:203], a[140:143], v[100:103]
    v_mfma_f32_16x16x32_bf16 v[32:35], a[104:107], v[192:195], v[32:35]
    ds_read_b128 a[224:227], v1 offset:60416
    v_mfma_f32_16x16x32_bf16 v[32:35], a[108:111], v[208:211], v[32:35]
    v_mfma_f32_16x16x32_bf16 v[36:39], a[128:131], v[192:195], v[36:39]
    ds_read_b128 a[228:231], v1 offset:61440
    v_mfma_f32_16x16x32_bf16 v[36:39], a[132:135], v[208:211], v[36:39]
    v_mfma_f32_16x16x32_bf16 v[40:43], a[152:155], v[192:195], v[40:43]
    ds_read_b128 a[232:235], v1 offset:62464
    v_mfma_f32_16x16x32_bf16 v[40:43], a[156:159], v[208:211], v[40:43]
    buffer_store_dwordx2 v[156:157], v11, s[12:15], s38 offen offset:896 sc1
    v_mfma_f32_16x16x32_bf16 v[44:47], a[176:179], v[192:195], v[44:47]
    ds_read_b128 a[236:239], v1 offset:63488
    v_cvt_pk_bf16_f32 v192, v96, v97
    v_mfma_f32_16x16x32_bf16 v[44:47], a[180:183], v[208:211], v[44:47]
    v_cvt_pk_bf16_f32 v193, v98, v99
    v_mfma_f32_16x16x32_bf16 v[48:51], a[104:107], v[196:199], v[48:51]
    buffer_load_dwordx4 a[32:35], v9, s[8:11], s26 offen offset:128 nt
    v_mfma_f32_16x16x32_bf16 v[48:51], a[108:111], v[212:215], v[48:51]
    buffer_load_dwordx4 a[36:39], v10, s[8:11], s26 offen offset:128 nt
    v_mfma_f32_16x16x32_bf16 v[52:55], a[128:131], v[196:199], v[52:55]
    ds_read_b128 a[240:243], v1 offset:64512
    v_mfma_f32_16x16x32_bf16 v[52:55], a[132:135], v[212:215], v[52:55]
    ds_read_b128 a[244:247], v2 offset:0
    v_mfma_f32_16x16x32_bf16 v[56:59], a[152:155], v[196:199], v[56:59]
    ds_read_b128 a[248:251], v2 offset:1024
    v_mfma_f32_16x16x32_bf16 v[56:59], a[156:159], v[212:215], v[56:59]
    ds_write_b64 v4, a[184:185] offset:0
    v_mfma_f32_16x16x32_bf16 v[60:63], a[176:179], v[196:199], v[60:63]
    ds_read_b128 a[192:195], v2 offset:2048
    v_cvt_pk_bf16_f32 v196, v100, v101
    v_mfma_f32_16x16x32_bf16 v[60:63], a[180:183], v[212:215], v[60:63]
    buffer_store_dwordx2 v[158:159], v11, s[12:15], s38 offen offset:1280 sc1
    s_waitcnt lgkmcnt(7)
    v_mfma_f32_16x16x32_bf16 v[112:115], a[204:207], a[96:99], 0
    ds_read_b128 a[196:199], v2 offset:3072
    v_cvt_pk_bf16_f32 v197, v102, v103
    v_mfma_f32_16x16x32_bf16 v[112:115], a[208:211], a[100:103], v[112:115]
    ds_write_b64 v4, a[186:187] offset:1024
    v_mfma_f32_16x16x32_bf16 v[112:115], a[212:215], a[104:107], v[112:115]
    ds_read_b128 a[200:203], v2 offset:4096
    v_mfma_f32_16x16x32_bf16 v[112:115], a[216:219], a[108:111], v[112:115]
    ds_write_b64 v4, a[188:189] offset:512
    v_mfma_f32_16x16x32_bf16 v[112:115], a[220:223], a[112:115], v[112:115]
    ds_write_b64 v4, a[190:191] offset:1536
    v_mfma_f32_16x16x32_bf16 v[112:115], a[224:227], a[116:119], v[112:115]
    ds_read2_b64 a[184:187], v5 offset0:0 offset1:128
    v_mfma_f32_16x16x32_bf16 v[116:119], a[204:207], a[120:123], 0
    ds_read2_b64 a[188:191], v6 offset0:0 offset1:128
    v_mfma_f32_16x16x32_bf16 v[116:119], a[208:211], a[124:127], v[116:119]
    ds_read_b128 a[204:207], v2 offset:5120
    v_mfma_f32_16x16x32_bf16 v[116:119], a[212:215], a[128:131], v[116:119]
    ds_read_b128 a[208:211], v2 offset:6144
    v_cvt_pk_bf16_f32 v194, v112, v113
    v_mfma_f32_16x16x32_bf16 v[116:119], a[216:219], a[132:135], v[116:119]
    ds_read_b128 a[212:215], v2 offset:7168
    v_cvt_pk_bf16_f32 v195, v114, v115
    v_mfma_f32_16x16x32_bf16 v[116:119], a[220:223], a[136:139], v[116:119]
    buffer_store_dwordx2 v[224:225], v11, s[12:15], s32 offen offset:0 sc1
    v_mfma_f32_16x16x32_bf16 v[116:119], a[224:227], a[140:143], v[116:119]
    ds_read_b128 a[216:219], v1 offset:0
    v_mfma_f32_16x16x32_bf16 v[96:99], a[228:231], a[96:99], 0
    ds_read_b128 a[220:223], v1 offset:1024
    s_waitcnt lgkmcnt(12)
    v_mfma_f32_16x16x32_bf16 v[96:99], a[232:235], a[100:103], v[96:99]
    v_mfma_f32_16x16x32_bf16 v[96:99], a[236:239], a[104:107], v[96:99]
    ds_read_b128 a[224:227], v1 offset:2048
    v_cvt_pk_bf16_f32 v198, v116, v117
    v_mfma_f32_16x16x32_bf16 v[96:99], a[240:243], a[108:111], v[96:99]
    v_cvt_pk_bf16_f32 v199, v118, v119
    v_mfma_f32_16x16x32_bf16 v[96:99], a[244:247], a[112:115], v[96:99]
    v_mfma_f32_16x16x32_bf16 v[96:99], a[248:251], a[116:119], v[96:99]
    v_mfma_f32_16x16x32_bf16 v[100:103], a[228:231], a[120:123], 0
    v_mfma_f32_16x16x32_bf16 v[100:103], a[232:235], a[124:127], v[100:103]
    ds_read_b128 a[228:231], v1 offset:3072
    v_mfma_f32_16x16x32_bf16 v[100:103], a[236:239], a[128:131], v[100:103]
    buffer_store_dwordx2 v[226:227], v11, s[12:15], s32 offen offset:384 sc1
    v_mfma_f32_16x16x32_bf16 v[100:103], a[240:243], a[132:135], v[100:103]
    ds_read_b128 a[232:235], v1 offset:4096
    v_cvt_pk_bf16_f32 v208, v96, v97
    v_mfma_f32_16x16x32_bf16 v[100:103], a[244:247], a[136:139], v[100:103]
    ds_read_b128 a[236:239], v1 offset:5120
    v_cvt_pk_bf16_f32 v209, v98, v99
    v_mfma_f32_16x16x32_bf16 v[100:103], a[248:251], a[140:143], v[100:103]
    v_mfma_f32_16x16x32_bf16 v[112:115], a[192:195], a[96:99], 0
    s_waitcnt lgkmcnt(5)
    v_mfma_f32_16x16x32_bf16 v[112:115], a[196:199], a[100:103], v[112:115]
    v_mfma_f32_16x16x32_bf16 v[112:115], a[200:203], a[104:107], v[112:115]
    s_waitcnt vmcnt(19)
    ds_write_b64 v4, a[16:17] offset:0
    v_mfma_f32_16x16x32_bf16 v[112:115], a[204:207], a[108:111], v[112:115]
    ds_write_b64 v4, a[18:19] offset:1024
    v_mfma_f32_16x16x32_bf16 v[112:115], a[208:211], a[112:115], v[112:115]
    s_waitcnt vmcnt(18)
    ds_write_b64 v4, a[20:21] offset:512
    v_mfma_f32_16x16x32_bf16 v[112:115], a[212:215], a[116:119], v[112:115]
    ds_write_b64 v4, a[22:23] offset:1536
    v_mfma_f32_16x16x32_bf16 v[116:119], a[192:195], a[120:123], 0
    ds_read2_b64 a[16:19], v5 offset0:0 offset1:128
    v_cvt_pk_bf16_f32 v212, v100, v101
    v_mfma_f32_16x16x32_bf16 v[116:119], a[196:199], a[124:127], v[116:119]
    buffer_store_dwordx2 v[228:229], v11, s[12:15], s32 offen offset:768 sc1
    v_mfma_f32_16x16x32_bf16 v[116:119], a[200:203], a[128:131], v[116:119]
    ds_read2_b64 a[20:23], v6 offset0:0 offset1:128
    v_cvt_pk_bf16_f32 v210, v112, v113
    v_mfma_f32_16x16x32_bf16 v[116:119], a[204:207], a[132:135], v[116:119]
    v_cvt_pk_bf16_f32 v211, v114, v115
    v_cvt_pk_bf16_f32 v213, v102, v103
    v_mfma_f32_16x16x32_bf16 v[116:119], a[208:211], a[136:139], v[116:119]
    v_mfma_f32_16x16x32_bf16 v[116:119], a[212:215], a[140:143], v[116:119]
    v_mfma_f32_16x16x32_bf16 v[104:107], a[216:219], a[144:147], 0
    s_waitcnt lgkmcnt(6)
    v_mfma_f32_16x16x32_bf16 v[104:107], a[220:223], a[148:151], v[104:107]
    v_mfma_f32_16x16x32_bf16 v[104:107], a[224:227], a[152:155], v[104:107]
    ds_read_b128 a[240:243], v1 offset:6144
    v_cvt_pk_bf16_f32 v214, v116, v117
    v_mfma_f32_16x16x32_bf16 v[104:107], a[228:231], a[156:159], v[104:107]
    v_cvt_pk_bf16_f32 v215, v118, v119
    v_mfma_f32_16x16x32_bf16 v[104:107], a[232:235], a[160:163], v[104:107]
    ds_read_b128 a[244:247], v1 offset:7168
    v_mfma_f32_16x16x32_bf16 v[104:107], a[236:239], a[164:167], v[104:107]
    buffer_store_dwordx2 v[230:231], v11, s[12:15], s32 offen offset:1152 sc1
    v_mfma_f32_16x16x32_bf16 v[108:111], a[216:219], a[168:171], 0
    ds_read_b128 a[248:251], v1 offset:8192
    v_mfma_f32_16x16x32_bf16 v[108:111], a[220:223], a[172:175], v[108:111]
    v_mfma_f32_16x16x32_bf16 v[108:111], a[224:227], a[176:179], v[108:111]
    ds_read_b128 a[192:195], v1 offset:9216
    v_cvt_pk_bf16_f32 v200, v104, v105
    v_mfma_f32_16x16x32_bf16 v[108:111], a[228:231], a[180:183], v[108:111]
    v_cvt_pk_bf16_f32 v201, v106, v107
    v_mfma_f32_16x16x32_bf16 v[108:111], a[232:235], a[184:187], v[108:111]
    ds_read_b128 a[196:199], v1 offset:10240
    v_mfma_f32_16x16x32_bf16 v[108:111], a[236:239], a[188:191], v[108:111]
    v_mfma_f32_16x16x32_bf16 v[32:35], a[112:115], v[192:195], v[32:35]
    buffer_load_dwordx4 a[40:43], v9, s[8:11], s26 offen offset:256 nt
    v_mfma_f32_16x16x32_bf16 v[32:35], a[116:119], v[208:211], v[32:35]
    buffer_load_dwordx4 a[44:47], v10, s[8:11], s26 offen offset:256 nt
    s_add_u32 s26, s16, 9830400
    v_mfma_f32_16x16x32_bf16 v[36:39], a[136:139], v[192:195], v[36:39]
    ds_read_b128 a[200:203], v1 offset:11264
    v_cvt_pk_bf16_f32 v204, v108, v109
    v_mfma_f32_16x16x32_bf16 v[36:39], a[140:143], v[208:211], v[36:39]
    ds_read_b128 a[204:207], v1 offset:12288
    v_cvt_pk_bf16_f32 v205, v110, v111
    v_mfma_f32_16x16x32_bf16 v[40:43], a[160:163], v[192:195], v[40:43]
    buffer_store_dwordx2 v[232:233], v11, s[12:15], s34 offen offset:0 sc1
    v_mfma_f32_16x16x32_bf16 v[40:43], a[164:167], v[208:211], v[40:43]
    ds_read_b128 a[208:211], v1 offset:13312
    v_max3_f32 v12, v32, v33, v34
    v_mfma_f32_16x16x32_bf16 v[44:47], a[184:187], v[192:195], v[44:47]
    ds_read_b128 a[212:215], v1 offset:14336
    v_max3_f32 v12, v12, v35, v36
    v_mfma_f32_16x16x32_bf16 v[44:47], a[188:191], v[208:211], v[44:47]
    v_max3_f32 v12, v12, v37, v38
    v_mfma_f32_16x16x32_bf16 v[48:51], a[112:115], v[196:199], v[48:51]
    ds_read_b128 a[216:219], v1 offset:15360
    v_max3_f32 v12, v12, v39, v40
    v_mfma_f32_16x16x32_bf16 v[48:51], a[116:119], v[212:215], v[48:51]
    v_max3_f32 v12, v12, v41, v42
    v_mfma_f32_16x16x32_bf16 v[52:55], a[136:139], v[196:199], v[52:55]
    ds_read_b128 a[220:223], v1 offset:16384
    v_max3_f32 v12, v12, v43, v44
    v_mfma_f32_16x16x32_bf16 v[52:55], a[140:143], v[212:215], v[52:55]
    v_max3_f32 v12, v12, v45, v46
    v_max_f32 v12, v12, v47
    v_mfma_f32_16x16x32_bf16 v[56:59], a[160:163], v[196:199], v[56:59]
    ds_read_b128 a[224:227], v1 offset:17408
    v_max3_f32 v13, v48, v49, v50
    v_mfma_f32_16x16x32_bf16 v[56:59], a[164:167], v[212:215], v[56:59]
    v_mfma_f32_16x16x32_bf16 v[60:63], a[184:187], v[196:199], v[60:63]
    buffer_store_dwordx2 v[234:235], v11, s[12:15], s34 offen offset:384 sc1
    v_mfma_f32_16x16x32_bf16 v[60:63], a[188:191], v[212:215], v[60:63]
    ds_read_b128 a[228:231], v1 offset:18432
    s_waitcnt lgkmcnt(7)
    v_mfma_f32_16x16x32_bf16 v[120:123], a[240:243], a[144:147], 0
    ds_read_b128 a[232:235], v1 offset:19456
    v_max3_f32 v13, v13, v51, v52
    v_mfma_f32_16x16x32_bf16 v[120:123], a[244:247], a[148:151], v[120:123]
    v_max3_f32 v13, v13, v53, v54
    v_max3_f32 v13, v13, v55, v56
    v_mfma_f32_16x16x32_bf16 v[120:123], a[248:251], a[152:155], v[120:123]
    ds_read_b128 a[236:239], v1 offset:20480
    v_max3_f32 v13, v13, v57, v58
    v_mfma_f32_16x16x32_bf16 v[120:123], a[192:195], a[156:159], v[120:123]
    v_max3_f32 v13, v13, v59, v60
    v_max3_f32 v13, v13, v61, v62
    v_mfma_f32_16x16x32_bf16 v[120:123], a[196:199], a[160:163], v[120:123]
    v_max_f32 v13, v13, v63
    v_mfma_f32_16x16x32_bf16 v[120:123], a[200:203], a[164:167], v[120:123]
    v_mfma_f32_16x16x32_bf16 v[124:127], a[240:243], a[168:171], 0
    v_permlane16_swap_b32 v12, v13
    v_max_f32 v12, v12, v13
    v_mfma_f32_16x16x32_bf16 v[124:127], a[244:247], a[172:175], v[124:127]
    ds_read_b128 a[240:243], v1 offset:21504
    v_mov_b32 v13, v12
    v_mfma_f32_16x16x32_bf16 v[124:127], a[248:251], a[176:179], v[124:127]
    ds_read_b128 a[244:247], v1 offset:22528
    v_cvt_pk_bf16_f32 v202, v120, v121
    v_mfma_f32_16x16x32_bf16 v[124:127], a[192:195], a[180:183], v[124:127]
    buffer_store_dwordx2 v[236:237], v11, s[12:15], s34 offen offset:768 sc1
    v_mfma_f32_16x16x32_bf16 v[124:127], a[196:199], a[184:187], v[124:127]
    ds_read_b128 a[248:251], v1 offset:23552
    v_cvt_pk_bf16_f32 v203, v122, v123
    v_mfma_f32_16x16x32_bf16 v[124:127], a[200:203], a[188:191], v[124:127]
    ds_read_b128 a[192:195], v1 offset:24576
    s_waitcnt lgkmcnt(7)
    v_mfma_f32_16x16x32_bf16 v[104:107], a[204:207], a[144:147], 0
    ds_read_b128 a[196:199], v1 offset:25600
    v_permlane32_swap_b32 v12, v13
    v_mfma_f32_16x16x32_bf16 v[104:107], a[208:211], a[148:151], v[104:107]
    v_max_f32 v12, v12, v13
    v_mov_b32 v13, v12
    v_mfma_f32_16x16x32_bf16 v[104:107], a[212:215], a[152:155], v[104:107]
    ds_read_b128 a[200:203], v1 offset:26624
    v_cvt_pk_bf16_f32 v206, v124, v125
    v_mfma_f32_16x16x32_bf16 v[104:107], a[216:219], a[156:159], v[104:107]
    v_cvt_pk_bf16_f32 v207, v126, v127
    v_permlane16_swap_b32 v12, v13
    v_mfma_f32_16x16x32_bf16 v[104:107], a[220:223], a[160:163], v[104:107]
    v_sub_f32 v32, v32, v12
    v_sub_f32 v33, v33, v12
    v_mfma_f32_16x16x32_bf16 v[104:107], a[224:227], a[164:167], v[104:107]
    v_sub_f32 v48, v48, v13
    v_sub_f32 v49, v49, v13
    v_mfma_f32_16x16x32_bf16 v[108:111], a[204:207], a[168:171], 0
    v_exp_f32 v32, v32
    v_mfma_f32_16x16x32_bf16 v[108:111], a[208:211], a[172:175], v[108:111]
    buffer_store_dwordx2 v[238:239], v11, s[12:15], s34 offen offset:1152 sc1
    v_mfma_f32_16x16x32_bf16 v[108:111], a[212:215], a[176:179], v[108:111]
    ds_read_b128 a[204:207], v1 offset:27648
    v_cvt_pk_bf16_f32 v216, v104, v105
    v_mfma_f32_16x16x32_bf16 v[108:111], a[216:219], a[180:183], v[108:111]
    ds_read_b128 a[208:211], v1 offset:28672
    v_cvt_pk_bf16_f32 v217, v106, v107
    v_mfma_f32_16x16x32_bf16 v[108:111], a[220:223], a[184:187], v[108:111]
    ds_read_b128 a[212:215], v1 offset:29696
    v_sub_f32 v34, v34, v12
    v_mfma_f32_16x16x32_bf16 v[108:111], a[224:227], a[188:191], v[108:111]
    v_sub_f32 v50, v50, v13
    s_waitcnt lgkmcnt(6)
    v_mfma_f32_16x16x32_bf16 v[120:123], a[228:231], a[144:147], 0
    v_exp_f32 v33, v33
    v_mfma_f32_16x16x32_bf16 v[120:123], a[232:235], a[148:151], v[120:123]
    v_exp_f32 v48, v48
    v_mfma_f32_16x16x32_bf16 v[120:123], a[236:239], a[152:155], v[120:123]
    v_cvt_pk_bf16_f32 v220, v108, v109
    v_cvt_pk_bf16_f32 v221, v110, v111
    v_mfma_f32_16x16x32_bf16 v[120:123], a[240:243], a[156:159], v[120:123]
    v_exp_f32 v49, v49
    v_mfma_f32_16x16x32_bf16 v[120:123], a[244:247], a[160:163], v[120:123]
    v_exp_f32 v34, v34
    v_mfma_f32_16x16x32_bf16 v[120:123], a[248:251], a[164:167], v[120:123]
    v_sub_f32 v35, v35, v12
    v_sub_f32 v51, v51, v13
    v_mfma_f32_16x16x32_bf16 v[124:127], a[228:231], a[168:171], 0
    buffer_store_dwordx2 v[240:241], v11, s[12:15], s36 offen offset:0 sc1
    v_mfma_f32_16x16x32_bf16 v[124:127], a[232:235], a[172:175], v[124:127]
    v_exp_f32 v50, v50
    v_mfma_f32_16x16x32_bf16 v[124:127], a[236:239], a[176:179], v[124:127]
    v_cvt_pk_bf16_f32 v218, v120, v121
    v_cvt_pk_bf16_f32 v219, v122, v123
    v_mfma_f32_16x16x32_bf16 v[124:127], a[240:243], a[180:183], v[124:127]
    v_exp_f32 v35, v35
    v_mfma_f32_16x16x32_bf16 v[124:127], a[244:247], a[184:187], v[124:127]
    v_sub_f32 v36, v36, v12
    v_sub_f32 v52, v52, v13
    v_mfma_f32_16x16x32_bf16 v[124:127], a[248:251], a[188:191], v[124:127]
    v_add_f32 v20, v32, v33
    s_waitcnt lgkmcnt(0)
    v_mfma_f32_16x16x32_bf16 v[104:107], a[192:195], a[144:147], 0
    v_exp_f32 v51, v51
    v_mfma_f32_16x16x32_bf16 v[104:107], a[196:199], a[148:151], v[104:107]
    v_exp_f32 v36, v36
    v_mfma_f32_16x16x32_bf16 v[104:107], a[200:203], a[152:155], v[104:107]
    ds_read_b128 a[216:219], v1 offset:30720
    v_cvt_pk_bf16_f32 v222, v124, v125
    v_mfma_f32_16x16x32_bf16 v[104:107], a[204:207], a[156:159], v[104:107]
    v_cvt_pk_bf16_f32 v223, v126, v127
    v_sub_f32 v37, v37, v12
    v_mfma_f32_16x16x32_bf16 v[104:107], a[208:211], a[160:163], v[104:107]
    buffer_store_dwordx2 v[242:243], v11, s[12:15], s36 offen offset:384 sc1
    v_mfma_f32_16x16x32_bf16 v[104:107], a[212:215], a[164:167], v[104:107]
    buffer_load_dwordx4 a[48:51], v9, s[8:11], s28 offen offset:0 nt
    v_add_f32 v21, v48, v49
    v_mfma_f32_16x16x32_bf16 v[108:111], a[192:195], a[168:171], 0
    buffer_load_dwordx4 a[52:55], v10, s[8:11], s28 offen offset:0 nt
    v_sub_f32 v53, v53, v13
    v_mfma_f32_16x16x32_bf16 v[108:111], a[196:199], a[172:175], v[108:111]
    ds_read_b128 a[220:223], v1 offset:31744
    v_add_f32 v20, v20, v34
    v_mfma_f32_16x16x32_bf16 v[108:111], a[200:203], a[176:179], v[108:111]
    ds_read_b128 a[224:227], v1 offset:32768
    v_sub_f32 v38, v38, v12
    v_mfma_f32_16x16x32_bf16 v[108:111], a[204:207], a[180:183], v[108:111]
    ds_read_b128 a[228:231], v1 offset:33792
    v_add_f32 v21, v21, v50
    v_mfma_f32_16x16x32_bf16 v[108:111], a[208:211], a[184:187], v[108:111]
    ds_read_b128 a[232:235], v1 offset:34816
    v_sub_f32 v54, v54, v13
    v_mfma_f32_16x16x32_bf16 v[108:111], a[212:215], a[188:191], v[108:111]
    v_exp_f32 v52, v52
    v_mfma_f32_16x16x32_bf16 v[64:67], a[96:99], v[200:203], 0
    ds_read_b128 a[236:239], v1 offset:35840
    v_add_f32 v20, v20, v35
    v_mfma_f32_16x16x32_bf16 v[64:67], a[100:103], v[216:219], v[64:67]
    v_exp_f32 v37, v37
    v_mfma_f32_16x16x32_bf16 v[68:71], a[120:123], v[200:203], 0
    ds_read_b128 a[240:243], v1 offset:36864
    v_sub_f32 v39, v39, v12
    v_mfma_f32_16x16x32_bf16 v[68:71], a[124:127], v[216:219], v[68:71]
    buffer_store_dwordx2 v[244:245], v11, s[12:15], s36 offen offset:768 sc1
    v_mfma_f32_16x16x32_bf16 v[72:75], a[144:147], v[200:203], 0
    ds_read_b128 a[244:247], v1 offset:37888
    v_add_f32 v21, v21, v51
    v_mfma_f32_16x16x32_bf16 v[72:75], a[148:151], v[216:219], v[72:75]
    v_exp_f32 v53, v53
    v_mfma_f32_16x16x32_bf16 v[76:79], a[168:171], v[200:203], 0
    ds_read_b128 a[248:251], v1 offset:38912
    v_cvt_pk_bf16_f32 v200, v104, v105
    v_mfma_f32_16x16x32_bf16 v[76:79], a[172:175], v[216:219], v[76:79]
    v_cvt_pk_bf16_f32 v201, v106, v107
    v_sub_f32 v55, v55, v13
    v_mfma_f32_16x16x32_bf16 v[80:83], a[96:99], v[204:207], 0
    ds_read_b128 a[192:195], v1 offset:39936
    v_add_f32 v20, v20, v36
    v_mfma_f32_16x16x32_bf16 v[80:83], a[100:103], v[220:223], v[80:83]
    v_exp_f32 v38, v38
    v_mfma_f32_16x16x32_bf16 v[84:87], a[120:123], v[204:207], 0
    ds_read_b128 a[196:199], v1 offset:40960
    v_sub_f32 v40, v40, v12
    v_mfma_f32_16x16x32_bf16 v[84:87], a[124:127], v[220:223], v[84:87]
    v_exp_f32 v54, v54
    v_mfma_f32_16x16x32_bf16 v[88:91], a[144:147], v[204:207], 0
    ds_read_b128 a[200:203], v1 offset:41984
    v_add_f32 v21, v21, v52
    v_mfma_f32_16x16x32_bf16 v[88:91], a[148:151], v[220:223], v[88:91]
    buffer_store_dwordx2 v[246:247], v11, s[12:15], s36 offen offset:1152 sc1
    v_mfma_f32_16x16x32_bf16 v[92:95], a[168:171], v[204:207], 0
    ds_read_b128 a[204:207], v1 offset:43008
    v_cvt_pk_bf16_f32 v204, v108, v109
    v_mfma_f32_16x16x32_bf16 v[92:95], a[172:175], v[220:223], v[92:95]
    v_cvt_pk_bf16_f32 v205, v110, v111
    s_waitcnt lgkmcnt(6)
    v_mfma_f32_16x16x32_bf16 v[120:123], a[216:219], a[144:147], 0
    ds_read_b128 a[208:211], v1 offset:44032
    v_sub_f32 v56, v56, v13
    v_mfma_f32_16x16x32_bf16 v[120:123], a[220:223], a[148:151], v[120:123]
    v_exp_f32 v39, v39
    v_mfma_f32_16x16x32_bf16 v[120:123], a[224:227], a[152:155], v[120:123]
    ds_read_b128 a[212:215], v1 offset:45056
    v_add_f32 v20, v20, v37
    v_mfma_f32_16x16x32_bf16 v[120:123], a[228:231], a[156:159], v[120:123]
    v_exp_f32 v55, v55
    v_mfma_f32_16x16x32_bf16 v[120:123], a[232:235], a[160:163], v[120:123]
    v_exp_f32 v40, v40
    v_mfma_f32_16x16x32_bf16 v[120:123], a[236:239], a[164:167], v[120:123]
    v_sub_f32 v41, v41, v12
    v_add_f32 v21, v21, v53
    v_mfma_f32_16x16x32_bf16 v[124:127], a[216:219], a[168:171], 0
    v_exp_f32 v56, v56
    v_mfma_f32_16x16x32_bf16 v[124:127], a[220:223], a[172:175], v[124:127]
    ds_read_b128 a[216:219], v1 offset:46080
    v_sub_f32 v57, v57, v13
    v_mfma_f32_16x16x32_bf16 v[124:127], a[224:227], a[176:179], v[124:127]
    buffer_store_dwordx2 v[248:249], v11, s[12:15], s38 offen offset:0 sc1
    v_mfma_f32_16x16x32_bf16 v[124:127], a[228:231], a[180:183], v[124:127]
    ds_read_b128 a[220:223], v1 offset:47104
    v_cvt_pk_bf16_f32 v202, v120, v121
    v_mfma_f32_16x16x32_bf16 v[124:127], a[232:235], a[184:187], v[124:127]
    ds_read_b128 a[224:227], v1 offset:48128
    v_cvt_pk_bf16_f32 v203, v122, v123
    v_mfma_f32_16x16x32_bf16 v[124:127], a[236:239], a[188:191], v[124:127]
    ds_read_b128 a[228:231], v1 offset:49152
    v_add_f32 v20, v20, v38
    v_mfma_f32_16x16x32_bf16 v[104:107], a[240:243], a[144:147], 0
    ds_read_b128 a[232:235], v1 offset:50176
    s_waitcnt lgkmcnt(7)
    v_mfma_f32_16x16x32_bf16 v[104:107], a[244:247], a[148:151], v[104:107]
    v_exp_f32 v41, v41
    v_mfma_f32_16x16x32_bf16 v[104:107], a[248:251], a[152:155], v[104:107]
    ds_read_b128 a[236:239], v1 offset:51200
    v_cvt_pk_bf16_f32 v206, v124, v125
    v_mfma_f32_16x16x32_bf16 v[104:107], a[192:195], a[156:159], v[104:107]
    v_cvt_pk_bf16_f32 v207, v126, v127
    v_sub_f32 v42, v42, v12
    v_mfma_f32_16x16x32_bf16 v[104:107], a[196:199], a[160:163], v[104:107]
    v_add_f32 v21, v21, v54
    v_sub_f32 v58, v58, v13
    v_mfma_f32_16x16x32_bf16 v[104:107], a[200:203], a[164:167], v[104:107]
    v_exp_f32 v57, v57
    v_mfma_f32_16x16x32_bf16 v[108:111], a[240:243], a[168:171], 0
    buffer_store_dwordx2 v[250:251], v11, s[12:15], s38 offen offset:384 sc1
    v_mfma_f32_16x16x32_bf16 v[108:111], a[244:247], a[172:175], v[108:111]
    ds_read_b128 a[240:243], v1 offset:52224
    v_add_f32 v20, v20, v39
    v_mfma_f32_16x16x32_bf16 v[108:111], a[248:251], a[176:179], v[108:111]
    ds_read_b128 a[244:247], v1 offset:53248
    v_cvt_pk_bf16_f32 v216, v104, v105
    v_mfma_f32_16x16x32_bf16 v[108:111], a[192:195], a[180:183], v[108:111]
    ds_read_b128 a[248:251], v1 offset:54272
    v_cvt_pk_bf16_f32 v217, v106, v107
    v_mfma_f32_16x16x32_bf16 v[108:111], a[196:199], a[184:187], v[108:111]
    v_exp_f32 v42, v42
    v_mfma_f32_16x16x32_bf16 v[108:111], a[200:203], a[188:191], v[108:111]
    v_sub_f32 v43, v43, v12
    v_add_f32 v21, v21, v55
    v_mfma_f32_16x16x32_bf16 v[120:123], a[204:207], a[144:147], 0
    v_sub_f32 v59, v59, v13
    s_waitcnt lgkmcnt(5)
    v_mfma_f32_16x16x32_bf16 v[120:123], a[208:211], a[148:151], v[120:123]
    v_exp_f32 v58, v58
    v_mfma_f32_16x16x32_bf16 v[120:123], a[212:215], a[152:155], v[120:123]
    v_cvt_pk_bf16_f32 v220, v108, v109
    v_cvt_pk_bf16_f32 v221, v110, v111
    v_mfma_f32_16x16x32_bf16 v[120:123], a[216:219], a[156:159], v[120:123]
    v_add_f32 v20, v20, v40
    v_sub_f32 v44, v44, v12
    v_mfma_f32_16x16x32_bf16 v[120:123], a[220:223], a[160:163], v[120:123]
    v_exp_f32 v43, v43
    v_mfma_f32_16x16x32_bf16 v[120:123], a[224:227], a[164:167], v[120:123]
    buffer_store_dwordx2 v[252:253], v11, s[12:15], s38 offen offset:768 sc1
    v_mfma_f32_16x16x32_bf16 v[124:127], a[204:207], a[168:171], 0
    v_add_f32 v21, v21, v56
    v_sub_f32 v60, v60, v13
    v_mfma_f32_16x16x32_bf16 v[124:127], a[208:211], a[172:175], v[124:127]
    v_exp_f32 v59, v59
    v_mfma_f32_16x16x32_bf16 v[124:127], a[212:215], a[176:179], v[124:127]
    buffer_load_dwordx4 a[56:59], v9, s[8:11], s28 offen offset:128 nt
    v_cvt_pk_bf16_f32 v218, v120, v121
    v_mfma_f32_16x16x32_bf16 v[124:127], a[216:219], a[180:183], v[124:127]
    buffer_load_dwordx4 a[60:63], v10, s[8:11], s28 offen offset:128 nt
    v_cvt_pk_bf16_f32 v219, v122, v123
    v_mfma_f32_16x16x32_bf16 v[124:127], a[220:223], a[184:187], v[124:127]
    v_add_f32 v20, v20, v41
    v_sub_f32 v45, v45, v12
    v_mfma_f32_16x16x32_bf16 v[124:127], a[224:227], a[188:191], v[124:127]
    v_exp_f32 v44, v44
    v_mfma_f32_16x16x32_bf16 v[104:107], a[228:231], a[144:147], 0
    v_add_f32 v21, v21, v57
    s_waitcnt lgkmcnt(0)
    v_mfma_f32_16x16x32_bf16 v[104:107], a[232:235], a[148:151], v[104:107]
    v_exp_f32 v60, v60
    v_mfma_f32_16x16x32_bf16 v[104:107], a[236:239], a[152:155], v[104:107]
    ds_read_b128 a[192:195], v1 offset:55296
    v_cvt_pk_bf16_f32 v222, v124, v125
    v_mfma_f32_16x16x32_bf16 v[104:107], a[240:243], a[156:159], v[104:107]
    buffer_store_dwordx2 v[254:255], v11, s[12:15], s38 offen offset:1152 sc1
    v_mfma_f32_16x16x32_bf16 v[104:107], a[244:247], a[160:163], v[104:107]
    ds_read_b128 a[196:199], v1 offset:56320
    v_cvt_pk_bf16_f32 v223, v126, v127
    v_mfma_f32_16x16x32_bf16 v[104:107], a[248:251], a[164:167], v[104:107]
    v_sub_f32 v61, v61, v13
    v_add_f32 v20, v20, v42
    v_mfma_f32_16x16x32_bf16 v[108:111], a[228:231], a[168:171], 0
    ds_read_b128 a[200:203], v1 offset:57344
    v_sub_f32 v46, v46, v12
    v_mfma_f32_16x16x32_bf16 v[108:111], a[232:235], a[172:175], v[108:111]
    v_exp_f32 v45, v45
    v_mfma_f32_16x16x32_bf16 v[108:111], a[236:239], a[176:179], v[108:111]
    ds_read_b128 a[204:207], v1 offset:58368
    v_add_f32 v21, v21, v58
    v_mfma_f32_16x16x32_bf16 v[108:111], a[240:243], a[180:183], v[108:111]
    v_exp_f32 v61, v61
    v_mfma_f32_16x16x32_bf16 v[108:111], a[244:247], a[184:187], v[108:111]
    ds_read_b128 a[208:211], v1 offset:59392
    v_sub_f32 v62, v62, v13
    v_mfma_f32_16x16x32_bf16 v[108:111], a[248:251], a[188:191], v[108:111]
    v_add_f32 v20, v20, v43
    v_sub_f32 v47, v47, v12
    v_mfma_f32_16x16x32_bf16 v[64:67], a[104:107], v[200:203], v[64:67]
    ds_read_b128 a[212:215], v1 offset:60416
    v_add_f32 v21, v21, v59
    v_mfma_f32_16x16x32_bf16 v[64:67], a[108:111], v[216:219], v[64:67]
    v_exp_f32 v46, v46
    v_mfma_f32_16x16x32_bf16 v[68:71], a[128:131], v[200:203], v[68:71]
    buffer_store_dwordx2 v[160:161], v11, s[12:15], s32 offen offset:256 sc1
    v_mfma_f32_16x16x32_bf16 v[68:71], a[132:135], v[216:219], v[68:71]
    ds_read_b128 a[216:219], v1 offset:61440
    v_sub_f32 v63, v63, v13
    v_mfma_f32_16x16x32_bf16 v[72:75], a[152:155], v[200:203], v[72:75]
    ds_read_b128 a[220:223], v1 offset:62464
    v_add_f32 v20, v20, v44
    v_mfma_f32_16x16x32_bf16 v[72:75], a[156:159], v[216:219], v[72:75]
    v_exp_f32 v62, v62
    v_mfma_f32_16x16x32_bf16 v[76:79], a[176:179], v[200:203], v[76:79]
    ds_read_b128 a[224:227], v1 offset:63488
    v_cvt_pk_bf16_f32 v200, v104, v105
    v_mfma_f32_16x16x32_bf16 v[76:79], a[180:183], v[216:219], v[76:79]
    v_cvt_pk_bf16_f32 v201, v106, v107
    v_add_f32 v21, v21, v60
    v_mfma_f32_16x16x32_bf16 v[80:83], a[104:107], v[204:207], v[80:83]
    ds_read_b128 a[228:231], v1 offset:64512
    v_add_f32 v20, v20, v45
    v_mfma_f32_16x16x32_bf16 v[80:83], a[108:111], v[220:223], v[80:83]
    v_exp_f32 v47, v47
    v_mfma_f32_16x16x32_bf16 v[84:87], a[128:131], v[204:207], v[84:87]
    ds_read_b128 a[232:235], v2 offset:0
    v_add_f32 v21, v21, v61
    v_mfma_f32_16x16x32_bf16 v[84:87], a[132:135], v[220:223], v[84:87]
    v_exp_f32 v63, v63
    v_mfma_f32_16x16x32_bf16 v[88:91], a[152:155], v[204:207], v[88:91]
    buffer_store_dwordx2 v[162:163], v11, s[12:15], s32 offen offset:640 sc1
    v_mfma_f32_16x16x32_bf16 v[88:91], a[156:159], v[220:223], v[88:91]
    ds_read_b128 a[236:239], v2 offset:1024
    v_add_f32 v20, v20, v46
    v_mfma_f32_16x16x32_bf16 v[92:95], a[176:179], v[204:207], v[92:95]
    ds_read_b128 a[240:243], v2 offset:2048
    v_cvt_pk_bf16_f32 v204, v108, v109
    v_mfma_f32_16x16x32_bf16 v[92:95], a[180:183], v[220:223], v[92:95]
    v_cvt_pk_bf16_f32 v205, v110, v111
    s_waitcnt lgkmcnt(7)
    v_mfma_f32_16x16x32_bf16 v[120:123], a[192:195], a[144:147], 0
    ds_read_b128 a[244:247], v2 offset:3072
    v_add_f32 v21, v21, v62
    v_mfma_f32_16x16x32_bf16 v[120:123], a[196:199], a[148:151], v[120:123]
    v_add_f32 v20, v20, v47
    v_add_f32 v21, v21, v63
    v_mfma_f32_16x16x32_bf16 v[120:123], a[200:203], a[152:155], v[120:123]
    ds_read_b128 a[248:251], v2 offset:4096
    v_permlane16_swap_b32 v20, v21
    v_mfma_f32_16x16x32_bf16 v[120:123], a[204:207], a[156:159], v[120:123]
    v_add_f32 v20, v20, v21
    v_mov_b32 v21, v20
    v_mfma_f32_16x16x32_bf16 v[120:123], a[208:211], a[160:163], v[120:123]
    v_mfma_f32_16x16x32_bf16 v[120:123], a[212:215], a[164:167], v[120:123]
    v_permlane32_swap_b32 v20, v21
    v_add_f32 v20, v20, v21
    v_mfma_f32_16x16x32_bf16 v[124:127], a[192:195], a[168:171], 0
    v_rcp_f32 v20, v20
    v_mfma_f32_16x16x32_bf16 v[124:127], a[196:199], a[172:175], v[124:127]
    buffer_store_dwordx2 v[164:165], v11, s[12:15], s32 offen offset:1024 sc1
    v_mfma_f32_16x16x32_bf16 v[124:127], a[200:203], a[176:179], v[124:127]
    ds_read_b128 a[192:195], v2 offset:5120
    v_cvt_pk_bf16_f32 v202, v120, v121
    v_mfma_f32_16x16x32_bf16 v[124:127], a[204:207], a[180:183], v[124:127]
    ds_read_b128 a[196:199], v2 offset:6144
    v_cvt_pk_bf16_f32 v203, v122, v123
    v_mfma_f32_16x16x32_bf16 v[124:127], a[208:211], a[184:187], v[124:127]
    ds_read_b128 a[200:203], v2 offset:7168
    v_mov_b32 v21, v20
    v_mfma_f32_16x16x32_bf16 v[124:127], a[212:215], a[188:191], v[124:127]
    ds_read_b128 a[204:207], v2 offset:8192
    s_waitcnt lgkmcnt(6)
    v_mfma_f32_16x16x32_bf16 v[104:107], a[216:219], a[144:147], 0
    ds_read_b128 a[208:211], v2 offset:9216
    v_permlane16_swap_b32 v20, v21
    v_mfma_f32_16x16x32_bf16 v[104:107], a[220:223], a[148:151], v[104:107]
    v_mul_f32 v32, v32, v20
    v_mul_f32 v33, v33, v20
    v_mfma_f32_16x16x32_bf16 v[104:107], a[224:227], a[152:155], v[104:107]
    ds_read_b128 a[212:215], v2 offset:10240
    v_cvt_pk_bf16_f32 v206, v124, v125
    v_mfma_f32_16x16x32_bf16 v[104:107], a[228:231], a[156:159], v[104:107]
    v_cvt_pk_bf16_f32 v207, v126, v127
    v_cvt_pk_bf16_f32 v32, v32, v33
    v_mfma_f32_16x16x32_bf16 v[104:107], a[232:235], a[160:163], v[104:107]
    v_mul_f32 v34, v34, v20
    v_mul_f32 v35, v35, v20
    v_mfma_f32_16x16x32_bf16 v[104:107], a[236:239], a[164:167], v[104:107]
    buffer_store_dwordx2 v[166:167], v11, s[12:15], s32 offen offset:1408 sc1
    v_mfma_f32_16x16x32_bf16 v[108:111], a[216:219], a[168:171], 0
    v_cvt_pk_bf16_f32 v33, v34, v35
    v_mul_f32 v36, v36, v20
    v_mfma_f32_16x16x32_bf16 v[108:111], a[220:223], a[172:175], v[108:111]
    ds_read_b128 a[216:219], v2 offset:11264
    v_mul_f32 v37, v37, v20
    v_mfma_f32_16x16x32_bf16 v[108:111], a[224:227], a[176:179], v[108:111]
    ds_read_b128 a[220:223], v2 offset:12288
    v_cvt_pk_bf16_f32 v216, v104, v105
    v_mfma_f32_16x16x32_bf16 v[108:111], a[228:231], a[180:183], v[108:111]
    ds_read_b128 a[224:227], v2 offset:13312
    v_cvt_pk_bf16_f32 v217, v106, v107
    v_mfma_f32_16x16x32_bf16 v[108:111], a[232:235], a[184:187], v[108:111]
    v_mul_f32 v38, v38, v20
    v_mul_f32 v39, v39, v20
    v_mfma_f32_16x16x32_bf16 v[108:111], a[236:239], a[188:191], v[108:111]
    v_cvt_pk_bf16_f32 v34, v36, v37
    v_cvt_pk_bf16_f32 v35, v38, v39
    v_mfma_f32_16x16x32_bf16 v[120:123], a[240:243], a[144:147], 0
    buffer_load_dwordx4 a[64:67], v9, s[8:11], s28 offen offset:256 nt
    s_waitcnt lgkmcnt(5)
    v_mfma_f32_16x16x32_bf16 v[120:123], a[244:247], a[148:151], v[120:123]
    buffer_load_dwordx4 a[68:71], v10, s[8:11], s28 offen offset:256 nt
    v_mul_f32 v40, v40, v20
    v_mfma_f32_16x16x32_bf16 v[120:123], a[248:251], a[152:155], v[120:123]
    v_cvt_pk_bf16_f32 v220, v108, v109
    v_cvt_pk_bf16_f32 v221, v110, v111
    v_mfma_f32_16x16x32_bf16 v[120:123], a[192:195], a[156:159], v[120:123]
    v_mul_f32 v41, v41, v20
    v_mul_f32 v42, v42, v20
    v_mfma_f32_16x16x32_bf16 v[120:123], a[196:199], a[160:163], v[120:123]
    buffer_store_dwordx2 v[168:169], v11, s[12:15], s34 offen offset:256 sc1
    v_mfma_f32_16x16x32_bf16 v[120:123], a[200:203], a[164:167], v[120:123]
    v_mul_f32 v43, v43, v20
    v_mul_f32 v44, v44, v20
    v_mfma_f32_16x16x32_bf16 v[124:127], a[240:243], a[168:171], 0
    v_mul_f32 v45, v45, v20
    v_mul_f32 v46, v46, v20
    v_mfma_f32_16x16x32_bf16 v[124:127], a[244:247], a[172:175], v[124:127]
    v_mul_f32 v47, v47, v20
    v_cvt_pk_bf16_f32 v36, v40, v41
    v_mfma_f32_16x16x32_bf16 v[124:127], a[248:251], a[176:179], v[124:127]
    v_cvt_pk_bf16_f32 v218, v120, v121
    v_cvt_pk_bf16_f32 v219, v122, v123
    v_mfma_f32_16x16x32_bf16 v[124:127], a[192:195], a[180:183], v[124:127]
    v_cvt_pk_bf16_f32 v37, v42, v43
    v_cvt_pk_bf16_f32 v38, v44, v45
    v_mfma_f32_16x16x32_bf16 v[124:127], a[196:199], a[184:187], v[124:127]
    v_cvt_pk_bf16_f32 v39, v46, v47
    v_mul_f32 v48, v48, v21
    v_mfma_f32_16x16x32_bf16 v[124:127], a[200:203], a[188:191], v[124:127]
    v_mul_f32 v49, v49, v21
    v_mul_f32 v50, v50, v21
    v_mfma_f32_16x16x32_bf16 v[96:99], a[96:99], a[204:207], 0
    v_mul_f32 v51, v51, v21
    s_waitcnt lgkmcnt(0)
    v_mfma_f32_16x16x32_bf16 v[96:99], a[100:103], a[208:211], v[96:99]
    v_mul_f32 v52, v52, v21
    v_mul_f32 v53, v53, v21
    v_mfma_f32_16x16x32_bf16 v[96:99], a[104:107], a[212:215], v[96:99]
    buffer_store_dwordx2 v[170:171], v11, s[12:15], s34 offen offset:640 sc1
    v_mfma_f32_16x16x32_bf16 v[96:99], a[108:111], a[216:219], v[96:99]
    v_cvt_pk_bf16_f32 v222, v124, v125
    v_cvt_pk_bf16_f32 v223, v126, v127
    v_mfma_f32_16x16x32_bf16 v[96:99], a[112:115], a[220:223], v[96:99]
    v_mul_f32 v54, v54, v21
    v_mul_f32 v55, v55, v21
    v_mfma_f32_16x16x32_bf16 v[96:99], a[116:119], a[224:227], v[96:99]
    v_cvt_pk_bf16_f32 v40, v48, v49
    v_cvt_pk_bf16_f32 v41, v50, v51
    v_mfma_f32_16x16x32_bf16 v[100:103], a[120:123], a[204:207], 0
    v_cvt_pk_bf16_f32 v42, v52, v53
    v_cvt_pk_bf16_f32 v43, v54, v55
    v_mfma_f32_16x16x32_bf16 v[100:103], a[124:127], a[208:211], v[100:103]
    v_mul_f32 v56, v56, v21
    v_mul_f32 v57, v57, v21
    v_mfma_f32_16x16x32_bf16 v[100:103], a[128:131], a[212:215], v[100:103]
    v_cvt_pk_bf16_f32 v128, v96, v97
    v_cvt_pk_bf16_f32 v129, v98, v99
    v_mfma_f32_16x16x32_bf16 v[100:103], a[132:135], a[216:219], v[100:103]
    v_mul_f32 v58, v58, v21
    v_mul_f32 v59, v59, v21
    v_mfma_f32_16x16x32_bf16 v[100:103], a[136:139], a[220:223], v[100:103]
    v_mul_f32 v60, v60, v21
    v_mul_f32 v61, v61, v21
    v_mfma_f32_16x16x32_bf16 v[100:103], a[140:143], a[224:227], v[100:103]
    v_mul_f32 v62, v62, v21
    v_mul_f32 v63, v63, v21
    v_mfma_f32_16x16x32_bf16 v[64:67], a[112:115], v[200:203], v[64:67]
    v_cvt_pk_bf16_f32 v44, v56, v57
    v_cvt_pk_bf16_f32 v45, v58, v59
    v_mfma_f32_16x16x32_bf16 v[64:67], a[116:119], v[216:219], v[64:67]
    buffer_store_dwordx2 v[172:173], v11, s[12:15], s34 offen offset:1024 sc1
    v_mfma_f32_16x16x32_bf16 v[68:71], a[136:139], v[200:203], v[68:71]
    ds_read_b128 a[228:231], v2 offset:14336
    v_cvt_pk_bf16_f32 v130, v100, v101
    v_mfma_f32_16x16x32_bf16 v[68:71], a[140:143], v[216:219], v[68:71]
    v_cvt_pk_bf16_f32 v131, v102, v103
    v_cvt_pk_bf16_f32 v46, v60, v61
    v_mfma_f32_16x16x32_bf16 v[72:75], a[160:163], v[200:203], v[72:75]
    ds_read_b128 a[232:235], v2 offset:15360
    v_cvt_pk_bf16_f32 v47, v62, v63
    v_mfma_f32_16x16x32_bf16 v[72:75], a[164:167], v[216:219], v[72:75]
    v_max3_f32 v14, v64, v65, v66
    s_add_u32 s28, s16, 10223616
    v_mfma_f32_16x16x32_bf16 v[76:79], a[184:187], v[200:203], v[76:79]
    ds_read_b128 a[236:239], v2 offset:16384
    v_max3_f32 v14, v14, v67, v68
    v_mfma_f32_16x16x32_bf16 v[76:79], a[188:191], v[216:219], v[76:79]
    v_max3_f32 v14, v14, v69, v70
    v_mfma_f32_16x16x32_bf16 v[80:83], a[112:115], v[204:207], v[80:83]
    ds_read_b128 a[240:243], v2 offset:17408
    v_max3_f32 v14, v14, v71, v72
    v_mfma_f32_16x16x32_bf16 v[80:83], a[116:119], v[220:223], v[80:83]
    v_max3_f32 v14, v14, v73, v74
    v_mfma_f32_16x16x32_bf16 v[84:87], a[136:139], v[204:207], v[84:87]
    ds_read_b128 a[244:247], v2 offset:18432
    v_max3_f32 v14, v14, v75, v76
    v_mfma_f32_16x16x32_bf16 v[84:87], a[140:143], v[220:223], v[84:87]
    buffer_store_dwordx2 v[174:175], v11, s[12:15], s34 offen offset:1408 sc1
    v_mfma_f32_16x16x32_bf16 v[88:91], a[160:163], v[204:207], v[88:91]
    ds_read_b128 a[248:251], v2 offset:19456
    v_max3_f32 v15, v80, v81, v82
    v_mfma_f32_16x16x32_bf16 v[88:91], a[164:167], v[220:223], v[88:91]
    v_max3_f32 v14, v14, v77, v78
    v_max_f32 v14, v14, v79
    v_mfma_f32_16x16x32_bf16 v[92:95], a[184:187], v[204:207], v[92:95]
    v_max3_f32 v15, v15, v83, v84
    v_max3_f32 v15, v15, v85, v86
    v_mfma_f32_16x16x32_bf16 v[92:95], a[188:191], v[220:223], v[92:95]
    v_mfma_f32_16x16x32_bf16 v[104:107], a[144:147], a[204:207], 0
    v_max3_f32 v15, v15, v87, v88
    v_max3_f32 v15, v15, v89, v90
    v_mfma_f32_16x16x32_bf16 v[104:107], a[148:151], a[208:211], v[104:107]
    v_mfma_f32_16x16x32_bf16 v[104:107], a[152:155], a[212:215], v[104:107]
    v_max3_f32 v15, v15, v91, v92
    v_max3_f32 v15, v15, v93, v94
    v_mfma_f32_16x16x32_bf16 v[104:107], a[156:159], a[216:219], v[104:107]
    v_max_f32 v15, v15, v95
    v_mfma_f32_16x16x32_bf16 v[104:107], a[160:163], a[220:223], v[104:107]
    v_mfma_f32_16x16x32_bf16 v[104:107], a[164:167], a[224:227], v[104:107]
    v_permlane16_swap_b32 v14, v15
    v_max_f32 v14, v14, v15
    v_mfma_f32_16x16x32_bf16 v[108:111], a[168:171], a[204:207], 0
    buffer_store_dwordx2 v[176:177], v11, s[12:15], s36 offen offset:256 sc1
    v_mfma_f32_16x16x32_bf16 v[108:111], a[172:175], a[208:211], v[108:111]
    v_mov_b32 v15, v14
    v_mfma_f32_16x16x32_bf16 v[108:111], a[176:179], a[212:215], v[108:111]
    v_cvt_pk_bf16_f32 v132, v104, v105
    v_cvt_pk_bf16_f32 v133, v106, v107
    v_mfma_f32_16x16x32_bf16 v[108:111], a[180:183], a[216:219], v[108:111]
    v_permlane32_swap_b32 v14, v15
    v_max_f32 v14, v14, v15
    v_mfma_f32_16x16x32_bf16 v[108:111], a[184:187], a[220:223], v[108:111]
    ds_read_b128 a[192:195], v2 offset:20480
    v_mov_b32 v15, v14
    v_mfma_f32_16x16x32_bf16 v[108:111], a[188:191], a[224:227], v[108:111]
    s_waitcnt lgkmcnt(1)
    v_mfma_f32_16x16x32_bf16 v[112:115], a[96:99], a[228:231], 0
    ds_read_b128 a[196:199], v2 offset:21504
    v_permlane16_swap_b32 v14, v15
    v_mfma_f32_16x16x32_bf16 v[112:115], a[100:103], a[232:235], v[112:115]
    v_sub_f32 v64, v64, v14
    v_sub_f32 v65, v65, v14
    v_mfma_f32_16x16x32_bf16 v[112:115], a[104:107], a[236:239], v[112:115]
    ds_read_b128 a[200:203], v2 offset:22528
    v_cvt_pk_bf16_f32 v134, v108, v109
    v_mfma_f32_16x16x32_bf16 v[112:115], a[108:111], a[240:243], v[112:115]
    v_cvt_pk_bf16_f32 v135, v110, v111
    v_sub_f32 v80, v80, v15
    v_mfma_f32_16x16x32_bf16 v[112:115], a[112:115], a[244:247], v[112:115]
    buffer_store_dwordx2 v[178:179], v11, s[12:15], s36 offen offset:640 sc1
    v_mfma_f32_16x16x32_bf16 v[112:115], a[116:119], a[248:251], v[112:115]
    buffer_load_dwordx4 a[72:75], v9, s[8:11], s30 offen offset:0 nt
    v_sub_f32 v81, v81, v15
    v_mfma_f32_16x16x32_bf16 v[116:119], a[120:123], a[228:231], 0
    buffer_load_dwordx4 a[76:79], v10, s[8:11], s30 offen offset:0 nt
    v_sub_f32 v66, v66, v14
    v_mfma_f32_16x16x32_bf16 v[116:119], a[124:127], a[232:235], v[116:119]
    ds_read_b128 a[204:207], v2 offset:23552
    v_sub_f32 v82, v82, v15
    v_mfma_f32_16x16x32_bf16 v[116:119], a[128:131], a[236:239], v[116:119]
    ds_read_b128 a[208:211], v2 offset:24576
    v_cvt_pk_bf16_f32 v136, v112, v113
    v_mfma_f32_16x16x32_bf16 v[116:119], a[132:135], a[240:243], v[116:119]
    ds_read_b128 a[212:215], v2 offset:25600
    v_cvt_pk_bf16_f32 v137, v114, v115
    v_mfma_f32_16x16x32_bf16 v[116:119], a[136:139], a[244:247], v[116:119]
    v_exp_f32 v64, v64
    v_mfma_f32_16x16x32_bf16 v[116:119], a[140:143], a[248:251], v[116:119]
    v_exp_f32 v65, v65
    v_mfma_f32_16x16x32_bf16 v[120:123], a[144:147], a[228:231], 0
    v_exp_f32 v80, v80
    v_mfma_f32_16x16x32_bf16 v[120:123], a[148:151], a[232:235], v[120:123]
    v_exp_f32 v81, v81
    v_mfma_f32_16x16x32_bf16 v[120:123], a[152:155], a[236:239], v[120:123]
    v_cvt_pk_bf16_f32 v138, v116, v117
    v_cvt_pk_bf16_f32 v139, v118, v119
    v_mfma_f32_16x16x32_bf16 v[120:123], a[156:159], a[240:243], v[120:123]
    buffer_store_dwordx2 v[180:181], v11, s[12:15], s36 offen offset:1024 sc1
    v_mfma_f32_16x16x32_bf16 v[120:123], a[160:163], a[244:247], v[120:123]
    v_exp_f32 v66, v66
    v_mfma_f32_16x16x32_bf16 v[120:123], a[164:167], a[248:251], v[120:123]
    v_sub_f32 v67, v67, v14
    v_sub_f32 v83, v83, v15
    v_mfma_f32_16x16x32_bf16 v[124:127], a[168:171], a[228:231], 0
    v_exp_f32 v82, v82
    v_mfma_f32_16x16x32_bf16 v[124:127], a[172:175], a[232:235], v[124:127]
    v_exp_f32 v67, v67
    v_mfma_f32_16x16x32_bf16 v[124:127], a[176:179], a[236:239], v[124:127]
    v_cvt_pk_bf16_f32 v140, v120, v121
    v_cvt_pk_bf16_f32 v141, v122, v123
    v_mfma_f32_16x16x32_bf16 v[124:127], a[180:183], a[240:243], v[124:127]
    v_sub_f32 v68, v68, v14
    v_sub_f32 v84, v84, v15
    v_mfma_f32_16x16x32_bf16 v[124:127], a[184:187], a[244:247], v[124:127]
    ds_read_b128 a[216:219], v2 offset:26624
    v_add_f32 v22, v64, v65
    v_mfma_f32_16x16x32_bf16 v[124:127], a[188:191], a[248:251], v[124:127]
    v_sub_f32 v69, v69, v14
    s_waitcnt lgkmcnt(1)
    v_mfma_f32_16x16x32_bf16 v[96:99], a[96:99], a[192:195], 0
    ds_read_b128 a[220:223], v2 offset:27648
    v_add_f32 v23, v80, v81
    v_mfma_f32_16x16x32_bf16 v[96:99], a[100:103], a[196:199], v[96:99]
    buffer_store_dwordx2 v[182:183], v11, s[12:15], s36 offen offset:1408 sc1
    v_mfma_f32_16x16x32_bf16 v[96:99], a[104:107], a[200:203], v[96:99]
    ds_read_b128 a[224:227], v2 offset:28672
    v_cvt_pk_bf16_f32 v142, v124, v125
    v_mfma_f32_16x16x32_bf16 v[96:99], a[108:111], a[204:207], v[96:99]
    v_cvt_pk_bf16_f32 v143, v126, v127
    v_sub_f32 v85, v85, v15
    v_mfma_f32_16x16x32_bf16 v[96:99], a[112:115], a[208:211], v[96:99]
    ds_read_b128 a[228:231], v2 offset:29696
    v_add_f32 v22, v22, v66
    v_mfma_f32_16x16x32_bf16 v[96:99], a[116:119], a[212:215], v[96:99]
    v_exp_f32 v83, v83
    v_mfma_f32_16x16x32_bf16 v[100:103], a[120:123], a[192:195], 0
    ds_read_b128 a[232:235], v2 offset:30720
    v_sub_f32 v70, v70, v14
    v_mfma_f32_16x16x32_bf16 v[100:103], a[124:127], a[196:199], v[100:103]
    v_exp_f32 v68, v68
    v_mfma_f32_16x16x32_bf16 v[100:103], a[128:131], a[200:203], v[100:103]
    ds_read_b128 a[236:239], v2 offset:31744
    v_cvt_pk_bf16_f32 v144, v96, v97
    v_mfma_f32_16x16x32_bf16 v[100:103], a[132:135], a[204:207], v[100:103]
    v_cvt_pk_bf16_f32 v145, v98, v99
    v_add_f32 v23, v23, v82
    v_mfma_f32_16x16x32_bf16 v[100:103], a[136:139], a[208:211], v[100:103]
    v_exp_f32 v84, v84
    v_mfma_f32_16x16x32_bf16 v[100:103], a[140:143], a[212:215], v[100:103]
    v_exp_f32 v69, v69
    v_mfma_f32_16x16x32_bf16 v[104:107], a[144:147], a[192:195], 0
    buffer_store_dwordx2 v[184:185], v11, s[12:15], s38 offen offset:256 sc1
    v_mfma_f32_16x16x32_bf16 v[104:107], a[148:151], a[196:199], v[104:107]
    v_exp_f32 v85, v85
    v_mfma_f32_16x16x32_bf16 v[104:107], a[152:155], a[200:203], v[104:107]
    v_cvt_pk_bf16_f32 v146, v100, v101
    v_cvt_pk_bf16_f32 v147, v102, v103
    v_mfma_f32_16x16x32_bf16 v[104:107], a[156:159], a[204:207], v[104:107]
    v_sub_f32 v86, v86, v15
    v_add_f32 v22, v22, v67
    v_mfma_f32_16x16x32_bf16 v[104:107], a[160:163], a[208:211], v[104:107]
    v_exp_f32 v70, v70
    v_mfma_f32_16x16x32_bf16 v[104:107], a[164:167], a[212:215], v[104:107]
    v_sub_f32 v71, v71, v14
    v_add_f32 v23, v23, v83
    v_mfma_f32_16x16x32_bf16 v[108:111], a[168:171], a[192:195], 0
    v_exp_f32 v86, v86
    v_mfma_f32_16x16x32_bf16 v[108:111], a[172:175], a[196:199], v[108:111]
    v_sub_f32 v87, v87, v15
    v_add_f32 v22, v22, v68
    v_mfma_f32_16x16x32_bf16 v[108:111], a[176:179], a[200:203], v[108:111]
    v_cvt_pk_bf16_f32 v148, v104, v105
    v_cvt_pk_bf16_f32 v149, v106, v107
    v_mfma_f32_16x16x32_bf16 v[108:111], a[180:183], a[204:207], v[108:111]
    v_exp_f32 v71, v71
    v_mfma_f32_16x16x32_bf16 v[108:111], a[184:187], a[208:211], v[108:111]
    buffer_store_dwordx2 v[186:187], v11, s[12:15], s38 offen offset:640 sc1
    v_mfma_f32_16x16x32_bf16 v[108:111], a[188:191], a[212:215], v[108:111]
    v_sub_f32 v72, v72, v14
    s_waitcnt lgkmcnt(0)
    v_mfma_f32_16x16x32_bf16 v[112:115], a[96:99], a[216:219], 0
    v_add_f32 v23, v23, v84
    v_sub_f32 v88, v88, v15
    v_mfma_f32_16x16x32_bf16 v[112:115], a[100:103], a[220:223], v[112:115]
    v_exp_f32 v87, v87
    v_mfma_f32_16x16x32_bf16 v[112:115], a[104:107], a[224:227], v[112:115]
    v_cvt_pk_bf16_f32 v150, v108, v109
    v_cvt_pk_bf16_f32 v151, v110, v111
    v_mfma_f32_16x16x32_bf16 v[112:115], a[108:111], a[228:231], v[112:115]
    v_add_f32 v22, v22, v69
    v_sub_f32 v73, v73, v14
    v_mfma_f32_16x16x32_bf16 v[112:115], a[112:115], a[232:235], v[112:115]
    v_exp_f32 v72, v72
    v_mfma_f32_16x16x32_bf16 v[112:115], a[116:119], a[236:239], v[112:115]
    v_add_f32 v23, v23, v85
    v_sub_f32 v89, v89, v15
    v_mfma_f32_16x16x32_bf16 v[116:119], a[120:123], a[216:219], 0
    v_exp_f32 v88, v88
    v_mfma_f32_16x16x32_bf16 v[116:119], a[124:127], a[220:223], v[116:119]
    v_add_f32 v22, v22, v70
    v_sub_f32 v74, v74, v14
    v_mfma_f32_16x16x32_bf16 v[116:119], a[128:131], a[224:227], v[116:119]
    v_cvt_pk_bf16_f32 v152, v112, v113
    v_cvt_pk_bf16_f32 v153, v114, v115
    v_mfma_f32_16x16x32_bf16 v[116:119], a[132:135], a[228:231], v[116:119]
    buffer_store_dwordx2 v[188:189], v11, s[12:15], s38 offen offset:1024 sc1
    v_mfma_f32_16x16x32_bf16 v[116:119], a[136:139], a[232:235], v[116:119]
    v_exp_f32 v73, v73
    v_mfma_f32_16x16x32_bf16 v[116:119], a[140:143], a[236:239], v[116:119]
    v_add_f32 v23, v23, v86
    v_sub_f32 v90, v90, v15
    v_mfma_f32_16x16x32_bf16 v[120:123], a[144:147], a[216:219], 0
    buffer_load_dwordx4 a[80:83], v9, s[8:11], s30 offen offset:128 nt
    v_add_f32 v22, v22, v71
    v_mfma_f32_16x16x32_bf16 v[120:123], a[148:151], a[220:223], v[120:123]
    buffer_load_dwordx4 a[84:87], v10, s[8:11], s30 offen offset:128 nt
    v_sub_f32 v75, v75, v14
    v_mfma_f32_16x16x32_bf16 v[120:123], a[152:155], a[224:227], v[120:123]
    ds_read_b128 a[240:243], v2 offset:32768
    v_cvt_pk_bf16_f32 v154, v116, v117
    v_mfma_f32_16x16x32_bf16 v[120:123], a[156:159], a[228:231], v[120:123]
    v_cvt_pk_bf16_f32 v155, v118, v119
    v_add_f32 v23, v23, v87
    v_mfma_f32_16x16x32_bf16 v[120:123], a[160:163], a[232:235], v[120:123]
    ds_read_b128 a[244:247], v2 offset:33792
    v_sub_f32 v91, v91, v15
    v_mfma_f32_16x16x32_bf16 v[120:123], a[164:167], a[236:239], v[120:123]
    v_exp_f32 v89, v89
    v_mfma_f32_16x16x32_bf16 v[124:127], a[168:171], a[216:219], 0
    ds_read_b128 a[248:251], v2 offset:34816
    v_add_f32 v22, v22, v72
    v_mfma_f32_16x16x32_bf16 v[124:127], a[172:175], a[220:223], v[124:127]
    buffer_store_dwordx2 v[190:191], v11, s[12:15], s38 offen offset:1408 sc1
    v_mfma_f32_16x16x32_bf16 v[124:127], a[176:179], a[224:227], v[124:127]
    ds_read_b128 a[192:195], v2 offset:35840
    v_cvt_pk_bf16_f32 v156, v120, v121
    v_mfma_f32_16x16x32_bf16 v[124:127], a[180:183], a[228:231], v[124:127]
    v_cvt_pk_bf16_f32 v157, v122, v123
    v_sub_f32 v76, v76, v14
    v_mfma_f32_16x16x32_bf16 v[124:127], a[184:187], a[232:235], v[124:127]
    ds_read_b128 a[196:199], v2 offset:36864
    v_add_f32 v23, v23, v88
    v_mfma_f32_16x16x32_bf16 v[124:127], a[188:191], a[236:239], v[124:127]
    v_exp_f32 v74, v74
    v_mfma_f32_16x16x32_bf16 v[192:195], v[32:35], v[128:131], 0
    ds_read_b128 a[200:203], v2 offset:37888
    v_sub_f32 v92, v92, v15
    v_mfma_f32_16x16x32_bf16 v[192:195], v[36:39], v[132:135], v[192:195]
    v_exp_f32 v90, v90
    v_mfma_f32_16x16x32_bf16 v[196:199], v[32:35], v[136:139], 0
    v_cvt_pk_bf16_f32 v158, v124, v125
    v_cvt_pk_bf16_f32 v159, v126, v127
    v_mfma_f32_16x16x32_bf16 v[196:199], v[36:39], v[140:143], v[196:199]
    v_exp_f32 v75, v75
    v_mfma_f32_16x16x32_bf16 v[200:203], v[32:35], v[144:147], 0
    v_exp_f32 v91, v91
    v_mfma_f32_16x16x32_bf16 v[200:203], v[36:39], v[148:151], v[200:203]
    v_add_f32 v22, v22, v73
    v_sub_f32 v77, v77, v14
    v_mfma_f32_16x16x32_bf16 v[204:207], v[32:35], v[152:155], 0
    v_cvt_pk_bf16_f32 v224, v192, v196
    v_cvt_pk_bf16_f32 v226, v193, v197
    v_mfma_f32_16x16x32_bf16 v[204:207], v[36:39], v[156:159], v[204:207]
    v_cvt_pk_bf16_f32 v228, v194, v198
    v_cvt_pk_bf16_f32 v230, v195, v199
    v_mfma_f32_16x16x32_bf16 v[208:211], v[40:43], v[128:131], 0
    v_exp_f32 v76, v76
    v_mfma_f32_16x16x32_bf16 v[208:211], v[44:47], v[132:135], v[208:211]
    v_add_f32 v23, v23, v89
    v_sub_f32 v93, v93, v15
    v_mfma_f32_16x16x32_bf16 v[212:215], v[40:43], v[136:139], 0
    v_cvt_pk_bf16_f32 v225, v200, v204
    v_cvt_pk_bf16_f32 v227, v201, v205
    v_mfma_f32_16x16x32_bf16 v[212:215], v[44:47], v[140:143], v[212:215]
    v_cvt_pk_bf16_f32 v229, v202, v206
    v_cvt_pk_bf16_f32 v231, v203, v207
    v_mfma_f32_16x16x32_bf16 v[216:219], v[40:43], v[144:147], 0
    v_exp_f32 v92, v92
    v_mfma_f32_16x16x32_bf16 v[216:219], v[44:47], v[148:151], v[216:219]
    v_add_f32 v22, v22, v74
    v_sub_f32 v78, v78, v14
    v_mfma_f32_16x16x32_bf16 v[220:223], v[40:43], v[152:155], 0
    ds_read_b128 a[204:207], v2 offset:38912
    v_add_f32 v23, v23, v90
    v_mfma_f32_16x16x32_bf16 v[220:223], v[44:47], v[156:159], v[220:223]
    v_sub_f32 v94, v94, v15
    s_waitcnt lgkmcnt(1)
    v_mfma_f32_16x16x32_bf16 v[96:99], a[96:99], a[240:243], 0
    ds_read_b128 a[208:211], v2 offset:39936
    v_add_f32 v22, v22, v75
    v_mfma_f32_16x16x32_bf16 v[96:99], a[100:103], a[244:247], v[96:99]
    v_exp_f32 v77, v77
    v_mfma_f32_16x16x32_bf16 v[96:99], a[104:107], a[248:251], v[96:99]
    ds_read_b128 a[212:215], v2 offset:40960
    v_sub_f32 v79, v79, v14
    v_mfma_f32_16x16x32_bf16 v[96:99], a[108:111], a[192:195], v[96:99]
    v_exp_f32 v93, v93
    v_mfma_f32_16x16x32_bf16 v[96:99], a[112:115], a[196:199], v[96:99]
    ds_read_b128 a[216:219], v2 offset:41984
    v_add_f32 v23, v23, v91
    v_mfma_f32_16x16x32_bf16 v[96:99], a[116:119], a[200:203], v[96:99]
    v_exp_f32 v78, v78
    v_mfma_f32_16x16x32_bf16 v[100:103], a[120:123], a[240:243], 0
    ds_read_b128 a[220:223], v2 offset:43008
    v_sub_f32 v95, v95, v15
    v_mfma_f32_16x16x32_bf16 v[100:103], a[124:127], a[244:247], v[100:103]
    v_exp_f32 v94, v94
    v_mfma_f32_16x16x32_bf16 v[100:103], a[128:131], a[248:251], v[100:103]
    ds_read_b128 a[224:227], v2 offset:44032
    v_add_f32 v22, v22, v76
    v_mfma_f32_16x16x32_bf16 v[100:103], a[132:135], a[192:195], v[100:103]
    buffer_store_dwordx2 v[224:225], v11, s[12:15], s33 offen offset:0 sc1
    v_mfma_f32_16x16x32_bf16 v[100:103], a[136:139], a[196:199], v[100:103]
    v_exp_f32 v79, v79
    v_mfma_f32_16x16x32_bf16 v[100:103], a[140:143], a[200:203], v[100:103]
    v_add_f32 v23, v23, v92
    v_add_f32 v22, v22, v77
    v_mfma_f32_16x16x32_bf16 v[104:107], a[144:147], a[240:243], 0
    v_exp_f32 v95, v95
    v_mfma_f32_16x16x32_bf16 v[104:107], a[148:151], a[244:247], v[104:107]
    v_add_f32 v23, v23, v93
    v_add_f32 v22, v22, v78
    v_mfma_f32_16x16x32_bf16 v[104:107], a[152:155], a[248:251], v[104:107]
    v_add_f32 v23, v23, v94
    v_add_f32 v22, v22, v79
    v_mfma_f32_16x16x32_bf16 v[104:107], a[156:159], a[192:195], v[104:107]
    v_add_f32 v23, v23, v95
    v_cvt_pk_bf16_f32 v232, v208, v212
    v_mfma_f32_16x16x32_bf16 v[104:107], a[160:163], a[196:199], v[104:107]
    buffer_store_dwordx2 v[226:227], v11, s[12:15], s33 offen offset:384 sc1
    v_mfma_f32_16x16x32_bf16 v[104:107], a[164:167], a[200:203], v[104:107]
    v_cvt_pk_bf16_f32 v233, v216, v220
    v_permlane16_swap_b32 v22, v23
    v_mfma_f32_16x16x32_bf16 v[108:111], a[168:171], a[240:243], 0
    v_add_f32 v22, v22, v23
    v_mov_b32 v23, v22
    v_mfma_f32_16x16x32_bf16 v[108:111], a[172:175], a[244:247], v[108:111]
    v_cvt_pk_bf16_f32 v234, v209, v213
    v_permlane32_swap_b32 v22, v23
    v_mfma_f32_16x16x32_bf16 v[108:111], a[176:179], a[248:251], v[108:111]
    v_add_f32 v22, v22, v23
    v_cvt_pk_bf16_f32 v235, v217, v221
    v_mfma_f32_16x16x32_bf16 v[108:111], a[180:183], a[192:195], v[108:111]
    v_rcp_f32 v22, v22
    v_mfma_f32_16x16x32_bf16 v[108:111], a[184:187], a[196:199], v[108:111]
    v_mov_b32 v23, v22
    v_cvt_pk_bf16_f32 v236, v210, v214
    v_mfma_f32_16x16x32_bf16 v[108:111], a[188:191], a[200:203], v[108:111]
    buffer_store_dwordx2 v[228:229], v11, s[12:15], s33 offen offset:768 sc1
    s_waitcnt lgkmcnt(0)
    v_mfma_f32_16x16x32_bf16 v[112:115], a[96:99], a[204:207], 0
    v_permlane16_swap_b32 v22, v23
    v_mul_f32 v64, v64, v22
    v_mfma_f32_16x16x32_bf16 v[112:115], a[100:103], a[208:211], v[112:115]
    v_mul_f32 v65, v65, v22
    v_mul_f32 v66, v66, v22
    v_mfma_f32_16x16x32_bf16 v[112:115], a[104:107], a[212:215], v[112:115]
    v_mul_f32 v67, v67, v22
    v_mul_f32 v68, v68, v22
    v_mfma_f32_16x16x32_bf16 v[112:115], a[108:111], a[216:219], v[112:115]
    v_mul_f32 v69, v69, v22
    v_mul_f32 v70, v70, v22
    v_mfma_f32_16x16x32_bf16 v[112:115], a[112:115], a[220:223], v[112:115]
    buffer_load_dwordx4 a[88:91], v9, s[8:11], s30 offen offset:256 nt
    v_mul_f32 v71, v71, v22
    v_mfma_f32_16x16x32_bf16 v[112:115], a[116:119], a[224:227], v[112:115]
    buffer_load_dwordx4 a[92:95], v10, s[8:11], s30 offen offset:256 nt
    v_cvt_pk_bf16_f32 v48, v64, v65
    v_mfma_f32_16x16x32_bf16 v[116:119], a[120:123], a[204:207], 0
    buffer_store_dwordx2 v[230:231], v11, s[12:15], s33 offen offset:1152 sc1
    v_mfma_f32_16x16x32_bf16 v[116:119], a[124:127], a[208:211], v[116:119]
    v_cvt_pk_bf16_f32 v49, v66, v67
    v_cvt_pk_bf16_f32 v50, v68, v69
    v_mfma_f32_16x16x32_bf16 v[116:119], a[128:131], a[212:215], v[116:119]
    v_cvt_pk_bf16_f32 v51, v70, v71
    v_mul_f32 v72, v72, v22
    v_mfma_f32_16x16x32_bf16 v[116:119], a[132:135], a[216:219], v[116:119]
    v_mul_f32 v73, v73, v22
    v_mul_f32 v74, v74, v22
    v_mfma_f32_16x16x32_bf16 v[116:119], a[136:139], a[220:223], v[116:119]
    v_mul_f32 v75, v75, v22
    v_mul_f32 v76, v76, v22
    v_mfma_f32_16x16x32_bf16 v[116:119], a[140:143], a[224:227], v[116:119]
    v_mul_f32 v77, v77, v22
    v_mul_f32 v78, v78, v22
    v_mfma_f32_16x16x32_bf16 v[120:123], a[144:147], a[204:207], 0
    v_mul_f32 v79, v79, v22
    v_cvt_pk_bf16_f32 v52, v72, v73
    v_mfma_f32_16x16x32_bf16 v[120:123], a[148:151], a[208:211], v[120:123]
    buffer_store_dwordx2 v[232:233], v11, s[12:15], s35 offen offset:0 sc1
    v_mfma_f32_16x16x32_bf16 v[120:123], a[152:155], a[212:215], v[120:123]
    ds_read_b128 a[228:231], v2 offset:45056
    v_cvt_pk_bf16_f32 v53, v74, v75
    v_mfma_f32_16x16x32_bf16 v[120:123], a[156:159], a[216:219], v[120:123]
    v_cvt_pk_bf16_f32 v54, v76, v77
    v_cvt_pk_bf16_f32 v55, v78, v79
    v_mfma_f32_16x16x32_bf16 v[120:123], a[160:163], a[220:223], v[120:123]
    ds_read_b128 a[232:235], v2 offset:46080
    v_mul_f32 v80, v80, v23
    v_mfma_f32_16x16x32_bf16 v[120:123], a[164:167], a[224:227], v[120:123]
    v_mul_f32 v81, v81, v23
    v_mul_f32 v82, v82, v23
    v_mfma_f32_16x16x32_bf16 v[124:127], a[168:171], a[204:207], 0
    ds_read_b128 a[236:239], v2 offset:47104
    v_mul_f32 v83, v83, v23
    v_mfma_f32_16x16x32_bf16 v[124:127], a[172:175], a[208:211], v[124:127]
    v_mul_f32 v84, v84, v23
    v_mul_f32 v85, v85, v23
    v_mfma_f32_16x16x32_bf16 v[124:127], a[176:179], a[212:215], v[124:127]
    buffer_store_dwordx2 v[234:235], v11, s[12:15], s35 offen offset:384 sc1
    v_mfma_f32_16x16x32_bf16 v[124:127], a[180:183], a[216:219], v[124:127]
    ds_read_b128 a[240:243], v2 offset:48128
    v_mul_f32 v86, v86, v23
    v_mfma_f32_16x16x32_bf16 v[124:127], a[184:187], a[220:223], v[124:127]
    ds_read_b128 a[244:247], v2 offset:49152
    v_mul_f32 v87, v87, v23
    v_mfma_f32_16x16x32_bf16 v[124:127], a[188:191], a[224:227], v[124:127]
    v_cvt_pk_bf16_f32 v56, v80, v81
    v_cvt_pk_bf16_f32 v57, v82, v83
    v_mfma_f32_16x16x32_bf16 v[64:67], v[48:51], v[128:131], 0
    ds_read_b128 a[248:251], v2 offset:50176
    v_cvt_pk_bf16_f32 v58, v84, v85
    v_mfma_f32_16x16x32_bf16 v[64:67], v[52:55], v[132:135], v[64:67]
    v_cvt_pk_bf16_f32 v59, v86, v87
    v_mul_f32 v88, v88, v23
    v_mfma_f32_16x16x32_bf16 v[68:71], v[48:51], v[136:139], 0
    v_mul_f32 v89, v89, v23
    v_mul_f32 v90, v90, v23
    v_mfma_f32_16x16x32_bf16 v[68:71], v[52:55], v[140:143], v[68:71]
    v_mul_f32 v91, v91, v23
    v_mul_f32 v92, v92, v23
    v_mfma_f32_16x16x32_bf16 v[72:75], v[48:51], v[144:147], 0
    v_mul_f32 v93, v93, v23
    v_mul_f32 v94, v94, v23
    v_mfma_f32_16x16x32_bf16 v[72:75], v[52:55], v[148:151], v[72:75]
    v_mul_f32 v95, v95, v23
    v_cvt_pk_bf16_f32 v60, v88, v89
    v_mfma_f32_16x16x32_bf16 v[76:79], v[48:51], v[152:155], 0
    v_cvt_pk_bf16_f32 v61, v90, v91
    v_cvt_pk_bf16_f32 v62, v92, v93
    v_mfma_f32_16x16x32_bf16 v[76:79], v[52:55], v[156:159], v[76:79]
    v_cvt_pk_bf16_f32 v63, v94, v95
    v_cvt_pk_bf16_f32 v237, v218, v222
    v_mfma_f32_16x16x32_bf16 v[80:83], v[56:59], v[128:131], 0
    buffer_store_dwordx2 v[236:237], v11, s[12:15], s35 offen offset:768 sc1
    v_mfma_f32_16x16x32_bf16 v[80:83], v[60:63], v[132:135], v[80:83]
    v_cvt_pk_bf16_f32 v238, v211, v215
    v_cvt_pk_bf16_f32 v239, v219, v223
    v_mfma_f32_16x16x32_bf16 v[84:87], v[56:59], v[136:139], 0
    buffer_store_dwordx2 v[238:239], v11, s[12:15], s35 offen offset:1152 sc1
    v_mfma_f32_16x16x32_bf16 v[84:87], v[60:63], v[140:143], v[84:87]
    v_cvt_pk_bf16_f32 v160, v96, v97
    v_cvt_pk_bf16_f32 v161, v98, v99
    v_mfma_f32_16x16x32_bf16 v[88:91], v[56:59], v[144:147], 0
    v_cvt_pk_bf16_f32 v162, v100, v101
    v_cvt_pk_bf16_f32 v163, v102, v103
    v_mfma_f32_16x16x32_bf16 v[88:91], v[60:63], v[148:151], v[88:91]
    v_cvt_pk_bf16_f32 v164, v104, v105
    v_cvt_pk_bf16_f32 v165, v106, v107
    v_mfma_f32_16x16x32_bf16 v[92:95], v[56:59], v[152:155], 0
    ds_read_b128 a[192:195], v2 offset:51200
    v_cvt_pk_bf16_f32 v240, v64, v68
    v_mfma_f32_16x16x32_bf16 v[92:95], v[60:63], v[156:159], v[92:95]
    v_cvt_pk_bf16_f32 v241, v72, v76
    s_waitcnt lgkmcnt(1)
    v_mfma_f32_16x16x32_bf16 v[96:99], a[96:99], a[228:231], 0
    ds_read_b128 a[196:199], v2 offset:52224
    v_cvt_pk_bf16_f32 v166, v108, v109
    v_mfma_f32_16x16x32_bf16 v[96:99], a[100:103], a[232:235], v[96:99]
    v_cvt_pk_bf16_f32 v167, v110, v111
    v_cvt_pk_bf16_f32 v242, v65, v69
    v_mfma_f32_16x16x32_bf16 v[96:99], a[104:107], a[236:239], v[96:99]
    ds_read_b128 a[200:203], v2 offset:53248
    v_cvt_pk_bf16_f32 v243, v73, v77
    v_mfma_f32_16x16x32_bf16 v[96:99], a[108:111], a[240:243], v[96:99]
    v_cvt_pk_bf16_f32 v168, v112, v113
    v_cvt_pk_bf16_f32 v169, v114, v115
    v_mfma_f32_16x16x32_bf16 v[96:99], a[112:115], a[244:247], v[96:99]
    ds_read_b128 a[204:207], v2 offset:54272
    v_cvt_pk_bf16_f32 v170, v116, v117
    v_mfma_f32_16x16x32_bf16 v[96:99], a[116:119], a[248:251], v[96:99]
    v_cvt_pk_bf16_f32 v171, v118, v119
    v_cvt_pk_bf16_f32 v244, v66, v70
    v_mfma_f32_16x16x32_bf16 v[100:103], a[120:123], a[228:231], 0
    ds_read_b128 a[208:211], v2 offset:55296
    v_cvt_pk_bf16_f32 v245, v74, v78
    v_mfma_f32_16x16x32_bf16 v[100:103], a[124:127], a[232:235], v[100:103]
    v_cvt_pk_bf16_f32 v172, v120, v121
    v_cvt_pk_bf16_f32 v173, v122, v123
    v_mfma_f32_16x16x32_bf16 v[100:103], a[128:131], a[236:239], v[100:103]
    buffer_store_dwordx2 v[240:241], v11, s[12:15], s37 offen offset:0 sc1
    v_mfma_f32_16x16x32_bf16 v[100:103], a[132:135], a[240:243], v[100:103]
    ds_read_b128 a[212:215], v2 offset:56320
    v_cvt_pk_bf16_f32 v246, v67, v71
    v_mfma_f32_16x16x32_bf16 v[100:103], a[136:139], a[244:247], v[100:103]
    v_cvt_pk_bf16_f32 v247, v75, v79
    v_cvt_pk_bf16_f32 v174, v124, v125
    v_mfma_f32_16x16x32_bf16 v[100:103], a[140:143], a[248:251], v[100:103]
    v_cvt_pk_bf16_f32 v175, v126, v127
    v_cvt_pk_bf16_f32 v248, v80, v84
    v_mfma_f32_16x16x32_bf16 v[104:107], a[144:147], a[228:231], 0
    v_cvt_pk_bf16_f32 v249, v88, v92
    v_cvt_pk_bf16_f32 v176, v96, v97
    v_mfma_f32_16x16x32_bf16 v[104:107], a[148:151], a[232:235], v[104:107]
    v_cvt_pk_bf16_f32 v177, v98, v99
    v_cvt_pk_bf16_f32 v250, v81, v85
    v_mfma_f32_16x16x32_bf16 v[104:107], a[152:155], a[236:239], v[104:107]
    v_cvt_pk_bf16_f32 v178, v100, v101
    v_cvt_pk_bf16_f32 v179, v102, v103
    v_mfma_f32_16x16x32_bf16 v[104:107], a[156:159], a[240:243], v[104:107]
    v_cvt_pk_bf16_f32 v251, v89, v93
    v_cvt_pk_bf16_f32 v252, v82, v86
    v_mfma_f32_16x16x32_bf16 v[104:107], a[160:163], a[244:247], v[104:107]
    buffer_store_dwordx2 v[242:243], v11, s[12:15], s37 offen offset:384 sc1
    v_mfma_f32_16x16x32_bf16 v[104:107], a[164:167], a[248:251], v[104:107]
    v_cvt_pk_bf16_f32 v254, v83, v87
    v_cvt_pk_bf16_f32 v253, v90, v94
    v_mfma_f32_16x16x32_bf16 v[108:111], a[168:171], a[228:231], 0
    v_cvt_pk_bf16_f32 v255, v91, v95
    s_add_u32 s30, s16, 10616832
    v_mfma_f32_16x16x32_bf16 v[108:111], a[172:175], a[232:235], v[108:111]
    s_add_u32 s16, s16, 6291456
    s_add_u32 s32, s16, 0
    v_mfma_f32_16x16x32_bf16 v[108:111], a[176:179], a[236:239], v[108:111]
    s_waitcnt vmcnt(63)
    ds_write_b64 v4, a[24:25] offset:0
    v_mfma_f32_16x16x32_bf16 v[108:111], a[180:183], a[240:243], v[108:111]
    ds_write_b64 v4, a[26:27] offset:1024
    v_mfma_f32_16x16x32_bf16 v[108:111], a[184:187], a[244:247], v[108:111]
    ds_write_b64 v4, a[28:29] offset:512
    v_mfma_f32_16x16x32_bf16 v[108:111], a[188:191], a[248:251], v[108:111]
    ds_write_b64 v4, a[30:31] offset:1536
    s_waitcnt lgkmcnt(4)
    v_mfma_f32_16x16x32_bf16 v[112:115], a[96:99], a[192:195], 0
    buffer_store_dwordx2 v[244:245], v11, s[12:15], s37 offen offset:768 sc1
    v_mfma_f32_16x16x32_bf16 v[112:115], a[100:103], a[196:199], v[112:115]
    ds_read2_b64 a[24:27], v5 offset0:0 offset1:128
    v_cvt_pk_bf16_f32 v180, v104, v105
    v_mfma_f32_16x16x32_bf16 v[112:115], a[104:107], a[200:203], v[112:115]
    ds_read2_b64 a[28:31], v6 offset0:0 offset1:128
    v_cvt_pk_bf16_f32 v181, v106, v107
    v_mfma_f32_16x16x32_bf16 v[112:115], a[108:111], a[204:207], v[112:115]
    v_cvt_pk_bf16_f32 v182, v108, v109
    v_cvt_pk_bf16_f32 v183, v110, v111
    v_mfma_f32_16x16x32_bf16 v[112:115], a[112:115], a[208:211], v[112:115]
    s_add_u32 s34, s16, 393216
    s_add_u32 s36, s16, 786432
    v_mfma_f32_16x16x32_bf16 v[112:115], a[116:119], a[212:215], v[112:115]
    s_add_u32 s38, s16, 1179648
    v_mfma_f32_16x16x32_bf16 v[116:119], a[120:123], a[192:195], 0
    v_mfma_f32_16x16x32_bf16 v[116:119], a[124:127], a[196:199], v[116:119]
    v_mfma_f32_16x16x32_bf16 v[116:119], a[128:131], a[200:203], v[116:119]
    buffer_store_dwordx2 v[246:247], v11, s[12:15], s37 offen offset:1152 sc1
    v_mfma_f32_16x16x32_bf16 v[116:119], a[132:135], a[204:207], v[116:119]
    v_cvt_pk_bf16_f32 v184, v112, v113
    v_cvt_pk_bf16_f32 v185, v114, v115
    v_mfma_f32_16x16x32_bf16 v[116:119], a[136:139], a[208:211], v[116:119]
    v_mfma_f32_16x16x32_bf16 v[116:119], a[140:143], a[212:215], v[116:119]
    v_mfma_f32_16x16x32_bf16 v[120:123], a[144:147], a[192:195], 0
    v_mfma_f32_16x16x32_bf16 v[120:123], a[148:151], a[196:199], v[120:123]
    v_mfma_f32_16x16x32_bf16 v[120:123], a[152:155], a[200:203], v[120:123]
    v_cvt_pk_bf16_f32 v186, v116, v117
    v_cvt_pk_bf16_f32 v187, v118, v119
    v_mfma_f32_16x16x32_bf16 v[120:123], a[156:159], a[204:207], v[120:123]
    v_mfma_f32_16x16x32_bf16 v[120:123], a[160:163], a[208:211], v[120:123]
    buffer_store_dwordx2 v[248:249], v11, s[12:15], s39 offen offset:0 sc1
    v_mfma_f32_16x16x32_bf16 v[120:123], a[164:167], a[212:215], v[120:123]
    s_waitcnt vmcnt(60)
    ds_write_b64 v4, a[32:33] offset:0
    v_mfma_f32_16x16x32_bf16 v[124:127], a[168:171], a[192:195], 0
    ds_write_b64 v4, a[34:35] offset:1024
    v_mfma_f32_16x16x32_bf16 v[124:127], a[172:175], a[196:199], v[124:127]
    ds_write_b64 v4, a[36:37] offset:512
    v_mfma_f32_16x16x32_bf16 v[124:127], a[176:179], a[200:203], v[124:127]
    ds_write_b64 v4, a[38:39] offset:1536
    v_mfma_f32_16x16x32_bf16 v[124:127], a[180:183], a[204:207], v[124:127]
    ds_read2_b64 a[32:35], v5 offset0:0 offset1:128
    v_cvt_pk_bf16_f32 v188, v120, v121
    v_mfma_f32_16x16x32_bf16 v[124:127], a[184:187], a[208:211], v[124:127]
    ds_read2_b64 a[36:39], v6 offset0:0 offset1:128
    v_cvt_pk_bf16_f32 v189, v122, v123
    v_mfma_f32_16x16x32_bf16 v[124:127], a[188:191], a[212:215], v[124:127]
    v_mfma_f32_16x16x32_bf16 v[64:67], v[32:35], v[160:163], 0
    buffer_store_dwordx2 v[250:251], v11, s[12:15], s39 offen offset:384 sc1
    v_mfma_f32_16x16x32_bf16 v[64:67], v[36:39], v[164:167], v[64:67]
    v_mfma_f32_16x16x32_bf16 v[68:71], v[32:35], v[168:171], 0
    v_cvt_pk_bf16_f32 v190, v124, v125
    v_cvt_pk_bf16_f32 v191, v126, v127
    v_mfma_f32_16x16x32_bf16 v[68:71], v[36:39], v[172:175], v[68:71]
    v_mfma_f32_16x16x32_bf16 v[72:75], v[32:35], v[176:179], 0
    v_mfma_f32_16x16x32_bf16 v[72:75], v[36:39], v[180:183], v[72:75]
    v_mfma_f32_16x16x32_bf16 v[76:79], v[32:35], v[184:187], 0
    ds_read_b128 a[216:219], v2 offset:57344
    v_cvt_pk_bf16_f32 v128, v64, v68
    v_mfma_f32_16x16x32_bf16 v[76:79], v[36:39], v[188:191], v[76:79]
    v_cvt_pk_bf16_f32 v130, v65, v69
    v_cvt_pk_bf16_f32 v132, v66, v70
    v_mfma_f32_16x16x32_bf16 v[80:83], v[40:43], v[160:163], 0
    buffer_store_dwordx2 v[252:253], v11, s[12:15], s39 offen offset:768 sc1
    v_mfma_f32_16x16x32_bf16 v[80:83], v[44:47], v[164:167], v[80:83]
    ds_read_b128 a[220:223], v2 offset:58368
    v_cvt_pk_bf16_f32 v134, v67, v71
    v_mfma_f32_16x16x32_bf16 v[84:87], v[40:43], v[168:171], 0
    ds_read_b128 a[224:227], v2 offset:59392
    v_cvt_pk_bf16_f32 v129, v72, v76
    v_mfma_f32_16x16x32_bf16 v[84:87], v[44:47], v[172:175], v[84:87]
    v_cvt_pk_bf16_f32 v131, v73, v77
    v_cvt_pk_bf16_f32 v133, v74, v78
    v_mfma_f32_16x16x32_bf16 v[88:91], v[40:43], v[176:179], 0
    ds_read_b128 a[228:231], v2 offset:60416
    v_cvt_pk_bf16_f32 v135, v75, v79
    v_mfma_f32_16x16x32_bf16 v[88:91], v[44:47], v[180:183], v[88:91]
    s_waitcnt vmcnt(55)
    ds_write_b64 v4, a[40:41] offset:0
    v_mfma_f32_16x16x32_bf16 v[92:95], v[40:43], v[184:187], 0
    ds_read_b128 a[232:235], v2 offset:61440
    v_cvt_pk_bf16_f32 v136, v80, v84
    v_mfma_f32_16x16x32_bf16 v[92:95], v[44:47], v[188:191], v[92:95]
    ds_write_b64 v4, a[42:43] offset:1024
    v_mfma_f32_16x16x32_bf16 v[192:195], v[48:51], v[160:163], 0
    buffer_store_dwordx2 v[254:255], v11, s[12:15], s39 offen offset:1152 sc1
    v_mfma_f32_16x16x32_bf16 v[192:195], v[52:55], v[164:167], v[192:195]
    ds_read_b128 a[236:239], v2 offset:62464
    v_cvt_pk_bf16_f32 v138, v81, v85
    v_mfma_f32_16x16x32_bf16 v[196:199], v[48:51], v[168:171], 0
    ds_write_b64 v4, a[44:45] offset:512
    v_mfma_f32_16x16x32_bf16 v[196:199], v[52:55], v[172:175], v[196:199]
    ds_write_b64 v4, a[46:47] offset:1536
    v_mfma_f32_16x16x32_bf16 v[200:203], v[48:51], v[176:179], 0
    ds_read2_b64 a[40:43], v5 offset0:0 offset1:128
    v_cvt_pk_bf16_f32 v137, v88, v92
    v_mfma_f32_16x16x32_bf16 v[200:203], v[52:55], v[180:183], v[200:203]
    ds_read2_b64 a[44:47], v6 offset0:0 offset1:128
    v_cvt_pk_bf16_f32 v139, v89, v93
    v_mfma_f32_16x16x32_bf16 v[204:207], v[48:51], v[184:187], 0
    v_cvt_pk_bf16_f32 v144, v192, v196
    v_cvt_pk_bf16_f32 v146, v193, v197
    v_mfma_f32_16x16x32_bf16 v[204:207], v[52:55], v[188:191], v[204:207]
    v_cvt_pk_bf16_f32 v148, v194, v198
    v_cvt_pk_bf16_f32 v150, v195, v199
    v_mfma_f32_16x16x32_bf16 v[208:211], v[56:59], v[160:163], 0
    v_cvt_pk_bf16_f32 v140, v82, v86
    v_cvt_pk_bf16_f32 v141, v90, v94
    v_mfma_f32_16x16x32_bf16 v[208:211], v[60:63], v[164:167], v[208:211]
    v_cvt_pk_bf16_f32 v142, v83, v87
    v_cvt_pk_bf16_f32 v143, v91, v95
    v_mfma_f32_16x16x32_bf16 v[212:215], v[56:59], v[168:171], 0
    v_cvt_pk_bf16_f32 v145, v200, v204
    v_cvt_pk_bf16_f32 v147, v201, v205
    v_mfma_f32_16x16x32_bf16 v[212:215], v[60:63], v[172:175], v[212:215]
    v_cvt_pk_bf16_f32 v149, v202, v206
    v_cvt_pk_bf16_f32 v151, v203, v207
    v_mfma_f32_16x16x32_bf16 v[216:219], v[56:59], v[176:179], 0
    v_mfma_f32_16x16x32_bf16 v[216:219], v[60:63], v[180:183], v[216:219]
    v_mfma_f32_16x16x32_bf16 v[220:223], v[56:59], v[184:187], 0
    ds_read_b128 a[240:243], v2 offset:63488
    v_cvt_pk_bf16_f32 v152, v208, v212
    v_mfma_f32_16x16x32_bf16 v[220:223], v[60:63], v[188:191], v[220:223]
    v_cvt_pk_bf16_f32 v154, v209, v213
    s_waitcnt lgkmcnt(5)
    v_mfma_f32_16x16x32_bf16 v[96:99], a[96:99], a[216:219], 0
    ds_read_b128 a[244:247], v2 offset:64512
    v_cvt_pk_bf16_f32 v156, v210, v214
    v_mfma_f32_16x16x32_bf16 v[96:99], a[100:103], a[220:223], v[96:99]
    s_waitcnt vmcnt(48)
    ds_write_b64 v4, a[48:49] offset:0
    v_mfma_f32_16x16x32_bf16 v[96:99], a[104:107], a[224:227], v[96:99]
    ds_read_b128 a[248:251], v3 offset:0
    v_cvt_pk_bf16_f32 v158, v211, v215
    v_mfma_f32_16x16x32_bf16 v[96:99], a[108:111], a[228:231], v[96:99]
    ds_write_b64 v4, a[50:51] offset:1024
    v_mfma_f32_16x16x32_bf16 v[96:99], a[112:115], a[232:235], v[96:99]
    ds_read_b128 a[192:195], v3 offset:1024
    v_cvt_pk_bf16_f32 v153, v216, v220
    v_mfma_f32_16x16x32_bf16 v[96:99], a[116:119], a[236:239], v[96:99]
    ds_write_b64 v4, a[52:53] offset:512
    v_mfma_f32_16x16x32_bf16 v[100:103], a[120:123], a[216:219], 0
    ds_read_b128 a[196:199], v3 offset:2048
    v_cvt_pk_bf16_f32 v155, v217, v221
    v_mfma_f32_16x16x32_bf16 v[100:103], a[124:127], a[220:223], v[100:103]
    ds_write_b64 v4, a[54:55] offset:1536
    v_mfma_f32_16x16x32_bf16 v[100:103], a[128:131], a[224:227], v[100:103]
    ds_read_b128 a[200:203], v3 offset:3072
    v_cvt_pk_bf16_f32 v192, v96, v97
    v_mfma_f32_16x16x32_bf16 v[100:103], a[132:135], a[228:231], v[100:103]
    ds_read2_b64 a[48:51], v5 offset0:0 offset1:128
    v_cvt_pk_bf16_f32 v193, v98, v99
    v_mfma_f32_16x16x32_bf16 v[100:103], a[136:139], a[232:235], v[100:103]
    buffer_store_dwordx2 v[128:129], v11, s[12:15], s33 offen offset:128 sc1
    v_mfma_f32_16x16x32_bf16 v[100:103], a[140:143], a[236:239], v[100:103]
    ds_read2_b64 a[52:55], v6 offset0:0 offset1:128
    v_cvt_pk_bf16_f32 v157, v218, v222
    v_mfma_f32_16x16x32_bf16 v[104:107], a[144:147], a[216:219], 0
    v_cvt_pk_bf16_f32 v159, v219, v223
    v_mfma_f32_16x16x32_bf16 v[104:107], a[148:151], a[220:223], v[104:107]
    v_mfma_f32_16x16x32_bf16 v[104:107], a[152:155], a[224:227], v[104:107]
    v_cvt_pk_bf16_f32 v194, v100, v101
    v_cvt_pk_bf16_f32 v195, v102, v103
    v_mfma_f32_16x16x32_bf16 v[104:107], a[156:159], a[228:231], v[104:107]
    v_mfma_f32_16x16x32_bf16 v[104:107], a[160:163], a[232:235], v[104:107]
    v_mfma_f32_16x16x32_bf16 v[104:107], a[164:167], a[236:239], v[104:107]
    buffer_store_dwordx2 v[130:131], v11, s[12:15], s33 offen offset:512 sc1
    v_mfma_f32_16x16x32_bf16 v[108:111], a[168:171], a[216:219], 0
    v_mfma_f32_16x16x32_bf16 v[108:111], a[172:175], a[220:223], v[108:111]
    v_mfma_f32_16x16x32_bf16 v[108:111], a[176:179], a[224:227], v[108:111]
    s_waitcnt vmcnt(43)
    ds_write_b64 v4, a[56:57] offset:0
    v_mfma_f32_16x16x32_bf16 v[108:111], a[180:183], a[228:231], v[108:111]
    ds_write_b64 v4, a[58:59] offset:1024
    v_mfma_f32_16x16x32_bf16 v[108:111], a[184:187], a[232:235], v[108:111]
    ds_read_b128 a[204:207], v3 offset:4096
    v_cvt_pk_bf16_f32 v196, v104, v105
    v_mfma_f32_16x16x32_bf16 v[108:111], a[188:191], a[236:239], v[108:111]
    ds_write_b64 v4, a[60:61] offset:512
    s_waitcnt lgkmcnt(5)
    v_mfma_f32_16x16x32_bf16 v[112:115], a[96:99], a[240:243], 0
    buffer_store_dwordx2 v[132:133], v11, s[12:15], s33 offen offset:896 sc1
    v_mfma_f32_16x16x32_bf16 v[112:115], a[100:103], a[244:247], v[112:115]
    ds_read_b128 a[208:211], v3 offset:5120
    v_cvt_pk_bf16_f32 v197, v106, v107
    v_mfma_f32_16x16x32_bf16 v[112:115], a[104:107], a[248:251], v[112:115]
    ds_read_b128 a[212:215], v3 offset:6144
    v_cvt_pk_bf16_f32 v198, v108, v109
    v_mfma_f32_16x16x32_bf16 v[112:115], a[108:111], a[192:195], v[112:115]
    ds_write_b64 v4, a[62:63] offset:1536
    v_mfma_f32_16x16x32_bf16 v[112:115], a[112:115], a[196:199], v[112:115]
    ds_read_b128 a[216:219], v3 offset:7168
    v_cvt_pk_bf16_f32 v199, v110, v111
    v_mfma_f32_16x16x32_bf16 v[112:115], a[116:119], a[200:203], v[112:115]
    ds_read2_b64 a[56:59], v5 offset0:0 offset1:128
    v_mfma_f32_16x16x32_bf16 v[116:119], a[120:123], a[240:243], 0
    ds_read_b128 a[220:223], v3 offset:8192
    v_mfma_f32_16x16x32_bf16 v[116:119], a[124:127], a[244:247], v[116:119]
    buffer_store_dwordx2 v[134:135], v11, s[12:15], s33 offen offset:1280 sc1
    v_mfma_f32_16x16x32_bf16 v[116:119], a[128:131], a[248:251], v[116:119]
    ds_read_b128 a[224:227], v3 offset:9216
    v_cvt_pk_bf16_f32 v200, v112, v113
    v_mfma_f32_16x16x32_bf16 v[116:119], a[132:135], a[192:195], v[116:119]
    ds_read2_b64 a[60:63], v6 offset0:0 offset1:128
    v_cvt_pk_bf16_f32 v201, v114, v115
    v_mfma_f32_16x16x32_bf16 v[116:119], a[136:139], a[196:199], v[116:119]
    v_mfma_f32_16x16x32_bf16 v[116:119], a[140:143], a[200:203], v[116:119]
    v_mfma_f32_16x16x32_bf16 v[120:123], a[144:147], a[240:243], 0
    v_mfma_f32_16x16x32_bf16 v[120:123], a[148:151], a[244:247], v[120:123]
    v_mfma_f32_16x16x32_bf16 v[120:123], a[152:155], a[248:251], v[120:123]
    buffer_store_dwordx2 v[136:137], v11, s[12:15], s35 offen offset:128 sc1
    v_mfma_f32_16x16x32_bf16 v[120:123], a[156:159], a[192:195], v[120:123]
    v_cvt_pk_bf16_f32 v202, v116, v117
    v_cvt_pk_bf16_f32 v203, v118, v119
    v_mfma_f32_16x16x32_bf16 v[120:123], a[160:163], a[196:199], v[120:123]
    s_waitcnt vmcnt(39)
    ds_write_b64 v4, a[64:65] offset:0
    v_mfma_f32_16x16x32_bf16 v[120:123], a[164:167], a[200:203], v[120:123]
    ds_write_b64 v4, a[66:67] offset:1024
    v_mfma_f32_16x16x32_bf16 v[124:127], a[168:171], a[240:243], 0
    ds_write_b64 v4, a[68:69] offset:512
    v_mfma_f32_16x16x32_bf16 v[124:127], a[172:175], a[244:247], v[124:127]
    ds_write_b64 v4, a[70:71] offset:1536
    v_mfma_f32_16x16x32_bf16 v[124:127], a[176:179], a[248:251], v[124:127]
    ds_read2_b64 a[64:67], v5 offset0:0 offset1:128
    v_cvt_pk_bf16_f32 v204, v120, v121
    v_mfma_f32_16x16x32_bf16 v[124:127], a[180:183], a[192:195], v[124:127]
    buffer_store_dwordx2 v[138:139], v11, s[12:15], s35 offen offset:512 sc1
    v_mfma_f32_16x16x32_bf16 v[124:127], a[184:187], a[196:199], v[124:127]
    ds_read_b128 a[228:231], v3 offset:10240
    v_cvt_pk_bf16_f32 v205, v122, v123
    v_mfma_f32_16x16x32_bf16 v[124:127], a[188:191], a[200:203], v[124:127]
    ds_read2_b64 a[68:71], v6 offset0:0 offset1:128
    s_waitcnt lgkmcnt(7)
    v_mfma_f32_16x16x32_bf16 v[96:99], a[96:99], a[204:207], 0
    ds_read_b128 a[232:235], v3 offset:11264
    v_mfma_f32_16x16x32_bf16 v[96:99], a[100:103], a[208:211], v[96:99]
    v_mfma_f32_16x16x32_bf16 v[96:99], a[104:107], a[212:215], v[96:99]
    ds_read_b128 a[236:239], v3 offset:12288
    v_cvt_pk_bf16_f32 v206, v124, v125
    v_mfma_f32_16x16x32_bf16 v[96:99], a[108:111], a[216:219], v[96:99]
    v_cvt_pk_bf16_f32 v207, v126, v127
    v_mfma_f32_16x16x32_bf16 v[96:99], a[112:115], a[220:223], v[96:99]
    buffer_store_dwordx2 v[140:141], v11, s[12:15], s35 offen offset:896 sc1
    v_mfma_f32_16x16x32_bf16 v[96:99], a[116:119], a[224:227], v[96:99]
    ds_read_b128 a[240:243], v3 offset:13312
    v_mfma_f32_16x16x32_bf16 v[100:103], a[120:123], a[204:207], 0
    ds_read_b128 a[244:247], v3 offset:14336
    v_mfma_f32_16x16x32_bf16 v[100:103], a[124:127], a[208:211], v[100:103]
    v_mfma_f32_16x16x32_bf16 v[100:103], a[128:131], a[212:215], v[100:103]
    ds_read_b128 a[248:251], v3 offset:15360
    v_cvt_pk_bf16_f32 v208, v96, v97
    v_mfma_f32_16x16x32_bf16 v[100:103], a[132:135], a[216:219], v[100:103]
    v_cvt_pk_bf16_f32 v209, v98, v99
    v_mfma_f32_16x16x32_bf16 v[100:103], a[136:139], a[220:223], v[100:103]
    v_mfma_f32_16x16x32_bf16 v[100:103], a[140:143], a[224:227], v[100:103]
    buffer_store_dwordx2 v[142:143], v11, s[12:15], s35 offen offset:1280 sc1
    v_mfma_f32_16x16x32_bf16 v[104:107], a[144:147], a[204:207], 0
    s_waitcnt vmcnt(34)
    ds_write_b64 v4, a[72:73] offset:0
    v_mfma_f32_16x16x32_bf16 v[104:107], a[148:151], a[208:211], v[104:107]
    ds_write_b64 v4, a[74:75] offset:1024
    v_mfma_f32_16x16x32_bf16 v[104:107], a[152:155], a[212:215], v[104:107]
    ds_write_b64 v4, a[76:77] offset:512
    v_mfma_f32_16x16x32_bf16 v[104:107], a[156:159], a[216:219], v[104:107]
    ds_write_b64 v4, a[78:79] offset:1536
    v_mfma_f32_16x16x32_bf16 v[104:107], a[160:163], a[220:223], v[104:107]
    ds_read2_b64 a[72:75], v5 offset0:0 offset1:128
    v_cvt_pk_bf16_f32 v210, v100, v101
    v_mfma_f32_16x16x32_bf16 v[104:107], a[164:167], a[224:227], v[104:107]
    ds_read2_b64 a[76:79], v6 offset0:0 offset1:128
    v_cvt_pk_bf16_f32 v211, v102, v103
    v_mfma_f32_16x16x32_bf16 v[108:111], a[168:171], a[204:207], 0
    buffer_store_dwordx2 v[144:145], v11, s[12:15], s37 offen offset:128 sc1
    v_mfma_f32_16x16x32_bf16 v[108:111], a[172:175], a[208:211], v[108:111]
    v_mfma_f32_16x16x32_bf16 v[108:111], a[176:179], a[212:215], v[108:111]
    v_cvt_pk_bf16_f32 v212, v104, v105
    v_cvt_pk_bf16_f32 v213, v106, v107
    v_mfma_f32_16x16x32_bf16 v[108:111], a[180:183], a[216:219], v[108:111]
    v_mfma_f32_16x16x32_bf16 v[108:111], a[184:187], a[220:223], v[108:111]
    v_mfma_f32_16x16x32_bf16 v[108:111], a[188:191], a[224:227], v[108:111]
    s_waitcnt lgkmcnt(6)
    v_mfma_f32_16x16x32_bf16 v[112:115], a[96:99], a[228:231], 0
    v_mfma_f32_16x16x32_bf16 v[112:115], a[100:103], a[232:235], v[112:115]
    buffer_store_dwordx2 v[146:147], v11, s[12:15], s37 offen offset:512 sc1
    v_mfma_f32_16x16x32_bf16 v[112:115], a[104:107], a[236:239], v[112:115]
    v_cvt_pk_bf16_f32 v214, v108, v109
    v_cvt_pk_bf16_f32 v215, v110, v111
    v_mfma_f32_16x16x32_bf16 v[112:115], a[108:111], a[240:243], v[112:115]
    v_mfma_f32_16x16x32_bf16 v[112:115], a[112:115], a[244:247], v[112:115]
    v_mfma_f32_16x16x32_bf16 v[112:115], a[116:119], a[248:251], v[112:115]
    v_mfma_f32_16x16x32_bf16 v[116:119], a[120:123], a[228:231], 0
    v_mfma_f32_16x16x32_bf16 v[116:119], a[124:127], a[232:235], v[116:119]
    v_mfma_f32_16x16x32_bf16 v[116:119], a[128:131], a[236:239], v[116:119]
    buffer_store_dwordx2 v[148:149], v11, s[12:15], s37 offen offset:896 sc1
    v_mfma_f32_16x16x32_bf16 v[116:119], a[132:135], a[240:243], v[116:119]
    s_waitcnt vmcnt(30)
    ds_write_b64 v4, a[80:81] offset:0
    v_mfma_f32_16x16x32_bf16 v[116:119], a[136:139], a[244:247], v[116:119]
    ds_write_b64 v4, a[82:83] offset:1024
    v_mfma_f32_16x16x32_bf16 v[116:119], a[140:143], a[248:251], v[116:119]
    ds_write_b64 v4, a[84:85] offset:512
    v_mfma_f32_16x16x32_bf16 v[120:123], a[144:147], a[228:231], 0
    ds_write_b64 v4, a[86:87] offset:1536
    v_mfma_f32_16x16x32_bf16 v[120:123], a[148:151], a[232:235], v[120:123]
    ds_read2_b64 a[80:83], v5 offset0:0 offset1:128
    v_cvt_pk_bf16_f32 v216, v112, v113
    v_mfma_f32_16x16x32_bf16 v[120:123], a[152:155], a[236:239], v[120:123]
    ds_read2_b64 a[84:87], v6 offset0:0 offset1:128
    v_cvt_pk_bf16_f32 v217, v114, v115
    v_mfma_f32_16x16x32_bf16 v[120:123], a[156:159], a[240:243], v[120:123]
    buffer_store_dwordx2 v[150:151], v11, s[12:15], s37 offen offset:1280 sc1
    v_mfma_f32_16x16x32_bf16 v[120:123], a[160:163], a[244:247], v[120:123]
    v_cvt_pk_bf16_f32 v218, v116, v117
    v_cvt_pk_bf16_f32 v219, v118, v119
    v_mfma_f32_16x16x32_bf16 v[120:123], a[164:167], a[248:251], v[120:123]
    v_mfma_f32_16x16x32_bf16 v[124:127], a[168:171], a[228:231], 0
    v_mfma_f32_16x16x32_bf16 v[124:127], a[172:175], a[232:235], v[124:127]
    v_mfma_f32_16x16x32_bf16 v[124:127], a[176:179], a[236:239], v[124:127]
    v_cvt_pk_bf16_f32 v220, v120, v121
    v_cvt_pk_bf16_f32 v221, v122, v123
    v_mfma_f32_16x16x32_bf16 v[124:127], a[180:183], a[240:243], v[124:127]
    v_mfma_f32_16x16x32_bf16 v[124:127], a[184:187], a[244:247], v[124:127]
    buffer_store_dwordx2 v[152:153], v11, s[12:15], s39 offen offset:128 sc1
    v_mfma_f32_16x16x32_bf16 v[124:127], a[188:191], a[248:251], v[124:127]
    v_mfma_f32_16x16x32_bf16 v[64:67], v[32:35], v[192:195], 0
    v_mfma_f32_16x16x32_bf16 v[64:67], v[36:39], v[196:199], v[64:67]
    v_mfma_f32_16x16x32_bf16 v[68:71], v[32:35], v[200:203], 0
    v_cvt_pk_bf16_f32 v222, v124, v125
    v_cvt_pk_bf16_f32 v223, v126, v127
    v_mfma_f32_16x16x32_bf16 v[68:71], v[36:39], v[204:207], v[68:71]
    v_mfma_f32_16x16x32_bf16 v[72:75], v[32:35], v[208:211], 0
    s_waitcnt vmcnt(26)
    ds_write_b64 v4, a[88:89] offset:0
    v_mfma_f32_16x16x32_bf16 v[72:75], v[36:39], v[212:215], v[72:75]
    buffer_store_dwordx2 v[154:155], v11, s[12:15], s39 offen offset:512 sc1
    v_mfma_f32_16x16x32_bf16 v[76:79], v[32:35], v[216:219], 0
    buffer_load_dwordx4 a[96:99], v9, s[8:11], s24 offen offset:0 nt
    v_cvt_pk_bf16_f32 v160, v64, v68
    v_mfma_f32_16x16x32_bf16 v[76:79], v[36:39], v[220:223], v[76:79]
    buffer_load_dwordx4 a[100:103], v10, s[8:11], s24 offen offset:0 nt
    v_cvt_pk_bf16_f32 v162, v65, v69
    v_mfma_f32_16x16x32_bf16 v[80:83], v[40:43], v[192:195], 0
    ds_read_b128 a[192:195], v1 offset:0
    v_cvt_pk_bf16_f32 v164, v66, v70
    v_mfma_f32_16x16x32_bf16 v[80:83], v[44:47], v[196:199], v[80:83]
    ds_read_b128 a[196:199], v1 offset:1024
    v_cvt_pk_bf16_f32 v166, v67, v71
    v_mfma_f32_16x16x32_bf16 v[84:87], v[40:43], v[200:203], 0
    ds_read_b128 a[200:203], v1 offset:2048
    v_cvt_pk_bf16_f32 v161, v72, v76
    v_mfma_f32_16x16x32_bf16 v[84:87], v[44:47], v[204:207], v[84:87]
    ds_write_b64 v4, a[90:91] offset:1024
    v_mfma_f32_16x16x32_bf16 v[88:91], v[40:43], v[208:211], 0
    buffer_store_dwordx2 v[156:157], v11, s[12:15], s39 offen offset:896 sc1
    v_mfma_f32_16x16x32_bf16 v[88:91], v[44:47], v[212:215], v[88:91]
    ds_read_b128 a[204:207], v1 offset:3072
    v_cvt_pk_bf16_f32 v163, v73, v77
    v_mfma_f32_16x16x32_bf16 v[92:95], v[40:43], v[216:219], 0
    ds_read_b128 a[208:211], v1 offset:4096
    v_cvt_pk_bf16_f32 v165, v74, v78
    v_mfma_f32_16x16x32_bf16 v[92:95], v[44:47], v[220:223], v[92:95]
    ds_write_b64 v4, a[92:93] offset:512
    v_mfma_f32_16x16x32_bf16 v[96:99], v[48:51], v[192:195], 0
    ds_read_b128 a[212:215], v1 offset:5120
    v_cvt_pk_bf16_f32 v167, v75, v79
    v_mfma_f32_16x16x32_bf16 v[96:99], v[52:55], v[196:199], v[96:99]
    ds_write_b64 v4, a[94:95] offset:1536
    v_mfma_f32_16x16x32_bf16 v[100:103], v[48:51], v[200:203], 0
    ds_read2_b64 a[88:91], v5 offset0:0 offset1:128
    v_cvt_pk_bf16_f32 v168, v80, v84
    v_mfma_f32_16x16x32_bf16 v[100:103], v[52:55], v[204:207], v[100:103]
    buffer_store_dwordx2 v[158:159], v11, s[12:15], s39 offen offset:1280 sc1
    v_mfma_f32_16x16x32_bf16 v[104:107], v[48:51], v[208:211], 0
    ds_read2_b64 a[92:95], v6 offset0:0 offset1:128
    v_cvt_pk_bf16_f32 v169, v88, v92
    v_mfma_f32_16x16x32_bf16 v[104:107], v[52:55], v[212:215], v[104:107]
    v_cvt_pk_bf16_f32 v170, v81, v85
    v_cvt_pk_bf16_f32 v172, v82, v86
    v_mfma_f32_16x16x32_bf16 v[108:111], v[48:51], v[216:219], 0
    v_cvt_pk_bf16_f32 v176, v96, v100
    v_cvt_pk_bf16_f32 v178, v97, v101
    v_mfma_f32_16x16x32_bf16 v[108:111], v[52:55], v[220:223], v[108:111]
    v_cvt_pk_bf16_f32 v180, v98, v102
    v_cvt_pk_bf16_f32 v182, v99, v103
    v_mfma_f32_16x16x32_bf16 v[112:115], v[56:59], v[192:195], 0
    v_cvt_pk_bf16_f32 v174, v83, v87
    v_cvt_pk_bf16_f32 v171, v89, v93
    v_mfma_f32_16x16x32_bf16 v[112:115], v[60:63], v[196:199], v[112:115]
    v_cvt_pk_bf16_f32 v173, v90, v94
    v_cvt_pk_bf16_f32 v175, v91, v95
    v_mfma_f32_16x16x32_bf16 v[116:119], v[56:59], v[200:203], 0
    v_cvt_pk_bf16_f32 v177, v104, v108
    v_cvt_pk_bf16_f32 v179, v105, v109
    v_mfma_f32_16x16x32_bf16 v[116:119], v[60:63], v[204:207], v[116:119]
    v_cvt_pk_bf16_f32 v181, v106, v110
    v_cvt_pk_bf16_f32 v183, v107, v111
    v_mfma_f32_16x16x32_bf16 v[120:123], v[56:59], v[208:211], 0
    v_mfma_f32_16x16x32_bf16 v[120:123], v[60:63], v[212:215], v[120:123]
    v_mfma_f32_16x16x32_bf16 v[124:127], v[56:59], v[216:219], 0
    ds_read_b128 a[216:219], v1 offset:6144
    v_cvt_pk_bf16_f32 v184, v112, v116
    v_mfma_f32_16x16x32_bf16 v[124:127], v[60:63], v[220:223], v[124:127]
    v_cvt_pk_bf16_f32 v186, v113, v117
    s_cmp_eq_u32 s18, 1
    s_cbranch_scc0 L_more
L_tail:
    buffer_store_dwordx2 v[160:161], v11, s[12:15], s33 offen offset:256 sc1
    buffer_store_dwordx2 v[162:163], v11, s[12:15], s33 offen offset:640 sc1
    buffer_store_dwordx2 v[164:165], v11, s[12:15], s33 offen offset:1024 sc1
    buffer_store_dwordx2 v[166:167], v11, s[12:15], s33 offen offset:1408 sc1
    buffer_store_dwordx2 v[168:169], v11, s[12:15], s35 offen offset:256 sc1
    buffer_store_dwordx2 v[170:171], v11, s[12:15], s35 offen offset:640 sc1
    buffer_store_dwordx2 v[172:173], v11, s[12:15], s35 offen offset:1024 sc1
    buffer_store_dwordx2 v[174:175], v11, s[12:15], s35 offen offset:1408 sc1
    buffer_store_dwordx2 v[176:177], v11, s[12:15], s37 offen offset:256 sc1
    buffer_store_dwordx2 v[178:179], v11, s[12:15], s37 offen offset:640 sc1
    buffer_store_dwordx2 v[180:181], v11, s[12:15], s37 offen offset:1024 sc1
    buffer_store_dwordx2 v[182:183], v11, s[12:15], s37 offen offset:1408 sc1
    v_cvt_pk_bf16_f32 v188, v114, v118
    v_cvt_pk_bf16_f32 v190, v115, v119
    v_cvt_pk_bf16_f32 v185, v120, v124
    v_cvt_pk_bf16_f32 v187, v121, v125
    v_cvt_pk_bf16_f32 v189, v122, v126
    v_cvt_pk_bf16_f32 v191, v123, v127
    buffer_store_dwordx2 v[184:185], v11, s[12:15], s39 offen offset:256 sc1
    buffer_store_dwordx2 v[186:187], v11, s[12:15], s39 offen offset:640 sc1
    buffer_store_dwordx2 v[188:189], v11, s[12:15], s39 offen offset:1024 sc1
    buffer_store_dwordx2 v[190:191], v11, s[12:15], s39 offen offset:1408 sc1
L_end:
    s_endpgm
L_more:
    s_waitcnt lgkmcnt(2)
    v_mfma_f32_16x16x32_bf16 v[96:99], a[192:195], a[0:3], 0
    ds_read_b128 a[220:223], v1 offset:7168
    v_cvt_pk_bf16_f32 v188, v114, v118
    v_mfma_f32_16x16x32_bf16 v[96:99], a[196:199], a[4:7], v[96:99]
    v_cvt_pk_bf16_f32 v190, v115, v119
    v_mfma_f32_16x16x32_bf16 v[96:99], a[200:203], a[8:11], v[96:99]
    ds_read_b128 a[224:227], v1 offset:8192
    v_cvt_pk_bf16_f32 v185, v120, v124
    v_mfma_f32_16x16x32_bf16 v[96:99], a[204:207], a[12:15], v[96:99]
    v_cvt_pk_bf16_f32 v187, v121, v125
    v_cvt_pk_bf16_f32 v189, v122, v126
    v_mfma_f32_16x16x32_bf16 v[96:99], a[208:211], a[16:19], v[96:99]
    ds_read_b128 a[228:231], v1 offset:9216
    v_cvt_pk_bf16_f32 v191, v123, v127
    v_mfma_f32_16x16x32_bf16 v[96:99], a[212:215], a[20:23], v[96:99]
    v_mfma_f32_16x16x32_bf16 v[100:103], a[192:195], a[24:27], 0
    ds_read_b128 a[232:235], v1 offset:10240
    v_mfma_f32_16x16x32_bf16 v[100:103], a[196:199], a[28:31], v[100:103]
    v_mfma_f32_16x16x32_bf16 v[100:103], a[200:203], a[32:35], v[100:103]
    ds_read_b128 a[236:239], v1 offset:11264
    v_cvt_pk_bf16_f32 v192, v96, v97
    v_mfma_f32_16x16x32_bf16 v[100:103], a[204:207], a[36:39], v[100:103]
    v_cvt_pk_bf16_f32 v193, v98, v99
    v_mfma_f32_16x16x32_bf16 v[100:103], a[208:211], a[40:43], v[100:103]
    v_mfma_f32_16x16x32_bf16 v[100:103], a[212:215], a[44:47], v[100:103]
    v_mfma_f32_16x16x32_bf16 v[104:107], a[192:195], a[48:51], 0
    v_mfma_f32_16x16x32_bf16 v[104:107], a[196:199], a[52:55], v[104:107]
    v_mfma_f32_16x16x32_bf16 v[104:107], a[200:203], a[56:59], v[104:107]
    v_cvt_pk_bf16_f32 v196, v100, v101
    v_cvt_pk_bf16_f32 v197, v102, v103
    v_mfma_f32_16x16x32_bf16 v[104:107], a[204:207], a[60:63], v[104:107]
    v_mfma_f32_16x16x32_bf16 v[104:107], a[208:211], a[64:67], v[104:107]
    v_mfma_f32_16x16x32_bf16 v[104:107], a[212:215], a[68:71], v[104:107]
    v_mfma_f32_16x16x32_bf16 v[108:111], a[192:195], a[72:75], 0
    v_mfma_f32_16x16x32_bf16 v[108:111], a[196:199], a[76:79], v[108:111]
    v_mfma_f32_16x16x32_bf16 v[108:111], a[200:203], a[80:83], v[108:111]
    v_cvt_pk_bf16_f32 v200, v104, v105
    v_cvt_pk_bf16_f32 v201, v106, v107
    v_mfma_f32_16x16x32_bf16 v[108:111], a[204:207], a[84:87], v[108:111]
    v_mfma_f32_16x16x32_bf16 v[108:111], a[208:211], a[88:91], v[108:111]
    buffer_store_dwordx2 v[160:161], v11, s[12:15], s33 offen offset:256 sc1
    s_waitcnt lgkmcnt(0)
    v_mfma_f32_16x16x32_bf16 v[108:111], a[212:215], a[92:95], v[108:111]
    ds_read_b128 a[240:243], v1 offset:12288
    v_mfma_f32_16x16x32_bf16 v[112:115], a[216:219], a[0:3], 0
    ds_read_b128 a[244:247], v1 offset:13312
    v_mfma_f32_16x16x32_bf16 v[112:115], a[220:223], a[4:7], v[112:115]
    v_mfma_f32_16x16x32_bf16 v[112:115], a[224:227], a[8:11], v[112:115]
    ds_read_b128 a[248:251], v1 offset:14336
    v_cvt_pk_bf16_f32 v204, v108, v109
    v_mfma_f32_16x16x32_bf16 v[112:115], a[228:231], a[12:15], v[112:115]
    v_cvt_pk_bf16_f32 v205, v110, v111
    v_mfma_f32_16x16x32_bf16 v[112:115], a[232:235], a[16:19], v[112:115]
    ds_read_b128 a[192:195], v1 offset:15360
    v_mfma_f32_16x16x32_bf16 v[112:115], a[236:239], a[20:23], v[112:115]
    v_mfma_f32_16x16x32_bf16 v[116:119], a[216:219], a[24:27], 0
    buffer_load_dwordx4 a[104:107], v9, s[8:11], s24 offen offset:128 nt
    v_mfma_f32_16x16x32_bf16 v[116:119], a[220:223], a[28:31], v[116:119]
    buffer_load_dwordx4 a[108:111], v10, s[8:11], s24 offen offset:128 nt
    v_mfma_f32_16x16x32_bf16 v[116:119], a[224:227], a[32:35], v[116:119]
    ds_read_b128 a[196:199], v1 offset:16384
    v_cvt_pk_bf16_f32 v194, v112, v113
    v_mfma_f32_16x16x32_bf16 v[116:119], a[228:231], a[36:39], v[116:119]
    ds_read_b128 a[200:203], v1 offset:17408
    v_cvt_pk_bf16_f32 v195, v114, v115
    v_mfma_f32_16x16x32_bf16 v[116:119], a[232:235], a[40:43], v[116:119]
    v_mfma_f32_16x16x32_bf16 v[116:119], a[236:239], a[44:47], v[116:119]
    v_mfma_f32_16x16x32_bf16 v[120:123], a[216:219], a[48:51], 0
    v_mfma_f32_16x16x32_bf16 v[120:123], a[220:223], a[52:55], v[120:123]
    v_mfma_f32_16x16x32_bf16 v[120:123], a[224:227], a[56:59], v[120:123]
    v_cvt_pk_bf16_f32 v198, v116, v117
    v_cvt_pk_bf16_f32 v199, v118, v119
    v_mfma_f32_16x16x32_bf16 v[120:123], a[228:231], a[60:63], v[120:123]
    v_mfma_f32_16x16x32_bf16 v[120:123], a[232:235], a[64:67], v[120:123]
    v_mfma_f32_16x16x32_bf16 v[120:123], a[236:239], a[68:71], v[120:123]
    v_mfma_f32_16x16x32_bf16 v[124:127], a[216:219], a[72:75], 0
    v_mfma_f32_16x16x32_bf16 v[124:127], a[220:223], a[76:79], v[124:127]
    v_mfma_f32_16x16x32_bf16 v[124:127], a[224:227], a[80:83], v[124:127]
    buffer_store_dwordx2 v[162:163], v11, s[12:15], s33 offen offset:640 sc1
    v_mfma_f32_16x16x32_bf16 v[124:127], a[228:231], a[84:87], v[124:127]
    v_cvt_pk_bf16_f32 v202, v120, v121
    v_cvt_pk_bf16_f32 v203, v122, v123
    v_mfma_f32_16x16x32_bf16 v[124:127], a[232:235], a[88:91], v[124:127]
    ds_read_b128 a[204:207], v1 offset:18432
    v_mfma_f32_16x16x32_bf16 v[124:127], a[236:239], a[92:95], v[124:127]
    s_waitcnt lgkmcnt(1)
    v_mfma_f32_16x16x32_bf16 v[96:99], a[240:243], a[0:3], 0
    ds_read_b128 a[208:211], v1 offset:19456
    v_mfma_f32_16x16x32_bf16 v[96:99], a[244:247], a[4:7], v[96:99]
    v_mfma_f32_16x16x32_bf16 v[96:99], a[248:251], a[8:11], v[96:99]
    ds_read_b128 a[212:215], v1 offset:20480
    v_cvt_pk_bf16_f32 v206, v124, v125
    v_mfma_f32_16x16x32_bf16 v[96:99], a[192:195], a[12:15], v[96:99]
    v_cvt_pk_bf16_f32 v207, v126, v127
    v_mfma_f32_16x16x32_bf16 v[96:99], a[196:199], a[16:19], v[96:99]
    ds_read_b128 a[216:219], v1 offset:21504
    v_mfma_f32_16x16x32_bf16 v[96:99], a[200:203], a[20:23], v[96:99]
    v_mfma_f32_16x16x32_bf16 v[100:103], a[240:243], a[24:27], 0
    ds_read_b128 a[220:223], v1 offset:22528
    v_mfma_f32_16x16x32_bf16 v[100:103], a[244:247], a[28:31], v[100:103]
    v_mfma_f32_16x16x32_bf16 v[100:103], a[248:251], a[32:35], v[100:103]
    ds_read_b128 a[224:227], v1 offset:23552
    v_cvt_pk_bf16_f32 v208, v96, v97
    v_mfma_f32_16x16x32_bf16 v[100:103], a[192:195], a[36:39], v[100:103]
    v_cvt_pk_bf16_f32 v209, v98, v99
    v_mfma_f32_16x16x32_bf16 v[100:103], a[196:199], a[40:43], v[100:103]
    v_mfma_f32_16x16x32_bf16 v[100:103], a[200:203], a[44:47], v[100:103]
    v_mfma_f32_16x16x32_bf16 v[104:107], a[240:243], a[48:51], 0
    v_mfma_f32_16x16x32_bf16 v[104:107], a[244:247], a[52:55], v[104:107]
    v_mfma_f32_16x16x32_bf16 v[104:107], a[248:251], a[56:59], v[104:107]
    v_cvt_pk_bf16_f32 v212, v100, v101
    v_cvt_pk_bf16_f32 v213, v102, v103
    v_mfma_f32_16x16x32_bf16 v[104:107], a[192:195], a[60:63], v[104:107]
    v_mfma_f32_16x16x32_bf16 v[104:107], a[196:199], a[64:67], v[104:107]
    v_mfma_f32_16x16x32_bf16 v[104:107], a[200:203], a[68:71], v[104:107]
    v_mfma_f32_16x16x32_bf16 v[108:111], a[240:243], a[72:75], 0
    buffer_store_dwordx2 v[164:165], v11, s[12:15], s33 offen offset:1024 sc1
    v_mfma_f32_16x16x32_bf16 v[108:111], a[244:247], a[76:79], v[108:111]
    v_mfma_f32_16x16x32_bf16 v[108:111], a[248:251], a[80:83], v[108:111]
    v_cvt_pk_bf16_f32 v216, v104, v105
    v_cvt_pk_bf16_f32 v217, v106, v107
    v_mfma_f32_16x16x32_bf16 v[108:111], a[192:195], a[84:87], v[108:111]
    v_mfma_f32_16x16x32_bf16 v[108:111], a[196:199], a[88:91], v[108:111]
    ds_read_b128 a[228:231], v1 offset:24576
    v_mfma_f32_16x16x32_bf16 v[108:111], a[200:203], a[92:95], v[108:111]
    s_waitcnt lgkmcnt(1)
    v_mfma_f32_16x16x32_bf16 v[112:115], a[204:207], a[0:3], 0
    ds_read_b128 a[232:235], v1 offset:25600
    v_mfma_f32_16x16x32_bf16 v[112:115], a[208:211], a[4:7], v[112:115]
    v_mfma_f32_16x16x32_bf16 v[112:115], a[212:215], a[8:11], v[112:115]
    ds_read_b128 a[236:239], v1 offset:26624
    v_cvt_pk_bf16_f32 v220, v108, v109
    v_mfma_f32_16x16x32_bf16 v[112:115], a[216:219], a[12:15], v[112:115]
    v_cvt_pk_bf16_f32 v221, v110, v111
    v_mfma_f32_16x16x32_bf16 v[112:115], a[220:223], a[16:19], v[112:115]
    ds_read_b128 a[240:243], v1 offset:27648
    v_mfma_f32_16x16x32_bf16 v[112:115], a[224:227], a[20:23], v[112:115]
    v_mfma_f32_16x16x32_bf16 v[116:119], a[204:207], a[24:27], 0
    ds_read_b128 a[244:247], v1 offset:28672
    v_mfma_f32_16x16x32_bf16 v[116:119], a[208:211], a[28:31], v[116:119]
    v_mfma_f32_16x16x32_bf16 v[116:119], a[212:215], a[32:35], v[116:119]
    ds_read_b128 a[248:251], v1 offset:29696
    v_cvt_pk_bf16_f32 v210, v112, v113
    v_mfma_f32_16x16x32_bf16 v[116:119], a[216:219], a[36:39], v[116:119]
    v_cvt_pk_bf16_f32 v211, v114, v115
    v_mfma_f32_16x16x32_bf16 v[116:119], a[220:223], a[40:43], v[116:119]
    v_mfma_f32_16x16x32_bf16 v[116:119], a[224:227], a[44:47], v[116:119]
    v_mfma_f32_16x16x32_bf16 v[120:123], a[204:207], a[48:51], 0
    v_mfma_f32_16x16x32_bf16 v[120:123], a[208:211], a[52:55], v[120:123]
    v_mfma_f32_16x16x32_bf16 v[120:123], a[212:215], a[56:59], v[120:123]
    buffer_load_dwordx4 a[112:115], v9, s[8:11], s24 offen offset:256 nt
    v_cvt_pk_bf16_f32 v214, v116, v117
    v_mfma_f32_16x16x32_bf16 v[120:123], a[216:219], a[60:63], v[120:123]
    buffer_load_dwordx4 a[116:119], v10, s[8:11], s24 offen offset:256 nt
    v_cvt_pk_bf16_f32 v215, v118, v119
    v_mfma_f32_16x16x32_bf16 v[120:123], a[220:223], a[64:67], v[120:123]
    buffer_store_dwordx2 v[166:167], v11, s[12:15], s33 offen offset:1408 sc1
    v_mfma_f32_16x16x32_bf16 v[120:123], a[224:227], a[68:71], v[120:123]
    s_add_u32 s24, s16, 6291456
    s_add_u32 s33, s16, 3145728
    v_mfma_f32_16x16x32_bf16 v[124:127], a[204:207], a[72:75], 0
    v_mfma_f32_16x16x32_bf16 v[124:127], a[208:211], a[76:79], v[124:127]
    v_mfma_f32_16x16x32_bf16 v[124:127], a[212:215], a[80:83], v[124:127]
    v_cvt_pk_bf16_f32 v218, v120, v121
    v_cvt_pk_bf16_f32 v219, v122, v123
    v_mfma_f32_16x16x32_bf16 v[124:127], a[216:219], a[84:87], v[124:127]
    v_mfma_f32_16x16x32_bf16 v[124:127], a[220:223], a[88:91], v[124:127]
    v_mfma_f32_16x16x32_bf16 v[124:127], a[224:227], a[92:95], v[124:127]
    s_waitcnt lgkmcnt(0)
    v_mfma_f32_16x16x32_bf16 v[96:99], a[228:231], a[0:3], 0
    v_mfma_f32_16x16x32_bf16 v[96:99], a[232:235], a[4:7], v[96:99]
    v_mfma_f32_16x16x32_bf16 v[96:99], a[236:239], a[8:11], v[96:99]
    v_cvt_pk_bf16_f32 v222, v124, v125
    v_cvt_pk_bf16_f32 v223, v126, v127
    v_mfma_f32_16x16x32_bf16 v[96:99], a[240:243], a[12:15], v[96:99]
    v_mfma_f32_16x16x32_bf16 v[96:99], a[244:247], a[16:19], v[96:99]
    v_mfma_f32_16x16x32_bf16 v[96:99], a[248:251], a[20:23], v[96:99]
    v_mfma_f32_16x16x32_bf16 v[100:103], a[228:231], a[24:27], 0
    v_mfma_f32_16x16x32_bf16 v[100:103], a[232:235], a[28:31], v[100:103]
    v_mfma_f32_16x16x32_bf16 v[100:103], a[236:239], a[32:35], v[100:103]
    v_mfma_f32_16x16x32_bf16 v[100:103], a[240:243], a[36:39], v[100:103]
    v_mfma_f32_16x16x32_bf16 v[100:103], a[244:247], a[40:43], v[100:103]
    v_mfma_f32_16x16x32_bf16 v[100:103], a[248:251], a[44:47], v[100:103]
    v_mfma_f32_16x16x32_bf16 v[32:35], a[0:3], v[192:195], 0
    v_mfma_f32_16x16x32_bf16 v[32:35], a[4:7], v[208:211], v[32:35]
    v_mfma_f32_16x16x32_bf16 v[36:39], a[24:27], v[192:195], 0
    buffer_store_dwordx2 v[168:169], v11, s[12:15], s35 offen offset:256 sc1
    v_mfma_f32_16x16x32_bf16 v[36:39], a[28:31], v[208:211], v[36:39]
    v_mfma_f32_16x16x32_bf16 v[40:43], a[48:51], v[192:195], 0
    v_mfma_f32_16x16x32_bf16 v[40:43], a[52:55], v[208:211], v[40:43]
    v_mfma_f32_16x16x32_bf16 v[44:47], a[72:75], v[192:195], 0
    v_cvt_pk_bf16_f32 v192, v96, v97
    v_cvt_pk_bf16_f32 v193, v98, v99
    v_mfma_f32_16x16x32_bf16 v[44:47], a[76:79], v[208:211], v[44:47]
    v_mfma_f32_16x16x32_bf16 v[48:51], a[0:3], v[196:199], 0
    v_mfma_f32_16x16x32_bf16 v[48:51], a[4:7], v[212:215], v[48:51]
    v_mfma_f32_16x16x32_bf16 v[52:55], a[24:27], v[196:199], 0
    v_mfma_f32_16x16x32_bf16 v[52:55], a[28:31], v[212:215], v[52:55]
    v_mfma_f32_16x16x32_bf16 v[56:59], a[48:51], v[196:199], 0
    v_mfma_f32_16x16x32_bf16 v[56:59], a[52:55], v[212:215], v[56:59]
    v_mfma_f32_16x16x32_bf16 v[60:63], a[72:75], v[196:199], 0
    v_cvt_pk_bf16_f32 v196, v100, v101
    v_cvt_pk_bf16_f32 v197, v102, v103
    v_mfma_f32_16x16x32_bf16 v[60:63], a[76:79], v[212:215], v[60:63]
    v_mfma_f32_16x16x32_bf16 v[64:67], a[0:3], v[200:203], 0
    v_mfma_f32_16x16x32_bf16 v[64:67], a[4:7], v[216:219], v[64:67]
    v_mfma_f32_16x16x32_bf16 v[68:71], a[24:27], v[200:203], 0
    ds_read_b128 a[192:195], v1 offset:30720
    v_mfma_f32_16x16x32_bf16 v[68:71], a[28:31], v[216:219], v[68:71]
    v_mfma_f32_16x16x32_bf16 v[72:75], a[48:51], v[200:203], 0
    ds_read_b128 a[196:199], v1 offset:31744
    v_mfma_f32_16x16x32_bf16 v[72:75], a[52:55], v[216:219], v[72:75]
    v_mfma_f32_16x16x32_bf16 v[76:79], a[72:75], v[200:203], 0
    ds_read_b128 a[200:203], v1 offset:32768
    v_mfma_f32_16x16x32_bf16 v[76:79], a[76:79], v[216:219], v[76:79]
    v_mfma_f32_16x16x32_bf16 v[80:83], a[0:3], v[204:207], 0
    buffer_store_dwordx2 v[170:171], v11, s[12:15], s35 offen offset:640 sc1
    v_mfma_f32_16x16x32_bf16 v[80:83], a[4:7], v[220:223], v[80:83]
    ds_read_b128 a[204:207], v1 offset:33792
    v_mfma_f32_16x16x32_bf16 v[84:87], a[24:27], v[204:207], 0
    ds_read_b128 a[208:211], v1 offset:34816
    v_mfma_f32_16x16x32_bf16 v[84:87], a[28:31], v[220:223], v[84:87]
    v_mfma_f32_16x16x32_bf16 v[88:91], a[48:51], v[204:207], 0
    ds_read_b128 a[212:215], v1 offset:35840
    v_mfma_f32_16x16x32_bf16 v[88:91], a[52:55], v[220:223], v[88:91]
    v_mfma_f32_16x16x32_bf16 v[92:95], a[72:75], v[204:207], 0
    v_mfma_f32_16x16x32_bf16 v[92:95], a[76:79], v[220:223], v[92:95]
    v_mfma_f32_16x16x32_bf16 v[104:107], a[228:231], a[48:51], 0
    v_mfma_f32_16x16x32_bf16 v[104:107], a[232:235], a[52:55], v[104:107]
    v_mfma_f32_16x16x32_bf16 v[104:107], a[236:239], a[56:59], v[104:107]
    buffer_load_dwordx4 a[120:123], v9, s[8:11], s26 offen offset:0 nt
    v_mfma_f32_16x16x32_bf16 v[104:107], a[240:243], a[60:63], v[104:107]
    buffer_load_dwordx4 a[124:127], v10, s[8:11], s26 offen offset:0 nt
    v_mfma_f32_16x16x32_bf16 v[104:107], a[244:247], a[64:67], v[104:107]
    v_mfma_f32_16x16x32_bf16 v[104:107], a[248:251], a[68:71], v[104:107]
    v_mfma_f32_16x16x32_bf16 v[108:111], a[228:231], a[72:75], 0
    v_mfma_f32_16x16x32_bf16 v[108:111], a[232:235], a[76:79], v[108:111]
    v_mfma_f32_16x16x32_bf16 v[108:111], a[236:239], a[80:83], v[108:111]
    v_cvt_pk_bf16_f32 v200, v104, v105
    v_cvt_pk_bf16_f32 v201, v106, v107
    v_mfma_f32_16x16x32_bf16 v[108:111], a[240:243], a[84:87], v[108:111]
    v_mfma_f32_16x16x32_bf16 v[108:111], a[244:247], a[88:91], v[108:111]
    ds_read_b128 a[216:219], v1 offset:36864
    v_mfma_f32_16x16x32_bf16 v[108:111], a[248:251], a[92:95], v[108:111]
    s_waitcnt lgkmcnt(1)
    v_mfma_f32_16x16x32_bf16 v[112:115], a[192:195], a[0:3], 0
    ds_read_b128 a[220:223], v1 offset:37888
    v_mfma_f32_16x16x32_bf16 v[112:115], a[196:199], a[4:7], v[112:115]
    v_mfma_f32_16x16x32_bf16 v[112:115], a[200:203], a[8:11], v[112:115]
    buffer_store_dwordx2 v[172:173], v11, s[12:15], s35 offen offset:1024 sc1
    v_mfma_f32_16x16x32_bf16 v[112:115], a[204:207], a[12:15], v[112:115]
    ds_read_b128 a[224:227], v1 offset:38912
    v_cvt_pk_bf16_f32 v204, v108, v109
    v_mfma_f32_16x16x32_bf16 v[112:115], a[208:211], a[16:19], v[112:115]
    ds_read_b128 a[228:231], v1 offset:39936
    v_cvt_pk_bf16_f32 v205, v110, v111
    v_mfma_f32_16x16x32_bf16 v[112:115], a[212:215], a[20:23], v[112:115]
    v_mfma_f32_16x16x32_bf16 v[116:119], a[192:195], a[24:27], 0
    ds_read_b128 a[232:235], v1 offset:40960
    v_mfma_f32_16x16x32_bf16 v[116:119], a[196:199], a[28:31], v[116:119]
    v_mfma_f32_16x16x32_bf16 v[116:119], a[200:203], a[32:35], v[116:119]
    ds_read_b128 a[236:239], v1 offset:41984
    v_cvt_pk_bf16_f32 v194, v112, v113
    v_mfma_f32_16x16x32_bf16 v[116:119], a[204:207], a[36:39], v[116:119]
    v_cvt_pk_bf16_f32 v195, v114, v115
    v_mfma_f32_16x16x32_bf16 v[116:119], a[208:211], a[40:43], v[116:119]
    v_mfma_f32_16x16x32_bf16 v[116:119], a[212:215], a[44:47], v[116:119]
    v_mfma_f32_16x16x32_bf16 v[120:123], a[192:195], a[48:51], 0
    v_mfma_f32_16x16x32_bf16 v[120:123], a[196:199], a[52:55], v[120:123]
    v_mfma_f32_16x16x32_bf16 v[120:123], a[200:203], a[56:59], v[120:123]
    v_cvt_pk_bf16_f32 v198, v116, v117
    v_cvt_pk_bf16_f32 v199, v118, v119
    v_mfma_f32_16x16x32_bf16 v[120:123], a[204:207], a[60:63], v[120:123]
    v_mfma_f32_16x16x32_bf16 v[120:123], a[208:211], a[64:67], v[120:123]
    v_mfma_f32_16x16x32_bf16 v[120:123], a[212:215], a[68:71], v[120:123]
    v_mfma_f32_16x16x32_bf16 v[124:127], a[192:195], a[72:75], 0
    v_mfma_f32_16x16x32_bf16 v[124:127], a[196:199], a[76:79], v[124:127]
    v_mfma_f32_16x16x32_bf16 v[124:127], a[200:203], a[80:83], v[124:127]
    v_cvt_pk_bf16_f32 v202, v120, v121
    v_cvt_pk_bf16_f32 v203, v122, v123
    v_mfma_f32_16x16x32_bf16 v[124:127], a[204:207], a[84:87], v[124:127]
    v_mfma_f32_16x16x32_bf16 v[124:127], a[208:211], a[88:91], v[124:127]
    ds_read_b128 a[240:243], v1 offset:43008
    v_mfma_f32_16x16x32_bf16 v[124:127], a[212:215], a[92:95], v[124:127]
    s_waitcnt lgkmcnt(1)
    v_mfma_f32_16x16x32_bf16 v[96:99], a[216:219], a[0:3], 0
    buffer_store_dwordx2 v[174:175], v11, s[12:15], s35 offen offset:1408 sc1
    v_mfma_f32_16x16x32_bf16 v[96:99], a[220:223], a[4:7], v[96:99]
    ds_read_b128 a[244:247], v1 offset:44032
    s_add_u32 s35, s16, 3538944
    v_mfma_f32_16x16x32_bf16 v[96:99], a[224:227], a[8:11], v[96:99]
    ds_read_b128 a[248:251], v1 offset:45056
    v_cvt_pk_bf16_f32 v206, v124, v125
    v_mfma_f32_16x16x32_bf16 v[96:99], a[228:231], a[12:15], v[96:99]
    v_cvt_pk_bf16_f32 v207, v126, v127
    v_mfma_f32_16x16x32_bf16 v[96:99], a[232:235], a[16:19], v[96:99]
    ds_read_b128 a[192:195], v1 offset:46080
    v_mfma_f32_16x16x32_bf16 v[96:99], a[236:239], a[20:23], v[96:99]
    v_mfma_f32_16x16x32_bf16 v[100:103], a[216:219], a[24:27], 0
    ds_read_b128 a[196:199], v1 offset:47104
    v_mfma_f32_16x16x32_bf16 v[100:103], a[220:223], a[28:31], v[100:103]
    v_mfma_f32_16x16x32_bf16 v[100:103], a[224:227], a[32:35], v[100:103]
    ds_read_b128 a[200:203], v1 offset:48128
    v_cvt_pk_bf16_f32 v208, v96, v97
    v_mfma_f32_16x16x32_bf16 v[100:103], a[228:231], a[36:39], v[100:103]
    v_cvt_pk_bf16_f32 v209, v98, v99
    v_mfma_f32_16x16x32_bf16 v[100:103], a[232:235], a[40:43], v[100:103]
    v_mfma_f32_16x16x32_bf16 v[100:103], a[236:239], a[44:47], v[100:103]
    v_mfma_f32_16x16x32_bf16 v[104:107], a[216:219], a[48:51], 0
    v_mfma_f32_16x16x32_bf16 v[104:107], a[220:223], a[52:55], v[104:107]
    v_mfma_f32_16x16x32_bf16 v[104:107], a[224:227], a[56:59], v[104:107]
    v_cvt_pk_bf16_f32 v212, v100, v101
    v_cvt_pk_bf16_f32 v213, v102, v103
    v_mfma_f32_16x16x32_bf16 v[104:107], a[228:231], a[60:63], v[104:107]
    v_mfma_f32_16x16x32_bf16 v[104:107], a[232:235], a[64:67], v[104:107]
    v_mfma_f32_16x16x32_bf16 v[104:107], a[236:239], a[68:71], v[104:107]
    v_mfma_f32_16x16x32_bf16 v[108:111], a[216:219], a[72:75], 0
    v_mfma_f32_16x16x32_bf16 v[108:111], a[220:223], a[76:79], v[108:111]
    v_mfma_f32_16x16x32_bf16 v[108:111], a[224:227], a[80:83], v[108:111]
    v_cvt_pk_bf16_f32 v216, v104, v105
    v_cvt_pk_bf16_f32 v217, v106, v107
    v_mfma_f32_16x16x32_bf16 v[108:111], a[228:231], a[84:87], v[108:111]
    v_mfma_f32_16x16x32_bf16 v[108:111], a[232:235], a[88:91], v[108:111]
    buffer_store_dwordx2 v[176:177], v11, s[12:15], s37 offen offset:256 sc1
    v_mfma_f32_16x16x32_bf16 v[108:111], a[236:239], a[92:95], v[108:111]
    buffer_load_dwordx4 a[128:131], v9, s[8:11], s26 offen offset:128 nt
    s_waitcnt lgkmcnt(0)
    v_mfma_f32_16x16x32_bf16 v[112:115], a[240:243], a[0:3], 0
    buffer_load_dwordx4 a[132:135], v10, s[8:11], s26 offen offset:128 nt
    v_mfma_f32_16x16x32_bf16 v[112:115], a[244:247], a[4:7], v[112:115]
    ds_read_b128 a[204:207], v1 offset:49152
    v_mfma_f32_16x16x32_bf16 v[112:115], a[248:251], a[8:11], v[112:115]
    ds_read_b128 a[208:211], v1 offset:50176
    v_cvt_pk_bf16_f32 v220, v108, v109
    v_mfma_f32_16x16x32_bf16 v[112:115], a[192:195], a[12:15], v[112:115]
    ds_read_b128 a[212:215], v1 offset:51200
    v_cvt_pk_bf16_f32 v221, v110, v111
    v_mfma_f32_16x16x32_bf16 v[112:115], a[196:199], a[16:19], v[112:115]
    ds_read_b128 a[216:219], v1 offset:52224
    v_mfma_f32_16x16x32_bf16 v[112:115], a[200:203], a[20:23], v[112:115]
    v_mfma_f32_16x16x32_bf16 v[116:119], a[240:243], a[24:27], 0
    ds_read_b128 a[220:223], v1 offset:53248
    v_mfma_f32_16x16x32_bf16 v[116:119], a[244:247], a[28:31], v[116:119]
    v_mfma_f32_16x16x32_bf16 v[116:119], a[248:251], a[32:35], v[116:119]
    ds_read_b128 a[224:227], v1 offset:54272
    v_cvt_pk_bf16_f32 v210, v112, v113
    v_mfma_f32_16x16x32_bf16 v[116:119], a[192:195], a[36:39], v[116:119]
    v_cvt_pk_bf16_f32 v211, v114, v115
    v_mfma_f32_16x16x32_bf16 v[116:119], a[196:199], a[40:43], v[116:119]
    v_mfma_f32_16x16x32_bf16 v[116:119], a[200:203], a[44:47], v[116:119]
    v_mfma_f32_16x16x32_bf16 v[120:123], a[240:243], a[48:51], 0
    v_mfma_f32_16x16x32_bf16 v[120:123], a[244:247], a[52:55], v[120:123]
    v_mfma_f32_16x16x32_bf16 v[120:123], a[248:251], a[56:59], v[120:123]
    v_cvt_pk_bf16_f32 v214, v116, v117
    v_cvt_pk_bf16_f32 v215, v118, v119
    v_mfma_f32_16x16x32_bf16 v[120:123], a[192:195], a[60:63], v[120:123]
    v_mfma_f32_16x16x32_bf16 v[120:123], a[196:199], a[64:67], v[120:123]
    v_mfma_f32_16x16x32_bf16 v[120:123], a[200:203], a[68:71], v[120:123]
    v_mfma_f32_16x16x32_bf16 v[124:127], a[240:243], a[72:75], 0
    v_mfma_f32_16x16x32_bf16 v[124:127], a[244:247], a[76:79], v[124:127]
    v_mfma_f32_16x16x32_bf16 v[124:127], a[248:251], a[80:83], v[124:127]
    buffer_store_dwordx2 v[178:179], v11, s[12:15], s37 offen offset:640 sc1
    v_mfma_f32_16x16x32_bf16 v[124:127], a[192:195], a[84:87], v[124:127]
    v_cvt_pk_bf16_f32 v218, v120, v121
    v_cvt_pk_bf16_f32 v219, v122, v123
    v_mfma_f32_16x16x32_bf16 v[124:127], a[196:199], a[88:91], v[124:127]
    v_mfma_f32_16x16x32_bf16 v[124:127], a[200:203], a[92:95], v[124:127]
    s_waitcnt lgkmcnt(0)
    v_mfma_f32_16x16x32_bf16 v[96:99], a[204:207], a[0:3], 0
    v_mfma_f32_16x16x32_bf16 v[96:99], a[208:211], a[4:7], v[96:99]
    v_mfma_f32_16x16x32_bf16 v[96:99], a[212:215], a[8:11], v[96:99]
    v_cvt_pk_bf16_f32 v222, v124, v125
    v_cvt_pk_bf16_f32 v223, v126, v127
    v_mfma_f32_16x16x32_bf16 v[96:99], a[216:219], a[12:15], v[96:99]
    v_mfma_f32_16x16x32_bf16 v[96:99], a[220:223], a[16:19], v[96:99]
    v_mfma_f32_16x16x32_bf16 v[96:99], a[224:227], a[20:23], v[96:99]
    v_mfma_f32_16x16x32_bf16 v[100:103], a[204:207], a[24:27], 0
    v_mfma_f32_16x16x32_bf16 v[100:103], a[208:211], a[28:31], v[100:103]
    v_mfma_f32_16x16x32_bf16 v[100:103], a[212:215], a[32:35], v[100:103]
    v_mfma_f32_16x16x32_bf16 v[100:103], a[216:219], a[36:39], v[100:103]
    v_mfma_f32_16x16x32_bf16 v[100:103], a[220:223], a[40:43], v[100:103]
    v_mfma_f32_16x16x32_bf16 v[100:103], a[224:227], a[44:47], v[100:103]
    v_mfma_f32_16x16x32_bf16 v[32:35], a[8:11], v[192:195], v[32:35]
    v_mfma_f32_16x16x32_bf16 v[32:35], a[12:15], v[208:211], v[32:35]
    v_mfma_f32_16x16x32_bf16 v[36:39], a[32:35], v[192:195], v[36:39]
    v_mfma_f32_16x16x32_bf16 v[36:39], a[36:39], v[208:211], v[36:39]
    v_mfma_f32_16x16x32_bf16 v[40:43], a[56:59], v[192:195], v[40:43]
    v_mfma_f32_16x16x32_bf16 v[40:43], a[60:63], v[208:211], v[40:43]
    v_mfma_f32_16x16x32_bf16 v[44:47], a[80:83], v[192:195], v[44:47]
    buffer_store_dwordx2 v[180:181], v11, s[12:15], s37 offen offset:1024 sc1
    v_mfma_f32_16x16x32_bf16 v[44:47], a[84:87], v[208:211], v[44:47]
    v_cvt_pk_bf16_f32 v192, v96, v97
    v_cvt_pk_bf16_f32 v193, v98, v99
    v_mfma_f32_16x16x32_bf16 v[48:51], a[8:11], v[196:199], v[48:51]
    v_mfma_f32_16x16x32_bf16 v[48:51], a[12:15], v[212:215], v[48:51]
    v_mfma_f32_16x16x32_bf16 v[52:55], a[32:35], v[196:199], v[52:55]
    v_mfma_f32_16x16x32_bf16 v[52:55], a[36:39], v[212:215], v[52:55]
    v_mfma_f32_16x16x32_bf16 v[56:59], a[56:59], v[196:199], v[56:59]
    v_mfma_f32_16x16x32_bf16 v[56:59], a[60:63], v[212:215], v[56:59]
    v_mfma_f32_16x16x32_bf16 v[60:63], a[80:83], v[196:199], v[60:63]
    v_cvt_pk_bf16_f32 v196, v100, v101
    v_cvt_pk_bf16_f32 v197, v102, v103
    v_mfma_f32_16x16x32_bf16 v[60:63], a[84:87], v[212:215], v[60:63]
    v_mfma_f32_16x16x32_bf16 v[64:67], a[8:11], v[200:203], v[64:67]
    v_mfma_f32_16x16x32_bf16 v[64:67], a[12:15], v[216:219], v[64:67]
    v_mfma_f32_16x16x32_bf16 v[68:71], a[32:35], v[200:203], v[68:71]
    buffer_load_dwordx4 a[136:139], v9, s[8:11], s26 offen offset:256 nt
    v_mfma_f32_16x16x32_bf16 v[68:71], a[36:39], v[216:219], v[68:71]
    buffer_load_dwordx4 a[140:143], v10, s[8:11], s26 offen offset:256 nt
    s_add_u32 s26, s16, 6684672
    v_mfma_f32_16x16x32_bf16 v[72:75], a[56:59], v[200:203], v[72:75]
    ds_read_b128 a[228:231], v1 offset:55296
    v_mfma_f32_16x16x32_bf16 v[72:75], a[60:63], v[216:219], v[72:75]
    ds_read_b128 a[232:235], v1 offset:56320
    v_mfma_f32_16x16x32_bf16 v[76:79], a[80:83], v[200:203], v[76:79]
    ds_read_b128 a[236:239], v1 offset:57344
    v_mfma_f32_16x16x32_bf16 v[76:79], a[84:87], v[216:219], v[76:79]
    v_mfma_f32_16x16x32_bf16 v[80:83], a[8:11], v[204:207], v[80:83]
    ds_read_b128 a[240:243], v1 offset:58368
    v_mfma_f32_16x16x32_bf16 v[80:83], a[12:15], v[220:223], v[80:83]
    v_mfma_f32_16x16x32_bf16 v[84:87], a[32:35], v[204:207], v[84:87]
    ds_read_b128 a[244:247], v1 offset:59392
    v_mfma_f32_16x16x32_bf16 v[84:87], a[36:39], v[220:223], v[84:87]
    v_mfma_f32_16x16x32_bf16 v[88:91], a[56:59], v[204:207], v[88:91]
    buffer_store_dwordx2 v[182:183], v11, s[12:15], s37 offen offset:1408 sc1
    v_mfma_f32_16x16x32_bf16 v[88:91], a[60:63], v[220:223], v[88:91]
    ds_read_b128 a[248:251], v1 offset:60416
    s_add_u32 s37, s16, 3932160
    v_mfma_f32_16x16x32_bf16 v[92:95], a[80:83], v[204:207], v[92:95]
    v_mfma_f32_16x16x32_bf16 v[92:95], a[84:87], v[220:223], v[92:95]
    v_mfma_f32_16x16x32_bf16 v[104:107], a[204:207], a[48:51], 0
    v_mfma_f32_16x16x32_bf16 v[104:107], a[208:211], a[52:55], v[104:107]
    v_mfma_f32_16x16x32_bf16 v[104:107], a[212:215], a[56:59], v[104:107]
    v_mfma_f32_16x16x32_bf16 v[104:107], a[216:219], a[60:63], v[104:107]
    v_mfma_f32_16x16x32_bf16 v[104:107], a[220:223], a[64:67], v[104:107]
    v_mfma_f32_16x16x32_bf16 v[104:107], a[224:227], a[68:71], v[104:107]
    v_mfma_f32_16x16x32_bf16 v[108:111], a[204:207], a[72:75], 0
    v_mfma_f32_16x16x32_bf16 v[108:111], a[208:211], a[76:79], v[108:111]
    v_mfma_f32_16x16x32_bf16 v[108:111], a[212:215], a[80:83], v[108:111]
    v_cvt_pk_bf16_f32 v200, v104, v105
    v_cvt_pk_bf16_f32 v201, v106, v107
    v_mfma_f32_16x16x32_bf16 v[108:111], a[216:219], a[84:87], v[108:111]
    v_mfma_f32_16x16x32_bf16 v[108:111], a[220:223], a[88:91], v[108:111]
    ds_read_b128 a[192:195], v1 offset:61440
    v_mfma_f32_16x16x32_bf16 v[108:111], a[224:227], a[92:95], v[108:111]
    s_waitcnt lgkmcnt(1)
    v_mfma_f32_16x16x32_bf16 v[112:115], a[228:231], a[0:3], 0
    ds_read_b128 a[196:199], v1 offset:62464
    v_mfma_f32_16x16x32_bf16 v[112:115], a[232:235], a[4:7], v[112:115]
    v_mfma_f32_16x16x32_bf16 v[112:115], a[236:239], a[8:11], v[112:115]
    ds_read_b128 a[200:203], v1 offset:63488
    v_cvt_pk_bf16_f32 v204, v108, v109
    v_mfma_f32_16x16x32_bf16 v[112:115], a[240:243], a[12:15], v[112:115]
    v_cvt_pk_bf16_f32 v205, v110, v111
    v_mfma_f32_16x16x32_bf16 v[112:115], a[244:247], a[16:19], v[112:115]
    ds_read_b128 a[204:207], v1 offset:64512
    v_mfma_f32_16x16x32_bf16 v[112:115], a[248:251], a[20:23], v[112:115]
    v_mfma_f32_16x16x32_bf16 v[116:119], a[228:231], a[24:27], 0
    buffer_store_dwordx2 v[184:185], v11, s[12:15], s39 offen offset:256 sc1
    v_mfma_f32_16x16x32_bf16 v[116:119], a[232:235], a[28:31], v[116:119]
    ds_read_b128 a[208:211], v2 offset:0
    v_mfma_f32_16x16x32_bf16 v[116:119], a[236:239], a[32:35], v[116:119]
    ds_read_b128 a[212:215], v2 offset:1024
    v_cvt_pk_bf16_f32 v194, v112, v113
    v_mfma_f32_16x16x32_bf16 v[116:119], a[240:243], a[36:39], v[116:119]
    v_cvt_pk_bf16_f32 v195, v114, v115
    v_mfma_f32_16x16x32_bf16 v[116:119], a[244:247], a[40:43], v[116:119]
    v_mfma_f32_16x16x32_bf16 v[116:119], a[248:251], a[44:47], v[116:119]
    v_mfma_f32_16x16x32_bf16 v[120:123], a[228:231], a[48:51], 0
    v_mfma_f32_16x16x32_bf16 v[120:123], a[232:235], a[52:55], v[120:123]
    v_mfma_f32_16x16x32_bf16 v[120:123], a[236:239], a[56:59], v[120:123]
    v_cvt_pk_bf16_f32 v198, v116, v117
    v_cvt_pk_bf16_f32 v199, v118, v119
    v_mfma_f32_16x16x32_bf16 v[120:123], a[240:243], a[60:63], v[120:123]
    v_mfma_f32_16x16x32_bf16 v[120:123], a[244:247], a[64:67], v[120:123]
    v_mfma_f32_16x16x32_bf16 v[120:123], a[248:251], a[68:71], v[120:123]
    v_mfma_f32_16x16x32_bf16 v[124:127], a[228:231], a[72:75], 0
    v_mfma_f32_16x16x32_bf16 v[124:127], a[232:235], a[76:79], v[124:127]
    v_mfma_f32_16x16x32_bf16 v[124:127], a[236:239], a[80:83], v[124:127]
    v_cvt_pk_bf16_f32 v202, v120, v121
    v_cvt_pk_bf16_f32 v203, v122, v123
    v_mfma_f32_16x16x32_bf16 v[124:127], a[240:243], a[84:87], v[124:127]
    v_mfma_f32_16x16x32_bf16 v[124:127], a[244:247], a[88:91], v[124:127]
    ds_read_b128 a[216:219], v2 offset:2048
    v_mfma_f32_16x16x32_bf16 v[124:127], a[248:251], a[92:95], v[124:127]
    s_waitcnt lgkmcnt(1)
    v_mfma_f32_16x16x32_bf16 v[96:99], a[192:195], a[0:3], 0
    ds_read_b128 a[220:223], v2 offset:3072
    v_mfma_f32_16x16x32_bf16 v[96:99], a[196:199], a[4:7], v[96:99]
    v_mfma_f32_16x16x32_bf16 v[96:99], a[200:203], a[8:11], v[96:99]
    ds_read_b128 a[224:227], v2 offset:4096
    v_cvt_pk_bf16_f32 v206, v124, v125
    v_mfma_f32_16x16x32_bf16 v[96:99], a[204:207], a[12:15], v[96:99]
    v_cvt_pk_bf16_f32 v207, v126, v127
    v_mfma_f32_16x16x32_bf16 v[96:99], a[208:211], a[16:19], v[96:99]
    buffer_store_dwordx2 v[186:187], v11, s[12:15], s39 offen offset:640 sc1
    v_mfma_f32_16x16x32_bf16 v[96:99], a[212:215], a[20:23], v[96:99]
    ds_read_b128 a[228:231], v2 offset:5120
    v_mfma_f32_16x16x32_bf16 v[100:103], a[192:195], a[24:27], 0
    buffer_load_dwordx4 a[144:147], v9, s[8:11], s28 offen offset:0 nt
    v_mfma_f32_16x16x32_bf16 v[100:103], a[196:199], a[28:31], v[100:103]
    buffer_load_dwordx4 a[148:151], v10, s[8:11], s28 offen offset:0 nt
    v_mfma_f32_16x16x32_bf16 v[100:103], a[200:203], a[32:35], v[100:103]
    ds_read_b128 a[232:235], v2 offset:6144
    v_cvt_pk_bf16_f32 v208, v96, v97
    v_mfma_f32_16x16x32_bf16 v[100:103], a[204:207], a[36:39], v[100:103]
    ds_read_b128 a[236:239], v2 offset:7168
    v_cvt_pk_bf16_f32 v209, v98, v99
    v_mfma_f32_16x16x32_bf16 v[100:103], a[208:211], a[40:43], v[100:103]
    s_waitcnt vmcnt(28)
    ds_write_b64 v4, a[96:97] offset:0
    v_mfma_f32_16x16x32_bf16 v[100:103], a[212:215], a[44:47], v[100:103]
    ds_write_b64 v4, a[98:99] offset:1024
    v_mfma_f32_16x16x32_bf16 v[104:107], a[192:195], a[48:51], 0
    ds_write_b64 v4, a[100:101] offset:512
    v_mfma_f32_16x16x32_bf16 v[104:107], a[196:199], a[52:55], v[104:107]
    ds_write_b64 v4, a[102:103] offset:1536
    v_mfma_f32_16x16x32_bf16 v[104:107], a[200:203], a[56:59], v[104:107]
    ds_read2_b64 a[96:99], v5 offset0:0 offset1:128
    v_cvt_pk_bf16_f32 v212, v100, v101
    v_mfma_f32_16x16x32_bf16 v[104:107], a[204:207], a[60:63], v[104:107]
    ds_read2_b64 a[100:103], v6 offset0:0 offset1:128
    v_cvt_pk_bf16_f32 v213, v102, v103
    v_mfma_f32_16x16x32_bf16 v[104:107], a[208:211], a[64:67], v[104:107]
    v_mfma_f32_16x16x32_bf16 v[104:107], a[212:215], a[68:71], v[104:107]
    v_mfma_f32_16x16x32_bf16 v[108:111], a[192:195], a[72:75], 0
    v_mfma_f32_16x16x32_bf16 v[108:111], a[196:199], a[76:79], v[108:111]
    v_mfma_f32_16x16x32_bf16 v[108:111], a[200:203], a[80:83], v[108:111]
    v_cvt_pk_bf16_f32 v216, v104, v105
    v_cvt_pk_bf16_f32 v217, v106, v107
    v_mfma_f32_16x16x32_bf16 v[108:111], a[204:207], a[84:87], v[108:111]
    v_mfma_f32_16x16x32_bf16 v[108:111], a[208:211], a[88:91], v[108:111]
    ds_read_b128 a[240:243], v2 offset:8192
    v_mfma_f32_16x16x32_bf16 v[108:111], a[212:215], a[92:95], v[108:111]
    s_waitcnt lgkmcnt(7)
    v_mfma_f32_16x16x32_bf16 v[112:115], a[216:219], a[0:3], 0
    ds_read_b128 a[244:247], v2 offset:9216
    v_mfma_f32_16x16x32_bf16 v[112:115], a[220:223], a[4:7], v[112:115]
    v_mfma_f32_16x16x32_bf16 v[112:115], a[224:227], a[8:11], v[112:115]
    buffer_store_dwordx2 v[188:189], v11, s[12:15], s39 offen offset:1024 sc1
    v_mfma_f32_16x16x32_bf16 v[112:115], a[228:231], a[12:15], v[112:115]
    ds_read_b128 a[248:251], v2 offset:10240
    v_cvt_pk_bf16_f32 v220, v108, v109
    v_mfma_f32_16x16x32_bf16 v[112:115], a[232:235], a[16:19], v[112:115]
    ds_read_b128 a[192:195], v2 offset:11264
    v_cvt_pk_bf16_f32 v221, v110, v111
    v_mfma_f32_16x16x32_bf16 v[112:115], a[236:239], a[20:23], v[112:115]
    v_mfma_f32_16x16x32_bf16 v[116:119], a[216:219], a[24:27], 0
    ds_read_b128 a[196:199], v2 offset:12288
    v_mfma_f32_16x16x32_bf16 v[116:119], a[220:223], a[28:31], v[116:119]
    s_waitcnt vmcnt(24)
    ds_write_b64 v4, a[104:105] offset:0
    v_mfma_f32_16x16x32_bf16 v[116:119], a[224:227], a[32:35], v[116:119]
    ds_read_b128 a[200:203], v2 offset:13312
    v_cvt_pk_bf16_f32 v210, v112, v113
    v_mfma_f32_16x16x32_bf16 v[116:119], a[228:231], a[36:39], v[116:119]
    ds_write_b64 v4, a[106:107] offset:1024
    v_mfma_f32_16x16x32_bf16 v[116:119], a[232:235], a[40:43], v[116:119]
    ds_write_b64 v4, a[108:109] offset:512
    v_mfma_f32_16x16x32_bf16 v[116:119], a[236:239], a[44:47], v[116:119]
    ds_write_b64 v4, a[110:111] offset:1536
    v_mfma_f32_16x16x32_bf16 v[120:123], a[216:219], a[48:51], 0
    ds_read2_b64 a[104:107], v5 offset0:0 offset1:128
    v_cvt_pk_bf16_f32 v211, v114, v115
    v_mfma_f32_16x16x32_bf16 v[120:123], a[220:223], a[52:55], v[120:123]
    ds_read2_b64 a[108:111], v6 offset0:0 offset1:128
    v_mfma_f32_16x16x32_bf16 v[120:123], a[224:227], a[56:59], v[120:123]
    v_cvt_pk_bf16_f32 v214, v116, v117
    v_cvt_pk_bf16_f32 v215, v118, v119
    v_mfma_f32_16x16x32_bf16 v[120:123], a[228:231], a[60:63], v[120:123]
    v_mfma_f32_16x16x32_bf16 v[120:123], a[232:235], a[64:67], v[120:123]
    v_mfma_f32_16x16x32_bf16 v[120:123], a[236:239], a[68:71], v[120:123]
    v_mfma_f32_16x16x32_bf16 v[124:127], a[216:219], a[72:75], 0
    v_mfma_f32_16x16x32_bf16 v[124:127], a[220:223], a[76:79], v[124:127]
    v_mfma_f32_16x16x32_bf16 v[124:127], a[224:227], a[80:83], v[124:127]
    v_cvt_pk_bf16_f32 v218, v120, v121
    v_cvt_pk_bf16_f32 v219, v122, v123
    v_mfma_f32_16x16x32_bf16 v[124:127], a[228:231], a[84:87], v[124:127]
    v_mfma_f32_16x16x32_bf16 v[124:127], a[232:235], a[88:91], v[124:127]
    v_mfma_f32_16x16x32_bf16 v[124:127], a[236:239], a[92:95], v[124:127]
    s_waitcnt lgkmcnt(4)
    v_mfma_f32_16x16x32_bf16 v[96:99], a[0:3], a[240:243], 0
    buffer_store_dwordx2 v[190:191], v11, s[12:15], s39 offen offset:1408 sc1
    v_mfma_f32_16x16x32_bf16 v[96:99], a[4:7], a[244:247], v[96:99]
    s_add_u32 s39, s16, 4325376
    v_mfma_f32_16x16x32_bf16 v[96:99], a[8:11], a[248:251], v[96:99]
    v_cvt_pk_bf16_f32 v222, v124, v125
    v_cvt_pk_bf16_f32 v223, v126, v127
    v_mfma_f32_16x16x32_bf16 v[96:99], a[12:15], a[192:195], v[96:99]
    v_mfma_f32_16x16x32_bf16 v[96:99], a[16:19], a[196:199], v[96:99]
    v_mfma_f32_16x16x32_bf16 v[96:99], a[20:23], a[200:203], v[96:99]
    v_mfma_f32_16x16x32_bf16 v[100:103], a[24:27], a[240:243], 0
    v_mfma_f32_16x16x32_bf16 v[100:103], a[28:31], a[244:247], v[100:103]
    v_mfma_f32_16x16x32_bf16 v[100:103], a[32:35], a[248:251], v[100:103]
    s_waitcnt vmcnt(21)
    ds_write_b64 v4, a[112:113] offset:0
    v_mfma_f32_16x16x32_bf16 v[100:103], a[36:39], a[192:195], v[100:103]
    ds_write_b64 v4, a[114:115] offset:1024
    v_mfma_f32_16x16x32_bf16 v[100:103], a[40:43], a[196:199], v[100:103]
    ds_write_b64 v4, a[116:117] offset:512
    v_mfma_f32_16x16x32_bf16 v[100:103], a[44:47], a[200:203], v[100:103]
    ds_write_b64 v4, a[118:119] offset:1536
    v_mfma_f32_16x16x32_bf16 v[32:35], a[16:19], v[192:195], v[32:35]
    ds_read2_b64 a[112:115], v5 offset0:0 offset1:128
    v_cvt_pk_bf16_f32 v128, v96, v97
    v_mfma_f32_16x16x32_bf16 v[32:35], a[20:23], v[208:211], v[32:35]
    ds_read2_b64 a[116:119], v6 offset0:0 offset1:128
    v_cvt_pk_bf16_f32 v129, v98, v99
    v_mfma_f32_16x16x32_bf16 v[36:39], a[40:43], v[192:195], v[36:39]
    buffer_load_dwordx4 a[168:171], v9, s[8:11], s30 offen offset:0 nt
    v_cvt_pk_bf16_f32 v130, v100, v101
    v_mfma_f32_16x16x32_bf16 v[36:39], a[44:47], v[208:211], v[36:39]
    buffer_load_dwordx4 a[172:175], v10, s[8:11], s30 offen offset:0 nt
    v_cvt_pk_bf16_f32 v131, v102, v103
    s_mov_b32 s18, 1
    s_mov_b32 s19, 0
    s_branch L_loop
L_slow0:
    s_sub_u32 s43, s43, 1
    s_cbranch_scc1 L_end
    ds_read_b32 v30, v29
    s_waitcnt lgkmcnt(0)
    v_readfirstlane_b32 s41, v30
    s_nop 1
    s_andn2_b32 s41, 1, s41
    s_cbranch_scc1 L_slow0
    s_branch L_ok0
L_slow1:
    s_sub_u32 s43, s43, 1
    s_cbranch_scc1 L_end
    ds_read_b32 v30, v29
    s_waitcnt lgkmcnt(0)
    v_readfirstlane_b32 s41, v30
    s_nop 1
    s_andn2_b32 s41, 2, s41
    s_cbranch_scc1 L_slow1
    s_branch L_ok1
L_slow2:
    s_sub_u32 s43, s43, 1
    s_cbranch_scc1 L_end
    ds_read_b32 v30, v29
    s_waitcnt lgkmcnt(0)
    v_readfirstlane_b32 s41, v30
    s_nop 1
    s_andn2_b32 s41, 4, s41
    s_cbranch_scc1 L_slow2
    s_branch L_ok2
L_slow3:
    s_sub_u32 s43, s43, 1
    s_cbranch_scc1 L_end
    ds_read_b32 v30, v29
    s_waitcnt lgkmcnt(0)
    v_readfirstlane_b32 s41, v30
    s_nop 1
    s_andn2_b32 s41, 8, s41
    s_cbranch_scc1 L_slow3
    s_branch L_ok3
L_slow4:
    s_sub_u32 s43, s43, 1
    s_cbranch_scc1 L_end
    ds_read_b32 v30, v29
    s_waitcnt lgkmcnt(0)
    v_readfirstlane_b32 s41, v30
    s_nop 1
    s_andn2_b32 s41, 16, s41
    s_cbranch_scc1 L_slow4
    s_branch L_ok4
L_slow5:
    s_sub_u32 s43, s43, 1
    s_cbranch_scc1 L_end
    ds_read_b32 v30, v29
    s_waitcnt lgkmcnt(0)
    v_readfirstlane_b32 s41, v30
    s_nop 1
    s_andn2_b32 s41, 32, s41
    s_cbranch_scc1 L_slow5
    s_branch L_ok5
L_slow6:
    s_sub_u32 s43, s43, 1
    s_cbranch_scc1 L_end
    ds_read_b32 v30, v29
    s_waitcnt lgkmcnt(0)
    v_readfirstlane_b32 s41, v30
    s_nop 1
    s_andn2_b32 s41, 960, s41
    s_cbranch_scc1 L_slow6
    s_branch L_ok6
L_fb:
    s_mov_b32 s60, 0
    s_cmp_lt_u32 s2, 192
    s_cbranch_scc0 L_fb_task
L_fbw:
    s_sub_u32 s43, s43, 1
    s_cbranch_scc1 L_end
    ds_read_b32 v34, v29 offset:4
    s_waitcnt lgkmcnt(0)
    v_readfirstlane_b32 s61, v34
    s_nop 1
    s_cmp_eq_u32 s61, 3
    s_cbranch_scc0 L_fbw
L_fb_task:
    s_mov_b32 s63, 3
    s_branch L_raw
L_fb_raw:
    s_bitcmp1_b32 s63, 1
    s_mov_b32 s63, 1
    s_cbranch_scc1 L_raw
    s_branch L_prod
L_fb_next:
    s_waitcnt vmcnt(0)
    s_add_u32 s60, s60, 1
    s_cmp_lt_u32 s60, 72
    s_cbranch_scc1 L_fb_task
    s_branch L_go
L_code_end:
.section .rodata,"a"
.p2align 6
.amdhsa_kernel standalone__swin_window_attn__vision_kernel
  .amdhsa_next_free_vgpr 512
  .amdhsa_next_free_sgpr 102
  .amdhsa_accum_offset 256
  .amdhsa_group_segment_fixed_size 0
  .amdhsa_kernarg_size 48
  .amdhsa_user_sgpr_count 2
  .amdhsa_user_sgpr_kernarg_segment_ptr 1
  .amdhsa_system_sgpr_workgroup_id_x 1
.end_amdhsa_kernel
```

```asm
; @launch grid=(256,1,1) block=(256,1,1) lds=163840
.amdgcn_target "amdgcn-amd-amdhsa--gfx950"
.text
.globl standalone__swin_window_attn__vision_kernel
.p2align 8
.type standalone__swin_window_attn__vision_kernel,@function
standalone__swin_window_attn__vision_kernel:
    s_cmp_ge_u32 s2, 256
    s_cbranch_scc1 L_end
    s_load_dwordx4 s[4:7], s[0:1], 0
    s_load_dwordx4 s[20:23], s[0:1], 16
    s_load_dwordx4 s[56:59], s[0:1], 32
    v_lshrrev_b32 v16, 6, v0
    v_and_b32 v0, 63, v0
    s_getpc_b64 s[44:45]
L_pc_ref:
    v_readfirstlane_b32 s49, v16
    s_mov_b32 s46, L_code_end-L_pc_ref
    s_mov_b32 s47, 0x00020000
    v_lshlrev_b32 v7, 6, v0
    s_lshr_b32 s60, s2, 3

    s_lshl_b32 s42, s60, 2
    s_add_u32 s42, s42, s49
    s_lshl_b32 s42, s42, 7
    v_lshrrev_b32 v8, 1, v0
    v_and_b32 v7, 1, v0
    v_lshlrev_b32 v7, 6, v7
    v_lshl_add_u32 v8, v8, 14, v7
    buffer_load_dword v8, v8, s[44:47], s42 offen
    s_cmp_lt_u32 s60, 24
    s_cbranch_scc0 L_setup
    s_cmp_ge_u32 s60, 12
    s_cselect_b32 s61, 12, 0
    s_cselect_b32 s62, 36, 0
    s_sub_u32 s61, s60, s61
    s_and_b32 s64, s61, 1
    s_mul_i32 s64, s64, 3
    s_max_u32 s65, s49, 1
    s_add_u32 s64, s64, s65
    s_sub_u32 s64, s64, 1
    s_mul_i32 s64, s64, 6
    s_lshr_b32 s61, s61, 1
    s_add_u32 s60, s64, s61
    s_add_u32 s60, s60, s62
    s_cmp_eq_u32 s49, 0
    s_cselect_b32 s63, 2, 0
L_raw:
    s_cmp_ge_u32 s60, 36
    s_cselect_b32 s65, 36, 0
    s_cselect_b32 s97, 768, 0
    s_sub_u32 s65, s60, s65
    s_mul_i32 s66, s65, 43
    s_lshr_b32 s66, s66, 8
    s_mul_i32 s67, s66, 6
    s_sub_u32 s67, s65, s67
    s_max_u32 s64, s49, 1
    s_mul_i32 s64, s64, 12288
    s_mul_i32 s61, s66, 36864
    s_add_u32 s61, s61, 384
    s_mul_i32 s62, s67, 36864
    s_add_u32 s62, s62, s97
    s_bitcmp1_b32 s63, 1
    s_cselect_b32 s61, s62, s61
    s_cselect_b32 s64, 0, s64
    s_cselect_b32 s97, 0, s97
    s_movk_i32 s62, 128
    s_movk_i32 s65, 9216
    s_mov_b32 s96, 32
    v_lshrrev_b32 v16, 3, v0
    v_and_b32 v17, 7, v0
    v_bfe_u32 v18, v0, 4, 1
    v_xor_b32 v17, v17, v18
    v_lshlrev_b32 v17, 4, v17
    v_mul_u32_u24 v16, 1152, v16
    s_cmp_eq_u32 s97, 0
    s_mov_b32 s18, 221184
    s_cbranch_scc1 L_raw_rows
    s_mov_b32 s18, 73728
    s_lshl_b32 s61, s66, 6
    s_movk_i32 s62, 6144
    s_movk_i32 s65, 18432
    s_mov_b32 s96, 0
    v_lshrrev_b32 v16, 2, v0
    v_mul_u32_u24 v16, 384, v16
    v_and_b32 v17, 3, v0
    v_lshlrev_b32 v17, 4, v17
L_raw_rows:
    s_waitcnt lgkmcnt(0)
    s_cmp_eq_u32 s97, 0
    s_cselect_b32 s16, s6, s20
    s_cselect_b32 s17, s7, s21
    s_mov_b32 s19, 0x00020000
    s_mov_b32 m0, s64
    s_mov_b32 s97, 4
L_raw_lp:
    v_add_u32 v18, v16, v17
    s_add_u32 s42, s61, s62
    buffer_load_dwordx4 v18, s[16:19], s61 offen lds
    s_add_u32 m0, m0, 1024
    s_add_u32 s41, s42, s62
    buffer_load_dwordx4 v18, s[16:19], s42 offen lds
    s_add_u32 m0, m0, 1024
    s_add_u32 s61, s61, s65
    buffer_load_dwordx4 v18, s[16:19], s41 offen lds
    s_add_u32 m0, m0, 1024
    s_and_b32 s42, s97, 1
    s_mul_i32 s42, s42, s96
    s_lshl_b32 s42, s42, 1
    s_add_u32 s42, s42, s96
    v_xor_b32 v17, s42, v17
    s_sub_u32 s97, s97, 1
    s_cmp_lg_u32 s97, 0
    s_cbranch_scc1 L_raw_lp
    s_bitcmp1_b32 s63, 0
    s_cbranch_scc1 L_fb_raw
L_setup:
    s_mov_b32 s43, 0x400000
    v_lshlrev_b32 v1, 4, v0
    v_add_u32 v2, 0x10000, v1
    v_add_u32 v3, 0x20000, v1
    v_lshrrev_b32 v16, 3, v0
    v_and_b32 v17, 7, v0
    v_lshrrev_b32 v18, 4, v0
    v_xor_b32 v17, v17, v18
    v_lshlrev_b32 v17, 4, v17
    v_mul_u32_u24 v16, 384, v16
    v_add_u32 v9, v16, v17
    v_xor_b32 v10, 64, v9
    v_add_u32 v10, 196608, v10
    s_lshl_b32 s52, s49, 11
    s_add_u32 s52, s52, 147456
    v_lshlrev_b32 v16, 3, v0
    v_add_u32 v4, s52, v16
    v_and_b32 v16, 15, v0
    v_lshrrev_b32 v17, 4, v0
    v_lshrrev_b32 v18, 1, v16
    v_xor_b32 v18, v18, v17
    v_lshlrev_b32 v18, 3, v18
    v_lshl_add_u32 v18, v16, 6, v18
    v_add_u32 v5, s52, v18
    v_xor_b32 v6, 32, v5
    v_lshrrev_b32 v16, 5, v0
    v_mul_u32_u24 v16, 196608, v16
    v_lshrrev_b32 v17, 4, v0
    v_and_b32 v17, 1, v17
    v_mul_u32_u24 v17, 1536, v17
    v_and_b32 v18, 15, v0
    v_lshlrev_b32 v18, 3, v18
    v_add3_u32 v11, v16, v17, v18
    s_nop 0
    s_and_b32 s53, s2, 7
    s_lshl_b32 s53, s53, 3
    s_lshr_b32 s54, s2, 7
    s_add_u32 s53, s53, s54
    s_lshr_b32 s54, s2, 3
    s_and_b32 s54, s54, 15
    s_mul_i32 s53, s53, 1572864
    s_lshl_b32 s54, s54, 2
    s_add_u32 s54, s54, s49
    s_mul_i32 s54, s54, 3072
    s_add_u32 s53, s53, s54
    s_add_u32 s24, s53, 0
    s_add_u32 s26, s53, 393216
    s_add_u32 s28, s53, 786432
    s_add_u32 s30, s53, 1179648
    v_mov_b32 v29, 155648
    v_mov_b32 v30, 0
    v_mov_b32 v31, 0
    ds_write_b64 v29, v[30:31]
    s_getreg_b32 s48, hwreg(HW_REG_XCC_ID, 0, 3)
    s_waitcnt lgkmcnt(0)
    s_mov_b32 s8, s4
    s_mov_b32 s9, s5
    s_mov_b32 s10, 100663296
    s_mov_b32 s11, 0x00020000
    s_barrier
    s_cmp_eq_u32 s49, 0
    s_cbranch_scc0 L_nox0
    buffer_load_dwordx4 a[0:3], v9, s[8:11], s24 offen offset:0 nt
    buffer_load_dwordx4 a[4:7], v10, s[8:11], s24 offen offset:0 nt
    buffer_load_dwordx4 a[8:11], v9, s[8:11], s24 offen offset:128 nt
    buffer_load_dwordx4 a[12:15], v10, s[8:11], s24 offen offset:128 nt
    buffer_load_dwordx4 a[16:19], v9, s[8:11], s24 offen offset:256 nt
    buffer_load_dwordx4 a[20:23], v10, s[8:11], s24 offen offset:256 nt
    buffer_load_dwordx4 a[24:27], v9, s[8:11], s26 offen offset:0 nt
    buffer_load_dwordx4 a[28:31], v10, s[8:11], s26 offen offset:0 nt
    buffer_load_dwordx4 a[32:35], v9, s[8:11], s26 offen offset:128 nt
    buffer_load_dwordx4 a[36:39], v10, s[8:11], s26 offen offset:128 nt
    buffer_load_dwordx4 a[40:43], v9, s[8:11], s26 offen offset:256 nt
    buffer_load_dwordx4 a[44:47], v10, s[8:11], s26 offen offset:256 nt
    buffer_load_dwordx4 a[48:51], v9, s[8:11], s28 offen offset:0 nt
    buffer_load_dwordx4 a[52:55], v10, s[8:11], s28 offen offset:0 nt
    buffer_load_dwordx4 a[56:59], v9, s[8:11], s28 offen offset:128 nt
    buffer_load_dwordx4 a[60:63], v10, s[8:11], s28 offen offset:128 nt
    buffer_load_dwordx4 a[64:67], v9, s[8:11], s28 offen offset:256 nt
    buffer_load_dwordx4 a[68:71], v10, s[8:11], s28 offen offset:256 nt
    buffer_load_dwordx4 a[72:75], v9, s[8:11], s30 offen offset:0 nt
    buffer_load_dwordx4 a[76:79], v10, s[8:11], s30 offen offset:0 nt
    buffer_load_dwordx4 a[80:83], v9, s[8:11], s30 offen offset:128 nt
    buffer_load_dwordx4 a[84:87], v10, s[8:11], s30 offen offset:128 nt
    buffer_load_dwordx4 a[88:91], v9, s[8:11], s30 offen offset:256 nt
    buffer_load_dwordx4 a[92:95], v10, s[8:11], s30 offen offset:256 nt
L_nox0:
    s_mov_b32 s3, s53
    s_mov_b32 s12, s22
    s_mov_b32 s13, s23
    s_mov_b32 s14, 100663296
    s_mov_b32 s15, 0x00020000
    s_mov_b32 s40, 0x3dd53b95
    s_mov_b32 s50, s58
    s_mov_b32 s51, s59
    s_mov_b32 s58, 256
    s_mov_b32 s59, 0x00020000
    s_mul_i32 s52, s48, 147456
    s_add_u32 s52, s50, s52
    s_addc_u32 s53, s51, 0
    s_mov_b32 s54, 147456
    s_mov_b32 s55, 0x00020000
    s_lshl_b32 s48, s48, 5
    s_lshl_b32 s42, 4096, s49
    v_mov_b32 v31, s42
    s_cmp_eq_u32 s49, 0
    s_cbranch_scc1 L_w0
    s_cmp_lt_u32 s2, 192
    s_cbranch_scc0 L_noprod
L_prod:
    s_mul_i32 s61, s66, 12
    s_add_u32 s61, s61, s67
    s_lshl_b32 s61, s61, 10
    s_add_u32 s62, s61, 6144
    v_mov_b32 v27, v1
    v_bfe_u32 v22, v0, 2, 2
    v_and_b32 v23, 3, v0
    v_lshrrev_b32 v26, 4, v0
    s_cmp_ge_u32 s60, 36
    s_cbranch_scc0 L_prod_A
    v_mul_u32_u24 v27, 6144, v23
    v_lshlrev_b32 v24, 8, v26
    v_lshlrev_b32 v25, 4, v22
    v_add3_u32 v27, v27, v24, v25
    s_lshr_b32 s61, s66, 1
    s_mul_i32 s61, s61, 24576
    s_and_b32 s62, s66, 1
    s_lshl_b32 s62, s62, 7
    s_add_u32 s61, s61, s62
    s_lshl_b32 s62, s67, 10
    s_add_u32 s61, s61, s62
    s_add_u32 s61, s61, 73728
    s_add_u32 s62, s61, 64
L_prod_A:
    v_mul_u32_u24 v24, 3072, v22
    v_lshl_add_u32 v24, v23, 7, v24
    v_bfe_u32 v25, v0, 1, 1
    v_lshl_add_u32 v25, v22, 1, v25
    v_xor_b32 v25, v25, v26
    v_lshl_add_u32 v24, v25, 4, v24
    v_xor_b32 v25, 64, v24
    v_lshl_add_u32 v26, v26, 3, v22
    v_lshlrev_b32 v26, 6, v26
    v_lshl_add_u32 v26, v23, 3, v26
    v_add_u32 v26, s64, v26
    s_waitcnt vmcnt(0)
    s_bitcmp1_b32 s63, 0
    s_cbranch_scc1 L_gotA
L_wA:
    s_sub_u32 s43, s43, 1
    s_cbranch_scc1 L_end
    ds_read_b32 v30, v29
    s_waitcnt lgkmcnt(0)
    v_readfirstlane_b32 s41, v30
    s_nop 1
    s_and_b32 s42, s41, 0x100000
    s_cmp_eq_u32 s42, 0x100000
    s_cbranch_scc0 L_wA
L_gotA:
    ds_read_b128 v[32:35], v24 offset:0
    ds_read_b128 v[56:59], v24 offset:512
    ds_read_b128 v[36:39], v25 offset:0
    ds_read_b128 v[60:63], v25 offset:512
    ds_read_b128 v[40:43], v24 offset:1024
    ds_read_b128 v[64:67], v24 offset:1536
    ds_read_b128 v[44:47], v25 offset:1024
    ds_read_b128 v[68:71], v25 offset:1536
    ds_read_b128 v[48:51], v24 offset:2048
    ds_read_b128 v[72:75], v24 offset:2560
    ds_read_b128 v[52:55], v25 offset:2048
    ds_read_b128 v[76:79], v25 offset:2560
    s_cmp_ge_u32 s60, 36
    s_cbranch_scc1 L_prod_N2
    v_add_u32 v24, s64, v24
    v_add_u32 v25, s64, v25
    ds_read_b128 v[80:83], v24 offset:0
    ds_read_b128 v[104:107], v24 offset:512
    ds_read_b128 v[84:87], v25 offset:0
    ds_read_b128 v[108:111], v25 offset:512
    ds_read_b128 v[88:91], v24 offset:1024
    ds_read_b128 v[112:115], v24 offset:1536
    ds_read_b128 v[92:95], v25 offset:1024
    ds_read_b128 v[116:119], v25 offset:1536
    ds_read_b128 v[96:99], v24 offset:2048
    ds_read_b128 v[120:123], v24 offset:2560
    ds_read_b128 v[100:103], v25 offset:2048
    ds_read_b128 v[124:127], v25 offset:2560
    s_branch L_prod_mm
L_prod_N2:
    ds_read_b64_tr_b16 v[80:81], v26 offset:0
    ds_read_b64_tr_b16 v[82:83], v26 offset:256
    ds_read_b64_tr_b16 v[104:105], v26 offset:32
    ds_read_b64_tr_b16 v[106:107], v26 offset:288
    ds_read_b64_tr_b16 v[84:85], v26 offset:2048
    ds_read_b64_tr_b16 v[86:87], v26 offset:2304
    ds_read_b64_tr_b16 v[108:109], v26 offset:2080
    ds_read_b64_tr_b16 v[110:111], v26 offset:2336
    ds_read_b64_tr_b16 v[88:89], v26 offset:4096
    ds_read_b64_tr_b16 v[90:91], v26 offset:4352
    ds_read_b64_tr_b16 v[112:113], v26 offset:4128
    ds_read_b64_tr_b16 v[114:115], v26 offset:4384
    ds_read_b64_tr_b16 v[92:93], v26 offset:6144
    ds_read_b64_tr_b16 v[94:95], v26 offset:6400
    ds_read_b64_tr_b16 v[116:117], v26 offset:6176
    ds_read_b64_tr_b16 v[118:119], v26 offset:6432
    ds_read_b64_tr_b16 v[96:97], v26 offset:8192
    ds_read_b64_tr_b16 v[98:99], v26 offset:8448
    ds_read_b64_tr_b16 v[120:121], v26 offset:8224
    ds_read_b64_tr_b16 v[122:123], v26 offset:8480
    ds_read_b64_tr_b16 v[100:101], v26 offset:10240
    ds_read_b64_tr_b16 v[102:103], v26 offset:10496
    ds_read_b64_tr_b16 v[124:125], v26 offset:10272
    ds_read_b64_tr_b16 v[126:127], v26 offset:10528
L_prod_mm:
    s_cmp_ge_u32 s60, 36
    s_cselect_b32 s65, 1.0, s40
    s_waitcnt lgkmcnt(0)
    v_mfma_f32_16x16x32_bf16 v[128:131], v[32:35], v[80:83], 0
    v_mfma_f32_16x16x32_bf16 v[132:135], v[56:59], v[80:83], 0
    v_mfma_f32_16x16x32_bf16 v[128:131], v[36:39], v[84:87], v[128:131]
    v_mfma_f32_16x16x32_bf16 v[132:135], v[60:63], v[84:87], v[132:135]
    v_mfma_f32_16x16x32_bf16 v[128:131], v[40:43], v[88:91], v[128:131]
    v_mfma_f32_16x16x32_bf16 v[132:135], v[64:67], v[88:91], v[132:135]
    v_mfma_f32_16x16x32_bf16 v[128:131], v[44:47], v[92:95], v[128:131]
    v_mfma_f32_16x16x32_bf16 v[132:135], v[68:71], v[92:95], v[132:135]
    v_mfma_f32_16x16x32_bf16 v[128:131], v[48:51], v[96:99], v[128:131]
    v_mfma_f32_16x16x32_bf16 v[132:135], v[72:75], v[96:99], v[132:135]
    v_mfma_f32_16x16x32_bf16 v[128:131], v[52:55], v[100:103], v[128:131]
    v_mfma_f32_16x16x32_bf16 v[132:135], v[76:79], v[100:103], v[132:135]
    v_mfma_f32_16x16x32_bf16 v[136:139], v[32:35], v[104:107], 0
    v_mfma_f32_16x16x32_bf16 v[140:143], v[56:59], v[104:107], 0
    v_mfma_f32_16x16x32_bf16 v[136:139], v[36:39], v[108:111], v[136:139]
    v_mfma_f32_16x16x32_bf16 v[140:143], v[60:63], v[108:111], v[140:143]
    v_mfma_f32_16x16x32_bf16 v[136:139], v[40:43], v[112:115], v[136:139]
    v_mfma_f32_16x16x32_bf16 v[140:143], v[64:67], v[112:115], v[140:143]
    v_mfma_f32_16x16x32_bf16 v[136:139], v[44:47], v[116:119], v[136:139]
    v_mfma_f32_16x16x32_bf16 v[140:143], v[68:71], v[116:119], v[140:143]
    v_mfma_f32_16x16x32_bf16 v[136:139], v[48:51], v[120:123], v[136:139]
    v_mfma_f32_16x16x32_bf16 v[140:143], v[72:75], v[120:123], v[140:143]
    v_mfma_f32_16x16x32_bf16 v[136:139], v[52:55], v[124:127], v[136:139]
    v_mfma_f32_16x16x32_bf16 v[140:143], v[76:79], v[124:127], v[140:143]
    v_mul_f32 v128, s65, v128
    v_mul_f32 v129, s65, v129
    v_mul_f32 v130, s65, v130
    v_mul_f32 v131, s65, v131
    v_mul_f32 v132, s65, v132
    v_mul_f32 v133, s65, v133
    v_mul_f32 v134, s65, v134
    v_mul_f32 v135, s65, v135
    v_cvt_pk_bf16_f32 v144, v128, v129
    v_cvt_pk_bf16_f32 v145, v130, v131
    v_cvt_pk_bf16_f32 v146, v132, v133
    v_cvt_pk_bf16_f32 v147, v134, v135
    buffer_store_dwordx4 v[144:147], v27, s[52:55], s61 offen
    s_nop 7
    v_mul_f32 v136, s65, v136
    v_mul_f32 v137, s65, v137
    v_mul_f32 v138, s65, v138
    v_mul_f32 v139, s65, v139
    v_mul_f32 v140, s65, v140
    v_mul_f32 v141, s65, v141
    v_mul_f32 v142, s65, v142
    v_mul_f32 v143, s65, v143
    v_cvt_pk_bf16_f32 v148, v136, v137
    v_cvt_pk_bf16_f32 v149, v138, v139
    v_cvt_pk_bf16_f32 v150, v140, v141
    v_cvt_pk_bf16_f32 v151, v142, v143
    buffer_store_dwordx4 v[148:151], v27, s[52:55], s62 offen
    s_bitcmp1_b32 s63, 0
    s_cbranch_scc1 L_fb_next
    s_cmp_eq_u32 s49, 1
    s_cbranch_scc0 L_p23
    buffer_load_dwordx4 a[0:3], v9, s[8:11], s24 offen offset:0 nt
    buffer_load_dwordx4 a[4:7], v10, s[8:11], s24 offen offset:0 nt
    buffer_load_dwordx4 a[8:11], v9, s[8:11], s24 offen offset:128 nt
    buffer_load_dwordx4 a[12:15], v10, s[8:11], s24 offen offset:128 nt
    buffer_load_dwordx4 a[16:19], v9, s[8:11], s24 offen offset:256 nt
    buffer_load_dwordx4 a[20:23], v10, s[8:11], s24 offen offset:256 nt
    buffer_load_dwordx4 a[24:27], v9, s[8:11], s26 offen offset:0 nt
    buffer_load_dwordx4 a[28:31], v10, s[8:11], s26 offen offset:0 nt
    buffer_load_dwordx4 a[32:35], v9, s[8:11], s26 offen offset:128 nt
    buffer_load_dwordx4 a[36:39], v10, s[8:11], s26 offen offset:128 nt
    buffer_load_dwordx4 a[40:43], v9, s[8:11], s26 offen offset:256 nt
    buffer_load_dwordx4 a[44:47], v10, s[8:11], s26 offen offset:256 nt
    buffer_load_dwordx4 a[48:51], v9, s[8:11], s28 offen offset:0 nt
    buffer_load_dwordx4 a[52:55], v10, s[8:11], s28 offen offset:0 nt
    buffer_load_dwordx4 a[56:59], v9, s[8:11], s28 offen offset:128 nt
    buffer_load_dwordx4 a[60:63], v10, s[8:11], s28 offen offset:128 nt
    buffer_load_dwordx4 a[64:67], v9, s[8:11], s28 offen offset:256 nt
    buffer_load_dwordx4 a[68:71], v10, s[8:11], s28 offen offset:256 nt
    buffer_load_dwordx4 a[72:75], v9, s[8:11], s30 offen offset:0 nt
    buffer_load_dwordx4 a[76:79], v10, s[8:11], s30 offen offset:0 nt
    buffer_load_dwordx4 a[80:83], v9, s[8:11], s30 offen offset:128 nt
    buffer_load_dwordx4 a[84:87], v10, s[8:11], s30 offen offset:128 nt
    buffer_load_dwordx4 a[88:91], v9, s[8:11], s30 offen offset:256 nt
    buffer_load_dwordx4 a[92:95], v10, s[8:11], s30 offen offset:256 nt
    s_waitcnt vmcnt(24)
    v_mov_b32 v32, 1
    s_lshr_b32 s60, s2, 3
    s_add_u32 s60, s60, s48
    v_mov_b32 v33, s60
    s_mov_b64 exec, 1
    ds_add_rtn_u32 v34, v29, v32 offset:4
    s_waitcnt lgkmcnt(0)
    v_readfirstlane_b32 s61, v34
    s_nop 1
    s_cmp_eq_u32 s61, 2
    s_cbranch_scc0 L_nl1
    buffer_store_byte v32, v33, s[56:59], 0 offen
    v_mov_b32 v32, 0x400000
    ds_or_b32 v29, v32
L_nl1:
    s_mov_b64 exec, -1
    v_mov_b32 v16, v4
    v_mov_b32 v17, v5
    v_mov_b32 v18, v6
    s_waitcnt vmcnt(22)
    ds_write_b64 v16, a[0:1] offset:0
    ds_write_b64 v16, a[2:3] offset:1024
    ds_write_b64 v16, a[4:5] offset:512
    ds_write_b64 v16, a[6:7] offset:1536
    ds_read2_b64 a[0:3], v17 offset0:0 offset1:128
    ds_read2_b64 a[4:7], v18 offset0:0 offset1:128
    s_waitcnt vmcnt(20)
    ds_or_b32 v29, v31
    ds_write_b64 v16, a[8:9] offset:0
    ds_write_b64 v16, a[10:11] offset:1024
    ds_write_b64 v16, a[12:13] offset:512
    ds_write_b64 v16, a[14:15] offset:1536
    ds_read2_b64 a[8:11], v17 offset0:0 offset1:128
    ds_read2_b64 a[12:15], v18 offset0:0 offset1:128
    s_waitcnt vmcnt(18)
    ds_write_b64 v16, a[16:17] offset:0
    ds_write_b64 v16, a[18:19] offset:1024
    ds_write_b64 v16, a[20:21] offset:512
    ds_write_b64 v16, a[22:23] offset:1536
    ds_read2_b64 a[16:19], v17 offset0:0 offset1:128
    ds_read2_b64 a[20:23], v18 offset0:0 offset1:128
    s_waitcnt vmcnt(16)
    ds_write_b64 v16, a[24:25] offset:0
    ds_write_b64 v16, a[26:27] offset:1024
    ds_write_b64 v16, a[28:29] offset:512
    ds_write_b64 v16, a[30:31] offset:1536
    ds_read2_b64 a[24:27], v17 offset0:0 offset1:128
    ds_read2_b64 a[28:31], v18 offset0:0 offset1:128
    s_waitcnt vmcnt(14)
    ds_write_b64 v16, a[32:33] offset:0
    ds_write_b64 v16, a[34:35] offset:1024
    ds_write_b64 v16, a[36:37] offset:512
    ds_write_b64 v16, a[38:39] offset:1536
    ds_read2_b64 a[32:35], v17 offset0:0 offset1:128
    ds_read2_b64 a[36:39], v18 offset0:0 offset1:128
    s_waitcnt vmcnt(12)
    ds_write_b64 v16, a[40:41] offset:0
    ds_write_b64 v16, a[42:43] offset:1024
    ds_write_b64 v16, a[44:45] offset:512
    ds_write_b64 v16, a[46:47] offset:1536
    ds_read2_b64 a[40:43], v17 offset0:0 offset1:128
    ds_read2_b64 a[44:47], v18 offset0:0 offset1:128
    s_waitcnt vmcnt(10)
    ds_write_b64 v16, a[48:49] offset:0
    ds_write_b64 v16, a[50:51] offset:1024
    ds_write_b64 v16, a[52:53] offset:512
    ds_write_b64 v16, a[54:55] offset:1536
    ds_read2_b64 a[48:51], v17 offset0:0 offset1:128
    ds_read2_b64 a[52:55], v18 offset0:0 offset1:128
    s_waitcnt vmcnt(8)
    ds_write_b64 v16, a[56:57] offset:0
    ds_write_b64 v16, a[58:59] offset:1024
    ds_write_b64 v16, a[60:61] offset:512
    ds_write_b64 v16, a[62:63] offset:1536
    ds_read2_b64 a[56:59], v17 offset0:0 offset1:128
    ds_read2_b64 a[60:63], v18 offset0:0 offset1:128
    s_waitcnt vmcnt(6)
    ds_write_b64 v16, a[64:65] offset:0
    ds_write_b64 v16, a[66:67] offset:1024
    ds_write_b64 v16, a[68:69] offset:512
    ds_write_b64 v16, a[70:71] offset:1536
    ds_read2_b64 a[64:67], v17 offset0:0 offset1:128
    ds_read2_b64 a[68:71], v18 offset0:0 offset1:128
    s_waitcnt vmcnt(4)
    ds_write_b64 v16, a[72:73] offset:0
    ds_write_b64 v16, a[74:75] offset:1024
    ds_write_b64 v16, a[76:77] offset:512
    ds_write_b64 v16, a[78:79] offset:1536
    ds_read2_b64 a[72:75], v17 offset0:0 offset1:128
    ds_read2_b64 a[76:79], v18 offset0:0 offset1:128
    s_waitcnt vmcnt(2)
    ds_write_b64 v16, a[80:81] offset:0
    ds_write_b64 v16, a[82:83] offset:1024
    ds_write_b64 v16, a[84:85] offset:512
    ds_write_b64 v16, a[86:87] offset:1536
    ds_read2_b64 a[80:83], v17 offset0:0 offset1:128
    ds_read2_b64 a[84:87], v18 offset0:0 offset1:128
    s_waitcnt vmcnt(0)
    ds_write_b64 v16, a[88:89] offset:0
    ds_write_b64 v16, a[90:91] offset:1024
    ds_write_b64 v16, a[92:93] offset:512
    ds_write_b64 v16, a[94:95] offset:1536
    ds_read2_b64 a[88:91], v17 offset0:0 offset1:128
    ds_read2_b64 a[92:95], v18 offset0:0 offset1:128
    s_branch L_w1go
L_p23:
    s_waitcnt vmcnt(0)
    v_mov_b32 v32, 1
    s_lshr_b32 s60, s2, 3
    s_add_u32 s60, s60, s48
    v_mov_b32 v33, s60
    s_mov_b64 exec, 1
    ds_add_rtn_u32 v34, v29, v32 offset:4
    s_waitcnt lgkmcnt(0)
    v_readfirstlane_b32 s61, v34
    s_nop 1
    s_cmp_eq_u32 s61, 2
    s_cbranch_scc0 L_nl2
    buffer_store_byte v32, v33, s[56:59], 0 offen
    v_mov_b32 v32, 0x400000
    ds_or_b32 v29, v32
L_nl2:
    s_mov_b64 exec, -1
L_noprod:
    s_lshl_b32 s60, 2048, s49
    s_cmp_lt_u32 s2, 192
    s_cselect_b32 s61, 0x400000, 0
    s_or_b32 s60, s60, s61
L_wpace:
    s_sub_u32 s43, s43, 1
    s_cbranch_scc1 L_end
    ds_read_b32 v30, v29
    s_waitcnt lgkmcnt(0)
    v_readfirstlane_b32 s41, v30
    s_nop 1
    s_and_b32 s42, s41, s60
    s_cmp_eq_u32 s42, s60
    s_cbranch_scc0 L_wpace
    buffer_load_dwordx4 a[0:3], v9, s[8:11], s24 offen offset:0 nt
    buffer_load_dwordx4 a[4:7], v10, s[8:11], s24 offen offset:0 nt
    buffer_load_dwordx4 a[8:11], v9, s[8:11], s24 offen offset:128 nt
    buffer_load_dwordx4 a[12:15], v10, s[8:11], s24 offen offset:128 nt
    buffer_load_dwordx4 a[16:19], v9, s[8:11], s24 offen offset:256 nt
    buffer_load_dwordx4 a[20:23], v10, s[8:11], s24 offen offset:256 nt
    buffer_load_dwordx4 a[24:27], v9, s[8:11], s26 offen offset:0 nt
    buffer_load_dwordx4 a[28:31], v10, s[8:11], s26 offen offset:0 nt
    buffer_load_dwordx4 a[32:35], v9, s[8:11], s26 offen offset:128 nt
    buffer_load_dwordx4 a[36:39], v10, s[8:11], s26 offen offset:128 nt
    buffer_load_dwordx4 a[40:43], v9, s[8:11], s26 offen offset:256 nt
    buffer_load_dwordx4 a[44:47], v10, s[8:11], s26 offen offset:256 nt
    buffer_load_dwordx4 a[48:51], v9, s[8:11], s28 offen offset:0 nt
    buffer_load_dwordx4 a[52:55], v10, s[8:11], s28 offen offset:0 nt
    buffer_load_dwordx4 a[56:59], v9, s[8:11], s28 offen offset:128 nt
    buffer_load_dwordx4 a[60:63], v10, s[8:11], s28 offen offset:128 nt
    buffer_load_dwordx4 a[64:67], v9, s[8:11], s28 offen offset:256 nt
    buffer_load_dwordx4 a[68:71], v10, s[8:11], s28 offen offset:256 nt
    buffer_load_dwordx4 a[72:75], v9, s[8:11], s30 offen offset:0 nt
    buffer_load_dwordx4 a[76:79], v10, s[8:11], s30 offen offset:0 nt
    buffer_load_dwordx4 a[80:83], v9, s[8:11], s30 offen offset:128 nt
    buffer_load_dwordx4 a[84:87], v10, s[8:11], s30 offen offset:128 nt
    buffer_load_dwordx4 a[88:91], v9, s[8:11], s30 offen offset:256 nt
    buffer_load_dwordx4 a[92:95], v10, s[8:11], s30 offen offset:256 nt
    v_mov_b32 v16, v4
    v_mov_b32 v17, v5
    v_mov_b32 v18, v6
    s_waitcnt vmcnt(22)
    ds_write_b64 v16, a[0:1] offset:0
    ds_write_b64 v16, a[2:3] offset:1024
    ds_write_b64 v16, a[4:5] offset:512
    ds_write_b64 v16, a[6:7] offset:1536
    ds_read2_b64 a[0:3], v17 offset0:0 offset1:128
    ds_read2_b64 a[4:7], v18 offset0:0 offset1:128
    s_waitcnt vmcnt(20)
    ds_or_b32 v29, v31
    ds_write_b64 v16, a[8:9] offset:0
    ds_write_b64 v16, a[10:11] offset:1024
    ds_write_b64 v16, a[12:13] offset:512
    ds_write_b64 v16, a[14:15] offset:1536
    ds_read2_b64 a[8:11], v17 offset0:0 offset1:128
    ds_read2_b64 a[12:15], v18 offset0:0 offset1:128
    s_waitcnt vmcnt(18)
    ds_write_b64 v16, a[16:17] offset:0
    ds_write_b64 v16, a[18:19] offset:1024
    ds_write_b64 v16, a[20:21] offset:512
    ds_write_b64 v16, a[22:23] offset:1536
    ds_read2_b64 a[16:19], v17 offset0:0 offset1:128
    ds_read2_b64 a[20:23], v18 offset0:0 offset1:128
    s_waitcnt vmcnt(16)
    ds_write_b64 v16, a[24:25] offset:0
    ds_write_b64 v16, a[26:27] offset:1024
    ds_write_b64 v16, a[28:29] offset:512
    ds_write_b64 v16, a[30:31] offset:1536
    ds_read2_b64 a[24:27], v17 offset0:0 offset1:128
    ds_read2_b64 a[28:31], v18 offset0:0 offset1:128
    s_waitcnt vmcnt(14)
    ds_write_b64 v16, a[32:33] offset:0
    ds_write_b64 v16, a[34:35] offset:1024
    ds_write_b64 v16, a[36:37] offset:512
    ds_write_b64 v16, a[38:39] offset:1536
    ds_read2_b64 a[32:35], v17 offset0:0 offset1:128
    ds_read2_b64 a[36:39], v18 offset0:0 offset1:128
    s_waitcnt vmcnt(12)
    ds_write_b64 v16, a[40:41] offset:0
    ds_write_b64 v16, a[42:43] offset:1024
    ds_write_b64 v16, a[44:45] offset:512
    ds_write_b64 v16, a[46:47] offset:1536
    ds_read2_b64 a[40:43], v17 offset0:0 offset1:128
    ds_read2_b64 a[44:47], v18 offset0:0 offset1:128
    s_waitcnt vmcnt(10)
    ds_write_b64 v16, a[48:49] offset:0
    ds_write_b64 v16, a[50:51] offset:1024
    ds_write_b64 v16, a[52:53] offset:512
    ds_write_b64 v16, a[54:55] offset:1536
    ds_read2_b64 a[48:51], v17 offset0:0 offset1:128
    ds_read2_b64 a[52:55], v18 offset0:0 offset1:128
    s_waitcnt vmcnt(8)
    ds_write_b64 v16, a[56:57] offset:0
    ds_write_b64 v16, a[58:59] offset:1024
    ds_write_b64 v16, a[60:61] offset:512
    ds_write_b64 v16, a[62:63] offset:1536
    ds_read2_b64 a[56:59], v17 offset0:0 offset1:128
    ds_read2_b64 a[60:63], v18 offset0:0 offset1:128
    s_waitcnt vmcnt(6)
    ds_write_b64 v16, a[64:65] offset:0
    ds_write_b64 v16, a[66:67] offset:1024
    ds_write_b64 v16, a[68:69] offset:512
    ds_write_b64 v16, a[70:71] offset:1536
    ds_read2_b64 a[64:67], v17 offset0:0 offset1:128
    ds_read2_b64 a[68:71], v18 offset0:0 offset1:128
    s_waitcnt vmcnt(4)
    ds_write_b64 v16, a[72:73] offset:0
    ds_write_b64 v16, a[74:75] offset:1024
    ds_write_b64 v16, a[76:77] offset:512
    ds_write_b64 v16, a[78:79] offset:1536
    ds_read2_b64 a[72:75], v17 offset0:0 offset1:128
    ds_read2_b64 a[76:79], v18 offset0:0 offset1:128
    s_waitcnt vmcnt(2)
    ds_write_b64 v16, a[80:81] offset:0
    ds_write_b64 v16, a[82:83] offset:1024
    ds_write_b64 v16, a[84:85] offset:512
    ds_write_b64 v16, a[86:87] offset:1536
    ds_read2_b64 a[80:83], v17 offset0:0 offset1:128
    ds_read2_b64 a[84:87], v18 offset0:0 offset1:128
    s_waitcnt vmcnt(0)
    ds_write_b64 v16, a[88:89] offset:0
    ds_write_b64 v16, a[90:91] offset:1024
    ds_write_b64 v16, a[92:93] offset:512
    ds_write_b64 v16, a[94:95] offset:1536
    ds_read2_b64 a[88:91], v17 offset0:0 offset1:128
    ds_read2_b64 a[92:95], v18 offset0:0 offset1:128
L_w1go:
    s_cmp_eq_u32 s49, 1
    s_cbranch_scc0 L_enter
L_wgo:
    s_sub_u32 s43, s43, 1
    s_cbranch_scc1 L_end
    ds_read_b32 v30, v29
    s_waitcnt lgkmcnt(0)
    v_readfirstlane_b32 s41, v30
    s_nop 1
    s_and_b32 s42, s41, 0x200000
    s_cmp_eq_u32 s42, 0x200000
    s_cbranch_scc0 L_wgo
    s_mov_b32 s60, 36864
    s_add_u32 s61, s60, 0
    s_mov_b32 m0, s61
    s_nop 0
    buffer_load_dwordx4 v1, s[52:55], s61 offen offset:0 lds
    buffer_load_dwordx4 v1, s[52:55], s61 offen offset:1024 lds
    buffer_load_dwordx4 v1, s[52:55], s61 offen offset:2048 lds
    buffer_load_dwordx4 v1, s[52:55], s61 offen offset:3072 lds
    s_add_u32 s61, s60, 4096
    s_mov_b32 m0, s61
    s_nop 0
    buffer_load_dwordx4 v1, s[52:55], s61 offen offset:0 lds
    buffer_load_dwordx4 v1, s[52:55], s61 offen offset:1024 lds
    buffer_load_dwordx4 v1, s[52:55], s61 offen offset:2048 lds
    buffer_load_dwordx4 v1, s[52:55], s61 offen offset:3072 lds
    s_add_u32 s61, s60, 8192
    s_mov_b32 m0, s61
    s_nop 0
    buffer_load_dwordx4 v1, s[52:55], s61 offen offset:0 lds
    buffer_load_dwordx4 v1, s[52:55], s61 offen offset:1024 lds
    buffer_load_dwordx4 v1, s[52:55], s61 offen offset:2048 lds
    buffer_load_dwordx4 v1, s[52:55], s61 offen offset:3072 lds
    s_add_u32 s61, s60, 12288
    s_mov_b32 m0, s61
    s_nop 0
    buffer_load_dwordx4 v1, s[52:55], s61 offen offset:0 lds
    buffer_load_dwordx4 v1, s[52:55], s61 offen offset:1024 lds
    buffer_load_dwordx4 v1, s[52:55], s61 offen offset:2048 lds
    buffer_load_dwordx4 v1, s[52:55], s61 offen offset:3072 lds
    s_add_u32 s61, s60, 16384
    s_mov_b32 m0, s61
    s_nop 0
    buffer_load_dwordx4 v1, s[52:55], s61 offen offset:0 lds
    buffer_load_dwordx4 v1, s[52:55], s61 offen offset:1024 lds
    buffer_load_dwordx4 v1, s[52:55], s61 offen offset:2048 lds
    buffer_load_dwordx4 v1, s[52:55], s61 offen offset:3072 lds
    s_add_u32 s61, s60, 20480
    s_mov_b32 m0, s61
    s_nop 0
    buffer_load_dwordx4 v1, s[52:55], s61 offen offset:0 lds
    buffer_load_dwordx4 v1, s[52:55], s61 offen offset:1024 lds
    buffer_load_dwordx4 v1, s[52:55], s61 offen offset:2048 lds
    buffer_load_dwordx4 v1, s[52:55], s61 offen offset:3072 lds
    s_add_u32 s61, s60, 24576
    s_mov_b32 m0, s61
    s_nop 0
    buffer_load_dwordx4 v1, s[52:55], s61 offen offset:0 lds
    buffer_load_dwordx4 v1, s[52:55], s61 offen offset:1024 lds
    buffer_load_dwordx4 v1, s[52:55], s61 offen offset:2048 lds
    buffer_load_dwordx4 v1, s[52:55], s61 offen offset:3072 lds
    s_add_u32 s61, s60, 28672
    s_mov_b32 m0, s61
    s_nop 0
    buffer_load_dwordx4 v1, s[52:55], s61 offen offset:0 lds
    buffer_load_dwordx4 v1, s[52:55], s61 offen offset:1024 lds
    buffer_load_dwordx4 v1, s[52:55], s61 offen offset:2048 lds
    buffer_load_dwordx4 v1, s[52:55], s61 offen offset:3072 lds
    s_add_u32 s61, s60, 32768
    s_mov_b32 m0, s61
    s_nop 0
    buffer_load_dwordx4 v1, s[52:55], s61 offen offset:0 lds
    buffer_load_dwordx4 v1, s[52:55], s61 offen offset:1024 lds
    buffer_load_dwordx4 v1, s[52:55], s61 offen offset:2048 lds
    buffer_load_dwordx4 v1, s[52:55], s61 offen offset:3072 lds
    v_mov_b32 v26, 8
    v_mov_b32 v27, 16
    v_mov_b32 v28, 32
    s_branch L_enter
L_w0:
    s_waitcnt vmcnt(24)
    v_mov_b32 v30, 1048576
    ds_or_b32 v29, v30
    v_mov_b32 v16, v4
    v_mov_b32 v17, v5
    v_mov_b32 v18, v6
    s_waitcnt vmcnt(22)
    ds_write_b64 v16, a[0:1] offset:0
    ds_write_b64 v16, a[2:3] offset:1024
    ds_write_b64 v16, a[4:5] offset:512
    ds_write_b64 v16, a[6:7] offset:1536
    ds_read2_b64 a[0:3], v17 offset0:0 offset1:128
    ds_read2_b64 a[4:7], v18 offset0:0 offset1:128
    s_waitcnt vmcnt(20)
    ds_or_b32 v29, v31
    ds_write_b64 v16, a[8:9] offset:0
    ds_write_b64 v16, a[10:11] offset:1024
    ds_write_b64 v16, a[12:13] offset:512
    ds_write_b64 v16, a[14:15] offset:1536
    ds_read2_b64 a[8:11], v17 offset0:0 offset1:128
    ds_read2_b64 a[12:15], v18 offset0:0 offset1:128
    s_waitcnt vmcnt(18)
    ds_write_b64 v16, a[16:17] offset:0
    ds_write_b64 v16, a[18:19] offset:1024
    ds_write_b64 v16, a[20:21] offset:512
    ds_write_b64 v16, a[22:23] offset:1536
    ds_read2_b64 a[16:19], v17 offset0:0 offset1:128
    ds_read2_b64 a[20:23], v18 offset0:0 offset1:128
    s_waitcnt vmcnt(16)
    ds_write_b64 v16, a[24:25] offset:0
    ds_write_b64 v16, a[26:27] offset:1024
    ds_write_b64 v16, a[28:29] offset:512
    ds_write_b64 v16, a[30:31] offset:1536
    ds_read2_b64 a[24:27], v17 offset0:0 offset1:128
    ds_read2_b64 a[28:31], v18 offset0:0 offset1:128
    s_waitcnt vmcnt(14)
    ds_write_b64 v16, a[32:33] offset:0
    ds_write_b64 v16, a[34:35] offset:1024
    ds_write_b64 v16, a[36:37] offset:512
    ds_write_b64 v16, a[38:39] offset:1536
    ds_read2_b64 a[32:35], v17 offset0:0 offset1:128
    ds_read2_b64 a[36:39], v18 offset0:0 offset1:128
    s_waitcnt vmcnt(12)
    ds_write_b64 v16, a[40:41] offset:0
    ds_write_b64 v16, a[42:43] offset:1024
    ds_write_b64 v16, a[44:45] offset:512
    ds_write_b64 v16, a[46:47] offset:1536
    ds_read2_b64 a[40:43], v17 offset0:0 offset1:128
    ds_read2_b64 a[44:47], v18 offset0:0 offset1:128
    s_waitcnt vmcnt(10)
    ds_write_b64 v16, a[48:49] offset:0
    ds_write_b64 v16, a[50:51] offset:1024
    ds_write_b64 v16, a[52:53] offset:512
    ds_write_b64 v16, a[54:55] offset:1536
    ds_read2_b64 a[48:51], v17 offset0:0 offset1:128
    ds_read2_b64 a[52:55], v18 offset0:0 offset1:128
    s_waitcnt vmcnt(8)
    ds_write_b64 v16, a[56:57] offset:0
    ds_write_b64 v16, a[58:59] offset:1024
    ds_write_b64 v16, a[60:61] offset:512
    ds_write_b64 v16, a[62:63] offset:1536
    ds_read2_b64 a[56:59], v17 offset0:0 offset1:128
    ds_read2_b64 a[60:63], v18 offset0:0 offset1:128
    s_waitcnt vmcnt(6)
    ds_write_b64 v16, a[64:65] offset:0
    ds_write_b64 v16, a[66:67] offset:1024
    ds_write_b64 v16, a[68:69] offset:512
    ds_write_b64 v16, a[70:71] offset:1536
    ds_read2_b64 a[64:67], v17 offset0:0 offset1:128
    ds_read2_b64 a[68:71], v18 offset0:0 offset1:128
    s_waitcnt vmcnt(4)
    ds_write_b64 v16, a[72:73] offset:0
    ds_write_b64 v16, a[74:75] offset:1024
    ds_write_b64 v16, a[76:77] offset:512
    ds_write_b64 v16, a[78:79] offset:1536
    ds_read2_b64 a[72:75], v17 offset0:0 offset1:128
    ds_read2_b64 a[76:79], v18 offset0:0 offset1:128
    s_waitcnt vmcnt(2)
    ds_write_b64 v16, a[80:81] offset:0
    ds_write_b64 v16, a[82:83] offset:1024
    ds_write_b64 v16, a[84:85] offset:512
    ds_write_b64 v16, a[86:87] offset:1536
    ds_read2_b64 a[80:83], v17 offset0:0 offset1:128
    ds_read2_b64 a[84:87], v18 offset0:0 offset1:128
    s_waitcnt vmcnt(0)
    ds_write_b64 v16, a[88:89] offset:0
    ds_write_b64 v16, a[90:91] offset:1024
    ds_write_b64 v16, a[92:93] offset:512
    ds_write_b64 v16, a[94:95] offset:1536
    ds_read2_b64 a[88:91], v17 offset0:0 offset1:128
    ds_read2_b64 a[92:95], v18 offset0:0 offset1:128
L_poll0:
    s_mov_b32 s61, 0
    v_min_u32 v33, 5, v0
    v_lshlrev_b32 v33, 2, v33
    s_mov_b32 s62, 0x01010101
    v_mov_b32 v34, 0
L_poll:
    buffer_load_dword v34, v33, s[56:59], s48 offen nt
    s_add_u32 s61, s61, 1
    s_sleep 4
    v_cmp_ne_u32 vcc, s62, v34
    s_nop 4
    s_cbranch_vccz L_go
    s_cmp_lt_u32 s61, 400
    s_cbranch_scc1 L_poll
    s_waitcnt vmcnt(0)
    s_branch L_fb
L_go:
    s_mov_b32 s60, 0
    s_add_u32 s61, s60, 0
    s_mov_b32 m0, s61
    s_nop 0
    buffer_load_dwordx4 v1, s[52:55], s61 offen offset:0 lds
    buffer_load_dwordx4 v1, s[52:55], s61 offen offset:1024 lds
    buffer_load_dwordx4 v1, s[52:55], s61 offen offset:2048 lds
    buffer_load_dwordx4 v1, s[52:55], s61 offen offset:3072 lds
    s_add_u32 s61, s60, 4096
    s_mov_b32 m0, s61
    s_nop 0
    buffer_load_dwordx4 v1, s[52:55], s61 offen offset:0 lds
    buffer_load_dwordx4 v1, s[52:55], s61 offen offset:1024 lds
    buffer_load_dwordx4 v1, s[52:55], s61 offen offset:2048 lds
    buffer_load_dwordx4 v1, s[52:55], s61 offen offset:3072 lds
    s_add_u32 s61, s60, 8192
    s_mov_b32 m0, s61
    s_nop 0
    buffer_load_dwordx4 v1, s[52:55], s61 offen offset:0 lds
    buffer_load_dwordx4 v1, s[52:55], s61 offen offset:1024 lds
    buffer_load_dwordx4 v1, s[52:55], s61 offen offset:2048 lds
    buffer_load_dwordx4 v1, s[52:55], s61 offen offset:3072 lds
    v_mov_b32 v30, 2097152
    ds_or_b32 v29, v30
    s_add_u32 s61, s60, 12288
    s_mov_b32 m0, s61
    s_nop 0
    buffer_load_dwordx4 v1, s[52:55], s61 offen offset:0 lds
    buffer_load_dwordx4 v1, s[52:55], s61 offen offset:1024 lds
    buffer_load_dwordx4 v1, s[52:55], s61 offen offset:2048 lds
    buffer_load_dwordx4 v1, s[52:55], s61 offen offset:3072 lds
    s_add_u32 s61, s60, 16384
    s_mov_b32 m0, s61
    s_nop 0
    buffer_load_dwordx4 v1, s[52:55], s61 offen offset:0 lds
    buffer_load_dwordx4 v1, s[52:55], s61 offen offset:1024 lds
    buffer_load_dwordx4 v1, s[52:55], s61 offen offset:2048 lds
    buffer_load_dwordx4 v1, s[52:55], s61 offen offset:3072 lds
    s_add_u32 s61, s60, 20480
    s_mov_b32 m0, s61
    s_nop 0
    buffer_load_dwordx4 v1, s[52:55], s61 offen offset:0 lds
    buffer_load_dwordx4 v1, s[52:55], s61 offen offset:1024 lds
    buffer_load_dwordx4 v1, s[52:55], s61 offen offset:2048 lds
    buffer_load_dwordx4 v1, s[52:55], s61 offen offset:3072 lds
    s_add_u32 s61, s60, 24576
    s_mov_b32 m0, s61
    s_nop 0
    buffer_load_dwordx4 v1, s[52:55], s61 offen offset:0 lds
    buffer_load_dwordx4 v1, s[52:55], s61 offen offset:1024 lds
    buffer_load_dwordx4 v1, s[52:55], s61 offen offset:2048 lds
    buffer_load_dwordx4 v1, s[52:55], s61 offen offset:3072 lds
    s_add_u32 s61, s60, 28672
    s_mov_b32 m0, s61
    s_nop 0
    buffer_load_dwordx4 v1, s[52:55], s61 offen offset:0 lds
    buffer_load_dwordx4 v1, s[52:55], s61 offen offset:1024 lds
    buffer_load_dwordx4 v1, s[52:55], s61 offen offset:2048 lds
    buffer_load_dwordx4 v1, s[52:55], s61 offen offset:3072 lds
    s_add_u32 s61, s60, 32768
    s_mov_b32 m0, s61
    s_nop 0
    buffer_load_dwordx4 v1, s[52:55], s61 offen offset:0 lds
    buffer_load_dwordx4 v1, s[52:55], s61 offen offset:1024 lds
    buffer_load_dwordx4 v1, s[52:55], s61 offen offset:2048 lds
    buffer_load_dwordx4 v1, s[52:55], s61 offen offset:3072 lds
    v_mov_b32 v26, 2
    v_mov_b32 v27, 4
    s_waitcnt vmcnt(24)
    v_mov_b32 v30, 1
    ds_or_b32 v29, v30
L_enter:
    v_mov_b32 v16, v4
    v_mov_b32 v17, v5
    v_mov_b32 v18, v6
    s_mul_i32 s60, s49, 18432
    s_add_u32 s60, s60, 73728
    v_add_u32 v24, s60, v1
    s_lshl_b32 s61, 64, s49
    v_mov_b32 v25, s61
    s_waitcnt lgkmcnt(0)
    s_sub_u32 s16, s3, 6291456
    s_mov_b32 s19, 100663296
    s_mov_b32 s18, 0
    s_mov_b32 s33, 100663296
    s_mov_b32 s35, 100663296
    s_mov_b32 s37, 100663296
    s_mov_b32 s39, 100663296
    ds_read_b32 v30, v29
    s_waitcnt lgkmcnt(0)
    v_readfirstlane_b32 s41, v30
    s_nop 1
    s_bitcmp1_b32 s41, 0
    s_cbranch_scc0 L_slow0
L_ok0:
    ds_read_b128 a[192:195], v1 offset:0
    ds_read_b128 a[196:199], v1 offset:1024
    ds_read_b128 a[200:203], v1 offset:2048
    ds_read_b128 a[204:207], v1 offset:3072
    ds_read_b128 a[208:211], v1 offset:4096
    ds_read_b128 a[212:215], v1 offset:5120
    ds_read_b128 a[216:219], v1 offset:6144
    ds_read_b128 a[220:223], v1 offset:7168
    s_waitcnt lgkmcnt(7)
    v_mfma_f32_16x16x32_bf16 v[96:99], a[192:195], a[0:3], 0
    s_add_u32 s16, s16, 6291456
    s_waitcnt lgkmcnt(6)
    v_mfma_f32_16x16x32_bf16 v[96:99], a[196:199], a[4:7], v[96:99]
    s_add_u32 s24, s16, 3145728
    s_waitcnt lgkmcnt(5)
    v_mfma_f32_16x16x32_bf16 v[96:99], a[200:203], a[8:11], v[96:99]
    ds_read_b128 a[224:227], v1 offset:8192
    s_waitcnt lgkmcnt(5)
    v_mfma_f32_16x16x32_bf16 v[96:99], a[204:207], a[12:15], v[96:99]
    s_add_u32 s26, s16, 3538944
    s_waitcnt lgkmcnt(4)
    v_mfma_f32_16x16x32_bf16 v[96:99], a[208:211], a[16:19], v[96:99]
    ds_read_b128 a[228:231], v1 offset:9216
    s_waitcnt lgkmcnt(2)
    v_mfma_f32_16x16x32_bf16 v[96:99], a[212:215], a[20:23], v[96:99]
    s_add_u32 s28, s16, 3932160
    s_add_u32 s30, s16, 4325376
    v_mfma_f32_16x16x32_bf16 v[100:103], a[192:195], a[24:27], 0
    ds_read_b128 a[232:235], v1 offset:10240
    s_add_u32 s32, s16, 0
    v_mfma_f32_16x16x32_bf16 v[100:103], a[196:199], a[28:31], v[100:103]
    s_add_u32 s34, s16, 393216
    s_add_u32 s36, s16, 786432
    v_mfma_f32_16x16x32_bf16 v[100:103], a[200:203], a[32:35], v[100:103]
    ds_read_b128 a[236:239], v1 offset:11264
    v_cvt_pk_bf16_f32 v192, v96, v97
    v_mfma_f32_16x16x32_bf16 v[100:103], a[204:207], a[36:39], v[100:103]
    v_cvt_pk_bf16_f32 v193, v98, v99
    s_add_u32 s38, s16, 1179648
    v_mfma_f32_16x16x32_bf16 v[100:103], a[208:211], a[40:43], v[100:103]
    s_cmp_eq_u32 s49, 0
    s_cbranch_scc0 L_pub0
    s_waitcnt vmcnt(12)
    ds_or_b32 v29, v26
L_pub0:
    v_mfma_f32_16x16x32_bf16 v[100:103], a[212:215], a[44:47], v[100:103]
    ds_read_b32 v30, v29
    s_add_u32 s33, s16, 3145728
    v_mfma_f32_16x16x32_bf16 v[104:107], a[192:195], a[48:51], 0
    s_add_u32 s35, s16, 3538944
    s_add_u32 s37, s16, 3932160
    v_mfma_f32_16x16x32_bf16 v[104:107], a[196:199], a[52:55], v[104:107]
    s_add_u32 s39, s16, 4325376
    v_mfma_f32_16x16x32_bf16 v[104:107], a[200:203], a[56:59], v[104:107]
    v_cvt_pk_bf16_f32 v196, v100, v101
    v_cvt_pk_bf16_f32 v197, v102, v103
    v_mfma_f32_16x16x32_bf16 v[104:107], a[204:207], a[60:63], v[104:107]
    v_mfma_f32_16x16x32_bf16 v[104:107], a[208:211], a[64:67], v[104:107]
    v_mfma_f32_16x16x32_bf16 v[104:107], a[212:215], a[68:71], v[104:107]
    v_mfma_f32_16x16x32_bf16 v[108:111], a[192:195], a[72:75], 0
    v_mfma_f32_16x16x32_bf16 v[108:111], a[196:199], a[76:79], v[108:111]
    v_mfma_f32_16x16x32_bf16 v[108:111], a[200:203], a[80:83], v[108:111]
    s_waitcnt lgkmcnt(0)
    v_readfirstlane_b32 s41, v30
    v_mfma_f32_16x16x32_bf16 v[108:111], a[204:207], a[84:87], v[108:111]
    v_cvt_pk_bf16_f32 v200, v104, v105
    v_cvt_pk_bf16_f32 v201, v106, v107
    v_mfma_f32_16x16x32_bf16 v[108:111], a[208:211], a[88:91], v[108:111]
    s_bitcmp1_b32 s41, 1
    s_cbranch_scc0 L_slow1
L_ok1:
    v_mfma_f32_16x16x32_bf16 v[108:111], a[212:215], a[92:95], v[108:111]
    ds_read_b128 a[240:243], v1 offset:12288
    s_add_u32 s61, s60, 0
    v_mfma_f32_16x16x32_bf16 v[112:115], a[216:219], a[0:3], 0
    buffer_load_dwordx4 v[128:131], v1, s[52:55], s61 offen offset:0
    v_mfma_f32_16x16x32_bf16 v[112:115], a[220:223], a[4:7], v[112:115]
    ds_read_b128 a[244:247], v1 offset:13312
    v_mfma_f32_16x16x32_bf16 v[112:115], a[224:227], a[8:11], v[112:115]
    ds_read_b128 a[248:251], v1 offset:14336
    v_cvt_pk_bf16_f32 v204, v108, v109
    v_mfma_f32_16x16x32_bf16 v[112:115], a[228:231], a[12:15], v[112:115]
    v_cvt_pk_bf16_f32 v205, v110, v111
    v_mfma_f32_16x16x32_bf16 v[112:115], a[232:235], a[16:19], v[112:115]
    ds_read_b128 a[192:195], v1 offset:15360
    v_mfma_f32_16x16x32_bf16 v[112:115], a[236:239], a[20:23], v[112:115]
    v_mfma_f32_16x16x32_bf16 v[116:119], a[216:219], a[24:27], 0
    buffer_load_dwordx4 v[132:135], v1, s[52:55], s61 offen offset:1024
    v_mfma_f32_16x16x32_bf16 v[116:119], a[220:223], a[28:31], v[116:119]
    ds_read_b128 a[196:199], v1 offset:16384
    v_mfma_f32_16x16x32_bf16 v[116:119], a[224:227], a[32:35], v[116:119]
    ds_read_b128 a[200:203], v1 offset:17408
    v_cvt_pk_bf16_f32 v194, v112, v113
    v_mfma_f32_16x16x32_bf16 v[116:119], a[228:231], a[36:39], v[116:119]
    s_cmp_eq_u32 s49, 1
    s_cbranch_scc0 L_pub2
    s_waitcnt vmcnt(26)
    ds_or_b32 v29, v26
L_pub2:
    v_mfma_f32_16x16x32_bf16 v[116:119], a[232:235], a[40:43], v[116:119]
    v_cvt_pk_bf16_f32 v195, v114, v115
    v_mfma_f32_16x16x32_bf16 v[116:119], a[236:239], a[44:47], v[116:119]
    v_mfma_f32_16x16x32_bf16 v[120:123], a[216:219], a[48:51], 0
    buffer_load_dwordx4 v[136:139], v1, s[52:55], s61 offen offset:2048
    v_mfma_f32_16x16x32_bf16 v[120:123], a[220:223], a[52:55], v[120:123]
    v_mfma_f32_16x16x32_bf16 v[120:123], a[224:227], a[56:59], v[120:123]
    v_cvt_pk_bf16_f32 v198, v116, v117
    v_cvt_pk_bf16_f32 v199, v118, v119
    v_mfma_f32_16x16x32_bf16 v[120:123], a[228:231], a[60:63], v[120:123]
    v_mfma_f32_16x16x32_bf16 v[120:123], a[232:235], a[64:67], v[120:123]
    v_mfma_f32_16x16x32_bf16 v[120:123], a[236:239], a[68:71], v[120:123]
    v_mfma_f32_16x16x32_bf16 v[124:127], a[216:219], a[72:75], 0
    buffer_load_dwordx4 v[140:143], v1, s[52:55], s61 offen offset:3072
    v_mfma_f32_16x16x32_bf16 v[124:127], a[220:223], a[76:79], v[124:127]
    v_mfma_f32_16x16x32_bf16 v[124:127], a[224:227], a[80:83], v[124:127]
    v_cvt_pk_bf16_f32 v202, v120, v121
    v_cvt_pk_bf16_f32 v203, v122, v123
    v_mfma_f32_16x16x32_bf16 v[124:127], a[228:231], a[84:87], v[124:127]
    v_mfma_f32_16x16x32_bf16 v[124:127], a[232:235], a[88:91], v[124:127]
    ds_read_b128 a[204:207], v1 offset:18432
    s_add_u32 s61, s60, 4096
    v_mfma_f32_16x16x32_bf16 v[124:127], a[236:239], a[92:95], v[124:127]
    s_waitcnt lgkmcnt(1)
    v_mfma_f32_16x16x32_bf16 v[96:99], a[240:243], a[0:3], 0
    buffer_load_dwordx4 v[144:147], v1, s[52:55], s61 offen offset:0
    v_mfma_f32_16x16x32_bf16 v[96:99], a[244:247], a[4:7], v[96:99]
    ds_read_b128 a[208:211], v1 offset:19456
    v_mfma_f32_16x16x32_bf16 v[96:99], a[248:251], a[8:11], v[96:99]
    ds_read_b128 a[212:215], v1 offset:20480
    v_cvt_pk_bf16_f32 v206, v124, v125
    v_mfma_f32_16x16x32_bf16 v[96:99], a[192:195], a[12:15], v[96:99]
    v_cvt_pk_bf16_f32 v207, v126, v127
    v_mfma_f32_16x16x32_bf16 v[96:99], a[196:199], a[16:19], v[96:99]
    ds_read_b128 a[216:219], v1 offset:21504
    v_mfma_f32_16x16x32_bf16 v[96:99], a[200:203], a[20:23], v[96:99]
    v_mfma_f32_16x16x32_bf16 v[100:103], a[240:243], a[24:27], 0
    buffer_load_dwordx4 v[148:151], v1, s[52:55], s61 offen offset:1024
    v_mfma_f32_16x16x32_bf16 v[100:103], a[244:247], a[28:31], v[100:103]
    ds_read_b128 a[220:223], v1 offset:22528
    v_mfma_f32_16x16x32_bf16 v[100:103], a[248:251], a[32:35], v[100:103]
    ds_read_b128 a[224:227], v1 offset:23552
    v_cvt_pk_bf16_f32 v208, v96, v97
    v_mfma_f32_16x16x32_bf16 v[100:103], a[192:195], a[36:39], v[100:103]
    v_cvt_pk_bf16_f32 v209, v98, v99
    v_mfma_f32_16x16x32_bf16 v[100:103], a[196:199], a[40:43], v[100:103]
    v_mfma_f32_16x16x32_bf16 v[100:103], a[200:203], a[44:47], v[100:103]
    v_mfma_f32_16x16x32_bf16 v[104:107], a[240:243], a[48:51], 0
    buffer_load_dwordx4 v[152:155], v1, s[52:55], s61 offen offset:2048
    v_mfma_f32_16x16x32_bf16 v[104:107], a[244:247], a[52:55], v[104:107]
    s_cmp_eq_u32 s49, 0
    s_cbranch_scc0 L_pub1
    s_waitcnt vmcnt(7)
    ds_or_b32 v29, v27
L_pub1:
    v_mfma_f32_16x16x32_bf16 v[104:107], a[248:251], a[56:59], v[104:107]
    ds_read_b32 v30, v29
    v_cvt_pk_bf16_f32 v212, v100, v101
    v_mfma_f32_16x16x32_bf16 v[104:107], a[192:195], a[60:63], v[104:107]
    v_cvt_pk_bf16_f32 v213, v102, v103
    v_mfma_f32_16x16x32_bf16 v[104:107], a[196:199], a[64:67], v[104:107]
    v_mfma_f32_16x16x32_bf16 v[104:107], a[200:203], a[68:71], v[104:107]
    v_mfma_f32_16x16x32_bf16 v[108:111], a[240:243], a[72:75], 0
    buffer_load_dwordx4 v[156:159], v1, s[52:55], s61 offen offset:3072
    v_mfma_f32_16x16x32_bf16 v[108:111], a[244:247], a[76:79], v[108:111]
    v_mfma_f32_16x16x32_bf16 v[108:111], a[248:251], a[80:83], v[108:111]
    v_cvt_pk_bf16_f32 v216, v104, v105
    v_cvt_pk_bf16_f32 v217, v106, v107
    v_mfma_f32_16x16x32_bf16 v[108:111], a[192:195], a[84:87], v[108:111]
    v_mfma_f32_16x16x32_bf16 v[108:111], a[196:199], a[88:91], v[108:111]
    s_add_u32 s61, s60, 8192
    v_mfma_f32_16x16x32_bf16 v[108:111], a[200:203], a[92:95], v[108:111]
    s_waitcnt lgkmcnt(1)
    v_mfma_f32_16x16x32_bf16 v[112:115], a[204:207], a[0:3], 0
    buffer_load_dwordx4 v[160:163], v1, s[52:55], s61 offen offset:0
    v_mfma_f32_16x16x32_bf16 v[112:115], a[208:211], a[4:7], v[112:115]
    s_waitcnt lgkmcnt(0)
    v_readfirstlane_b32 s41, v30
    v_mfma_f32_16x16x32_bf16 v[112:115], a[212:215], a[8:11], v[112:115]
    v_cvt_pk_bf16_f32 v220, v108, v109
    v_cvt_pk_bf16_f32 v221, v110, v111
    v_mfma_f32_16x16x32_bf16 v[112:115], a[216:219], a[12:15], v[112:115]
    s_bitcmp1_b32 s41, 2
    s_cbranch_scc0 L_slow2
L_ok2:
    v_mfma_f32_16x16x32_bf16 v[112:115], a[220:223], a[16:19], v[112:115]
    ds_read_b128 a[228:231], v1 offset:24576
    v_mfma_f32_16x16x32_bf16 v[112:115], a[224:227], a[20:23], v[112:115]
    ds_read_b128 a[232:235], v1 offset:25600
    v_mfma_f32_16x16x32_bf16 v[116:119], a[204:207], a[24:27], 0
    ds_read_b128 a[236:239], v1 offset:26624
    v_mfma_f32_16x16x32_bf16 v[116:119], a[208:211], a[28:31], v[116:119]
    ds_read_b128 a[240:243], v1 offset:27648
    v_mfma_f32_16x16x32_bf16 v[116:119], a[212:215], a[32:35], v[116:119]
    buffer_load_dwordx4 v[164:167], v1, s[52:55], s61 offen offset:1024
    v_cvt_pk_bf16_f32 v210, v112, v113
    v_mfma_f32_16x16x32_bf16 v[116:119], a[216:219], a[36:39], v[116:119]
    ds_read_b128 a[244:247], v1 offset:28672
    v_cvt_pk_bf16_f32 v211, v114, v115
    v_mfma_f32_16x16x32_bf16 v[116:119], a[220:223], a[40:43], v[116:119]
    ds_read_b128 a[248:251], v1 offset:29696
    v_mfma_f32_16x16x32_bf16 v[116:119], a[224:227], a[44:47], v[116:119]
    s_cmp_eq_u32 s49, 1
    s_cbranch_scc0 L_pub3
    s_waitcnt vmcnt(22)
    ds_or_b32 v29, v27
L_pub3:
    v_mfma_f32_16x16x32_bf16 v[120:123], a[204:207], a[48:51], 0
    buffer_load_dwordx4 v[168:171], v1, s[52:55], s61 offen offset:2048
    v_mfma_f32_16x16x32_bf16 v[120:123], a[208:211], a[52:55], v[120:123]
    v_mfma_f32_16x16x32_bf16 v[120:123], a[212:215], a[56:59], v[120:123]
    v_cvt_pk_bf16_f32 v214, v116, v117
    v_cvt_pk_bf16_f32 v215, v118, v119
    v_mfma_f32_16x16x32_bf16 v[120:123], a[216:219], a[60:63], v[120:123]
    v_mfma_f32_16x16x32_bf16 v[120:123], a[220:223], a[64:67], v[120:123]
    v_mfma_f32_16x16x32_bf16 v[120:123], a[224:227], a[68:71], v[120:123]
    v_mfma_f32_16x16x32_bf16 v[124:127], a[204:207], a[72:75], 0
    buffer_load_dwordx4 v[172:175], v1, s[52:55], s61 offen offset:3072
    v_mfma_f32_16x16x32_bf16 v[124:127], a[208:211], a[76:79], v[124:127]
    v_mfma_f32_16x16x32_bf16 v[124:127], a[212:215], a[80:83], v[124:127]
    v_cvt_pk_bf16_f32 v218, v120, v121
    v_cvt_pk_bf16_f32 v219, v122, v123
    v_mfma_f32_16x16x32_bf16 v[124:127], a[216:219], a[84:87], v[124:127]
    v_mfma_f32_16x16x32_bf16 v[124:127], a[220:223], a[88:91], v[124:127]
    s_add_u32 s61, s60, 12288
    v_mfma_f32_16x16x32_bf16 v[124:127], a[224:227], a[92:95], v[124:127]
    s_waitcnt lgkmcnt(1)
    v_mfma_f32_16x16x32_bf16 v[96:99], a[228:231], a[0:3], 0
    buffer_load_dwordx4 v[176:179], v1, s[52:55], s61 offen offset:0
    v_mfma_f32_16x16x32_bf16 v[96:99], a[232:235], a[4:7], v[96:99]
    v_mfma_f32_16x16x32_bf16 v[96:99], a[236:239], a[8:11], v[96:99]
    v_cvt_pk_bf16_f32 v222, v124, v125
    v_cvt_pk_bf16_f32 v223, v126, v127
    v_mfma_f32_16x16x32_bf16 v[96:99], a[240:243], a[12:15], v[96:99]
    v_mfma_f32_16x16x32_bf16 v[96:99], a[244:247], a[16:19], v[96:99]
    s_waitcnt lgkmcnt(0)
    v_mfma_f32_16x16x32_bf16 v[96:99], a[248:251], a[20:23], v[96:99]
    v_mfma_f32_16x16x32_bf16 v[100:103], a[228:231], a[24:27], 0
    buffer_load_dwordx4 v[180:183], v1, s[52:55], s61 offen offset:1024
    v_mfma_f32_16x16x32_bf16 v[100:103], a[232:235], a[28:31], v[100:103]
    v_mfma_f32_16x16x32_bf16 v[100:103], a[236:239], a[32:35], v[100:103]
    s_waitcnt vmcnt(13)
    ds_write_b64 v24, v[128:129] offset:0
    v_mfma_f32_16x16x32_bf16 v[100:103], a[240:243], a[36:39], v[100:103]
    ds_write_b64 v24, v[130:131] offset:8
    v_mfma_f32_16x16x32_bf16 v[100:103], a[244:247], a[40:43], v[100:103]
    v_mfma_f32_16x16x32_bf16 v[100:103], a[248:251], a[44:47], v[100:103]
    v_mfma_f32_16x16x32_bf16 v[32:35], a[0:3], v[192:195], 0
    buffer_load_dwordx4 v[184:187], v1, s[52:55], s61 offen offset:2048
    v_mfma_f32_16x16x32_bf16 v[32:35], a[4:7], v[208:211], v[32:35]
    v_mfma_f32_16x16x32_bf16 v[36:39], a[24:27], v[192:195], 0
    s_waitcnt vmcnt(13)
    ds_write_b64 v24, v[132:133] offset:1024
    v_mfma_f32_16x16x32_bf16 v[36:39], a[28:31], v[208:211], v[36:39]
    ds_write_b64 v24, v[134:135] offset:1032
    v_mfma_f32_16x16x32_bf16 v[40:43], a[48:51], v[192:195], 0
    v_mfma_f32_16x16x32_bf16 v[40:43], a[52:55], v[208:211], v[40:43]
    v_mfma_f32_16x16x32_bf16 v[44:47], a[72:75], v[192:195], 0
    buffer_load_dwordx4 v[188:191], v1, s[52:55], s61 offen offset:3072
    v_cvt_pk_bf16_f32 v192, v96, v97
    v_mfma_f32_16x16x32_bf16 v[44:47], a[76:79], v[208:211], v[44:47]
    v_cvt_pk_bf16_f32 v193, v98, v99
    v_mfma_f32_16x16x32_bf16 v[48:51], a[0:3], v[196:199], 0
    s_waitcnt vmcnt(13)
    ds_write_b64 v24, v[136:137] offset:2048
    v_mfma_f32_16x16x32_bf16 v[48:51], a[4:7], v[212:215], v[48:51]
    ds_write_b64 v24, v[138:139] offset:2056
    v_mfma_f32_16x16x32_bf16 v[52:55], a[24:27], v[196:199], 0
    s_add_u32 s61, s60, 16384
    v_mfma_f32_16x16x32_bf16 v[52:55], a[28:31], v[212:215], v[52:55]
    v_mfma_f32_16x16x32_bf16 v[56:59], a[48:51], v[196:199], 0
    buffer_load_dwordx4 v[224:227], v1, s[52:55], s61 offen offset:0
    v_mfma_f32_16x16x32_bf16 v[56:59], a[52:55], v[212:215], v[56:59]
    v_mfma_f32_16x16x32_bf16 v[60:63], a[72:75], v[196:199], 0
    s_waitcnt vmcnt(13)
    ds_write_b64 v24, v[140:141] offset:3072
    v_mfma_f32_16x16x32_bf16 v[60:63], a[76:79], v[212:215], v[60:63]
    ds_write_b64 v24, v[142:143] offset:3080
    v_mfma_f32_16x16x32_bf16 v[64:67], a[0:3], v[200:203], 0
    v_cvt_pk_bf16_f32 v196, v100, v101
    v_cvt_pk_bf16_f32 v197, v102, v103
    v_mfma_f32_16x16x32_bf16 v[64:67], a[4:7], v[216:219], v[64:67]
    v_mfma_f32_16x16x32_bf16 v[68:71], a[24:27], v[200:203], 0
    buffer_load_dwordx4 v[228:231], v1, s[52:55], s61 offen offset:1024
    v_mfma_f32_16x16x32_bf16 v[68:71], a[28:31], v[216:219], v[68:71]
    ds_read_b128 a[192:195], v1 offset:30720
    v_mfma_f32_16x16x32_bf16 v[72:75], a[48:51], v[200:203], 0
    ds_read_b128 a[196:199], v1 offset:31744
    v_mfma_f32_16x16x32_bf16 v[72:75], a[52:55], v[216:219], v[72:75]
    s_waitcnt vmcnt(13)
    ds_write_b64 v24, v[144:145] offset:4096
    v_mfma_f32_16x16x32_bf16 v[76:79], a[72:75], v[200:203], 0
    ds_read_b128 a[200:203], v1 offset:32768
    v_mfma_f32_16x16x32_bf16 v[76:79], a[76:79], v[216:219], v[76:79]
    ds_write_b64 v24, v[146:147] offset:4104
    v_mfma_f32_16x16x32_bf16 v[80:83], a[0:3], v[204:207], 0
    ds_read_b128 a[204:207], v1 offset:33792
    v_mfma_f32_16x16x32_bf16 v[80:83], a[4:7], v[220:223], v[80:83]
    s_cmp_eq_u32 s49, 1
    s_cbranch_scc0 L_pub4
    s_waitcnt vmcnt(18)
    ds_or_b32 v29, v28
L_pub4:
    v_mfma_f32_16x16x32_bf16 v[84:87], a[24:27], v[204:207], 0
    ds_read_b128 a[208:211], v1 offset:34816
    v_mfma_f32_16x16x32_bf16 v[84:87], a[28:31], v[220:223], v[84:87]
    s_waitcnt vmcnt(12)
    ds_write_b64 v24, v[148:149] offset:5120
    v_mfma_f32_16x16x32_bf16 v[88:91], a[48:51], v[204:207], 0
    ds_read_b32 v30, v29
    v_mfma_f32_16x16x32_bf16 v[88:91], a[52:55], v[220:223], v[88:91]
    ds_read_b128 a[212:215], v1 offset:35840
    v_mfma_f32_16x16x32_bf16 v[92:95], a[72:75], v[204:207], 0
    ds_write_b64 v24, v[150:151] offset:5128
    v_mfma_f32_16x16x32_bf16 v[92:95], a[76:79], v[220:223], v[92:95]
    v_mfma_f32_16x16x32_bf16 v[104:107], a[228:231], a[48:51], 0
    s_waitcnt vmcnt(11)
    ds_write_b64 v24, v[152:153] offset:6144
    v_mfma_f32_16x16x32_bf16 v[104:107], a[232:235], a[52:55], v[104:107]
    ds_write_b64 v24, v[154:155] offset:6152
    v_mfma_f32_16x16x32_bf16 v[104:107], a[236:239], a[56:59], v[104:107]
    v_mfma_f32_16x16x32_bf16 v[104:107], a[240:243], a[60:63], v[104:107]
    v_mfma_f32_16x16x32_bf16 v[104:107], a[244:247], a[64:67], v[104:107]
    v_mfma_f32_16x16x32_bf16 v[104:107], a[248:251], a[68:71], v[104:107]
    s_waitcnt lgkmcnt(4)
    v_readfirstlane_b32 s41, v30
    v_mfma_f32_16x16x32_bf16 v[108:111], a[228:231], a[72:75], 0
    s_waitcnt vmcnt(10)
    ds_write_b64 v24, v[156:157] offset:7168
    v_mfma_f32_16x16x32_bf16 v[108:111], a[232:235], a[76:79], v[108:111]
    ds_write_b64 v24, v[158:159] offset:7176
    v_mfma_f32_16x16x32_bf16 v[108:111], a[236:239], a[80:83], v[108:111]
    s_bitcmp1_b32 s41, 3
    s_cbranch_scc0 L_slow3
L_ok3:
    v_mfma_f32_16x16x32_bf16 v[108:111], a[240:243], a[84:87], v[108:111]
    v_cvt_pk_bf16_f32 v200, v104, v105
    v_cvt_pk_bf16_f32 v201, v106, v107
    v_mfma_f32_16x16x32_bf16 v[108:111], a[244:247], a[88:91], v[108:111]
    buffer_load_dwordx4 a[96:99], v9, s[8:11], s24 offen offset:0 nt
    v_mfma_f32_16x16x32_bf16 v[108:111], a[248:251], a[92:95], v[108:111]
    buffer_load_dwordx4 a[100:103], v10, s[8:11], s24 offen offset:0 nt
    v_mfma_f32_16x16x32_bf16 v[112:115], a[192:195], a[0:3], 0
    ds_read_b128 a[216:219], v1 offset:36864
    v_mfma_f32_16x16x32_bf16 v[112:115], a[196:199], a[4:7], v[112:115]
    ds_read_b128 a[220:223], v1 offset:37888
    v_mfma_f32_16x16x32_bf16 v[112:115], a[200:203], a[8:11], v[112:115]
    ds_read_b128 a[224:227], v1 offset:38912
    v_cvt_pk_bf16_f32 v204, v108, v109
    v_mfma_f32_16x16x32_bf16 v[112:115], a[204:207], a[12:15], v[112:115]
    s_waitcnt vmcnt(11)
    ds_write_b64 v24, v[160:161] offset:8192
    v_mfma_f32_16x16x32_bf16 v[112:115], a[208:211], a[16:19], v[112:115]
    ds_read_b128 a[228:231], v1 offset:39936
    s_waitcnt lgkmcnt(7)
    v_mfma_f32_16x16x32_bf16 v[112:115], a[212:215], a[20:23], v[112:115]
    ds_write_b64 v24, v[162:163] offset:8200
    v_mfma_f32_16x16x32_bf16 v[116:119], a[192:195], a[24:27], 0
    ds_read_b128 a[232:235], v1 offset:40960
    v_cvt_pk_bf16_f32 v205, v110, v111
    v_mfma_f32_16x16x32_bf16 v[116:119], a[196:199], a[28:31], v[116:119]
    s_waitcnt vmcnt(10)
    ds_write_b64 v24, v[164:165] offset:9216
    v_mfma_f32_16x16x32_bf16 v[116:119], a[200:203], a[32:35], v[116:119]
    ds_read_b128 a[236:239], v1 offset:41984
    v_cvt_pk_bf16_f32 v194, v112, v113
    v_mfma_f32_16x16x32_bf16 v[116:119], a[204:207], a[36:39], v[116:119]
    ds_write_b64 v24, v[166:167] offset:9224
    v_mfma_f32_16x16x32_bf16 v[116:119], a[208:211], a[40:43], v[116:119]
    v_cvt_pk_bf16_f32 v195, v114, v115
    v_mfma_f32_16x16x32_bf16 v[116:119], a[212:215], a[44:47], v[116:119]
    v_mfma_f32_16x16x32_bf16 v[120:123], a[192:195], a[48:51], 0
    s_waitcnt vmcnt(9)
    ds_write_b64 v24, v[168:169] offset:10240
    v_mfma_f32_16x16x32_bf16 v[120:123], a[196:199], a[52:55], v[120:123]
    ds_write_b64 v24, v[170:171] offset:10248
    v_mfma_f32_16x16x32_bf16 v[120:123], a[200:203], a[56:59], v[120:123]
    v_cvt_pk_bf16_f32 v198, v116, v117
    v_cvt_pk_bf16_f32 v199, v118, v119
    v_mfma_f32_16x16x32_bf16 v[120:123], a[204:207], a[60:63], v[120:123]
    v_mfma_f32_16x16x32_bf16 v[120:123], a[208:211], a[64:67], v[120:123]
    v_mfma_f32_16x16x32_bf16 v[120:123], a[212:215], a[68:71], v[120:123]
    v_mfma_f32_16x16x32_bf16 v[124:127], a[192:195], a[72:75], 0
    s_waitcnt vmcnt(8)
    ds_write_b64 v24, v[172:173] offset:11264
    v_mfma_f32_16x16x32_bf16 v[124:127], a[196:199], a[76:79], v[124:127]
    ds_write_b64 v24, v[174:175] offset:11272
    v_mfma_f32_16x16x32_bf16 v[124:127], a[200:203], a[80:83], v[124:127]
    buffer_load_dwordx4 a[104:107], v9, s[8:11], s24 offen offset:128 nt
    v_cvt_pk_bf16_f32 v202, v120, v121
    v_mfma_f32_16x16x32_bf16 v[124:127], a[204:207], a[84:87], v[124:127]
    buffer_load_dwordx4 a[108:111], v10, s[8:11], s24 offen offset:128 nt
    v_cvt_pk_bf16_f32 v203, v122, v123
    v_mfma_f32_16x16x32_bf16 v[124:127], a[208:211], a[88:91], v[124:127]
    ds_read_b128 a[240:243], v1 offset:43008
    v_mfma_f32_16x16x32_bf16 v[124:127], a[212:215], a[92:95], v[124:127]
    s_waitcnt lgkmcnt(5)
    v_mfma_f32_16x16x32_bf16 v[96:99], a[216:219], a[0:3], 0
    ds_read_b128 a[244:247], v1 offset:44032
    v_mfma_f32_16x16x32_bf16 v[96:99], a[220:223], a[4:7], v[96:99]
    s_waitcnt vmcnt(9)
    ds_write_b64 v24, v[176:177] offset:12288
    v_mfma_f32_16x16x32_bf16 v[96:99], a[224:227], a[8:11], v[96:99]
    ds_read_b128 a[248:251], v1 offset:45056
    v_cvt_pk_bf16_f32 v206, v124, v125
    v_mfma_f32_16x16x32_bf16 v[96:99], a[228:231], a[12:15], v[96:99]
    ds_write_b64 v24, v[178:179] offset:12296
    v_mfma_f32_16x16x32_bf16 v[96:99], a[232:235], a[16:19], v[96:99]
    ds_read_b128 a[192:195], v1 offset:46080
    v_cvt_pk_bf16_f32 v207, v126, v127
    v_mfma_f32_16x16x32_bf16 v[96:99], a[236:239], a[20:23], v[96:99]
    v_mfma_f32_16x16x32_bf16 v[100:103], a[216:219], a[24:27], 0
    ds_read_b128 a[196:199], v1 offset:47104
    v_mfma_f32_16x16x32_bf16 v[100:103], a[220:223], a[28:31], v[100:103]
    s_waitcnt vmcnt(8)
    ds_write_b64 v24, v[180:181] offset:13312
    v_mfma_f32_16x16x32_bf16 v[100:103], a[224:227], a[32:35], v[100:103]
    ds_read_b32 v30, v29
    v_cvt_pk_bf16_f32 v208, v96, v97
    v_mfma_f32_16x16x32_bf16 v[100:103], a[228:231], a[36:39], v[100:103]
    ds_read_b128 a[200:203], v1 offset:48128
    v_cvt_pk_bf16_f32 v209, v98, v99
    v_mfma_f32_16x16x32_bf16 v[100:103], a[232:235], a[40:43], v[100:103]
    ds_write_b64 v24, v[182:183] offset:13320
    v_mfma_f32_16x16x32_bf16 v[100:103], a[236:239], a[44:47], v[100:103]
    v_mfma_f32_16x16x32_bf16 v[104:107], a[216:219], a[48:51], 0
    s_waitcnt vmcnt(7)
    ds_write_b64 v24, v[184:185] offset:14336
    v_mfma_f32_16x16x32_bf16 v[104:107], a[220:223], a[52:55], v[104:107]
    ds_write_b64 v24, v[186:187] offset:14344
    v_mfma_f32_16x16x32_bf16 v[104:107], a[224:227], a[56:59], v[104:107]
    v_cvt_pk_bf16_f32 v212, v100, v101
    v_cvt_pk_bf16_f32 v213, v102, v103
    v_mfma_f32_16x16x32_bf16 v[104:107], a[228:231], a[60:63], v[104:107]
    v_mfma_f32_16x16x32_bf16 v[104:107], a[232:235], a[64:67], v[104:107]
    v_mfma_f32_16x16x32_bf16 v[104:107], a[236:239], a[68:71], v[104:107]
    s_waitcnt lgkmcnt(4)
    v_readfirstlane_b32 s41, v30
    v_mfma_f32_16x16x32_bf16 v[108:111], a[216:219], a[72:75], 0
    buffer_load_dwordx4 a[112:115], v9, s[8:11], s24 offen offset:256 nt
    v_mfma_f32_16x16x32_bf16 v[108:111], a[220:223], a[76:79], v[108:111]
    buffer_load_dwordx4 a[116:119], v10, s[8:11], s24 offen offset:256 nt
    s_add_u32 s24, s16, 6291456
    v_mfma_f32_16x16x32_bf16 v[108:111], a[224:227], a[80:83], v[108:111]
    s_waitcnt vmcnt(8)
    ds_write_b64 v24, v[188:189] offset:15360
    v_mfma_f32_16x16x32_bf16 v[108:111], a[228:231], a[84:87], v[108:111]
    ds_write_b64 v24, v[190:191] offset:15368
    v_mfma_f32_16x16x32_bf16 v[108:111], a[232:235], a[88:91], v[108:111]
    s_bitcmp1_b32 s41, 4
    s_cbranch_scc0 L_slow4
L_ok4:
    v_mfma_f32_16x16x32_bf16 v[108:111], a[236:239], a[92:95], v[108:111]
    ds_read_b128 a[204:207], v1 offset:49152
    v_cvt_pk_bf16_f32 v216, v104, v105
    v_mfma_f32_16x16x32_bf16 v[112:115], a[240:243], a[0:3], 0
    ds_read_b128 a[208:211], v1 offset:50176
    v_cvt_pk_bf16_f32 v217, v106, v107
    v_mfma_f32_16x16x32_bf16 v[112:115], a[244:247], a[4:7], v[112:115]
    s_waitcnt vmcnt(7)
    ds_write_b64 v24, v[224:225] offset:16384
    v_mfma_f32_16x16x32_bf16 v[112:115], a[248:251], a[8:11], v[112:115]
    ds_read_b128 a[212:215], v1 offset:51200
    v_cvt_pk_bf16_f32 v220, v108, v109
    v_mfma_f32_16x16x32_bf16 v[112:115], a[192:195], a[12:15], v[112:115]
    ds_write_b64 v24, v[226:227] offset:16392
    v_mfma_f32_16x16x32_bf16 v[112:115], a[196:199], a[16:19], v[112:115]
    ds_read_b128 a[216:219], v1 offset:52224
    s_waitcnt lgkmcnt(8)
    v_mfma_f32_16x16x32_bf16 v[112:115], a[200:203], a[20:23], v[112:115]
    v_cvt_pk_bf16_f32 v221, v110, v111
    v_mfma_f32_16x16x32_bf16 v[116:119], a[240:243], a[24:27], 0
    ds_read_b128 a[220:223], v1 offset:53248
    v_mfma_f32_16x16x32_bf16 v[116:119], a[244:247], a[28:31], v[116:119]
    s_waitcnt vmcnt(6)
    ds_write_b64 v24, v[228:229] offset:17408
    v_mfma_f32_16x16x32_bf16 v[116:119], a[248:251], a[32:35], v[116:119]
    ds_read_b128 a[224:227], v1 offset:54272
    v_cvt_pk_bf16_f32 v210, v112, v113
    v_mfma_f32_16x16x32_bf16 v[116:119], a[192:195], a[36:39], v[116:119]
    ds_write_b64 v24, v[230:231] offset:17416
    v_mfma_f32_16x16x32_bf16 v[116:119], a[196:199], a[40:43], v[116:119]
    ds_or_b32 v29, v25
    v_mfma_f32_16x16x32_bf16 v[116:119], a[200:203], a[44:47], v[116:119]
    v_cvt_pk_bf16_f32 v211, v114, v115
    v_mfma_f32_16x16x32_bf16 v[120:123], a[240:243], a[48:51], 0
    v_mfma_f32_16x16x32_bf16 v[120:123], a[244:247], a[52:55], v[120:123]
    v_mfma_f32_16x16x32_bf16 v[120:123], a[248:251], a[56:59], v[120:123]
    v_cvt_pk_bf16_f32 v214, v116, v117
    v_cvt_pk_bf16_f32 v215, v118, v119
    v_mfma_f32_16x16x32_bf16 v[120:123], a[192:195], a[60:63], v[120:123]
    v_mfma_f32_16x16x32_bf16 v[120:123], a[196:199], a[64:67], v[120:123]
    buffer_load_dwordx4 a[120:123], v9, s[8:11], s26 offen offset:0 nt
    v_mfma_f32_16x16x32_bf16 v[120:123], a[200:203], a[68:71], v[120:123]
    buffer_load_dwordx4 a[124:127], v10, s[8:11], s26 offen offset:0 nt
    v_mfma_f32_16x16x32_bf16 v[124:127], a[240:243], a[72:75], 0
    v_mfma_f32_16x16x32_bf16 v[124:127], a[244:247], a[76:79], v[124:127]
    v_mfma_f32_16x16x32_bf16 v[124:127], a[248:251], a[80:83], v[124:127]
    v_cvt_pk_bf16_f32 v218, v120, v121
    v_cvt_pk_bf16_f32 v219, v122, v123
    v_mfma_f32_16x16x32_bf16 v[124:127], a[192:195], a[84:87], v[124:127]
    v_mfma_f32_16x16x32_bf16 v[124:127], a[196:199], a[88:91], v[124:127]
    v_mfma_f32_16x16x32_bf16 v[124:127], a[200:203], a[92:95], v[124:127]
    s_waitcnt lgkmcnt(1)
    v_mfma_f32_16x16x32_bf16 v[96:99], a[204:207], a[0:3], 0
    v_mfma_f32_16x16x32_bf16 v[96:99], a[208:211], a[4:7], v[96:99]
    v_mfma_f32_16x16x32_bf16 v[96:99], a[212:215], a[8:11], v[96:99]
    v_cvt_pk_bf16_f32 v222, v124, v125
    v_cvt_pk_bf16_f32 v223, v126, v127
    v_mfma_f32_16x16x32_bf16 v[96:99], a[216:219], a[12:15], v[96:99]
    v_mfma_f32_16x16x32_bf16 v[96:99], a[220:223], a[16:19], v[96:99]
    v_mfma_f32_16x16x32_bf16 v[96:99], a[224:227], a[20:23], v[96:99]
    v_mfma_f32_16x16x32_bf16 v[100:103], a[204:207], a[24:27], 0
    v_mfma_f32_16x16x32_bf16 v[100:103], a[208:211], a[28:31], v[100:103]
    v_mfma_f32_16x16x32_bf16 v[100:103], a[212:215], a[32:35], v[100:103]
    v_mfma_f32_16x16x32_bf16 v[100:103], a[216:219], a[36:39], v[100:103]
    v_mfma_f32_16x16x32_bf16 v[100:103], a[220:223], a[40:43], v[100:103]
    v_mfma_f32_16x16x32_bf16 v[100:103], a[224:227], a[44:47], v[100:103]
    v_mfma_f32_16x16x32_bf16 v[32:35], a[8:11], v[192:195], v[32:35]
    v_mfma_f32_16x16x32_bf16 v[32:35], a[12:15], v[208:211], v[32:35]
    v_mfma_f32_16x16x32_bf16 v[36:39], a[32:35], v[192:195], v[36:39]
    buffer_load_dwordx4 a[128:131], v9, s[8:11], s26 offen offset:128 nt
    v_mfma_f32_16x16x32_bf16 v[36:39], a[36:39], v[208:211], v[36:39]
    buffer_load_dwordx4 a[132:135], v10, s[8:11], s26 offen offset:128 nt
    v_mfma_f32_16x16x32_bf16 v[40:43], a[56:59], v[192:195], v[40:43]
    v_mfma_f32_16x16x32_bf16 v[40:43], a[60:63], v[208:211], v[40:43]
    v_mfma_f32_16x16x32_bf16 v[44:47], a[80:83], v[192:195], v[44:47]
    v_cvt_pk_bf16_f32 v192, v96, v97
    v_cvt_pk_bf16_f32 v193, v98, v99
    v_mfma_f32_16x16x32_bf16 v[44:47], a[84:87], v[208:211], v[44:47]
    v_mfma_f32_16x16x32_bf16 v[48:51], a[8:11], v[196:199], v[48:51]
    v_mfma_f32_16x16x32_bf16 v[48:51], a[12:15], v[212:215], v[48:51]
    v_mfma_f32_16x16x32_bf16 v[52:55], a[32:35], v[196:199], v[52:55]
    v_mfma_f32_16x16x32_bf16 v[52:55], a[36:39], v[212:215], v[52:55]
    v_mfma_f32_16x16x32_bf16 v[56:59], a[56:59], v[196:199], v[56:59]
    v_mfma_f32_16x16x32_bf16 v[56:59], a[60:63], v[212:215], v[56:59]
    v_mfma_f32_16x16x32_bf16 v[60:63], a[80:83], v[196:199], v[60:63]
    v_cvt_pk_bf16_f32 v196, v100, v101
    v_cvt_pk_bf16_f32 v197, v102, v103
    v_mfma_f32_16x16x32_bf16 v[60:63], a[84:87], v[212:215], v[60:63]
    v_mfma_f32_16x16x32_bf16 v[64:67], a[8:11], v[200:203], v[64:67]
    v_mfma_f32_16x16x32_bf16 v[64:67], a[12:15], v[216:219], v[64:67]
    v_mfma_f32_16x16x32_bf16 v[68:71], a[32:35], v[200:203], v[68:71]
    ds_read_b128 a[228:231], v1 offset:55296
    v_mfma_f32_16x16x32_bf16 v[68:71], a[36:39], v[216:219], v[68:71]
    v_mfma_f32_16x16x32_bf16 v[72:75], a[56:59], v[200:203], v[72:75]
    ds_read_b128 a[232:235], v1 offset:56320
    v_mfma_f32_16x16x32_bf16 v[72:75], a[60:63], v[216:219], v[72:75]
    v_mfma_f32_16x16x32_bf16 v[76:79], a[80:83], v[200:203], v[76:79]
    ds_read_b128 a[236:239], v1 offset:57344
    v_mfma_f32_16x16x32_bf16 v[76:79], a[84:87], v[216:219], v[76:79]
    v_mfma_f32_16x16x32_bf16 v[80:83], a[8:11], v[204:207], v[80:83]
    buffer_load_dwordx4 a[136:139], v9, s[8:11], s26 offen offset:256 nt
    v_mfma_f32_16x16x32_bf16 v[80:83], a[12:15], v[220:223], v[80:83]
    buffer_load_dwordx4 a[140:143], v10, s[8:11], s26 offen offset:256 nt
    s_add_u32 s26, s16, 6684672
    v_mfma_f32_16x16x32_bf16 v[84:87], a[32:35], v[204:207], v[84:87]
    ds_read_b128 a[240:243], v1 offset:58368
    v_mfma_f32_16x16x32_bf16 v[84:87], a[36:39], v[220:223], v[84:87]
    ds_read_b128 a[244:247], v1 offset:59392
    v_mfma_f32_16x16x32_bf16 v[88:91], a[56:59], v[204:207], v[88:91]
    ds_read_b32 v30, v29
    v_mfma_f32_16x16x32_bf16 v[88:91], a[60:63], v[220:223], v[88:91]
    ds_read_b128 a[248:251], v1 offset:60416
    v_mfma_f32_16x16x32_bf16 v[92:95], a[80:83], v[204:207], v[92:95]
    v_mfma_f32_16x16x32_bf16 v[92:95], a[84:87], v[220:223], v[92:95]
    v_mfma_f32_16x16x32_bf16 v[104:107], a[204:207], a[48:51], 0
    v_mfma_f32_16x16x32_bf16 v[104:107], a[208:211], a[52:55], v[104:107]
    v_mfma_f32_16x16x32_bf16 v[104:107], a[212:215], a[56:59], v[104:107]
    v_mfma_f32_16x16x32_bf16 v[104:107], a[216:219], a[60:63], v[104:107]
    v_mfma_f32_16x16x32_bf16 v[104:107], a[220:223], a[64:67], v[104:107]
    v_mfma_f32_16x16x32_bf16 v[104:107], a[224:227], a[68:71], v[104:107]
    s_waitcnt lgkmcnt(1)
    v_readfirstlane_b32 s41, v30
    v_mfma_f32_16x16x32_bf16 v[108:111], a[204:207], a[72:75], 0
    v_mfma_f32_16x16x32_bf16 v[108:111], a[208:211], a[76:79], v[108:111]
    s_bitcmp1_b32 s41, 5
    s_cbranch_scc0 L_slow5
L_ok5:
    v_mfma_f32_16x16x32_bf16 v[108:111], a[212:215], a[80:83], v[108:111]
    v_cvt_pk_bf16_f32 v200, v104, v105
    v_cvt_pk_bf16_f32 v201, v106, v107
    v_mfma_f32_16x16x32_bf16 v[108:111], a[216:219], a[84:87], v[108:111]
    v_mfma_f32_16x16x32_bf16 v[108:111], a[220:223], a[88:91], v[108:111]
    ds_read_b128 a[192:195], v1 offset:61440
    v_mfma_f32_16x16x32_bf16 v[108:111], a[224:227], a[92:95], v[108:111]
    v_mfma_f32_16x16x32_bf16 v[112:115], a[228:231], a[0:3], 0
    ds_read_b128 a[196:199], v1 offset:62464
    v_mfma_f32_16x16x32_bf16 v[112:115], a[232:235], a[4:7], v[112:115]
    v_mfma_f32_16x16x32_bf16 v[112:115], a[236:239], a[8:11], v[112:115]
    buffer_load_dwordx4 a[144:147], v9, s[8:11], s28 offen offset:0 nt
    v_cvt_pk_bf16_f32 v204, v108, v109
    v_mfma_f32_16x16x32_bf16 v[112:115], a[240:243], a[12:15], v[112:115]
    buffer_load_dwordx4 a[148:151], v10, s[8:11], s28 offen offset:0 nt
    v_cvt_pk_bf16_f32 v205, v110, v111
    v_mfma_f32_16x16x32_bf16 v[112:115], a[244:247], a[16:19], v[112:115]
    ds_read_b128 a[200:203], v1 offset:63488
    s_waitcnt lgkmcnt(3)
    v_mfma_f32_16x16x32_bf16 v[112:115], a[248:251], a[20:23], v[112:115]
    ds_read_b128 a[204:207], v1 offset:64512
    v_mfma_f32_16x16x32_bf16 v[116:119], a[228:231], a[24:27], 0
    ds_read_b128 a[208:211], v2 offset:0
    v_mfma_f32_16x16x32_bf16 v[116:119], a[232:235], a[28:31], v[116:119]
    v_mfma_f32_16x16x32_bf16 v[116:119], a[236:239], a[32:35], v[116:119]
    ds_read_b128 a[212:215], v2 offset:1024
    v_cvt_pk_bf16_f32 v194, v112, v113
    v_mfma_f32_16x16x32_bf16 v[116:119], a[240:243], a[36:39], v[116:119]
    v_cvt_pk_bf16_f32 v195, v114, v115
    v_mfma_f32_16x16x32_bf16 v[116:119], a[244:247], a[40:43], v[116:119]
    v_mfma_f32_16x16x32_bf16 v[116:119], a[248:251], a[44:47], v[116:119]
    v_mfma_f32_16x16x32_bf16 v[120:123], a[228:231], a[48:51], 0
    v_mfma_f32_16x16x32_bf16 v[120:123], a[232:235], a[52:55], v[120:123]
    v_mfma_f32_16x16x32_bf16 v[120:123], a[236:239], a[56:59], v[120:123]
    v_cvt_pk_bf16_f32 v198, v116, v117
    v_cvt_pk_bf16_f32 v199, v118, v119
    v_mfma_f32_16x16x32_bf16 v[120:123], a[240:243], a[60:63], v[120:123]
    v_mfma_f32_16x16x32_bf16 v[120:123], a[244:247], a[64:67], v[120:123]
    v_mfma_f32_16x16x32_bf16 v[120:123], a[248:251], a[68:71], v[120:123]
    v_mfma_f32_16x16x32_bf16 v[124:127], a[228:231], a[72:75], 0
    v_mfma_f32_16x16x32_bf16 v[124:127], a[232:235], a[76:79], v[124:127]
    v_mfma_f32_16x16x32_bf16 v[124:127], a[236:239], a[80:83], v[124:127]
    v_cvt_pk_bf16_f32 v202, v120, v121
    v_cvt_pk_bf16_f32 v203, v122, v123
    v_mfma_f32_16x16x32_bf16 v[124:127], a[240:243], a[84:87], v[124:127]
    v_mfma_f32_16x16x32_bf16 v[124:127], a[244:247], a[88:91], v[124:127]
    ds_read_b128 a[216:219], v2 offset:2048
    v_mfma_f32_16x16x32_bf16 v[124:127], a[248:251], a[92:95], v[124:127]
    s_waitcnt lgkmcnt(1)
    v_mfma_f32_16x16x32_bf16 v[96:99], a[192:195], a[0:3], 0
    buffer_load_dwordx4 a[168:171], v9, s[8:11], s30 offen offset:0 nt
    v_mfma_f32_16x16x32_bf16 v[96:99], a[196:199], a[4:7], v[96:99]
    buffer_load_dwordx4 a[172:175], v10, s[8:11], s30 offen offset:0 nt
    v_mfma_f32_16x16x32_bf16 v[96:99], a[200:203], a[8:11], v[96:99]
    ds_read_b128 a[220:223], v2 offset:3072
    v_cvt_pk_bf16_f32 v206, v124, v125
    v_mfma_f32_16x16x32_bf16 v[96:99], a[204:207], a[12:15], v[96:99]
    ds_read_b128 a[224:227], v2 offset:4096
    v_cvt_pk_bf16_f32 v207, v126, v127
    v_mfma_f32_16x16x32_bf16 v[96:99], a[208:211], a[16:19], v[96:99]
    ds_read_b128 a[228:231], v2 offset:5120
    v_mfma_f32_16x16x32_bf16 v[96:99], a[212:215], a[20:23], v[96:99]
    v_mfma_f32_16x16x32_bf16 v[100:103], a[192:195], a[24:27], 0
    ds_read_b128 a[232:235], v2 offset:6144
    v_mfma_f32_16x16x32_bf16 v[100:103], a[196:199], a[28:31], v[100:103]
    s_waitcnt vmcnt(15)
    ds_write_b64 v4, a[96:97] offset:0
    v_mfma_f32_16x16x32_bf16 v[100:103], a[200:203], a[32:35], v[100:103]
    ds_read_b32 v30, v29
    v_cvt_pk_bf16_f32 v208, v96, v97
    v_mfma_f32_16x16x32_bf16 v[100:103], a[204:207], a[36:39], v[100:103]
    ds_read_b128 a[236:239], v2 offset:7168
    v_cvt_pk_bf16_f32 v209, v98, v99
    v_mfma_f32_16x16x32_bf16 v[100:103], a[208:211], a[40:43], v[100:103]
    ds_write_b64 v4, a[98:99] offset:1024
    v_mfma_f32_16x16x32_bf16 v[100:103], a[212:215], a[44:47], v[100:103]
    s_waitcnt vmcnt(14)
    ds_write_b64 v4, a[100:101] offset:512
    v_mfma_f32_16x16x32_bf16 v[104:107], a[192:195], a[48:51], 0
    ds_write_b64 v4, a[102:103] offset:1536
    v_mfma_f32_16x16x32_bf16 v[104:107], a[196:199], a[52:55], v[104:107]
    ds_read2_b64 a[96:99], v5 offset0:0 offset1:128
    v_mfma_f32_16x16x32_bf16 v[104:107], a[200:203], a[56:59], v[104:107]
    ds_read2_b64 a[100:103], v6 offset0:0 offset1:128
    v_cvt_pk_bf16_f32 v212, v100, v101
    v_mfma_f32_16x16x32_bf16 v[104:107], a[204:207], a[60:63], v[104:107]
    v_cvt_pk_bf16_f32 v213, v102, v103
    v_mfma_f32_16x16x32_bf16 v[104:107], a[208:211], a[64:67], v[104:107]
    v_mfma_f32_16x16x32_bf16 v[104:107], a[212:215], a[68:71], v[104:107]
    s_waitcnt lgkmcnt(6)
    v_readfirstlane_b32 s41, v30
    v_mfma_f32_16x16x32_bf16 v[108:111], a[192:195], a[72:75], 0
    v_mfma_f32_16x16x32_bf16 v[108:111], a[196:199], a[76:79], v[108:111]
    s_andn2_b32 s41, 960, s41
    s_cbranch_scc1 L_slow6
L_ok6:
    v_mfma_f32_16x16x32_bf16 v[108:111], a[200:203], a[80:83], v[108:111]
    v_cvt_pk_bf16_f32 v216, v104, v105
    v_cvt_pk_bf16_f32 v217, v106, v107
    v_mfma_f32_16x16x32_bf16 v[108:111], a[204:207], a[84:87], v[108:111]
    v_mfma_f32_16x16x32_bf16 v[108:111], a[208:211], a[88:91], v[108:111]
    ds_read_b128 a[240:243], v2 offset:8192
    v_mfma_f32_16x16x32_bf16 v[108:111], a[212:215], a[92:95], v[108:111]
    v_mfma_f32_16x16x32_bf16 v[112:115], a[216:219], a[0:3], 0
    ds_read_b128 a[244:247], v2 offset:9216
    v_mfma_f32_16x16x32_bf16 v[112:115], a[220:223], a[4:7], v[112:115]
    v_mfma_f32_16x16x32_bf16 v[112:115], a[224:227], a[8:11], v[112:115]
    ds_read_b128 a[248:251], v2 offset:10240
    v_cvt_pk_bf16_f32 v220, v108, v109
    v_mfma_f32_16x16x32_bf16 v[112:115], a[228:231], a[12:15], v[112:115]
    v_cvt_pk_bf16_f32 v221, v110, v111
    v_mfma_f32_16x16x32_bf16 v[112:115], a[232:235], a[16:19], v[112:115]
    ds_read_b128 a[192:195], v2 offset:11264
    s_waitcnt lgkmcnt(4)
    v_mfma_f32_16x16x32_bf16 v[112:115], a[236:239], a[20:23], v[112:115]
    v_mfma_f32_16x16x32_bf16 v[116:119], a[216:219], a[24:27], 0
    ds_read_b128 a[196:199], v2 offset:12288
    v_mfma_f32_16x16x32_bf16 v[116:119], a[220:223], a[28:31], v[116:119]
    s_waitcnt vmcnt(13)
    ds_write_b64 v4, a[104:105] offset:0
    v_mfma_f32_16x16x32_bf16 v[116:119], a[224:227], a[32:35], v[116:119]
    ds_read_b128 a[200:203], v2 offset:13312
    v_cvt_pk_bf16_f32 v210, v112, v113
    v_mfma_f32_16x16x32_bf16 v[116:119], a[228:231], a[36:39], v[116:119]
    ds_write_b64 v4, a[106:107] offset:1024
    v_mfma_f32_16x16x32_bf16 v[116:119], a[232:235], a[40:43], v[116:119]
    s_waitcnt vmcnt(12)
    ds_write_b64 v4, a[108:109] offset:512
    v_mfma_f32_16x16x32_bf16 v[116:119], a[236:239], a[44:47], v[116:119]
    ds_write_b64 v4, a[110:111] offset:1536
    v_mfma_f32_16x16x32_bf16 v[120:123], a[216:219], a[48:51], 0
    ds_read2_b64 a[104:107], v5 offset0:0 offset1:128
    v_cvt_pk_bf16_f32 v211, v114, v115
    v_mfma_f32_16x16x32_bf16 v[120:123], a[220:223], a[52:55], v[120:123]
    ds_read2_b64 a[108:111], v6 offset0:0 offset1:128
    v_mfma_f32_16x16x32_bf16 v[120:123], a[224:227], a[56:59], v[120:123]
    v_cvt_pk_bf16_f32 v214, v116, v117
    v_cvt_pk_bf16_f32 v215, v118, v119
    v_mfma_f32_16x16x32_bf16 v[120:123], a[228:231], a[60:63], v[120:123]
    v_mfma_f32_16x16x32_bf16 v[120:123], a[232:235], a[64:67], v[120:123]
    v_mfma_f32_16x16x32_bf16 v[120:123], a[236:239], a[68:71], v[120:123]
    v_mfma_f32_16x16x32_bf16 v[124:127], a[216:219], a[72:75], 0
    v_mfma_f32_16x16x32_bf16 v[124:127], a[220:223], a[76:79], v[124:127]
    v_mfma_f32_16x16x32_bf16 v[124:127], a[224:227], a[80:83], v[124:127]
    v_cvt_pk_bf16_f32 v218, v120, v121
    v_cvt_pk_bf16_f32 v219, v122, v123
    v_mfma_f32_16x16x32_bf16 v[124:127], a[228:231], a[84:87], v[124:127]
    v_mfma_f32_16x16x32_bf16 v[124:127], a[232:235], a[88:91], v[124:127]
    v_mfma_f32_16x16x32_bf16 v[124:127], a[236:239], a[92:95], v[124:127]
    s_waitcnt lgkmcnt(4)
    v_mfma_f32_16x16x32_bf16 v[96:99], a[0:3], a[240:243], 0
    v_mfma_f32_16x16x32_bf16 v[96:99], a[4:7], a[244:247], v[96:99]
    v_mfma_f32_16x16x32_bf16 v[96:99], a[8:11], a[248:251], v[96:99]
    v_cvt_pk_bf16_f32 v222, v124, v125
    v_cvt_pk_bf16_f32 v223, v126, v127
    v_mfma_f32_16x16x32_bf16 v[96:99], a[12:15], a[192:195], v[96:99]
    v_mfma_f32_16x16x32_bf16 v[96:99], a[16:19], a[196:199], v[96:99]
    v_mfma_f32_16x16x32_bf16 v[96:99], a[20:23], a[200:203], v[96:99]
    v_mfma_f32_16x16x32_bf16 v[100:103], a[24:27], a[240:243], 0
    v_mfma_f32_16x16x32_bf16 v[100:103], a[28:31], a[244:247], v[100:103]
    v_mfma_f32_16x16x32_bf16 v[100:103], a[32:35], a[248:251], v[100:103]
    s_waitcnt vmcnt(11)
    ds_write_b64 v4, a[112:113] offset:0
    v_mfma_f32_16x16x32_bf16 v[100:103], a[36:39], a[192:195], v[100:103]
    ds_write_b64 v4, a[114:115] offset:1024
    v_mfma_f32_16x16x32_bf16 v[100:103], a[40:43], a[196:199], v[100:103]
    s_waitcnt vmcnt(10)
    ds_write_b64 v4, a[116:117] offset:512
    v_mfma_f32_16x16x32_bf16 v[100:103], a[44:47], a[200:203], v[100:103]
    ds_write_b64 v4, a[118:119] offset:1536
    v_mfma_f32_16x16x32_bf16 v[32:35], a[16:19], v[192:195], v[32:35]
    ds_read2_b64 a[112:115], v5 offset0:0 offset1:128
    v_cvt_pk_bf16_f32 v128, v96, v97
    v_mfma_f32_16x16x32_bf16 v[32:35], a[20:23], v[208:211], v[32:35]
    ds_read2_b64 a[116:119], v6 offset0:0 offset1:128
    v_cvt_pk_bf16_f32 v129, v98, v99
    v_mfma_f32_16x16x32_bf16 v[36:39], a[40:43], v[192:195], v[36:39]
    v_cvt_pk_bf16_f32 v130, v100, v101
    v_cvt_pk_bf16_f32 v131, v102, v103
    v_mfma_f32_16x16x32_bf16 v[36:39], a[44:47], v[208:211], v[36:39]
L_loop:
    v_mfma_f32_16x16x32_bf16 v[40:43], a[64:67], v[192:195], v[40:43]
    v_max3_f32 v12, v32, v33, v34
    v_mfma_f32_16x16x32_bf16 v[40:43], a[68:71], v[208:211], v[40:43]
    v_mfma_f32_16x16x32_bf16 v[44:47], a[88:91], v[192:195], v[44:47]
    v_max3_f32 v12, v12, v35, v36
    v_max3_f32 v12, v12, v37, v38
    v_mfma_f32_16x16x32_bf16 v[44:47], a[92:95], v[208:211], v[44:47]
    v_mfma_f32_16x16x32_bf16 v[48:51], a[16:19], v[196:199], v[48:51]
    v_max3_f32 v12, v12, v39, v40
    v_max3_f32 v12, v12, v41, v42
    v_mfma_f32_16x16x32_bf16 v[48:51], a[20:23], v[212:215], v[48:51]
    v_mfma_f32_16x16x32_bf16 v[52:55], a[40:43], v[196:199], v[52:55]
    v_max3_f32 v12, v12, v43, v44
    v_max3_f32 v12, v12, v45, v46
    v_mfma_f32_16x16x32_bf16 v[52:55], a[44:47], v[212:215], v[52:55]
    v_max_f32 v12, v12, v47
    v_mfma_f32_16x16x32_bf16 v[56:59], a[64:67], v[196:199], v[56:59]
    v_max3_f32 v13, v48, v49, v50
    v_mfma_f32_16x16x32_bf16 v[56:59], a[68:71], v[212:215], v[56:59]
    v_mfma_f32_16x16x32_bf16 v[60:63], a[88:91], v[196:199], v[60:63]
    v_max3_f32 v13, v13, v51, v52
    v_max3_f32 v13, v13, v53, v54
    v_mfma_f32_16x16x32_bf16 v[60:63], a[92:95], v[212:215], v[60:63]
    v_mfma_f32_16x16x32_bf16 v[64:67], a[16:19], v[200:203], v[64:67]
    v_max3_f32 v13, v13, v55, v56
    v_max3_f32 v13, v13, v57, v58
    v_mfma_f32_16x16x32_bf16 v[64:67], a[20:23], v[216:219], v[64:67]
    v_mfma_f32_16x16x32_bf16 v[68:71], a[40:43], v[200:203], v[68:71]
    ds_read_b128 a[204:207], v2 offset:14336
    v_max3_f32 v13, v13, v59, v60
    v_mfma_f32_16x16x32_bf16 v[68:71], a[44:47], v[216:219], v[68:71]
    v_max3_f32 v13, v13, v61, v62
    v_max_f32 v13, v13, v63
    v_mfma_f32_16x16x32_bf16 v[72:75], a[64:67], v[200:203], v[72:75]
    ds_read_b128 a[208:211], v2 offset:15360
    v_max3_f32 v14, v64, v65, v66
    v_mfma_f32_16x16x32_bf16 v[72:75], a[68:71], v[216:219], v[72:75]
    v_permlane16_swap_b32 v12, v13
    v_max_f32 v12, v12, v13
    v_mfma_f32_16x16x32_bf16 v[76:79], a[88:91], v[200:203], v[76:79]
    ds_read_b128 a[212:215], v2 offset:16384
    v_max3_f32 v14, v14, v67, v68
    v_mfma_f32_16x16x32_bf16 v[76:79], a[92:95], v[216:219], v[76:79]
    v_max3_f32 v14, v14, v69, v70
    v_mfma_f32_16x16x32_bf16 v[80:83], a[16:19], v[204:207], v[80:83]
    ds_read_b128 a[216:219], v2 offset:17408
    v_max3_f32 v14, v14, v71, v72
    v_mfma_f32_16x16x32_bf16 v[80:83], a[20:23], v[220:223], v[80:83]
    v_max3_f32 v14, v14, v73, v74
    v_mfma_f32_16x16x32_bf16 v[84:87], a[40:43], v[204:207], v[84:87]
    ds_read_b128 a[220:223], v2 offset:18432
    v_max3_f32 v14, v14, v75, v76
    v_mfma_f32_16x16x32_bf16 v[84:87], a[44:47], v[220:223], v[84:87]
    v_max3_f32 v14, v14, v77, v78
    v_max_f32 v14, v14, v79
    v_mfma_f32_16x16x32_bf16 v[88:91], a[64:67], v[204:207], v[88:91]
    ds_read_b128 a[224:227], v2 offset:19456
    v_max3_f32 v15, v80, v81, v82
    v_mfma_f32_16x16x32_bf16 v[88:91], a[68:71], v[220:223], v[88:91]
    v_mfma_f32_16x16x32_bf16 v[92:95], a[88:91], v[204:207], v[92:95]
    v_max3_f32 v15, v15, v83, v84
    v_max3_f32 v15, v15, v85, v86
    v_mfma_f32_16x16x32_bf16 v[92:95], a[92:95], v[220:223], v[92:95]
    v_mfma_f32_16x16x32_bf16 v[104:107], a[48:51], a[240:243], 0
    v_max3_f32 v15, v15, v87, v88
    v_max3_f32 v15, v15, v89, v90
    v_mfma_f32_16x16x32_bf16 v[104:107], a[52:55], a[244:247], v[104:107]
    v_mfma_f32_16x16x32_bf16 v[104:107], a[56:59], a[248:251], v[104:107]
    v_max3_f32 v15, v15, v91, v92
    v_max3_f32 v15, v15, v93, v94
    v_mfma_f32_16x16x32_bf16 v[104:107], a[60:63], a[192:195], v[104:107]
    v_max_f32 v15, v15, v95
    v_mfma_f32_16x16x32_bf16 v[104:107], a[64:67], a[196:199], v[104:107]
    v_mfma_f32_16x16x32_bf16 v[104:107], a[68:71], a[200:203], v[104:107]
    v_permlane16_swap_b32 v14, v15
    v_max_f32 v14, v14, v15
    v_mfma_f32_16x16x32_bf16 v[108:111], a[72:75], a[240:243], 0
    v_mfma_f32_16x16x32_bf16 v[108:111], a[76:79], a[244:247], v[108:111]
    v_permlane32_swap_b32 v12, v14
    v_max_f32 v12, v12, v14
    v_mfma_f32_16x16x32_bf16 v[108:111], a[80:83], a[248:251], v[108:111]
    v_cvt_pk_bf16_f32 v132, v104, v105
    v_cvt_pk_bf16_f32 v133, v106, v107
    v_mfma_f32_16x16x32_bf16 v[108:111], a[84:87], a[192:195], v[108:111]
    v_mov_b32 v14, v12
    v_mfma_f32_16x16x32_bf16 v[108:111], a[88:91], a[196:199], v[108:111]
    ds_read_b128 a[228:231], v2 offset:20480
    v_permlane32_swap_b32 v12, v14
    v_mfma_f32_16x16x32_bf16 v[108:111], a[92:95], a[200:203], v[108:111]
    v_mov_b32 v13, v12
    s_waitcnt lgkmcnt(1)
    v_mfma_f32_16x16x32_bf16 v[112:115], a[0:3], a[204:207], 0
    ds_read_b128 a[232:235], v2 offset:21504
    v_mov_b32 v15, v14
    v_mfma_f32_16x16x32_bf16 v[112:115], a[4:7], a[208:211], v[112:115]
    v_permlane16_swap_b32 v12, v13
    v_permlane16_swap_b32 v14, v15
    v_mfma_f32_16x16x32_bf16 v[112:115], a[8:11], a[212:215], v[112:115]
    ds_read_b128 a[236:239], v2 offset:22528
    v_cvt_pk_bf16_f32 v134, v108, v109
    v_mfma_f32_16x16x32_bf16 v[112:115], a[12:15], a[216:219], v[112:115]
    v_cvt_pk_bf16_f32 v135, v110, v111
    v_sub_f32 v32, v32, v12
    v_mfma_f32_16x16x32_bf16 v[112:115], a[16:19], a[220:223], v[112:115]
    ds_read_b128 a[240:243], v2 offset:23552
    v_sub_f32 v33, v33, v12
    v_mfma_f32_16x16x32_bf16 v[112:115], a[20:23], a[224:227], v[112:115]
    v_sub_f32 v48, v48, v13
    v_sub_f32 v49, v49, v13
    v_mfma_f32_16x16x32_bf16 v[116:119], a[24:27], a[204:207], 0
    ds_read_b128 a[244:247], v2 offset:24576
    v_sub_f32 v64, v64, v14
    v_mfma_f32_16x16x32_bf16 v[116:119], a[28:31], a[208:211], v[116:119]
    v_sub_f32 v65, v65, v14
    v_sub_f32 v80, v80, v15
    v_mfma_f32_16x16x32_bf16 v[116:119], a[32:35], a[212:215], v[116:119]
    ds_read_b128 a[248:251], v2 offset:25600
    v_cvt_pk_bf16_f32 v136, v112, v113
    v_mfma_f32_16x16x32_bf16 v[116:119], a[36:39], a[216:219], v[116:119]
    v_cvt_pk_bf16_f32 v137, v114, v115
    v_sub_f32 v81, v81, v15
    v_mfma_f32_16x16x32_bf16 v[116:119], a[40:43], a[220:223], v[116:119]
    v_exp_f32 v32, v32
    v_mfma_f32_16x16x32_bf16 v[116:119], a[44:47], a[224:227], v[116:119]
    v_exp_f32 v33, v33
    v_mfma_f32_16x16x32_bf16 v[120:123], a[48:51], a[204:207], 0
    v_sub_f32 v34, v34, v12
    v_sub_f32 v50, v50, v13
    v_mfma_f32_16x16x32_bf16 v[120:123], a[52:55], a[208:211], v[120:123]
    v_exp_f32 v48, v48
    v_mfma_f32_16x16x32_bf16 v[120:123], a[56:59], a[212:215], v[120:123]
    buffer_load_dwordx4 a[152:155], v9, s[8:11], s28 offen offset:128 nt
    v_cvt_pk_bf16_f32 v138, v116, v117
    v_mfma_f32_16x16x32_bf16 v[120:123], a[60:63], a[216:219], v[120:123]
    buffer_load_dwordx4 a[156:159], v10, s[8:11], s28 offen offset:128 nt
    v_cvt_pk_bf16_f32 v139, v118, v119
    v_mfma_f32_16x16x32_bf16 v[120:123], a[64:67], a[220:223], v[120:123]
    v_exp_f32 v49, v49
    v_mfma_f32_16x16x32_bf16 v[120:123], a[68:71], a[224:227], v[120:123]
    v_exp_f32 v64, v64
    v_mfma_f32_16x16x32_bf16 v[124:127], a[72:75], a[204:207], 0
    v_exp_f32 v65, v65
    v_mfma_f32_16x16x32_bf16 v[124:127], a[76:79], a[208:211], v[124:127]
    v_sub_f32 v66, v66, v14
    v_sub_f32 v82, v82, v15
    v_mfma_f32_16x16x32_bf16 v[124:127], a[80:83], a[212:215], v[124:127]
    v_cvt_pk_bf16_f32 v140, v120, v121
    v_cvt_pk_bf16_f32 v141, v122, v123
    v_mfma_f32_16x16x32_bf16 v[124:127], a[84:87], a[216:219], v[124:127]
    v_exp_f32 v80, v80
    v_mfma_f32_16x16x32_bf16 v[124:127], a[88:91], a[220:223], v[124:127]
    ds_read_b128 a[192:195], v2 offset:26624
    v_sub_f32 v35, v35, v12
    v_mfma_f32_16x16x32_bf16 v[124:127], a[92:95], a[224:227], v[124:127]
    v_sub_f32 v51, v51, v13
    s_waitcnt lgkmcnt(1)
    v_mfma_f32_16x16x32_bf16 v[96:99], a[0:3], a[228:231], 0
    ds_read_b128 a[196:199], v2 offset:27648
    v_sub_f32 v67, v67, v14
    v_mfma_f32_16x16x32_bf16 v[96:99], a[4:7], a[232:235], v[96:99]
    v_exp_f32 v81, v81
    v_mfma_f32_16x16x32_bf16 v[96:99], a[8:11], a[236:239], v[96:99]
    ds_read_b128 a[200:203], v2 offset:28672
    v_cvt_pk_bf16_f32 v142, v124, v125
    v_mfma_f32_16x16x32_bf16 v[96:99], a[12:15], a[240:243], v[96:99]
    v_cvt_pk_bf16_f32 v143, v126, v127
    v_sub_f32 v83, v83, v15
    v_mfma_f32_16x16x32_bf16 v[96:99], a[16:19], a[244:247], v[96:99]
    ds_read_b128 a[204:207], v2 offset:29696
    v_sub_f32 v36, v36, v12
    v_mfma_f32_16x16x32_bf16 v[96:99], a[20:23], a[248:251], v[96:99]
    v_exp_f32 v34, v34
    v_mfma_f32_16x16x32_bf16 v[100:103], a[24:27], a[228:231], 0
    ds_read_b128 a[208:211], v2 offset:30720
    v_sub_f32 v52, v52, v13
    v_mfma_f32_16x16x32_bf16 v[100:103], a[28:31], a[232:235], v[100:103]
    v_exp_f32 v50, v50
    v_mfma_f32_16x16x32_bf16 v[100:103], a[32:35], a[236:239], v[100:103]
    ds_read_b128 a[212:215], v2 offset:31744
    v_cvt_pk_bf16_f32 v144, v96, v97
    v_mfma_f32_16x16x32_bf16 v[100:103], a[36:39], a[240:243], v[100:103]
    v_cvt_pk_bf16_f32 v145, v98, v99
    v_sub_f32 v68, v68, v14
    v_mfma_f32_16x16x32_bf16 v[100:103], a[40:43], a[244:247], v[100:103]
    v_exp_f32 v66, v66
    v_mfma_f32_16x16x32_bf16 v[100:103], a[44:47], a[248:251], v[100:103]
    v_exp_f32 v82, v82
    v_mfma_f32_16x16x32_bf16 v[104:107], a[48:51], a[228:231], 0
    v_exp_f32 v35, v35
    v_mfma_f32_16x16x32_bf16 v[104:107], a[52:55], a[232:235], v[104:107]
    v_exp_f32 v51, v51
    v_mfma_f32_16x16x32_bf16 v[104:107], a[56:59], a[236:239], v[104:107]
    v_cvt_pk_bf16_f32 v146, v100, v101
    v_cvt_pk_bf16_f32 v147, v102, v103
    v_mfma_f32_16x16x32_bf16 v[104:107], a[60:63], a[240:243], v[104:107]
    v_exp_f32 v67, v67
    v_mfma_f32_16x16x32_bf16 v[104:107], a[64:67], a[244:247], v[104:107]
    v_exp_f32 v83, v83
    v_mfma_f32_16x16x32_bf16 v[104:107], a[68:71], a[248:251], v[104:107]
    v_sub_f32 v84, v84, v15
    v_add_f32 v20, v32, v33
    v_mfma_f32_16x16x32_bf16 v[108:111], a[72:75], a[228:231], 0
    v_exp_f32 v36, v36
    v_mfma_f32_16x16x32_bf16 v[108:111], a[76:79], a[232:235], v[108:111]
    v_sub_f32 v37, v37, v12
    v_add_f32 v21, v48, v49
    v_mfma_f32_16x16x32_bf16 v[108:111], a[80:83], a[236:239], v[108:111]
    v_cvt_pk_bf16_f32 v148, v104, v105
    v_cvt_pk_bf16_f32 v149, v106, v107
    v_mfma_f32_16x16x32_bf16 v[108:111], a[84:87], a[240:243], v[108:111]
    v_exp_f32 v52, v52
    v_mfma_f32_16x16x32_bf16 v[108:111], a[88:91], a[244:247], v[108:111]
    ds_read_b128 a[216:219], v2 offset:32768
    v_sub_f32 v53, v53, v13
    v_mfma_f32_16x16x32_bf16 v[108:111], a[92:95], a[248:251], v[108:111]
    v_add_f32 v22, v64, v65
    s_waitcnt lgkmcnt(1)
    v_mfma_f32_16x16x32_bf16 v[112:115], a[0:3], a[192:195], 0
    ds_read_b128 a[220:223], v2 offset:33792
    v_sub_f32 v69, v69, v14
    v_mfma_f32_16x16x32_bf16 v[112:115], a[4:7], a[196:199], v[112:115]
    v_exp_f32 v68, v68
    v_mfma_f32_16x16x32_bf16 v[112:115], a[8:11], a[200:203], v[112:115]
    ds_read_b128 a[224:227], v2 offset:34816
    v_cvt_pk_bf16_f32 v150, v108, v109
    v_mfma_f32_16x16x32_bf16 v[112:115], a[12:15], a[204:207], v[112:115]
    v_cvt_pk_bf16_f32 v151, v110, v111
    v_add_f32 v23, v80, v81
    v_mfma_f32_16x16x32_bf16 v[112:115], a[16:19], a[208:211], v[112:115]
    ds_read_b128 a[228:231], v2 offset:35840
    v_sub_f32 v85, v85, v15
    v_mfma_f32_16x16x32_bf16 v[112:115], a[20:23], a[212:215], v[112:115]
    v_exp_f32 v84, v84
    v_mfma_f32_16x16x32_bf16 v[116:119], a[24:27], a[192:195], 0
    ds_read_b128 a[232:235], v2 offset:36864
    v_add_f32 v20, v20, v34
    v_mfma_f32_16x16x32_bf16 v[116:119], a[28:31], a[196:199], v[116:119]
    v_exp_f32 v37, v37
    v_mfma_f32_16x16x32_bf16 v[116:119], a[32:35], a[200:203], v[116:119]
    ds_read_b128 a[236:239], v2 offset:37888
    v_cvt_pk_bf16_f32 v152, v112, v113
    v_mfma_f32_16x16x32_bf16 v[116:119], a[36:39], a[204:207], v[116:119]
    v_cvt_pk_bf16_f32 v153, v114, v115
    v_sub_f32 v38, v38, v12
    v_mfma_f32_16x16x32_bf16 v[116:119], a[40:43], a[208:211], v[116:119]
    v_add_f32 v21, v21, v50
    v_sub_f32 v54, v54, v13
    v_mfma_f32_16x16x32_bf16 v[116:119], a[44:47], a[212:215], v[116:119]
    v_exp_f32 v53, v53
    v_mfma_f32_16x16x32_bf16 v[120:123], a[48:51], a[192:195], 0
    v_add_f32 v22, v22, v66
    v_sub_f32 v70, v70, v14
    v_mfma_f32_16x16x32_bf16 v[120:123], a[52:55], a[196:199], v[120:123]
    v_exp_f32 v69, v69
    v_mfma_f32_16x16x32_bf16 v[120:123], a[56:59], a[200:203], v[120:123]
    v_cvt_pk_bf16_f32 v154, v116, v117
    v_cvt_pk_bf16_f32 v155, v118, v119
    v_mfma_f32_16x16x32_bf16 v[120:123], a[60:63], a[204:207], v[120:123]
    v_add_f32 v23, v23, v82
    v_sub_f32 v86, v86, v15
    v_mfma_f32_16x16x32_bf16 v[120:123], a[64:67], a[208:211], v[120:123]
    v_exp_f32 v85, v85
    v_mfma_f32_16x16x32_bf16 v[120:123], a[68:71], a[212:215], v[120:123]
    v_add_f32 v20, v20, v35
    v_sub_f32 v39, v39, v12
    v_mfma_f32_16x16x32_bf16 v[124:127], a[72:75], a[192:195], 0
    v_exp_f32 v38, v38
    v_mfma_f32_16x16x32_bf16 v[124:127], a[76:79], a[196:199], v[124:127]
    v_add_f32 v21, v21, v51
    v_sub_f32 v55, v55, v13
    v_mfma_f32_16x16x32_bf16 v[124:127], a[80:83], a[200:203], v[124:127]
    v_cvt_pk_bf16_f32 v156, v120, v121
    v_cvt_pk_bf16_f32 v157, v122, v123
    v_mfma_f32_16x16x32_bf16 v[124:127], a[84:87], a[204:207], v[124:127]
    v_exp_f32 v54, v54
    v_mfma_f32_16x16x32_bf16 v[124:127], a[88:91], a[208:211], v[124:127]
    buffer_load_dwordx4 a[176:179], v9, s[8:11], s30 offen offset:128 nt
    v_add_f32 v22, v22, v67
    v_mfma_f32_16x16x32_bf16 v[124:127], a[92:95], a[212:215], v[124:127]
    buffer_load_dwordx4 a[180:183], v10, s[8:11], s30 offen offset:128 nt
    s_waitcnt lgkmcnt(0)
    v_mfma_f32_16x16x32_bf16 v[96:99], a[0:3], a[216:219], 0
    ds_read_b128 a[240:243], v2 offset:38912
    v_sub_f32 v71, v71, v14
    v_mfma_f32_16x16x32_bf16 v[96:99], a[4:7], a[220:223], v[96:99]
    ds_read_b128 a[244:247], v2 offset:39936
    v_add_f32 v23, v23, v83
    v_mfma_f32_16x16x32_bf16 v[96:99], a[8:11], a[224:227], v[96:99]
    ds_read_b128 a[248:251], v2 offset:40960
    v_cvt_pk_bf16_f32 v158, v124, v125
    v_mfma_f32_16x16x32_bf16 v[96:99], a[12:15], a[228:231], v[96:99]
    v_cvt_pk_bf16_f32 v159, v126, v127
    v_sub_f32 v87, v87, v15
    v_mfma_f32_16x16x32_bf16 v[96:99], a[16:19], a[232:235], v[96:99]
    ds_read_b128 a[192:195], v2 offset:41984
    v_add_f32 v20, v20, v36
    v_mfma_f32_16x16x32_bf16 v[96:99], a[20:23], a[236:239], v[96:99]
    v_exp_f32 v70, v70
    v_mfma_f32_16x16x32_bf16 v[100:103], a[24:27], a[216:219], 0
    ds_read_b128 a[196:199], v2 offset:43008
    v_sub_f32 v40, v40, v12
    v_mfma_f32_16x16x32_bf16 v[100:103], a[28:31], a[220:223], v[100:103]
    v_exp_f32 v86, v86
    v_mfma_f32_16x16x32_bf16 v[100:103], a[32:35], a[224:227], v[100:103]
    ds_read_b128 a[200:203], v2 offset:44032
    v_cvt_pk_bf16_f32 v160, v96, v97
    v_mfma_f32_16x16x32_bf16 v[100:103], a[36:39], a[228:231], v[100:103]
    v_cvt_pk_bf16_f32 v161, v98, v99
    v_add_f32 v21, v21, v52
    v_mfma_f32_16x16x32_bf16 v[100:103], a[40:43], a[232:235], v[100:103]
    v_exp_f32 v39, v39
    v_mfma_f32_16x16x32_bf16 v[100:103], a[44:47], a[236:239], v[100:103]
    v_exp_f32 v55, v55
    v_mfma_f32_16x16x32_bf16 v[104:107], a[48:51], a[216:219], 0
    v_sub_f32 v56, v56, v13
    v_add_f32 v22, v22, v68
    v_mfma_f32_16x16x32_bf16 v[104:107], a[52:55], a[220:223], v[104:107]
    v_exp_f32 v71, v71
    v_mfma_f32_16x16x32_bf16 v[104:107], a[56:59], a[224:227], v[104:107]
    v_cvt_pk_bf16_f32 v162, v100, v101
    v_cvt_pk_bf16_f32 v163, v102, v103
    v_mfma_f32_16x16x32_bf16 v[104:107], a[60:63], a[228:231], v[104:107]
    v_sub_f32 v72, v72, v14
    v_add_f32 v23, v23, v84
    v_mfma_f32_16x16x32_bf16 v[104:107], a[64:67], a[232:235], v[104:107]
    v_exp_f32 v87, v87
    v_mfma_f32_16x16x32_bf16 v[104:107], a[68:71], a[236:239], v[104:107]
    v_sub_f32 v88, v88, v15
    v_add_f32 v20, v20, v37
    v_mfma_f32_16x16x32_bf16 v[108:111], a[72:75], a[216:219], 0
    v_exp_f32 v40, v40
    v_mfma_f32_16x16x32_bf16 v[108:111], a[76:79], a[220:223], v[108:111]
    v_sub_f32 v41, v41, v12
    v_add_f32 v21, v21, v53
    v_mfma_f32_16x16x32_bf16 v[108:111], a[80:83], a[224:227], v[108:111]
    v_cvt_pk_bf16_f32 v164, v104, v105
    v_cvt_pk_bf16_f32 v165, v106, v107
    v_mfma_f32_16x16x32_bf16 v[108:111], a[84:87], a[228:231], v[108:111]
    v_exp_f32 v56, v56
    v_mfma_f32_16x16x32_bf16 v[108:111], a[88:91], a[232:235], v[108:111]
    ds_read_b128 a[204:207], v2 offset:45056
    v_sub_f32 v57, v57, v13
    v_mfma_f32_16x16x32_bf16 v[108:111], a[92:95], a[236:239], v[108:111]
    v_add_f32 v22, v22, v69
    s_waitcnt lgkmcnt(1)
    v_mfma_f32_16x16x32_bf16 v[112:115], a[0:3], a[240:243], 0
    ds_read_b128 a[208:211], v2 offset:46080
    v_sub_f32 v73, v73, v14
    v_mfma_f32_16x16x32_bf16 v[112:115], a[4:7], a[244:247], v[112:115]
    v_exp_f32 v72, v72
    v_mfma_f32_16x16x32_bf16 v[112:115], a[8:11], a[248:251], v[112:115]
    ds_read_b128 a[212:215], v2 offset:47104
    v_cvt_pk_bf16_f32 v166, v108, v109
    v_mfma_f32_16x16x32_bf16 v[112:115], a[12:15], a[192:195], v[112:115]
    v_cvt_pk_bf16_f32 v167, v110, v111
    v_add_f32 v23, v23, v85
    v_mfma_f32_16x16x32_bf16 v[112:115], a[16:19], a[196:199], v[112:115]
    ds_read_b128 a[216:219], v2 offset:48128
    v_sub_f32 v89, v89, v15
    v_mfma_f32_16x16x32_bf16 v[112:115], a[20:23], a[200:203], v[112:115]
    v_exp_f32 v88, v88
    v_mfma_f32_16x16x32_bf16 v[116:119], a[24:27], a[240:243], 0
    ds_read_b128 a[220:223], v2 offset:49152
    v_add_f32 v20, v20, v38
    v_mfma_f32_16x16x32_bf16 v[116:119], a[28:31], a[244:247], v[116:119]
    v_exp_f32 v41, v41
    v_mfma_f32_16x16x32_bf16 v[116:119], a[32:35], a[248:251], v[116:119]
    ds_read_b128 a[224:227], v2 offset:50176
    v_cvt_pk_bf16_f32 v168, v112, v113
    v_mfma_f32_16x16x32_bf16 v[116:119], a[36:39], a[192:195], v[116:119]
    v_cvt_pk_bf16_f32 v169, v114, v115
    v_sub_f32 v42, v42, v12
    v_mfma_f32_16x16x32_bf16 v[116:119], a[40:43], a[196:199], v[116:119]
    v_add_f32 v21, v21, v54
    v_sub_f32 v58, v58, v13
    v_mfma_f32_16x16x32_bf16 v[116:119], a[44:47], a[200:203], v[116:119]
    v_exp_f32 v57, v57
    v_mfma_f32_16x16x32_bf16 v[120:123], a[48:51], a[240:243], 0
    v_add_f32 v22, v22, v70
    v_sub_f32 v74, v74, v14
    v_mfma_f32_16x16x32_bf16 v[120:123], a[52:55], a[244:247], v[120:123]
    v_exp_f32 v73, v73
    v_mfma_f32_16x16x32_bf16 v[120:123], a[56:59], a[248:251], v[120:123]
    v_cvt_pk_bf16_f32 v170, v116, v117
    v_cvt_pk_bf16_f32 v171, v118, v119
    v_mfma_f32_16x16x32_bf16 v[120:123], a[60:63], a[192:195], v[120:123]
    v_add_f32 v23, v23, v86
    v_sub_f32 v90, v90, v15
    v_mfma_f32_16x16x32_bf16 v[120:123], a[64:67], a[196:199], v[120:123]
    v_exp_f32 v89, v89
    v_mfma_f32_16x16x32_bf16 v[120:123], a[68:71], a[200:203], v[120:123]
    v_add_f32 v20, v20, v39
    v_sub_f32 v43, v43, v12
    v_mfma_f32_16x16x32_bf16 v[124:127], a[72:75], a[240:243], 0
    v_exp_f32 v42, v42
    v_mfma_f32_16x16x32_bf16 v[124:127], a[76:79], a[244:247], v[124:127]
    v_add_f32 v21, v21, v55
    v_sub_f32 v59, v59, v13
    v_mfma_f32_16x16x32_bf16 v[124:127], a[80:83], a[248:251], v[124:127]
    v_cvt_pk_bf16_f32 v172, v120, v121
    v_cvt_pk_bf16_f32 v173, v122, v123
    v_mfma_f32_16x16x32_bf16 v[124:127], a[84:87], a[192:195], v[124:127]
    v_exp_f32 v58, v58
    v_mfma_f32_16x16x32_bf16 v[124:127], a[88:91], a[196:199], v[124:127]
    ds_read_b128 a[228:231], v2 offset:51200
    v_add_f32 v22, v22, v71
    v_mfma_f32_16x16x32_bf16 v[124:127], a[92:95], a[200:203], v[124:127]
    v_sub_f32 v75, v75, v14
    s_waitcnt lgkmcnt(1)
    v_mfma_f32_16x16x32_bf16 v[96:99], a[0:3], a[204:207], 0
    ds_read_b128 a[232:235], v2 offset:52224
    v_add_f32 v23, v23, v87
    v_mfma_f32_16x16x32_bf16 v[96:99], a[4:7], a[208:211], v[96:99]
    v_exp_f32 v74, v74
    v_mfma_f32_16x16x32_bf16 v[96:99], a[8:11], a[212:215], v[96:99]
    ds_read_b128 a[236:239], v2 offset:53248
    v_cvt_pk_bf16_f32 v174, v124, v125
    v_mfma_f32_16x16x32_bf16 v[96:99], a[12:15], a[216:219], v[96:99]
    v_cvt_pk_bf16_f32 v175, v126, v127
    v_sub_f32 v91, v91, v15
    v_mfma_f32_16x16x32_bf16 v[96:99], a[16:19], a[220:223], v[96:99]
    ds_read_b128 a[240:243], v2 offset:54272
    v_add_f32 v20, v20, v40
    v_mfma_f32_16x16x32_bf16 v[96:99], a[20:23], a[224:227], v[96:99]
    v_exp_f32 v90, v90
    v_mfma_f32_16x16x32_bf16 v[100:103], a[24:27], a[204:207], 0
    buffer_load_dwordx4 a[160:163], v9, s[8:11], s28 offen offset:256 nt
    v_sub_f32 v44, v44, v12
    v_mfma_f32_16x16x32_bf16 v[100:103], a[28:31], a[208:211], v[100:103]
    buffer_load_dwordx4 a[164:167], v10, s[8:11], s28 offen offset:256 nt
    v_add_f32 v21, v21, v56
    v_mfma_f32_16x16x32_bf16 v[100:103], a[32:35], a[212:215], v[100:103]
    ds_read_b128 a[244:247], v2 offset:55296
    v_cvt_pk_bf16_f32 v176, v96, v97
    v_mfma_f32_16x16x32_bf16 v[100:103], a[36:39], a[216:219], v[100:103]
    ds_read_b128 a[248:251], v2 offset:56320
    v_cvt_pk_bf16_f32 v177, v98, v99
    v_mfma_f32_16x16x32_bf16 v[100:103], a[40:43], a[220:223], v[100:103]
    v_exp_f32 v43, v43
    v_mfma_f32_16x16x32_bf16 v[100:103], a[44:47], a[224:227], v[100:103]
    v_exp_f32 v59, v59
    v_mfma_f32_16x16x32_bf16 v[104:107], a[48:51], a[204:207], 0
    v_sub_f32 v60, v60, v13
    v_add_f32 v22, v22, v72
    v_mfma_f32_16x16x32_bf16 v[104:107], a[52:55], a[208:211], v[104:107]
    v_exp_f32 v75, v75
    v_mfma_f32_16x16x32_bf16 v[104:107], a[56:59], a[212:215], v[104:107]
    v_cvt_pk_bf16_f32 v178, v100, v101
    v_cvt_pk_bf16_f32 v179, v102, v103
    v_mfma_f32_16x16x32_bf16 v[104:107], a[60:63], a[216:219], v[104:107]
    v_sub_f32 v76, v76, v14
    v_add_f32 v23, v23, v88
    v_mfma_f32_16x16x32_bf16 v[104:107], a[64:67], a[220:223], v[104:107]
    v_exp_f32 v91, v91
    v_mfma_f32_16x16x32_bf16 v[104:107], a[68:71], a[224:227], v[104:107]
    v_sub_f32 v92, v92, v15
    v_add_f32 v20, v20, v41
    v_mfma_f32_16x16x32_bf16 v[108:111], a[72:75], a[204:207], 0
    v_exp_f32 v44, v44
    v_mfma_f32_16x16x32_bf16 v[108:111], a[76:79], a[208:211], v[108:111]
    v_sub_f32 v45, v45, v12
    v_add_f32 v21, v21, v57
    v_mfma_f32_16x16x32_bf16 v[108:111], a[80:83], a[212:215], v[108:111]
    v_cvt_pk_bf16_f32 v180, v104, v105
    v_cvt_pk_bf16_f32 v181, v106, v107
    v_mfma_f32_16x16x32_bf16 v[108:111], a[84:87], a[216:219], v[108:111]
    v_exp_f32 v60, v60
    v_mfma_f32_16x16x32_bf16 v[108:111], a[88:91], a[220:223], v[108:111]
    ds_read_b128 a[192:195], v2 offset:57344
    v_sub_f32 v61, v61, v13
    v_mfma_f32_16x16x32_bf16 v[108:111], a[92:95], a[224:227], v[108:111]
    v_add_f32 v22, v22, v73
    s_waitcnt lgkmcnt(1)
    v_mfma_f32_16x16x32_bf16 v[112:115], a[0:3], a[228:231], 0
    ds_read_b128 a[196:199], v2 offset:58368
    v_sub_f32 v77, v77, v14
    v_mfma_f32_16x16x32_bf16 v[112:115], a[4:7], a[232:235], v[112:115]
    v_exp_f32 v76, v76
    v_mfma_f32_16x16x32_bf16 v[112:115], a[8:11], a[236:239], v[112:115]
    ds_read_b128 a[200:203], v2 offset:59392
    v_cvt_pk_bf16_f32 v182, v108, v109
    v_mfma_f32_16x16x32_bf16 v[112:115], a[12:15], a[240:243], v[112:115]
    v_cvt_pk_bf16_f32 v183, v110, v111
    v_add_f32 v23, v23, v89
    v_mfma_f32_16x16x32_bf16 v[112:115], a[16:19], a[244:247], v[112:115]
    ds_read_b128 a[204:207], v2 offset:60416
    v_sub_f32 v93, v93, v15
    v_mfma_f32_16x16x32_bf16 v[112:115], a[20:23], a[248:251], v[112:115]
    v_exp_f32 v92, v92
    v_mfma_f32_16x16x32_bf16 v[116:119], a[24:27], a[228:231], 0
    ds_read_b128 a[208:211], v2 offset:61440
    v_add_f32 v20, v20, v42
    v_mfma_f32_16x16x32_bf16 v[116:119], a[28:31], a[232:235], v[116:119]
    v_exp_f32 v45, v45
    v_mfma_f32_16x16x32_bf16 v[116:119], a[32:35], a[236:239], v[116:119]
    ds_read_b128 a[212:215], v2 offset:62464
    v_cvt_pk_bf16_f32 v184, v112, v113
    v_mfma_f32_16x16x32_bf16 v[116:119], a[36:39], a[240:243], v[116:119]
    v_cvt_pk_bf16_f32 v185, v114, v115
    v_sub_f32 v46, v46, v12
    v_mfma_f32_16x16x32_bf16 v[116:119], a[40:43], a[244:247], v[116:119]
    v_add_f32 v21, v21, v58
    v_sub_f32 v62, v62, v13
    v_mfma_f32_16x16x32_bf16 v[116:119], a[44:47], a[248:251], v[116:119]
    v_exp_f32 v61, v61
    v_mfma_f32_16x16x32_bf16 v[120:123], a[48:51], a[228:231], 0
    v_add_f32 v22, v22, v74
    v_sub_f32 v78, v78, v14
    v_mfma_f32_16x16x32_bf16 v[120:123], a[52:55], a[232:235], v[120:123]
    v_exp_f32 v77, v77
    v_mfma_f32_16x16x32_bf16 v[120:123], a[56:59], a[236:239], v[120:123]
    v_cvt_pk_bf16_f32 v186, v116, v117
    v_cvt_pk_bf16_f32 v187, v118, v119
    v_mfma_f32_16x16x32_bf16 v[120:123], a[60:63], a[240:243], v[120:123]
    v_add_f32 v23, v23, v90
    v_sub_f32 v94, v94, v15
    v_mfma_f32_16x16x32_bf16 v[120:123], a[64:67], a[244:247], v[120:123]
    v_exp_f32 v93, v93
    v_mfma_f32_16x16x32_bf16 v[120:123], a[68:71], a[248:251], v[120:123]
    v_add_f32 v20, v20, v43
    v_sub_f32 v47, v47, v12
    v_mfma_f32_16x16x32_bf16 v[124:127], a[72:75], a[228:231], 0
    v_exp_f32 v46, v46
    v_mfma_f32_16x16x32_bf16 v[124:127], a[76:79], a[232:235], v[124:127]
    v_add_f32 v21, v21, v59
    v_sub_f32 v63, v63, v13
    v_mfma_f32_16x16x32_bf16 v[124:127], a[80:83], a[236:239], v[124:127]
    v_cvt_pk_bf16_f32 v188, v120, v121
    v_cvt_pk_bf16_f32 v189, v122, v123
    v_mfma_f32_16x16x32_bf16 v[124:127], a[84:87], a[240:243], v[124:127]
    v_exp_f32 v62, v62
    v_mfma_f32_16x16x32_bf16 v[124:127], a[88:91], a[244:247], v[124:127]
    ds_read_b128 a[216:219], v2 offset:63488
    v_add_f32 v22, v22, v75
    v_mfma_f32_16x16x32_bf16 v[124:127], a[92:95], a[248:251], v[124:127]
    v_sub_f32 v79, v79, v14
    s_waitcnt lgkmcnt(1)
    v_mfma_f32_16x16x32_bf16 v[96:99], a[0:3], a[192:195], 0
    ds_read_b128 a[220:223], v2 offset:64512
    v_add_f32 v23, v23, v91
    v_mfma_f32_16x16x32_bf16 v[96:99], a[4:7], a[196:199], v[96:99]
    v_exp_f32 v78, v78
    v_mfma_f32_16x16x32_bf16 v[96:99], a[8:11], a[200:203], v[96:99]
    ds_read_b128 a[224:227], v3 offset:0
    v_cvt_pk_bf16_f32 v190, v124, v125
    v_mfma_f32_16x16x32_bf16 v[96:99], a[12:15], a[204:207], v[96:99]
    v_cvt_pk_bf16_f32 v191, v126, v127
    v_sub_f32 v95, v95, v15
    v_mfma_f32_16x16x32_bf16 v[96:99], a[16:19], a[208:211], v[96:99]
    ds_read_b128 a[228:231], v3 offset:1024
    v_add_f32 v20, v20, v44
    v_mfma_f32_16x16x32_bf16 v[96:99], a[20:23], a[212:215], v[96:99]
    v_exp_f32 v94, v94
    v_mfma_f32_16x16x32_bf16 v[100:103], a[24:27], a[192:195], 0
    ds_read_b128 a[232:235], v3 offset:2048
    v_add_f32 v21, v21, v60
    v_mfma_f32_16x16x32_bf16 v[100:103], a[28:31], a[196:199], v[100:103]
    v_exp_f32 v47, v47
    v_mfma_f32_16x16x32_bf16 v[100:103], a[32:35], a[200:203], v[100:103]
    ds_read_b128 a[236:239], v3 offset:3072
    v_cvt_pk_bf16_f32 v192, v96, v97
    v_mfma_f32_16x16x32_bf16 v[100:103], a[36:39], a[204:207], v[100:103]
    v_cvt_pk_bf16_f32 v193, v98, v99
    v_add_f32 v22, v22, v76
    v_mfma_f32_16x16x32_bf16 v[100:103], a[40:43], a[208:211], v[100:103]
    v_exp_f32 v63, v63
    v_mfma_f32_16x16x32_bf16 v[100:103], a[44:47], a[212:215], v[100:103]
    v_exp_f32 v79, v79
    v_mfma_f32_16x16x32_bf16 v[104:107], a[48:51], a[192:195], 0
    v_add_f32 v23, v23, v92
    v_add_f32 v20, v20, v45
    v_mfma_f32_16x16x32_bf16 v[104:107], a[52:55], a[196:199], v[104:107]
    v_exp_f32 v95, v95
    v_mfma_f32_16x16x32_bf16 v[104:107], a[56:59], a[200:203], v[104:107]
    buffer_load_dwordx4 a[184:187], v9, s[8:11], s30 offen offset:256 nt
    v_cvt_pk_bf16_f32 v194, v100, v101
    v_mfma_f32_16x16x32_bf16 v[104:107], a[60:63], a[204:207], v[104:107]
    buffer_load_dwordx4 a[188:191], v10, s[8:11], s30 offen offset:256 nt
    v_cvt_pk_bf16_f32 v195, v102, v103
    v_mfma_f32_16x16x32_bf16 v[104:107], a[64:67], a[208:211], v[104:107]
    v_add_f32 v21, v21, v61
    v_add_f32 v22, v22, v77
    v_mfma_f32_16x16x32_bf16 v[104:107], a[68:71], a[212:215], v[104:107]
    v_add_f32 v23, v23, v93
    v_add_f32 v20, v20, v46
    v_mfma_f32_16x16x32_bf16 v[108:111], a[72:75], a[192:195], 0
    v_add_f32 v21, v21, v62
    v_add_f32 v22, v22, v78
    v_mfma_f32_16x16x32_bf16 v[108:111], a[76:79], a[196:199], v[108:111]
    v_add_f32 v23, v23, v94
    v_add_f32 v20, v20, v47
    v_mfma_f32_16x16x32_bf16 v[108:111], a[80:83], a[200:203], v[108:111]
    v_cvt_pk_bf16_f32 v196, v104, v105
    v_cvt_pk_bf16_f32 v197, v106, v107
    v_mfma_f32_16x16x32_bf16 v[108:111], a[84:87], a[204:207], v[108:111]
    v_add_f32 v21, v21, v63
    v_add_f32 v22, v22, v79
    v_mfma_f32_16x16x32_bf16 v[108:111], a[88:91], a[208:211], v[108:111]
    ds_read_b128 a[240:243], v3 offset:4096
    v_add_f32 v23, v23, v95
    v_mfma_f32_16x16x32_bf16 v[108:111], a[92:95], a[212:215], v[108:111]
    v_permlane16_swap_b32 v20, v21
    s_waitcnt lgkmcnt(1)
    v_mfma_f32_16x16x32_bf16 v[112:115], a[0:3], a[216:219], 0
    ds_read_b128 a[244:247], v3 offset:5120
    v_permlane16_swap_b32 v22, v23
    v_mfma_f32_16x16x32_bf16 v[112:115], a[4:7], a[220:223], v[112:115]
    v_add_f32 v20, v20, v21
    v_add_f32 v22, v22, v23
    v_mfma_f32_16x16x32_bf16 v[112:115], a[8:11], a[224:227], v[112:115]
    ds_read_b128 a[248:251], v3 offset:6144
    v_cvt_pk_bf16_f32 v198, v108, v109
    v_mfma_f32_16x16x32_bf16 v[112:115], a[12:15], a[228:231], v[112:115]
    v_cvt_pk_bf16_f32 v199, v110, v111
    v_permlane32_swap_b32 v20, v22
    v_mfma_f32_16x16x32_bf16 v[112:115], a[16:19], a[232:235], v[112:115]
    ds_read_b128 a[192:195], v3 offset:7168
    v_add_f32 v20, v20, v22
    v_mfma_f32_16x16x32_bf16 v[112:115], a[20:23], a[236:239], v[112:115]
    v_rcp_f32 v20, v20
    v_mfma_f32_16x16x32_bf16 v[116:119], a[24:27], a[216:219], 0
    ds_read_b128 a[196:199], v3 offset:8192
    v_mov_b32 v22, v20
    v_mfma_f32_16x16x32_bf16 v[116:119], a[28:31], a[220:223], v[116:119]
    s_add_u32 s28, s16, 7077888
    v_permlane32_swap_b32 v20, v22
    v_mfma_f32_16x16x32_bf16 v[116:119], a[32:35], a[224:227], v[116:119]
    ds_read_b128 a[200:203], v3 offset:9216
    v_cvt_pk_bf16_f32 v200, v112, v113
    v_mfma_f32_16x16x32_bf16 v[116:119], a[36:39], a[228:231], v[116:119]
    v_cvt_pk_bf16_f32 v201, v114, v115
    v_mov_b32 v21, v20
    v_mfma_f32_16x16x32_bf16 v[116:119], a[40:43], a[232:235], v[116:119]
    v_mov_b32 v23, v22
    v_permlane16_swap_b32 v20, v21
    v_mfma_f32_16x16x32_bf16 v[116:119], a[44:47], a[236:239], v[116:119]
    v_mul_f32 v32, v32, v20
    v_mul_f32 v33, v33, v20
    v_mfma_f32_16x16x32_bf16 v[120:123], a[48:51], a[216:219], 0
    v_cvt_pk_bf16_f32 v32, v32, v33
    v_mul_f32 v34, v34, v20
    v_mfma_f32_16x16x32_bf16 v[120:123], a[52:55], a[220:223], v[120:123]
    v_mul_f32 v35, v35, v20
    v_cvt_pk_bf16_f32 v33, v34, v35
    v_mfma_f32_16x16x32_bf16 v[120:123], a[56:59], a[224:227], v[120:123]
    v_cvt_pk_bf16_f32 v202, v116, v117
    v_cvt_pk_bf16_f32 v203, v118, v119
    v_mfma_f32_16x16x32_bf16 v[120:123], a[60:63], a[228:231], v[120:123]
    v_mul_f32 v36, v36, v20
    v_mul_f32 v37, v37, v20
    v_mfma_f32_16x16x32_bf16 v[120:123], a[64:67], a[232:235], v[120:123]
    v_cvt_pk_bf16_f32 v34, v36, v37
    v_mul_f32 v38, v38, v20
    v_mfma_f32_16x16x32_bf16 v[120:123], a[68:71], a[236:239], v[120:123]
    v_mul_f32 v39, v39, v20
    v_mul_f32 v40, v40, v20
    v_mfma_f32_16x16x32_bf16 v[124:127], a[72:75], a[216:219], 0
    v_mul_f32 v41, v41, v20
    v_permlane16_swap_b32 v22, v23
    v_mfma_f32_16x16x32_bf16 v[124:127], a[76:79], a[220:223], v[124:127]
    v_cvt_pk_bf16_f32 v35, v38, v39
    v_cvt_pk_bf16_f32 v36, v40, v41
    v_mfma_f32_16x16x32_bf16 v[124:127], a[80:83], a[224:227], v[124:127]
    v_cvt_pk_bf16_f32 v204, v120, v121
    v_cvt_pk_bf16_f32 v205, v122, v123
    v_mfma_f32_16x16x32_bf16 v[124:127], a[84:87], a[228:231], v[124:127]
    v_mul_f32 v48, v48, v21
    v_mul_f32 v49, v49, v21
    v_mfma_f32_16x16x32_bf16 v[124:127], a[88:91], a[232:235], v[124:127]
    ds_read_b128 a[204:207], v3 offset:10240
    v_cvt_pk_bf16_f32 v40, v48, v49
    v_mfma_f32_16x16x32_bf16 v[124:127], a[92:95], a[236:239], v[124:127]
    v_mul_f32 v64, v64, v22
    s_waitcnt lgkmcnt(1)
    v_mfma_f32_16x16x32_bf16 v[96:99], a[0:3], a[240:243], 0
    ds_read_b128 a[208:211], v3 offset:11264
    v_mul_f32 v65, v65, v22
    v_mfma_f32_16x16x32_bf16 v[96:99], a[4:7], a[244:247], v[96:99]
    v_mul_f32 v66, v66, v22
    v_mul_f32 v67, v67, v22
    v_mfma_f32_16x16x32_bf16 v[96:99], a[8:11], a[248:251], v[96:99]
    ds_read_b128 a[212:215], v3 offset:12288
    v_cvt_pk_bf16_f32 v206, v124, v125
    v_mfma_f32_16x16x32_bf16 v[96:99], a[12:15], a[192:195], v[96:99]
    v_cvt_pk_bf16_f32 v207, v126, v127
    v_cvt_pk_bf16_f32 v48, v64, v65
    v_mfma_f32_16x16x32_bf16 v[96:99], a[16:19], a[196:199], v[96:99]
    ds_read_b128 a[216:219], v3 offset:13312
    v_cvt_pk_bf16_f32 v49, v66, v67
    v_mfma_f32_16x16x32_bf16 v[96:99], a[20:23], a[200:203], v[96:99]
    v_mul_f32 v42, v42, v20
    v_mul_f32 v43, v43, v20
    v_mfma_f32_16x16x32_bf16 v[100:103], a[24:27], a[240:243], 0
    ds_read_b128 a[220:223], v3 offset:14336
    v_mul_f32 v44, v44, v20
    v_mfma_f32_16x16x32_bf16 v[100:103], a[28:31], a[244:247], v[100:103]
    v_mul_f32 v45, v45, v20
    v_mul_f32 v46, v46, v20
    v_mfma_f32_16x16x32_bf16 v[100:103], a[32:35], a[248:251], v[100:103]
    ds_read_b128 a[224:227], v3 offset:15360
    v_mul_f32 v47, v47, v20
    v_mfma_f32_16x16x32_bf16 v[100:103], a[36:39], a[192:195], v[100:103]
    v_cvt_pk_bf16_f32 v37, v42, v43
    v_cvt_pk_bf16_f32 v38, v44, v45
    v_mfma_f32_16x16x32_bf16 v[100:103], a[40:43], a[196:199], v[100:103]
    v_cvt_pk_bf16_f32 v39, v46, v47
    v_mul_f32 v50, v50, v21
    v_mfma_f32_16x16x32_bf16 v[100:103], a[44:47], a[200:203], v[100:103]
    v_mul_f32 v51, v51, v21
    v_cvt_pk_bf16_f32 v41, v50, v51
    v_mfma_f32_16x16x32_bf16 v[104:107], a[48:51], a[240:243], 0
    v_mul_f32 v68, v68, v22
    v_mul_f32 v69, v69, v22
    v_mfma_f32_16x16x32_bf16 v[104:107], a[52:55], a[244:247], v[104:107]
    v_mul_f32 v70, v70, v22
    v_mul_f32 v71, v71, v22
    v_mfma_f32_16x16x32_bf16 v[104:107], a[56:59], a[248:251], v[104:107]
    v_cvt_pk_bf16_f32 v50, v68, v69
    v_cvt_pk_bf16_f32 v51, v70, v71
    v_mfma_f32_16x16x32_bf16 v[104:107], a[60:63], a[192:195], v[104:107]
    v_mul_f32 v52, v52, v21
    v_mul_f32 v53, v53, v21
    v_mfma_f32_16x16x32_bf16 v[104:107], a[64:67], a[196:199], v[104:107]
    v_cvt_pk_bf16_f32 v42, v52, v53
    v_mul_f32 v72, v72, v22
    v_mfma_f32_16x16x32_bf16 v[104:107], a[68:71], a[200:203], v[104:107]
    v_mul_f32 v73, v73, v22
    v_mul_f32 v74, v74, v22
    v_mfma_f32_16x16x32_bf16 v[108:111], a[72:75], a[240:243], 0
    v_mul_f32 v75, v75, v22
    v_cvt_pk_bf16_f32 v52, v72, v73
    v_mfma_f32_16x16x32_bf16 v[108:111], a[76:79], a[244:247], v[108:111]
    v_cvt_pk_bf16_f32 v53, v74, v75
    v_mul_f32 v54, v54, v21
    v_mfma_f32_16x16x32_bf16 v[108:111], a[80:83], a[248:251], v[108:111]
    v_mul_f32 v55, v55, v21
    v_cvt_pk_bf16_f32 v43, v54, v55
    v_mfma_f32_16x16x32_bf16 v[108:111], a[84:87], a[192:195], v[108:111]
    v_mul_f32 v76, v76, v22
    v_mul_f32 v77, v77, v22
    v_mfma_f32_16x16x32_bf16 v[108:111], a[88:91], a[196:199], v[108:111]
    v_mul_f32 v78, v78, v22
    v_mul_f32 v79, v79, v22
    v_mfma_f32_16x16x32_bf16 v[108:111], a[92:95], a[200:203], v[108:111]
    v_cvt_pk_bf16_f32 v54, v76, v77
    s_waitcnt lgkmcnt(0)
    v_mfma_f32_16x16x32_bf16 v[112:115], a[0:3], a[204:207], 0
    v_cvt_pk_bf16_f32 v55, v78, v79
    v_mul_f32 v56, v56, v21
    v_mfma_f32_16x16x32_bf16 v[112:115], a[4:7], a[208:211], v[112:115]
    v_mul_f32 v57, v57, v21
    v_cvt_pk_bf16_f32 v44, v56, v57
    v_mfma_f32_16x16x32_bf16 v[112:115], a[8:11], a[212:215], v[112:115]
    v_mul_f32 v80, v80, v23
    v_mul_f32 v81, v81, v23
    v_mfma_f32_16x16x32_bf16 v[112:115], a[12:15], a[216:219], v[112:115]
    v_mul_f32 v82, v82, v23
    v_mul_f32 v83, v83, v23
    v_mfma_f32_16x16x32_bf16 v[112:115], a[16:19], a[220:223], v[112:115]
    v_cvt_pk_bf16_f32 v56, v80, v81
    v_cvt_pk_bf16_f32 v57, v82, v83
    v_mfma_f32_16x16x32_bf16 v[112:115], a[20:23], a[224:227], v[112:115]
    v_mul_f32 v58, v58, v21
    v_mul_f32 v59, v59, v21
    v_mfma_f32_16x16x32_bf16 v[116:119], a[24:27], a[204:207], 0
    v_mul_f32 v60, v60, v21
    v_mul_f32 v61, v61, v21
    v_mfma_f32_16x16x32_bf16 v[116:119], a[28:31], a[208:211], v[116:119]
    v_mul_f32 v62, v62, v21
    v_mul_f32 v63, v63, v21
    v_mfma_f32_16x16x32_bf16 v[116:119], a[32:35], a[212:215], v[116:119]
    v_cvt_pk_bf16_f32 v45, v58, v59
    v_cvt_pk_bf16_f32 v46, v60, v61
    v_mfma_f32_16x16x32_bf16 v[116:119], a[36:39], a[216:219], v[116:119]
    v_cvt_pk_bf16_f32 v47, v62, v63
    v_mul_f32 v84, v84, v23
    v_mfma_f32_16x16x32_bf16 v[116:119], a[40:43], a[220:223], v[116:119]
    v_mul_f32 v85, v85, v23
    v_mul_f32 v86, v86, v23
    v_mfma_f32_16x16x32_bf16 v[116:119], a[44:47], a[224:227], v[116:119]
    v_mul_f32 v87, v87, v23
    v_cvt_pk_bf16_f32 v58, v84, v85
    v_mfma_f32_16x16x32_bf16 v[120:123], a[48:51], a[204:207], 0
    s_mov_b32 s10, s19
    v_cvt_pk_bf16_f32 v59, v86, v87
    v_mfma_f32_16x16x32_bf16 v[120:123], a[52:55], a[208:211], v[120:123]
    v_mul_f32 v88, v88, v23
    v_mul_f32 v89, v89, v23
    v_mfma_f32_16x16x32_bf16 v[120:123], a[56:59], a[212:215], v[120:123]
    v_mul_f32 v90, v90, v23
    v_mul_f32 v91, v91, v23
    v_mfma_f32_16x16x32_bf16 v[120:123], a[60:63], a[216:219], v[120:123]
    v_cvt_pk_bf16_f32 v60, v88, v89
    v_cvt_pk_bf16_f32 v61, v90, v91
    v_mfma_f32_16x16x32_bf16 v[120:123], a[64:67], a[220:223], v[120:123]
    v_mul_f32 v92, v92, v23
    v_mul_f32 v93, v93, v23
    v_mfma_f32_16x16x32_bf16 v[120:123], a[68:71], a[224:227], v[120:123]
    v_mul_f32 v94, v94, v23
    v_mul_f32 v95, v95, v23
    v_mfma_f32_16x16x32_bf16 v[124:127], a[72:75], a[204:207], 0
    v_cvt_pk_bf16_f32 v62, v92, v93
    v_cvt_pk_bf16_f32 v63, v94, v95
    v_mfma_f32_16x16x32_bf16 v[124:127], a[76:79], a[208:211], v[124:127]
    v_cvt_pk_bf16_f32 v208, v96, v97
    v_cvt_pk_bf16_f32 v209, v98, v99
    v_mfma_f32_16x16x32_bf16 v[124:127], a[80:83], a[212:215], v[124:127]
    v_cvt_pk_bf16_f32 v210, v100, v101
    v_cvt_pk_bf16_f32 v211, v102, v103
    v_mfma_f32_16x16x32_bf16 v[124:127], a[84:87], a[216:219], v[124:127]
    v_cvt_pk_bf16_f32 v212, v104, v105
    v_cvt_pk_bf16_f32 v213, v106, v107
    v_mfma_f32_16x16x32_bf16 v[124:127], a[88:91], a[220:223], v[124:127]
    v_cvt_pk_bf16_f32 v214, v108, v109
    v_cvt_pk_bf16_f32 v215, v110, v111
    v_mfma_f32_16x16x32_bf16 v[124:127], a[92:95], a[224:227], v[124:127]
    v_cvt_pk_bf16_f32 v216, v112, v113
    v_cvt_pk_bf16_f32 v217, v114, v115
    v_mfma_f32_16x16x32_bf16 v[64:67], v[32:35], v[128:131], 0
    v_cvt_pk_bf16_f32 v218, v116, v117
    v_cvt_pk_bf16_f32 v219, v118, v119
    v_mfma_f32_16x16x32_bf16 v[64:67], v[36:39], v[132:135], v[64:67]
    v_cvt_pk_bf16_f32 v220, v120, v121
    v_cvt_pk_bf16_f32 v221, v122, v123
    v_mfma_f32_16x16x32_bf16 v[68:71], v[32:35], v[136:139], 0
    v_cvt_pk_bf16_f32 v222, v124, v125
    v_cvt_pk_bf16_f32 v223, v126, v127
    v_mfma_f32_16x16x32_bf16 v[68:71], v[36:39], v[140:143], v[68:71]
    s_add_u32 s30, s16, 7471104
    v_mfma_f32_16x16x32_bf16 v[72:75], v[32:35], v[144:147], 0
    buffer_load_dwordx4 a[0:3], v9, s[8:11], s24 offen offset:0 nt
    v_mfma_f32_16x16x32_bf16 v[72:75], v[36:39], v[148:151], v[72:75]
    buffer_load_dwordx4 a[4:7], v10, s[8:11], s24 offen offset:0 nt
    v_mfma_f32_16x16x32_bf16 v[76:79], v[32:35], v[152:155], 0
    v_cvt_pk_bf16_f32 v224, v64, v68
    v_cvt_pk_bf16_f32 v226, v65, v69
    v_mfma_f32_16x16x32_bf16 v[76:79], v[36:39], v[156:159], v[76:79]
    v_cvt_pk_bf16_f32 v228, v66, v70
    v_cvt_pk_bf16_f32 v230, v67, v71
    v_mfma_f32_16x16x32_bf16 v[80:83], v[40:43], v[128:131], 0
    v_mfma_f32_16x16x32_bf16 v[80:83], v[44:47], v[132:135], v[80:83]
    v_mfma_f32_16x16x32_bf16 v[84:87], v[40:43], v[136:139], 0
    v_cvt_pk_bf16_f32 v225, v72, v76
    v_cvt_pk_bf16_f32 v227, v73, v77
    v_mfma_f32_16x16x32_bf16 v[84:87], v[44:47], v[140:143], v[84:87]
    v_cvt_pk_bf16_f32 v229, v74, v78
    v_cvt_pk_bf16_f32 v231, v75, v79
    v_mfma_f32_16x16x32_bf16 v[88:91], v[40:43], v[144:147], 0
    v_mfma_f32_16x16x32_bf16 v[88:91], v[44:47], v[148:151], v[88:91]
    v_mfma_f32_16x16x32_bf16 v[92:95], v[40:43], v[152:155], 0
    v_cvt_pk_bf16_f32 v232, v80, v84
    v_cvt_pk_bf16_f32 v234, v81, v85
    v_mfma_f32_16x16x32_bf16 v[92:95], v[44:47], v[156:159], v[92:95]
    v_cvt_pk_bf16_f32 v236, v82, v86
    v_cvt_pk_bf16_f32 v238, v83, v87
    v_mfma_f32_16x16x32_bf16 v[96:99], v[48:51], v[128:131], 0
    v_mfma_f32_16x16x32_bf16 v[96:99], v[52:55], v[132:135], v[96:99]
    v_mfma_f32_16x16x32_bf16 v[100:103], v[48:51], v[136:139], 0
    v_cvt_pk_bf16_f32 v233, v88, v92
    v_cvt_pk_bf16_f32 v235, v89, v93
    v_mfma_f32_16x16x32_bf16 v[100:103], v[52:55], v[140:143], v[100:103]
    v_cvt_pk_bf16_f32 v237, v90, v94
    v_cvt_pk_bf16_f32 v239, v91, v95
    v_mfma_f32_16x16x32_bf16 v[104:107], v[48:51], v[144:147], 0
    v_mfma_f32_16x16x32_bf16 v[104:107], v[52:55], v[148:151], v[104:107]
    v_mfma_f32_16x16x32_bf16 v[108:111], v[48:51], v[152:155], 0
    v_cvt_pk_bf16_f32 v240, v96, v100
    v_cvt_pk_bf16_f32 v242, v97, v101
    v_mfma_f32_16x16x32_bf16 v[108:111], v[52:55], v[156:159], v[108:111]
    v_cvt_pk_bf16_f32 v244, v98, v102
    v_cvt_pk_bf16_f32 v246, v99, v103
    v_mfma_f32_16x16x32_bf16 v[112:115], v[56:59], v[128:131], 0
    v_mfma_f32_16x16x32_bf16 v[112:115], v[60:63], v[132:135], v[112:115]
    v_mfma_f32_16x16x32_bf16 v[116:119], v[56:59], v[136:139], 0
    v_cvt_pk_bf16_f32 v241, v104, v108
    v_cvt_pk_bf16_f32 v243, v105, v109
    v_mfma_f32_16x16x32_bf16 v[116:119], v[60:63], v[140:143], v[116:119]
    v_cvt_pk_bf16_f32 v245, v106, v110
    v_cvt_pk_bf16_f32 v247, v107, v111
    v_mfma_f32_16x16x32_bf16 v[120:123], v[56:59], v[144:147], 0
    v_mfma_f32_16x16x32_bf16 v[120:123], v[60:63], v[148:151], v[120:123]
    v_mfma_f32_16x16x32_bf16 v[124:127], v[56:59], v[152:155], 0
    v_cvt_pk_bf16_f32 v248, v112, v116
    v_cvt_pk_bf16_f32 v250, v113, v117
    v_mfma_f32_16x16x32_bf16 v[124:127], v[60:63], v[156:159], v[124:127]
    v_cvt_pk_bf16_f32 v252, v114, v118
    v_cvt_pk_bf16_f32 v254, v115, v119
    v_mfma_f32_16x16x32_bf16 v[64:67], v[32:35], v[160:163], 0
    v_mfma_f32_16x16x32_bf16 v[64:67], v[36:39], v[164:167], v[64:67]
    v_mfma_f32_16x16x32_bf16 v[68:71], v[32:35], v[168:171], 0
    v_cvt_pk_bf16_f32 v249, v120, v124
    v_cvt_pk_bf16_f32 v251, v121, v125
    v_mfma_f32_16x16x32_bf16 v[68:71], v[36:39], v[172:175], v[68:71]
    v_cvt_pk_bf16_f32 v253, v122, v126
    v_cvt_pk_bf16_f32 v255, v123, v127
    v_mfma_f32_16x16x32_bf16 v[72:75], v[32:35], v[176:179], 0
    v_mfma_f32_16x16x32_bf16 v[72:75], v[36:39], v[180:183], v[72:75]
    v_mfma_f32_16x16x32_bf16 v[76:79], v[32:35], v[184:187], 0
    v_cvt_pk_bf16_f32 v128, v64, v68
    v_cvt_pk_bf16_f32 v130, v65, v69
    v_mfma_f32_16x16x32_bf16 v[76:79], v[36:39], v[188:191], v[76:79]
    v_cvt_pk_bf16_f32 v132, v66, v70
    v_cvt_pk_bf16_f32 v134, v67, v71
    v_mfma_f32_16x16x32_bf16 v[80:83], v[40:43], v[160:163], 0
    v_mfma_f32_16x16x32_bf16 v[80:83], v[44:47], v[164:167], v[80:83]
    v_mfma_f32_16x16x32_bf16 v[84:87], v[40:43], v[168:171], 0
    v_cvt_pk_bf16_f32 v129, v72, v76
    v_cvt_pk_bf16_f32 v131, v73, v77
    v_mfma_f32_16x16x32_bf16 v[84:87], v[44:47], v[172:175], v[84:87]
    v_cvt_pk_bf16_f32 v133, v74, v78
    v_cvt_pk_bf16_f32 v135, v75, v79
    v_mfma_f32_16x16x32_bf16 v[88:91], v[40:43], v[176:179], 0
    v_mfma_f32_16x16x32_bf16 v[88:91], v[44:47], v[180:183], v[88:91]
    v_mfma_f32_16x16x32_bf16 v[92:95], v[40:43], v[184:187], 0
    v_cvt_pk_bf16_f32 v136, v80, v84
    v_cvt_pk_bf16_f32 v138, v81, v85
    v_mfma_f32_16x16x32_bf16 v[92:95], v[44:47], v[188:191], v[92:95]
    v_cvt_pk_bf16_f32 v140, v82, v86
    v_cvt_pk_bf16_f32 v142, v83, v87
    v_mfma_f32_16x16x32_bf16 v[96:99], v[48:51], v[160:163], 0
    s_waitcnt vmcnt(6)
    ds_write_b64 v4, a[120:121] offset:0
    v_mfma_f32_16x16x32_bf16 v[96:99], v[52:55], v[164:167], v[96:99]
    ds_write_b64 v4, a[122:123] offset:1024
    v_mfma_f32_16x16x32_bf16 v[100:103], v[48:51], v[168:171], 0
    ds_write_b64 v4, a[124:125] offset:512
    v_mfma_f32_16x16x32_bf16 v[100:103], v[52:55], v[172:175], v[100:103]
    ds_write_b64 v4, a[126:127] offset:1536
    v_mfma_f32_16x16x32_bf16 v[104:107], v[48:51], v[176:179], 0
    ds_read2_b64 a[120:123], v5 offset0:0 offset1:128
    v_cvt_pk_bf16_f32 v137, v88, v92
    v_mfma_f32_16x16x32_bf16 v[104:107], v[52:55], v[180:183], v[104:107]
    ds_read2_b64 a[124:127], v6 offset0:0 offset1:128
    v_cvt_pk_bf16_f32 v139, v89, v93
    v_mfma_f32_16x16x32_bf16 v[108:111], v[48:51], v[184:187], 0
    v_cvt_pk_bf16_f32 v141, v90, v94
    v_cvt_pk_bf16_f32 v143, v91, v95
    v_mfma_f32_16x16x32_bf16 v[108:111], v[52:55], v[188:191], v[108:111]
    v_cvt_pk_bf16_f32 v144, v96, v100
    v_cvt_pk_bf16_f32 v146, v97, v101
    v_mfma_f32_16x16x32_bf16 v[112:115], v[56:59], v[160:163], 0
    v_cvt_pk_bf16_f32 v148, v98, v102
    v_cvt_pk_bf16_f32 v150, v99, v103
    v_mfma_f32_16x16x32_bf16 v[112:115], v[60:63], v[164:167], v[112:115]
    v_mfma_f32_16x16x32_bf16 v[116:119], v[56:59], v[168:171], 0
    v_cvt_pk_bf16_f32 v145, v104, v108
    v_cvt_pk_bf16_f32 v147, v105, v109
    v_mfma_f32_16x16x32_bf16 v[116:119], v[60:63], v[172:175], v[116:119]
    v_cvt_pk_bf16_f32 v149, v106, v110
    v_cvt_pk_bf16_f32 v151, v107, v111
    v_mfma_f32_16x16x32_bf16 v[120:123], v[56:59], v[176:179], 0
    buffer_load_dwordx4 a[8:11], v9, s[8:11], s24 offen offset:128 nt
    v_mfma_f32_16x16x32_bf16 v[120:123], v[60:63], v[180:183], v[120:123]
    buffer_load_dwordx4 a[12:15], v10, s[8:11], s24 offen offset:128 nt
    v_mfma_f32_16x16x32_bf16 v[124:127], v[56:59], v[184:187], 0
    v_cvt_pk_bf16_f32 v152, v112, v116
    v_cvt_pk_bf16_f32 v154, v113, v117
    v_mfma_f32_16x16x32_bf16 v[124:127], v[60:63], v[188:191], v[124:127]
    s_waitcnt vmcnt(23)
    ds_write_b64 v4, a[128:129] offset:0
    v_mfma_f32_16x16x32_bf16 v[64:67], v[32:35], v[192:195], 0
    ds_write_b64 v4, a[130:131] offset:1024
    v_mfma_f32_16x16x32_bf16 v[64:67], v[36:39], v[196:199], v[64:67]
    ds_write_b64 v4, a[132:133] offset:512
    v_mfma_f32_16x16x32_bf16 v[68:71], v[32:35], v[200:203], 0
    ds_write_b64 v4, a[134:135] offset:1536
    v_mfma_f32_16x16x32_bf16 v[68:71], v[36:39], v[204:207], v[68:71]
    ds_read2_b64 a[128:131], v5 offset0:0 offset1:128
    v_cvt_pk_bf16_f32 v156, v114, v118
    v_mfma_f32_16x16x32_bf16 v[72:75], v[32:35], v[208:211], 0
    ds_read2_b64 a[132:135], v6 offset0:0 offset1:128
    v_cvt_pk_bf16_f32 v158, v115, v119
    v_mfma_f32_16x16x32_bf16 v[72:75], v[36:39], v[212:215], v[72:75]
    v_cvt_pk_bf16_f32 v153, v120, v124
    v_cvt_pk_bf16_f32 v155, v121, v125
    v_mfma_f32_16x16x32_bf16 v[76:79], v[32:35], v[216:219], 0
    ds_read_b128 a[228:231], v1 offset:0
    v_cvt_pk_bf16_f32 v157, v122, v126
    v_mfma_f32_16x16x32_bf16 v[76:79], v[36:39], v[220:223], v[76:79]
    v_cvt_pk_bf16_f32 v159, v123, v127
    v_cvt_pk_bf16_f32 v160, v64, v68
    v_mfma_f32_16x16x32_bf16 v[80:83], v[40:43], v[192:195], 0
    ds_read_b128 a[232:235], v1 offset:1024
    v_cvt_pk_bf16_f32 v162, v65, v69
    v_mfma_f32_16x16x32_bf16 v[80:83], v[44:47], v[196:199], v[80:83]
    v_cvt_pk_bf16_f32 v164, v66, v70
    v_cvt_pk_bf16_f32 v166, v67, v71
    v_mfma_f32_16x16x32_bf16 v[84:87], v[40:43], v[200:203], 0
    ds_read_b128 a[236:239], v1 offset:2048
    v_cvt_pk_bf16_f32 v161, v72, v76
    v_mfma_f32_16x16x32_bf16 v[84:87], v[44:47], v[204:207], v[84:87]
    v_cvt_pk_bf16_f32 v163, v73, v77
    v_cvt_pk_bf16_f32 v165, v74, v78
    v_mfma_f32_16x16x32_bf16 v[88:91], v[40:43], v[208:211], 0
    ds_read_b128 a[240:243], v1 offset:3072
    v_cvt_pk_bf16_f32 v167, v75, v79
    v_mfma_f32_16x16x32_bf16 v[88:91], v[44:47], v[212:215], v[88:91]
    v_mfma_f32_16x16x32_bf16 v[92:95], v[40:43], v[216:219], 0
    buffer_store_dwordx2 v[128:129], v11, s[12:15], s32 offen offset:128 sc1
    v_mfma_f32_16x16x32_bf16 v[92:95], v[44:47], v[220:223], v[92:95]
    ds_read_b128 a[244:247], v1 offset:4096
    v_cvt_pk_bf16_f32 v168, v80, v84
    v_mfma_f32_16x16x32_bf16 v[96:99], v[48:51], v[192:195], 0
    ds_read_b128 a[248:251], v1 offset:5120
    v_cvt_pk_bf16_f32 v170, v81, v85
    v_mfma_f32_16x16x32_bf16 v[96:99], v[52:55], v[196:199], v[96:99]
    s_waitcnt vmcnt(20)
    ds_write_b64 v4, a[136:137] offset:0
    v_mfma_f32_16x16x32_bf16 v[100:103], v[48:51], v[200:203], 0
    ds_read_b128 a[192:195], v1 offset:6144
    v_cvt_pk_bf16_f32 v172, v82, v86
    v_mfma_f32_16x16x32_bf16 v[100:103], v[52:55], v[204:207], v[100:103]
    ds_write_b64 v4, a[138:139] offset:1024
    v_mfma_f32_16x16x32_bf16 v[104:107], v[48:51], v[208:211], 0
    ds_read_b128 a[196:199], v1 offset:7168
    v_cvt_pk_bf16_f32 v174, v83, v87
    v_mfma_f32_16x16x32_bf16 v[104:107], v[52:55], v[212:215], v[104:107]
    ds_write_b64 v4, a[140:141] offset:512
    v_mfma_f32_16x16x32_bf16 v[108:111], v[48:51], v[216:219], 0
    ds_read_b128 a[200:203], v1 offset:8192
    v_cvt_pk_bf16_f32 v176, v96, v100
    v_mfma_f32_16x16x32_bf16 v[108:111], v[52:55], v[220:223], v[108:111]
    ds_write_b64 v4, a[142:143] offset:1536
    v_mfma_f32_16x16x32_bf16 v[112:115], v[56:59], v[192:195], 0
    buffer_store_dwordx2 v[130:131], v11, s[12:15], s32 offen offset:512 sc1
    v_mfma_f32_16x16x32_bf16 v[112:115], v[60:63], v[196:199], v[112:115]
    ds_read_b128 a[204:207], v1 offset:9216
    v_cvt_pk_bf16_f32 v178, v97, v101
    v_mfma_f32_16x16x32_bf16 v[116:119], v[56:59], v[200:203], 0
    ds_read_b128 a[208:211], v1 offset:10240
    v_cvt_pk_bf16_f32 v180, v98, v102
    v_mfma_f32_16x16x32_bf16 v[116:119], v[60:63], v[204:207], v[116:119]
    ds_read2_b64 a[136:139], v5 offset0:0 offset1:128
    v_cvt_pk_bf16_f32 v182, v99, v103
    v_mfma_f32_16x16x32_bf16 v[120:123], v[56:59], v[208:211], 0
    ds_read_b128 a[212:215], v1 offset:11264
    v_cvt_pk_bf16_f32 v177, v104, v108
    v_mfma_f32_16x16x32_bf16 v[120:123], v[60:63], v[212:215], v[120:123]
    ds_read2_b64 a[140:143], v6 offset0:0 offset1:128
    v_cvt_pk_bf16_f32 v179, v105, v109
    v_mfma_f32_16x16x32_bf16 v[124:127], v[56:59], v[216:219], 0
    ds_read_b128 a[216:219], v1 offset:12288
    v_cvt_pk_bf16_f32 v184, v112, v116
    v_mfma_f32_16x16x32_bf16 v[124:127], v[60:63], v[220:223], v[124:127]
    v_cvt_pk_bf16_f32 v186, v113, v117
    s_waitcnt lgkmcnt(11)
    v_mfma_f32_16x16x32_bf16 v[96:99], a[228:231], a[96:99], 0
    ds_read_b128 a[220:223], v1 offset:13312
    v_cvt_pk_bf16_f32 v188, v114, v118
    v_mfma_f32_16x16x32_bf16 v[96:99], a[232:235], a[100:103], v[96:99]
    v_cvt_pk_bf16_f32 v190, v115, v119
    v_cvt_pk_bf16_f32 v181, v106, v110
    v_mfma_f32_16x16x32_bf16 v[96:99], a[236:239], a[104:107], v[96:99]
    ds_read_b128 a[224:227], v1 offset:14336
    v_cvt_pk_bf16_f32 v183, v107, v111
    v_mfma_f32_16x16x32_bf16 v[96:99], a[240:243], a[108:111], v[96:99]
    buffer_store_dwordx2 v[132:133], v11, s[12:15], s32 offen offset:896 sc1
    v_mfma_f32_16x16x32_bf16 v[96:99], a[244:247], a[112:115], v[96:99]
    s_waitcnt vmcnt(9)
    ds_write_b64 v4, a[144:145] offset:0
    v_mfma_f32_16x16x32_bf16 v[96:99], a[248:251], a[116:119], v[96:99]
    ds_write_b64 v4, a[146:147] offset:1024
    v_mfma_f32_16x16x32_bf16 v[100:103], a[228:231], a[120:123], 0
    ds_write_b64 v4, a[148:149] offset:512
    v_mfma_f32_16x16x32_bf16 v[100:103], a[232:235], a[124:127], v[100:103]
    ds_read_b128 a[228:231], v1 offset:15360
    v_cvt_pk_bf16_f32 v185, v120, v124
    v_mfma_f32_16x16x32_bf16 v[100:103], a[236:239], a[128:131], v[100:103]
    ds_read_b128 a[232:235], v1 offset:16384
    v_cvt_pk_bf16_f32 v192, v96, v97
    v_mfma_f32_16x16x32_bf16 v[100:103], a[240:243], a[132:135], v[100:103]
    ds_read_b128 a[236:239], v1 offset:17408
    s_waitcnt lgkmcnt(10)
    v_mfma_f32_16x16x32_bf16 v[100:103], a[244:247], a[136:139], v[100:103]
    ds_read_b128 a[240:243], v1 offset:18432
    s_waitcnt lgkmcnt(10)
    v_mfma_f32_16x16x32_bf16 v[100:103], a[248:251], a[140:143], v[100:103]
    ds_write_b64 v4, a[150:151] offset:1536
    v_mfma_f32_16x16x32_bf16 v[112:115], a[192:195], a[96:99], 0
    ds_read_b128 a[244:247], v1 offset:19456
    v_cvt_pk_bf16_f32 v193, v98, v99
    v_mfma_f32_16x16x32_bf16 v[112:115], a[196:199], a[100:103], v[112:115]
    buffer_store_dwordx2 v[134:135], v11, s[12:15], s32 offen offset:1280 sc1
    v_mfma_f32_16x16x32_bf16 v[112:115], a[200:203], a[104:107], v[112:115]
    ds_read_b128 a[248:251], v1 offset:20480
    v_cvt_pk_bf16_f32 v196, v100, v101
    v_mfma_f32_16x16x32_bf16 v[112:115], a[204:207], a[108:111], v[112:115]
    ds_read2_b64 a[144:147], v5 offset0:0 offset1:128
    v_cvt_pk_bf16_f32 v197, v102, v103
    v_mfma_f32_16x16x32_bf16 v[112:115], a[208:211], a[112:115], v[112:115]
    ds_read2_b64 a[148:151], v6 offset0:0 offset1:128
    v_cvt_pk_bf16_f32 v187, v121, v125
    v_mfma_f32_16x16x32_bf16 v[112:115], a[212:215], a[116:119], v[112:115]
    v_cvt_pk_bf16_f32 v189, v122, v126
    v_cvt_pk_bf16_f32 v191, v123, v127
    v_mfma_f32_16x16x32_bf16 v[116:119], a[192:195], a[120:123], 0
    ds_write_b64 v4, a[168:169] offset:0
    v_mfma_f32_16x16x32_bf16 v[116:119], a[196:199], a[124:127], v[116:119]
    ds_read_b128 a[192:195], v1 offset:21504
    v_cvt_pk_bf16_f32 v169, v88, v92
    v_mfma_f32_16x16x32_bf16 v[116:119], a[200:203], a[128:131], v[116:119]
    buffer_load_dwordx4 a[16:19], v9, s[8:11], s24 offen offset:256 nt
    v_cvt_pk_bf16_f32 v194, v112, v113
    v_mfma_f32_16x16x32_bf16 v[116:119], a[204:207], a[132:135], v[116:119]
    buffer_load_dwordx4 a[20:23], v10, s[8:11], s24 offen offset:256 nt
    v_cvt_pk_bf16_f32 v195, v114, v115
    v_mfma_f32_16x16x32_bf16 v[116:119], a[208:211], a[136:139], v[116:119]
    ds_read_b128 a[196:199], v1 offset:22528
    v_cvt_pk_bf16_f32 v171, v89, v93
    v_mfma_f32_16x16x32_bf16 v[116:119], a[212:215], a[140:143], v[116:119]
    ds_read_b128 a[200:203], v1 offset:23552
    s_waitcnt lgkmcnt(9)
    v_mfma_f32_16x16x32_bf16 v[96:99], a[216:219], a[96:99], 0
    ds_read_b128 a[204:207], v1 offset:24576
    v_cvt_pk_bf16_f32 v173, v90, v94
    v_mfma_f32_16x16x32_bf16 v[96:99], a[220:223], a[100:103], v[96:99]
    buffer_store_dwordx2 v[136:137], v11, s[12:15], s34 offen offset:128 sc1
    v_mfma_f32_16x16x32_bf16 v[96:99], a[224:227], a[104:107], v[96:99]
    ds_read_b128 a[208:211], v1 offset:25600
    v_cvt_pk_bf16_f32 v198, v116, v117
    v_mfma_f32_16x16x32_bf16 v[96:99], a[228:231], a[108:111], v[96:99]
    ds_read_b128 a[212:215], v1 offset:26624
    v_cvt_pk_bf16_f32 v199, v118, v119
    v_mfma_f32_16x16x32_bf16 v[96:99], a[232:235], a[112:115], v[96:99]
    ds_write_b64 v4, a[170:171] offset:1024
    v_mfma_f32_16x16x32_bf16 v[96:99], a[236:239], a[116:119], v[96:99]
    ds_write_b64 v4, a[172:173] offset:512
    v_mfma_f32_16x16x32_bf16 v[100:103], a[216:219], a[120:123], 0
    ds_write_b64 v4, a[174:175] offset:1536
    v_mfma_f32_16x16x32_bf16 v[100:103], a[220:223], a[124:127], v[100:103]
    ds_read_b128 a[216:219], v1 offset:27648
    v_cvt_pk_bf16_f32 v175, v91, v95
    v_mfma_f32_16x16x32_bf16 v[100:103], a[224:227], a[128:131], v[100:103]
    ds_read_b128 a[220:223], v1 offset:28672
    v_cvt_pk_bf16_f32 v208, v96, v97
    v_mfma_f32_16x16x32_bf16 v[100:103], a[228:231], a[132:135], v[100:103]
    ds_read_b128 a[224:227], v1 offset:29696
    v_cvt_pk_bf16_f32 v209, v98, v99
    v_mfma_f32_16x16x32_bf16 v[100:103], a[232:235], a[136:139], v[100:103]
    buffer_store_dwordx2 v[138:139], v11, s[12:15], s34 offen offset:512 sc1
    v_mfma_f32_16x16x32_bf16 v[100:103], a[236:239], a[140:143], v[100:103]
    ds_read2_b64 a[168:171], v5 offset0:0 offset1:128
    s_add_u32 s24, s16, 9437184
    v_mfma_f32_16x16x32_bf16 v[112:115], a[240:243], a[96:99], 0
    ds_read2_b64 a[172:175], v6 offset0:0 offset1:128
    s_waitcnt lgkmcnt(11)
    v_mfma_f32_16x16x32_bf16 v[112:115], a[244:247], a[100:103], v[112:115]
    v_mfma_f32_16x16x32_bf16 v[112:115], a[248:251], a[104:107], v[112:115]
    v_cvt_pk_bf16_f32 v212, v100, v101
    v_cvt_pk_bf16_f32 v213, v102, v103
    v_mfma_f32_16x16x32_bf16 v[112:115], a[192:195], a[108:111], v[112:115]
    v_mfma_f32_16x16x32_bf16 v[112:115], a[196:199], a[112:115], v[112:115]
    v_mfma_f32_16x16x32_bf16 v[112:115], a[200:203], a[116:119], v[112:115]
    v_mfma_f32_16x16x32_bf16 v[116:119], a[240:243], a[120:123], 0
    ds_write_b64 v4, a[152:153] offset:0
    v_mfma_f32_16x16x32_bf16 v[116:119], a[244:247], a[124:127], v[116:119]
    ds_write_b64 v4, a[154:155] offset:1024
    v_mfma_f32_16x16x32_bf16 v[116:119], a[248:251], a[128:131], v[116:119]
    ds_write_b64 v4, a[156:157] offset:512
    v_mfma_f32_16x16x32_bf16 v[116:119], a[192:195], a[132:135], v[116:119]
    buffer_store_dwordx2 v[140:141], v11, s[12:15], s34 offen offset:896 sc1
    v_mfma_f32_16x16x32_bf16 v[116:119], a[196:199], a[136:139], v[116:119]
    ds_write_b64 v4, a[158:159] offset:1536
    v_mfma_f32_16x16x32_bf16 v[116:119], a[200:203], a[140:143], v[116:119]
    ds_read2_b64 a[152:155], v5 offset0:0 offset1:128
    s_waitcnt lgkmcnt(7)
    v_mfma_f32_16x16x32_bf16 v[96:99], a[204:207], a[96:99], 0
    ds_read2_b64 a[156:159], v6 offset0:0 offset1:128
    v_cvt_pk_bf16_f32 v210, v112, v113
    v_mfma_f32_16x16x32_bf16 v[96:99], a[208:211], a[100:103], v[96:99]
    v_cvt_pk_bf16_f32 v211, v114, v115
    v_mfma_f32_16x16x32_bf16 v[96:99], a[212:215], a[104:107], v[96:99]
    ds_read_b128 a[228:231], v1 offset:30720
    v_cvt_pk_bf16_f32 v214, v116, v117
    v_mfma_f32_16x16x32_bf16 v[96:99], a[216:219], a[108:111], v[96:99]
    v_cvt_pk_bf16_f32 v215, v118, v119
    v_mfma_f32_16x16x32_bf16 v[96:99], a[220:223], a[112:115], v[96:99]
    ds_read_b128 a[232:235], v1 offset:31744
    v_mfma_f32_16x16x32_bf16 v[96:99], a[224:227], a[116:119], v[96:99]
    v_mfma_f32_16x16x32_bf16 v[100:103], a[204:207], a[120:123], 0
    ds_read_b128 a[236:239], v1 offset:32768
    v_mfma_f32_16x16x32_bf16 v[100:103], a[208:211], a[124:127], v[100:103]
    buffer_store_dwordx2 v[142:143], v11, s[12:15], s34 offen offset:1280 sc1
    v_mfma_f32_16x16x32_bf16 v[100:103], a[212:215], a[128:131], v[100:103]
    ds_read_b128 a[240:243], v1 offset:33792
    v_mfma_f32_16x16x32_bf16 v[100:103], a[216:219], a[132:135], v[100:103]
    v_mfma_f32_16x16x32_bf16 v[100:103], a[220:223], a[136:139], v[100:103]
    ds_read_b128 a[244:247], v1 offset:34816
    v_mfma_f32_16x16x32_bf16 v[100:103], a[224:227], a[140:143], v[100:103]
    v_mfma_f32_16x16x32_bf16 v[32:35], a[96:99], v[192:195], 0
    ds_read_b128 a[248:251], v1 offset:35840
    v_mfma_f32_16x16x32_bf16 v[32:35], a[100:103], v[208:211], v[32:35]
    s_waitcnt vmcnt(13)
    ds_write_b64 v16, a[0:1] offset:0
    v_mfma_f32_16x16x32_bf16 v[36:39], a[120:123], v[192:195], 0
    ds_read_b128 a[192:195], v1 offset:36864
    v_mfma_f32_16x16x32_bf16 v[36:39], a[124:127], v[208:211], v[36:39]
    ds_write_b64 v16, a[2:3] offset:1024
    v_mfma_f32_16x16x32_bf16 v[40:43], a[144:147], v[192:195], 0
    ds_read_b128 a[196:199], v1 offset:37888
    v_mfma_f32_16x16x32_bf16 v[40:43], a[148:151], v[208:211], v[40:43]
    s_waitcnt vmcnt(12)
    ds_write_b64 v16, a[4:5] offset:512
    s_waitcnt lgkmcnt(9)
    v_mfma_f32_16x16x32_bf16 v[44:47], a[168:171], v[192:195], 0
    buffer_store_dwordx2 v[144:145], v11, s[12:15], s36 offen offset:128 sc1
    v_mfma_f32_16x16x32_bf16 v[44:47], a[172:175], v[208:211], v[44:47]
    ds_read_b128 a[200:203], v1 offset:38912
    v_cvt_pk_bf16_f32 v192, v96, v97
    v_mfma_f32_16x16x32_bf16 v[48:51], a[96:99], v[196:199], 0
    ds_read_b128 a[204:207], v1 offset:39936
    v_cvt_pk_bf16_f32 v193, v98, v99
    v_mfma_f32_16x16x32_bf16 v[48:51], a[100:103], v[212:215], v[48:51]
    ds_write_b64 v16, a[6:7] offset:1536
    v_mfma_f32_16x16x32_bf16 v[52:55], a[120:123], v[196:199], 0
    ds_read_b128 a[208:211], v1 offset:40960
    v_mfma_f32_16x16x32_bf16 v[52:55], a[124:127], v[212:215], v[52:55]
    ds_read2_b64 a[0:3], v17 offset0:0 offset1:128
    v_mfma_f32_16x16x32_bf16 v[56:59], a[144:147], v[196:199], 0
    ds_read_b128 a[212:215], v1 offset:41984
    v_mfma_f32_16x16x32_bf16 v[56:59], a[148:151], v[212:215], v[56:59]
    ds_read2_b64 a[4:7], v18 offset0:0 offset1:128
    v_mfma_f32_16x16x32_bf16 v[60:63], a[168:171], v[196:199], 0
    ds_read_b128 a[216:219], v1 offset:43008
    v_cvt_pk_bf16_f32 v196, v100, v101
    v_mfma_f32_16x16x32_bf16 v[60:63], a[172:175], v[212:215], v[60:63]
    ds_write_b64 v4, a[176:177] offset:0
    v_mfma_f32_16x16x32_bf16 v[112:115], a[228:231], a[96:99], 0
    buffer_store_dwordx2 v[146:147], v11, s[12:15], s36 offen offset:512 sc1
    v_mfma_f32_16x16x32_bf16 v[112:115], a[232:235], a[100:103], v[112:115]
    buffer_load_dwordx4 a[24:27], v9, s[8:11], s26 offen offset:0 nt
    s_waitcnt lgkmcnt(10)
    v_mfma_f32_16x16x32_bf16 v[112:115], a[236:239], a[104:107], v[112:115]
    buffer_load_dwordx4 a[28:31], v10, s[8:11], s26 offen offset:0 nt
    v_cvt_pk_bf16_f32 v197, v102, v103
    v_mfma_f32_16x16x32_bf16 v[112:115], a[240:243], a[108:111], v[112:115]
    ds_read_b128 a[220:223], v1 offset:44032
    v_mfma_f32_16x16x32_bf16 v[112:115], a[244:247], a[112:115], v[112:115]
    ds_read_b128 a[224:227], v1 offset:45056
    v_mfma_f32_16x16x32_bf16 v[112:115], a[248:251], a[116:119], v[112:115]
    ds_write_b64 v4, a[178:179] offset:1024
    v_mfma_f32_16x16x32_bf16 v[116:119], a[228:231], a[120:123], 0
    ds_write_b64 v4, a[180:181] offset:512
    v_mfma_f32_16x16x32_bf16 v[116:119], a[232:235], a[124:127], v[116:119]
    ds_read_b128 a[228:231], v1 offset:46080
    v_mfma_f32_16x16x32_bf16 v[116:119], a[236:239], a[128:131], v[116:119]
    ds_read_b128 a[232:235], v1 offset:47104
    v_cvt_pk_bf16_f32 v194, v112, v113
    v_mfma_f32_16x16x32_bf16 v[116:119], a[240:243], a[132:135], v[116:119]
    ds_write_b64 v4, a[182:183] offset:1536
    v_mfma_f32_16x16x32_bf16 v[116:119], a[244:247], a[136:139], v[116:119]
    ds_read2_b64 a[176:179], v5 offset0:0 offset1:128
    v_cvt_pk_bf16_f32 v195, v114, v115
    v_mfma_f32_16x16x32_bf16 v[116:119], a[248:251], a[140:143], v[116:119]
    ds_read2_b64 a[180:183], v6 offset0:0 offset1:128
    v_mfma_f32_16x16x32_bf16 v[96:99], a[192:195], a[96:99], 0
    ds_read_b128 a[236:239], v1 offset:48128
    v_mfma_f32_16x16x32_bf16 v[96:99], a[196:199], a[100:103], v[96:99]
    ds_read_b128 a[240:243], v1 offset:49152
    s_waitcnt lgkmcnt(11)
    v_mfma_f32_16x16x32_bf16 v[96:99], a[200:203], a[104:107], v[96:99]
    buffer_store_dwordx2 v[148:149], v11, s[12:15], s36 offen offset:896 sc1
    v_mfma_f32_16x16x32_bf16 v[96:99], a[204:207], a[108:111], v[96:99]
    ds_read_b128 a[244:247], v1 offset:50176
    v_cvt_pk_bf16_f32 v198, v116, v117
    v_mfma_f32_16x16x32_bf16 v[96:99], a[208:211], a[112:115], v[96:99]
    ds_read_b128 a[248:251], v1 offset:51200
    v_cvt_pk_bf16_f32 v199, v118, v119
    v_mfma_f32_16x16x32_bf16 v[96:99], a[212:215], a[116:119], v[96:99]
    v_mfma_f32_16x16x32_bf16 v[100:103], a[192:195], a[120:123], 0
    v_mfma_f32_16x16x32_bf16 v[100:103], a[196:199], a[124:127], v[100:103]
    ds_read_b128 a[192:195], v1 offset:52224
    v_mfma_f32_16x16x32_bf16 v[100:103], a[200:203], a[128:131], v[100:103]
    ds_read_b128 a[196:199], v1 offset:53248
    v_cvt_pk_bf16_f32 v208, v96, v97
    v_mfma_f32_16x16x32_bf16 v[100:103], a[204:207], a[132:135], v[100:103]
    buffer_store_dwordx2 v[150:151], v11, s[12:15], s36 offen offset:1280 sc1
    v_mfma_f32_16x16x32_bf16 v[100:103], a[208:211], a[136:139], v[100:103]
    ds_read_b128 a[200:203], v1 offset:54272
    v_cvt_pk_bf16_f32 v209, v98, v99
    v_mfma_f32_16x16x32_bf16 v[100:103], a[212:215], a[140:143], v[100:103]
    v_mfma_f32_16x16x32_bf16 v[112:115], a[216:219], a[96:99], 0
    s_waitcnt lgkmcnt(7)
    v_mfma_f32_16x16x32_bf16 v[112:115], a[220:223], a[100:103], v[112:115]
    v_mfma_f32_16x16x32_bf16 v[112:115], a[224:227], a[104:107], v[112:115]
    ds_write_b64 v4, a[160:161] offset:0
    v_mfma_f32_16x16x32_bf16 v[112:115], a[228:231], a[108:111], v[112:115]
    ds_write_b64 v4, a[162:163] offset:1024
    v_mfma_f32_16x16x32_bf16 v[112:115], a[232:235], a[112:115], v[112:115]
    ds_write_b64 v4, a[164:165] offset:512
    s_waitcnt lgkmcnt(7)
    v_mfma_f32_16x16x32_bf16 v[112:115], a[236:239], a[116:119], v[112:115]
    ds_write_b64 v4, a[166:167] offset:1536
    v_mfma_f32_16x16x32_bf16 v[116:119], a[216:219], a[120:123], 0
    ds_read2_b64 a[160:163], v5 offset0:0 offset1:128
    v_cvt_pk_bf16_f32 v212, v100, v101
    v_mfma_f32_16x16x32_bf16 v[116:119], a[220:223], a[124:127], v[116:119]
    ds_read2_b64 a[164:167], v6 offset0:0 offset1:128
    v_cvt_pk_bf16_f32 v213, v102, v103
    v_mfma_f32_16x16x32_bf16 v[116:119], a[224:227], a[128:131], v[116:119]
    buffer_store_dwordx2 v[152:153], v11, s[12:15], s38 offen offset:128 sc1
    v_mfma_f32_16x16x32_bf16 v[116:119], a[228:231], a[132:135], v[116:119]
    v_cvt_pk_bf16_f32 v210, v112, v113
    v_cvt_pk_bf16_f32 v211, v114, v115
    v_mfma_f32_16x16x32_bf16 v[116:119], a[232:235], a[136:139], v[116:119]
    v_mfma_f32_16x16x32_bf16 v[116:119], a[236:239], a[140:143], v[116:119]
    s_waitcnt vmcnt(18)
    ds_write_b64 v16, a[8:9] offset:0
    v_mfma_f32_16x16x32_bf16 v[96:99], a[240:243], a[96:99], 0
    ds_write_b64 v16, a[10:11] offset:1024
    v_mfma_f32_16x16x32_bf16 v[96:99], a[244:247], a[100:103], v[96:99]
    s_waitcnt vmcnt(17)
    ds_write_b64 v16, a[12:13] offset:512
    s_waitcnt lgkmcnt(9)
    v_mfma_f32_16x16x32_bf16 v[96:99], a[248:251], a[104:107], v[96:99]
    ds_read_b128 a[204:207], v1 offset:55296
    v_cvt_pk_bf16_f32 v214, v116, v117
    v_mfma_f32_16x16x32_bf16 v[96:99], a[192:195], a[108:111], v[96:99]
    ds_write_b64 v16, a[14:15] offset:1536
    v_mfma_f32_16x16x32_bf16 v[96:99], a[196:199], a[112:115], v[96:99]
    ds_read_b128 a[208:211], v1 offset:56320
    v_cvt_pk_bf16_f32 v215, v118, v119
    v_mfma_f32_16x16x32_bf16 v[96:99], a[200:203], a[116:119], v[96:99]
    ds_read2_b64 a[8:11], v17 offset0:0 offset1:128
    v_mfma_f32_16x16x32_bf16 v[100:103], a[240:243], a[120:123], 0
    buffer_store_dwordx2 v[154:155], v11, s[12:15], s38 offen offset:512 sc1
    v_mfma_f32_16x16x32_bf16 v[100:103], a[244:247], a[124:127], v[100:103]
    ds_read_b128 a[212:215], v1 offset:57344
    v_mfma_f32_16x16x32_bf16 v[100:103], a[248:251], a[128:131], v[100:103]
    ds_read_b128 a[216:219], v1 offset:58368
    v_mfma_f32_16x16x32_bf16 v[100:103], a[192:195], a[132:135], v[100:103]
    ds_read2_b64 a[12:15], v18 offset0:0 offset1:128
    v_mfma_f32_16x16x32_bf16 v[100:103], a[196:199], a[136:139], v[100:103]
    ds_read_b128 a[220:223], v1 offset:59392
    v_mfma_f32_16x16x32_bf16 v[100:103], a[200:203], a[140:143], v[100:103]
    v_mfma_f32_16x16x32_bf16 v[32:35], a[104:107], v[192:195], v[32:35]
    ds_read_b128 a[224:227], v1 offset:60416
    v_mfma_f32_16x16x32_bf16 v[32:35], a[108:111], v[208:211], v[32:35]
    v_mfma_f32_16x16x32_bf16 v[36:39], a[128:131], v[192:195], v[36:39]
    ds_read_b128 a[228:231], v1 offset:61440
    v_mfma_f32_16x16x32_bf16 v[36:39], a[132:135], v[208:211], v[36:39]
    v_mfma_f32_16x16x32_bf16 v[40:43], a[152:155], v[192:195], v[40:43]
    ds_read_b128 a[232:235], v1 offset:62464
    v_mfma_f32_16x16x32_bf16 v[40:43], a[156:159], v[208:211], v[40:43]
    buffer_store_dwordx2 v[156:157], v11, s[12:15], s38 offen offset:896 sc1
    v_mfma_f32_16x16x32_bf16 v[44:47], a[176:179], v[192:195], v[44:47]
    ds_read_b128 a[236:239], v1 offset:63488
    v_cvt_pk_bf16_f32 v192, v96, v97
    v_mfma_f32_16x16x32_bf16 v[44:47], a[180:183], v[208:211], v[44:47]
    v_cvt_pk_bf16_f32 v193, v98, v99
    v_mfma_f32_16x16x32_bf16 v[48:51], a[104:107], v[196:199], v[48:51]
    buffer_load_dwordx4 a[32:35], v9, s[8:11], s26 offen offset:128 nt
    v_mfma_f32_16x16x32_bf16 v[48:51], a[108:111], v[212:215], v[48:51]
    buffer_load_dwordx4 a[36:39], v10, s[8:11], s26 offen offset:128 nt
    v_mfma_f32_16x16x32_bf16 v[52:55], a[128:131], v[196:199], v[52:55]
    ds_read_b128 a[240:243], v1 offset:64512
    v_mfma_f32_16x16x32_bf16 v[52:55], a[132:135], v[212:215], v[52:55]
    ds_read_b128 a[244:247], v2 offset:0
    v_mfma_f32_16x16x32_bf16 v[56:59], a[152:155], v[196:199], v[56:59]
    ds_read_b128 a[248:251], v2 offset:1024
    v_mfma_f32_16x16x32_bf16 v[56:59], a[156:159], v[212:215], v[56:59]
    ds_write_b64 v4, a[184:185] offset:0
    v_mfma_f32_16x16x32_bf16 v[60:63], a[176:179], v[196:199], v[60:63]
    ds_read_b128 a[192:195], v2 offset:2048
    v_cvt_pk_bf16_f32 v196, v100, v101
    v_mfma_f32_16x16x32_bf16 v[60:63], a[180:183], v[212:215], v[60:63]
    buffer_store_dwordx2 v[158:159], v11, s[12:15], s38 offen offset:1280 sc1
    s_waitcnt lgkmcnt(7)
    v_mfma_f32_16x16x32_bf16 v[112:115], a[204:207], a[96:99], 0
    ds_read_b128 a[196:199], v2 offset:3072
    v_cvt_pk_bf16_f32 v197, v102, v103
    v_mfma_f32_16x16x32_bf16 v[112:115], a[208:211], a[100:103], v[112:115]
    ds_write_b64 v4, a[186:187] offset:1024
    v_mfma_f32_16x16x32_bf16 v[112:115], a[212:215], a[104:107], v[112:115]
    ds_read_b128 a[200:203], v2 offset:4096
    v_mfma_f32_16x16x32_bf16 v[112:115], a[216:219], a[108:111], v[112:115]
    ds_write_b64 v4, a[188:189] offset:512
    v_mfma_f32_16x16x32_bf16 v[112:115], a[220:223], a[112:115], v[112:115]
    ds_write_b64 v4, a[190:191] offset:1536
    v_mfma_f32_16x16x32_bf16 v[112:115], a[224:227], a[116:119], v[112:115]
    ds_read2_b64 a[184:187], v5 offset0:0 offset1:128
    v_mfma_f32_16x16x32_bf16 v[116:119], a[204:207], a[120:123], 0
    ds_read2_b64 a[188:191], v6 offset0:0 offset1:128
    v_mfma_f32_16x16x32_bf16 v[116:119], a[208:211], a[124:127], v[116:119]
    ds_read_b128 a[204:207], v2 offset:5120
    v_mfma_f32_16x16x32_bf16 v[116:119], a[212:215], a[128:131], v[116:119]
    ds_read_b128 a[208:211], v2 offset:6144
    v_cvt_pk_bf16_f32 v194, v112, v113
    v_mfma_f32_16x16x32_bf16 v[116:119], a[216:219], a[132:135], v[116:119]
    ds_read_b128 a[212:215], v2 offset:7168
    v_cvt_pk_bf16_f32 v195, v114, v115
    v_mfma_f32_16x16x32_bf16 v[116:119], a[220:223], a[136:139], v[116:119]
    buffer_store_dwordx2 v[224:225], v11, s[12:15], s32 offen offset:0 sc1
    v_mfma_f32_16x16x32_bf16 v[116:119], a[224:227], a[140:143], v[116:119]
    ds_read_b128 a[216:219], v1 offset:0
    v_mfma_f32_16x16x32_bf16 v[96:99], a[228:231], a[96:99], 0
    ds_read_b128 a[220:223], v1 offset:1024
    s_waitcnt lgkmcnt(12)
    v_mfma_f32_16x16x32_bf16 v[96:99], a[232:235], a[100:103], v[96:99]
    v_mfma_f32_16x16x32_bf16 v[96:99], a[236:239], a[104:107], v[96:99]
    ds_read_b128 a[224:227], v1 offset:2048
    v_cvt_pk_bf16_f32 v198, v116, v117
    v_mfma_f32_16x16x32_bf16 v[96:99], a[240:243], a[108:111], v[96:99]
    v_cvt_pk_bf16_f32 v199, v118, v119
    v_mfma_f32_16x16x32_bf16 v[96:99], a[244:247], a[112:115], v[96:99]
    v_mfma_f32_16x16x32_bf16 v[96:99], a[248:251], a[116:119], v[96:99]
    v_mfma_f32_16x16x32_bf16 v[100:103], a[228:231], a[120:123], 0
    v_mfma_f32_16x16x32_bf16 v[100:103], a[232:235], a[124:127], v[100:103]
    ds_read_b128 a[228:231], v1 offset:3072
    v_mfma_f32_16x16x32_bf16 v[100:103], a[236:239], a[128:131], v[100:103]
    buffer_store_dwordx2 v[226:227], v11, s[12:15], s32 offen offset:384 sc1
    v_mfma_f32_16x16x32_bf16 v[100:103], a[240:243], a[132:135], v[100:103]
    ds_read_b128 a[232:235], v1 offset:4096
    v_cvt_pk_bf16_f32 v208, v96, v97
    v_mfma_f32_16x16x32_bf16 v[100:103], a[244:247], a[136:139], v[100:103]
    ds_read_b128 a[236:239], v1 offset:5120
    v_cvt_pk_bf16_f32 v209, v98, v99
    v_mfma_f32_16x16x32_bf16 v[100:103], a[248:251], a[140:143], v[100:103]
    v_mfma_f32_16x16x32_bf16 v[112:115], a[192:195], a[96:99], 0
    s_waitcnt lgkmcnt(5)
    v_mfma_f32_16x16x32_bf16 v[112:115], a[196:199], a[100:103], v[112:115]
    v_mfma_f32_16x16x32_bf16 v[112:115], a[200:203], a[104:107], v[112:115]
    s_waitcnt vmcnt(19)
    ds_write_b64 v16, a[16:17] offset:0
    v_mfma_f32_16x16x32_bf16 v[112:115], a[204:207], a[108:111], v[112:115]
    ds_write_b64 v16, a[18:19] offset:1024
    v_mfma_f32_16x16x32_bf16 v[112:115], a[208:211], a[112:115], v[112:115]
    s_waitcnt vmcnt(18)
    ds_write_b64 v16, a[20:21] offset:512
    v_mfma_f32_16x16x32_bf16 v[112:115], a[212:215], a[116:119], v[112:115]
    ds_write_b64 v16, a[22:23] offset:1536
    v_mfma_f32_16x16x32_bf16 v[116:119], a[192:195], a[120:123], 0
    ds_read2_b64 a[16:19], v17 offset0:0 offset1:128
    v_cvt_pk_bf16_f32 v212, v100, v101
    v_mfma_f32_16x16x32_bf16 v[116:119], a[196:199], a[124:127], v[116:119]
    buffer_store_dwordx2 v[228:229], v11, s[12:15], s32 offen offset:768 sc1
    v_mfma_f32_16x16x32_bf16 v[116:119], a[200:203], a[128:131], v[116:119]
    ds_read2_b64 a[20:23], v18 offset0:0 offset1:128
    v_cvt_pk_bf16_f32 v210, v112, v113
    v_mfma_f32_16x16x32_bf16 v[116:119], a[204:207], a[132:135], v[116:119]
    v_cvt_pk_bf16_f32 v211, v114, v115
    v_cvt_pk_bf16_f32 v213, v102, v103
    v_mfma_f32_16x16x32_bf16 v[116:119], a[208:211], a[136:139], v[116:119]
    v_mfma_f32_16x16x32_bf16 v[116:119], a[212:215], a[140:143], v[116:119]
    v_mfma_f32_16x16x32_bf16 v[104:107], a[216:219], a[144:147], 0
    s_waitcnt lgkmcnt(6)
    v_mfma_f32_16x16x32_bf16 v[104:107], a[220:223], a[148:151], v[104:107]
    v_mfma_f32_16x16x32_bf16 v[104:107], a[224:227], a[152:155], v[104:107]
    ds_read_b128 a[240:243], v1 offset:6144
    v_cvt_pk_bf16_f32 v214, v116, v117
    v_mfma_f32_16x16x32_bf16 v[104:107], a[228:231], a[156:159], v[104:107]
    v_cvt_pk_bf16_f32 v215, v118, v119
    v_mfma_f32_16x16x32_bf16 v[104:107], a[232:235], a[160:163], v[104:107]
    ds_read_b128 a[244:247], v1 offset:7168
    v_mfma_f32_16x16x32_bf16 v[104:107], a[236:239], a[164:167], v[104:107]
    buffer_store_dwordx2 v[230:231], v11, s[12:15], s32 offen offset:1152 sc1
    v_mfma_f32_16x16x32_bf16 v[108:111], a[216:219], a[168:171], 0
    ds_read_b128 a[248:251], v1 offset:8192
    v_mfma_f32_16x16x32_bf16 v[108:111], a[220:223], a[172:175], v[108:111]
    v_mfma_f32_16x16x32_bf16 v[108:111], a[224:227], a[176:179], v[108:111]
    ds_read_b128 a[192:195], v1 offset:9216
    v_cvt_pk_bf16_f32 v200, v104, v105
    v_mfma_f32_16x16x32_bf16 v[108:111], a[228:231], a[180:183], v[108:111]
    v_cvt_pk_bf16_f32 v201, v106, v107
    v_mfma_f32_16x16x32_bf16 v[108:111], a[232:235], a[184:187], v[108:111]
    ds_read_b128 a[196:199], v1 offset:10240
    v_mfma_f32_16x16x32_bf16 v[108:111], a[236:239], a[188:191], v[108:111]
    v_mfma_f32_16x16x32_bf16 v[32:35], a[112:115], v[192:195], v[32:35]
    buffer_load_dwordx4 a[40:43], v9, s[8:11], s26 offen offset:256 nt
    v_mfma_f32_16x16x32_bf16 v[32:35], a[116:119], v[208:211], v[32:35]
    buffer_load_dwordx4 a[44:47], v10, s[8:11], s26 offen offset:256 nt
    s_add_u32 s26, s16, 9830400
    v_mfma_f32_16x16x32_bf16 v[36:39], a[136:139], v[192:195], v[36:39]
    ds_read_b128 a[200:203], v1 offset:11264
    v_cvt_pk_bf16_f32 v204, v108, v109
    v_mfma_f32_16x16x32_bf16 v[36:39], a[140:143], v[208:211], v[36:39]
    ds_read_b128 a[204:207], v1 offset:12288
    v_cvt_pk_bf16_f32 v205, v110, v111
    v_mfma_f32_16x16x32_bf16 v[40:43], a[160:163], v[192:195], v[40:43]
    buffer_store_dwordx2 v[232:233], v11, s[12:15], s34 offen offset:0 sc1
    v_mfma_f32_16x16x32_bf16 v[40:43], a[164:167], v[208:211], v[40:43]
    ds_read_b128 a[208:211], v1 offset:13312
    v_max3_f32 v12, v32, v33, v34
    v_mfma_f32_16x16x32_bf16 v[44:47], a[184:187], v[192:195], v[44:47]
    ds_read_b128 a[212:215], v1 offset:14336
    v_max3_f32 v12, v12, v35, v36
    v_mfma_f32_16x16x32_bf16 v[44:47], a[188:191], v[208:211], v[44:47]
    v_max3_f32 v12, v12, v37, v38
    v_mfma_f32_16x16x32_bf16 v[48:51], a[112:115], v[196:199], v[48:51]
    ds_read_b128 a[216:219], v1 offset:15360
    v_max3_f32 v12, v12, v39, v40
    v_mfma_f32_16x16x32_bf16 v[48:51], a[116:119], v[212:215], v[48:51]
    v_max3_f32 v12, v12, v41, v42
    v_mfma_f32_16x16x32_bf16 v[52:55], a[136:139], v[196:199], v[52:55]
    ds_read_b128 a[220:223], v1 offset:16384
    v_max3_f32 v12, v12, v43, v44
    v_mfma_f32_16x16x32_bf16 v[52:55], a[140:143], v[212:215], v[52:55]
    v_max3_f32 v12, v12, v45, v46
    v_max_f32 v12, v12, v47
    v_mfma_f32_16x16x32_bf16 v[56:59], a[160:163], v[196:199], v[56:59]
    ds_read_b128 a[224:227], v1 offset:17408
    v_max3_f32 v13, v48, v49, v50
    v_mfma_f32_16x16x32_bf16 v[56:59], a[164:167], v[212:215], v[56:59]
    v_mfma_f32_16x16x32_bf16 v[60:63], a[184:187], v[196:199], v[60:63]
    buffer_store_dwordx2 v[234:235], v11, s[12:15], s34 offen offset:384 sc1
    v_mfma_f32_16x16x32_bf16 v[60:63], a[188:191], v[212:215], v[60:63]
    ds_read_b128 a[228:231], v1 offset:18432
    s_waitcnt lgkmcnt(7)
    v_mfma_f32_16x16x32_bf16 v[120:123], a[240:243], a[144:147], 0
    ds_read_b128 a[232:235], v1 offset:19456
    v_max3_f32 v13, v13, v51, v52
    v_mfma_f32_16x16x32_bf16 v[120:123], a[244:247], a[148:151], v[120:123]
    v_max3_f32 v13, v13, v53, v54
    v_max3_f32 v13, v13, v55, v56
    v_mfma_f32_16x16x32_bf16 v[120:123], a[248:251], a[152:155], v[120:123]
    ds_read_b128 a[236:239], v1 offset:20480
    v_max3_f32 v13, v13, v57, v58
    v_mfma_f32_16x16x32_bf16 v[120:123], a[192:195], a[156:159], v[120:123]
    v_max3_f32 v13, v13, v59, v60
    v_max3_f32 v13, v13, v61, v62
    v_mfma_f32_16x16x32_bf16 v[120:123], a[196:199], a[160:163], v[120:123]
    v_max_f32 v13, v13, v63
    v_mfma_f32_16x16x32_bf16 v[120:123], a[200:203], a[164:167], v[120:123]
    v_mfma_f32_16x16x32_bf16 v[124:127], a[240:243], a[168:171], 0
    v_permlane16_swap_b32 v12, v13
    v_max_f32 v12, v12, v13
    v_mfma_f32_16x16x32_bf16 v[124:127], a[244:247], a[172:175], v[124:127]
    ds_read_b128 a[240:243], v1 offset:21504
    v_mov_b32 v13, v12
    v_mfma_f32_16x16x32_bf16 v[124:127], a[248:251], a[176:179], v[124:127]
    ds_read_b128 a[244:247], v1 offset:22528
    v_cvt_pk_bf16_f32 v202, v120, v121
    v_mfma_f32_16x16x32_bf16 v[124:127], a[192:195], a[180:183], v[124:127]
    buffer_store_dwordx2 v[236:237], v11, s[12:15], s34 offen offset:768 sc1
    v_mfma_f32_16x16x32_bf16 v[124:127], a[196:199], a[184:187], v[124:127]
    ds_read_b128 a[248:251], v1 offset:23552
    v_cvt_pk_bf16_f32 v203, v122, v123
    v_mfma_f32_16x16x32_bf16 v[124:127], a[200:203], a[188:191], v[124:127]
    ds_read_b128 a[192:195], v1 offset:24576
    s_waitcnt lgkmcnt(7)
    v_mfma_f32_16x16x32_bf16 v[104:107], a[204:207], a[144:147], 0
    ds_read_b128 a[196:199], v1 offset:25600
    v_permlane32_swap_b32 v12, v13
    v_mfma_f32_16x16x32_bf16 v[104:107], a[208:211], a[148:151], v[104:107]
    v_max_f32 v12, v12, v13
    v_mov_b32 v13, v12
    v_mfma_f32_16x16x32_bf16 v[104:107], a[212:215], a[152:155], v[104:107]
    ds_read_b128 a[200:203], v1 offset:26624
    v_cvt_pk_bf16_f32 v206, v124, v125
    v_mfma_f32_16x16x32_bf16 v[104:107], a[216:219], a[156:159], v[104:107]
    v_cvt_pk_bf16_f32 v207, v126, v127
    v_permlane16_swap_b32 v12, v13
    v_mfma_f32_16x16x32_bf16 v[104:107], a[220:223], a[160:163], v[104:107]
    v_sub_f32 v32, v32, v12
    v_sub_f32 v33, v33, v12
    v_mfma_f32_16x16x32_bf16 v[104:107], a[224:227], a[164:167], v[104:107]
    v_sub_f32 v48, v48, v13
    v_sub_f32 v49, v49, v13
    v_mfma_f32_16x16x32_bf16 v[108:111], a[204:207], a[168:171], 0
    v_exp_f32 v32, v32
    v_mfma_f32_16x16x32_bf16 v[108:111], a[208:211], a[172:175], v[108:111]
    buffer_store_dwordx2 v[238:239], v11, s[12:15], s34 offen offset:1152 sc1
    v_mfma_f32_16x16x32_bf16 v[108:111], a[212:215], a[176:179], v[108:111]
    ds_read_b128 a[204:207], v1 offset:27648
    v_cvt_pk_bf16_f32 v216, v104, v105
    v_mfma_f32_16x16x32_bf16 v[108:111], a[216:219], a[180:183], v[108:111]
    ds_read_b128 a[208:211], v1 offset:28672
    v_cvt_pk_bf16_f32 v217, v106, v107
    v_mfma_f32_16x16x32_bf16 v[108:111], a[220:223], a[184:187], v[108:111]
    ds_read_b128 a[212:215], v1 offset:29696
    v_sub_f32 v34, v34, v12
    v_mfma_f32_16x16x32_bf16 v[108:111], a[224:227], a[188:191], v[108:111]
    v_sub_f32 v50, v50, v13
    s_waitcnt lgkmcnt(6)
    v_mfma_f32_16x16x32_bf16 v[120:123], a[228:231], a[144:147], 0
    v_exp_f32 v33, v33
    v_mfma_f32_16x16x32_bf16 v[120:123], a[232:235], a[148:151], v[120:123]
    v_exp_f32 v48, v48
    v_mfma_f32_16x16x32_bf16 v[120:123], a[236:239], a[152:155], v[120:123]
    v_cvt_pk_bf16_f32 v220, v108, v109
    v_cvt_pk_bf16_f32 v221, v110, v111
    v_mfma_f32_16x16x32_bf16 v[120:123], a[240:243], a[156:159], v[120:123]
    v_exp_f32 v49, v49
    v_mfma_f32_16x16x32_bf16 v[120:123], a[244:247], a[160:163], v[120:123]
    v_exp_f32 v34, v34
    v_mfma_f32_16x16x32_bf16 v[120:123], a[248:251], a[164:167], v[120:123]
    v_sub_f32 v35, v35, v12
    v_sub_f32 v51, v51, v13
    v_mfma_f32_16x16x32_bf16 v[124:127], a[228:231], a[168:171], 0
    buffer_store_dwordx2 v[240:241], v11, s[12:15], s36 offen offset:0 sc1
    v_mfma_f32_16x16x32_bf16 v[124:127], a[232:235], a[172:175], v[124:127]
    v_exp_f32 v50, v50
    v_mfma_f32_16x16x32_bf16 v[124:127], a[236:239], a[176:179], v[124:127]
    v_cvt_pk_bf16_f32 v218, v120, v121
    v_cvt_pk_bf16_f32 v219, v122, v123
    v_mfma_f32_16x16x32_bf16 v[124:127], a[240:243], a[180:183], v[124:127]
    v_exp_f32 v35, v35
    v_mfma_f32_16x16x32_bf16 v[124:127], a[244:247], a[184:187], v[124:127]
    v_sub_f32 v36, v36, v12
    v_sub_f32 v52, v52, v13
    v_mfma_f32_16x16x32_bf16 v[124:127], a[248:251], a[188:191], v[124:127]
    v_add_f32 v20, v32, v33
    s_waitcnt lgkmcnt(0)
    v_mfma_f32_16x16x32_bf16 v[104:107], a[192:195], a[144:147], 0
    v_exp_f32 v51, v51
    v_mfma_f32_16x16x32_bf16 v[104:107], a[196:199], a[148:151], v[104:107]
    v_exp_f32 v36, v36
    v_mfma_f32_16x16x32_bf16 v[104:107], a[200:203], a[152:155], v[104:107]
    ds_read_b128 a[216:219], v1 offset:30720
    v_cvt_pk_bf16_f32 v222, v124, v125
    v_mfma_f32_16x16x32_bf16 v[104:107], a[204:207], a[156:159], v[104:107]
    v_cvt_pk_bf16_f32 v223, v126, v127
    v_sub_f32 v37, v37, v12
    v_mfma_f32_16x16x32_bf16 v[104:107], a[208:211], a[160:163], v[104:107]
    buffer_store_dwordx2 v[242:243], v11, s[12:15], s36 offen offset:384 sc1
    v_mfma_f32_16x16x32_bf16 v[104:107], a[212:215], a[164:167], v[104:107]
    buffer_load_dwordx4 a[48:51], v9, s[8:11], s28 offen offset:0 nt
    v_add_f32 v21, v48, v49
    v_mfma_f32_16x16x32_bf16 v[108:111], a[192:195], a[168:171], 0
    buffer_load_dwordx4 a[52:55], v10, s[8:11], s28 offen offset:0 nt
    v_sub_f32 v53, v53, v13
    v_mfma_f32_16x16x32_bf16 v[108:111], a[196:199], a[172:175], v[108:111]
    ds_read_b128 a[220:223], v1 offset:31744
    v_add_f32 v20, v20, v34
    v_mfma_f32_16x16x32_bf16 v[108:111], a[200:203], a[176:179], v[108:111]
    ds_read_b128 a[224:227], v1 offset:32768
    v_sub_f32 v38, v38, v12
    v_mfma_f32_16x16x32_bf16 v[108:111], a[204:207], a[180:183], v[108:111]
    ds_read_b128 a[228:231], v1 offset:33792
    v_add_f32 v21, v21, v50
    v_mfma_f32_16x16x32_bf16 v[108:111], a[208:211], a[184:187], v[108:111]
    ds_read_b128 a[232:235], v1 offset:34816
    v_sub_f32 v54, v54, v13
    v_mfma_f32_16x16x32_bf16 v[108:111], a[212:215], a[188:191], v[108:111]
    v_exp_f32 v52, v52
    v_mfma_f32_16x16x32_bf16 v[64:67], a[96:99], v[200:203], 0
    ds_read_b128 a[236:239], v1 offset:35840
    v_add_f32 v20, v20, v35
    v_mfma_f32_16x16x32_bf16 v[64:67], a[100:103], v[216:219], v[64:67]
    v_exp_f32 v37, v37
    v_mfma_f32_16x16x32_bf16 v[68:71], a[120:123], v[200:203], 0
    ds_read_b128 a[240:243], v1 offset:36864
    v_sub_f32 v39, v39, v12
    v_mfma_f32_16x16x32_bf16 v[68:71], a[124:127], v[216:219], v[68:71]
    buffer_store_dwordx2 v[244:245], v11, s[12:15], s36 offen offset:768 sc1
    v_mfma_f32_16x16x32_bf16 v[72:75], a[144:147], v[200:203], 0
    ds_read_b128 a[244:247], v1 offset:37888
    v_add_f32 v21, v21, v51
    v_mfma_f32_16x16x32_bf16 v[72:75], a[148:151], v[216:219], v[72:75]
    v_exp_f32 v53, v53
    v_mfma_f32_16x16x32_bf16 v[76:79], a[168:171], v[200:203], 0
    ds_read_b128 a[248:251], v1 offset:38912
    v_cvt_pk_bf16_f32 v200, v104, v105
    v_mfma_f32_16x16x32_bf16 v[76:79], a[172:175], v[216:219], v[76:79]
    v_cvt_pk_bf16_f32 v201, v106, v107
    v_sub_f32 v55, v55, v13
    v_mfma_f32_16x16x32_bf16 v[80:83], a[96:99], v[204:207], 0
    ds_read_b128 a[192:195], v1 offset:39936
    v_add_f32 v20, v20, v36
    v_mfma_f32_16x16x32_bf16 v[80:83], a[100:103], v[220:223], v[80:83]
    v_exp_f32 v38, v38
    v_mfma_f32_16x16x32_bf16 v[84:87], a[120:123], v[204:207], 0
    ds_read_b128 a[196:199], v1 offset:40960
    v_sub_f32 v40, v40, v12
    v_mfma_f32_16x16x32_bf16 v[84:87], a[124:127], v[220:223], v[84:87]
    v_exp_f32 v54, v54
    v_mfma_f32_16x16x32_bf16 v[88:91], a[144:147], v[204:207], 0
    ds_read_b128 a[200:203], v1 offset:41984
    v_add_f32 v21, v21, v52
    v_mfma_f32_16x16x32_bf16 v[88:91], a[148:151], v[220:223], v[88:91]
    buffer_store_dwordx2 v[246:247], v11, s[12:15], s36 offen offset:1152 sc1
    v_mfma_f32_16x16x32_bf16 v[92:95], a[168:171], v[204:207], 0
    ds_read_b128 a[204:207], v1 offset:43008
    v_cvt_pk_bf16_f32 v204, v108, v109
    v_mfma_f32_16x16x32_bf16 v[92:95], a[172:175], v[220:223], v[92:95]
    v_cvt_pk_bf16_f32 v205, v110, v111
    s_waitcnt lgkmcnt(6)
    v_mfma_f32_16x16x32_bf16 v[120:123], a[216:219], a[144:147], 0
    ds_read_b128 a[208:211], v1 offset:44032
    v_sub_f32 v56, v56, v13
    v_mfma_f32_16x16x32_bf16 v[120:123], a[220:223], a[148:151], v[120:123]
    v_exp_f32 v39, v39
    v_mfma_f32_16x16x32_bf16 v[120:123], a[224:227], a[152:155], v[120:123]
    ds_read_b128 a[212:215], v1 offset:45056
    v_add_f32 v20, v20, v37
    v_mfma_f32_16x16x32_bf16 v[120:123], a[228:231], a[156:159], v[120:123]
    v_exp_f32 v55, v55
    v_mfma_f32_16x16x32_bf16 v[120:123], a[232:235], a[160:163], v[120:123]
    v_exp_f32 v40, v40
    v_mfma_f32_16x16x32_bf16 v[120:123], a[236:239], a[164:167], v[120:123]
    v_sub_f32 v41, v41, v12
    v_add_f32 v21, v21, v53
    v_mfma_f32_16x16x32_bf16 v[124:127], a[216:219], a[168:171], 0
    v_exp_f32 v56, v56
    v_mfma_f32_16x16x32_bf16 v[124:127], a[220:223], a[172:175], v[124:127]
    ds_read_b128 a[216:219], v1 offset:46080
    v_sub_f32 v57, v57, v13
    v_mfma_f32_16x16x32_bf16 v[124:127], a[224:227], a[176:179], v[124:127]
    buffer_store_dwordx2 v[248:249], v11, s[12:15], s38 offen offset:0 sc1
    v_mfma_f32_16x16x32_bf16 v[124:127], a[228:231], a[180:183], v[124:127]
    ds_read_b128 a[220:223], v1 offset:47104
    v_cvt_pk_bf16_f32 v202, v120, v121
    v_mfma_f32_16x16x32_bf16 v[124:127], a[232:235], a[184:187], v[124:127]
    ds_read_b128 a[224:227], v1 offset:48128
    v_cvt_pk_bf16_f32 v203, v122, v123
    v_mfma_f32_16x16x32_bf16 v[124:127], a[236:239], a[188:191], v[124:127]
    ds_read_b128 a[228:231], v1 offset:49152
    v_add_f32 v20, v20, v38
    v_mfma_f32_16x16x32_bf16 v[104:107], a[240:243], a[144:147], 0
    ds_read_b128 a[232:235], v1 offset:50176
    s_waitcnt lgkmcnt(7)
    v_mfma_f32_16x16x32_bf16 v[104:107], a[244:247], a[148:151], v[104:107]
    v_exp_f32 v41, v41
    v_mfma_f32_16x16x32_bf16 v[104:107], a[248:251], a[152:155], v[104:107]
    ds_read_b128 a[236:239], v1 offset:51200
    v_cvt_pk_bf16_f32 v206, v124, v125
    v_mfma_f32_16x16x32_bf16 v[104:107], a[192:195], a[156:159], v[104:107]
    v_cvt_pk_bf16_f32 v207, v126, v127
    v_sub_f32 v42, v42, v12
    v_mfma_f32_16x16x32_bf16 v[104:107], a[196:199], a[160:163], v[104:107]
    v_add_f32 v21, v21, v54
    v_sub_f32 v58, v58, v13
    v_mfma_f32_16x16x32_bf16 v[104:107], a[200:203], a[164:167], v[104:107]
    v_exp_f32 v57, v57
    v_mfma_f32_16x16x32_bf16 v[108:111], a[240:243], a[168:171], 0
    buffer_store_dwordx2 v[250:251], v11, s[12:15], s38 offen offset:384 sc1
    v_mfma_f32_16x16x32_bf16 v[108:111], a[244:247], a[172:175], v[108:111]
    ds_read_b128 a[240:243], v1 offset:52224
    v_add_f32 v20, v20, v39
    v_mfma_f32_16x16x32_bf16 v[108:111], a[248:251], a[176:179], v[108:111]
    ds_read_b128 a[244:247], v1 offset:53248
    v_cvt_pk_bf16_f32 v216, v104, v105
    v_mfma_f32_16x16x32_bf16 v[108:111], a[192:195], a[180:183], v[108:111]
    ds_read_b128 a[248:251], v1 offset:54272
    v_cvt_pk_bf16_f32 v217, v106, v107
    v_mfma_f32_16x16x32_bf16 v[108:111], a[196:199], a[184:187], v[108:111]
    v_exp_f32 v42, v42
    v_mfma_f32_16x16x32_bf16 v[108:111], a[200:203], a[188:191], v[108:111]
    v_sub_f32 v43, v43, v12
    v_add_f32 v21, v21, v55
    v_mfma_f32_16x16x32_bf16 v[120:123], a[204:207], a[144:147], 0
    v_sub_f32 v59, v59, v13
    s_waitcnt lgkmcnt(5)
    v_mfma_f32_16x16x32_bf16 v[120:123], a[208:211], a[148:151], v[120:123]
    v_exp_f32 v58, v58
    v_mfma_f32_16x16x32_bf16 v[120:123], a[212:215], a[152:155], v[120:123]
    v_cvt_pk_bf16_f32 v220, v108, v109
    v_cvt_pk_bf16_f32 v221, v110, v111
    v_mfma_f32_16x16x32_bf16 v[120:123], a[216:219], a[156:159], v[120:123]
    v_add_f32 v20, v20, v40
    v_sub_f32 v44, v44, v12
    v_mfma_f32_16x16x32_bf16 v[120:123], a[220:223], a[160:163], v[120:123]
    v_exp_f32 v43, v43
    v_mfma_f32_16x16x32_bf16 v[120:123], a[224:227], a[164:167], v[120:123]
    buffer_store_dwordx2 v[252:253], v11, s[12:15], s38 offen offset:768 sc1
    v_mfma_f32_16x16x32_bf16 v[124:127], a[204:207], a[168:171], 0
    v_add_f32 v21, v21, v56
    v_sub_f32 v60, v60, v13
    v_mfma_f32_16x16x32_bf16 v[124:127], a[208:211], a[172:175], v[124:127]
    v_exp_f32 v59, v59
    v_mfma_f32_16x16x32_bf16 v[124:127], a[212:215], a[176:179], v[124:127]
    buffer_load_dwordx4 a[56:59], v9, s[8:11], s28 offen offset:128 nt
    v_cvt_pk_bf16_f32 v218, v120, v121
    v_mfma_f32_16x16x32_bf16 v[124:127], a[216:219], a[180:183], v[124:127]
    buffer_load_dwordx4 a[60:63], v10, s[8:11], s28 offen offset:128 nt
    v_cvt_pk_bf16_f32 v219, v122, v123
    v_mfma_f32_16x16x32_bf16 v[124:127], a[220:223], a[184:187], v[124:127]
    v_add_f32 v20, v20, v41
    v_sub_f32 v45, v45, v12
    v_mfma_f32_16x16x32_bf16 v[124:127], a[224:227], a[188:191], v[124:127]
    v_exp_f32 v44, v44
    v_mfma_f32_16x16x32_bf16 v[104:107], a[228:231], a[144:147], 0
    v_add_f32 v21, v21, v57
    s_waitcnt lgkmcnt(0)
    v_mfma_f32_16x16x32_bf16 v[104:107], a[232:235], a[148:151], v[104:107]
    v_exp_f32 v60, v60
    v_mfma_f32_16x16x32_bf16 v[104:107], a[236:239], a[152:155], v[104:107]
    ds_read_b128 a[192:195], v1 offset:55296
    v_cvt_pk_bf16_f32 v222, v124, v125
    v_mfma_f32_16x16x32_bf16 v[104:107], a[240:243], a[156:159], v[104:107]
    buffer_store_dwordx2 v[254:255], v11, s[12:15], s38 offen offset:1152 sc1
    v_mfma_f32_16x16x32_bf16 v[104:107], a[244:247], a[160:163], v[104:107]
    ds_read_b128 a[196:199], v1 offset:56320
    v_cvt_pk_bf16_f32 v223, v126, v127
    v_mfma_f32_16x16x32_bf16 v[104:107], a[248:251], a[164:167], v[104:107]
    v_sub_f32 v61, v61, v13
    v_add_f32 v20, v20, v42
    v_mfma_f32_16x16x32_bf16 v[108:111], a[228:231], a[168:171], 0
    ds_read_b128 a[200:203], v1 offset:57344
    v_sub_f32 v46, v46, v12
    v_mfma_f32_16x16x32_bf16 v[108:111], a[232:235], a[172:175], v[108:111]
    v_exp_f32 v45, v45
    v_mfma_f32_16x16x32_bf16 v[108:111], a[236:239], a[176:179], v[108:111]
    ds_read_b128 a[204:207], v1 offset:58368
    v_add_f32 v21, v21, v58
    v_mfma_f32_16x16x32_bf16 v[108:111], a[240:243], a[180:183], v[108:111]
    v_exp_f32 v61, v61
    v_mfma_f32_16x16x32_bf16 v[108:111], a[244:247], a[184:187], v[108:111]
    ds_read_b128 a[208:211], v1 offset:59392
    v_sub_f32 v62, v62, v13
    v_mfma_f32_16x16x32_bf16 v[108:111], a[248:251], a[188:191], v[108:111]
    v_add_f32 v20, v20, v43
    v_sub_f32 v47, v47, v12
    v_mfma_f32_16x16x32_bf16 v[64:67], a[104:107], v[200:203], v[64:67]
    ds_read_b128 a[212:215], v1 offset:60416
    v_add_f32 v21, v21, v59
    v_mfma_f32_16x16x32_bf16 v[64:67], a[108:111], v[216:219], v[64:67]
    v_exp_f32 v46, v46
    v_mfma_f32_16x16x32_bf16 v[68:71], a[128:131], v[200:203], v[68:71]
    buffer_store_dwordx2 v[160:161], v11, s[12:15], s32 offen offset:256 sc1
    v_mfma_f32_16x16x32_bf16 v[68:71], a[132:135], v[216:219], v[68:71]
    ds_read_b128 a[216:219], v1 offset:61440
    v_sub_f32 v63, v63, v13
    v_mfma_f32_16x16x32_bf16 v[72:75], a[152:155], v[200:203], v[72:75]
    ds_read_b128 a[220:223], v1 offset:62464
    v_add_f32 v20, v20, v44
    v_mfma_f32_16x16x32_bf16 v[72:75], a[156:159], v[216:219], v[72:75]
    v_exp_f32 v62, v62
    v_mfma_f32_16x16x32_bf16 v[76:79], a[176:179], v[200:203], v[76:79]
    ds_read_b128 a[224:227], v1 offset:63488
    v_cvt_pk_bf16_f32 v200, v104, v105
    v_mfma_f32_16x16x32_bf16 v[76:79], a[180:183], v[216:219], v[76:79]
    v_cvt_pk_bf16_f32 v201, v106, v107
    v_add_f32 v21, v21, v60
    v_mfma_f32_16x16x32_bf16 v[80:83], a[104:107], v[204:207], v[80:83]
    ds_read_b128 a[228:231], v1 offset:64512
    v_add_f32 v20, v20, v45
    v_mfma_f32_16x16x32_bf16 v[80:83], a[108:111], v[220:223], v[80:83]
    v_exp_f32 v47, v47
    v_mfma_f32_16x16x32_bf16 v[84:87], a[128:131], v[204:207], v[84:87]
    ds_read_b128 a[232:235], v2 offset:0
    v_add_f32 v21, v21, v61
    v_mfma_f32_16x16x32_bf16 v[84:87], a[132:135], v[220:223], v[84:87]
    v_exp_f32 v63, v63
    v_mfma_f32_16x16x32_bf16 v[88:91], a[152:155], v[204:207], v[88:91]
    buffer_store_dwordx2 v[162:163], v11, s[12:15], s32 offen offset:640 sc1
    v_mfma_f32_16x16x32_bf16 v[88:91], a[156:159], v[220:223], v[88:91]
    ds_read_b128 a[236:239], v2 offset:1024
    v_add_f32 v20, v20, v46
    v_mfma_f32_16x16x32_bf16 v[92:95], a[176:179], v[204:207], v[92:95]
    ds_read_b128 a[240:243], v2 offset:2048
    v_cvt_pk_bf16_f32 v204, v108, v109
    v_mfma_f32_16x16x32_bf16 v[92:95], a[180:183], v[220:223], v[92:95]
    v_cvt_pk_bf16_f32 v205, v110, v111
    s_waitcnt lgkmcnt(7)
    v_mfma_f32_16x16x32_bf16 v[120:123], a[192:195], a[144:147], 0
    ds_read_b128 a[244:247], v2 offset:3072
    v_add_f32 v21, v21, v62
    v_mfma_f32_16x16x32_bf16 v[120:123], a[196:199], a[148:151], v[120:123]
    v_add_f32 v20, v20, v47
    v_add_f32 v21, v21, v63
    v_mfma_f32_16x16x32_bf16 v[120:123], a[200:203], a[152:155], v[120:123]
    ds_read_b128 a[248:251], v2 offset:4096
    v_permlane16_swap_b32 v20, v21
    v_mfma_f32_16x16x32_bf16 v[120:123], a[204:207], a[156:159], v[120:123]
    v_add_f32 v20, v20, v21
    v_mov_b32 v21, v20
    v_mfma_f32_16x16x32_bf16 v[120:123], a[208:211], a[160:163], v[120:123]
    v_mfma_f32_16x16x32_bf16 v[120:123], a[212:215], a[164:167], v[120:123]
    v_permlane32_swap_b32 v20, v21
    v_add_f32 v20, v20, v21
    v_mfma_f32_16x16x32_bf16 v[124:127], a[192:195], a[168:171], 0
    v_rcp_f32 v20, v20
    v_mfma_f32_16x16x32_bf16 v[124:127], a[196:199], a[172:175], v[124:127]
    buffer_store_dwordx2 v[164:165], v11, s[12:15], s32 offen offset:1024 sc1
    v_mfma_f32_16x16x32_bf16 v[124:127], a[200:203], a[176:179], v[124:127]
    ds_read_b128 a[192:195], v2 offset:5120
    v_cvt_pk_bf16_f32 v202, v120, v121
    v_mfma_f32_16x16x32_bf16 v[124:127], a[204:207], a[180:183], v[124:127]
    ds_read_b128 a[196:199], v2 offset:6144
    v_cvt_pk_bf16_f32 v203, v122, v123
    v_mfma_f32_16x16x32_bf16 v[124:127], a[208:211], a[184:187], v[124:127]
    ds_read_b128 a[200:203], v2 offset:7168
    v_mov_b32 v21, v20
    v_mfma_f32_16x16x32_bf16 v[124:127], a[212:215], a[188:191], v[124:127]
    ds_read_b128 a[204:207], v2 offset:8192
    s_waitcnt lgkmcnt(6)
    v_mfma_f32_16x16x32_bf16 v[104:107], a[216:219], a[144:147], 0
    ds_read_b128 a[208:211], v2 offset:9216
    v_permlane16_swap_b32 v20, v21
    v_mfma_f32_16x16x32_bf16 v[104:107], a[220:223], a[148:151], v[104:107]
    v_mul_f32 v32, v32, v20
    v_mul_f32 v33, v33, v20
    v_mfma_f32_16x16x32_bf16 v[104:107], a[224:227], a[152:155], v[104:107]
    ds_read_b128 a[212:215], v2 offset:10240
    v_cvt_pk_bf16_f32 v206, v124, v125
    v_mfma_f32_16x16x32_bf16 v[104:107], a[228:231], a[156:159], v[104:107]
    v_cvt_pk_bf16_f32 v207, v126, v127
    v_cvt_pk_bf16_f32 v32, v32, v33
    v_mfma_f32_16x16x32_bf16 v[104:107], a[232:235], a[160:163], v[104:107]
    v_mul_f32 v34, v34, v20
    v_mul_f32 v35, v35, v20
    v_mfma_f32_16x16x32_bf16 v[104:107], a[236:239], a[164:167], v[104:107]
    buffer_store_dwordx2 v[166:167], v11, s[12:15], s32 offen offset:1408 sc1
    v_mfma_f32_16x16x32_bf16 v[108:111], a[216:219], a[168:171], 0
    v_cvt_pk_bf16_f32 v33, v34, v35
    v_mul_f32 v36, v36, v20
    v_mfma_f32_16x16x32_bf16 v[108:111], a[220:223], a[172:175], v[108:111]
    ds_read_b128 a[216:219], v2 offset:11264
    v_mul_f32 v37, v37, v20
    v_mfma_f32_16x16x32_bf16 v[108:111], a[224:227], a[176:179], v[108:111]
    ds_read_b128 a[220:223], v2 offset:12288
    v_cvt_pk_bf16_f32 v216, v104, v105
    v_mfma_f32_16x16x32_bf16 v[108:111], a[228:231], a[180:183], v[108:111]
    ds_read_b128 a[224:227], v2 offset:13312
    v_cvt_pk_bf16_f32 v217, v106, v107
    v_mfma_f32_16x16x32_bf16 v[108:111], a[232:235], a[184:187], v[108:111]
    v_mul_f32 v38, v38, v20
    v_mul_f32 v39, v39, v20
    v_mfma_f32_16x16x32_bf16 v[108:111], a[236:239], a[188:191], v[108:111]
    v_cvt_pk_bf16_f32 v34, v36, v37
    v_cvt_pk_bf16_f32 v35, v38, v39
    v_mfma_f32_16x16x32_bf16 v[120:123], a[240:243], a[144:147], 0
    buffer_load_dwordx4 a[64:67], v9, s[8:11], s28 offen offset:256 nt
    s_waitcnt lgkmcnt(5)
    v_mfma_f32_16x16x32_bf16 v[120:123], a[244:247], a[148:151], v[120:123]
    buffer_load_dwordx4 a[68:71], v10, s[8:11], s28 offen offset:256 nt
    v_mul_f32 v40, v40, v20
    v_mfma_f32_16x16x32_bf16 v[120:123], a[248:251], a[152:155], v[120:123]
    v_cvt_pk_bf16_f32 v220, v108, v109
    v_cvt_pk_bf16_f32 v221, v110, v111
    v_mfma_f32_16x16x32_bf16 v[120:123], a[192:195], a[156:159], v[120:123]
    v_mul_f32 v41, v41, v20
    v_mul_f32 v42, v42, v20
    v_mfma_f32_16x16x32_bf16 v[120:123], a[196:199], a[160:163], v[120:123]
    buffer_store_dwordx2 v[168:169], v11, s[12:15], s34 offen offset:256 sc1
    v_mfma_f32_16x16x32_bf16 v[120:123], a[200:203], a[164:167], v[120:123]
    v_mul_f32 v43, v43, v20
    v_mul_f32 v44, v44, v20
    v_mfma_f32_16x16x32_bf16 v[124:127], a[240:243], a[168:171], 0
    v_mul_f32 v45, v45, v20
    v_mul_f32 v46, v46, v20
    v_mfma_f32_16x16x32_bf16 v[124:127], a[244:247], a[172:175], v[124:127]
    v_mul_f32 v47, v47, v20
    v_cvt_pk_bf16_f32 v36, v40, v41
    v_mfma_f32_16x16x32_bf16 v[124:127], a[248:251], a[176:179], v[124:127]
    v_cvt_pk_bf16_f32 v218, v120, v121
    v_cvt_pk_bf16_f32 v219, v122, v123
    v_mfma_f32_16x16x32_bf16 v[124:127], a[192:195], a[180:183], v[124:127]
    v_cvt_pk_bf16_f32 v37, v42, v43
    v_cvt_pk_bf16_f32 v38, v44, v45
    v_mfma_f32_16x16x32_bf16 v[124:127], a[196:199], a[184:187], v[124:127]
    v_cvt_pk_bf16_f32 v39, v46, v47
    v_mul_f32 v48, v48, v21
    v_mfma_f32_16x16x32_bf16 v[124:127], a[200:203], a[188:191], v[124:127]
    v_mul_f32 v49, v49, v21
    v_mul_f32 v50, v50, v21
    v_mfma_f32_16x16x32_bf16 v[96:99], a[96:99], a[204:207], 0
    v_mul_f32 v51, v51, v21
    s_waitcnt lgkmcnt(0)
    v_mfma_f32_16x16x32_bf16 v[96:99], a[100:103], a[208:211], v[96:99]
    v_mul_f32 v52, v52, v21
    v_mul_f32 v53, v53, v21
    v_mfma_f32_16x16x32_bf16 v[96:99], a[104:107], a[212:215], v[96:99]
    buffer_store_dwordx2 v[170:171], v11, s[12:15], s34 offen offset:640 sc1
    v_mfma_f32_16x16x32_bf16 v[96:99], a[108:111], a[216:219], v[96:99]
    v_cvt_pk_bf16_f32 v222, v124, v125
    v_cvt_pk_bf16_f32 v223, v126, v127
    v_mfma_f32_16x16x32_bf16 v[96:99], a[112:115], a[220:223], v[96:99]
    v_mul_f32 v54, v54, v21
    v_mul_f32 v55, v55, v21
    v_mfma_f32_16x16x32_bf16 v[96:99], a[116:119], a[224:227], v[96:99]
    v_cvt_pk_bf16_f32 v40, v48, v49
    v_cvt_pk_bf16_f32 v41, v50, v51
    v_mfma_f32_16x16x32_bf16 v[100:103], a[120:123], a[204:207], 0
    v_cvt_pk_bf16_f32 v42, v52, v53
    v_cvt_pk_bf16_f32 v43, v54, v55
    v_mfma_f32_16x16x32_bf16 v[100:103], a[124:127], a[208:211], v[100:103]
    v_mul_f32 v56, v56, v21
    v_mul_f32 v57, v57, v21
    v_mfma_f32_16x16x32_bf16 v[100:103], a[128:131], a[212:215], v[100:103]
    v_cvt_pk_bf16_f32 v128, v96, v97
    v_cvt_pk_bf16_f32 v129, v98, v99
    v_mfma_f32_16x16x32_bf16 v[100:103], a[132:135], a[216:219], v[100:103]
    v_mul_f32 v58, v58, v21
    v_mul_f32 v59, v59, v21
    v_mfma_f32_16x16x32_bf16 v[100:103], a[136:139], a[220:223], v[100:103]
    v_mul_f32 v60, v60, v21
    v_mul_f32 v61, v61, v21
    v_mfma_f32_16x16x32_bf16 v[100:103], a[140:143], a[224:227], v[100:103]
    v_mul_f32 v62, v62, v21
    v_mul_f32 v63, v63, v21
    v_mfma_f32_16x16x32_bf16 v[64:67], a[112:115], v[200:203], v[64:67]
    v_cvt_pk_bf16_f32 v44, v56, v57
    v_cvt_pk_bf16_f32 v45, v58, v59
    v_mfma_f32_16x16x32_bf16 v[64:67], a[116:119], v[216:219], v[64:67]
    buffer_store_dwordx2 v[172:173], v11, s[12:15], s34 offen offset:1024 sc1
    v_mfma_f32_16x16x32_bf16 v[68:71], a[136:139], v[200:203], v[68:71]
    ds_read_b128 a[228:231], v2 offset:14336
    v_cvt_pk_bf16_f32 v130, v100, v101
    v_mfma_f32_16x16x32_bf16 v[68:71], a[140:143], v[216:219], v[68:71]
    v_cvt_pk_bf16_f32 v131, v102, v103
    v_cvt_pk_bf16_f32 v46, v60, v61
    v_mfma_f32_16x16x32_bf16 v[72:75], a[160:163], v[200:203], v[72:75]
    ds_read_b128 a[232:235], v2 offset:15360
    v_cvt_pk_bf16_f32 v47, v62, v63
    v_mfma_f32_16x16x32_bf16 v[72:75], a[164:167], v[216:219], v[72:75]
    v_max3_f32 v14, v64, v65, v66
    s_add_u32 s28, s16, 10223616
    v_mfma_f32_16x16x32_bf16 v[76:79], a[184:187], v[200:203], v[76:79]
    ds_read_b128 a[236:239], v2 offset:16384
    v_max3_f32 v14, v14, v67, v68
    v_mfma_f32_16x16x32_bf16 v[76:79], a[188:191], v[216:219], v[76:79]
    v_max3_f32 v14, v14, v69, v70
    v_mfma_f32_16x16x32_bf16 v[80:83], a[112:115], v[204:207], v[80:83]
    ds_read_b128 a[240:243], v2 offset:17408
    v_max3_f32 v14, v14, v71, v72
    v_mfma_f32_16x16x32_bf16 v[80:83], a[116:119], v[220:223], v[80:83]
    v_max3_f32 v14, v14, v73, v74
    v_mfma_f32_16x16x32_bf16 v[84:87], a[136:139], v[204:207], v[84:87]
    ds_read_b128 a[244:247], v2 offset:18432
    v_max3_f32 v14, v14, v75, v76
    v_mfma_f32_16x16x32_bf16 v[84:87], a[140:143], v[220:223], v[84:87]
    buffer_store_dwordx2 v[174:175], v11, s[12:15], s34 offen offset:1408 sc1
    v_mfma_f32_16x16x32_bf16 v[88:91], a[160:163], v[204:207], v[88:91]
    ds_read_b128 a[248:251], v2 offset:19456
    v_max3_f32 v15, v80, v81, v82
    v_mfma_f32_16x16x32_bf16 v[88:91], a[164:167], v[220:223], v[88:91]
    v_max3_f32 v14, v14, v77, v78
    v_max_f32 v14, v14, v79
    v_mfma_f32_16x16x32_bf16 v[92:95], a[184:187], v[204:207], v[92:95]
    v_max3_f32 v15, v15, v83, v84
    v_max3_f32 v15, v15, v85, v86
    v_mfma_f32_16x16x32_bf16 v[92:95], a[188:191], v[220:223], v[92:95]
    v_mfma_f32_16x16x32_bf16 v[104:107], a[144:147], a[204:207], 0
    v_max3_f32 v15, v15, v87, v88
    v_max3_f32 v15, v15, v89, v90
    v_mfma_f32_16x16x32_bf16 v[104:107], a[148:151], a[208:211], v[104:107]
    v_mfma_f32_16x16x32_bf16 v[104:107], a[152:155], a[212:215], v[104:107]
    v_max3_f32 v15, v15, v91, v92
    v_max3_f32 v15, v15, v93, v94
    v_mfma_f32_16x16x32_bf16 v[104:107], a[156:159], a[216:219], v[104:107]
    v_max_f32 v15, v15, v95
    v_mfma_f32_16x16x32_bf16 v[104:107], a[160:163], a[220:223], v[104:107]
    v_mfma_f32_16x16x32_bf16 v[104:107], a[164:167], a[224:227], v[104:107]
    v_permlane16_swap_b32 v14, v15
    v_max_f32 v14, v14, v15
    v_mfma_f32_16x16x32_bf16 v[108:111], a[168:171], a[204:207], 0
    buffer_store_dwordx2 v[176:177], v11, s[12:15], s36 offen offset:256 sc1
    v_mfma_f32_16x16x32_bf16 v[108:111], a[172:175], a[208:211], v[108:111]
    v_mov_b32 v15, v14
    v_mfma_f32_16x16x32_bf16 v[108:111], a[176:179], a[212:215], v[108:111]
    v_cvt_pk_bf16_f32 v132, v104, v105
    v_cvt_pk_bf16_f32 v133, v106, v107
    v_mfma_f32_16x16x32_bf16 v[108:111], a[180:183], a[216:219], v[108:111]
    v_permlane32_swap_b32 v14, v15
    v_max_f32 v14, v14, v15
    v_mfma_f32_16x16x32_bf16 v[108:111], a[184:187], a[220:223], v[108:111]
    ds_read_b128 a[192:195], v2 offset:20480
    v_mov_b32 v15, v14
    v_mfma_f32_16x16x32_bf16 v[108:111], a[188:191], a[224:227], v[108:111]
    s_waitcnt lgkmcnt(1)
    v_mfma_f32_16x16x32_bf16 v[112:115], a[96:99], a[228:231], 0
    ds_read_b128 a[196:199], v2 offset:21504
    v_permlane16_swap_b32 v14, v15
    v_mfma_f32_16x16x32_bf16 v[112:115], a[100:103], a[232:235], v[112:115]
    v_sub_f32 v64, v64, v14
    v_sub_f32 v65, v65, v14
    v_mfma_f32_16x16x32_bf16 v[112:115], a[104:107], a[236:239], v[112:115]
    ds_read_b128 a[200:203], v2 offset:22528
    v_cvt_pk_bf16_f32 v134, v108, v109
    v_mfma_f32_16x16x32_bf16 v[112:115], a[108:111], a[240:243], v[112:115]
    v_cvt_pk_bf16_f32 v135, v110, v111
    v_sub_f32 v80, v80, v15
    v_mfma_f32_16x16x32_bf16 v[112:115], a[112:115], a[244:247], v[112:115]
    buffer_store_dwordx2 v[178:179], v11, s[12:15], s36 offen offset:640 sc1
    v_mfma_f32_16x16x32_bf16 v[112:115], a[116:119], a[248:251], v[112:115]
    buffer_load_dwordx4 a[72:75], v9, s[8:11], s30 offen offset:0 nt
    v_sub_f32 v81, v81, v15
    v_mfma_f32_16x16x32_bf16 v[116:119], a[120:123], a[228:231], 0
    buffer_load_dwordx4 a[76:79], v10, s[8:11], s30 offen offset:0 nt
    v_sub_f32 v66, v66, v14
    v_mfma_f32_16x16x32_bf16 v[116:119], a[124:127], a[232:235], v[116:119]
    ds_read_b128 a[204:207], v2 offset:23552
    v_sub_f32 v82, v82, v15
    v_mfma_f32_16x16x32_bf16 v[116:119], a[128:131], a[236:239], v[116:119]
    ds_read_b128 a[208:211], v2 offset:24576
    v_cvt_pk_bf16_f32 v136, v112, v113
    v_mfma_f32_16x16x32_bf16 v[116:119], a[132:135], a[240:243], v[116:119]
    ds_read_b128 a[212:215], v2 offset:25600
    v_cvt_pk_bf16_f32 v137, v114, v115
    v_mfma_f32_16x16x32_bf16 v[116:119], a[136:139], a[244:247], v[116:119]
    v_exp_f32 v64, v64
    v_mfma_f32_16x16x32_bf16 v[116:119], a[140:143], a[248:251], v[116:119]
    v_exp_f32 v65, v65
    v_mfma_f32_16x16x32_bf16 v[120:123], a[144:147], a[228:231], 0
    v_exp_f32 v80, v80
    v_mfma_f32_16x16x32_bf16 v[120:123], a[148:151], a[232:235], v[120:123]
    v_exp_f32 v81, v81
    v_mfma_f32_16x16x32_bf16 v[120:123], a[152:155], a[236:239], v[120:123]
    v_cvt_pk_bf16_f32 v138, v116, v117
    v_cvt_pk_bf16_f32 v139, v118, v119
    v_mfma_f32_16x16x32_bf16 v[120:123], a[156:159], a[240:243], v[120:123]
    buffer_store_dwordx2 v[180:181], v11, s[12:15], s36 offen offset:1024 sc1
    v_mfma_f32_16x16x32_bf16 v[120:123], a[160:163], a[244:247], v[120:123]
    v_exp_f32 v66, v66
    v_mfma_f32_16x16x32_bf16 v[120:123], a[164:167], a[248:251], v[120:123]
    v_sub_f32 v67, v67, v14
    v_sub_f32 v83, v83, v15
    v_mfma_f32_16x16x32_bf16 v[124:127], a[168:171], a[228:231], 0
    v_exp_f32 v82, v82
    v_mfma_f32_16x16x32_bf16 v[124:127], a[172:175], a[232:235], v[124:127]
    v_exp_f32 v67, v67
    v_mfma_f32_16x16x32_bf16 v[124:127], a[176:179], a[236:239], v[124:127]
    v_cvt_pk_bf16_f32 v140, v120, v121
    v_cvt_pk_bf16_f32 v141, v122, v123
    v_mfma_f32_16x16x32_bf16 v[124:127], a[180:183], a[240:243], v[124:127]
    v_sub_f32 v68, v68, v14
    v_sub_f32 v84, v84, v15
    v_mfma_f32_16x16x32_bf16 v[124:127], a[184:187], a[244:247], v[124:127]
    ds_read_b128 a[216:219], v2 offset:26624
    v_add_f32 v22, v64, v65
    v_mfma_f32_16x16x32_bf16 v[124:127], a[188:191], a[248:251], v[124:127]
    v_sub_f32 v69, v69, v14
    s_waitcnt lgkmcnt(1)
    v_mfma_f32_16x16x32_bf16 v[96:99], a[96:99], a[192:195], 0
    ds_read_b128 a[220:223], v2 offset:27648
    v_add_f32 v23, v80, v81
    v_mfma_f32_16x16x32_bf16 v[96:99], a[100:103], a[196:199], v[96:99]
    buffer_store_dwordx2 v[182:183], v11, s[12:15], s36 offen offset:1408 sc1
    v_mfma_f32_16x16x32_bf16 v[96:99], a[104:107], a[200:203], v[96:99]
    ds_read_b128 a[224:227], v2 offset:28672
    v_cvt_pk_bf16_f32 v142, v124, v125
    v_mfma_f32_16x16x32_bf16 v[96:99], a[108:111], a[204:207], v[96:99]
    v_cvt_pk_bf16_f32 v143, v126, v127
    v_sub_f32 v85, v85, v15
    v_mfma_f32_16x16x32_bf16 v[96:99], a[112:115], a[208:211], v[96:99]
    ds_read_b128 a[228:231], v2 offset:29696
    v_add_f32 v22, v22, v66
    v_mfma_f32_16x16x32_bf16 v[96:99], a[116:119], a[212:215], v[96:99]
    v_exp_f32 v83, v83
    v_mfma_f32_16x16x32_bf16 v[100:103], a[120:123], a[192:195], 0
    ds_read_b128 a[232:235], v2 offset:30720
    v_sub_f32 v70, v70, v14
    v_mfma_f32_16x16x32_bf16 v[100:103], a[124:127], a[196:199], v[100:103]
    v_exp_f32 v68, v68
    v_mfma_f32_16x16x32_bf16 v[100:103], a[128:131], a[200:203], v[100:103]
    ds_read_b128 a[236:239], v2 offset:31744
    v_cvt_pk_bf16_f32 v144, v96, v97
    v_mfma_f32_16x16x32_bf16 v[100:103], a[132:135], a[204:207], v[100:103]
    v_cvt_pk_bf16_f32 v145, v98, v99
    v_add_f32 v23, v23, v82
    v_mfma_f32_16x16x32_bf16 v[100:103], a[136:139], a[208:211], v[100:103]
    v_exp_f32 v84, v84
    v_mfma_f32_16x16x32_bf16 v[100:103], a[140:143], a[212:215], v[100:103]
    v_exp_f32 v69, v69
    v_mfma_f32_16x16x32_bf16 v[104:107], a[144:147], a[192:195], 0
    buffer_store_dwordx2 v[184:185], v11, s[12:15], s38 offen offset:256 sc1
    v_mfma_f32_16x16x32_bf16 v[104:107], a[148:151], a[196:199], v[104:107]
    v_exp_f32 v85, v85
    v_mfma_f32_16x16x32_bf16 v[104:107], a[152:155], a[200:203], v[104:107]
    v_cvt_pk_bf16_f32 v146, v100, v101
    v_cvt_pk_bf16_f32 v147, v102, v103
    v_mfma_f32_16x16x32_bf16 v[104:107], a[156:159], a[204:207], v[104:107]
    v_sub_f32 v86, v86, v15
    v_add_f32 v22, v22, v67
    v_mfma_f32_16x16x32_bf16 v[104:107], a[160:163], a[208:211], v[104:107]
    v_exp_f32 v70, v70
    v_mfma_f32_16x16x32_bf16 v[104:107], a[164:167], a[212:215], v[104:107]
    v_sub_f32 v71, v71, v14
    v_add_f32 v23, v23, v83
    v_mfma_f32_16x16x32_bf16 v[108:111], a[168:171], a[192:195], 0
    v_exp_f32 v86, v86
    v_mfma_f32_16x16x32_bf16 v[108:111], a[172:175], a[196:199], v[108:111]
    v_sub_f32 v87, v87, v15
    v_add_f32 v22, v22, v68
    v_mfma_f32_16x16x32_bf16 v[108:111], a[176:179], a[200:203], v[108:111]
    v_cvt_pk_bf16_f32 v148, v104, v105
    v_cvt_pk_bf16_f32 v149, v106, v107
    v_mfma_f32_16x16x32_bf16 v[108:111], a[180:183], a[204:207], v[108:111]
    v_exp_f32 v71, v71
    v_mfma_f32_16x16x32_bf16 v[108:111], a[184:187], a[208:211], v[108:111]
    buffer_store_dwordx2 v[186:187], v11, s[12:15], s38 offen offset:640 sc1
    v_mfma_f32_16x16x32_bf16 v[108:111], a[188:191], a[212:215], v[108:111]
    v_sub_f32 v72, v72, v14
    s_waitcnt lgkmcnt(0)
    v_mfma_f32_16x16x32_bf16 v[112:115], a[96:99], a[216:219], 0
    v_add_f32 v23, v23, v84
    v_sub_f32 v88, v88, v15
    v_mfma_f32_16x16x32_bf16 v[112:115], a[100:103], a[220:223], v[112:115]
    v_exp_f32 v87, v87
    v_mfma_f32_16x16x32_bf16 v[112:115], a[104:107], a[224:227], v[112:115]
    v_cvt_pk_bf16_f32 v150, v108, v109
    v_cvt_pk_bf16_f32 v151, v110, v111
    v_mfma_f32_16x16x32_bf16 v[112:115], a[108:111], a[228:231], v[112:115]
    v_add_f32 v22, v22, v69
    v_sub_f32 v73, v73, v14
    v_mfma_f32_16x16x32_bf16 v[112:115], a[112:115], a[232:235], v[112:115]
    v_exp_f32 v72, v72
    v_mfma_f32_16x16x32_bf16 v[112:115], a[116:119], a[236:239], v[112:115]
    v_add_f32 v23, v23, v85
    v_sub_f32 v89, v89, v15
    v_mfma_f32_16x16x32_bf16 v[116:119], a[120:123], a[216:219], 0
    v_exp_f32 v88, v88
    v_mfma_f32_16x16x32_bf16 v[116:119], a[124:127], a[220:223], v[116:119]
    v_add_f32 v22, v22, v70
    v_sub_f32 v74, v74, v14
    v_mfma_f32_16x16x32_bf16 v[116:119], a[128:131], a[224:227], v[116:119]
    v_cvt_pk_bf16_f32 v152, v112, v113
    v_cvt_pk_bf16_f32 v153, v114, v115
    v_mfma_f32_16x16x32_bf16 v[116:119], a[132:135], a[228:231], v[116:119]
    buffer_store_dwordx2 v[188:189], v11, s[12:15], s38 offen offset:1024 sc1
    v_mfma_f32_16x16x32_bf16 v[116:119], a[136:139], a[232:235], v[116:119]
    v_exp_f32 v73, v73
    v_mfma_f32_16x16x32_bf16 v[116:119], a[140:143], a[236:239], v[116:119]
    v_add_f32 v23, v23, v86
    v_sub_f32 v90, v90, v15
    v_mfma_f32_16x16x32_bf16 v[120:123], a[144:147], a[216:219], 0
    buffer_load_dwordx4 a[80:83], v9, s[8:11], s30 offen offset:128 nt
    v_add_f32 v22, v22, v71
    v_mfma_f32_16x16x32_bf16 v[120:123], a[148:151], a[220:223], v[120:123]
    buffer_load_dwordx4 a[84:87], v10, s[8:11], s30 offen offset:128 nt
    v_sub_f32 v75, v75, v14
    v_mfma_f32_16x16x32_bf16 v[120:123], a[152:155], a[224:227], v[120:123]
    ds_read_b128 a[240:243], v2 offset:32768
    v_cvt_pk_bf16_f32 v154, v116, v117
    v_mfma_f32_16x16x32_bf16 v[120:123], a[156:159], a[228:231], v[120:123]
    v_cvt_pk_bf16_f32 v155, v118, v119
    v_add_f32 v23, v23, v87
    v_mfma_f32_16x16x32_bf16 v[120:123], a[160:163], a[232:235], v[120:123]
    ds_read_b128 a[244:247], v2 offset:33792
    v_sub_f32 v91, v91, v15
    v_mfma_f32_16x16x32_bf16 v[120:123], a[164:167], a[236:239], v[120:123]
    v_exp_f32 v89, v89
    v_mfma_f32_16x16x32_bf16 v[124:127], a[168:171], a[216:219], 0
    ds_read_b128 a[248:251], v2 offset:34816
    v_add_f32 v22, v22, v72
    v_mfma_f32_16x16x32_bf16 v[124:127], a[172:175], a[220:223], v[124:127]
    buffer_store_dwordx2 v[190:191], v11, s[12:15], s38 offen offset:1408 sc1
    v_mfma_f32_16x16x32_bf16 v[124:127], a[176:179], a[224:227], v[124:127]
    ds_read_b128 a[192:195], v2 offset:35840
    v_cvt_pk_bf16_f32 v156, v120, v121
    v_mfma_f32_16x16x32_bf16 v[124:127], a[180:183], a[228:231], v[124:127]
    v_cvt_pk_bf16_f32 v157, v122, v123
    v_sub_f32 v76, v76, v14
    v_mfma_f32_16x16x32_bf16 v[124:127], a[184:187], a[232:235], v[124:127]
    ds_read_b128 a[196:199], v2 offset:36864
    v_add_f32 v23, v23, v88
    v_mfma_f32_16x16x32_bf16 v[124:127], a[188:191], a[236:239], v[124:127]
    v_exp_f32 v74, v74
    v_mfma_f32_16x16x32_bf16 v[192:195], v[32:35], v[128:131], 0
    ds_read_b128 a[200:203], v2 offset:37888
    v_sub_f32 v92, v92, v15
    v_mfma_f32_16x16x32_bf16 v[192:195], v[36:39], v[132:135], v[192:195]
    v_exp_f32 v90, v90
    v_mfma_f32_16x16x32_bf16 v[196:199], v[32:35], v[136:139], 0
    v_cvt_pk_bf16_f32 v158, v124, v125
    v_cvt_pk_bf16_f32 v159, v126, v127
    v_mfma_f32_16x16x32_bf16 v[196:199], v[36:39], v[140:143], v[196:199]
    v_exp_f32 v75, v75
    v_mfma_f32_16x16x32_bf16 v[200:203], v[32:35], v[144:147], 0
    v_exp_f32 v91, v91
    v_mfma_f32_16x16x32_bf16 v[200:203], v[36:39], v[148:151], v[200:203]
    v_add_f32 v22, v22, v73
    v_sub_f32 v77, v77, v14
    v_mfma_f32_16x16x32_bf16 v[204:207], v[32:35], v[152:155], 0
    v_cvt_pk_bf16_f32 v224, v192, v196
    v_cvt_pk_bf16_f32 v226, v193, v197
    v_mfma_f32_16x16x32_bf16 v[204:207], v[36:39], v[156:159], v[204:207]
    v_cvt_pk_bf16_f32 v228, v194, v198
    v_cvt_pk_bf16_f32 v230, v195, v199
    v_mfma_f32_16x16x32_bf16 v[208:211], v[40:43], v[128:131], 0
    v_exp_f32 v76, v76
    v_mfma_f32_16x16x32_bf16 v[208:211], v[44:47], v[132:135], v[208:211]
    v_add_f32 v23, v23, v89
    v_sub_f32 v93, v93, v15
    v_mfma_f32_16x16x32_bf16 v[212:215], v[40:43], v[136:139], 0
    v_cvt_pk_bf16_f32 v225, v200, v204
    v_cvt_pk_bf16_f32 v227, v201, v205
    v_mfma_f32_16x16x32_bf16 v[212:215], v[44:47], v[140:143], v[212:215]
    v_cvt_pk_bf16_f32 v229, v202, v206
    v_cvt_pk_bf16_f32 v231, v203, v207
    v_mfma_f32_16x16x32_bf16 v[216:219], v[40:43], v[144:147], 0
    v_exp_f32 v92, v92
    v_mfma_f32_16x16x32_bf16 v[216:219], v[44:47], v[148:151], v[216:219]
    v_add_f32 v22, v22, v74
    v_sub_f32 v78, v78, v14
    v_mfma_f32_16x16x32_bf16 v[220:223], v[40:43], v[152:155], 0
    ds_read_b128 a[204:207], v2 offset:38912
    v_add_f32 v23, v23, v90
    v_mfma_f32_16x16x32_bf16 v[220:223], v[44:47], v[156:159], v[220:223]
    v_sub_f32 v94, v94, v15
    s_waitcnt lgkmcnt(1)
    v_mfma_f32_16x16x32_bf16 v[96:99], a[96:99], a[240:243], 0
    ds_read_b128 a[208:211], v2 offset:39936
    v_add_f32 v22, v22, v75
    v_mfma_f32_16x16x32_bf16 v[96:99], a[100:103], a[244:247], v[96:99]
    v_exp_f32 v77, v77
    v_mfma_f32_16x16x32_bf16 v[96:99], a[104:107], a[248:251], v[96:99]
    ds_read_b128 a[212:215], v2 offset:40960
    v_sub_f32 v79, v79, v14
    v_mfma_f32_16x16x32_bf16 v[96:99], a[108:111], a[192:195], v[96:99]
    v_exp_f32 v93, v93
    v_mfma_f32_16x16x32_bf16 v[96:99], a[112:115], a[196:199], v[96:99]
    ds_read_b128 a[216:219], v2 offset:41984
    v_add_f32 v23, v23, v91
    v_mfma_f32_16x16x32_bf16 v[96:99], a[116:119], a[200:203], v[96:99]
    v_exp_f32 v78, v78
    v_mfma_f32_16x16x32_bf16 v[100:103], a[120:123], a[240:243], 0
    ds_read_b128 a[220:223], v2 offset:43008
    v_sub_f32 v95, v95, v15
    v_mfma_f32_16x16x32_bf16 v[100:103], a[124:127], a[244:247], v[100:103]
    v_exp_f32 v94, v94
    v_mfma_f32_16x16x32_bf16 v[100:103], a[128:131], a[248:251], v[100:103]
    ds_read_b128 a[224:227], v2 offset:44032
    v_add_f32 v22, v22, v76
    v_mfma_f32_16x16x32_bf16 v[100:103], a[132:135], a[192:195], v[100:103]
    buffer_store_dwordx2 v[224:225], v11, s[12:15], s33 offen offset:0 sc1
    v_mfma_f32_16x16x32_bf16 v[100:103], a[136:139], a[196:199], v[100:103]
    v_exp_f32 v79, v79
    v_mfma_f32_16x16x32_bf16 v[100:103], a[140:143], a[200:203], v[100:103]
    v_add_f32 v23, v23, v92
    v_add_f32 v22, v22, v77
    v_mfma_f32_16x16x32_bf16 v[104:107], a[144:147], a[240:243], 0
    v_exp_f32 v95, v95
    v_mfma_f32_16x16x32_bf16 v[104:107], a[148:151], a[244:247], v[104:107]
    v_add_f32 v23, v23, v93
    v_add_f32 v22, v22, v78
    v_mfma_f32_16x16x32_bf16 v[104:107], a[152:155], a[248:251], v[104:107]
    v_add_f32 v23, v23, v94
    v_add_f32 v22, v22, v79
    v_mfma_f32_16x16x32_bf16 v[104:107], a[156:159], a[192:195], v[104:107]
    v_add_f32 v23, v23, v95
    v_cvt_pk_bf16_f32 v232, v208, v212
    v_mfma_f32_16x16x32_bf16 v[104:107], a[160:163], a[196:199], v[104:107]
    buffer_store_dwordx2 v[226:227], v11, s[12:15], s33 offen offset:384 sc1
    v_mfma_f32_16x16x32_bf16 v[104:107], a[164:167], a[200:203], v[104:107]
    v_cvt_pk_bf16_f32 v233, v216, v220
    v_permlane16_swap_b32 v22, v23
    v_mfma_f32_16x16x32_bf16 v[108:111], a[168:171], a[240:243], 0
    v_add_f32 v22, v22, v23
    v_mov_b32 v23, v22
    v_mfma_f32_16x16x32_bf16 v[108:111], a[172:175], a[244:247], v[108:111]
    v_cvt_pk_bf16_f32 v234, v209, v213
    v_permlane32_swap_b32 v22, v23
    v_mfma_f32_16x16x32_bf16 v[108:111], a[176:179], a[248:251], v[108:111]
    v_add_f32 v22, v22, v23
    v_cvt_pk_bf16_f32 v235, v217, v221
    v_mfma_f32_16x16x32_bf16 v[108:111], a[180:183], a[192:195], v[108:111]
    v_rcp_f32 v22, v22
    v_mfma_f32_16x16x32_bf16 v[108:111], a[184:187], a[196:199], v[108:111]
    v_mov_b32 v23, v22
    v_cvt_pk_bf16_f32 v236, v210, v214
    v_mfma_f32_16x16x32_bf16 v[108:111], a[188:191], a[200:203], v[108:111]
    buffer_store_dwordx2 v[228:229], v11, s[12:15], s33 offen offset:768 sc1
    s_waitcnt lgkmcnt(0)
    v_mfma_f32_16x16x32_bf16 v[112:115], a[96:99], a[204:207], 0
    v_permlane16_swap_b32 v22, v23
    v_mul_f32 v64, v64, v22
    v_mfma_f32_16x16x32_bf16 v[112:115], a[100:103], a[208:211], v[112:115]
    v_mul_f32 v65, v65, v22
    v_mul_f32 v66, v66, v22
    v_mfma_f32_16x16x32_bf16 v[112:115], a[104:107], a[212:215], v[112:115]
    v_mul_f32 v67, v67, v22
    v_mul_f32 v68, v68, v22
    v_mfma_f32_16x16x32_bf16 v[112:115], a[108:111], a[216:219], v[112:115]
    v_mul_f32 v69, v69, v22
    v_mul_f32 v70, v70, v22
    v_mfma_f32_16x16x32_bf16 v[112:115], a[112:115], a[220:223], v[112:115]
    buffer_load_dwordx4 a[88:91], v9, s[8:11], s30 offen offset:256 nt
    v_mul_f32 v71, v71, v22
    v_mfma_f32_16x16x32_bf16 v[112:115], a[116:119], a[224:227], v[112:115]
    buffer_load_dwordx4 a[92:95], v10, s[8:11], s30 offen offset:256 nt
    v_cvt_pk_bf16_f32 v48, v64, v65
    v_mfma_f32_16x16x32_bf16 v[116:119], a[120:123], a[204:207], 0
    buffer_store_dwordx2 v[230:231], v11, s[12:15], s33 offen offset:1152 sc1
    v_mfma_f32_16x16x32_bf16 v[116:119], a[124:127], a[208:211], v[116:119]
    v_cvt_pk_bf16_f32 v49, v66, v67
    v_cvt_pk_bf16_f32 v50, v68, v69
    v_mfma_f32_16x16x32_bf16 v[116:119], a[128:131], a[212:215], v[116:119]
    v_cvt_pk_bf16_f32 v51, v70, v71
    v_mul_f32 v72, v72, v22
    v_mfma_f32_16x16x32_bf16 v[116:119], a[132:135], a[216:219], v[116:119]
    v_mul_f32 v73, v73, v22
    v_mul_f32 v74, v74, v22
    v_mfma_f32_16x16x32_bf16 v[116:119], a[136:139], a[220:223], v[116:119]
    v_mul_f32 v75, v75, v22
    v_mul_f32 v76, v76, v22
    v_mfma_f32_16x16x32_bf16 v[116:119], a[140:143], a[224:227], v[116:119]
    v_mul_f32 v77, v77, v22
    v_mul_f32 v78, v78, v22
    v_mfma_f32_16x16x32_bf16 v[120:123], a[144:147], a[204:207], 0
    v_mul_f32 v79, v79, v22
    v_cvt_pk_bf16_f32 v52, v72, v73
    v_mfma_f32_16x16x32_bf16 v[120:123], a[148:151], a[208:211], v[120:123]
    buffer_store_dwordx2 v[232:233], v11, s[12:15], s35 offen offset:0 sc1
    v_mfma_f32_16x16x32_bf16 v[120:123], a[152:155], a[212:215], v[120:123]
    ds_read_b128 a[228:231], v2 offset:45056
    v_cvt_pk_bf16_f32 v53, v74, v75
    v_mfma_f32_16x16x32_bf16 v[120:123], a[156:159], a[216:219], v[120:123]
    v_cvt_pk_bf16_f32 v54, v76, v77
    v_cvt_pk_bf16_f32 v55, v78, v79
    v_mfma_f32_16x16x32_bf16 v[120:123], a[160:163], a[220:223], v[120:123]
    ds_read_b128 a[232:235], v2 offset:46080
    v_mul_f32 v80, v80, v23
    v_mfma_f32_16x16x32_bf16 v[120:123], a[164:167], a[224:227], v[120:123]
    v_mul_f32 v81, v81, v23
    v_mul_f32 v82, v82, v23
    v_mfma_f32_16x16x32_bf16 v[124:127], a[168:171], a[204:207], 0
    ds_read_b128 a[236:239], v2 offset:47104
    v_mul_f32 v83, v83, v23
    v_mfma_f32_16x16x32_bf16 v[124:127], a[172:175], a[208:211], v[124:127]
    v_mul_f32 v84, v84, v23
    v_mul_f32 v85, v85, v23
    v_mfma_f32_16x16x32_bf16 v[124:127], a[176:179], a[212:215], v[124:127]
    buffer_store_dwordx2 v[234:235], v11, s[12:15], s35 offen offset:384 sc1
    v_mfma_f32_16x16x32_bf16 v[124:127], a[180:183], a[216:219], v[124:127]
    ds_read_b128 a[240:243], v2 offset:48128
    v_mul_f32 v86, v86, v23
    v_mfma_f32_16x16x32_bf16 v[124:127], a[184:187], a[220:223], v[124:127]
    ds_read_b128 a[244:247], v2 offset:49152
    v_mul_f32 v87, v87, v23
    v_mfma_f32_16x16x32_bf16 v[124:127], a[188:191], a[224:227], v[124:127]
    v_cvt_pk_bf16_f32 v56, v80, v81
    v_cvt_pk_bf16_f32 v57, v82, v83
    v_mfma_f32_16x16x32_bf16 v[64:67], v[48:51], v[128:131], 0
    ds_read_b128 a[248:251], v2 offset:50176
    v_cvt_pk_bf16_f32 v58, v84, v85
    v_mfma_f32_16x16x32_bf16 v[64:67], v[52:55], v[132:135], v[64:67]
    v_cvt_pk_bf16_f32 v59, v86, v87
    v_mul_f32 v88, v88, v23
    v_mfma_f32_16x16x32_bf16 v[68:71], v[48:51], v[136:139], 0
    v_mul_f32 v89, v89, v23
    v_mul_f32 v90, v90, v23
    v_mfma_f32_16x16x32_bf16 v[68:71], v[52:55], v[140:143], v[68:71]
    v_mul_f32 v91, v91, v23
    v_mul_f32 v92, v92, v23
    v_mfma_f32_16x16x32_bf16 v[72:75], v[48:51], v[144:147], 0
    v_mul_f32 v93, v93, v23
    v_mul_f32 v94, v94, v23
    v_mfma_f32_16x16x32_bf16 v[72:75], v[52:55], v[148:151], v[72:75]
    v_mul_f32 v95, v95, v23
    v_cvt_pk_bf16_f32 v60, v88, v89
    v_mfma_f32_16x16x32_bf16 v[76:79], v[48:51], v[152:155], 0
    v_cvt_pk_bf16_f32 v61, v90, v91
    v_cvt_pk_bf16_f32 v62, v92, v93
    v_mfma_f32_16x16x32_bf16 v[76:79], v[52:55], v[156:159], v[76:79]
    v_cvt_pk_bf16_f32 v63, v94, v95
    v_cvt_pk_bf16_f32 v237, v218, v222
    v_mfma_f32_16x16x32_bf16 v[80:83], v[56:59], v[128:131], 0
    buffer_store_dwordx2 v[236:237], v11, s[12:15], s35 offen offset:768 sc1
    v_mfma_f32_16x16x32_bf16 v[80:83], v[60:63], v[132:135], v[80:83]
    v_cvt_pk_bf16_f32 v238, v211, v215
    v_cvt_pk_bf16_f32 v239, v219, v223
    v_mfma_f32_16x16x32_bf16 v[84:87], v[56:59], v[136:139], 0
    buffer_store_dwordx2 v[238:239], v11, s[12:15], s35 offen offset:1152 sc1
    v_mfma_f32_16x16x32_bf16 v[84:87], v[60:63], v[140:143], v[84:87]
    v_cvt_pk_bf16_f32 v160, v96, v97
    v_cvt_pk_bf16_f32 v161, v98, v99
    v_mfma_f32_16x16x32_bf16 v[88:91], v[56:59], v[144:147], 0
    v_cvt_pk_bf16_f32 v162, v100, v101
    v_cvt_pk_bf16_f32 v163, v102, v103
    v_mfma_f32_16x16x32_bf16 v[88:91], v[60:63], v[148:151], v[88:91]
    v_cvt_pk_bf16_f32 v164, v104, v105
    v_cvt_pk_bf16_f32 v165, v106, v107
    v_mfma_f32_16x16x32_bf16 v[92:95], v[56:59], v[152:155], 0
    ds_read_b128 a[192:195], v2 offset:51200
    v_cvt_pk_bf16_f32 v240, v64, v68
    v_mfma_f32_16x16x32_bf16 v[92:95], v[60:63], v[156:159], v[92:95]
    v_cvt_pk_bf16_f32 v241, v72, v76
    s_waitcnt lgkmcnt(1)
    v_mfma_f32_16x16x32_bf16 v[96:99], a[96:99], a[228:231], 0
    ds_read_b128 a[196:199], v2 offset:52224
    v_cvt_pk_bf16_f32 v166, v108, v109
    v_mfma_f32_16x16x32_bf16 v[96:99], a[100:103], a[232:235], v[96:99]
    v_cvt_pk_bf16_f32 v167, v110, v111
    v_cvt_pk_bf16_f32 v242, v65, v69
    v_mfma_f32_16x16x32_bf16 v[96:99], a[104:107], a[236:239], v[96:99]
    ds_read_b128 a[200:203], v2 offset:53248
    v_cvt_pk_bf16_f32 v243, v73, v77
    v_mfma_f32_16x16x32_bf16 v[96:99], a[108:111], a[240:243], v[96:99]
    v_cvt_pk_bf16_f32 v168, v112, v113
    v_cvt_pk_bf16_f32 v169, v114, v115
    v_mfma_f32_16x16x32_bf16 v[96:99], a[112:115], a[244:247], v[96:99]
    ds_read_b128 a[204:207], v2 offset:54272
    v_cvt_pk_bf16_f32 v170, v116, v117
    v_mfma_f32_16x16x32_bf16 v[96:99], a[116:119], a[248:251], v[96:99]
    v_cvt_pk_bf16_f32 v171, v118, v119
    v_cvt_pk_bf16_f32 v244, v66, v70
    v_mfma_f32_16x16x32_bf16 v[100:103], a[120:123], a[228:231], 0
    ds_read_b128 a[208:211], v2 offset:55296
    v_cvt_pk_bf16_f32 v245, v74, v78
    v_mfma_f32_16x16x32_bf16 v[100:103], a[124:127], a[232:235], v[100:103]
    v_cvt_pk_bf16_f32 v172, v120, v121
    v_cvt_pk_bf16_f32 v173, v122, v123
    v_mfma_f32_16x16x32_bf16 v[100:103], a[128:131], a[236:239], v[100:103]
    buffer_store_dwordx2 v[240:241], v11, s[12:15], s37 offen offset:0 sc1
    v_mfma_f32_16x16x32_bf16 v[100:103], a[132:135], a[240:243], v[100:103]
    ds_read_b128 a[212:215], v2 offset:56320
    v_cvt_pk_bf16_f32 v246, v67, v71
    v_mfma_f32_16x16x32_bf16 v[100:103], a[136:139], a[244:247], v[100:103]
    v_cvt_pk_bf16_f32 v247, v75, v79
    v_cvt_pk_bf16_f32 v174, v124, v125
    v_mfma_f32_16x16x32_bf16 v[100:103], a[140:143], a[248:251], v[100:103]
    v_cvt_pk_bf16_f32 v175, v126, v127
    v_cvt_pk_bf16_f32 v248, v80, v84
    v_mfma_f32_16x16x32_bf16 v[104:107], a[144:147], a[228:231], 0
    v_cvt_pk_bf16_f32 v249, v88, v92
    v_cvt_pk_bf16_f32 v176, v96, v97
    v_mfma_f32_16x16x32_bf16 v[104:107], a[148:151], a[232:235], v[104:107]
    v_cvt_pk_bf16_f32 v177, v98, v99
    v_cvt_pk_bf16_f32 v250, v81, v85
    v_mfma_f32_16x16x32_bf16 v[104:107], a[152:155], a[236:239], v[104:107]
    v_cvt_pk_bf16_f32 v178, v100, v101
    v_cvt_pk_bf16_f32 v179, v102, v103
    v_mfma_f32_16x16x32_bf16 v[104:107], a[156:159], a[240:243], v[104:107]
    v_cvt_pk_bf16_f32 v251, v89, v93
    v_cvt_pk_bf16_f32 v252, v82, v86
    v_mfma_f32_16x16x32_bf16 v[104:107], a[160:163], a[244:247], v[104:107]
    buffer_store_dwordx2 v[242:243], v11, s[12:15], s37 offen offset:384 sc1
    v_mfma_f32_16x16x32_bf16 v[104:107], a[164:167], a[248:251], v[104:107]
    v_cvt_pk_bf16_f32 v254, v83, v87
    v_cvt_pk_bf16_f32 v253, v90, v94
    v_mfma_f32_16x16x32_bf16 v[108:111], a[168:171], a[228:231], 0
    v_cvt_pk_bf16_f32 v255, v91, v95
    s_add_u32 s30, s16, 10616832
    v_mfma_f32_16x16x32_bf16 v[108:111], a[172:175], a[232:235], v[108:111]
    s_add_u32 s16, s16, 6291456
    s_add_u32 s32, s16, 0
    v_mfma_f32_16x16x32_bf16 v[108:111], a[176:179], a[236:239], v[108:111]
    s_waitcnt vmcnt(63)
    ds_write_b64 v16, a[24:25] offset:0
    v_mfma_f32_16x16x32_bf16 v[108:111], a[180:183], a[240:243], v[108:111]
    ds_write_b64 v16, a[26:27] offset:1024
    v_mfma_f32_16x16x32_bf16 v[108:111], a[184:187], a[244:247], v[108:111]
    ds_write_b64 v16, a[28:29] offset:512
    v_mfma_f32_16x16x32_bf16 v[108:111], a[188:191], a[248:251], v[108:111]
    ds_write_b64 v16, a[30:31] offset:1536
    s_waitcnt lgkmcnt(4)
    v_mfma_f32_16x16x32_bf16 v[112:115], a[96:99], a[192:195], 0
    buffer_store_dwordx2 v[244:245], v11, s[12:15], s37 offen offset:768 sc1
    v_mfma_f32_16x16x32_bf16 v[112:115], a[100:103], a[196:199], v[112:115]
    ds_read2_b64 a[24:27], v17 offset0:0 offset1:128
    v_cvt_pk_bf16_f32 v180, v104, v105
    v_mfma_f32_16x16x32_bf16 v[112:115], a[104:107], a[200:203], v[112:115]
    ds_read2_b64 a[28:31], v18 offset0:0 offset1:128
    v_cvt_pk_bf16_f32 v181, v106, v107
    v_mfma_f32_16x16x32_bf16 v[112:115], a[108:111], a[204:207], v[112:115]
    v_cvt_pk_bf16_f32 v182, v108, v109
    v_cvt_pk_bf16_f32 v183, v110, v111
    v_mfma_f32_16x16x32_bf16 v[112:115], a[112:115], a[208:211], v[112:115]
    s_add_u32 s34, s16, 393216
    s_add_u32 s36, s16, 786432
    v_mfma_f32_16x16x32_bf16 v[112:115], a[116:119], a[212:215], v[112:115]
    s_add_u32 s38, s16, 1179648
    v_mfma_f32_16x16x32_bf16 v[116:119], a[120:123], a[192:195], 0
    v_mfma_f32_16x16x32_bf16 v[116:119], a[124:127], a[196:199], v[116:119]
    v_mfma_f32_16x16x32_bf16 v[116:119], a[128:131], a[200:203], v[116:119]
    buffer_store_dwordx2 v[246:247], v11, s[12:15], s37 offen offset:1152 sc1
    v_mfma_f32_16x16x32_bf16 v[116:119], a[132:135], a[204:207], v[116:119]
    v_cvt_pk_bf16_f32 v184, v112, v113
    v_cvt_pk_bf16_f32 v185, v114, v115
    v_mfma_f32_16x16x32_bf16 v[116:119], a[136:139], a[208:211], v[116:119]
    v_mfma_f32_16x16x32_bf16 v[116:119], a[140:143], a[212:215], v[116:119]
    v_mfma_f32_16x16x32_bf16 v[120:123], a[144:147], a[192:195], 0
    v_mfma_f32_16x16x32_bf16 v[120:123], a[148:151], a[196:199], v[120:123]
    v_mfma_f32_16x16x32_bf16 v[120:123], a[152:155], a[200:203], v[120:123]
    v_cvt_pk_bf16_f32 v186, v116, v117
    v_cvt_pk_bf16_f32 v187, v118, v119
    v_mfma_f32_16x16x32_bf16 v[120:123], a[156:159], a[204:207], v[120:123]
    v_mfma_f32_16x16x32_bf16 v[120:123], a[160:163], a[208:211], v[120:123]
    buffer_store_dwordx2 v[248:249], v11, s[12:15], s39 offen offset:0 sc1
    v_mfma_f32_16x16x32_bf16 v[120:123], a[164:167], a[212:215], v[120:123]
    s_waitcnt vmcnt(60)
    ds_write_b64 v16, a[32:33] offset:0
    v_mfma_f32_16x16x32_bf16 v[124:127], a[168:171], a[192:195], 0
    ds_write_b64 v16, a[34:35] offset:1024
    v_mfma_f32_16x16x32_bf16 v[124:127], a[172:175], a[196:199], v[124:127]
    ds_write_b64 v16, a[36:37] offset:512
    v_mfma_f32_16x16x32_bf16 v[124:127], a[176:179], a[200:203], v[124:127]
    ds_write_b64 v16, a[38:39] offset:1536
    v_mfma_f32_16x16x32_bf16 v[124:127], a[180:183], a[204:207], v[124:127]
    ds_read2_b64 a[32:35], v17 offset0:0 offset1:128
    v_cvt_pk_bf16_f32 v188, v120, v121
    v_mfma_f32_16x16x32_bf16 v[124:127], a[184:187], a[208:211], v[124:127]
    ds_read2_b64 a[36:39], v18 offset0:0 offset1:128
    v_cvt_pk_bf16_f32 v189, v122, v123
    v_mfma_f32_16x16x32_bf16 v[124:127], a[188:191], a[212:215], v[124:127]
    v_mfma_f32_16x16x32_bf16 v[64:67], v[32:35], v[160:163], 0
    buffer_store_dwordx2 v[250:251], v11, s[12:15], s39 offen offset:384 sc1
    v_mfma_f32_16x16x32_bf16 v[64:67], v[36:39], v[164:167], v[64:67]
    v_mfma_f32_16x16x32_bf16 v[68:71], v[32:35], v[168:171], 0
    v_cvt_pk_bf16_f32 v190, v124, v125
    v_cvt_pk_bf16_f32 v191, v126, v127
    v_mfma_f32_16x16x32_bf16 v[68:71], v[36:39], v[172:175], v[68:71]
    v_mfma_f32_16x16x32_bf16 v[72:75], v[32:35], v[176:179], 0
    v_mfma_f32_16x16x32_bf16 v[72:75], v[36:39], v[180:183], v[72:75]
    v_mfma_f32_16x16x32_bf16 v[76:79], v[32:35], v[184:187], 0
    ds_read_b128 a[216:219], v2 offset:57344
    v_cvt_pk_bf16_f32 v128, v64, v68
    v_mfma_f32_16x16x32_bf16 v[76:79], v[36:39], v[188:191], v[76:79]
    v_cvt_pk_bf16_f32 v130, v65, v69
    v_cvt_pk_bf16_f32 v132, v66, v70
    v_mfma_f32_16x16x32_bf16 v[80:83], v[40:43], v[160:163], 0
    buffer_store_dwordx2 v[252:253], v11, s[12:15], s39 offen offset:768 sc1
    v_mfma_f32_16x16x32_bf16 v[80:83], v[44:47], v[164:167], v[80:83]
    ds_read_b128 a[220:223], v2 offset:58368
    v_cvt_pk_bf16_f32 v134, v67, v71
    v_mfma_f32_16x16x32_bf16 v[84:87], v[40:43], v[168:171], 0
    ds_read_b128 a[224:227], v2 offset:59392
    v_cvt_pk_bf16_f32 v129, v72, v76
    v_mfma_f32_16x16x32_bf16 v[84:87], v[44:47], v[172:175], v[84:87]
    v_cvt_pk_bf16_f32 v131, v73, v77
    v_cvt_pk_bf16_f32 v133, v74, v78
    v_mfma_f32_16x16x32_bf16 v[88:91], v[40:43], v[176:179], 0
    ds_read_b128 a[228:231], v2 offset:60416
    v_cvt_pk_bf16_f32 v135, v75, v79
    v_mfma_f32_16x16x32_bf16 v[88:91], v[44:47], v[180:183], v[88:91]
    s_waitcnt vmcnt(55)
    ds_write_b64 v16, a[40:41] offset:0
    v_mfma_f32_16x16x32_bf16 v[92:95], v[40:43], v[184:187], 0
    ds_read_b128 a[232:235], v2 offset:61440
    v_cvt_pk_bf16_f32 v136, v80, v84
    v_mfma_f32_16x16x32_bf16 v[92:95], v[44:47], v[188:191], v[92:95]
    ds_write_b64 v16, a[42:43] offset:1024
    v_mfma_f32_16x16x32_bf16 v[192:195], v[48:51], v[160:163], 0
    buffer_store_dwordx2 v[254:255], v11, s[12:15], s39 offen offset:1152 sc1
    v_mfma_f32_16x16x32_bf16 v[192:195], v[52:55], v[164:167], v[192:195]
    ds_read_b128 a[236:239], v2 offset:62464
    v_cvt_pk_bf16_f32 v138, v81, v85
    v_mfma_f32_16x16x32_bf16 v[196:199], v[48:51], v[168:171], 0
    ds_write_b64 v16, a[44:45] offset:512
    v_mfma_f32_16x16x32_bf16 v[196:199], v[52:55], v[172:175], v[196:199]
    ds_write_b64 v16, a[46:47] offset:1536
    v_mfma_f32_16x16x32_bf16 v[200:203], v[48:51], v[176:179], 0
    ds_read2_b64 a[40:43], v17 offset0:0 offset1:128
    v_cvt_pk_bf16_f32 v137, v88, v92
    v_mfma_f32_16x16x32_bf16 v[200:203], v[52:55], v[180:183], v[200:203]
    ds_read2_b64 a[44:47], v18 offset0:0 offset1:128
    v_cvt_pk_bf16_f32 v139, v89, v93
    v_mfma_f32_16x16x32_bf16 v[204:207], v[48:51], v[184:187], 0
    v_cvt_pk_bf16_f32 v140, v82, v86
    v_cvt_pk_bf16_f32 v141, v90, v94
    v_mfma_f32_16x16x32_bf16 v[204:207], v[52:55], v[188:191], v[204:207]
    v_cvt_pk_bf16_f32 v144, v192, v196
    v_cvt_pk_bf16_f32 v146, v193, v197
    v_mfma_f32_16x16x32_bf16 v[208:211], v[56:59], v[160:163], 0
    v_cvt_pk_bf16_f32 v142, v83, v87
    v_cvt_pk_bf16_f32 v143, v91, v95
    v_mfma_f32_16x16x32_bf16 v[208:211], v[60:63], v[164:167], v[208:211]
    v_cvt_pk_bf16_f32 v148, v194, v198
    v_cvt_pk_bf16_f32 v150, v195, v199
    v_mfma_f32_16x16x32_bf16 v[212:215], v[56:59], v[168:171], 0
    v_cvt_pk_bf16_f32 v145, v200, v204
    v_cvt_pk_bf16_f32 v147, v201, v205
    v_mfma_f32_16x16x32_bf16 v[212:215], v[60:63], v[172:175], v[212:215]
    v_cvt_pk_bf16_f32 v149, v202, v206
    v_cvt_pk_bf16_f32 v151, v203, v207
    v_mfma_f32_16x16x32_bf16 v[216:219], v[56:59], v[176:179], 0
    v_mfma_f32_16x16x32_bf16 v[216:219], v[60:63], v[180:183], v[216:219]
    v_mfma_f32_16x16x32_bf16 v[220:223], v[56:59], v[184:187], 0
    ds_read_b128 a[240:243], v2 offset:63488
    v_cvt_pk_bf16_f32 v152, v208, v212
    v_mfma_f32_16x16x32_bf16 v[220:223], v[60:63], v[188:191], v[220:223]
    v_cvt_pk_bf16_f32 v154, v209, v213
    s_waitcnt lgkmcnt(5)
    v_mfma_f32_16x16x32_bf16 v[96:99], a[96:99], a[216:219], 0
    ds_read_b128 a[244:247], v2 offset:64512
    v_cvt_pk_bf16_f32 v156, v210, v214
    v_mfma_f32_16x16x32_bf16 v[96:99], a[100:103], a[220:223], v[96:99]
    s_waitcnt vmcnt(48)
    ds_write_b64 v16, a[48:49] offset:0
    v_mfma_f32_16x16x32_bf16 v[96:99], a[104:107], a[224:227], v[96:99]
    ds_read_b128 a[248:251], v3 offset:0
    v_cvt_pk_bf16_f32 v153, v216, v220
    v_mfma_f32_16x16x32_bf16 v[96:99], a[108:111], a[228:231], v[96:99]
    ds_write_b64 v16, a[50:51] offset:1024
    v_mfma_f32_16x16x32_bf16 v[96:99], a[112:115], a[232:235], v[96:99]
    ds_read_b128 a[192:195], v3 offset:1024
    v_cvt_pk_bf16_f32 v155, v217, v221
    v_mfma_f32_16x16x32_bf16 v[96:99], a[116:119], a[236:239], v[96:99]
    ds_write_b64 v16, a[52:53] offset:512
    v_mfma_f32_16x16x32_bf16 v[100:103], a[120:123], a[216:219], 0
    ds_read_b128 a[196:199], v3 offset:2048
    v_cvt_pk_bf16_f32 v157, v218, v222
    v_mfma_f32_16x16x32_bf16 v[100:103], a[124:127], a[220:223], v[100:103]
    ds_write_b64 v16, a[54:55] offset:1536
    v_mfma_f32_16x16x32_bf16 v[100:103], a[128:131], a[224:227], v[100:103]
    ds_read_b128 a[200:203], v3 offset:3072
    v_cvt_pk_bf16_f32 v192, v96, v97
    v_mfma_f32_16x16x32_bf16 v[100:103], a[132:135], a[228:231], v[100:103]
    ds_read2_b64 a[48:51], v17 offset0:0 offset1:128
    v_cvt_pk_bf16_f32 v193, v98, v99
    v_mfma_f32_16x16x32_bf16 v[100:103], a[136:139], a[232:235], v[100:103]
    buffer_store_dwordx2 v[128:129], v11, s[12:15], s33 offen offset:128 sc1
    v_mfma_f32_16x16x32_bf16 v[100:103], a[140:143], a[236:239], v[100:103]
    ds_read2_b64 a[52:55], v18 offset0:0 offset1:128
    v_cvt_pk_bf16_f32 v158, v211, v215
    v_mfma_f32_16x16x32_bf16 v[104:107], a[144:147], a[216:219], 0
    v_cvt_pk_bf16_f32 v159, v219, v223
    v_mfma_f32_16x16x32_bf16 v[104:107], a[148:151], a[220:223], v[104:107]
    v_mfma_f32_16x16x32_bf16 v[104:107], a[152:155], a[224:227], v[104:107]
    v_cvt_pk_bf16_f32 v194, v100, v101
    v_cvt_pk_bf16_f32 v195, v102, v103
    v_mfma_f32_16x16x32_bf16 v[104:107], a[156:159], a[228:231], v[104:107]
    buffer_store_dwordx2 v[130:131], v11, s[12:15], s33 offen offset:512 sc1
    v_mfma_f32_16x16x32_bf16 v[104:107], a[160:163], a[232:235], v[104:107]
    v_mfma_f32_16x16x32_bf16 v[104:107], a[164:167], a[236:239], v[104:107]
    v_mfma_f32_16x16x32_bf16 v[108:111], a[168:171], a[216:219], 0
    v_mfma_f32_16x16x32_bf16 v[108:111], a[172:175], a[220:223], v[108:111]
    v_mfma_f32_16x16x32_bf16 v[108:111], a[176:179], a[224:227], v[108:111]
    buffer_store_dwordx2 v[132:133], v11, s[12:15], s33 offen offset:896 sc1
    v_mfma_f32_16x16x32_bf16 v[108:111], a[180:183], a[228:231], v[108:111]
    s_waitcnt vmcnt(44)
    ds_write_b64 v16, a[56:57] offset:0
    v_mfma_f32_16x16x32_bf16 v[108:111], a[184:187], a[232:235], v[108:111]
    ds_read_b128 a[204:207], v3 offset:4096
    v_cvt_pk_bf16_f32 v196, v104, v105
    v_mfma_f32_16x16x32_bf16 v[108:111], a[188:191], a[236:239], v[108:111]
    ds_write_b64 v16, a[58:59] offset:1024
    s_waitcnt lgkmcnt(4)
    v_mfma_f32_16x16x32_bf16 v[112:115], a[96:99], a[240:243], 0
    ds_read_b128 a[208:211], v3 offset:5120
    v_cvt_pk_bf16_f32 v197, v106, v107
    v_mfma_f32_16x16x32_bf16 v[112:115], a[100:103], a[244:247], v[112:115]
    buffer_store_dwordx2 v[134:135], v11, s[12:15], s33 offen offset:1280 sc1
    v_mfma_f32_16x16x32_bf16 v[112:115], a[104:107], a[248:251], v[112:115]
    ds_read_b128 a[212:215], v3 offset:6144
    v_cvt_pk_bf16_f32 v198, v108, v109
    v_mfma_f32_16x16x32_bf16 v[112:115], a[108:111], a[192:195], v[112:115]
    ds_write_b64 v16, a[60:61] offset:512
    v_mfma_f32_16x16x32_bf16 v[112:115], a[112:115], a[196:199], v[112:115]
    ds_read_b128 a[216:219], v3 offset:7168
    v_cvt_pk_bf16_f32 v199, v110, v111
    v_mfma_f32_16x16x32_bf16 v[112:115], a[116:119], a[200:203], v[112:115]
    ds_write_b64 v16, a[62:63] offset:1536
    v_mfma_f32_16x16x32_bf16 v[116:119], a[120:123], a[240:243], 0
    buffer_store_dwordx2 v[136:137], v11, s[12:15], s35 offen offset:128 sc1
    v_mfma_f32_16x16x32_bf16 v[116:119], a[124:127], a[244:247], v[116:119]
    ds_read_b128 a[220:223], v3 offset:8192
    v_mfma_f32_16x16x32_bf16 v[116:119], a[128:131], a[248:251], v[116:119]
    ds_read_b128 a[224:227], v3 offset:9216
    v_cvt_pk_bf16_f32 v200, v112, v113
    v_mfma_f32_16x16x32_bf16 v[116:119], a[132:135], a[192:195], v[116:119]
    ds_read2_b64 a[56:59], v17 offset0:0 offset1:128
    v_cvt_pk_bf16_f32 v201, v114, v115
    v_mfma_f32_16x16x32_bf16 v[116:119], a[136:139], a[196:199], v[116:119]
    ds_read2_b64 a[60:63], v18 offset0:0 offset1:128
    v_mfma_f32_16x16x32_bf16 v[116:119], a[140:143], a[200:203], v[116:119]
    buffer_store_dwordx2 v[138:139], v11, s[12:15], s35 offen offset:512 sc1
    v_mfma_f32_16x16x32_bf16 v[120:123], a[144:147], a[240:243], 0
    v_mfma_f32_16x16x32_bf16 v[120:123], a[148:151], a[244:247], v[120:123]
    v_mfma_f32_16x16x32_bf16 v[120:123], a[152:155], a[248:251], v[120:123]
    v_cvt_pk_bf16_f32 v202, v116, v117
    v_cvt_pk_bf16_f32 v203, v118, v119
    v_mfma_f32_16x16x32_bf16 v[120:123], a[156:159], a[192:195], v[120:123]
    v_mfma_f32_16x16x32_bf16 v[120:123], a[160:163], a[196:199], v[120:123]
    buffer_store_dwordx2 v[140:141], v11, s[12:15], s35 offen offset:896 sc1
    v_mfma_f32_16x16x32_bf16 v[120:123], a[164:167], a[200:203], v[120:123]
    s_waitcnt vmcnt(41)
    ds_write_b64 v16, a[64:65] offset:0
    v_mfma_f32_16x16x32_bf16 v[124:127], a[168:171], a[240:243], 0
    ds_write_b64 v16, a[66:67] offset:1024
    v_mfma_f32_16x16x32_bf16 v[124:127], a[172:175], a[244:247], v[124:127]
    ds_write_b64 v16, a[68:69] offset:512
    v_mfma_f32_16x16x32_bf16 v[124:127], a[176:179], a[248:251], v[124:127]
    ds_write_b64 v16, a[70:71] offset:1536
    v_mfma_f32_16x16x32_bf16 v[124:127], a[180:183], a[192:195], v[124:127]
    buffer_store_dwordx2 v[142:143], v11, s[12:15], s35 offen offset:1280 sc1
    v_mfma_f32_16x16x32_bf16 v[124:127], a[184:187], a[196:199], v[124:127]
    ds_read_b128 a[228:231], v3 offset:10240
    v_cvt_pk_bf16_f32 v204, v120, v121
    v_mfma_f32_16x16x32_bf16 v[124:127], a[188:191], a[200:203], v[124:127]
    ds_read2_b64 a[64:67], v17 offset0:0 offset1:128
    s_waitcnt lgkmcnt(6)
    v_mfma_f32_16x16x32_bf16 v[96:99], a[96:99], a[204:207], 0
    ds_read_b128 a[232:235], v3 offset:11264
    v_cvt_pk_bf16_f32 v205, v122, v123
    v_mfma_f32_16x16x32_bf16 v[96:99], a[100:103], a[208:211], v[96:99]
    ds_read2_b64 a[68:71], v18 offset0:0 offset1:128
    v_mfma_f32_16x16x32_bf16 v[96:99], a[104:107], a[212:215], v[96:99]
    buffer_store_dwordx2 v[144:145], v11, s[12:15], s37 offen offset:128 sc1
    v_mfma_f32_16x16x32_bf16 v[96:99], a[108:111], a[216:219], v[96:99]
    ds_read_b128 a[236:239], v3 offset:12288
    v_cvt_pk_bf16_f32 v206, v124, v125
    v_mfma_f32_16x16x32_bf16 v[96:99], a[112:115], a[220:223], v[96:99]
    ds_read_b128 a[240:243], v3 offset:13312
    v_cvt_pk_bf16_f32 v207, v126, v127
    v_mfma_f32_16x16x32_bf16 v[96:99], a[116:119], a[224:227], v[96:99]
    v_mfma_f32_16x16x32_bf16 v[100:103], a[120:123], a[204:207], 0
    ds_read_b128 a[244:247], v3 offset:14336
    v_mfma_f32_16x16x32_bf16 v[100:103], a[124:127], a[208:211], v[100:103]
    buffer_store_dwordx2 v[146:147], v11, s[12:15], s37 offen offset:512 sc1
    v_mfma_f32_16x16x32_bf16 v[100:103], a[128:131], a[212:215], v[100:103]
    ds_read_b128 a[248:251], v3 offset:15360
    v_cvt_pk_bf16_f32 v208, v96, v97
    v_mfma_f32_16x16x32_bf16 v[100:103], a[132:135], a[216:219], v[100:103]
    v_cvt_pk_bf16_f32 v209, v98, v99
    v_mfma_f32_16x16x32_bf16 v[100:103], a[136:139], a[220:223], v[100:103]
    v_mfma_f32_16x16x32_bf16 v[100:103], a[140:143], a[224:227], v[100:103]
    v_mfma_f32_16x16x32_bf16 v[104:107], a[144:147], a[204:207], 0
    buffer_store_dwordx2 v[148:149], v11, s[12:15], s37 offen offset:896 sc1
    v_mfma_f32_16x16x32_bf16 v[104:107], a[148:151], a[208:211], v[104:107]
    s_waitcnt vmcnt(37)
    ds_write_b64 v16, a[72:73] offset:0
    v_mfma_f32_16x16x32_bf16 v[104:107], a[152:155], a[212:215], v[104:107]
    ds_write_b64 v16, a[74:75] offset:1024
    v_mfma_f32_16x16x32_bf16 v[104:107], a[156:159], a[216:219], v[104:107]
    ds_write_b64 v16, a[76:77] offset:512
    v_mfma_f32_16x16x32_bf16 v[104:107], a[160:163], a[220:223], v[104:107]
    ds_write_b64 v16, a[78:79] offset:1536
    v_mfma_f32_16x16x32_bf16 v[104:107], a[164:167], a[224:227], v[104:107]
    buffer_store_dwordx2 v[150:151], v11, s[12:15], s37 offen offset:1280 sc1
    v_mfma_f32_16x16x32_bf16 v[108:111], a[168:171], a[204:207], 0
    ds_read2_b64 a[72:75], v17 offset0:0 offset1:128
    v_cvt_pk_bf16_f32 v210, v100, v101
    v_mfma_f32_16x16x32_bf16 v[108:111], a[172:175], a[208:211], v[108:111]
    ds_read2_b64 a[76:79], v18 offset0:0 offset1:128
    v_cvt_pk_bf16_f32 v211, v102, v103
    v_mfma_f32_16x16x32_bf16 v[108:111], a[176:179], a[212:215], v[108:111]
    v_cvt_pk_bf16_f32 v212, v104, v105
    v_cvt_pk_bf16_f32 v213, v106, v107
    v_mfma_f32_16x16x32_bf16 v[108:111], a[180:183], a[216:219], v[108:111]
    v_mfma_f32_16x16x32_bf16 v[108:111], a[184:187], a[220:223], v[108:111]
    buffer_store_dwordx2 v[152:153], v11, s[12:15], s39 offen offset:128 sc1
    v_mfma_f32_16x16x32_bf16 v[108:111], a[188:191], a[224:227], v[108:111]
    s_waitcnt lgkmcnt(6)
    v_mfma_f32_16x16x32_bf16 v[112:115], a[96:99], a[228:231], 0
    v_mfma_f32_16x16x32_bf16 v[112:115], a[100:103], a[232:235], v[112:115]
    v_mfma_f32_16x16x32_bf16 v[112:115], a[104:107], a[236:239], v[112:115]
    v_cvt_pk_bf16_f32 v214, v108, v109
    v_cvt_pk_bf16_f32 v215, v110, v111
    v_mfma_f32_16x16x32_bf16 v[112:115], a[108:111], a[240:243], v[112:115]
    buffer_store_dwordx2 v[154:155], v11, s[12:15], s39 offen offset:512 sc1
    v_mfma_f32_16x16x32_bf16 v[112:115], a[112:115], a[244:247], v[112:115]
    v_mfma_f32_16x16x32_bf16 v[112:115], a[116:119], a[248:251], v[112:115]
    v_mfma_f32_16x16x32_bf16 v[116:119], a[120:123], a[228:231], 0
    v_mfma_f32_16x16x32_bf16 v[116:119], a[124:127], a[232:235], v[116:119]
    v_mfma_f32_16x16x32_bf16 v[116:119], a[128:131], a[236:239], v[116:119]
    buffer_store_dwordx2 v[156:157], v11, s[12:15], s39 offen offset:896 sc1
    v_mfma_f32_16x16x32_bf16 v[116:119], a[132:135], a[240:243], v[116:119]
    s_waitcnt vmcnt(34)
    ds_write_b64 v16, a[80:81] offset:0
    v_mfma_f32_16x16x32_bf16 v[116:119], a[136:139], a[244:247], v[116:119]
    ds_write_b64 v16, a[82:83] offset:1024
    v_mfma_f32_16x16x32_bf16 v[116:119], a[140:143], a[248:251], v[116:119]
    ds_write_b64 v16, a[84:85] offset:512
    v_mfma_f32_16x16x32_bf16 v[120:123], a[144:147], a[228:231], 0
    ds_write_b64 v16, a[86:87] offset:1536
    v_mfma_f32_16x16x32_bf16 v[120:123], a[148:151], a[232:235], v[120:123]
    buffer_store_dwordx2 v[158:159], v11, s[12:15], s39 offen offset:1280 sc1
    v_mfma_f32_16x16x32_bf16 v[120:123], a[152:155], a[236:239], v[120:123]
    ds_read2_b64 a[80:83], v17 offset0:0 offset1:128
    v_cvt_pk_bf16_f32 v216, v112, v113
    v_mfma_f32_16x16x32_bf16 v[120:123], a[156:159], a[240:243], v[120:123]
    ds_read2_b64 a[84:87], v18 offset0:0 offset1:128
    v_cvt_pk_bf16_f32 v217, v114, v115
    v_mfma_f32_16x16x32_bf16 v[120:123], a[160:163], a[244:247], v[120:123]
    v_cvt_pk_bf16_f32 v218, v116, v117
    v_cvt_pk_bf16_f32 v219, v118, v119
    v_mfma_f32_16x16x32_bf16 v[120:123], a[164:167], a[248:251], v[120:123]
    v_mfma_f32_16x16x32_bf16 v[124:127], a[168:171], a[228:231], 0
    v_mfma_f32_16x16x32_bf16 v[124:127], a[172:175], a[232:235], v[124:127]
    v_mfma_f32_16x16x32_bf16 v[124:127], a[176:179], a[236:239], v[124:127]
    v_cvt_pk_bf16_f32 v220, v120, v121
    v_cvt_pk_bf16_f32 v221, v122, v123
    v_mfma_f32_16x16x32_bf16 v[124:127], a[180:183], a[240:243], v[124:127]
    v_mfma_f32_16x16x32_bf16 v[124:127], a[184:187], a[244:247], v[124:127]
    v_mfma_f32_16x16x32_bf16 v[124:127], a[188:191], a[248:251], v[124:127]
    v_mfma_f32_16x16x32_bf16 v[64:67], v[32:35], v[192:195], 0
    v_mfma_f32_16x16x32_bf16 v[64:67], v[36:39], v[196:199], v[64:67]
    v_mfma_f32_16x16x32_bf16 v[68:71], v[32:35], v[200:203], 0
    v_cvt_pk_bf16_f32 v222, v124, v125
    v_cvt_pk_bf16_f32 v223, v126, v127
    v_mfma_f32_16x16x32_bf16 v[68:71], v[36:39], v[204:207], v[68:71]
    v_mfma_f32_16x16x32_bf16 v[72:75], v[32:35], v[208:211], 0
    s_waitcnt vmcnt(29)
    ds_write_b64 v16, a[88:89] offset:0
    v_mfma_f32_16x16x32_bf16 v[72:75], v[36:39], v[212:215], v[72:75]
    ds_write_b64 v16, a[90:91] offset:1024
    v_mfma_f32_16x16x32_bf16 v[76:79], v[32:35], v[216:219], 0
    buffer_load_dwordx4 a[96:99], v9, s[8:11], s24 offen offset:0 nt
    v_cvt_pk_bf16_f32 v160, v64, v68
    v_mfma_f32_16x16x32_bf16 v[76:79], v[36:39], v[220:223], v[76:79]
    buffer_load_dwordx4 a[100:103], v10, s[8:11], s24 offen offset:0 nt
    v_cvt_pk_bf16_f32 v162, v65, v69
    v_mfma_f32_16x16x32_bf16 v[80:83], v[40:43], v[192:195], 0
    ds_read_b128 a[192:195], v1 offset:0
    v_cvt_pk_bf16_f32 v164, v66, v70
    v_mfma_f32_16x16x32_bf16 v[80:83], v[44:47], v[196:199], v[80:83]
    ds_read_b128 a[196:199], v1 offset:1024
    v_cvt_pk_bf16_f32 v166, v67, v71
    v_mfma_f32_16x16x32_bf16 v[84:87], v[40:43], v[200:203], 0
    ds_read_b128 a[200:203], v1 offset:2048
    v_cvt_pk_bf16_f32 v161, v72, v76
    v_mfma_f32_16x16x32_bf16 v[84:87], v[44:47], v[204:207], v[84:87]
    ds_write_b64 v16, a[92:93] offset:512
    v_mfma_f32_16x16x32_bf16 v[88:91], v[40:43], v[208:211], 0
    ds_read_b128 a[204:207], v1 offset:3072
    v_cvt_pk_bf16_f32 v163, v73, v77
    v_mfma_f32_16x16x32_bf16 v[88:91], v[44:47], v[212:215], v[88:91]
    ds_write_b64 v16, a[94:95] offset:1536
    v_mfma_f32_16x16x32_bf16 v[92:95], v[40:43], v[216:219], 0
    ds_read_b128 a[208:211], v1 offset:4096
    v_cvt_pk_bf16_f32 v165, v74, v78
    v_mfma_f32_16x16x32_bf16 v[92:95], v[44:47], v[220:223], v[92:95]
    ds_read2_b64 a[88:91], v17 offset0:0 offset1:128
    v_cvt_pk_bf16_f32 v167, v75, v79
    v_mfma_f32_16x16x32_bf16 v[96:99], v[48:51], v[192:195], 0
    ds_read_b128 a[212:215], v1 offset:5120
    v_cvt_pk_bf16_f32 v168, v80, v84
    v_mfma_f32_16x16x32_bf16 v[96:99], v[52:55], v[196:199], v[96:99]
    ds_read2_b64 a[92:95], v18 offset0:0 offset1:128
    v_cvt_pk_bf16_f32 v170, v81, v85
    v_mfma_f32_16x16x32_bf16 v[100:103], v[48:51], v[200:203], 0
    buffer_store_dwordx2 v[160:161], v11, s[12:15], s33 offen offset:256 sc1
    v_mfma_f32_16x16x32_bf16 v[100:103], v[52:55], v[204:207], v[100:103]
    v_cvt_pk_bf16_f32 v169, v88, v92
    v_cvt_pk_bf16_f32 v171, v89, v93
    v_mfma_f32_16x16x32_bf16 v[104:107], v[48:51], v[208:211], 0
    v_cvt_pk_bf16_f32 v172, v82, v86
    v_cvt_pk_bf16_f32 v173, v90, v94
    v_mfma_f32_16x16x32_bf16 v[104:107], v[52:55], v[212:215], v[104:107]
    buffer_store_dwordx2 v[162:163], v11, s[12:15], s33 offen offset:640 sc1
    v_mfma_f32_16x16x32_bf16 v[108:111], v[48:51], v[216:219], 0
    v_cvt_pk_bf16_f32 v176, v96, v100
    v_cvt_pk_bf16_f32 v178, v97, v101
    v_mfma_f32_16x16x32_bf16 v[108:111], v[52:55], v[220:223], v[108:111]
    v_cvt_pk_bf16_f32 v180, v98, v102
    v_cvt_pk_bf16_f32 v182, v99, v103
    v_mfma_f32_16x16x32_bf16 v[112:115], v[56:59], v[192:195], 0
    buffer_store_dwordx2 v[164:165], v11, s[12:15], s33 offen offset:1024 sc1
    v_mfma_f32_16x16x32_bf16 v[112:115], v[60:63], v[196:199], v[112:115]
    v_cvt_pk_bf16_f32 v174, v83, v87
    v_cvt_pk_bf16_f32 v175, v91, v95
    v_mfma_f32_16x16x32_bf16 v[116:119], v[56:59], v[200:203], 0
    v_cvt_pk_bf16_f32 v177, v104, v108
    v_cvt_pk_bf16_f32 v179, v105, v109
    v_mfma_f32_16x16x32_bf16 v[116:119], v[60:63], v[204:207], v[116:119]
    buffer_store_dwordx2 v[166:167], v11, s[12:15], s33 offen offset:1408 sc1
    v_mfma_f32_16x16x32_bf16 v[120:123], v[56:59], v[208:211], 0
    v_cvt_pk_bf16_f32 v181, v106, v110
    v_cvt_pk_bf16_f32 v183, v107, v111
    v_mfma_f32_16x16x32_bf16 v[120:123], v[60:63], v[212:215], v[120:123]
    s_add_u32 s33, s16, 3145728
    v_mfma_f32_16x16x32_bf16 v[124:127], v[56:59], v[216:219], 0
    ds_read_b128 a[216:219], v1 offset:6144
    v_cvt_pk_bf16_f32 v184, v112, v116
    v_mfma_f32_16x16x32_bf16 v[124:127], v[60:63], v[220:223], v[124:127]
    v_cvt_pk_bf16_f32 v186, v113, v117
    s_cmp_eq_u32 s18, 1
    s_cbranch_scc0 L_more
L_tail:
    buffer_store_dwordx2 v[168:169], v11, s[12:15], s35 offen offset:256 sc1
    buffer_store_dwordx2 v[170:171], v11, s[12:15], s35 offen offset:640 sc1
    buffer_store_dwordx2 v[172:173], v11, s[12:15], s35 offen offset:1024 sc1
    buffer_store_dwordx2 v[174:175], v11, s[12:15], s35 offen offset:1408 sc1
    buffer_store_dwordx2 v[176:177], v11, s[12:15], s37 offen offset:256 sc1
    buffer_store_dwordx2 v[178:179], v11, s[12:15], s37 offen offset:640 sc1
    buffer_store_dwordx2 v[180:181], v11, s[12:15], s37 offen offset:1024 sc1
    buffer_store_dwordx2 v[182:183], v11, s[12:15], s37 offen offset:1408 sc1
    v_cvt_pk_bf16_f32 v188, v114, v118
    v_cvt_pk_bf16_f32 v190, v115, v119
    v_cvt_pk_bf16_f32 v185, v120, v124
    v_cvt_pk_bf16_f32 v187, v121, v125
    v_cvt_pk_bf16_f32 v189, v122, v126
    v_cvt_pk_bf16_f32 v191, v123, v127
    buffer_store_dwordx2 v[184:185], v11, s[12:15], s39 offen offset:256 sc1
    buffer_store_dwordx2 v[186:187], v11, s[12:15], s39 offen offset:640 sc1
    buffer_store_dwordx2 v[188:189], v11, s[12:15], s39 offen offset:1024 sc1
    buffer_store_dwordx2 v[190:191], v11, s[12:15], s39 offen offset:1408 sc1
L_end:
    s_endpgm
L_more:
    s_waitcnt lgkmcnt(1)
    v_mfma_f32_16x16x32_bf16 v[96:99], a[192:195], a[0:3], 0
    ds_read_b128 a[220:223], v1 offset:7168
    v_cvt_pk_bf16_f32 v188, v114, v118
    v_mfma_f32_16x16x32_bf16 v[96:99], a[196:199], a[4:7], v[96:99]
    v_cvt_pk_bf16_f32 v190, v115, v119
    v_mfma_f32_16x16x32_bf16 v[96:99], a[200:203], a[8:11], v[96:99]
    ds_read_b128 a[224:227], v1 offset:8192
    v_cvt_pk_bf16_f32 v185, v120, v124
    v_mfma_f32_16x16x32_bf16 v[96:99], a[204:207], a[12:15], v[96:99]
    v_cvt_pk_bf16_f32 v187, v121, v125
    v_cvt_pk_bf16_f32 v189, v122, v126
    v_mfma_f32_16x16x32_bf16 v[96:99], a[208:211], a[16:19], v[96:99]
    ds_read_b128 a[228:231], v1 offset:9216
    v_cvt_pk_bf16_f32 v191, v123, v127
    v_mfma_f32_16x16x32_bf16 v[96:99], a[212:215], a[20:23], v[96:99]
    v_mfma_f32_16x16x32_bf16 v[100:103], a[192:195], a[24:27], 0
    ds_read_b128 a[232:235], v1 offset:10240
    v_mfma_f32_16x16x32_bf16 v[100:103], a[196:199], a[28:31], v[100:103]
    v_mfma_f32_16x16x32_bf16 v[100:103], a[200:203], a[32:35], v[100:103]
    ds_read_b128 a[236:239], v1 offset:11264
    v_cvt_pk_bf16_f32 v192, v96, v97
    v_mfma_f32_16x16x32_bf16 v[100:103], a[204:207], a[36:39], v[100:103]
    v_cvt_pk_bf16_f32 v193, v98, v99
    v_mfma_f32_16x16x32_bf16 v[100:103], a[208:211], a[40:43], v[100:103]
    v_mfma_f32_16x16x32_bf16 v[100:103], a[212:215], a[44:47], v[100:103]
    v_mfma_f32_16x16x32_bf16 v[104:107], a[192:195], a[48:51], 0
    v_mfma_f32_16x16x32_bf16 v[104:107], a[196:199], a[52:55], v[104:107]
    v_mfma_f32_16x16x32_bf16 v[104:107], a[200:203], a[56:59], v[104:107]
    v_cvt_pk_bf16_f32 v196, v100, v101
    v_cvt_pk_bf16_f32 v197, v102, v103
    v_mfma_f32_16x16x32_bf16 v[104:107], a[204:207], a[60:63], v[104:107]
    v_mfma_f32_16x16x32_bf16 v[104:107], a[208:211], a[64:67], v[104:107]
    v_mfma_f32_16x16x32_bf16 v[104:107], a[212:215], a[68:71], v[104:107]
    v_mfma_f32_16x16x32_bf16 v[108:111], a[192:195], a[72:75], 0
    v_mfma_f32_16x16x32_bf16 v[108:111], a[196:199], a[76:79], v[108:111]
    v_mfma_f32_16x16x32_bf16 v[108:111], a[200:203], a[80:83], v[108:111]
    v_cvt_pk_bf16_f32 v200, v104, v105
    v_cvt_pk_bf16_f32 v201, v106, v107
    v_mfma_f32_16x16x32_bf16 v[108:111], a[204:207], a[84:87], v[108:111]
    v_mfma_f32_16x16x32_bf16 v[108:111], a[208:211], a[88:91], v[108:111]
    ds_read_b128 a[240:243], v1 offset:12288
    v_mfma_f32_16x16x32_bf16 v[108:111], a[212:215], a[92:95], v[108:111]
    s_waitcnt lgkmcnt(1)
    v_mfma_f32_16x16x32_bf16 v[112:115], a[216:219], a[0:3], 0
    ds_read_b128 a[244:247], v1 offset:13312
    v_mfma_f32_16x16x32_bf16 v[112:115], a[220:223], a[4:7], v[112:115]
    v_mfma_f32_16x16x32_bf16 v[112:115], a[224:227], a[8:11], v[112:115]
    ds_read_b128 a[248:251], v1 offset:14336
    v_cvt_pk_bf16_f32 v204, v108, v109
    v_mfma_f32_16x16x32_bf16 v[112:115], a[228:231], a[12:15], v[112:115]
    v_cvt_pk_bf16_f32 v205, v110, v111
    v_mfma_f32_16x16x32_bf16 v[112:115], a[232:235], a[16:19], v[112:115]
    ds_read_b128 a[192:195], v1 offset:15360
    v_mfma_f32_16x16x32_bf16 v[112:115], a[236:239], a[20:23], v[112:115]
    v_mfma_f32_16x16x32_bf16 v[116:119], a[216:219], a[24:27], 0
    buffer_load_dwordx4 a[104:107], v9, s[8:11], s24 offen offset:128 nt
    v_mfma_f32_16x16x32_bf16 v[116:119], a[220:223], a[28:31], v[116:119]
    buffer_load_dwordx4 a[108:111], v10, s[8:11], s24 offen offset:128 nt
    v_mfma_f32_16x16x32_bf16 v[116:119], a[224:227], a[32:35], v[116:119]
    ds_read_b128 a[196:199], v1 offset:16384
    v_cvt_pk_bf16_f32 v194, v112, v113
    v_mfma_f32_16x16x32_bf16 v[116:119], a[228:231], a[36:39], v[116:119]
    buffer_store_dwordx2 v[168:169], v11, s[12:15], s35 offen offset:256 sc1
    v_mfma_f32_16x16x32_bf16 v[116:119], a[232:235], a[40:43], v[116:119]
    ds_read_b128 a[200:203], v1 offset:17408
    v_cvt_pk_bf16_f32 v195, v114, v115
    v_mfma_f32_16x16x32_bf16 v[116:119], a[236:239], a[44:47], v[116:119]
    v_mfma_f32_16x16x32_bf16 v[120:123], a[216:219], a[48:51], 0
    v_mfma_f32_16x16x32_bf16 v[120:123], a[220:223], a[52:55], v[120:123]
    v_mfma_f32_16x16x32_bf16 v[120:123], a[224:227], a[56:59], v[120:123]
    v_cvt_pk_bf16_f32 v198, v116, v117
    v_cvt_pk_bf16_f32 v199, v118, v119
    v_mfma_f32_16x16x32_bf16 v[120:123], a[228:231], a[60:63], v[120:123]
    v_mfma_f32_16x16x32_bf16 v[120:123], a[232:235], a[64:67], v[120:123]
    v_mfma_f32_16x16x32_bf16 v[120:123], a[236:239], a[68:71], v[120:123]
    v_mfma_f32_16x16x32_bf16 v[124:127], a[216:219], a[72:75], 0
    v_mfma_f32_16x16x32_bf16 v[124:127], a[220:223], a[76:79], v[124:127]
    v_mfma_f32_16x16x32_bf16 v[124:127], a[224:227], a[80:83], v[124:127]
    v_cvt_pk_bf16_f32 v202, v120, v121
    v_cvt_pk_bf16_f32 v203, v122, v123
    v_mfma_f32_16x16x32_bf16 v[124:127], a[228:231], a[84:87], v[124:127]
    v_mfma_f32_16x16x32_bf16 v[124:127], a[232:235], a[88:91], v[124:127]
    ds_read_b128 a[204:207], v1 offset:18432
    v_mfma_f32_16x16x32_bf16 v[124:127], a[236:239], a[92:95], v[124:127]
    s_waitcnt lgkmcnt(2)
    v_mfma_f32_16x16x32_bf16 v[96:99], a[240:243], a[0:3], 0
    ds_read_b128 a[208:211], v1 offset:19456
    v_mfma_f32_16x16x32_bf16 v[96:99], a[244:247], a[4:7], v[96:99]
    v_mfma_f32_16x16x32_bf16 v[96:99], a[248:251], a[8:11], v[96:99]
    ds_read_b128 a[212:215], v1 offset:20480
    v_cvt_pk_bf16_f32 v206, v124, v125
    v_mfma_f32_16x16x32_bf16 v[96:99], a[192:195], a[12:15], v[96:99]
    v_cvt_pk_bf16_f32 v207, v126, v127
    v_mfma_f32_16x16x32_bf16 v[96:99], a[196:199], a[16:19], v[96:99]
    ds_read_b128 a[216:219], v1 offset:21504
    s_waitcnt lgkmcnt(4)
    v_mfma_f32_16x16x32_bf16 v[96:99], a[200:203], a[20:23], v[96:99]
    v_mfma_f32_16x16x32_bf16 v[100:103], a[240:243], a[24:27], 0
    ds_read_b128 a[220:223], v1 offset:22528
    v_mfma_f32_16x16x32_bf16 v[100:103], a[244:247], a[28:31], v[100:103]
    v_mfma_f32_16x16x32_bf16 v[100:103], a[248:251], a[32:35], v[100:103]
    ds_read_b128 a[224:227], v1 offset:23552
    v_cvt_pk_bf16_f32 v208, v96, v97
    v_mfma_f32_16x16x32_bf16 v[100:103], a[192:195], a[36:39], v[100:103]
    buffer_store_dwordx2 v[170:171], v11, s[12:15], s35 offen offset:640 sc1
    v_mfma_f32_16x16x32_bf16 v[100:103], a[196:199], a[40:43], v[100:103]
    v_cvt_pk_bf16_f32 v209, v98, v99
    v_mfma_f32_16x16x32_bf16 v[100:103], a[200:203], a[44:47], v[100:103]
    v_mfma_f32_16x16x32_bf16 v[104:107], a[240:243], a[48:51], 0
    v_mfma_f32_16x16x32_bf16 v[104:107], a[244:247], a[52:55], v[104:107]
    v_mfma_f32_16x16x32_bf16 v[104:107], a[248:251], a[56:59], v[104:107]
    v_cvt_pk_bf16_f32 v212, v100, v101
    v_cvt_pk_bf16_f32 v213, v102, v103
    v_mfma_f32_16x16x32_bf16 v[104:107], a[192:195], a[60:63], v[104:107]
    v_mfma_f32_16x16x32_bf16 v[104:107], a[196:199], a[64:67], v[104:107]
    v_mfma_f32_16x16x32_bf16 v[104:107], a[200:203], a[68:71], v[104:107]
    v_mfma_f32_16x16x32_bf16 v[108:111], a[240:243], a[72:75], 0
    v_mfma_f32_16x16x32_bf16 v[108:111], a[244:247], a[76:79], v[108:111]
    v_mfma_f32_16x16x32_bf16 v[108:111], a[248:251], a[80:83], v[108:111]
    v_cvt_pk_bf16_f32 v216, v104, v105
    v_cvt_pk_bf16_f32 v217, v106, v107
    v_mfma_f32_16x16x32_bf16 v[108:111], a[192:195], a[84:87], v[108:111]
    v_mfma_f32_16x16x32_bf16 v[108:111], a[196:199], a[88:91], v[108:111]
    ds_read_b128 a[228:231], v1 offset:24576
    v_mfma_f32_16x16x32_bf16 v[108:111], a[200:203], a[92:95], v[108:111]
    s_waitcnt lgkmcnt(1)
    v_mfma_f32_16x16x32_bf16 v[112:115], a[204:207], a[0:3], 0
    ds_read_b128 a[232:235], v1 offset:25600
    v_mfma_f32_16x16x32_bf16 v[112:115], a[208:211], a[4:7], v[112:115]
    v_mfma_f32_16x16x32_bf16 v[112:115], a[212:215], a[8:11], v[112:115]
    ds_read_b128 a[236:239], v1 offset:26624
    v_cvt_pk_bf16_f32 v220, v108, v109
    v_mfma_f32_16x16x32_bf16 v[112:115], a[216:219], a[12:15], v[112:115]
    v_cvt_pk_bf16_f32 v221, v110, v111
    v_mfma_f32_16x16x32_bf16 v[112:115], a[220:223], a[16:19], v[112:115]
    ds_read_b128 a[240:243], v1 offset:27648
    v_mfma_f32_16x16x32_bf16 v[112:115], a[224:227], a[20:23], v[112:115]
    v_mfma_f32_16x16x32_bf16 v[116:119], a[204:207], a[24:27], 0
    ds_read_b128 a[244:247], v1 offset:28672
    v_mfma_f32_16x16x32_bf16 v[116:119], a[208:211], a[28:31], v[116:119]
    v_mfma_f32_16x16x32_bf16 v[116:119], a[212:215], a[32:35], v[116:119]
    ds_read_b128 a[248:251], v1 offset:29696
    v_cvt_pk_bf16_f32 v210, v112, v113
    v_mfma_f32_16x16x32_bf16 v[116:119], a[216:219], a[36:39], v[116:119]
    v_cvt_pk_bf16_f32 v211, v114, v115
    v_mfma_f32_16x16x32_bf16 v[116:119], a[220:223], a[40:43], v[116:119]
    buffer_store_dwordx2 v[172:173], v11, s[12:15], s35 offen offset:1024 sc1
    v_mfma_f32_16x16x32_bf16 v[116:119], a[224:227], a[44:47], v[116:119]
    v_mfma_f32_16x16x32_bf16 v[120:123], a[204:207], a[48:51], 0
    v_mfma_f32_16x16x32_bf16 v[120:123], a[208:211], a[52:55], v[120:123]
    v_mfma_f32_16x16x32_bf16 v[120:123], a[212:215], a[56:59], v[120:123]
    buffer_load_dwordx4 a[112:115], v9, s[8:11], s24 offen offset:256 nt
    v_cvt_pk_bf16_f32 v214, v116, v117
    v_mfma_f32_16x16x32_bf16 v[120:123], a[216:219], a[60:63], v[120:123]
    buffer_load_dwordx4 a[116:119], v10, s[8:11], s24 offen offset:256 nt
    v_cvt_pk_bf16_f32 v215, v118, v119
    v_mfma_f32_16x16x32_bf16 v[120:123], a[220:223], a[64:67], v[120:123]
    s_add_u32 s24, s16, 6291456
    v_mfma_f32_16x16x32_bf16 v[120:123], a[224:227], a[68:71], v[120:123]
    v_mfma_f32_16x16x32_bf16 v[124:127], a[204:207], a[72:75], 0
    v_mfma_f32_16x16x32_bf16 v[124:127], a[208:211], a[76:79], v[124:127]
    v_mfma_f32_16x16x32_bf16 v[124:127], a[212:215], a[80:83], v[124:127]
    v_cvt_pk_bf16_f32 v218, v120, v121
    v_cvt_pk_bf16_f32 v219, v122, v123
    v_mfma_f32_16x16x32_bf16 v[124:127], a[216:219], a[84:87], v[124:127]
    v_mfma_f32_16x16x32_bf16 v[124:127], a[220:223], a[88:91], v[124:127]
    v_mfma_f32_16x16x32_bf16 v[124:127], a[224:227], a[92:95], v[124:127]
    s_waitcnt lgkmcnt(0)
    v_mfma_f32_16x16x32_bf16 v[96:99], a[228:231], a[0:3], 0
    v_mfma_f32_16x16x32_bf16 v[96:99], a[232:235], a[4:7], v[96:99]
    v_mfma_f32_16x16x32_bf16 v[96:99], a[236:239], a[8:11], v[96:99]
    v_cvt_pk_bf16_f32 v222, v124, v125
    v_cvt_pk_bf16_f32 v223, v126, v127
    v_mfma_f32_16x16x32_bf16 v[96:99], a[240:243], a[12:15], v[96:99]
    v_mfma_f32_16x16x32_bf16 v[96:99], a[244:247], a[16:19], v[96:99]
    v_mfma_f32_16x16x32_bf16 v[96:99], a[248:251], a[20:23], v[96:99]
    v_mfma_f32_16x16x32_bf16 v[100:103], a[228:231], a[24:27], 0
    v_mfma_f32_16x16x32_bf16 v[100:103], a[232:235], a[28:31], v[100:103]
    v_mfma_f32_16x16x32_bf16 v[100:103], a[236:239], a[32:35], v[100:103]
    v_mfma_f32_16x16x32_bf16 v[100:103], a[240:243], a[36:39], v[100:103]
    v_mfma_f32_16x16x32_bf16 v[100:103], a[244:247], a[40:43], v[100:103]
    v_mfma_f32_16x16x32_bf16 v[100:103], a[248:251], a[44:47], v[100:103]
    buffer_store_dwordx2 v[174:175], v11, s[12:15], s35 offen offset:1408 sc1
    v_mfma_f32_16x16x32_bf16 v[32:35], a[0:3], v[192:195], 0
    s_add_u32 s35, s16, 3538944
    v_mfma_f32_16x16x32_bf16 v[32:35], a[4:7], v[208:211], v[32:35]
    v_mfma_f32_16x16x32_bf16 v[36:39], a[24:27], v[192:195], 0
    v_mfma_f32_16x16x32_bf16 v[36:39], a[28:31], v[208:211], v[36:39]
    v_mfma_f32_16x16x32_bf16 v[40:43], a[48:51], v[192:195], 0
    v_mfma_f32_16x16x32_bf16 v[40:43], a[52:55], v[208:211], v[40:43]
    v_mfma_f32_16x16x32_bf16 v[44:47], a[72:75], v[192:195], 0
    v_cvt_pk_bf16_f32 v192, v96, v97
    v_cvt_pk_bf16_f32 v193, v98, v99
    v_mfma_f32_16x16x32_bf16 v[44:47], a[76:79], v[208:211], v[44:47]
    v_mfma_f32_16x16x32_bf16 v[48:51], a[0:3], v[196:199], 0
    v_mfma_f32_16x16x32_bf16 v[48:51], a[4:7], v[212:215], v[48:51]
    v_mfma_f32_16x16x32_bf16 v[52:55], a[24:27], v[196:199], 0
    v_mfma_f32_16x16x32_bf16 v[52:55], a[28:31], v[212:215], v[52:55]
    v_mfma_f32_16x16x32_bf16 v[56:59], a[48:51], v[196:199], 0
    v_mfma_f32_16x16x32_bf16 v[56:59], a[52:55], v[212:215], v[56:59]
    v_mfma_f32_16x16x32_bf16 v[60:63], a[72:75], v[196:199], 0
    v_cvt_pk_bf16_f32 v196, v100, v101
    v_cvt_pk_bf16_f32 v197, v102, v103
    v_mfma_f32_16x16x32_bf16 v[60:63], a[76:79], v[212:215], v[60:63]
    v_mfma_f32_16x16x32_bf16 v[64:67], a[0:3], v[200:203], 0
    v_mfma_f32_16x16x32_bf16 v[64:67], a[4:7], v[216:219], v[64:67]
    v_mfma_f32_16x16x32_bf16 v[68:71], a[24:27], v[200:203], 0
    ds_read_b128 a[192:195], v1 offset:30720
    v_mfma_f32_16x16x32_bf16 v[68:71], a[28:31], v[216:219], v[68:71]
    v_mfma_f32_16x16x32_bf16 v[72:75], a[48:51], v[200:203], 0
    ds_read_b128 a[196:199], v1 offset:31744
    v_mfma_f32_16x16x32_bf16 v[72:75], a[52:55], v[216:219], v[72:75]
    v_mfma_f32_16x16x32_bf16 v[76:79], a[72:75], v[200:203], 0
    ds_read_b128 a[200:203], v1 offset:32768
    v_mfma_f32_16x16x32_bf16 v[76:79], a[76:79], v[216:219], v[76:79]
    v_mfma_f32_16x16x32_bf16 v[80:83], a[0:3], v[204:207], 0
    buffer_store_dwordx2 v[176:177], v11, s[12:15], s37 offen offset:256 sc1
    v_mfma_f32_16x16x32_bf16 v[80:83], a[4:7], v[220:223], v[80:83]
    ds_read_b128 a[204:207], v1 offset:33792
    v_mfma_f32_16x16x32_bf16 v[84:87], a[24:27], v[204:207], 0
    ds_read_b128 a[208:211], v1 offset:34816
    v_mfma_f32_16x16x32_bf16 v[84:87], a[28:31], v[220:223], v[84:87]
    v_mfma_f32_16x16x32_bf16 v[88:91], a[48:51], v[204:207], 0
    ds_read_b128 a[212:215], v1 offset:35840
    v_mfma_f32_16x16x32_bf16 v[88:91], a[52:55], v[220:223], v[88:91]
    v_mfma_f32_16x16x32_bf16 v[92:95], a[72:75], v[204:207], 0
    v_mfma_f32_16x16x32_bf16 v[92:95], a[76:79], v[220:223], v[92:95]
    v_mfma_f32_16x16x32_bf16 v[104:107], a[228:231], a[48:51], 0
    v_mfma_f32_16x16x32_bf16 v[104:107], a[232:235], a[52:55], v[104:107]
    v_mfma_f32_16x16x32_bf16 v[104:107], a[236:239], a[56:59], v[104:107]
    buffer_load_dwordx4 a[120:123], v9, s[8:11], s26 offen offset:0 nt
    v_mfma_f32_16x16x32_bf16 v[104:107], a[240:243], a[60:63], v[104:107]
    buffer_load_dwordx4 a[124:127], v10, s[8:11], s26 offen offset:0 nt
    v_mfma_f32_16x16x32_bf16 v[104:107], a[244:247], a[64:67], v[104:107]
    v_mfma_f32_16x16x32_bf16 v[104:107], a[248:251], a[68:71], v[104:107]
    v_mfma_f32_16x16x32_bf16 v[108:111], a[228:231], a[72:75], 0
    v_mfma_f32_16x16x32_bf16 v[108:111], a[232:235], a[76:79], v[108:111]
    v_mfma_f32_16x16x32_bf16 v[108:111], a[236:239], a[80:83], v[108:111]
    v_cvt_pk_bf16_f32 v200, v104, v105
    v_cvt_pk_bf16_f32 v201, v106, v107
    v_mfma_f32_16x16x32_bf16 v[108:111], a[240:243], a[84:87], v[108:111]
    v_mfma_f32_16x16x32_bf16 v[108:111], a[244:247], a[88:91], v[108:111]
    ds_read_b128 a[216:219], v1 offset:36864
    v_mfma_f32_16x16x32_bf16 v[108:111], a[248:251], a[92:95], v[108:111]
    s_waitcnt lgkmcnt(1)
    v_mfma_f32_16x16x32_bf16 v[112:115], a[192:195], a[0:3], 0
    ds_read_b128 a[220:223], v1 offset:37888
    v_mfma_f32_16x16x32_bf16 v[112:115], a[196:199], a[4:7], v[112:115]
    v_mfma_f32_16x16x32_bf16 v[112:115], a[200:203], a[8:11], v[112:115]
    ds_read_b128 a[224:227], v1 offset:38912
    v_cvt_pk_bf16_f32 v204, v108, v109
    v_mfma_f32_16x16x32_bf16 v[112:115], a[204:207], a[12:15], v[112:115]
    v_cvt_pk_bf16_f32 v205, v110, v111
    v_mfma_f32_16x16x32_bf16 v[112:115], a[208:211], a[16:19], v[112:115]
    ds_read_b128 a[228:231], v1 offset:39936
    v_mfma_f32_16x16x32_bf16 v[112:115], a[212:215], a[20:23], v[112:115]
    buffer_store_dwordx2 v[178:179], v11, s[12:15], s37 offen offset:640 sc1
    v_mfma_f32_16x16x32_bf16 v[116:119], a[192:195], a[24:27], 0
    ds_read_b128 a[232:235], v1 offset:40960
    v_mfma_f32_16x16x32_bf16 v[116:119], a[196:199], a[28:31], v[116:119]
    v_mfma_f32_16x16x32_bf16 v[116:119], a[200:203], a[32:35], v[116:119]
    ds_read_b128 a[236:239], v1 offset:41984
    v_cvt_pk_bf16_f32 v194, v112, v113
    v_mfma_f32_16x16x32_bf16 v[116:119], a[204:207], a[36:39], v[116:119]
    v_cvt_pk_bf16_f32 v195, v114, v115
    v_mfma_f32_16x16x32_bf16 v[116:119], a[208:211], a[40:43], v[116:119]
    v_mfma_f32_16x16x32_bf16 v[116:119], a[212:215], a[44:47], v[116:119]
    v_mfma_f32_16x16x32_bf16 v[120:123], a[192:195], a[48:51], 0
    v_mfma_f32_16x16x32_bf16 v[120:123], a[196:199], a[52:55], v[120:123]
    v_mfma_f32_16x16x32_bf16 v[120:123], a[200:203], a[56:59], v[120:123]
    v_cvt_pk_bf16_f32 v198, v116, v117
    v_cvt_pk_bf16_f32 v199, v118, v119
    v_mfma_f32_16x16x32_bf16 v[120:123], a[204:207], a[60:63], v[120:123]
    v_mfma_f32_16x16x32_bf16 v[120:123], a[208:211], a[64:67], v[120:123]
    v_mfma_f32_16x16x32_bf16 v[120:123], a[212:215], a[68:71], v[120:123]
    v_mfma_f32_16x16x32_bf16 v[124:127], a[192:195], a[72:75], 0
    v_mfma_f32_16x16x32_bf16 v[124:127], a[196:199], a[76:79], v[124:127]
    v_mfma_f32_16x16x32_bf16 v[124:127], a[200:203], a[80:83], v[124:127]
    v_cvt_pk_bf16_f32 v202, v120, v121
    v_cvt_pk_bf16_f32 v203, v122, v123
    v_mfma_f32_16x16x32_bf16 v[124:127], a[204:207], a[84:87], v[124:127]
    v_mfma_f32_16x16x32_bf16 v[124:127], a[208:211], a[88:91], v[124:127]
    ds_read_b128 a[240:243], v1 offset:43008
    v_mfma_f32_16x16x32_bf16 v[124:127], a[212:215], a[92:95], v[124:127]
    s_waitcnt lgkmcnt(1)
    v_mfma_f32_16x16x32_bf16 v[96:99], a[216:219], a[0:3], 0
    ds_read_b128 a[244:247], v1 offset:44032
    v_mfma_f32_16x16x32_bf16 v[96:99], a[220:223], a[4:7], v[96:99]
    v_mfma_f32_16x16x32_bf16 v[96:99], a[224:227], a[8:11], v[96:99]
    ds_read_b128 a[248:251], v1 offset:45056
    v_cvt_pk_bf16_f32 v206, v124, v125
    v_mfma_f32_16x16x32_bf16 v[96:99], a[228:231], a[12:15], v[96:99]
    v_cvt_pk_bf16_f32 v207, v126, v127
    v_mfma_f32_16x16x32_bf16 v[96:99], a[232:235], a[16:19], v[96:99]
    ds_read_b128 a[192:195], v1 offset:46080
    v_mfma_f32_16x16x32_bf16 v[96:99], a[236:239], a[20:23], v[96:99]
    v_mfma_f32_16x16x32_bf16 v[100:103], a[216:219], a[24:27], 0
    buffer_store_dwordx2 v[180:181], v11, s[12:15], s37 offen offset:1024 sc1
    v_mfma_f32_16x16x32_bf16 v[100:103], a[220:223], a[28:31], v[100:103]
    ds_read_b128 a[196:199], v1 offset:47104
    v_mfma_f32_16x16x32_bf16 v[100:103], a[224:227], a[32:35], v[100:103]
    ds_read_b128 a[200:203], v1 offset:48128
    v_cvt_pk_bf16_f32 v208, v96, v97
    v_mfma_f32_16x16x32_bf16 v[100:103], a[228:231], a[36:39], v[100:103]
    v_cvt_pk_bf16_f32 v209, v98, v99
    v_mfma_f32_16x16x32_bf16 v[100:103], a[232:235], a[40:43], v[100:103]
    v_mfma_f32_16x16x32_bf16 v[100:103], a[236:239], a[44:47], v[100:103]
    v_mfma_f32_16x16x32_bf16 v[104:107], a[216:219], a[48:51], 0
    v_mfma_f32_16x16x32_bf16 v[104:107], a[220:223], a[52:55], v[104:107]
    v_mfma_f32_16x16x32_bf16 v[104:107], a[224:227], a[56:59], v[104:107]
    v_cvt_pk_bf16_f32 v212, v100, v101
    v_cvt_pk_bf16_f32 v213, v102, v103
    v_mfma_f32_16x16x32_bf16 v[104:107], a[228:231], a[60:63], v[104:107]
    v_mfma_f32_16x16x32_bf16 v[104:107], a[232:235], a[64:67], v[104:107]
    v_mfma_f32_16x16x32_bf16 v[104:107], a[236:239], a[68:71], v[104:107]
    v_mfma_f32_16x16x32_bf16 v[108:111], a[216:219], a[72:75], 0
    v_mfma_f32_16x16x32_bf16 v[108:111], a[220:223], a[76:79], v[108:111]
    v_mfma_f32_16x16x32_bf16 v[108:111], a[224:227], a[80:83], v[108:111]
    v_cvt_pk_bf16_f32 v216, v104, v105
    v_cvt_pk_bf16_f32 v217, v106, v107
    v_mfma_f32_16x16x32_bf16 v[108:111], a[228:231], a[84:87], v[108:111]
    v_mfma_f32_16x16x32_bf16 v[108:111], a[232:235], a[88:91], v[108:111]
    buffer_load_dwordx4 a[128:131], v9, s[8:11], s26 offen offset:128 nt
    v_mfma_f32_16x16x32_bf16 v[108:111], a[236:239], a[92:95], v[108:111]
    buffer_load_dwordx4 a[132:135], v10, s[8:11], s26 offen offset:128 nt
    s_waitcnt lgkmcnt(0)
    v_mfma_f32_16x16x32_bf16 v[112:115], a[240:243], a[0:3], 0
    ds_read_b128 a[204:207], v1 offset:49152
    v_mfma_f32_16x16x32_bf16 v[112:115], a[244:247], a[4:7], v[112:115]
    ds_read_b128 a[208:211], v1 offset:50176
    v_mfma_f32_16x16x32_bf16 v[112:115], a[248:251], a[8:11], v[112:115]
    ds_read_b128 a[212:215], v1 offset:51200
    v_cvt_pk_bf16_f32 v220, v108, v109
    v_mfma_f32_16x16x32_bf16 v[112:115], a[192:195], a[12:15], v[112:115]
    v_cvt_pk_bf16_f32 v221, v110, v111
    v_mfma_f32_16x16x32_bf16 v[112:115], a[196:199], a[16:19], v[112:115]
    ds_read_b128 a[216:219], v1 offset:52224
    v_mfma_f32_16x16x32_bf16 v[112:115], a[200:203], a[20:23], v[112:115]
    v_mfma_f32_16x16x32_bf16 v[116:119], a[240:243], a[24:27], 0
    ds_read_b128 a[220:223], v1 offset:53248
    v_mfma_f32_16x16x32_bf16 v[116:119], a[244:247], a[28:31], v[116:119]
    buffer_store_dwordx2 v[182:183], v11, s[12:15], s37 offen offset:1408 sc1
    v_mfma_f32_16x16x32_bf16 v[116:119], a[248:251], a[32:35], v[116:119]
    ds_read_b128 a[224:227], v1 offset:54272
    v_cvt_pk_bf16_f32 v210, v112, v113
    v_mfma_f32_16x16x32_bf16 v[116:119], a[192:195], a[36:39], v[116:119]
    v_cvt_pk_bf16_f32 v211, v114, v115
    s_add_u32 s37, s16, 3932160
    v_mfma_f32_16x16x32_bf16 v[116:119], a[196:199], a[40:43], v[116:119]
    v_mfma_f32_16x16x32_bf16 v[116:119], a[200:203], a[44:47], v[116:119]
    v_mfma_f32_16x16x32_bf16 v[120:123], a[240:243], a[48:51], 0
    v_mfma_f32_16x16x32_bf16 v[120:123], a[244:247], a[52:55], v[120:123]
    v_mfma_f32_16x16x32_bf16 v[120:123], a[248:251], a[56:59], v[120:123]
    v_cvt_pk_bf16_f32 v214, v116, v117
    v_cvt_pk_bf16_f32 v215, v118, v119
    v_mfma_f32_16x16x32_bf16 v[120:123], a[192:195], a[60:63], v[120:123]
    v_mfma_f32_16x16x32_bf16 v[120:123], a[196:199], a[64:67], v[120:123]
    v_mfma_f32_16x16x32_bf16 v[120:123], a[200:203], a[68:71], v[120:123]
    v_mfma_f32_16x16x32_bf16 v[124:127], a[240:243], a[72:75], 0
    v_mfma_f32_16x16x32_bf16 v[124:127], a[244:247], a[76:79], v[124:127]
    v_mfma_f32_16x16x32_bf16 v[124:127], a[248:251], a[80:83], v[124:127]
    v_cvt_pk_bf16_f32 v218, v120, v121
    v_cvt_pk_bf16_f32 v219, v122, v123
    v_mfma_f32_16x16x32_bf16 v[124:127], a[192:195], a[84:87], v[124:127]
    v_mfma_f32_16x16x32_bf16 v[124:127], a[196:199], a[88:91], v[124:127]
    v_mfma_f32_16x16x32_bf16 v[124:127], a[200:203], a[92:95], v[124:127]
    s_waitcnt lgkmcnt(0)
    v_mfma_f32_16x16x32_bf16 v[96:99], a[204:207], a[0:3], 0
    v_mfma_f32_16x16x32_bf16 v[96:99], a[208:211], a[4:7], v[96:99]
    v_mfma_f32_16x16x32_bf16 v[96:99], a[212:215], a[8:11], v[96:99]
    v_cvt_pk_bf16_f32 v222, v124, v125
    v_cvt_pk_bf16_f32 v223, v126, v127
    v_mfma_f32_16x16x32_bf16 v[96:99], a[216:219], a[12:15], v[96:99]
    v_mfma_f32_16x16x32_bf16 v[96:99], a[220:223], a[16:19], v[96:99]
    v_mfma_f32_16x16x32_bf16 v[96:99], a[224:227], a[20:23], v[96:99]
    v_mfma_f32_16x16x32_bf16 v[100:103], a[204:207], a[24:27], 0
    v_mfma_f32_16x16x32_bf16 v[100:103], a[208:211], a[28:31], v[100:103]
    v_mfma_f32_16x16x32_bf16 v[100:103], a[212:215], a[32:35], v[100:103]
    buffer_store_dwordx2 v[184:185], v11, s[12:15], s39 offen offset:256 sc1
    v_mfma_f32_16x16x32_bf16 v[100:103], a[216:219], a[36:39], v[100:103]
    v_mfma_f32_16x16x32_bf16 v[100:103], a[220:223], a[40:43], v[100:103]
    v_mfma_f32_16x16x32_bf16 v[100:103], a[224:227], a[44:47], v[100:103]
    v_mfma_f32_16x16x32_bf16 v[32:35], a[8:11], v[192:195], v[32:35]
    v_mfma_f32_16x16x32_bf16 v[32:35], a[12:15], v[208:211], v[32:35]
    v_mfma_f32_16x16x32_bf16 v[36:39], a[32:35], v[192:195], v[36:39]
    v_mfma_f32_16x16x32_bf16 v[36:39], a[36:39], v[208:211], v[36:39]
    v_mfma_f32_16x16x32_bf16 v[40:43], a[56:59], v[192:195], v[40:43]
    v_mfma_f32_16x16x32_bf16 v[40:43], a[60:63], v[208:211], v[40:43]
    v_mfma_f32_16x16x32_bf16 v[44:47], a[80:83], v[192:195], v[44:47]
    v_cvt_pk_bf16_f32 v192, v96, v97
    v_cvt_pk_bf16_f32 v193, v98, v99
    v_mfma_f32_16x16x32_bf16 v[44:47], a[84:87], v[208:211], v[44:47]
    v_mfma_f32_16x16x32_bf16 v[48:51], a[8:11], v[196:199], v[48:51]
    v_mfma_f32_16x16x32_bf16 v[48:51], a[12:15], v[212:215], v[48:51]
    v_mfma_f32_16x16x32_bf16 v[52:55], a[32:35], v[196:199], v[52:55]
    v_mfma_f32_16x16x32_bf16 v[52:55], a[36:39], v[212:215], v[52:55]
    v_mfma_f32_16x16x32_bf16 v[56:59], a[56:59], v[196:199], v[56:59]
    v_mfma_f32_16x16x32_bf16 v[56:59], a[60:63], v[212:215], v[56:59]
    v_mfma_f32_16x16x32_bf16 v[60:63], a[80:83], v[196:199], v[60:63]
    v_cvt_pk_bf16_f32 v196, v100, v101
    v_cvt_pk_bf16_f32 v197, v102, v103
    v_mfma_f32_16x16x32_bf16 v[60:63], a[84:87], v[212:215], v[60:63]
    v_mfma_f32_16x16x32_bf16 v[64:67], a[8:11], v[200:203], v[64:67]
    v_mfma_f32_16x16x32_bf16 v[64:67], a[12:15], v[216:219], v[64:67]
    v_mfma_f32_16x16x32_bf16 v[68:71], a[32:35], v[200:203], v[68:71]
    buffer_load_dwordx4 a[136:139], v9, s[8:11], s26 offen offset:256 nt
    v_mfma_f32_16x16x32_bf16 v[68:71], a[36:39], v[216:219], v[68:71]
    buffer_load_dwordx4 a[140:143], v10, s[8:11], s26 offen offset:256 nt
    s_add_u32 s26, s16, 6684672
    v_mfma_f32_16x16x32_bf16 v[72:75], a[56:59], v[200:203], v[72:75]
    ds_read_b128 a[228:231], v1 offset:55296
    v_mfma_f32_16x16x32_bf16 v[72:75], a[60:63], v[216:219], v[72:75]
    ds_read_b128 a[232:235], v1 offset:56320
    v_mfma_f32_16x16x32_bf16 v[76:79], a[80:83], v[200:203], v[76:79]
    buffer_store_dwordx2 v[186:187], v11, s[12:15], s39 offen offset:640 sc1
    v_mfma_f32_16x16x32_bf16 v[76:79], a[84:87], v[216:219], v[76:79]
    ds_read_b128 a[236:239], v1 offset:57344
    v_mfma_f32_16x16x32_bf16 v[80:83], a[8:11], v[204:207], v[80:83]
    ds_read_b128 a[240:243], v1 offset:58368
    v_mfma_f32_16x16x32_bf16 v[80:83], a[12:15], v[220:223], v[80:83]
    v_mfma_f32_16x16x32_bf16 v[84:87], a[32:35], v[204:207], v[84:87]
    ds_read_b128 a[244:247], v1 offset:59392
    v_mfma_f32_16x16x32_bf16 v[84:87], a[36:39], v[220:223], v[84:87]
    v_mfma_f32_16x16x32_bf16 v[88:91], a[56:59], v[204:207], v[88:91]
    ds_read_b128 a[248:251], v1 offset:60416
    v_mfma_f32_16x16x32_bf16 v[88:91], a[60:63], v[220:223], v[88:91]
    v_mfma_f32_16x16x32_bf16 v[92:95], a[80:83], v[204:207], v[92:95]
    v_mfma_f32_16x16x32_bf16 v[92:95], a[84:87], v[220:223], v[92:95]
    v_mfma_f32_16x16x32_bf16 v[104:107], a[204:207], a[48:51], 0
    v_mfma_f32_16x16x32_bf16 v[104:107], a[208:211], a[52:55], v[104:107]
    v_mfma_f32_16x16x32_bf16 v[104:107], a[212:215], a[56:59], v[104:107]
    v_mfma_f32_16x16x32_bf16 v[104:107], a[216:219], a[60:63], v[104:107]
    v_mfma_f32_16x16x32_bf16 v[104:107], a[220:223], a[64:67], v[104:107]
    v_mfma_f32_16x16x32_bf16 v[104:107], a[224:227], a[68:71], v[104:107]
    v_mfma_f32_16x16x32_bf16 v[108:111], a[204:207], a[72:75], 0
    v_mfma_f32_16x16x32_bf16 v[108:111], a[208:211], a[76:79], v[108:111]
    v_mfma_f32_16x16x32_bf16 v[108:111], a[212:215], a[80:83], v[108:111]
    v_cvt_pk_bf16_f32 v200, v104, v105
    v_cvt_pk_bf16_f32 v201, v106, v107
    v_mfma_f32_16x16x32_bf16 v[108:111], a[216:219], a[84:87], v[108:111]
    v_mfma_f32_16x16x32_bf16 v[108:111], a[220:223], a[88:91], v[108:111]
    ds_read_b128 a[192:195], v1 offset:61440
    v_mfma_f32_16x16x32_bf16 v[108:111], a[224:227], a[92:95], v[108:111]
    s_waitcnt lgkmcnt(1)
    v_mfma_f32_16x16x32_bf16 v[112:115], a[228:231], a[0:3], 0
    ds_read_b128 a[196:199], v1 offset:62464
    v_mfma_f32_16x16x32_bf16 v[112:115], a[232:235], a[4:7], v[112:115]
    v_mfma_f32_16x16x32_bf16 v[112:115], a[236:239], a[8:11], v[112:115]
    buffer_store_dwordx2 v[188:189], v11, s[12:15], s39 offen offset:1024 sc1
    v_mfma_f32_16x16x32_bf16 v[112:115], a[240:243], a[12:15], v[112:115]
    ds_read_b128 a[200:203], v1 offset:63488
    v_cvt_pk_bf16_f32 v204, v108, v109
    v_mfma_f32_16x16x32_bf16 v[112:115], a[244:247], a[16:19], v[112:115]
    ds_read_b128 a[204:207], v1 offset:64512
    v_cvt_pk_bf16_f32 v205, v110, v111
    v_mfma_f32_16x16x32_bf16 v[112:115], a[248:251], a[20:23], v[112:115]
    v_mfma_f32_16x16x32_bf16 v[116:119], a[228:231], a[24:27], 0
    ds_read_b128 a[208:211], v2 offset:0
    v_mfma_f32_16x16x32_bf16 v[116:119], a[232:235], a[28:31], v[116:119]
    v_mfma_f32_16x16x32_bf16 v[116:119], a[236:239], a[32:35], v[116:119]
    ds_read_b128 a[212:215], v2 offset:1024
    v_cvt_pk_bf16_f32 v194, v112, v113
    v_mfma_f32_16x16x32_bf16 v[116:119], a[240:243], a[36:39], v[116:119]
    v_cvt_pk_bf16_f32 v195, v114, v115
    v_mfma_f32_16x16x32_bf16 v[116:119], a[244:247], a[40:43], v[116:119]
    v_mfma_f32_16x16x32_bf16 v[116:119], a[248:251], a[44:47], v[116:119]
    v_mfma_f32_16x16x32_bf16 v[120:123], a[228:231], a[48:51], 0
    v_mfma_f32_16x16x32_bf16 v[120:123], a[232:235], a[52:55], v[120:123]
    v_mfma_f32_16x16x32_bf16 v[120:123], a[236:239], a[56:59], v[120:123]
    v_cvt_pk_bf16_f32 v198, v116, v117
    v_cvt_pk_bf16_f32 v199, v118, v119
    v_mfma_f32_16x16x32_bf16 v[120:123], a[240:243], a[60:63], v[120:123]
    v_mfma_f32_16x16x32_bf16 v[120:123], a[244:247], a[64:67], v[120:123]
    v_mfma_f32_16x16x32_bf16 v[120:123], a[248:251], a[68:71], v[120:123]
    v_mfma_f32_16x16x32_bf16 v[124:127], a[228:231], a[72:75], 0
    v_mfma_f32_16x16x32_bf16 v[124:127], a[232:235], a[76:79], v[124:127]
    v_mfma_f32_16x16x32_bf16 v[124:127], a[236:239], a[80:83], v[124:127]
    v_cvt_pk_bf16_f32 v202, v120, v121
    v_cvt_pk_bf16_f32 v203, v122, v123
    v_mfma_f32_16x16x32_bf16 v[124:127], a[240:243], a[84:87], v[124:127]
    v_mfma_f32_16x16x32_bf16 v[124:127], a[244:247], a[88:91], v[124:127]
    ds_read_b128 a[216:219], v2 offset:2048
    v_mfma_f32_16x16x32_bf16 v[124:127], a[248:251], a[92:95], v[124:127]
    s_waitcnt lgkmcnt(1)
    v_mfma_f32_16x16x32_bf16 v[96:99], a[192:195], a[0:3], 0
    ds_read_b128 a[220:223], v2 offset:3072
    v_mfma_f32_16x16x32_bf16 v[96:99], a[196:199], a[4:7], v[96:99]
    v_mfma_f32_16x16x32_bf16 v[96:99], a[200:203], a[8:11], v[96:99]
    ds_read_b128 a[224:227], v2 offset:4096
    v_cvt_pk_bf16_f32 v206, v124, v125
    v_mfma_f32_16x16x32_bf16 v[96:99], a[204:207], a[12:15], v[96:99]
    buffer_store_dwordx2 v[190:191], v11, s[12:15], s39 offen offset:1408 sc1
    v_mfma_f32_16x16x32_bf16 v[96:99], a[208:211], a[16:19], v[96:99]
    ds_read_b128 a[228:231], v2 offset:5120
    v_cvt_pk_bf16_f32 v207, v126, v127
    v_mfma_f32_16x16x32_bf16 v[96:99], a[212:215], a[20:23], v[96:99]
    s_add_u32 s39, s16, 4325376
    v_mfma_f32_16x16x32_bf16 v[100:103], a[192:195], a[24:27], 0
    buffer_load_dwordx4 a[144:147], v9, s[8:11], s28 offen offset:0 nt
    v_mfma_f32_16x16x32_bf16 v[100:103], a[196:199], a[28:31], v[100:103]
    buffer_load_dwordx4 a[148:151], v10, s[8:11], s28 offen offset:0 nt
    v_mfma_f32_16x16x32_bf16 v[100:103], a[200:203], a[32:35], v[100:103]
    ds_read_b128 a[232:235], v2 offset:6144
    v_cvt_pk_bf16_f32 v208, v96, v97
    v_mfma_f32_16x16x32_bf16 v[100:103], a[204:207], a[36:39], v[100:103]
    ds_read_b128 a[236:239], v2 offset:7168
    v_cvt_pk_bf16_f32 v209, v98, v99
    v_mfma_f32_16x16x32_bf16 v[100:103], a[208:211], a[40:43], v[100:103]
    s_waitcnt vmcnt(28)
    ds_write_b64 v4, a[96:97] offset:0
    v_mfma_f32_16x16x32_bf16 v[100:103], a[212:215], a[44:47], v[100:103]
    ds_write_b64 v4, a[98:99] offset:1024
    v_mfma_f32_16x16x32_bf16 v[104:107], a[192:195], a[48:51], 0
    ds_write_b64 v4, a[100:101] offset:512
    v_mfma_f32_16x16x32_bf16 v[104:107], a[196:199], a[52:55], v[104:107]
    ds_write_b64 v4, a[102:103] offset:1536
    v_mfma_f32_16x16x32_bf16 v[104:107], a[200:203], a[56:59], v[104:107]
    ds_read2_b64 a[96:99], v5 offset0:0 offset1:128
    v_cvt_pk_bf16_f32 v212, v100, v101
    v_mfma_f32_16x16x32_bf16 v[104:107], a[204:207], a[60:63], v[104:107]
    ds_read2_b64 a[100:103], v6 offset0:0 offset1:128
    v_cvt_pk_bf16_f32 v213, v102, v103
    v_mfma_f32_16x16x32_bf16 v[104:107], a[208:211], a[64:67], v[104:107]
    v_mfma_f32_16x16x32_bf16 v[104:107], a[212:215], a[68:71], v[104:107]
    v_mfma_f32_16x16x32_bf16 v[108:111], a[192:195], a[72:75], 0
    v_mfma_f32_16x16x32_bf16 v[108:111], a[196:199], a[76:79], v[108:111]
    v_mfma_f32_16x16x32_bf16 v[108:111], a[200:203], a[80:83], v[108:111]
    v_cvt_pk_bf16_f32 v216, v104, v105
    v_cvt_pk_bf16_f32 v217, v106, v107
    v_mfma_f32_16x16x32_bf16 v[108:111], a[204:207], a[84:87], v[108:111]
    v_mfma_f32_16x16x32_bf16 v[108:111], a[208:211], a[88:91], v[108:111]
    ds_read_b128 a[240:243], v2 offset:8192
    v_mfma_f32_16x16x32_bf16 v[108:111], a[212:215], a[92:95], v[108:111]
    s_waitcnt lgkmcnt(7)
    v_mfma_f32_16x16x32_bf16 v[112:115], a[216:219], a[0:3], 0
    ds_read_b128 a[244:247], v2 offset:9216
    v_mfma_f32_16x16x32_bf16 v[112:115], a[220:223], a[4:7], v[112:115]
    v_mfma_f32_16x16x32_bf16 v[112:115], a[224:227], a[8:11], v[112:115]
    ds_read_b128 a[248:251], v2 offset:10240
    v_cvt_pk_bf16_f32 v220, v108, v109
    v_mfma_f32_16x16x32_bf16 v[112:115], a[228:231], a[12:15], v[112:115]
    v_cvt_pk_bf16_f32 v221, v110, v111
    v_mfma_f32_16x16x32_bf16 v[112:115], a[232:235], a[16:19], v[112:115]
    ds_read_b128 a[192:195], v2 offset:11264
    v_mfma_f32_16x16x32_bf16 v[112:115], a[236:239], a[20:23], v[112:115]
    v_mfma_f32_16x16x32_bf16 v[116:119], a[216:219], a[24:27], 0
    ds_read_b128 a[196:199], v2 offset:12288
    v_mfma_f32_16x16x32_bf16 v[116:119], a[220:223], a[28:31], v[116:119]
    s_waitcnt vmcnt(22)
    ds_write_b64 v4, a[104:105] offset:0
    v_mfma_f32_16x16x32_bf16 v[116:119], a[224:227], a[32:35], v[116:119]
    ds_read_b128 a[200:203], v2 offset:13312
    v_cvt_pk_bf16_f32 v210, v112, v113
    v_mfma_f32_16x16x32_bf16 v[116:119], a[228:231], a[36:39], v[116:119]
    ds_write_b64 v4, a[106:107] offset:1024
    v_mfma_f32_16x16x32_bf16 v[116:119], a[232:235], a[40:43], v[116:119]
    ds_write_b64 v4, a[108:109] offset:512
    v_mfma_f32_16x16x32_bf16 v[116:119], a[236:239], a[44:47], v[116:119]
    ds_write_b64 v4, a[110:111] offset:1536
    v_mfma_f32_16x16x32_bf16 v[120:123], a[216:219], a[48:51], 0
    ds_read2_b64 a[104:107], v5 offset0:0 offset1:128
    v_cvt_pk_bf16_f32 v211, v114, v115
    v_mfma_f32_16x16x32_bf16 v[120:123], a[220:223], a[52:55], v[120:123]
    ds_read2_b64 a[108:111], v6 offset0:0 offset1:128
    v_mfma_f32_16x16x32_bf16 v[120:123], a[224:227], a[56:59], v[120:123]
    v_cvt_pk_bf16_f32 v214, v116, v117
    v_cvt_pk_bf16_f32 v215, v118, v119
    v_mfma_f32_16x16x32_bf16 v[120:123], a[228:231], a[60:63], v[120:123]
    v_mfma_f32_16x16x32_bf16 v[120:123], a[232:235], a[64:67], v[120:123]
    v_mfma_f32_16x16x32_bf16 v[120:123], a[236:239], a[68:71], v[120:123]
    v_mfma_f32_16x16x32_bf16 v[124:127], a[216:219], a[72:75], 0
    v_mfma_f32_16x16x32_bf16 v[124:127], a[220:223], a[76:79], v[124:127]
    v_mfma_f32_16x16x32_bf16 v[124:127], a[224:227], a[80:83], v[124:127]
    v_cvt_pk_bf16_f32 v218, v120, v121
    v_cvt_pk_bf16_f32 v219, v122, v123
    v_mfma_f32_16x16x32_bf16 v[124:127], a[228:231], a[84:87], v[124:127]
    v_mfma_f32_16x16x32_bf16 v[124:127], a[232:235], a[88:91], v[124:127]
    v_mfma_f32_16x16x32_bf16 v[124:127], a[236:239], a[92:95], v[124:127]
    s_waitcnt lgkmcnt(4)
    v_mfma_f32_16x16x32_bf16 v[96:99], a[0:3], a[240:243], 0
    v_mfma_f32_16x16x32_bf16 v[96:99], a[4:7], a[244:247], v[96:99]
    v_mfma_f32_16x16x32_bf16 v[96:99], a[8:11], a[248:251], v[96:99]
    v_cvt_pk_bf16_f32 v222, v124, v125
    v_cvt_pk_bf16_f32 v223, v126, v127
    v_mfma_f32_16x16x32_bf16 v[96:99], a[12:15], a[192:195], v[96:99]
    v_mfma_f32_16x16x32_bf16 v[96:99], a[16:19], a[196:199], v[96:99]
    v_mfma_f32_16x16x32_bf16 v[96:99], a[20:23], a[200:203], v[96:99]
    v_mfma_f32_16x16x32_bf16 v[100:103], a[24:27], a[240:243], 0
    v_mfma_f32_16x16x32_bf16 v[100:103], a[28:31], a[244:247], v[100:103]
    v_mfma_f32_16x16x32_bf16 v[100:103], a[32:35], a[248:251], v[100:103]
    s_waitcnt vmcnt(17)
    ds_write_b64 v4, a[112:113] offset:0
    v_mfma_f32_16x16x32_bf16 v[100:103], a[36:39], a[192:195], v[100:103]
    ds_write_b64 v4, a[114:115] offset:1024
    v_mfma_f32_16x16x32_bf16 v[100:103], a[40:43], a[196:199], v[100:103]
    ds_write_b64 v4, a[116:117] offset:512
    v_mfma_f32_16x16x32_bf16 v[100:103], a[44:47], a[200:203], v[100:103]
    ds_write_b64 v4, a[118:119] offset:1536
    v_mfma_f32_16x16x32_bf16 v[32:35], a[16:19], v[192:195], v[32:35]
    ds_read2_b64 a[112:115], v5 offset0:0 offset1:128
    v_cvt_pk_bf16_f32 v128, v96, v97
    v_mfma_f32_16x16x32_bf16 v[32:35], a[20:23], v[208:211], v[32:35]
    ds_read2_b64 a[116:119], v6 offset0:0 offset1:128
    v_cvt_pk_bf16_f32 v129, v98, v99
    v_mfma_f32_16x16x32_bf16 v[36:39], a[40:43], v[192:195], v[36:39]
    buffer_load_dwordx4 a[168:171], v9, s[8:11], s30 offen offset:0 nt
    v_cvt_pk_bf16_f32 v130, v100, v101
    v_mfma_f32_16x16x32_bf16 v[36:39], a[44:47], v[208:211], v[36:39]
    buffer_load_dwordx4 a[172:175], v10, s[8:11], s30 offen offset:0 nt
    v_cvt_pk_bf16_f32 v131, v102, v103
    v_mov_b32 v16, 0x30000
    v_mov_b32 v17, 0x30000
    v_mov_b32 v18, 0x30000
    s_mov_b32 s18, 1
    s_mov_b32 s19, 0
    s_branch L_loop
L_slow0:
    s_sub_u32 s43, s43, 1
    s_cbranch_scc1 L_end
    ds_read_b32 v30, v29
    s_waitcnt lgkmcnt(0)
    v_readfirstlane_b32 s41, v30
    s_nop 1
    s_andn2_b32 s41, 1, s41
    s_cbranch_scc1 L_slow0
    s_branch L_ok0
L_slow1:
    s_sub_u32 s43, s43, 1
    s_cbranch_scc1 L_end
    ds_read_b32 v30, v29
    s_waitcnt lgkmcnt(0)
    v_readfirstlane_b32 s41, v30
    s_nop 1
    s_andn2_b32 s41, 2, s41
    s_cbranch_scc1 L_slow1
    s_branch L_ok1
L_slow2:
    s_sub_u32 s43, s43, 1
    s_cbranch_scc1 L_end
    ds_read_b32 v30, v29
    s_waitcnt lgkmcnt(0)
    v_readfirstlane_b32 s41, v30
    s_nop 1
    s_andn2_b32 s41, 4, s41
    s_cbranch_scc1 L_slow2
    s_branch L_ok2
L_slow3:
    s_sub_u32 s43, s43, 1
    s_cbranch_scc1 L_end
    ds_read_b32 v30, v29
    s_waitcnt lgkmcnt(0)
    v_readfirstlane_b32 s41, v30
    s_nop 1
    s_andn2_b32 s41, 8, s41
    s_cbranch_scc1 L_slow3
    s_branch L_ok3
L_slow4:
    s_sub_u32 s43, s43, 1
    s_cbranch_scc1 L_end
    ds_read_b32 v30, v29
    s_waitcnt lgkmcnt(0)
    v_readfirstlane_b32 s41, v30
    s_nop 1
    s_andn2_b32 s41, 16, s41
    s_cbranch_scc1 L_slow4
    s_branch L_ok4
L_slow5:
    s_sub_u32 s43, s43, 1
    s_cbranch_scc1 L_end
    ds_read_b32 v30, v29
    s_waitcnt lgkmcnt(0)
    v_readfirstlane_b32 s41, v30
    s_nop 1
    s_andn2_b32 s41, 32, s41
    s_cbranch_scc1 L_slow5
    s_branch L_ok5
L_slow6:
    s_sub_u32 s43, s43, 1
    s_cbranch_scc1 L_end
    ds_read_b32 v30, v29
    s_waitcnt lgkmcnt(0)
    v_readfirstlane_b32 s41, v30
    s_nop 1
    s_andn2_b32 s41, 960, s41
    s_cbranch_scc1 L_slow6
    s_branch L_ok6
L_fb:
    s_mov_b32 s60, 0
    s_cmp_lt_u32 s2, 192
    s_cbranch_scc0 L_fb_task
L_fbw:
    s_sub_u32 s43, s43, 1
    s_cbranch_scc1 L_end
    ds_read_b32 v34, v29 offset:4
    s_waitcnt lgkmcnt(0)
    v_readfirstlane_b32 s61, v34
    s_nop 1
    s_cmp_eq_u32 s61, 3
    s_cbranch_scc0 L_fbw
L_fb_task:
    s_mov_b32 s63, 3
    s_branch L_raw
L_fb_raw:
    s_bitcmp1_b32 s63, 1
    s_mov_b32 s63, 1
    s_cbranch_scc1 L_raw
    s_branch L_prod
L_fb_next:
    s_waitcnt vmcnt(0)
    s_add_u32 s60, s60, 1
    s_cmp_lt_u32 s60, 72
    s_cbranch_scc1 L_fb_task
    s_branch L_go
L_code_end:
.section .rodata,"a"
.p2align 6
.amdhsa_kernel standalone__swin_window_attn__vision_kernel
  .amdhsa_next_free_vgpr 512
  .amdhsa_next_free_sgpr 102
  .amdhsa_accum_offset 256
  .amdhsa_group_segment_fixed_size 0
  .amdhsa_kernarg_size 48
  .amdhsa_user_sgpr_count 2
  .amdhsa_user_sgpr_kernarg_segment_ptr 1
  .amdhsa_system_sgpr_workgroup_id_x 1
.end_amdhsa_kernel
```

```asm
; @launch grid=(256,1,1) block=(256,1,1) lds=163840
.amdgcn_target "amdgcn-amd-amdhsa--gfx950"
.text
.globl standalone__swin_window_attn__vision_kernel
.p2align 8
.type standalone__swin_window_attn__vision_kernel,@function
standalone__swin_window_attn__vision_kernel:
    s_cmp_ge_u32 s2, 256
    s_cbranch_scc1 L_end
    s_load_dwordx4 s[4:7], s[0:1], 0
    s_load_dwordx4 s[20:23], s[0:1], 16
    s_load_dwordx4 s[56:59], s[0:1], 32
    v_lshrrev_b32 v16, 6, v0
    v_and_b32 v0, 63, v0
    s_getpc_b64 s[44:45]
L_pc_ref:
    v_readfirstlane_b32 s49, v16
    s_mov_b32 s46, L_code_end-L_pc_ref
    s_mov_b32 s47, 0x00020000
    v_lshlrev_b32 v7, 6, v0
    s_lshr_b32 s60, s2, 3

    s_lshl_b32 s42, s60, 2
    s_add_u32 s42, s42, s49
    s_lshl_b32 s42, s42, 7
    v_lshrrev_b32 v8, 1, v0
    v_and_b32 v7, 1, v0
    v_lshlrev_b32 v7, 6, v7
    v_lshl_add_u32 v8, v8, 14, v7
    buffer_load_dword v8, v8, s[44:47], s42 offen
    s_cmp_lt_u32 s60, 24
    s_cbranch_scc0 L_setup
    s_cmp_ge_u32 s60, 12
    s_cselect_b32 s61, 12, 0
    s_cselect_b32 s62, 36, 0
    s_sub_u32 s61, s60, s61
    s_and_b32 s64, s61, 1
    s_mul_i32 s64, s64, 3
    s_max_u32 s65, s49, 1
    s_add_u32 s64, s64, s65
    s_sub_u32 s64, s64, 1
    s_mul_i32 s64, s64, 6
    s_lshr_b32 s61, s61, 1
    s_add_u32 s60, s64, s61
    s_add_u32 s60, s60, s62
    s_cmp_eq_u32 s49, 0
    s_cselect_b32 s63, 2, 0
L_raw:
    s_cmp_ge_u32 s60, 36
    s_cselect_b32 s65, 36, 0
    s_cselect_b32 s97, 768, 0
    s_sub_u32 s65, s60, s65
    s_mul_i32 s66, s65, 43
    s_lshr_b32 s66, s66, 8
    s_mul_i32 s67, s66, 6
    s_sub_u32 s67, s65, s67
    s_max_u32 s64, s49, 1
    s_mul_i32 s64, s64, 12288
    s_mul_i32 s61, s66, 36864
    s_add_u32 s61, s61, 384
    s_mul_i32 s62, s67, 36864
    s_add_u32 s62, s62, s97
    s_bitcmp1_b32 s63, 1
    s_cselect_b32 s61, s62, s61
    s_cselect_b32 s64, 0, s64
    s_cselect_b32 s97, 0, s97
    s_movk_i32 s62, 128
    s_movk_i32 s65, 9216
    s_mov_b32 s96, 32
    v_lshrrev_b32 v16, 3, v0
    v_and_b32 v17, 7, v0
    v_bfe_u32 v18, v0, 4, 1
    v_xor_b32 v17, v17, v18
    v_lshlrev_b32 v17, 4, v17
    v_mul_u32_u24 v16, 1152, v16
    s_cmp_eq_u32 s97, 0
    s_mov_b32 s18, 221184
    s_cbranch_scc1 L_raw_rows
    s_mov_b32 s18, 73728
    s_lshl_b32 s61, s66, 6
    s_movk_i32 s62, 6144
    s_movk_i32 s65, 18432
    s_mov_b32 s96, 0
    v_lshrrev_b32 v16, 2, v0
    v_mul_u32_u24 v16, 384, v16
    v_and_b32 v17, 3, v0
    v_lshlrev_b32 v17, 4, v17
L_raw_rows:
    s_waitcnt lgkmcnt(0)
    s_cmp_eq_u32 s97, 0
    s_cselect_b32 s16, s6, s20
    s_cselect_b32 s17, s7, s21
    s_mov_b32 s19, 0x00020000
    s_mov_b32 m0, s64
    s_mov_b32 s97, 4
L_raw_lp:
    v_add_u32 v18, v16, v17
    s_add_u32 s42, s61, s62
    buffer_load_dwordx4 v18, s[16:19], s61 offen lds
    s_add_u32 m0, m0, 1024
    s_add_u32 s41, s42, s62
    buffer_load_dwordx4 v18, s[16:19], s42 offen lds
    s_add_u32 m0, m0, 1024
    s_add_u32 s61, s61, s65
    buffer_load_dwordx4 v18, s[16:19], s41 offen lds
    s_add_u32 m0, m0, 1024
    s_and_b32 s42, s97, 1
    s_mul_i32 s42, s42, s96
    s_lshl_b32 s42, s42, 1
    s_add_u32 s42, s42, s96
    v_xor_b32 v17, s42, v17
    s_sub_u32 s97, s97, 1
    s_cmp_lg_u32 s97, 0
    s_cbranch_scc1 L_raw_lp
    s_bitcmp1_b32 s63, 0
    s_cbranch_scc1 L_fb_raw
L_setup:
    s_mov_b32 s43, 0x400000
    v_lshlrev_b32 v1, 4, v0
    v_add_u32 v2, 0x10000, v1
    v_add_u32 v3, 0x20000, v1
    v_lshrrev_b32 v16, 3, v0
    v_and_b32 v17, 7, v0
    v_lshrrev_b32 v18, 4, v0
    v_xor_b32 v17, v17, v18
    v_lshlrev_b32 v17, 4, v17
    v_mul_u32_u24 v16, 384, v16
    v_add_u32 v9, v16, v17
    v_xor_b32 v10, 64, v9
    v_add_u32 v10, 196608, v10
    s_lshl_b32 s52, s49, 11
    s_add_u32 s52, s52, 147456
    v_lshlrev_b32 v16, 3, v0
    v_add_u32 v4, s52, v16
    v_and_b32 v16, 15, v0
    v_lshrrev_b32 v17, 4, v0
    v_lshrrev_b32 v18, 1, v16
    v_xor_b32 v18, v18, v17
    v_lshlrev_b32 v18, 3, v18
    v_lshl_add_u32 v18, v16, 6, v18
    v_add_u32 v5, s52, v18
    v_xor_b32 v6, 32, v5
    v_lshrrev_b32 v16, 5, v0
    v_mul_u32_u24 v16, 196608, v16
    v_lshrrev_b32 v17, 4, v0
    v_and_b32 v17, 1, v17
    v_mul_u32_u24 v17, 1536, v17
    v_and_b32 v18, 15, v0
    v_lshlrev_b32 v18, 3, v18
    v_add3_u32 v11, v16, v17, v18
    s_nop 0
    s_and_b32 s53, s2, 7
    s_lshl_b32 s53, s53, 3
    s_lshr_b32 s54, s2, 7
    s_add_u32 s53, s53, s54
    s_lshr_b32 s54, s2, 3
    s_and_b32 s54, s54, 15
    s_mul_i32 s53, s53, 1572864
    s_lshl_b32 s54, s54, 2
    s_add_u32 s54, s54, s49
    s_mul_i32 s54, s54, 3072
    s_add_u32 s53, s53, s54
    s_add_u32 s24, s53, 0
    s_add_u32 s26, s53, 393216
    s_add_u32 s28, s53, 786432
    s_add_u32 s30, s53, 1179648
    v_mov_b32 v29, 155648
    v_mov_b32 v30, 0
    v_mov_b32 v31, 0
    ds_write_b64 v29, v[30:31]
    s_getreg_b32 s48, hwreg(HW_REG_XCC_ID, 0, 3)
    s_waitcnt lgkmcnt(0)
    s_mov_b32 s8, s4
    s_mov_b32 s9, s5
    s_mov_b32 s10, 100663296
    s_mov_b32 s11, 0x00020000
    s_barrier
    s_cmp_eq_u32 s49, 0
    s_cbranch_scc0 L_nox0
    buffer_load_dwordx4 a[0:3], v9, s[8:11], s24 offen offset:0 nt
    buffer_load_dwordx4 a[4:7], v10, s[8:11], s24 offen offset:0 nt
    buffer_load_dwordx4 a[8:11], v9, s[8:11], s24 offen offset:128 nt
    buffer_load_dwordx4 a[12:15], v10, s[8:11], s24 offen offset:128 nt
    buffer_load_dwordx4 a[16:19], v9, s[8:11], s24 offen offset:256 nt
    buffer_load_dwordx4 a[20:23], v10, s[8:11], s24 offen offset:256 nt
    buffer_load_dwordx4 a[24:27], v9, s[8:11], s26 offen offset:0 nt
    buffer_load_dwordx4 a[28:31], v10, s[8:11], s26 offen offset:0 nt
    buffer_load_dwordx4 a[32:35], v9, s[8:11], s26 offen offset:128 nt
    buffer_load_dwordx4 a[36:39], v10, s[8:11], s26 offen offset:128 nt
    buffer_load_dwordx4 a[40:43], v9, s[8:11], s26 offen offset:256 nt
    buffer_load_dwordx4 a[44:47], v10, s[8:11], s26 offen offset:256 nt
    buffer_load_dwordx4 a[48:51], v9, s[8:11], s28 offen offset:0 nt
    buffer_load_dwordx4 a[52:55], v10, s[8:11], s28 offen offset:0 nt
    buffer_load_dwordx4 a[56:59], v9, s[8:11], s28 offen offset:128 nt
    buffer_load_dwordx4 a[60:63], v10, s[8:11], s28 offen offset:128 nt
    buffer_load_dwordx4 a[64:67], v9, s[8:11], s28 offen offset:256 nt
    buffer_load_dwordx4 a[68:71], v10, s[8:11], s28 offen offset:256 nt
    buffer_load_dwordx4 a[72:75], v9, s[8:11], s30 offen offset:0 nt
    buffer_load_dwordx4 a[76:79], v10, s[8:11], s30 offen offset:0 nt
    buffer_load_dwordx4 a[80:83], v9, s[8:11], s30 offen offset:128 nt
    buffer_load_dwordx4 a[84:87], v10, s[8:11], s30 offen offset:128 nt
    buffer_load_dwordx4 a[88:91], v9, s[8:11], s30 offen offset:256 nt
    buffer_load_dwordx4 a[92:95], v10, s[8:11], s30 offen offset:256 nt
L_nox0:
    s_mov_b32 s3, s53
    s_mov_b32 s12, s22
    s_mov_b32 s13, s23
    s_mov_b32 s14, 100663296
    s_mov_b32 s15, 0x00020000
    s_mov_b32 s40, 0x3dd53b95
    s_mov_b32 s50, s58
    s_mov_b32 s51, s59
    s_mov_b32 s58, 256
    s_mov_b32 s59, 0x00020000
    s_mul_i32 s52, s48, 147456
    s_add_u32 s52, s50, s52
    s_addc_u32 s53, s51, 0
    s_mov_b32 s54, 147456
    s_mov_b32 s55, 0x00020000
    s_lshl_b32 s48, s48, 5
    s_lshl_b32 s42, 4096, s49
    v_mov_b32 v31, s42
    s_cmp_eq_u32 s49, 0
    s_cbranch_scc1 L_w0
    s_cmp_lt_u32 s2, 192
    s_cbranch_scc0 L_noprod
L_prod:
    s_mul_i32 s61, s66, 12
    s_add_u32 s61, s61, s67
    s_lshl_b32 s61, s61, 10
    s_add_u32 s62, s61, 6144
    v_mov_b32 v27, v1
    v_bfe_u32 v22, v0, 2, 2
    v_and_b32 v23, 3, v0
    v_lshrrev_b32 v26, 4, v0
    s_cmp_ge_u32 s60, 36
    s_cbranch_scc0 L_prod_A
    v_mul_u32_u24 v27, 6144, v23
    v_lshlrev_b32 v24, 8, v26
    v_lshlrev_b32 v25, 4, v22
    v_add3_u32 v27, v27, v24, v25
    s_lshr_b32 s61, s66, 1
    s_mul_i32 s61, s61, 24576
    s_and_b32 s62, s66, 1
    s_lshl_b32 s62, s62, 7
    s_add_u32 s61, s61, s62
    s_lshl_b32 s62, s67, 10
    s_add_u32 s61, s61, s62
    s_add_u32 s61, s61, 73728
    s_add_u32 s62, s61, 64
L_prod_A:
    v_mul_u32_u24 v24, 3072, v22
    v_lshl_add_u32 v24, v23, 7, v24
    v_bfe_u32 v25, v0, 1, 1
    v_lshl_add_u32 v25, v22, 1, v25
    v_xor_b32 v25, v25, v26
    v_lshl_add_u32 v24, v25, 4, v24
    v_xor_b32 v25, 64, v24
    v_lshl_add_u32 v26, v26, 3, v22
    v_lshlrev_b32 v26, 6, v26
    v_lshl_add_u32 v26, v23, 3, v26
    v_add_u32 v26, s64, v26
    s_waitcnt vmcnt(0)
    s_bitcmp1_b32 s63, 0
    s_cbranch_scc1 L_gotA
L_wA:
    s_sub_u32 s43, s43, 1
    s_cbranch_scc1 L_end
    ds_read_b32 v30, v29
    s_waitcnt lgkmcnt(0)
    v_readfirstlane_b32 s41, v30
    s_nop 1
    s_and_b32 s42, s41, 0x100000
    s_cmp_eq_u32 s42, 0x100000
    s_cbranch_scc0 L_wA
L_gotA:
    ds_read_b128 v[32:35], v24 offset:0
    ds_read_b128 v[56:59], v24 offset:512
    ds_read_b128 v[36:39], v25 offset:0
    ds_read_b128 v[60:63], v25 offset:512
    ds_read_b128 v[40:43], v24 offset:1024
    ds_read_b128 v[64:67], v24 offset:1536
    ds_read_b128 v[44:47], v25 offset:1024
    ds_read_b128 v[68:71], v25 offset:1536
    ds_read_b128 v[48:51], v24 offset:2048
    ds_read_b128 v[72:75], v24 offset:2560
    ds_read_b128 v[52:55], v25 offset:2048
    ds_read_b128 v[76:79], v25 offset:2560
    s_cmp_ge_u32 s60, 36
    s_cbranch_scc1 L_prod_N2
    v_add_u32 v24, s64, v24
    v_add_u32 v25, s64, v25
    ds_read_b128 v[80:83], v24 offset:0
    ds_read_b128 v[104:107], v24 offset:512
    ds_read_b128 v[84:87], v25 offset:0
    ds_read_b128 v[108:111], v25 offset:512
    ds_read_b128 v[88:91], v24 offset:1024
    ds_read_b128 v[112:115], v24 offset:1536
    ds_read_b128 v[92:95], v25 offset:1024
    ds_read_b128 v[116:119], v25 offset:1536
    ds_read_b128 v[96:99], v24 offset:2048
    ds_read_b128 v[120:123], v24 offset:2560
    ds_read_b128 v[100:103], v25 offset:2048
    ds_read_b128 v[124:127], v25 offset:2560
    s_branch L_prod_mm
L_prod_N2:
    ds_read_b64_tr_b16 v[80:81], v26 offset:0
    ds_read_b64_tr_b16 v[82:83], v26 offset:256
    ds_read_b64_tr_b16 v[104:105], v26 offset:32
    ds_read_b64_tr_b16 v[106:107], v26 offset:288
    ds_read_b64_tr_b16 v[84:85], v26 offset:2048
    ds_read_b64_tr_b16 v[86:87], v26 offset:2304
    ds_read_b64_tr_b16 v[108:109], v26 offset:2080
    ds_read_b64_tr_b16 v[110:111], v26 offset:2336
    ds_read_b64_tr_b16 v[88:89], v26 offset:4096
    ds_read_b64_tr_b16 v[90:91], v26 offset:4352
    ds_read_b64_tr_b16 v[112:113], v26 offset:4128
    ds_read_b64_tr_b16 v[114:115], v26 offset:4384
    ds_read_b64_tr_b16 v[92:93], v26 offset:6144
    ds_read_b64_tr_b16 v[94:95], v26 offset:6400
    ds_read_b64_tr_b16 v[116:117], v26 offset:6176
    ds_read_b64_tr_b16 v[118:119], v26 offset:6432
    ds_read_b64_tr_b16 v[96:97], v26 offset:8192
    ds_read_b64_tr_b16 v[98:99], v26 offset:8448
    ds_read_b64_tr_b16 v[120:121], v26 offset:8224
    ds_read_b64_tr_b16 v[122:123], v26 offset:8480
    ds_read_b64_tr_b16 v[100:101], v26 offset:10240
    ds_read_b64_tr_b16 v[102:103], v26 offset:10496
    ds_read_b64_tr_b16 v[124:125], v26 offset:10272
    ds_read_b64_tr_b16 v[126:127], v26 offset:10528
L_prod_mm:
    s_cmp_ge_u32 s60, 36
    s_cselect_b32 s65, 1.0, s40
    s_waitcnt lgkmcnt(0)
    v_mfma_f32_16x16x32_bf16 v[128:131], v[32:35], v[80:83], 0
    v_mfma_f32_16x16x32_bf16 v[132:135], v[56:59], v[80:83], 0
    v_mfma_f32_16x16x32_bf16 v[128:131], v[36:39], v[84:87], v[128:131]
    v_mfma_f32_16x16x32_bf16 v[132:135], v[60:63], v[84:87], v[132:135]
    v_mfma_f32_16x16x32_bf16 v[128:131], v[40:43], v[88:91], v[128:131]
    v_mfma_f32_16x16x32_bf16 v[132:135], v[64:67], v[88:91], v[132:135]
    v_mfma_f32_16x16x32_bf16 v[128:131], v[44:47], v[92:95], v[128:131]
    v_mfma_f32_16x16x32_bf16 v[132:135], v[68:71], v[92:95], v[132:135]
    v_mfma_f32_16x16x32_bf16 v[128:131], v[48:51], v[96:99], v[128:131]
    v_mfma_f32_16x16x32_bf16 v[132:135], v[72:75], v[96:99], v[132:135]
    v_mfma_f32_16x16x32_bf16 v[128:131], v[52:55], v[100:103], v[128:131]
    v_mfma_f32_16x16x32_bf16 v[132:135], v[76:79], v[100:103], v[132:135]
    v_mfma_f32_16x16x32_bf16 v[136:139], v[32:35], v[104:107], 0
    v_mfma_f32_16x16x32_bf16 v[140:143], v[56:59], v[104:107], 0
    v_mfma_f32_16x16x32_bf16 v[136:139], v[36:39], v[108:111], v[136:139]
    v_mfma_f32_16x16x32_bf16 v[140:143], v[60:63], v[108:111], v[140:143]
    v_mfma_f32_16x16x32_bf16 v[136:139], v[40:43], v[112:115], v[136:139]
    v_mfma_f32_16x16x32_bf16 v[140:143], v[64:67], v[112:115], v[140:143]
    v_mfma_f32_16x16x32_bf16 v[136:139], v[44:47], v[116:119], v[136:139]
    v_mfma_f32_16x16x32_bf16 v[140:143], v[68:71], v[116:119], v[140:143]
    v_mfma_f32_16x16x32_bf16 v[136:139], v[48:51], v[120:123], v[136:139]
    v_mfma_f32_16x16x32_bf16 v[140:143], v[72:75], v[120:123], v[140:143]
    v_mfma_f32_16x16x32_bf16 v[136:139], v[52:55], v[124:127], v[136:139]
    v_mfma_f32_16x16x32_bf16 v[140:143], v[76:79], v[124:127], v[140:143]
    v_mul_f32 v128, s65, v128
    v_mul_f32 v129, s65, v129
    v_mul_f32 v130, s65, v130
    v_mul_f32 v131, s65, v131
    v_mul_f32 v132, s65, v132
    v_mul_f32 v133, s65, v133
    v_mul_f32 v134, s65, v134
    v_mul_f32 v135, s65, v135
    v_cvt_pk_bf16_f32 v144, v128, v129
    v_cvt_pk_bf16_f32 v145, v130, v131
    v_cvt_pk_bf16_f32 v146, v132, v133
    v_cvt_pk_bf16_f32 v147, v134, v135
    buffer_store_dwordx4 v[144:147], v27, s[52:55], s61 offen
    s_nop 7
    v_mul_f32 v136, s65, v136
    v_mul_f32 v137, s65, v137
    v_mul_f32 v138, s65, v138
    v_mul_f32 v139, s65, v139
    v_mul_f32 v140, s65, v140
    v_mul_f32 v141, s65, v141
    v_mul_f32 v142, s65, v142
    v_mul_f32 v143, s65, v143
    v_cvt_pk_bf16_f32 v148, v136, v137
    v_cvt_pk_bf16_f32 v149, v138, v139
    v_cvt_pk_bf16_f32 v150, v140, v141
    v_cvt_pk_bf16_f32 v151, v142, v143
    buffer_store_dwordx4 v[148:151], v27, s[52:55], s62 offen
    s_bitcmp1_b32 s63, 0
    s_cbranch_scc1 L_fb_next
    s_cmp_eq_u32 s49, 1
    s_cbranch_scc0 L_p23
    buffer_load_dwordx4 a[0:3], v9, s[8:11], s24 offen offset:0 nt
    buffer_load_dwordx4 a[4:7], v10, s[8:11], s24 offen offset:0 nt
    buffer_load_dwordx4 a[8:11], v9, s[8:11], s24 offen offset:128 nt
    buffer_load_dwordx4 a[12:15], v10, s[8:11], s24 offen offset:128 nt
    buffer_load_dwordx4 a[16:19], v9, s[8:11], s24 offen offset:256 nt
    buffer_load_dwordx4 a[20:23], v10, s[8:11], s24 offen offset:256 nt
    buffer_load_dwordx4 a[24:27], v9, s[8:11], s26 offen offset:0 nt
    buffer_load_dwordx4 a[28:31], v10, s[8:11], s26 offen offset:0 nt
    buffer_load_dwordx4 a[32:35], v9, s[8:11], s26 offen offset:128 nt
    buffer_load_dwordx4 a[36:39], v10, s[8:11], s26 offen offset:128 nt
    buffer_load_dwordx4 a[40:43], v9, s[8:11], s26 offen offset:256 nt
    buffer_load_dwordx4 a[44:47], v10, s[8:11], s26 offen offset:256 nt
    buffer_load_dwordx4 a[48:51], v9, s[8:11], s28 offen offset:0 nt
    buffer_load_dwordx4 a[52:55], v10, s[8:11], s28 offen offset:0 nt
    buffer_load_dwordx4 a[56:59], v9, s[8:11], s28 offen offset:128 nt
    buffer_load_dwordx4 a[60:63], v10, s[8:11], s28 offen offset:128 nt
    buffer_load_dwordx4 a[64:67], v9, s[8:11], s28 offen offset:256 nt
    buffer_load_dwordx4 a[68:71], v10, s[8:11], s28 offen offset:256 nt
    buffer_load_dwordx4 a[72:75], v9, s[8:11], s30 offen offset:0 nt
    buffer_load_dwordx4 a[76:79], v10, s[8:11], s30 offen offset:0 nt
    buffer_load_dwordx4 a[80:83], v9, s[8:11], s30 offen offset:128 nt
    buffer_load_dwordx4 a[84:87], v10, s[8:11], s30 offen offset:128 nt
    buffer_load_dwordx4 a[88:91], v9, s[8:11], s30 offen offset:256 nt
    buffer_load_dwordx4 a[92:95], v10, s[8:11], s30 offen offset:256 nt
    s_waitcnt vmcnt(24)
    v_mov_b32 v32, 1
    s_lshr_b32 s60, s2, 3
    s_add_u32 s60, s60, s48
    v_mov_b32 v33, s60
    s_mov_b64 exec, 1
    ds_add_rtn_u32 v34, v29, v32 offset:4
    s_waitcnt lgkmcnt(0)
    v_readfirstlane_b32 s61, v34
    s_nop 1
    s_cmp_eq_u32 s61, 2
    s_cbranch_scc0 L_nl1
    buffer_store_byte v32, v33, s[56:59], 0 offen
    v_mov_b32 v32, 0x400000
    ds_or_b32 v29, v32
L_nl1:
    s_mov_b64 exec, -1
    v_mov_b32 v16, v4
    v_mov_b32 v17, v5
    v_mov_b32 v18, v6
    s_waitcnt vmcnt(22)
    ds_write_b64 v16, a[0:1] offset:0
    ds_write_b64 v16, a[2:3] offset:1024
    ds_write_b64 v16, a[4:5] offset:512
    ds_write_b64 v16, a[6:7] offset:1536
    ds_read2_b64 a[0:3], v17 offset0:0 offset1:128
    ds_read2_b64 a[4:7], v18 offset0:0 offset1:128
    s_waitcnt vmcnt(20)
    ds_or_b32 v29, v31
    ds_write_b64 v16, a[8:9] offset:0
    ds_write_b64 v16, a[10:11] offset:1024
    ds_write_b64 v16, a[12:13] offset:512
    ds_write_b64 v16, a[14:15] offset:1536
    ds_read2_b64 a[8:11], v17 offset0:0 offset1:128
    ds_read2_b64 a[12:15], v18 offset0:0 offset1:128
    s_waitcnt vmcnt(18)
    ds_write_b64 v16, a[16:17] offset:0
    ds_write_b64 v16, a[18:19] offset:1024
    ds_write_b64 v16, a[20:21] offset:512
    ds_write_b64 v16, a[22:23] offset:1536
    ds_read2_b64 a[16:19], v17 offset0:0 offset1:128
    ds_read2_b64 a[20:23], v18 offset0:0 offset1:128
    s_waitcnt vmcnt(16)
    ds_write_b64 v16, a[24:25] offset:0
    ds_write_b64 v16, a[26:27] offset:1024
    ds_write_b64 v16, a[28:29] offset:512
    ds_write_b64 v16, a[30:31] offset:1536
    ds_read2_b64 a[24:27], v17 offset0:0 offset1:128
    ds_read2_b64 a[28:31], v18 offset0:0 offset1:128
    s_waitcnt vmcnt(14)
    ds_write_b64 v16, a[32:33] offset:0
    ds_write_b64 v16, a[34:35] offset:1024
    ds_write_b64 v16, a[36:37] offset:512
    ds_write_b64 v16, a[38:39] offset:1536
    ds_read2_b64 a[32:35], v17 offset0:0 offset1:128
    ds_read2_b64 a[36:39], v18 offset0:0 offset1:128
    s_waitcnt vmcnt(12)
    ds_write_b64 v16, a[40:41] offset:0
    ds_write_b64 v16, a[42:43] offset:1024
    ds_write_b64 v16, a[44:45] offset:512
    ds_write_b64 v16, a[46:47] offset:1536
    ds_read2_b64 a[40:43], v17 offset0:0 offset1:128
    ds_read2_b64 a[44:47], v18 offset0:0 offset1:128
    s_waitcnt vmcnt(10)
    ds_write_b64 v16, a[48:49] offset:0
    ds_write_b64 v16, a[50:51] offset:1024
    ds_write_b64 v16, a[52:53] offset:512
    ds_write_b64 v16, a[54:55] offset:1536
    ds_read2_b64 a[48:51], v17 offset0:0 offset1:128
    ds_read2_b64 a[52:55], v18 offset0:0 offset1:128
    s_waitcnt vmcnt(8)
    ds_write_b64 v16, a[56:57] offset:0
    ds_write_b64 v16, a[58:59] offset:1024
    ds_write_b64 v16, a[60:61] offset:512
    ds_write_b64 v16, a[62:63] offset:1536
    ds_read2_b64 a[56:59], v17 offset0:0 offset1:128
    ds_read2_b64 a[60:63], v18 offset0:0 offset1:128
    s_waitcnt vmcnt(6)
    ds_write_b64 v16, a[64:65] offset:0
    ds_write_b64 v16, a[66:67] offset:1024
    ds_write_b64 v16, a[68:69] offset:512
    ds_write_b64 v16, a[70:71] offset:1536
    ds_read2_b64 a[64:67], v17 offset0:0 offset1:128
    ds_read2_b64 a[68:71], v18 offset0:0 offset1:128
    s_waitcnt vmcnt(4)
    ds_write_b64 v16, a[72:73] offset:0
    ds_write_b64 v16, a[74:75] offset:1024
    ds_write_b64 v16, a[76:77] offset:512
    ds_write_b64 v16, a[78:79] offset:1536
    ds_read2_b64 a[72:75], v17 offset0:0 offset1:128
    ds_read2_b64 a[76:79], v18 offset0:0 offset1:128
    s_waitcnt vmcnt(2)
    ds_write_b64 v16, a[80:81] offset:0
    ds_write_b64 v16, a[82:83] offset:1024
    ds_write_b64 v16, a[84:85] offset:512
    ds_write_b64 v16, a[86:87] offset:1536
    ds_read2_b64 a[80:83], v17 offset0:0 offset1:128
    ds_read2_b64 a[84:87], v18 offset0:0 offset1:128
    s_waitcnt vmcnt(0)
    ds_write_b64 v16, a[88:89] offset:0
    ds_write_b64 v16, a[90:91] offset:1024
    ds_write_b64 v16, a[92:93] offset:512
    ds_write_b64 v16, a[94:95] offset:1536
    ds_read2_b64 a[88:91], v17 offset0:0 offset1:128
    ds_read2_b64 a[92:95], v18 offset0:0 offset1:128
    s_branch L_w1go
L_p23:
    s_waitcnt vmcnt(0)
    v_mov_b32 v32, 1
    s_lshr_b32 s60, s2, 3
    s_add_u32 s60, s60, s48
    v_mov_b32 v33, s60
    s_mov_b64 exec, 1
    ds_add_rtn_u32 v34, v29, v32 offset:4
    s_waitcnt lgkmcnt(0)
    v_readfirstlane_b32 s61, v34
    s_nop 1
    s_cmp_eq_u32 s61, 2
    s_cbranch_scc0 L_nl2
    buffer_store_byte v32, v33, s[56:59], 0 offen
    v_mov_b32 v32, 0x400000
    ds_or_b32 v29, v32
L_nl2:
    s_mov_b64 exec, -1
L_noprod:
    s_lshl_b32 s60, 2048, s49
    s_cmp_lt_u32 s2, 192
    s_cselect_b32 s61, 0x400000, 0
    s_or_b32 s60, s60, s61
L_wpace:
    s_sub_u32 s43, s43, 1
    s_cbranch_scc1 L_end
    ds_read_b32 v30, v29
    s_waitcnt lgkmcnt(0)
    v_readfirstlane_b32 s41, v30
    s_nop 1
    s_and_b32 s42, s41, s60
    s_cmp_eq_u32 s42, s60
    s_cbranch_scc0 L_wpace
    buffer_load_dwordx4 a[0:3], v9, s[8:11], s24 offen offset:0 nt
    buffer_load_dwordx4 a[4:7], v10, s[8:11], s24 offen offset:0 nt
    buffer_load_dwordx4 a[8:11], v9, s[8:11], s24 offen offset:128 nt
    buffer_load_dwordx4 a[12:15], v10, s[8:11], s24 offen offset:128 nt
    buffer_load_dwordx4 a[16:19], v9, s[8:11], s24 offen offset:256 nt
    buffer_load_dwordx4 a[20:23], v10, s[8:11], s24 offen offset:256 nt
    buffer_load_dwordx4 a[24:27], v9, s[8:11], s26 offen offset:0 nt
    buffer_load_dwordx4 a[28:31], v10, s[8:11], s26 offen offset:0 nt
    buffer_load_dwordx4 a[32:35], v9, s[8:11], s26 offen offset:128 nt
    buffer_load_dwordx4 a[36:39], v10, s[8:11], s26 offen offset:128 nt
    buffer_load_dwordx4 a[40:43], v9, s[8:11], s26 offen offset:256 nt
    buffer_load_dwordx4 a[44:47], v10, s[8:11], s26 offen offset:256 nt
    buffer_load_dwordx4 a[48:51], v9, s[8:11], s28 offen offset:0 nt
    buffer_load_dwordx4 a[52:55], v10, s[8:11], s28 offen offset:0 nt
    buffer_load_dwordx4 a[56:59], v9, s[8:11], s28 offen offset:128 nt
    buffer_load_dwordx4 a[60:63], v10, s[8:11], s28 offen offset:128 nt
    buffer_load_dwordx4 a[64:67], v9, s[8:11], s28 offen offset:256 nt
    buffer_load_dwordx4 a[68:71], v10, s[8:11], s28 offen offset:256 nt
    buffer_load_dwordx4 a[72:75], v9, s[8:11], s30 offen offset:0 nt
    buffer_load_dwordx4 a[76:79], v10, s[8:11], s30 offen offset:0 nt
    buffer_load_dwordx4 a[80:83], v9, s[8:11], s30 offen offset:128 nt
    buffer_load_dwordx4 a[84:87], v10, s[8:11], s30 offen offset:128 nt
    buffer_load_dwordx4 a[88:91], v9, s[8:11], s30 offen offset:256 nt
    buffer_load_dwordx4 a[92:95], v10, s[8:11], s30 offen offset:256 nt
    v_mov_b32 v16, v4
    v_mov_b32 v17, v5
    v_mov_b32 v18, v6
    s_waitcnt vmcnt(22)
    ds_write_b64 v16, a[0:1] offset:0
    ds_write_b64 v16, a[2:3] offset:1024
    ds_write_b64 v16, a[4:5] offset:512
    ds_write_b64 v16, a[6:7] offset:1536
    ds_read2_b64 a[0:3], v17 offset0:0 offset1:128
    ds_read2_b64 a[4:7], v18 offset0:0 offset1:128
    s_waitcnt vmcnt(20)
    ds_or_b32 v29, v31
    ds_write_b64 v16, a[8:9] offset:0
    ds_write_b64 v16, a[10:11] offset:1024
    ds_write_b64 v16, a[12:13] offset:512
    ds_write_b64 v16, a[14:15] offset:1536
    ds_read2_b64 a[8:11], v17 offset0:0 offset1:128
    ds_read2_b64 a[12:15], v18 offset0:0 offset1:128
    s_waitcnt vmcnt(18)
    ds_write_b64 v16, a[16:17] offset:0
    ds_write_b64 v16, a[18:19] offset:1024
    ds_write_b64 v16, a[20:21] offset:512
    ds_write_b64 v16, a[22:23] offset:1536
    ds_read2_b64 a[16:19], v17 offset0:0 offset1:128
    ds_read2_b64 a[20:23], v18 offset0:0 offset1:128
    s_waitcnt vmcnt(16)
    ds_write_b64 v16, a[24:25] offset:0
    ds_write_b64 v16, a[26:27] offset:1024
    ds_write_b64 v16, a[28:29] offset:512
    ds_write_b64 v16, a[30:31] offset:1536
    ds_read2_b64 a[24:27], v17 offset0:0 offset1:128
    ds_read2_b64 a[28:31], v18 offset0:0 offset1:128
    s_waitcnt vmcnt(14)
    ds_write_b64 v16, a[32:33] offset:0
    ds_write_b64 v16, a[34:35] offset:1024
    ds_write_b64 v16, a[36:37] offset:512
    ds_write_b64 v16, a[38:39] offset:1536
    ds_read2_b64 a[32:35], v17 offset0:0 offset1:128
    ds_read2_b64 a[36:39], v18 offset0:0 offset1:128
    s_waitcnt vmcnt(12)
    ds_write_b64 v16, a[40:41] offset:0
    ds_write_b64 v16, a[42:43] offset:1024
    ds_write_b64 v16, a[44:45] offset:512
    ds_write_b64 v16, a[46:47] offset:1536
    ds_read2_b64 a[40:43], v17 offset0:0 offset1:128
    ds_read2_b64 a[44:47], v18 offset0:0 offset1:128
    s_waitcnt vmcnt(10)
    ds_write_b64 v16, a[48:49] offset:0
    ds_write_b64 v16, a[50:51] offset:1024
    ds_write_b64 v16, a[52:53] offset:512
    ds_write_b64 v16, a[54:55] offset:1536
    ds_read2_b64 a[48:51], v17 offset0:0 offset1:128
    ds_read2_b64 a[52:55], v18 offset0:0 offset1:128
    s_waitcnt vmcnt(8)
    ds_write_b64 v16, a[56:57] offset:0
    ds_write_b64 v16, a[58:59] offset:1024
    ds_write_b64 v16, a[60:61] offset:512
    ds_write_b64 v16, a[62:63] offset:1536
    ds_read2_b64 a[56:59], v17 offset0:0 offset1:128
    ds_read2_b64 a[60:63], v18 offset0:0 offset1:128
    s_waitcnt vmcnt(6)
    ds_write_b64 v16, a[64:65] offset:0
    ds_write_b64 v16, a[66:67] offset:1024
    ds_write_b64 v16, a[68:69] offset:512
    ds_write_b64 v16, a[70:71] offset:1536
    ds_read2_b64 a[64:67], v17 offset0:0 offset1:128
    ds_read2_b64 a[68:71], v18 offset0:0 offset1:128
    s_waitcnt vmcnt(4)
    ds_write_b64 v16, a[72:73] offset:0
    ds_write_b64 v16, a[74:75] offset:1024
    ds_write_b64 v16, a[76:77] offset:512
    ds_write_b64 v16, a[78:79] offset:1536
    ds_read2_b64 a[72:75], v17 offset0:0 offset1:128
    ds_read2_b64 a[76:79], v18 offset0:0 offset1:128
    s_waitcnt vmcnt(2)
    ds_write_b64 v16, a[80:81] offset:0
    ds_write_b64 v16, a[82:83] offset:1024
    ds_write_b64 v16, a[84:85] offset:512
    ds_write_b64 v16, a[86:87] offset:1536
    ds_read2_b64 a[80:83], v17 offset0:0 offset1:128
    ds_read2_b64 a[84:87], v18 offset0:0 offset1:128
    s_waitcnt vmcnt(0)
    ds_write_b64 v16, a[88:89] offset:0
    ds_write_b64 v16, a[90:91] offset:1024
    ds_write_b64 v16, a[92:93] offset:512
    ds_write_b64 v16, a[94:95] offset:1536
    ds_read2_b64 a[88:91], v17 offset0:0 offset1:128
    ds_read2_b64 a[92:95], v18 offset0:0 offset1:128
L_w1go:
    s_cmp_eq_u32 s49, 1
    s_cbranch_scc0 L_enter
L_wgo:
    s_sub_u32 s43, s43, 1
    s_cbranch_scc1 L_end
    ds_read_b32 v30, v29
    s_waitcnt lgkmcnt(0)
    v_readfirstlane_b32 s41, v30
    s_nop 1
    s_and_b32 s42, s41, 0x200000
    s_cmp_eq_u32 s42, 0x200000
    s_cbranch_scc0 L_wgo
    s_mov_b32 s60, 36864
    s_add_u32 s61, s60, 0
    s_mov_b32 m0, s61
    s_nop 0
    buffer_load_dwordx4 v1, s[52:55], s61 offen offset:0 lds
    buffer_load_dwordx4 v1, s[52:55], s61 offen offset:1024 lds
    buffer_load_dwordx4 v1, s[52:55], s61 offen offset:2048 lds
    buffer_load_dwordx4 v1, s[52:55], s61 offen offset:3072 lds
    s_add_u32 s61, s60, 4096
    s_mov_b32 m0, s61
    s_nop 0
    buffer_load_dwordx4 v1, s[52:55], s61 offen offset:0 lds
    buffer_load_dwordx4 v1, s[52:55], s61 offen offset:1024 lds
    buffer_load_dwordx4 v1, s[52:55], s61 offen offset:2048 lds
    buffer_load_dwordx4 v1, s[52:55], s61 offen offset:3072 lds
    s_add_u32 s61, s60, 8192
    s_mov_b32 m0, s61
    s_nop 0
    buffer_load_dwordx4 v1, s[52:55], s61 offen offset:0 lds
    buffer_load_dwordx4 v1, s[52:55], s61 offen offset:1024 lds
    buffer_load_dwordx4 v1, s[52:55], s61 offen offset:2048 lds
    buffer_load_dwordx4 v1, s[52:55], s61 offen offset:3072 lds
    s_add_u32 s61, s60, 12288
    s_mov_b32 m0, s61
    s_nop 0
    buffer_load_dwordx4 v1, s[52:55], s61 offen offset:0 lds
    buffer_load_dwordx4 v1, s[52:55], s61 offen offset:1024 lds
    buffer_load_dwordx4 v1, s[52:55], s61 offen offset:2048 lds
    buffer_load_dwordx4 v1, s[52:55], s61 offen offset:3072 lds
    s_add_u32 s61, s60, 16384
    s_mov_b32 m0, s61
    s_nop 0
    buffer_load_dwordx4 v1, s[52:55], s61 offen offset:0 lds
    buffer_load_dwordx4 v1, s[52:55], s61 offen offset:1024 lds
    buffer_load_dwordx4 v1, s[52:55], s61 offen offset:2048 lds
    buffer_load_dwordx4 v1, s[52:55], s61 offen offset:3072 lds
    s_add_u32 s61, s60, 20480
    s_mov_b32 m0, s61
    s_nop 0
    buffer_load_dwordx4 v1, s[52:55], s61 offen offset:0 lds
    buffer_load_dwordx4 v1, s[52:55], s61 offen offset:1024 lds
    buffer_load_dwordx4 v1, s[52:55], s61 offen offset:2048 lds
    buffer_load_dwordx4 v1, s[52:55], s61 offen offset:3072 lds
    s_add_u32 s61, s60, 24576
    s_mov_b32 m0, s61
    s_nop 0
    buffer_load_dwordx4 v1, s[52:55], s61 offen offset:0 lds
    buffer_load_dwordx4 v1, s[52:55], s61 offen offset:1024 lds
    buffer_load_dwordx4 v1, s[52:55], s61 offen offset:2048 lds
    buffer_load_dwordx4 v1, s[52:55], s61 offen offset:3072 lds
    s_add_u32 s61, s60, 28672
    s_mov_b32 m0, s61
    s_nop 0
    buffer_load_dwordx4 v1, s[52:55], s61 offen offset:0 lds
    buffer_load_dwordx4 v1, s[52:55], s61 offen offset:1024 lds
    buffer_load_dwordx4 v1, s[52:55], s61 offen offset:2048 lds
    buffer_load_dwordx4 v1, s[52:55], s61 offen offset:3072 lds
    s_add_u32 s61, s60, 32768
    s_mov_b32 m0, s61
    s_nop 0
    buffer_load_dwordx4 v1, s[52:55], s61 offen offset:0 lds
    buffer_load_dwordx4 v1, s[52:55], s61 offen offset:1024 lds
    buffer_load_dwordx4 v1, s[52:55], s61 offen offset:2048 lds
    buffer_load_dwordx4 v1, s[52:55], s61 offen offset:3072 lds
    v_mov_b32 v26, 8
    v_mov_b32 v27, 16
    v_mov_b32 v28, 32
    s_branch L_enter
L_w0:
    s_waitcnt vmcnt(24)
    v_mov_b32 v30, 1048576
    ds_or_b32 v29, v30
    v_mov_b32 v16, v4
    v_mov_b32 v17, v5
    v_mov_b32 v18, v6
    s_waitcnt vmcnt(22)
    ds_write_b64 v16, a[0:1] offset:0
    ds_write_b64 v16, a[2:3] offset:1024
    ds_write_b64 v16, a[4:5] offset:512
    ds_write_b64 v16, a[6:7] offset:1536
    ds_read2_b64 a[0:3], v17 offset0:0 offset1:128
    ds_read2_b64 a[4:7], v18 offset0:0 offset1:128
    s_waitcnt vmcnt(20)
    ds_or_b32 v29, v31
    ds_write_b64 v16, a[8:9] offset:0
    ds_write_b64 v16, a[10:11] offset:1024
    ds_write_b64 v16, a[12:13] offset:512
    ds_write_b64 v16, a[14:15] offset:1536
    ds_read2_b64 a[8:11], v17 offset0:0 offset1:128
    ds_read2_b64 a[12:15], v18 offset0:0 offset1:128
    s_waitcnt vmcnt(18)
    ds_write_b64 v16, a[16:17] offset:0
    ds_write_b64 v16, a[18:19] offset:1024
    ds_write_b64 v16, a[20:21] offset:512
    ds_write_b64 v16, a[22:23] offset:1536
    ds_read2_b64 a[16:19], v17 offset0:0 offset1:128
    ds_read2_b64 a[20:23], v18 offset0:0 offset1:128
    s_waitcnt vmcnt(16)
    ds_write_b64 v16, a[24:25] offset:0
    ds_write_b64 v16, a[26:27] offset:1024
    ds_write_b64 v16, a[28:29] offset:512
    ds_write_b64 v16, a[30:31] offset:1536
    ds_read2_b64 a[24:27], v17 offset0:0 offset1:128
    ds_read2_b64 a[28:31], v18 offset0:0 offset1:128
    s_waitcnt vmcnt(14)
    ds_write_b64 v16, a[32:33] offset:0
    ds_write_b64 v16, a[34:35] offset:1024
    ds_write_b64 v16, a[36:37] offset:512
    ds_write_b64 v16, a[38:39] offset:1536
    ds_read2_b64 a[32:35], v17 offset0:0 offset1:128
    ds_read2_b64 a[36:39], v18 offset0:0 offset1:128
    s_waitcnt vmcnt(12)
    ds_write_b64 v16, a[40:41] offset:0
    ds_write_b64 v16, a[42:43] offset:1024
    ds_write_b64 v16, a[44:45] offset:512
    ds_write_b64 v16, a[46:47] offset:1536
    ds_read2_b64 a[40:43], v17 offset0:0 offset1:128
    ds_read2_b64 a[44:47], v18 offset0:0 offset1:128
    s_waitcnt vmcnt(10)
    ds_write_b64 v16, a[48:49] offset:0
    ds_write_b64 v16, a[50:51] offset:1024
    ds_write_b64 v16, a[52:53] offset:512
    ds_write_b64 v16, a[54:55] offset:1536
    ds_read2_b64 a[48:51], v17 offset0:0 offset1:128
    ds_read2_b64 a[52:55], v18 offset0:0 offset1:128
    s_waitcnt vmcnt(8)
    ds_write_b64 v16, a[56:57] offset:0
    ds_write_b64 v16, a[58:59] offset:1024
    ds_write_b64 v16, a[60:61] offset:512
    ds_write_b64 v16, a[62:63] offset:1536
    ds_read2_b64 a[56:59], v17 offset0:0 offset1:128
    ds_read2_b64 a[60:63], v18 offset0:0 offset1:128
    s_waitcnt vmcnt(6)
    ds_write_b64 v16, a[64:65] offset:0
    ds_write_b64 v16, a[66:67] offset:1024
    ds_write_b64 v16, a[68:69] offset:512
    ds_write_b64 v16, a[70:71] offset:1536
    ds_read2_b64 a[64:67], v17 offset0:0 offset1:128
    ds_read2_b64 a[68:71], v18 offset0:0 offset1:128
    s_waitcnt vmcnt(4)
    ds_write_b64 v16, a[72:73] offset:0
    ds_write_b64 v16, a[74:75] offset:1024
    ds_write_b64 v16, a[76:77] offset:512
    ds_write_b64 v16, a[78:79] offset:1536
    ds_read2_b64 a[72:75], v17 offset0:0 offset1:128
    ds_read2_b64 a[76:79], v18 offset0:0 offset1:128
    s_waitcnt vmcnt(2)
    ds_write_b64 v16, a[80:81] offset:0
    ds_write_b64 v16, a[82:83] offset:1024
    ds_write_b64 v16, a[84:85] offset:512
    ds_write_b64 v16, a[86:87] offset:1536
    ds_read2_b64 a[80:83], v17 offset0:0 offset1:128
    ds_read2_b64 a[84:87], v18 offset0:0 offset1:128
    s_waitcnt vmcnt(0)
    ds_write_b64 v16, a[88:89] offset:0
    ds_write_b64 v16, a[90:91] offset:1024
    ds_write_b64 v16, a[92:93] offset:512
    ds_write_b64 v16, a[94:95] offset:1536
    ds_read2_b64 a[88:91], v17 offset0:0 offset1:128
    ds_read2_b64 a[92:95], v18 offset0:0 offset1:128
L_poll0:
    s_mov_b32 s61, 0
    v_min_u32 v33, 5, v0
    v_lshlrev_b32 v33, 2, v33
    s_mov_b32 s62, 0x01010101
    v_mov_b32 v34, 0
L_poll:
    buffer_load_dword v34, v33, s[56:59], s48 offen nt
    s_add_u32 s61, s61, 1
    s_sleep 4
    v_cmp_ne_u32 vcc, s62, v34
    s_nop 4
    s_cbranch_vccz L_go
    s_cmp_lt_u32 s61, 400
    s_cbranch_scc1 L_poll
    s_waitcnt vmcnt(0)
    s_branch L_fb
L_go:
    s_mov_b32 s60, 0
    s_add_u32 s61, s60, 0
    s_mov_b32 m0, s61
    s_nop 0
    buffer_load_dwordx4 v1, s[52:55], s61 offen offset:0 lds
    buffer_load_dwordx4 v1, s[52:55], s61 offen offset:1024 lds
    buffer_load_dwordx4 v1, s[52:55], s61 offen offset:2048 lds
    buffer_load_dwordx4 v1, s[52:55], s61 offen offset:3072 lds
    s_add_u32 s61, s60, 4096
    s_mov_b32 m0, s61
    s_nop 0
    buffer_load_dwordx4 v1, s[52:55], s61 offen offset:0 lds
    buffer_load_dwordx4 v1, s[52:55], s61 offen offset:1024 lds
    buffer_load_dwordx4 v1, s[52:55], s61 offen offset:2048 lds
    buffer_load_dwordx4 v1, s[52:55], s61 offen offset:3072 lds
    s_add_u32 s61, s60, 8192
    s_mov_b32 m0, s61
    s_nop 0
    buffer_load_dwordx4 v1, s[52:55], s61 offen offset:0 lds
    buffer_load_dwordx4 v1, s[52:55], s61 offen offset:1024 lds
    buffer_load_dwordx4 v1, s[52:55], s61 offen offset:2048 lds
    buffer_load_dwordx4 v1, s[52:55], s61 offen offset:3072 lds
    v_mov_b32 v30, 2097152
    ds_or_b32 v29, v30
    s_add_u32 s61, s60, 12288
    s_mov_b32 m0, s61
    s_nop 0
    buffer_load_dwordx4 v1, s[52:55], s61 offen offset:0 lds
    buffer_load_dwordx4 v1, s[52:55], s61 offen offset:1024 lds
    buffer_load_dwordx4 v1, s[52:55], s61 offen offset:2048 lds
    buffer_load_dwordx4 v1, s[52:55], s61 offen offset:3072 lds
    s_add_u32 s61, s60, 16384
    s_mov_b32 m0, s61
    s_nop 0
    buffer_load_dwordx4 v1, s[52:55], s61 offen offset:0 lds
    buffer_load_dwordx4 v1, s[52:55], s61 offen offset:1024 lds
    buffer_load_dwordx4 v1, s[52:55], s61 offen offset:2048 lds
    buffer_load_dwordx4 v1, s[52:55], s61 offen offset:3072 lds
    s_add_u32 s61, s60, 20480
    s_mov_b32 m0, s61
    s_nop 0
    buffer_load_dwordx4 v1, s[52:55], s61 offen offset:0 lds
    buffer_load_dwordx4 v1, s[52:55], s61 offen offset:1024 lds
    buffer_load_dwordx4 v1, s[52:55], s61 offen offset:2048 lds
    buffer_load_dwordx4 v1, s[52:55], s61 offen offset:3072 lds
    s_add_u32 s61, s60, 24576
    s_mov_b32 m0, s61
    s_nop 0
    buffer_load_dwordx4 v1, s[52:55], s61 offen offset:0 lds
    buffer_load_dwordx4 v1, s[52:55], s61 offen offset:1024 lds
    buffer_load_dwordx4 v1, s[52:55], s61 offen offset:2048 lds
    buffer_load_dwordx4 v1, s[52:55], s61 offen offset:3072 lds
    s_add_u32 s61, s60, 28672
    s_mov_b32 m0, s61
    s_nop 0
    buffer_load_dwordx4 v1, s[52:55], s61 offen offset:0 lds
    buffer_load_dwordx4 v1, s[52:55], s61 offen offset:1024 lds
    buffer_load_dwordx4 v1, s[52:55], s61 offen offset:2048 lds
    buffer_load_dwordx4 v1, s[52:55], s61 offen offset:3072 lds
    s_add_u32 s61, s60, 32768
    s_mov_b32 m0, s61
    s_nop 0
    buffer_load_dwordx4 v1, s[52:55], s61 offen offset:0 lds
    buffer_load_dwordx4 v1, s[52:55], s61 offen offset:1024 lds
    buffer_load_dwordx4 v1, s[52:55], s61 offen offset:2048 lds
    buffer_load_dwordx4 v1, s[52:55], s61 offen offset:3072 lds
    v_mov_b32 v26, 2
    v_mov_b32 v27, 4
    s_waitcnt vmcnt(24)
    v_mov_b32 v30, 1
    ds_or_b32 v29, v30
L_enter:
    v_mov_b32 v16, v4
    v_mov_b32 v17, v5
    v_mov_b32 v18, v6
    s_mul_i32 s60, s49, 18432
    s_add_u32 s60, s60, 73728
    v_add_u32 v24, s60, v1
    s_lshl_b32 s61, 64, s49
    v_mov_b32 v25, s61
    s_waitcnt lgkmcnt(0)
    s_sub_u32 s16, s3, 6291456
    s_mov_b32 s19, 100663296
    s_mov_b32 s18, 0
    s_mov_b32 s33, 100663296
    s_mov_b32 s35, 100663296
    s_mov_b32 s37, 100663296
    s_mov_b32 s39, 100663296
    ds_read_b32 v30, v29
    s_waitcnt lgkmcnt(0)
    v_readfirstlane_b32 s41, v30
    s_nop 1
    s_bitcmp1_b32 s41, 0
    s_cbranch_scc0 L_slow0
L_ok0:
    ds_read_b128 a[192:195], v1 offset:0
    ds_read_b128 a[196:199], v1 offset:1024
    ds_read_b128 a[200:203], v1 offset:2048
    ds_read_b128 a[204:207], v1 offset:3072
    ds_read_b128 a[208:211], v1 offset:4096
    ds_read_b128 a[212:215], v1 offset:5120
    ds_read_b128 a[216:219], v1 offset:6144
    ds_read_b128 a[220:223], v1 offset:7168
    s_waitcnt lgkmcnt(7)
    v_mfma_f32_16x16x32_bf16 v[96:99], a[192:195], a[0:3], 0
    s_add_u32 s16, s16, 6291456
    s_add_u32 s24, s16, 3145728
    s_waitcnt lgkmcnt(6)
    v_mfma_f32_16x16x32_bf16 v[96:99], a[196:199], a[4:7], v[96:99]
    s_add_u32 s26, s16, 3538944
    s_add_u32 s28, s16, 3932160
    s_waitcnt lgkmcnt(5)
    v_mfma_f32_16x16x32_bf16 v[96:99], a[200:203], a[8:11], v[96:99]
    s_waitcnt lgkmcnt(4)
    ds_read_b128 a[224:227], v1 offset:8192
    s_add_u32 s30, s16, 4325376
    v_mfma_f32_16x16x32_bf16 v[96:99], a[204:207], a[12:15], v[96:99]
    s_add_u32 s32, s16, 0
    s_add_u32 s34, s16, 393216
    s_waitcnt lgkmcnt(4)
    v_mfma_f32_16x16x32_bf16 v[96:99], a[208:211], a[16:19], v[96:99]
    s_waitcnt lgkmcnt(1)
    ds_read_b128 a[228:231], v1 offset:9216
    s_add_u32 s36, s16, 786432
    v_mfma_f32_16x16x32_bf16 v[96:99], a[212:215], a[20:23], v[96:99]
    s_add_u32 s38, s16, 1179648
    s_add_u32 s33, s16, 3145728
    s_add_u32 s35, s16, 3538944
    v_mfma_f32_16x16x32_bf16 v[100:103], a[192:195], a[24:27], 0
    s_add_u32 s37, s16, 3932160
    ds_read_b128 a[232:235], v1 offset:10240
    s_add_u32 s39, s16, 4325376
    v_mfma_f32_16x16x32_bf16 v[100:103], a[196:199], a[28:31], v[100:103]
    v_mfma_f32_16x16x32_bf16 v[100:103], a[200:203], a[32:35], v[100:103]
    ds_read_b128 a[236:239], v1 offset:11264
    v_cvt_pk_bf16_f32 v192, v96, v97
    v_mfma_f32_16x16x32_bf16 v[100:103], a[204:207], a[36:39], v[100:103]
    v_cvt_pk_bf16_f32 v193, v98, v99
    v_mfma_f32_16x16x32_bf16 v[100:103], a[208:211], a[40:43], v[100:103]
    s_cmp_eq_u32 s49, 0
    s_cbranch_scc0 L_pub0
    s_waitcnt vmcnt(12)
    ds_or_b32 v29, v26
L_pub0:
    v_mfma_f32_16x16x32_bf16 v[100:103], a[212:215], a[44:47], v[100:103]
    ds_read_b32 v30, v29
    v_mfma_f32_16x16x32_bf16 v[104:107], a[192:195], a[48:51], 0
    v_mfma_f32_16x16x32_bf16 v[104:107], a[196:199], a[52:55], v[104:107]
    v_mfma_f32_16x16x32_bf16 v[104:107], a[200:203], a[56:59], v[104:107]
    v_cvt_pk_bf16_f32 v196, v100, v101
    v_cvt_pk_bf16_f32 v197, v102, v103
    v_mfma_f32_16x16x32_bf16 v[104:107], a[204:207], a[60:63], v[104:107]
    v_mfma_f32_16x16x32_bf16 v[104:107], a[208:211], a[64:67], v[104:107]
    v_mfma_f32_16x16x32_bf16 v[104:107], a[212:215], a[68:71], v[104:107]
    v_mfma_f32_16x16x32_bf16 v[108:111], a[192:195], a[72:75], 0
    v_mfma_f32_16x16x32_bf16 v[108:111], a[196:199], a[76:79], v[108:111]
    v_mfma_f32_16x16x32_bf16 v[108:111], a[200:203], a[80:83], v[108:111]
    s_waitcnt lgkmcnt(0)
    v_readfirstlane_b32 s41, v30
    v_cvt_pk_bf16_f32 v200, v104, v105
    v_mfma_f32_16x16x32_bf16 v[108:111], a[204:207], a[84:87], v[108:111]
    s_bitcmp1_b32 s41, 1
    s_cbranch_scc0 L_slow1
L_ok1:
    v_cvt_pk_bf16_f32 v201, v106, v107
    v_mfma_f32_16x16x32_bf16 v[108:111], a[208:211], a[88:91], v[108:111]
    s_add_u32 s61, s60, 0
    ds_read_b128 a[240:243], v1 offset:12288
    v_mfma_f32_16x16x32_bf16 v[108:111], a[212:215], a[92:95], v[108:111]
    v_mfma_f32_16x16x32_bf16 v[112:115], a[216:219], a[0:3], 0
    buffer_load_dwordx4 v[128:131], v1, s[52:55], s61 offen offset:0
    v_mfma_f32_16x16x32_bf16 v[112:115], a[220:223], a[4:7], v[112:115]
    ds_read_b128 a[244:247], v1 offset:13312
    v_mfma_f32_16x16x32_bf16 v[112:115], a[224:227], a[8:11], v[112:115]
    ds_read_b128 a[248:251], v1 offset:14336
    v_cvt_pk_bf16_f32 v204, v108, v109
    v_mfma_f32_16x16x32_bf16 v[112:115], a[228:231], a[12:15], v[112:115]
    v_cvt_pk_bf16_f32 v205, v110, v111
    v_mfma_f32_16x16x32_bf16 v[112:115], a[232:235], a[16:19], v[112:115]
    ds_read_b128 a[192:195], v1 offset:15360
    v_mfma_f32_16x16x32_bf16 v[112:115], a[236:239], a[20:23], v[112:115]
    v_mfma_f32_16x16x32_bf16 v[116:119], a[216:219], a[24:27], 0
    s_cmp_eq_u32 s49, 1
    s_cbranch_scc0 L_pub2
    s_waitcnt vmcnt(25)
    ds_or_b32 v29, v26
L_pub2:
    v_mfma_f32_16x16x32_bf16 v[116:119], a[220:223], a[28:31], v[116:119]
    buffer_load_dwordx4 v[132:135], v1, s[52:55], s61 offen offset:1024
    v_mfma_f32_16x16x32_bf16 v[116:119], a[224:227], a[32:35], v[116:119]
    ds_read_b128 a[196:199], v1 offset:16384
    v_cvt_pk_bf16_f32 v194, v112, v113
    v_mfma_f32_16x16x32_bf16 v[116:119], a[228:231], a[36:39], v[116:119]
    ds_read_b128 a[200:203], v1 offset:17408
    v_cvt_pk_bf16_f32 v195, v114, v115
    v_mfma_f32_16x16x32_bf16 v[116:119], a[232:235], a[40:43], v[116:119]
    v_mfma_f32_16x16x32_bf16 v[116:119], a[236:239], a[44:47], v[116:119]
    v_mfma_f32_16x16x32_bf16 v[120:123], a[216:219], a[48:51], 0
    buffer_load_dwordx4 v[136:139], v1, s[52:55], s61 offen offset:2048
    v_mfma_f32_16x16x32_bf16 v[120:123], a[220:223], a[52:55], v[120:123]
    v_mfma_f32_16x16x32_bf16 v[120:123], a[224:227], a[56:59], v[120:123]
    v_cvt_pk_bf16_f32 v198, v116, v117
    v_cvt_pk_bf16_f32 v199, v118, v119
    v_mfma_f32_16x16x32_bf16 v[120:123], a[228:231], a[60:63], v[120:123]
    v_mfma_f32_16x16x32_bf16 v[120:123], a[232:235], a[64:67], v[120:123]
    v_mfma_f32_16x16x32_bf16 v[120:123], a[236:239], a[68:71], v[120:123]
    v_mfma_f32_16x16x32_bf16 v[124:127], a[216:219], a[72:75], 0
    buffer_load_dwordx4 v[140:143], v1, s[52:55], s61 offen offset:3072
    v_mfma_f32_16x16x32_bf16 v[124:127], a[220:223], a[76:79], v[124:127]
    v_mfma_f32_16x16x32_bf16 v[124:127], a[224:227], a[80:83], v[124:127]
    v_cvt_pk_bf16_f32 v202, v120, v121
    v_cvt_pk_bf16_f32 v203, v122, v123
    v_mfma_f32_16x16x32_bf16 v[124:127], a[228:231], a[84:87], v[124:127]
    v_mfma_f32_16x16x32_bf16 v[124:127], a[232:235], a[88:91], v[124:127]
    s_add_u32 s61, s60, 4096
    ds_read_b128 a[204:207], v1 offset:18432
    v_mfma_f32_16x16x32_bf16 v[124:127], a[236:239], a[92:95], v[124:127]
    s_waitcnt lgkmcnt(1)
    v_mfma_f32_16x16x32_bf16 v[96:99], a[240:243], a[0:3], 0
    buffer_load_dwordx4 v[144:147], v1, s[52:55], s61 offen offset:0
    v_mfma_f32_16x16x32_bf16 v[96:99], a[244:247], a[4:7], v[96:99]
    ds_read_b128 a[208:211], v1 offset:19456
    v_mfma_f32_16x16x32_bf16 v[96:99], a[248:251], a[8:11], v[96:99]
    ds_read_b128 a[212:215], v1 offset:20480
    v_cvt_pk_bf16_f32 v206, v124, v125
    v_mfma_f32_16x16x32_bf16 v[96:99], a[192:195], a[12:15], v[96:99]
    v_cvt_pk_bf16_f32 v207, v126, v127
    v_mfma_f32_16x16x32_bf16 v[96:99], a[196:199], a[16:19], v[96:99]
    ds_read_b128 a[216:219], v1 offset:21504
    v_mfma_f32_16x16x32_bf16 v[96:99], a[200:203], a[20:23], v[96:99]
    v_mfma_f32_16x16x32_bf16 v[100:103], a[240:243], a[24:27], 0
    buffer_load_dwordx4 v[148:151], v1, s[52:55], s61 offen offset:1024
    v_mfma_f32_16x16x32_bf16 v[100:103], a[244:247], a[28:31], v[100:103]
    ds_read_b128 a[220:223], v1 offset:22528
    v_mfma_f32_16x16x32_bf16 v[100:103], a[248:251], a[32:35], v[100:103]
    ds_read_b128 a[224:227], v1 offset:23552
    v_cvt_pk_bf16_f32 v208, v96, v97
    v_mfma_f32_16x16x32_bf16 v[100:103], a[192:195], a[36:39], v[100:103]
    v_cvt_pk_bf16_f32 v209, v98, v99
    v_mfma_f32_16x16x32_bf16 v[100:103], a[196:199], a[40:43], v[100:103]
    v_mfma_f32_16x16x32_bf16 v[100:103], a[200:203], a[44:47], v[100:103]
    v_mfma_f32_16x16x32_bf16 v[104:107], a[240:243], a[48:51], 0
    s_cmp_eq_u32 s49, 0
    s_cbranch_scc0 L_pub1
    s_waitcnt vmcnt(6)
    ds_or_b32 v29, v27
L_pub1:
    v_mfma_f32_16x16x32_bf16 v[104:107], a[244:247], a[52:55], v[104:107]
    ds_read_b32 v30, v29
    v_mfma_f32_16x16x32_bf16 v[104:107], a[248:251], a[56:59], v[104:107]
    buffer_load_dwordx4 v[152:155], v1, s[52:55], s61 offen offset:2048
    v_cvt_pk_bf16_f32 v212, v100, v101
    v_mfma_f32_16x16x32_bf16 v[104:107], a[192:195], a[60:63], v[104:107]
    v_cvt_pk_bf16_f32 v213, v102, v103
    v_mfma_f32_16x16x32_bf16 v[104:107], a[196:199], a[64:67], v[104:107]
    v_mfma_f32_16x16x32_bf16 v[104:107], a[200:203], a[68:71], v[104:107]
    v_mfma_f32_16x16x32_bf16 v[108:111], a[240:243], a[72:75], 0
    buffer_load_dwordx4 v[156:159], v1, s[52:55], s61 offen offset:3072
    v_mfma_f32_16x16x32_bf16 v[108:111], a[244:247], a[76:79], v[108:111]
    v_mfma_f32_16x16x32_bf16 v[108:111], a[248:251], a[80:83], v[108:111]
    v_cvt_pk_bf16_f32 v216, v104, v105
    v_cvt_pk_bf16_f32 v217, v106, v107
    v_mfma_f32_16x16x32_bf16 v[108:111], a[192:195], a[84:87], v[108:111]
    v_mfma_f32_16x16x32_bf16 v[108:111], a[196:199], a[88:91], v[108:111]
    s_add_u32 s61, s60, 8192
    s_waitcnt lgkmcnt(0)
    v_readfirstlane_b32 s41, v30
    v_mfma_f32_16x16x32_bf16 v[108:111], a[200:203], a[92:95], v[108:111]
    v_mfma_f32_16x16x32_bf16 v[112:115], a[204:207], a[0:3], 0
    s_bitcmp1_b32 s41, 2
    s_cbranch_scc0 L_slow2
L_ok2:
    v_mfma_f32_16x16x32_bf16 v[112:115], a[208:211], a[4:7], v[112:115]
    ds_read_b128 a[228:231], v1 offset:24576
    v_mfma_f32_16x16x32_bf16 v[112:115], a[212:215], a[8:11], v[112:115]
    buffer_load_dwordx4 v[160:163], v1, s[52:55], s61 offen offset:0
    v_cvt_pk_bf16_f32 v220, v108, v109
    v_mfma_f32_16x16x32_bf16 v[112:115], a[216:219], a[12:15], v[112:115]
    ds_read_b128 a[232:235], v1 offset:25600
    v_cvt_pk_bf16_f32 v221, v110, v111
    v_mfma_f32_16x16x32_bf16 v[112:115], a[220:223], a[16:19], v[112:115]
    ds_read_b128 a[236:239], v1 offset:26624
    v_mfma_f32_16x16x32_bf16 v[112:115], a[224:227], a[20:23], v[112:115]
    ds_read_b128 a[240:243], v1 offset:27648
    v_mfma_f32_16x16x32_bf16 v[116:119], a[204:207], a[24:27], 0
    buffer_load_dwordx4 v[164:167], v1, s[52:55], s61 offen offset:1024
    v_mfma_f32_16x16x32_bf16 v[116:119], a[208:211], a[28:31], v[116:119]
    ds_read_b128 a[244:247], v1 offset:28672
    v_mfma_f32_16x16x32_bf16 v[116:119], a[212:215], a[32:35], v[116:119]
    s_cmp_eq_u32 s49, 1
    s_cbranch_scc0 L_pub3
    s_waitcnt vmcnt(22)
    ds_or_b32 v29, v27
L_pub3:
    v_cvt_pk_bf16_f32 v210, v112, v113
    v_mfma_f32_16x16x32_bf16 v[116:119], a[216:219], a[36:39], v[116:119]
    ds_read_b128 a[248:251], v1 offset:29696
    v_cvt_pk_bf16_f32 v211, v114, v115
    v_mfma_f32_16x16x32_bf16 v[116:119], a[220:223], a[40:43], v[116:119]
    v_mfma_f32_16x16x32_bf16 v[116:119], a[224:227], a[44:47], v[116:119]
    v_mfma_f32_16x16x32_bf16 v[120:123], a[204:207], a[48:51], 0
    buffer_load_dwordx4 v[168:171], v1, s[52:55], s61 offen offset:2048
    v_mfma_f32_16x16x32_bf16 v[120:123], a[208:211], a[52:55], v[120:123]
    v_mfma_f32_16x16x32_bf16 v[120:123], a[212:215], a[56:59], v[120:123]
    v_cvt_pk_bf16_f32 v214, v116, v117
    v_cvt_pk_bf16_f32 v215, v118, v119
    v_mfma_f32_16x16x32_bf16 v[120:123], a[216:219], a[60:63], v[120:123]
    v_mfma_f32_16x16x32_bf16 v[120:123], a[220:223], a[64:67], v[120:123]
    v_mfma_f32_16x16x32_bf16 v[120:123], a[224:227], a[68:71], v[120:123]
    v_mfma_f32_16x16x32_bf16 v[124:127], a[204:207], a[72:75], 0
    buffer_load_dwordx4 v[172:175], v1, s[52:55], s61 offen offset:3072
    v_mfma_f32_16x16x32_bf16 v[124:127], a[208:211], a[76:79], v[124:127]
    v_mfma_f32_16x16x32_bf16 v[124:127], a[212:215], a[80:83], v[124:127]
    v_cvt_pk_bf16_f32 v218, v120, v121
    v_cvt_pk_bf16_f32 v219, v122, v123
    v_mfma_f32_16x16x32_bf16 v[124:127], a[216:219], a[84:87], v[124:127]
    v_mfma_f32_16x16x32_bf16 v[124:127], a[220:223], a[88:91], v[124:127]
    s_add_u32 s61, s60, 12288
    v_mfma_f32_16x16x32_bf16 v[124:127], a[224:227], a[92:95], v[124:127]
    s_waitcnt lgkmcnt(0)
    v_mfma_f32_16x16x32_bf16 v[96:99], a[228:231], a[0:3], 0
    buffer_load_dwordx4 v[176:179], v1, s[52:55], s61 offen offset:0
    v_mfma_f32_16x16x32_bf16 v[96:99], a[232:235], a[4:7], v[96:99]
    v_mfma_f32_16x16x32_bf16 v[96:99], a[236:239], a[8:11], v[96:99]
    v_cvt_pk_bf16_f32 v222, v124, v125
    v_cvt_pk_bf16_f32 v223, v126, v127
    v_mfma_f32_16x16x32_bf16 v[96:99], a[240:243], a[12:15], v[96:99]
    v_mfma_f32_16x16x32_bf16 v[96:99], a[244:247], a[16:19], v[96:99]
    v_mfma_f32_16x16x32_bf16 v[96:99], a[248:251], a[20:23], v[96:99]
    v_mfma_f32_16x16x32_bf16 v[100:103], a[228:231], a[24:27], 0
    buffer_load_dwordx4 v[180:183], v1, s[52:55], s61 offen offset:1024
    v_mfma_f32_16x16x32_bf16 v[100:103], a[232:235], a[28:31], v[100:103]
    v_mfma_f32_16x16x32_bf16 v[100:103], a[236:239], a[32:35], v[100:103]
    s_waitcnt vmcnt(13)
    ds_write_b64 v24, v[128:129] offset:0
    v_mfma_f32_16x16x32_bf16 v[100:103], a[240:243], a[36:39], v[100:103]
    ds_write_b64 v24, v[130:131] offset:8
    v_mfma_f32_16x16x32_bf16 v[100:103], a[244:247], a[40:43], v[100:103]
    v_mfma_f32_16x16x32_bf16 v[100:103], a[248:251], a[44:47], v[100:103]
    v_mfma_f32_16x16x32_bf16 v[32:35], a[0:3], v[192:195], 0
    buffer_load_dwordx4 v[184:187], v1, s[52:55], s61 offen offset:2048
    v_mfma_f32_16x16x32_bf16 v[32:35], a[4:7], v[208:211], v[32:35]
    v_mfma_f32_16x16x32_bf16 v[36:39], a[24:27], v[192:195], 0
    v_mfma_f32_16x16x32_bf16 v[36:39], a[28:31], v[208:211], v[36:39]
    s_waitcnt vmcnt(13)
    ds_write_b64 v24, v[132:133] offset:1024
    v_mfma_f32_16x16x32_bf16 v[40:43], a[48:51], v[192:195], 0
    ds_write_b64 v24, v[134:135] offset:1032
    v_mfma_f32_16x16x32_bf16 v[40:43], a[52:55], v[208:211], v[40:43]
    v_mfma_f32_16x16x32_bf16 v[44:47], a[72:75], v[192:195], 0
    buffer_load_dwordx4 v[188:191], v1, s[52:55], s61 offen offset:3072
    v_cvt_pk_bf16_f32 v192, v96, v97
    v_mfma_f32_16x16x32_bf16 v[44:47], a[76:79], v[208:211], v[44:47]
    v_cvt_pk_bf16_f32 v193, v98, v99
    v_mfma_f32_16x16x32_bf16 v[48:51], a[0:3], v[196:199], 0
    s_waitcnt vmcnt(13)
    ds_write_b64 v24, v[136:137] offset:2048
    v_mfma_f32_16x16x32_bf16 v[48:51], a[4:7], v[212:215], v[48:51]
    ds_write_b64 v24, v[138:139] offset:2056
    v_mfma_f32_16x16x32_bf16 v[52:55], a[24:27], v[196:199], 0
    s_add_u32 s61, s60, 16384
    v_mfma_f32_16x16x32_bf16 v[52:55], a[28:31], v[212:215], v[52:55]
    v_mfma_f32_16x16x32_bf16 v[56:59], a[48:51], v[196:199], 0
    buffer_load_dwordx4 v[224:227], v1, s[52:55], s61 offen offset:0
    v_mfma_f32_16x16x32_bf16 v[56:59], a[52:55], v[212:215], v[56:59]
    v_mfma_f32_16x16x32_bf16 v[60:63], a[72:75], v[196:199], 0
    s_waitcnt vmcnt(13)
    ds_write_b64 v24, v[140:141] offset:3072
    v_mfma_f32_16x16x32_bf16 v[60:63], a[76:79], v[212:215], v[60:63]
    ds_write_b64 v24, v[142:143] offset:3080
    v_mfma_f32_16x16x32_bf16 v[64:67], a[0:3], v[200:203], 0
    v_cvt_pk_bf16_f32 v196, v100, v101
    v_cvt_pk_bf16_f32 v197, v102, v103
    v_mfma_f32_16x16x32_bf16 v[64:67], a[4:7], v[216:219], v[64:67]
    v_mfma_f32_16x16x32_bf16 v[68:71], a[24:27], v[200:203], 0
    buffer_load_dwordx4 v[228:231], v1, s[52:55], s61 offen offset:1024
    v_mfma_f32_16x16x32_bf16 v[68:71], a[28:31], v[216:219], v[68:71]
    ds_read_b128 a[192:195], v1 offset:30720
    v_mfma_f32_16x16x32_bf16 v[72:75], a[48:51], v[200:203], 0
    ds_read_b128 a[196:199], v1 offset:31744
    v_mfma_f32_16x16x32_bf16 v[72:75], a[52:55], v[216:219], v[72:75]
    s_waitcnt vmcnt(13)
    ds_write_b64 v24, v[144:145] offset:4096
    v_mfma_f32_16x16x32_bf16 v[76:79], a[72:75], v[200:203], 0
    s_cmp_eq_u32 s49, 1
    s_cbranch_scc0 L_pub4
    s_waitcnt vmcnt(18)
    ds_or_b32 v29, v28
L_pub4:
    v_mfma_f32_16x16x32_bf16 v[76:79], a[76:79], v[216:219], v[76:79]
    ds_read_b128 a[200:203], v1 offset:32768
    v_mfma_f32_16x16x32_bf16 v[80:83], a[0:3], v[204:207], 0
    ds_read_b128 a[204:207], v1 offset:33792
    v_mfma_f32_16x16x32_bf16 v[80:83], a[4:7], v[220:223], v[80:83]
    ds_write_b64 v24, v[146:147] offset:4104
    v_mfma_f32_16x16x32_bf16 v[84:87], a[24:27], v[204:207], 0
    ds_read_b128 a[208:211], v1 offset:34816
    v_mfma_f32_16x16x32_bf16 v[84:87], a[28:31], v[220:223], v[84:87]
    s_waitcnt vmcnt(12)
    ds_write_b64 v24, v[148:149] offset:5120
    v_mfma_f32_16x16x32_bf16 v[88:91], a[48:51], v[204:207], 0
    ds_read_b32 v30, v29
    v_mfma_f32_16x16x32_bf16 v[88:91], a[52:55], v[220:223], v[88:91]
    ds_read_b128 a[212:215], v1 offset:35840
    v_mfma_f32_16x16x32_bf16 v[92:95], a[72:75], v[204:207], 0
    ds_write_b64 v24, v[150:151] offset:5128
    v_mfma_f32_16x16x32_bf16 v[92:95], a[76:79], v[220:223], v[92:95]
    v_mfma_f32_16x16x32_bf16 v[104:107], a[228:231], a[48:51], 0
    s_waitcnt vmcnt(11)
    ds_write_b64 v24, v[152:153] offset:6144
    v_mfma_f32_16x16x32_bf16 v[104:107], a[232:235], a[52:55], v[104:107]
    ds_write_b64 v24, v[154:155] offset:6152
    v_mfma_f32_16x16x32_bf16 v[104:107], a[236:239], a[56:59], v[104:107]
    v_mfma_f32_16x16x32_bf16 v[104:107], a[240:243], a[60:63], v[104:107]
    v_mfma_f32_16x16x32_bf16 v[104:107], a[244:247], a[64:67], v[104:107]
    s_waitcnt lgkmcnt(4)
    v_readfirstlane_b32 s41, v30
    v_mfma_f32_16x16x32_bf16 v[104:107], a[248:251], a[68:71], v[104:107]
    v_mfma_f32_16x16x32_bf16 v[108:111], a[228:231], a[72:75], 0
    s_bitcmp1_b32 s41, 3
    s_cbranch_scc0 L_slow3
L_ok3:
    v_mfma_f32_16x16x32_bf16 v[108:111], a[232:235], a[76:79], v[108:111]
    s_waitcnt vmcnt(10)
    ds_write_b64 v24, v[156:157] offset:7168
    v_mfma_f32_16x16x32_bf16 v[108:111], a[236:239], a[80:83], v[108:111]
    ds_write_b64 v24, v[158:159] offset:7176
    v_mfma_f32_16x16x32_bf16 v[108:111], a[240:243], a[84:87], v[108:111]
    v_cvt_pk_bf16_f32 v200, v104, v105
    v_cvt_pk_bf16_f32 v201, v106, v107
    v_mfma_f32_16x16x32_bf16 v[108:111], a[244:247], a[88:91], v[108:111]
    buffer_load_dwordx4 a[96:99], v9, s[8:11], s24 offen offset:0 nt
    v_mfma_f32_16x16x32_bf16 v[108:111], a[248:251], a[92:95], v[108:111]
    buffer_load_dwordx4 a[100:103], v10, s[8:11], s24 offen offset:0 nt
    v_mfma_f32_16x16x32_bf16 v[112:115], a[192:195], a[0:3], 0
    ds_read_b128 a[216:219], v1 offset:36864
    v_mfma_f32_16x16x32_bf16 v[112:115], a[196:199], a[4:7], v[112:115]
    ds_read_b128 a[220:223], v1 offset:37888
    v_mfma_f32_16x16x32_bf16 v[112:115], a[200:203], a[8:11], v[112:115]
    ds_read_b128 a[224:227], v1 offset:38912
    v_cvt_pk_bf16_f32 v204, v108, v109
    v_mfma_f32_16x16x32_bf16 v[112:115], a[204:207], a[12:15], v[112:115]
    s_waitcnt vmcnt(11)
    ds_write_b64 v24, v[160:161] offset:8192
    v_mfma_f32_16x16x32_bf16 v[112:115], a[208:211], a[16:19], v[112:115]
    s_waitcnt lgkmcnt(6)
    ds_read_b128 a[228:231], v1 offset:39936
    v_cvt_pk_bf16_f32 v205, v110, v111
    v_mfma_f32_16x16x32_bf16 v[112:115], a[212:215], a[20:23], v[112:115]
    ds_write_b64 v24, v[162:163] offset:8200
    v_mfma_f32_16x16x32_bf16 v[116:119], a[192:195], a[24:27], 0
    ds_read_b128 a[232:235], v1 offset:40960
    v_mfma_f32_16x16x32_bf16 v[116:119], a[196:199], a[28:31], v[116:119]
    s_waitcnt vmcnt(10)
    ds_write_b64 v24, v[164:165] offset:9216
    v_mfma_f32_16x16x32_bf16 v[116:119], a[200:203], a[32:35], v[116:119]
    ds_read_b128 a[236:239], v1 offset:41984
    v_cvt_pk_bf16_f32 v194, v112, v113
    v_mfma_f32_16x16x32_bf16 v[116:119], a[204:207], a[36:39], v[116:119]
    ds_write_b64 v24, v[166:167] offset:9224
    v_mfma_f32_16x16x32_bf16 v[116:119], a[208:211], a[40:43], v[116:119]
    v_cvt_pk_bf16_f32 v195, v114, v115
    v_mfma_f32_16x16x32_bf16 v[116:119], a[212:215], a[44:47], v[116:119]
    v_mfma_f32_16x16x32_bf16 v[120:123], a[192:195], a[48:51], 0
    s_waitcnt vmcnt(9)
    ds_write_b64 v24, v[168:169] offset:10240
    v_mfma_f32_16x16x32_bf16 v[120:123], a[196:199], a[52:55], v[120:123]
    ds_write_b64 v24, v[170:171] offset:10248
    v_mfma_f32_16x16x32_bf16 v[120:123], a[200:203], a[56:59], v[120:123]
    v_cvt_pk_bf16_f32 v198, v116, v117
    v_cvt_pk_bf16_f32 v199, v118, v119
    v_mfma_f32_16x16x32_bf16 v[120:123], a[204:207], a[60:63], v[120:123]
    v_mfma_f32_16x16x32_bf16 v[120:123], a[208:211], a[64:67], v[120:123]
    v_mfma_f32_16x16x32_bf16 v[120:123], a[212:215], a[68:71], v[120:123]
    v_mfma_f32_16x16x32_bf16 v[124:127], a[192:195], a[72:75], 0
    s_waitcnt vmcnt(8)
    ds_write_b64 v24, v[172:173] offset:11264
    v_mfma_f32_16x16x32_bf16 v[124:127], a[196:199], a[76:79], v[124:127]
    ds_write_b64 v24, v[174:175] offset:11272
    v_mfma_f32_16x16x32_bf16 v[124:127], a[200:203], a[80:83], v[124:127]
    buffer_load_dwordx4 a[104:107], v9, s[8:11], s24 offen offset:128 nt
    v_cvt_pk_bf16_f32 v202, v120, v121
    v_mfma_f32_16x16x32_bf16 v[124:127], a[204:207], a[84:87], v[124:127]
    buffer_load_dwordx4 a[108:111], v10, s[8:11], s24 offen offset:128 nt
    v_cvt_pk_bf16_f32 v203, v122, v123
    v_mfma_f32_16x16x32_bf16 v[124:127], a[208:211], a[88:91], v[124:127]
    ds_read_b128 a[240:243], v1 offset:43008
    v_mfma_f32_16x16x32_bf16 v[124:127], a[212:215], a[92:95], v[124:127]
    s_waitcnt lgkmcnt(5)
    v_mfma_f32_16x16x32_bf16 v[96:99], a[216:219], a[0:3], 0
    ds_read_b128 a[244:247], v1 offset:44032
    v_mfma_f32_16x16x32_bf16 v[96:99], a[220:223], a[4:7], v[96:99]
    s_waitcnt vmcnt(9)
    ds_write_b64 v24, v[176:177] offset:12288
    v_mfma_f32_16x16x32_bf16 v[96:99], a[224:227], a[8:11], v[96:99]
    ds_read_b128 a[248:251], v1 offset:45056
    v_cvt_pk_bf16_f32 v206, v124, v125
    v_mfma_f32_16x16x32_bf16 v[96:99], a[228:231], a[12:15], v[96:99]
    ds_write_b64 v24, v[178:179] offset:12296
    v_mfma_f32_16x16x32_bf16 v[96:99], a[232:235], a[16:19], v[96:99]
    ds_read_b128 a[192:195], v1 offset:46080
    v_cvt_pk_bf16_f32 v207, v126, v127
    v_mfma_f32_16x16x32_bf16 v[96:99], a[236:239], a[20:23], v[96:99]
    v_mfma_f32_16x16x32_bf16 v[100:103], a[216:219], a[24:27], 0
    ds_read_b128 a[196:199], v1 offset:47104
    v_mfma_f32_16x16x32_bf16 v[100:103], a[220:223], a[28:31], v[100:103]
    s_waitcnt vmcnt(8)
    ds_write_b64 v24, v[180:181] offset:13312
    v_mfma_f32_16x16x32_bf16 v[100:103], a[224:227], a[32:35], v[100:103]
    ds_read_b32 v30, v29
    v_cvt_pk_bf16_f32 v208, v96, v97
    v_mfma_f32_16x16x32_bf16 v[100:103], a[228:231], a[36:39], v[100:103]
    ds_read_b128 a[200:203], v1 offset:48128
    v_cvt_pk_bf16_f32 v209, v98, v99
    v_mfma_f32_16x16x32_bf16 v[100:103], a[232:235], a[40:43], v[100:103]
    ds_write_b64 v24, v[182:183] offset:13320
    v_mfma_f32_16x16x32_bf16 v[100:103], a[236:239], a[44:47], v[100:103]
    v_mfma_f32_16x16x32_bf16 v[104:107], a[216:219], a[48:51], 0
    s_waitcnt vmcnt(7)
    ds_write_b64 v24, v[184:185] offset:14336
    v_mfma_f32_16x16x32_bf16 v[104:107], a[220:223], a[52:55], v[104:107]
    ds_write_b64 v24, v[186:187] offset:14344
    v_mfma_f32_16x16x32_bf16 v[104:107], a[224:227], a[56:59], v[104:107]
    v_cvt_pk_bf16_f32 v212, v100, v101
    v_cvt_pk_bf16_f32 v213, v102, v103
    v_mfma_f32_16x16x32_bf16 v[104:107], a[228:231], a[60:63], v[104:107]
    v_mfma_f32_16x16x32_bf16 v[104:107], a[232:235], a[64:67], v[104:107]
    s_waitcnt lgkmcnt(4)
    v_readfirstlane_b32 s41, v30
    v_mfma_f32_16x16x32_bf16 v[104:107], a[236:239], a[68:71], v[104:107]
    v_mfma_f32_16x16x32_bf16 v[108:111], a[216:219], a[72:75], 0
    s_bitcmp1_b32 s41, 4
    s_cbranch_scc0 L_slow4
L_ok4:
    v_mfma_f32_16x16x32_bf16 v[108:111], a[220:223], a[76:79], v[108:111]
    buffer_load_dwordx4 a[112:115], v9, s[8:11], s24 offen offset:256 nt
    v_mfma_f32_16x16x32_bf16 v[108:111], a[224:227], a[80:83], v[108:111]
    buffer_load_dwordx4 a[116:119], v10, s[8:11], s24 offen offset:256 nt
    v_cvt_pk_bf16_f32 v216, v104, v105
    v_mfma_f32_16x16x32_bf16 v[108:111], a[228:231], a[84:87], v[108:111]
    s_add_u32 s24, s16, 6291456
    v_cvt_pk_bf16_f32 v217, v106, v107
    v_mfma_f32_16x16x32_bf16 v[108:111], a[232:235], a[88:91], v[108:111]
    ds_read_b128 a[204:207], v1 offset:49152
    v_mfma_f32_16x16x32_bf16 v[108:111], a[236:239], a[92:95], v[108:111]
    s_waitcnt vmcnt(8)
    ds_write_b64 v24, v[188:189] offset:15360
    v_mfma_f32_16x16x32_bf16 v[112:115], a[240:243], a[0:3], 0
    ds_read_b128 a[208:211], v1 offset:50176
    v_mfma_f32_16x16x32_bf16 v[112:115], a[244:247], a[4:7], v[112:115]
    ds_write_b64 v24, v[190:191] offset:15368
    v_mfma_f32_16x16x32_bf16 v[112:115], a[248:251], a[8:11], v[112:115]
    ds_read_b128 a[212:215], v1 offset:51200
    v_cvt_pk_bf16_f32 v220, v108, v109
    v_mfma_f32_16x16x32_bf16 v[112:115], a[192:195], a[12:15], v[112:115]
    s_waitcnt vmcnt(7)
    ds_write_b64 v24, v[224:225] offset:16384
    v_mfma_f32_16x16x32_bf16 v[112:115], a[196:199], a[16:19], v[112:115]
    s_waitcnt lgkmcnt(6)
    ds_read_b128 a[216:219], v1 offset:52224
    v_cvt_pk_bf16_f32 v221, v110, v111
    v_mfma_f32_16x16x32_bf16 v[112:115], a[200:203], a[20:23], v[112:115]
    ds_write_b64 v24, v[226:227] offset:16392
    v_mfma_f32_16x16x32_bf16 v[116:119], a[240:243], a[24:27], 0
    ds_read_b128 a[220:223], v1 offset:53248
    v_mfma_f32_16x16x32_bf16 v[116:119], a[244:247], a[28:31], v[116:119]
    s_waitcnt vmcnt(6)
    ds_write_b64 v24, v[228:229] offset:17408
    v_mfma_f32_16x16x32_bf16 v[116:119], a[248:251], a[32:35], v[116:119]
    ds_read_b128 a[224:227], v1 offset:54272
    v_cvt_pk_bf16_f32 v210, v112, v113
    v_mfma_f32_16x16x32_bf16 v[116:119], a[192:195], a[36:39], v[116:119]
    ds_write_b64 v24, v[230:231] offset:17416
    v_mfma_f32_16x16x32_bf16 v[116:119], a[196:199], a[40:43], v[116:119]
    ds_or_b32 v29, v25
    v_mfma_f32_16x16x32_bf16 v[116:119], a[200:203], a[44:47], v[116:119]
    v_cvt_pk_bf16_f32 v211, v114, v115
    v_mfma_f32_16x16x32_bf16 v[120:123], a[240:243], a[48:51], 0
    v_mfma_f32_16x16x32_bf16 v[120:123], a[244:247], a[52:55], v[120:123]
    v_mfma_f32_16x16x32_bf16 v[120:123], a[248:251], a[56:59], v[120:123]
    v_cvt_pk_bf16_f32 v214, v116, v117
    v_cvt_pk_bf16_f32 v215, v118, v119
    v_mfma_f32_16x16x32_bf16 v[120:123], a[192:195], a[60:63], v[120:123]
    v_mfma_f32_16x16x32_bf16 v[120:123], a[196:199], a[64:67], v[120:123]
    buffer_load_dwordx4 a[120:123], v9, s[8:11], s26 offen offset:0 nt
    v_mfma_f32_16x16x32_bf16 v[120:123], a[200:203], a[68:71], v[120:123]
    buffer_load_dwordx4 a[124:127], v10, s[8:11], s26 offen offset:0 nt
    v_mfma_f32_16x16x32_bf16 v[124:127], a[240:243], a[72:75], 0
    v_mfma_f32_16x16x32_bf16 v[124:127], a[244:247], a[76:79], v[124:127]
    v_mfma_f32_16x16x32_bf16 v[124:127], a[248:251], a[80:83], v[124:127]
    v_cvt_pk_bf16_f32 v218, v120, v121
    v_cvt_pk_bf16_f32 v219, v122, v123
    v_mfma_f32_16x16x32_bf16 v[124:127], a[192:195], a[84:87], v[124:127]
    v_mfma_f32_16x16x32_bf16 v[124:127], a[196:199], a[88:91], v[124:127]
    v_mfma_f32_16x16x32_bf16 v[124:127], a[200:203], a[92:95], v[124:127]
    s_waitcnt lgkmcnt(0)
    v_mfma_f32_16x16x32_bf16 v[96:99], a[204:207], a[0:3], 0
    v_mfma_f32_16x16x32_bf16 v[96:99], a[208:211], a[4:7], v[96:99]
    v_mfma_f32_16x16x32_bf16 v[96:99], a[212:215], a[8:11], v[96:99]
    v_cvt_pk_bf16_f32 v222, v124, v125
    v_cvt_pk_bf16_f32 v223, v126, v127
    v_mfma_f32_16x16x32_bf16 v[96:99], a[216:219], a[12:15], v[96:99]
    v_mfma_f32_16x16x32_bf16 v[96:99], a[220:223], a[16:19], v[96:99]
    v_mfma_f32_16x16x32_bf16 v[96:99], a[224:227], a[20:23], v[96:99]
    v_mfma_f32_16x16x32_bf16 v[100:103], a[204:207], a[24:27], 0
    v_mfma_f32_16x16x32_bf16 v[100:103], a[208:211], a[28:31], v[100:103]
    v_mfma_f32_16x16x32_bf16 v[100:103], a[212:215], a[32:35], v[100:103]
    v_mfma_f32_16x16x32_bf16 v[100:103], a[216:219], a[36:39], v[100:103]
    v_mfma_f32_16x16x32_bf16 v[100:103], a[220:223], a[40:43], v[100:103]
    v_mfma_f32_16x16x32_bf16 v[100:103], a[224:227], a[44:47], v[100:103]
    v_mfma_f32_16x16x32_bf16 v[32:35], a[8:11], v[192:195], v[32:35]
    v_mfma_f32_16x16x32_bf16 v[32:35], a[12:15], v[208:211], v[32:35]
    v_mfma_f32_16x16x32_bf16 v[36:39], a[32:35], v[192:195], v[36:39]
    buffer_load_dwordx4 a[128:131], v9, s[8:11], s26 offen offset:128 nt
    v_mfma_f32_16x16x32_bf16 v[36:39], a[36:39], v[208:211], v[36:39]
    buffer_load_dwordx4 a[132:135], v10, s[8:11], s26 offen offset:128 nt
    v_mfma_f32_16x16x32_bf16 v[40:43], a[56:59], v[192:195], v[40:43]
    v_mfma_f32_16x16x32_bf16 v[40:43], a[60:63], v[208:211], v[40:43]
    v_mfma_f32_16x16x32_bf16 v[44:47], a[80:83], v[192:195], v[44:47]
    v_cvt_pk_bf16_f32 v192, v96, v97
    v_cvt_pk_bf16_f32 v193, v98, v99
    v_mfma_f32_16x16x32_bf16 v[44:47], a[84:87], v[208:211], v[44:47]
    v_mfma_f32_16x16x32_bf16 v[48:51], a[8:11], v[196:199], v[48:51]
    v_mfma_f32_16x16x32_bf16 v[48:51], a[12:15], v[212:215], v[48:51]
    v_mfma_f32_16x16x32_bf16 v[52:55], a[32:35], v[196:199], v[52:55]
    v_mfma_f32_16x16x32_bf16 v[52:55], a[36:39], v[212:215], v[52:55]
    v_mfma_f32_16x16x32_bf16 v[56:59], a[56:59], v[196:199], v[56:59]
    v_mfma_f32_16x16x32_bf16 v[56:59], a[60:63], v[212:215], v[56:59]
    v_mfma_f32_16x16x32_bf16 v[60:63], a[80:83], v[196:199], v[60:63]
    v_cvt_pk_bf16_f32 v196, v100, v101
    v_cvt_pk_bf16_f32 v197, v102, v103
    v_mfma_f32_16x16x32_bf16 v[60:63], a[84:87], v[212:215], v[60:63]
    v_mfma_f32_16x16x32_bf16 v[64:67], a[8:11], v[200:203], v[64:67]
    v_mfma_f32_16x16x32_bf16 v[64:67], a[12:15], v[216:219], v[64:67]
    v_mfma_f32_16x16x32_bf16 v[68:71], a[32:35], v[200:203], v[68:71]
    ds_read_b128 a[228:231], v1 offset:55296
    v_mfma_f32_16x16x32_bf16 v[68:71], a[36:39], v[216:219], v[68:71]
    v_mfma_f32_16x16x32_bf16 v[72:75], a[56:59], v[200:203], v[72:75]
    ds_read_b128 a[232:235], v1 offset:56320
    v_mfma_f32_16x16x32_bf16 v[72:75], a[60:63], v[216:219], v[72:75]
    v_mfma_f32_16x16x32_bf16 v[76:79], a[80:83], v[200:203], v[76:79]
    ds_read_b128 a[236:239], v1 offset:57344
    v_mfma_f32_16x16x32_bf16 v[76:79], a[84:87], v[216:219], v[76:79]
    v_mfma_f32_16x16x32_bf16 v[80:83], a[8:11], v[204:207], v[80:83]
    buffer_load_dwordx4 a[136:139], v9, s[8:11], s26 offen offset:256 nt
    v_mfma_f32_16x16x32_bf16 v[80:83], a[12:15], v[220:223], v[80:83]
    buffer_load_dwordx4 a[140:143], v10, s[8:11], s26 offen offset:256 nt
    s_add_u32 s26, s16, 6684672
    v_mfma_f32_16x16x32_bf16 v[84:87], a[32:35], v[204:207], v[84:87]
    ds_read_b128 a[240:243], v1 offset:58368
    v_mfma_f32_16x16x32_bf16 v[84:87], a[36:39], v[220:223], v[84:87]
    ds_read_b128 a[244:247], v1 offset:59392
    v_mfma_f32_16x16x32_bf16 v[88:91], a[56:59], v[204:207], v[88:91]
    ds_read_b32 v30, v29
    v_mfma_f32_16x16x32_bf16 v[88:91], a[60:63], v[220:223], v[88:91]
    ds_read_b128 a[248:251], v1 offset:60416
    v_mfma_f32_16x16x32_bf16 v[92:95], a[80:83], v[204:207], v[92:95]
    v_mfma_f32_16x16x32_bf16 v[92:95], a[84:87], v[220:223], v[92:95]
    v_mfma_f32_16x16x32_bf16 v[104:107], a[204:207], a[48:51], 0
    v_mfma_f32_16x16x32_bf16 v[104:107], a[208:211], a[52:55], v[104:107]
    v_mfma_f32_16x16x32_bf16 v[104:107], a[212:215], a[56:59], v[104:107]
    v_mfma_f32_16x16x32_bf16 v[104:107], a[216:219], a[60:63], v[104:107]
    v_mfma_f32_16x16x32_bf16 v[104:107], a[220:223], a[64:67], v[104:107]
    v_mfma_f32_16x16x32_bf16 v[104:107], a[224:227], a[68:71], v[104:107]
    s_waitcnt lgkmcnt(1)
    v_readfirstlane_b32 s41, v30
    v_mfma_f32_16x16x32_bf16 v[108:111], a[204:207], a[72:75], 0
    v_mfma_f32_16x16x32_bf16 v[108:111], a[208:211], a[76:79], v[108:111]
    s_bitcmp1_b32 s41, 5
    s_cbranch_scc0 L_slow5
L_ok5:
    v_mfma_f32_16x16x32_bf16 v[108:111], a[212:215], a[80:83], v[108:111]
    v_cvt_pk_bf16_f32 v200, v104, v105
    v_cvt_pk_bf16_f32 v201, v106, v107
    v_mfma_f32_16x16x32_bf16 v[108:111], a[216:219], a[84:87], v[108:111]
    v_mfma_f32_16x16x32_bf16 v[108:111], a[220:223], a[88:91], v[108:111]
    ds_read_b128 a[192:195], v1 offset:61440
    v_mfma_f32_16x16x32_bf16 v[108:111], a[224:227], a[92:95], v[108:111]
    v_mfma_f32_16x16x32_bf16 v[112:115], a[228:231], a[0:3], 0
    ds_read_b128 a[196:199], v1 offset:62464
    v_mfma_f32_16x16x32_bf16 v[112:115], a[232:235], a[4:7], v[112:115]
    v_mfma_f32_16x16x32_bf16 v[112:115], a[236:239], a[8:11], v[112:115]
    buffer_load_dwordx4 a[144:147], v9, s[8:11], s28 offen offset:0 nt
    v_cvt_pk_bf16_f32 v204, v108, v109
    v_mfma_f32_16x16x32_bf16 v[112:115], a[240:243], a[12:15], v[112:115]
    buffer_load_dwordx4 a[148:151], v10, s[8:11], s28 offen offset:0 nt
    v_cvt_pk_bf16_f32 v205, v110, v111
    v_mfma_f32_16x16x32_bf16 v[112:115], a[244:247], a[16:19], v[112:115]
    s_waitcnt lgkmcnt(2)
    ds_read_b128 a[200:203], v1 offset:63488
    v_mfma_f32_16x16x32_bf16 v[112:115], a[248:251], a[20:23], v[112:115]
    ds_read_b128 a[204:207], v1 offset:64512
    v_mfma_f32_16x16x32_bf16 v[116:119], a[228:231], a[24:27], 0
    ds_read_b128 a[208:211], v2 offset:0
    v_mfma_f32_16x16x32_bf16 v[116:119], a[232:235], a[28:31], v[116:119]
    v_mfma_f32_16x16x32_bf16 v[116:119], a[236:239], a[32:35], v[116:119]
    ds_read_b128 a[212:215], v2 offset:1024
    v_cvt_pk_bf16_f32 v194, v112, v113
    v_mfma_f32_16x16x32_bf16 v[116:119], a[240:243], a[36:39], v[116:119]
    v_cvt_pk_bf16_f32 v195, v114, v115
    v_mfma_f32_16x16x32_bf16 v[116:119], a[244:247], a[40:43], v[116:119]
    v_mfma_f32_16x16x32_bf16 v[116:119], a[248:251], a[44:47], v[116:119]
    v_mfma_f32_16x16x32_bf16 v[120:123], a[228:231], a[48:51], 0
    v_mfma_f32_16x16x32_bf16 v[120:123], a[232:235], a[52:55], v[120:123]
    v_mfma_f32_16x16x32_bf16 v[120:123], a[236:239], a[56:59], v[120:123]
    v_cvt_pk_bf16_f32 v198, v116, v117
    v_cvt_pk_bf16_f32 v199, v118, v119
    v_mfma_f32_16x16x32_bf16 v[120:123], a[240:243], a[60:63], v[120:123]
    v_mfma_f32_16x16x32_bf16 v[120:123], a[244:247], a[64:67], v[120:123]
    v_mfma_f32_16x16x32_bf16 v[120:123], a[248:251], a[68:71], v[120:123]
    v_mfma_f32_16x16x32_bf16 v[124:127], a[228:231], a[72:75], 0
    v_mfma_f32_16x16x32_bf16 v[124:127], a[232:235], a[76:79], v[124:127]
    v_mfma_f32_16x16x32_bf16 v[124:127], a[236:239], a[80:83], v[124:127]
    v_cvt_pk_bf16_f32 v202, v120, v121
    v_cvt_pk_bf16_f32 v203, v122, v123
    v_mfma_f32_16x16x32_bf16 v[124:127], a[240:243], a[84:87], v[124:127]
    v_mfma_f32_16x16x32_bf16 v[124:127], a[244:247], a[88:91], v[124:127]
    ds_read_b128 a[216:219], v2 offset:2048
    v_mfma_f32_16x16x32_bf16 v[124:127], a[248:251], a[92:95], v[124:127]
    s_waitcnt lgkmcnt(1)
    v_mfma_f32_16x16x32_bf16 v[96:99], a[192:195], a[0:3], 0
    buffer_load_dwordx4 a[168:171], v9, s[8:11], s30 offen offset:0 nt
    v_mfma_f32_16x16x32_bf16 v[96:99], a[196:199], a[4:7], v[96:99]
    buffer_load_dwordx4 a[172:175], v10, s[8:11], s30 offen offset:0 nt
    v_mfma_f32_16x16x32_bf16 v[96:99], a[200:203], a[8:11], v[96:99]
    ds_read_b128 a[220:223], v2 offset:3072
    v_cvt_pk_bf16_f32 v206, v124, v125
    v_mfma_f32_16x16x32_bf16 v[96:99], a[204:207], a[12:15], v[96:99]
    ds_read_b128 a[224:227], v2 offset:4096
    v_cvt_pk_bf16_f32 v207, v126, v127
    v_mfma_f32_16x16x32_bf16 v[96:99], a[208:211], a[16:19], v[96:99]
    ds_read_b128 a[228:231], v2 offset:5120
    v_mfma_f32_16x16x32_bf16 v[96:99], a[212:215], a[20:23], v[96:99]
    v_mfma_f32_16x16x32_bf16 v[100:103], a[192:195], a[24:27], 0
    ds_read_b128 a[232:235], v2 offset:6144
    v_mfma_f32_16x16x32_bf16 v[100:103], a[196:199], a[28:31], v[100:103]
    s_waitcnt vmcnt(15)
    ds_write_b32 v4, a96 offset:0
    v_mfma_f32_16x16x32_bf16 v[100:103], a[200:203], a[32:35], v[100:103]
    ds_read_b32 v30, v29
    v_cvt_pk_bf16_f32 v208, v96, v97
    v_mfma_f32_16x16x32_bf16 v[100:103], a[204:207], a[36:39], v[100:103]
    ds_read_b128 a[236:239], v2 offset:7168
    v_cvt_pk_bf16_f32 v209, v98, v99
    v_mfma_f32_16x16x32_bf16 v[100:103], a[208:211], a[40:43], v[100:103]
    ds_write_b32 v4, a97 offset:4
    v_mfma_f32_16x16x32_bf16 v[100:103], a[212:215], a[44:47], v[100:103]
    ds_write_b32 v4, a98 offset:1024
    v_mfma_f32_16x16x32_bf16 v[104:107], a[192:195], a[48:51], 0
    ds_write_b32 v4, a99 offset:1028
    v_mfma_f32_16x16x32_bf16 v[104:107], a[196:199], a[52:55], v[104:107]
    s_waitcnt vmcnt(14)
    ds_write_b32 v4, a100 offset:512
    v_mfma_f32_16x16x32_bf16 v[104:107], a[200:203], a[56:59], v[104:107]
    ds_write_b32 v4, a101 offset:516
    v_mfma_f32_16x16x32_bf16 v[104:107], a[204:207], a[60:63], v[104:107]
    ds_write_b32 v4, a102 offset:1536
    v_mfma_f32_16x16x32_bf16 v[104:107], a[208:211], a[64:67], v[104:107]
    ds_write_b32 v4, a103 offset:1540
    v_mfma_f32_16x16x32_bf16 v[104:107], a[212:215], a[68:71], v[104:107]
    s_waitcnt lgkmcnt(8)
    ds_read2_b64 a[96:99], v5 offset0:0 offset1:128
    v_readfirstlane_b32 s41, v30
    v_mfma_f32_16x16x32_bf16 v[108:111], a[192:195], a[72:75], 0
    ds_read2_b64 a[100:103], v6 offset0:0 offset1:128
    v_cvt_pk_bf16_f32 v212, v100, v101
    v_mfma_f32_16x16x32_bf16 v[108:111], a[196:199], a[76:79], v[108:111]
    s_andn2_b32 s41, 960, s41
    s_cbranch_scc1 L_slow6
L_ok6:
    v_cvt_pk_bf16_f32 v213, v102, v103
    v_mfma_f32_16x16x32_bf16 v[108:111], a[200:203], a[80:83], v[108:111]
    v_cvt_pk_bf16_f32 v216, v104, v105
    v_cvt_pk_bf16_f32 v217, v106, v107
    v_mfma_f32_16x16x32_bf16 v[108:111], a[204:207], a[84:87], v[108:111]
    v_mfma_f32_16x16x32_bf16 v[108:111], a[208:211], a[88:91], v[108:111]
    ds_read_b128 a[240:243], v2 offset:8192
    v_mfma_f32_16x16x32_bf16 v[108:111], a[212:215], a[92:95], v[108:111]
    v_mfma_f32_16x16x32_bf16 v[112:115], a[216:219], a[0:3], 0
    ds_read_b128 a[244:247], v2 offset:9216
    v_mfma_f32_16x16x32_bf16 v[112:115], a[220:223], a[4:7], v[112:115]
    v_mfma_f32_16x16x32_bf16 v[112:115], a[224:227], a[8:11], v[112:115]
    ds_read_b128 a[248:251], v2 offset:10240
    v_cvt_pk_bf16_f32 v220, v108, v109
    v_mfma_f32_16x16x32_bf16 v[112:115], a[228:231], a[12:15], v[112:115]
    v_cvt_pk_bf16_f32 v221, v110, v111
    v_mfma_f32_16x16x32_bf16 v[112:115], a[232:235], a[16:19], v[112:115]
    s_waitcnt lgkmcnt(7)
    ds_read_b128 a[192:195], v2 offset:11264
    v_mfma_f32_16x16x32_bf16 v[112:115], a[236:239], a[20:23], v[112:115]
    v_mfma_f32_16x16x32_bf16 v[116:119], a[216:219], a[24:27], 0
    ds_read_b128 a[196:199], v2 offset:12288
    v_mfma_f32_16x16x32_bf16 v[116:119], a[220:223], a[28:31], v[116:119]
    s_waitcnt vmcnt(13)
    ds_write_b32 v4, a104 offset:0
    v_mfma_f32_16x16x32_bf16 v[116:119], a[224:227], a[32:35], v[116:119]
    ds_read_b128 a[200:203], v2 offset:13312
    v_cvt_pk_bf16_f32 v210, v112, v113
    v_mfma_f32_16x16x32_bf16 v[116:119], a[228:231], a[36:39], v[116:119]
    ds_write_b32 v4, a105 offset:4
    v_mfma_f32_16x16x32_bf16 v[116:119], a[232:235], a[40:43], v[116:119]
    ds_write_b32 v4, a106 offset:1024
    v_mfma_f32_16x16x32_bf16 v[116:119], a[236:239], a[44:47], v[116:119]
    ds_write_b32 v4, a107 offset:1028
    v_mfma_f32_16x16x32_bf16 v[120:123], a[216:219], a[48:51], 0
    s_waitcnt vmcnt(12)
    ds_write_b32 v4, a108 offset:512
    v_mfma_f32_16x16x32_bf16 v[120:123], a[220:223], a[52:55], v[120:123]
    ds_write_b32 v4, a109 offset:516
    v_mfma_f32_16x16x32_bf16 v[120:123], a[224:227], a[56:59], v[120:123]
    ds_write_b32 v4, a110 offset:1536
    v_mfma_f32_16x16x32_bf16 v[120:123], a[228:231], a[60:63], v[120:123]
    ds_write_b32 v4, a111 offset:1540
    v_mfma_f32_16x16x32_bf16 v[120:123], a[232:235], a[64:67], v[120:123]
    ds_read2_b64 a[104:107], v5 offset0:0 offset1:128
    v_cvt_pk_bf16_f32 v211, v114, v115
    v_mfma_f32_16x16x32_bf16 v[120:123], a[236:239], a[68:71], v[120:123]
    ds_read2_b64 a[108:111], v6 offset0:0 offset1:128
    v_cvt_pk_bf16_f32 v214, v116, v117
    v_mfma_f32_16x16x32_bf16 v[124:127], a[216:219], a[72:75], 0
    v_cvt_pk_bf16_f32 v215, v118, v119
    v_mfma_f32_16x16x32_bf16 v[124:127], a[220:223], a[76:79], v[124:127]
    v_mfma_f32_16x16x32_bf16 v[124:127], a[224:227], a[80:83], v[124:127]
    v_cvt_pk_bf16_f32 v218, v120, v121
    v_cvt_pk_bf16_f32 v219, v122, v123
    v_mfma_f32_16x16x32_bf16 v[124:127], a[228:231], a[84:87], v[124:127]
    v_mfma_f32_16x16x32_bf16 v[124:127], a[232:235], a[88:91], v[124:127]
    v_mfma_f32_16x16x32_bf16 v[124:127], a[236:239], a[92:95], v[124:127]
    s_waitcnt lgkmcnt(8)
    v_mfma_f32_16x16x32_bf16 v[96:99], a[0:3], a[240:243], 0
    v_mfma_f32_16x16x32_bf16 v[96:99], a[4:7], a[244:247], v[96:99]
    v_mfma_f32_16x16x32_bf16 v[96:99], a[8:11], a[248:251], v[96:99]
    v_cvt_pk_bf16_f32 v222, v124, v125
    v_cvt_pk_bf16_f32 v223, v126, v127
    v_mfma_f32_16x16x32_bf16 v[96:99], a[12:15], a[192:195], v[96:99]
    v_mfma_f32_16x16x32_bf16 v[96:99], a[16:19], a[196:199], v[96:99]
    v_mfma_f32_16x16x32_bf16 v[96:99], a[20:23], a[200:203], v[96:99]
    v_mfma_f32_16x16x32_bf16 v[100:103], a[24:27], a[240:243], 0
    v_mfma_f32_16x16x32_bf16 v[100:103], a[28:31], a[244:247], v[100:103]
    v_mfma_f32_16x16x32_bf16 v[100:103], a[32:35], a[248:251], v[100:103]
    s_waitcnt vmcnt(11)
    ds_write_b32 v4, a112 offset:0
    v_mfma_f32_16x16x32_bf16 v[100:103], a[36:39], a[192:195], v[100:103]
    ds_write_b32 v4, a113 offset:4
    v_mfma_f32_16x16x32_bf16 v[100:103], a[40:43], a[196:199], v[100:103]
    ds_write_b32 v4, a114 offset:1024
    v_mfma_f32_16x16x32_bf16 v[100:103], a[44:47], a[200:203], v[100:103]
    ds_write_b32 v4, a115 offset:1028
    v_mfma_f32_16x16x32_bf16 v[32:35], a[16:19], v[192:195], v[32:35]
    s_waitcnt vmcnt(10)
    ds_write_b32 v4, a116 offset:512
    v_mfma_f32_16x16x32_bf16 v[32:35], a[20:23], v[208:211], v[32:35]
    ds_write_b32 v4, a117 offset:516
    v_mfma_f32_16x16x32_bf16 v[36:39], a[40:43], v[192:195], v[36:39]
    v_cvt_pk_bf16_f32 v128, v96, v97
    v_cvt_pk_bf16_f32 v129, v98, v99
    v_mfma_f32_16x16x32_bf16 v[36:39], a[44:47], v[208:211], v[36:39]
L_loop:
    v_mfma_f32_16x16x32_bf16 v[40:43], a[64:67], v[192:195], v[40:43]
    ds_write_b32 v4, a118 offset:1536
    v_mfma_f32_16x16x32_bf16 v[40:43], a[68:71], v[208:211], v[40:43]
    ds_write_b32 v4, a119 offset:1540
    v_mfma_f32_16x16x32_bf16 v[44:47], a[88:91], v[192:195], v[44:47]
    ds_read2_b64 a[112:115], v5 offset0:0 offset1:128
    v_cvt_pk_bf16_f32 v130, v100, v101
    v_mfma_f32_16x16x32_bf16 v[44:47], a[92:95], v[208:211], v[44:47]
    ds_read2_b64 a[116:119], v6 offset0:0 offset1:128
    v_cvt_pk_bf16_f32 v131, v102, v103
    v_mfma_f32_16x16x32_bf16 v[48:51], a[16:19], v[196:199], v[48:51]
    v_max3_f32 v12, v32, v33, v34
    v_max3_f32 v12, v12, v35, v36
    v_mfma_f32_16x16x32_bf16 v[48:51], a[20:23], v[212:215], v[48:51]
    v_max3_f32 v12, v12, v37, v38
    v_max3_f32 v12, v12, v39, v40
    v_mfma_f32_16x16x32_bf16 v[52:55], a[40:43], v[196:199], v[52:55]
    v_max3_f32 v12, v12, v41, v42
    v_max3_f32 v12, v12, v43, v44
    v_mfma_f32_16x16x32_bf16 v[52:55], a[44:47], v[212:215], v[52:55]
    v_max3_f32 v12, v12, v45, v46
    v_max_f32 v12, v12, v47
    v_mfma_f32_16x16x32_bf16 v[56:59], a[64:67], v[196:199], v[56:59]
    v_max3_f32 v13, v48, v49, v50
    v_mfma_f32_16x16x32_bf16 v[56:59], a[68:71], v[212:215], v[56:59]
    v_mfma_f32_16x16x32_bf16 v[60:63], a[88:91], v[196:199], v[60:63]
    v_max3_f32 v13, v13, v51, v52
    v_max3_f32 v13, v13, v53, v54
    v_mfma_f32_16x16x32_bf16 v[60:63], a[92:95], v[212:215], v[60:63]
    v_mfma_f32_16x16x32_bf16 v[64:67], a[16:19], v[200:203], v[64:67]
    v_max3_f32 v13, v13, v55, v56
    v_max3_f32 v13, v13, v57, v58
    v_mfma_f32_16x16x32_bf16 v[64:67], a[20:23], v[216:219], v[64:67]
    v_mfma_f32_16x16x32_bf16 v[68:71], a[40:43], v[200:203], v[68:71]
    ds_read_b128 a[204:207], v2 offset:14336
    v_max3_f32 v13, v13, v59, v60
    v_mfma_f32_16x16x32_bf16 v[68:71], a[44:47], v[216:219], v[68:71]
    v_max3_f32 v13, v13, v61, v62
    v_max_f32 v13, v13, v63
    v_mfma_f32_16x16x32_bf16 v[72:75], a[64:67], v[200:203], v[72:75]
    ds_read_b128 a[208:211], v2 offset:15360
    v_max3_f32 v14, v64, v65, v66
    v_mfma_f32_16x16x32_bf16 v[72:75], a[68:71], v[216:219], v[72:75]
    v_permlane16_swap_b32 v12, v13
    v_mfma_f32_16x16x32_bf16 v[76:79], a[88:91], v[200:203], v[76:79]
    ds_read_b128 a[212:215], v2 offset:16384
    v_max3_f32 v14, v14, v67, v68
    v_mfma_f32_16x16x32_bf16 v[76:79], a[92:95], v[216:219], v[76:79]
    v_max3_f32 v14, v14, v69, v70
    v_max_f32 v12, v12, v13
    v_mfma_f32_16x16x32_bf16 v[80:83], a[16:19], v[204:207], v[80:83]
    ds_read_b128 a[216:219], v2 offset:17408
    v_max3_f32 v14, v14, v71, v72
    v_mfma_f32_16x16x32_bf16 v[80:83], a[20:23], v[220:223], v[80:83]
    v_max3_f32 v14, v14, v73, v74
    v_mfma_f32_16x16x32_bf16 v[84:87], a[40:43], v[204:207], v[84:87]
    ds_read_b128 a[220:223], v2 offset:18432
    v_max3_f32 v14, v14, v75, v76
    v_mfma_f32_16x16x32_bf16 v[84:87], a[44:47], v[220:223], v[84:87]
    v_max3_f32 v14, v14, v77, v78
    v_max_f32 v14, v14, v79
    v_mfma_f32_16x16x32_bf16 v[88:91], a[64:67], v[204:207], v[88:91]
    ds_read_b128 a[224:227], v2 offset:19456
    v_max3_f32 v15, v80, v81, v82
    v_mfma_f32_16x16x32_bf16 v[88:91], a[68:71], v[220:223], v[88:91]
    v_mfma_f32_16x16x32_bf16 v[92:95], a[88:91], v[204:207], v[92:95]
    v_max3_f32 v15, v15, v83, v84
    v_max3_f32 v15, v15, v85, v86
    v_mfma_f32_16x16x32_bf16 v[92:95], a[92:95], v[220:223], v[92:95]
    v_mfma_f32_16x16x32_bf16 v[104:107], a[48:51], a[240:243], 0
    v_max3_f32 v15, v15, v87, v88
    v_max3_f32 v15, v15, v89, v90
    v_mfma_f32_16x16x32_bf16 v[104:107], a[52:55], a[244:247], v[104:107]
    v_mfma_f32_16x16x32_bf16 v[104:107], a[56:59], a[248:251], v[104:107]
    v_max3_f32 v15, v15, v91, v92
    v_max3_f32 v15, v15, v93, v94
    v_mfma_f32_16x16x32_bf16 v[104:107], a[60:63], a[192:195], v[104:107]
    v_max_f32 v15, v15, v95
    v_mfma_f32_16x16x32_bf16 v[104:107], a[64:67], a[196:199], v[104:107]
    v_mfma_f32_16x16x32_bf16 v[104:107], a[68:71], a[200:203], v[104:107]
    v_permlane16_swap_b32 v14, v15
    v_mfma_f32_16x16x32_bf16 v[108:111], a[72:75], a[240:243], 0
    v_max_f32 v14, v14, v15
    v_mfma_f32_16x16x32_bf16 v[108:111], a[76:79], a[244:247], v[108:111]
    v_mfma_f32_16x16x32_bf16 v[108:111], a[80:83], a[248:251], v[108:111]
    v_cvt_pk_bf16_f32 v132, v104, v105
    v_cvt_pk_bf16_f32 v133, v106, v107
    v_mfma_f32_16x16x32_bf16 v[108:111], a[84:87], a[192:195], v[108:111]
    v_permlane32_swap_b32 v12, v14
    v_mfma_f32_16x16x32_bf16 v[108:111], a[88:91], a[196:199], v[108:111]
    ds_read_b128 a[228:231], v2 offset:20480
    v_max_f32 v12, v12, v14
    v_mfma_f32_16x16x32_bf16 v[108:111], a[92:95], a[200:203], v[108:111]
    s_waitcnt lgkmcnt(1)
    v_mov_b32 v14, v12
    v_mfma_f32_16x16x32_bf16 v[112:115], a[0:3], a[204:207], 0
    ds_read_b128 a[232:235], v2 offset:21504
    v_mfma_f32_16x16x32_bf16 v[112:115], a[4:7], a[208:211], v[112:115]
    v_permlane32_swap_b32 v12, v14
    v_mfma_f32_16x16x32_bf16 v[112:115], a[8:11], a[212:215], v[112:115]
    ds_read_b128 a[236:239], v2 offset:22528
    v_cvt_pk_bf16_f32 v134, v108, v109
    v_mfma_f32_16x16x32_bf16 v[112:115], a[12:15], a[216:219], v[112:115]
    v_cvt_pk_bf16_f32 v135, v110, v111
    v_mov_b32 v13, v12
    v_mfma_f32_16x16x32_bf16 v[112:115], a[16:19], a[220:223], v[112:115]
    ds_read_b128 a[240:243], v2 offset:23552
    v_mov_b32 v15, v14
    v_mfma_f32_16x16x32_bf16 v[112:115], a[20:23], a[224:227], v[112:115]
    v_permlane16_swap_b32 v12, v13
    v_mfma_f32_16x16x32_bf16 v[116:119], a[24:27], a[204:207], 0
    ds_read_b128 a[244:247], v2 offset:24576
    v_sub_f32 v32, v32, v12
    v_mfma_f32_16x16x32_bf16 v[116:119], a[28:31], a[208:211], v[116:119]
    v_permlane16_swap_b32 v14, v15
    v_mfma_f32_16x16x32_bf16 v[116:119], a[32:35], a[212:215], v[116:119]
    ds_read_b128 a[248:251], v2 offset:25600
    v_cvt_pk_bf16_f32 v136, v112, v113
    v_mfma_f32_16x16x32_bf16 v[116:119], a[36:39], a[216:219], v[116:119]
    v_cvt_pk_bf16_f32 v137, v114, v115
    v_sub_f32 v33, v33, v12
    v_mfma_f32_16x16x32_bf16 v[116:119], a[40:43], a[220:223], v[116:119]
    v_sub_f32 v48, v48, v13
    v_sub_f32 v49, v49, v13
    v_mfma_f32_16x16x32_bf16 v[116:119], a[44:47], a[224:227], v[116:119]
    v_sub_f32 v64, v64, v14
    v_sub_f32 v65, v65, v14
    v_mfma_f32_16x16x32_bf16 v[120:123], a[48:51], a[204:207], 0
    v_sub_f32 v80, v80, v15
    v_sub_f32 v81, v81, v15
    v_mfma_f32_16x16x32_bf16 v[120:123], a[52:55], a[208:211], v[120:123]
    v_exp_f32 v32, v32
    v_mfma_f32_16x16x32_bf16 v[120:123], a[56:59], a[212:215], v[120:123]
    buffer_load_dwordx4 a[152:155], v9, s[8:11], s28 offen offset:128 nt
    v_cvt_pk_bf16_f32 v138, v116, v117
    v_mfma_f32_16x16x32_bf16 v[120:123], a[60:63], a[216:219], v[120:123]
    buffer_load_dwordx4 a[156:159], v10, s[8:11], s28 offen offset:128 nt
    v_cvt_pk_bf16_f32 v139, v118, v119
    v_mfma_f32_16x16x32_bf16 v[120:123], a[64:67], a[220:223], v[120:123]
    v_exp_f32 v33, v33
    v_mfma_f32_16x16x32_bf16 v[120:123], a[68:71], a[224:227], v[120:123]
    v_sub_f32 v34, v34, v12
    v_sub_f32 v50, v50, v13
    v_mfma_f32_16x16x32_bf16 v[124:127], a[72:75], a[204:207], 0
    v_exp_f32 v48, v48
    v_mfma_f32_16x16x32_bf16 v[124:127], a[76:79], a[208:211], v[124:127]
    v_exp_f32 v49, v49
    v_mfma_f32_16x16x32_bf16 v[124:127], a[80:83], a[212:215], v[124:127]
    v_cvt_pk_bf16_f32 v140, v120, v121
    v_cvt_pk_bf16_f32 v141, v122, v123
    v_mfma_f32_16x16x32_bf16 v[124:127], a[84:87], a[216:219], v[124:127]
    v_exp_f32 v64, v64
    v_mfma_f32_16x16x32_bf16 v[124:127], a[88:91], a[220:223], v[124:127]
    ds_read_b128 a[192:195], v2 offset:26624
    v_sub_f32 v66, v66, v14
    v_mfma_f32_16x16x32_bf16 v[124:127], a[92:95], a[224:227], v[124:127]
    s_waitcnt lgkmcnt(1)
    v_exp_f32 v65, v65
    v_mfma_f32_16x16x32_bf16 v[96:99], a[0:3], a[228:231], 0
    ds_read_b128 a[196:199], v2 offset:27648
    v_sub_f32 v82, v82, v15
    v_mfma_f32_16x16x32_bf16 v[96:99], a[4:7], a[232:235], v[96:99]
    v_exp_f32 v80, v80
    v_mfma_f32_16x16x32_bf16 v[96:99], a[8:11], a[236:239], v[96:99]
    ds_read_b128 a[200:203], v2 offset:28672
    v_cvt_pk_bf16_f32 v142, v124, v125
    v_mfma_f32_16x16x32_bf16 v[96:99], a[12:15], a[240:243], v[96:99]
    v_cvt_pk_bf16_f32 v143, v126, v127
    v_sub_f32 v35, v35, v12
    v_mfma_f32_16x16x32_bf16 v[96:99], a[16:19], a[244:247], v[96:99]
    ds_read_b128 a[204:207], v2 offset:29696
    v_sub_f32 v51, v51, v13
    v_mfma_f32_16x16x32_bf16 v[96:99], a[20:23], a[248:251], v[96:99]
    v_exp_f32 v81, v81
    v_mfma_f32_16x16x32_bf16 v[100:103], a[24:27], a[228:231], 0
    ds_read_b128 a[208:211], v2 offset:30720
    v_sub_f32 v67, v67, v14
    v_mfma_f32_16x16x32_bf16 v[100:103], a[28:31], a[232:235], v[100:103]
    v_exp_f32 v34, v34
    v_mfma_f32_16x16x32_bf16 v[100:103], a[32:35], a[236:239], v[100:103]
    ds_read_b128 a[212:215], v2 offset:31744
    v_cvt_pk_bf16_f32 v144, v96, v97
    v_mfma_f32_16x16x32_bf16 v[100:103], a[36:39], a[240:243], v[100:103]
    v_cvt_pk_bf16_f32 v145, v98, v99
    v_sub_f32 v83, v83, v15
    v_mfma_f32_16x16x32_bf16 v[100:103], a[40:43], a[244:247], v[100:103]
    v_exp_f32 v50, v50
    v_mfma_f32_16x16x32_bf16 v[100:103], a[44:47], a[248:251], v[100:103]
    v_exp_f32 v66, v66
    v_mfma_f32_16x16x32_bf16 v[104:107], a[48:51], a[228:231], 0
    v_exp_f32 v82, v82
    v_mfma_f32_16x16x32_bf16 v[104:107], a[52:55], a[232:235], v[104:107]
    v_exp_f32 v35, v35
    v_mfma_f32_16x16x32_bf16 v[104:107], a[56:59], a[236:239], v[104:107]
    v_cvt_pk_bf16_f32 v146, v100, v101
    v_cvt_pk_bf16_f32 v147, v102, v103
    v_mfma_f32_16x16x32_bf16 v[104:107], a[60:63], a[240:243], v[104:107]
    v_sub_f32 v36, v36, v12
    v_sub_f32 v52, v52, v13
    v_mfma_f32_16x16x32_bf16 v[104:107], a[64:67], a[244:247], v[104:107]
    v_exp_f32 v51, v51
    v_mfma_f32_16x16x32_bf16 v[104:107], a[68:71], a[248:251], v[104:107]
    v_exp_f32 v67, v67
    v_mfma_f32_16x16x32_bf16 v[108:111], a[72:75], a[228:231], 0
    v_sub_f32 v68, v68, v14
    v_sub_f32 v84, v84, v15
    v_mfma_f32_16x16x32_bf16 v[108:111], a[76:79], a[232:235], v[108:111]
    v_exp_f32 v83, v83
    v_mfma_f32_16x16x32_bf16 v[108:111], a[80:83], a[236:239], v[108:111]
    v_cvt_pk_bf16_f32 v148, v104, v105
    v_cvt_pk_bf16_f32 v149, v106, v107
    v_mfma_f32_16x16x32_bf16 v[108:111], a[84:87], a[240:243], v[108:111]
    v_add_f32 v20, v32, v33
    v_sub_f32 v37, v37, v12
    v_mfma_f32_16x16x32_bf16 v[108:111], a[88:91], a[244:247], v[108:111]
    ds_read_b128 a[216:219], v2 offset:32768
    v_add_f32 v21, v48, v49
    v_mfma_f32_16x16x32_bf16 v[108:111], a[92:95], a[248:251], v[108:111]
    s_waitcnt lgkmcnt(1)
    v_exp_f32 v36, v36
    v_mfma_f32_16x16x32_bf16 v[112:115], a[0:3], a[192:195], 0
    ds_read_b128 a[220:223], v2 offset:33792
    v_sub_f32 v53, v53, v13
    v_mfma_f32_16x16x32_bf16 v[112:115], a[4:7], a[196:199], v[112:115]
    v_exp_f32 v52, v52
    v_mfma_f32_16x16x32_bf16 v[112:115], a[8:11], a[200:203], v[112:115]
    ds_read_b128 a[224:227], v2 offset:34816
    v_cvt_pk_bf16_f32 v150, v108, v109
    v_mfma_f32_16x16x32_bf16 v[112:115], a[12:15], a[204:207], v[112:115]
    v_cvt_pk_bf16_f32 v151, v110, v111
    v_add_f32 v22, v64, v65
    v_mfma_f32_16x16x32_bf16 v[112:115], a[16:19], a[208:211], v[112:115]
    ds_read_b128 a[228:231], v2 offset:35840
    v_sub_f32 v69, v69, v14
    v_mfma_f32_16x16x32_bf16 v[112:115], a[20:23], a[212:215], v[112:115]
    v_exp_f32 v68, v68
    v_mfma_f32_16x16x32_bf16 v[116:119], a[24:27], a[192:195], 0
    ds_read_b128 a[232:235], v2 offset:36864
    v_add_f32 v23, v80, v81
    v_mfma_f32_16x16x32_bf16 v[116:119], a[28:31], a[196:199], v[116:119]
    v_exp_f32 v84, v84
    v_mfma_f32_16x16x32_bf16 v[116:119], a[32:35], a[200:203], v[116:119]
    ds_read_b128 a[236:239], v2 offset:37888
    v_cvt_pk_bf16_f32 v152, v112, v113
    v_mfma_f32_16x16x32_bf16 v[116:119], a[36:39], a[204:207], v[116:119]
    v_cvt_pk_bf16_f32 v153, v114, v115
    v_sub_f32 v85, v85, v15
    v_mfma_f32_16x16x32_bf16 v[116:119], a[40:43], a[208:211], v[116:119]
    v_add_f32 v20, v20, v34
    v_sub_f32 v38, v38, v12
    v_mfma_f32_16x16x32_bf16 v[116:119], a[44:47], a[212:215], v[116:119]
    v_exp_f32 v37, v37
    v_mfma_f32_16x16x32_bf16 v[120:123], a[48:51], a[192:195], 0
    v_add_f32 v21, v21, v50
    v_sub_f32 v54, v54, v13
    v_mfma_f32_16x16x32_bf16 v[120:123], a[52:55], a[196:199], v[120:123]
    v_exp_f32 v53, v53
    v_mfma_f32_16x16x32_bf16 v[120:123], a[56:59], a[200:203], v[120:123]
    v_cvt_pk_bf16_f32 v154, v116, v117
    v_cvt_pk_bf16_f32 v155, v118, v119
    v_mfma_f32_16x16x32_bf16 v[120:123], a[60:63], a[204:207], v[120:123]
    v_add_f32 v22, v22, v66
    v_sub_f32 v70, v70, v14
    v_mfma_f32_16x16x32_bf16 v[120:123], a[64:67], a[208:211], v[120:123]
    v_exp_f32 v69, v69
    v_mfma_f32_16x16x32_bf16 v[120:123], a[68:71], a[212:215], v[120:123]
    v_add_f32 v23, v23, v82
    v_sub_f32 v86, v86, v15
    v_mfma_f32_16x16x32_bf16 v[124:127], a[72:75], a[192:195], 0
    v_exp_f32 v85, v85
    v_mfma_f32_16x16x32_bf16 v[124:127], a[76:79], a[196:199], v[124:127]
    v_add_f32 v20, v20, v35
    v_sub_f32 v39, v39, v12
    v_mfma_f32_16x16x32_bf16 v[124:127], a[80:83], a[200:203], v[124:127]
    v_cvt_pk_bf16_f32 v156, v120, v121
    v_cvt_pk_bf16_f32 v157, v122, v123
    v_mfma_f32_16x16x32_bf16 v[124:127], a[84:87], a[204:207], v[124:127]
    v_exp_f32 v38, v38
    v_mfma_f32_16x16x32_bf16 v[124:127], a[88:91], a[208:211], v[124:127]
    buffer_load_dwordx4 a[176:179], v9, s[8:11], s30 offen offset:128 nt
    v_add_f32 v21, v21, v51
    v_mfma_f32_16x16x32_bf16 v[124:127], a[92:95], a[212:215], v[124:127]
    s_waitcnt lgkmcnt(0)
    buffer_load_dwordx4 a[180:183], v10, s[8:11], s30 offen offset:128 nt
    v_sub_f32 v55, v55, v13
    v_mfma_f32_16x16x32_bf16 v[96:99], a[0:3], a[216:219], 0
    ds_read_b128 a[240:243], v2 offset:38912
    v_add_f32 v22, v22, v67
    v_mfma_f32_16x16x32_bf16 v[96:99], a[4:7], a[220:223], v[96:99]
    ds_read_b128 a[244:247], v2 offset:39936
    v_sub_f32 v71, v71, v14
    v_mfma_f32_16x16x32_bf16 v[96:99], a[8:11], a[224:227], v[96:99]
    ds_read_b128 a[248:251], v2 offset:40960
    v_cvt_pk_bf16_f32 v158, v124, v125
    v_mfma_f32_16x16x32_bf16 v[96:99], a[12:15], a[228:231], v[96:99]
    v_cvt_pk_bf16_f32 v159, v126, v127
    v_add_f32 v23, v23, v83
    v_mfma_f32_16x16x32_bf16 v[96:99], a[16:19], a[232:235], v[96:99]
    ds_read_b128 a[192:195], v2 offset:41984
    v_sub_f32 v87, v87, v15
    v_mfma_f32_16x16x32_bf16 v[96:99], a[20:23], a[236:239], v[96:99]
    v_exp_f32 v54, v54
    v_mfma_f32_16x16x32_bf16 v[100:103], a[24:27], a[216:219], 0
    ds_read_b128 a[196:199], v2 offset:43008
    v_add_f32 v20, v20, v36
    v_mfma_f32_16x16x32_bf16 v[100:103], a[28:31], a[220:223], v[100:103]
    v_exp_f32 v70, v70
    v_mfma_f32_16x16x32_bf16 v[100:103], a[32:35], a[224:227], v[100:103]
    ds_read_b128 a[200:203], v2 offset:44032
    v_cvt_pk_bf16_f32 v160, v96, v97
    v_mfma_f32_16x16x32_bf16 v[100:103], a[36:39], a[228:231], v[100:103]
    v_cvt_pk_bf16_f32 v161, v98, v99
    v_sub_f32 v40, v40, v12
    v_mfma_f32_16x16x32_bf16 v[100:103], a[40:43], a[232:235], v[100:103]
    v_exp_f32 v86, v86
    v_mfma_f32_16x16x32_bf16 v[100:103], a[44:47], a[236:239], v[100:103]
    v_exp_f32 v39, v39
    v_mfma_f32_16x16x32_bf16 v[104:107], a[48:51], a[216:219], 0
    v_add_f32 v21, v21, v52
    v_sub_f32 v56, v56, v13
    v_mfma_f32_16x16x32_bf16 v[104:107], a[52:55], a[220:223], v[104:107]
    v_exp_f32 v55, v55
    v_mfma_f32_16x16x32_bf16 v[104:107], a[56:59], a[224:227], v[104:107]
    v_cvt_pk_bf16_f32 v162, v100, v101
    v_cvt_pk_bf16_f32 v163, v102, v103
    v_mfma_f32_16x16x32_bf16 v[104:107], a[60:63], a[228:231], v[104:107]
    v_add_f32 v22, v22, v68
    v_sub_f32 v72, v72, v14
    v_mfma_f32_16x16x32_bf16 v[104:107], a[64:67], a[232:235], v[104:107]
    v_exp_f32 v71, v71
    v_mfma_f32_16x16x32_bf16 v[104:107], a[68:71], a[236:239], v[104:107]
    v_add_f32 v23, v23, v84
    v_sub_f32 v88, v88, v15
    v_mfma_f32_16x16x32_bf16 v[108:111], a[72:75], a[216:219], 0
    v_exp_f32 v87, v87
    v_mfma_f32_16x16x32_bf16 v[108:111], a[76:79], a[220:223], v[108:111]
    v_add_f32 v20, v20, v37
    v_sub_f32 v41, v41, v12
    v_mfma_f32_16x16x32_bf16 v[108:111], a[80:83], a[224:227], v[108:111]
    v_cvt_pk_bf16_f32 v164, v104, v105
    v_cvt_pk_bf16_f32 v165, v106, v107
    v_mfma_f32_16x16x32_bf16 v[108:111], a[84:87], a[228:231], v[108:111]
    v_exp_f32 v40, v40
    v_mfma_f32_16x16x32_bf16 v[108:111], a[88:91], a[232:235], v[108:111]
    ds_read_b128 a[204:207], v2 offset:45056
    v_add_f32 v21, v21, v53
    v_mfma_f32_16x16x32_bf16 v[108:111], a[92:95], a[236:239], v[108:111]
    s_waitcnt lgkmcnt(1)
    v_exp_f32 v56, v56
    v_mfma_f32_16x16x32_bf16 v[112:115], a[0:3], a[240:243], 0
    ds_read_b128 a[208:211], v2 offset:46080
    v_sub_f32 v57, v57, v13
    v_mfma_f32_16x16x32_bf16 v[112:115], a[4:7], a[244:247], v[112:115]
    v_add_f32 v22, v22, v69
    v_sub_f32 v73, v73, v14
    v_mfma_f32_16x16x32_bf16 v[112:115], a[8:11], a[248:251], v[112:115]
    ds_read_b128 a[212:215], v2 offset:47104
    v_cvt_pk_bf16_f32 v166, v108, v109
    v_mfma_f32_16x16x32_bf16 v[112:115], a[12:15], a[192:195], v[112:115]
    v_cvt_pk_bf16_f32 v167, v110, v111
    v_add_f32 v23, v23, v85
    v_mfma_f32_16x16x32_bf16 v[112:115], a[16:19], a[196:199], v[112:115]
    ds_read_b128 a[216:219], v2 offset:48128
    v_sub_f32 v89, v89, v15
    v_mfma_f32_16x16x32_bf16 v[112:115], a[20:23], a[200:203], v[112:115]
    v_exp_f32 v72, v72
    v_mfma_f32_16x16x32_bf16 v[116:119], a[24:27], a[240:243], 0
    ds_read_b128 a[220:223], v2 offset:49152
    v_add_f32 v20, v20, v38
    v_mfma_f32_16x16x32_bf16 v[116:119], a[28:31], a[244:247], v[116:119]
    v_exp_f32 v88, v88
    v_mfma_f32_16x16x32_bf16 v[116:119], a[32:35], a[248:251], v[116:119]
    ds_read_b128 a[224:227], v2 offset:50176
    v_cvt_pk_bf16_f32 v168, v112, v113
    v_mfma_f32_16x16x32_bf16 v[116:119], a[36:39], a[192:195], v[116:119]
    v_cvt_pk_bf16_f32 v169, v114, v115
    v_sub_f32 v42, v42, v12
    v_mfma_f32_16x16x32_bf16 v[116:119], a[40:43], a[196:199], v[116:119]
    v_exp_f32 v41, v41
    v_mfma_f32_16x16x32_bf16 v[116:119], a[44:47], a[200:203], v[116:119]
    v_add_f32 v21, v21, v54
    v_sub_f32 v58, v58, v13
    v_mfma_f32_16x16x32_bf16 v[120:123], a[48:51], a[240:243], 0
    v_exp_f32 v57, v57
    v_mfma_f32_16x16x32_bf16 v[120:123], a[52:55], a[244:247], v[120:123]
    v_add_f32 v22, v22, v70
    v_sub_f32 v74, v74, v14
    v_mfma_f32_16x16x32_bf16 v[120:123], a[56:59], a[248:251], v[120:123]
    v_cvt_pk_bf16_f32 v170, v116, v117
    v_cvt_pk_bf16_f32 v171, v118, v119
    v_mfma_f32_16x16x32_bf16 v[120:123], a[60:63], a[192:195], v[120:123]
    v_exp_f32 v73, v73
    v_mfma_f32_16x16x32_bf16 v[120:123], a[64:67], a[196:199], v[120:123]
    v_add_f32 v23, v23, v86
    v_sub_f32 v90, v90, v15
    v_mfma_f32_16x16x32_bf16 v[120:123], a[68:71], a[200:203], v[120:123]
    v_exp_f32 v89, v89
    v_mfma_f32_16x16x32_bf16 v[124:127], a[72:75], a[240:243], 0
    v_add_f32 v20, v20, v39
    v_sub_f32 v43, v43, v12
    v_mfma_f32_16x16x32_bf16 v[124:127], a[76:79], a[244:247], v[124:127]
    v_exp_f32 v42, v42
    v_mfma_f32_16x16x32_bf16 v[124:127], a[80:83], a[248:251], v[124:127]
    v_cvt_pk_bf16_f32 v172, v120, v121
    v_cvt_pk_bf16_f32 v173, v122, v123
    v_mfma_f32_16x16x32_bf16 v[124:127], a[84:87], a[192:195], v[124:127]
    v_add_f32 v21, v21, v55
    v_sub_f32 v59, v59, v13
    v_mfma_f32_16x16x32_bf16 v[124:127], a[88:91], a[196:199], v[124:127]
    ds_read_b128 a[228:231], v2 offset:51200
    v_add_f32 v22, v22, v71
    v_mfma_f32_16x16x32_bf16 v[124:127], a[92:95], a[200:203], v[124:127]
    s_waitcnt lgkmcnt(1)
    v_exp_f32 v58, v58
    v_mfma_f32_16x16x32_bf16 v[96:99], a[0:3], a[204:207], 0
    ds_read_b128 a[232:235], v2 offset:52224
    v_sub_f32 v75, v75, v14
    v_mfma_f32_16x16x32_bf16 v[96:99], a[4:7], a[208:211], v[96:99]
    v_exp_f32 v74, v74
    v_mfma_f32_16x16x32_bf16 v[96:99], a[8:11], a[212:215], v[96:99]
    ds_read_b128 a[236:239], v2 offset:53248
    v_cvt_pk_bf16_f32 v174, v124, v125
    v_mfma_f32_16x16x32_bf16 v[96:99], a[12:15], a[216:219], v[96:99]
    v_cvt_pk_bf16_f32 v175, v126, v127
    v_add_f32 v23, v23, v87
    v_mfma_f32_16x16x32_bf16 v[96:99], a[16:19], a[220:223], v[96:99]
    ds_read_b128 a[240:243], v2 offset:54272
    v_sub_f32 v91, v91, v15
    v_mfma_f32_16x16x32_bf16 v[96:99], a[20:23], a[224:227], v[96:99]
    v_exp_f32 v90, v90
    v_mfma_f32_16x16x32_bf16 v[100:103], a[24:27], a[204:207], 0
    buffer_load_dwordx4 a[160:163], v9, s[8:11], s28 offen offset:256 nt
    v_add_f32 v20, v20, v40
    v_mfma_f32_16x16x32_bf16 v[100:103], a[28:31], a[208:211], v[100:103]
    buffer_load_dwordx4 a[164:167], v10, s[8:11], s28 offen offset:256 nt
    v_sub_f32 v44, v44, v12
    v_mfma_f32_16x16x32_bf16 v[100:103], a[32:35], a[212:215], v[100:103]
    s_add_u32 s28, s16, 7077888
    ds_read_b128 a[244:247], v2 offset:55296
    v_cvt_pk_bf16_f32 v176, v96, v97
    v_mfma_f32_16x16x32_bf16 v[100:103], a[36:39], a[216:219], v[100:103]
    ds_read_b128 a[248:251], v2 offset:56320
    v_cvt_pk_bf16_f32 v177, v98, v99
    v_mfma_f32_16x16x32_bf16 v[100:103], a[40:43], a[220:223], v[100:103]
    v_exp_f32 v43, v43
    v_mfma_f32_16x16x32_bf16 v[100:103], a[44:47], a[224:227], v[100:103]
    v_add_f32 v21, v21, v56
    v_sub_f32 v60, v60, v13
    v_mfma_f32_16x16x32_bf16 v[104:107], a[48:51], a[204:207], 0
    v_exp_f32 v59, v59
    v_mfma_f32_16x16x32_bf16 v[104:107], a[52:55], a[208:211], v[104:107]
    v_add_f32 v22, v22, v72
    v_sub_f32 v76, v76, v14
    v_mfma_f32_16x16x32_bf16 v[104:107], a[56:59], a[212:215], v[104:107]
    v_cvt_pk_bf16_f32 v178, v100, v101
    v_cvt_pk_bf16_f32 v179, v102, v103
    v_mfma_f32_16x16x32_bf16 v[104:107], a[60:63], a[216:219], v[104:107]
    v_exp_f32 v75, v75
    v_mfma_f32_16x16x32_bf16 v[104:107], a[64:67], a[220:223], v[104:107]
    v_add_f32 v23, v23, v88
    v_sub_f32 v92, v92, v15
    v_mfma_f32_16x16x32_bf16 v[104:107], a[68:71], a[224:227], v[104:107]
    v_exp_f32 v91, v91
    v_mfma_f32_16x16x32_bf16 v[108:111], a[72:75], a[204:207], 0
    v_add_f32 v20, v20, v41
    v_sub_f32 v45, v45, v12
    v_mfma_f32_16x16x32_bf16 v[108:111], a[76:79], a[208:211], v[108:111]
    v_exp_f32 v44, v44
    v_mfma_f32_16x16x32_bf16 v[108:111], a[80:83], a[212:215], v[108:111]
    v_cvt_pk_bf16_f32 v180, v104, v105
    v_cvt_pk_bf16_f32 v181, v106, v107
    v_mfma_f32_16x16x32_bf16 v[108:111], a[84:87], a[216:219], v[108:111]
    v_add_f32 v21, v21, v57
    v_sub_f32 v61, v61, v13
    v_mfma_f32_16x16x32_bf16 v[108:111], a[88:91], a[220:223], v[108:111]
    ds_read_b128 a[192:195], v2 offset:57344
    v_add_f32 v22, v22, v73
    v_mfma_f32_16x16x32_bf16 v[108:111], a[92:95], a[224:227], v[108:111]
    s_waitcnt lgkmcnt(1)
    v_exp_f32 v60, v60
    v_mfma_f32_16x16x32_bf16 v[112:115], a[0:3], a[228:231], 0
    ds_read_b128 a[196:199], v2 offset:58368
    v_sub_f32 v77, v77, v14
    v_mfma_f32_16x16x32_bf16 v[112:115], a[4:7], a[232:235], v[112:115]
    v_exp_f32 v76, v76
    v_mfma_f32_16x16x32_bf16 v[112:115], a[8:11], a[236:239], v[112:115]
    ds_read_b128 a[200:203], v2 offset:59392
    v_cvt_pk_bf16_f32 v182, v108, v109
    v_mfma_f32_16x16x32_bf16 v[112:115], a[12:15], a[240:243], v[112:115]
    v_cvt_pk_bf16_f32 v183, v110, v111
    v_add_f32 v23, v23, v89
    v_mfma_f32_16x16x32_bf16 v[112:115], a[16:19], a[244:247], v[112:115]
    ds_read_b128 a[204:207], v2 offset:60416
    v_sub_f32 v93, v93, v15
    v_mfma_f32_16x16x32_bf16 v[112:115], a[20:23], a[248:251], v[112:115]
    v_exp_f32 v92, v92
    v_mfma_f32_16x16x32_bf16 v[116:119], a[24:27], a[228:231], 0
    ds_read_b128 a[208:211], v2 offset:61440
    v_add_f32 v20, v20, v42
    v_mfma_f32_16x16x32_bf16 v[116:119], a[28:31], a[232:235], v[116:119]
    v_exp_f32 v45, v45
    v_mfma_f32_16x16x32_bf16 v[116:119], a[32:35], a[236:239], v[116:119]
    ds_read_b128 a[212:215], v2 offset:62464
    v_cvt_pk_bf16_f32 v184, v112, v113
    v_mfma_f32_16x16x32_bf16 v[116:119], a[36:39], a[240:243], v[116:119]
    v_cvt_pk_bf16_f32 v185, v114, v115
    v_sub_f32 v46, v46, v12
    v_mfma_f32_16x16x32_bf16 v[116:119], a[40:43], a[244:247], v[116:119]
    v_add_f32 v21, v21, v58
    v_sub_f32 v62, v62, v13
    v_mfma_f32_16x16x32_bf16 v[116:119], a[44:47], a[248:251], v[116:119]
    v_exp_f32 v61, v61
    v_mfma_f32_16x16x32_bf16 v[120:123], a[48:51], a[228:231], 0
    v_add_f32 v22, v22, v74
    v_sub_f32 v78, v78, v14
    v_mfma_f32_16x16x32_bf16 v[120:123], a[52:55], a[232:235], v[120:123]
    v_exp_f32 v77, v77
    v_mfma_f32_16x16x32_bf16 v[120:123], a[56:59], a[236:239], v[120:123]
    v_cvt_pk_bf16_f32 v186, v116, v117
    v_cvt_pk_bf16_f32 v187, v118, v119
    v_mfma_f32_16x16x32_bf16 v[120:123], a[60:63], a[240:243], v[120:123]
    v_add_f32 v23, v23, v90
    v_sub_f32 v94, v94, v15
    v_mfma_f32_16x16x32_bf16 v[120:123], a[64:67], a[244:247], v[120:123]
    v_exp_f32 v93, v93
    v_mfma_f32_16x16x32_bf16 v[120:123], a[68:71], a[248:251], v[120:123]
    v_add_f32 v20, v20, v43
    v_sub_f32 v47, v47, v12
    v_mfma_f32_16x16x32_bf16 v[124:127], a[72:75], a[228:231], 0
    v_exp_f32 v46, v46
    v_mfma_f32_16x16x32_bf16 v[124:127], a[76:79], a[232:235], v[124:127]
    v_add_f32 v21, v21, v59
    v_sub_f32 v63, v63, v13
    v_mfma_f32_16x16x32_bf16 v[124:127], a[80:83], a[236:239], v[124:127]
    v_cvt_pk_bf16_f32 v188, v120, v121
    v_cvt_pk_bf16_f32 v189, v122, v123
    v_mfma_f32_16x16x32_bf16 v[124:127], a[84:87], a[240:243], v[124:127]
    v_exp_f32 v62, v62
    v_mfma_f32_16x16x32_bf16 v[124:127], a[88:91], a[244:247], v[124:127]
    ds_read_b128 a[216:219], v2 offset:63488
    v_add_f32 v22, v22, v75
    v_mfma_f32_16x16x32_bf16 v[124:127], a[92:95], a[248:251], v[124:127]
    s_waitcnt lgkmcnt(1)
    v_exp_f32 v78, v78
    v_mfma_f32_16x16x32_bf16 v[96:99], a[0:3], a[192:195], 0
    ds_read_b128 a[220:223], v2 offset:64512
    v_sub_f32 v79, v79, v14
    v_mfma_f32_16x16x32_bf16 v[96:99], a[4:7], a[196:199], v[96:99]
    v_add_f32 v23, v23, v91
    v_sub_f32 v95, v95, v15
    v_mfma_f32_16x16x32_bf16 v[96:99], a[8:11], a[200:203], v[96:99]
    ds_read_b128 a[224:227], v3 offset:0
    v_cvt_pk_bf16_f32 v190, v124, v125
    v_mfma_f32_16x16x32_bf16 v[96:99], a[12:15], a[204:207], v[96:99]
    v_cvt_pk_bf16_f32 v191, v126, v127
    v_add_f32 v20, v20, v44
    v_mfma_f32_16x16x32_bf16 v[96:99], a[16:19], a[208:211], v[96:99]
    ds_read_b128 a[228:231], v3 offset:1024
    v_add_f32 v21, v21, v60
    v_mfma_f32_16x16x32_bf16 v[96:99], a[20:23], a[212:215], v[96:99]
    v_exp_f32 v94, v94
    v_mfma_f32_16x16x32_bf16 v[100:103], a[24:27], a[192:195], 0
    ds_read_b128 a[232:235], v3 offset:2048
    v_add_f32 v22, v22, v76
    v_mfma_f32_16x16x32_bf16 v[100:103], a[28:31], a[196:199], v[100:103]
    v_exp_f32 v47, v47
    v_mfma_f32_16x16x32_bf16 v[100:103], a[32:35], a[200:203], v[100:103]
    ds_read_b128 a[236:239], v3 offset:3072
    v_cvt_pk_bf16_f32 v192, v96, v97
    v_mfma_f32_16x16x32_bf16 v[100:103], a[36:39], a[204:207], v[100:103]
    v_cvt_pk_bf16_f32 v193, v98, v99
    v_add_f32 v23, v23, v92
    v_mfma_f32_16x16x32_bf16 v[100:103], a[40:43], a[208:211], v[100:103]
    v_exp_f32 v63, v63
    v_mfma_f32_16x16x32_bf16 v[100:103], a[44:47], a[212:215], v[100:103]
    v_exp_f32 v79, v79
    v_mfma_f32_16x16x32_bf16 v[104:107], a[48:51], a[192:195], 0
    v_exp_f32 v95, v95
    v_mfma_f32_16x16x32_bf16 v[104:107], a[52:55], a[196:199], v[104:107]
    v_add_f32 v20, v20, v45
    v_add_f32 v21, v21, v61
    v_mfma_f32_16x16x32_bf16 v[104:107], a[56:59], a[200:203], v[104:107]
    buffer_load_dwordx4 a[184:187], v9, s[8:11], s30 offen offset:256 nt
    v_cvt_pk_bf16_f32 v194, v100, v101
    v_mfma_f32_16x16x32_bf16 v[104:107], a[60:63], a[204:207], v[104:107]
    buffer_load_dwordx4 a[188:191], v10, s[8:11], s30 offen offset:256 nt
    v_cvt_pk_bf16_f32 v195, v102, v103
    v_mfma_f32_16x16x32_bf16 v[104:107], a[64:67], a[208:211], v[104:107]
    s_add_u32 s30, s16, 7471104
    v_add_f32 v22, v22, v77
    v_add_f32 v23, v23, v93
    v_mfma_f32_16x16x32_bf16 v[104:107], a[68:71], a[212:215], v[104:107]
    v_add_f32 v20, v20, v46
    v_add_f32 v21, v21, v62
    v_mfma_f32_16x16x32_bf16 v[108:111], a[72:75], a[192:195], 0
    v_add_f32 v22, v22, v78
    v_add_f32 v23, v23, v94
    v_mfma_f32_16x16x32_bf16 v[108:111], a[76:79], a[196:199], v[108:111]
    v_add_f32 v20, v20, v47
    v_add_f32 v21, v21, v63
    v_mfma_f32_16x16x32_bf16 v[108:111], a[80:83], a[200:203], v[108:111]
    v_cvt_pk_bf16_f32 v196, v104, v105
    v_cvt_pk_bf16_f32 v197, v106, v107
    v_mfma_f32_16x16x32_bf16 v[108:111], a[84:87], a[204:207], v[108:111]
    v_add_f32 v22, v22, v79
    v_add_f32 v23, v23, v95
    v_mfma_f32_16x16x32_bf16 v[108:111], a[88:91], a[208:211], v[108:111]
    ds_read_b128 a[240:243], v3 offset:4096
    v_mfma_f32_16x16x32_bf16 v[108:111], a[92:95], a[212:215], v[108:111]
    s_waitcnt lgkmcnt(1)
    v_permlane16_swap_b32 v20, v21
    v_mfma_f32_16x16x32_bf16 v[112:115], a[0:3], a[216:219], 0
    ds_read_b128 a[244:247], v3 offset:5120
    v_add_f32 v20, v20, v21
    v_mfma_f32_16x16x32_bf16 v[112:115], a[4:7], a[220:223], v[112:115]
    v_permlane16_swap_b32 v22, v23
    v_mfma_f32_16x16x32_bf16 v[112:115], a[8:11], a[224:227], v[112:115]
    ds_read_b128 a[248:251], v3 offset:6144
    v_cvt_pk_bf16_f32 v198, v108, v109
    v_mfma_f32_16x16x32_bf16 v[112:115], a[12:15], a[228:231], v[112:115]
    v_cvt_pk_bf16_f32 v199, v110, v111
    v_add_f32 v22, v22, v23
    v_mfma_f32_16x16x32_bf16 v[112:115], a[16:19], a[232:235], v[112:115]
    ds_read_b128 a[192:195], v3 offset:7168
    v_mfma_f32_16x16x32_bf16 v[112:115], a[20:23], a[236:239], v[112:115]
    v_permlane32_swap_b32 v20, v22
    v_mfma_f32_16x16x32_bf16 v[116:119], a[24:27], a[216:219], 0
    ds_read_b128 a[196:199], v3 offset:8192
    v_add_f32 v20, v20, v22
    v_mfma_f32_16x16x32_bf16 v[116:119], a[28:31], a[220:223], v[116:119]
    v_rcp_f32 v20, v20
    v_mfma_f32_16x16x32_bf16 v[116:119], a[32:35], a[224:227], v[116:119]
    ds_read_b128 a[200:203], v3 offset:9216
    v_cvt_pk_bf16_f32 v200, v112, v113
    v_mfma_f32_16x16x32_bf16 v[116:119], a[36:39], a[228:231], v[116:119]
    v_cvt_pk_bf16_f32 v201, v114, v115
    v_mov_b32 v22, v20
    v_mfma_f32_16x16x32_bf16 v[116:119], a[40:43], a[232:235], v[116:119]
    v_mfma_f32_16x16x32_bf16 v[116:119], a[44:47], a[236:239], v[116:119]
    v_permlane32_swap_b32 v20, v22
    v_mfma_f32_16x16x32_bf16 v[120:123], a[48:51], a[216:219], 0
    v_mov_b32 v21, v20
    v_mov_b32 v23, v22
    v_mfma_f32_16x16x32_bf16 v[120:123], a[52:55], a[220:223], v[120:123]
    v_permlane16_swap_b32 v20, v21
    v_mfma_f32_16x16x32_bf16 v[120:123], a[56:59], a[224:227], v[120:123]
    v_cvt_pk_bf16_f32 v202, v116, v117
    v_cvt_pk_bf16_f32 v203, v118, v119
    v_mfma_f32_16x16x32_bf16 v[120:123], a[60:63], a[228:231], v[120:123]
    v_mul_f32 v32, v32, v20
    v_mul_f32 v33, v33, v20
    v_mfma_f32_16x16x32_bf16 v[120:123], a[64:67], a[232:235], v[120:123]
    v_cvt_pk_bf16_f32 v32, v32, v33
    v_mul_f32 v34, v34, v20
    v_mfma_f32_16x16x32_bf16 v[120:123], a[68:71], a[236:239], v[120:123]
    v_mul_f32 v35, v35, v20
    v_cvt_pk_bf16_f32 v33, v34, v35
    v_mfma_f32_16x16x32_bf16 v[124:127], a[72:75], a[216:219], 0
    v_mul_f32 v36, v36, v20
    v_mul_f32 v37, v37, v20
    v_mfma_f32_16x16x32_bf16 v[124:127], a[76:79], a[220:223], v[124:127]
    v_permlane16_swap_b32 v22, v23
    v_mfma_f32_16x16x32_bf16 v[124:127], a[80:83], a[224:227], v[124:127]
    v_cvt_pk_bf16_f32 v204, v120, v121
    v_cvt_pk_bf16_f32 v205, v122, v123
    v_mfma_f32_16x16x32_bf16 v[124:127], a[84:87], a[228:231], v[124:127]
    v_cvt_pk_bf16_f32 v34, v36, v37
    v_mul_f32 v38, v38, v20
    v_mfma_f32_16x16x32_bf16 v[124:127], a[88:91], a[232:235], v[124:127]
    ds_read_b128 a[204:207], v3 offset:10240
    v_mul_f32 v39, v39, v20
    v_mfma_f32_16x16x32_bf16 v[124:127], a[92:95], a[236:239], v[124:127]
    s_waitcnt lgkmcnt(1)
    v_mul_f32 v40, v40, v20
    v_mul_f32 v41, v41, v20
    v_mfma_f32_16x16x32_bf16 v[96:99], a[0:3], a[240:243], 0
    ds_read_b128 a[208:211], v3 offset:11264
    v_cvt_pk_bf16_f32 v35, v38, v39
    v_mfma_f32_16x16x32_bf16 v[96:99], a[4:7], a[244:247], v[96:99]
    v_cvt_pk_bf16_f32 v36, v40, v41
    v_mul_f32 v48, v48, v21
    v_mfma_f32_16x16x32_bf16 v[96:99], a[8:11], a[248:251], v[96:99]
    ds_read_b128 a[212:215], v3 offset:12288
    v_cvt_pk_bf16_f32 v206, v124, v125
    v_mfma_f32_16x16x32_bf16 v[96:99], a[12:15], a[192:195], v[96:99]
    v_cvt_pk_bf16_f32 v207, v126, v127
    v_mul_f32 v49, v49, v21
    v_mfma_f32_16x16x32_bf16 v[96:99], a[16:19], a[196:199], v[96:99]
    ds_read_b128 a[216:219], v3 offset:13312
    v_cvt_pk_bf16_f32 v40, v48, v49
    v_mfma_f32_16x16x32_bf16 v[96:99], a[20:23], a[200:203], v[96:99]
    v_mul_f32 v64, v64, v22
    v_mul_f32 v65, v65, v22
    v_mfma_f32_16x16x32_bf16 v[100:103], a[24:27], a[240:243], 0
    ds_read_b128 a[220:223], v3 offset:14336
    v_mul_f32 v66, v66, v22
    v_mfma_f32_16x16x32_bf16 v[100:103], a[28:31], a[244:247], v[100:103]
    v_mul_f32 v67, v67, v22
    v_cvt_pk_bf16_f32 v48, v64, v65
    v_mfma_f32_16x16x32_bf16 v[100:103], a[32:35], a[248:251], v[100:103]
    ds_read_b128 a[224:227], v3 offset:15360
    v_cvt_pk_bf16_f32 v49, v66, v67
    v_mfma_f32_16x16x32_bf16 v[100:103], a[36:39], a[192:195], v[100:103]
    v_mul_f32 v42, v42, v20
    v_mul_f32 v43, v43, v20
    v_mfma_f32_16x16x32_bf16 v[100:103], a[40:43], a[196:199], v[100:103]
    v_mul_f32 v44, v44, v20
    v_mul_f32 v45, v45, v20
    v_mfma_f32_16x16x32_bf16 v[100:103], a[44:47], a[200:203], v[100:103]
    v_mul_f32 v46, v46, v20
    v_mul_f32 v47, v47, v20
    v_mfma_f32_16x16x32_bf16 v[104:107], a[48:51], a[240:243], 0
    v_cvt_pk_bf16_f32 v37, v42, v43
    v_cvt_pk_bf16_f32 v38, v44, v45
    v_mfma_f32_16x16x32_bf16 v[104:107], a[52:55], a[244:247], v[104:107]
    v_cvt_pk_bf16_f32 v39, v46, v47
    v_mul_f32 v50, v50, v21
    v_mfma_f32_16x16x32_bf16 v[104:107], a[56:59], a[248:251], v[104:107]
    v_mul_f32 v51, v51, v21
    v_cvt_pk_bf16_f32 v41, v50, v51
    v_mfma_f32_16x16x32_bf16 v[104:107], a[60:63], a[192:195], v[104:107]
    v_mul_f32 v68, v68, v22
    v_mul_f32 v69, v69, v22
    v_mfma_f32_16x16x32_bf16 v[104:107], a[64:67], a[196:199], v[104:107]
    v_mul_f32 v70, v70, v22
    v_mul_f32 v71, v71, v22
    v_mfma_f32_16x16x32_bf16 v[104:107], a[68:71], a[200:203], v[104:107]
    v_cvt_pk_bf16_f32 v50, v68, v69
    v_cvt_pk_bf16_f32 v51, v70, v71
    v_mfma_f32_16x16x32_bf16 v[108:111], a[72:75], a[240:243], 0
    v_mul_f32 v52, v52, v21
    v_mul_f32 v53, v53, v21
    v_mfma_f32_16x16x32_bf16 v[108:111], a[76:79], a[244:247], v[108:111]
    v_cvt_pk_bf16_f32 v42, v52, v53
    v_mul_f32 v72, v72, v22
    v_mfma_f32_16x16x32_bf16 v[108:111], a[80:83], a[248:251], v[108:111]
    v_mul_f32 v73, v73, v22
    v_mul_f32 v74, v74, v22
    v_mfma_f32_16x16x32_bf16 v[108:111], a[84:87], a[192:195], v[108:111]
    v_mul_f32 v75, v75, v22
    v_cvt_pk_bf16_f32 v52, v72, v73
    v_mfma_f32_16x16x32_bf16 v[108:111], a[88:91], a[196:199], v[108:111]
    v_cvt_pk_bf16_f32 v53, v74, v75
    v_mul_f32 v54, v54, v21
    v_mfma_f32_16x16x32_bf16 v[108:111], a[92:95], a[200:203], v[108:111]
    s_waitcnt lgkmcnt(0)
    v_mul_f32 v55, v55, v21
    v_cvt_pk_bf16_f32 v43, v54, v55
    v_mfma_f32_16x16x32_bf16 v[112:115], a[0:3], a[204:207], 0
    v_mul_f32 v76, v76, v22
    v_mul_f32 v77, v77, v22
    v_mfma_f32_16x16x32_bf16 v[112:115], a[4:7], a[208:211], v[112:115]
    v_mul_f32 v78, v78, v22
    v_mul_f32 v79, v79, v22
    v_mfma_f32_16x16x32_bf16 v[112:115], a[8:11], a[212:215], v[112:115]
    v_cvt_pk_bf16_f32 v54, v76, v77
    v_cvt_pk_bf16_f32 v55, v78, v79
    v_mfma_f32_16x16x32_bf16 v[112:115], a[12:15], a[216:219], v[112:115]
    v_mul_f32 v56, v56, v21
    v_mul_f32 v57, v57, v21
    v_mfma_f32_16x16x32_bf16 v[112:115], a[16:19], a[220:223], v[112:115]
    v_cvt_pk_bf16_f32 v44, v56, v57
    v_mul_f32 v80, v80, v23
    v_mfma_f32_16x16x32_bf16 v[112:115], a[20:23], a[224:227], v[112:115]
    v_mul_f32 v81, v81, v23
    v_mul_f32 v82, v82, v23
    v_mfma_f32_16x16x32_bf16 v[116:119], a[24:27], a[204:207], 0
    v_mul_f32 v83, v83, v23
    v_cvt_pk_bf16_f32 v56, v80, v81
    v_mfma_f32_16x16x32_bf16 v[116:119], a[28:31], a[208:211], v[116:119]
    v_cvt_pk_bf16_f32 v57, v82, v83
    v_mul_f32 v58, v58, v21
    v_mfma_f32_16x16x32_bf16 v[116:119], a[32:35], a[212:215], v[116:119]
    v_mul_f32 v59, v59, v21
    v_mul_f32 v60, v60, v21
    v_mfma_f32_16x16x32_bf16 v[116:119], a[36:39], a[216:219], v[116:119]
    v_mul_f32 v61, v61, v21
    v_mul_f32 v62, v62, v21
    v_mfma_f32_16x16x32_bf16 v[116:119], a[40:43], a[220:223], v[116:119]
    v_mul_f32 v63, v63, v21
    v_cvt_pk_bf16_f32 v45, v58, v59
    v_mfma_f32_16x16x32_bf16 v[116:119], a[44:47], a[224:227], v[116:119]
    v_cvt_pk_bf16_f32 v46, v60, v61
    v_cvt_pk_bf16_f32 v47, v62, v63
    v_mfma_f32_16x16x32_bf16 v[120:123], a[48:51], a[204:207], 0
    s_mov_b32 s10, s19
    v_mul_f32 v84, v84, v23
    v_mul_f32 v85, v85, v23
    v_mfma_f32_16x16x32_bf16 v[120:123], a[52:55], a[208:211], v[120:123]
    v_mul_f32 v86, v86, v23
    v_mul_f32 v87, v87, v23
    v_mfma_f32_16x16x32_bf16 v[120:123], a[56:59], a[212:215], v[120:123]
    v_cvt_pk_bf16_f32 v58, v84, v85
    v_cvt_pk_bf16_f32 v59, v86, v87
    v_mfma_f32_16x16x32_bf16 v[120:123], a[60:63], a[216:219], v[120:123]
    v_mul_f32 v88, v88, v23
    v_mul_f32 v89, v89, v23
    v_mfma_f32_16x16x32_bf16 v[120:123], a[64:67], a[220:223], v[120:123]
    v_mul_f32 v90, v90, v23
    v_mul_f32 v91, v91, v23
    v_mfma_f32_16x16x32_bf16 v[120:123], a[68:71], a[224:227], v[120:123]
    v_cvt_pk_bf16_f32 v60, v88, v89
    v_cvt_pk_bf16_f32 v61, v90, v91
    v_mfma_f32_16x16x32_bf16 v[124:127], a[72:75], a[204:207], 0
    v_mul_f32 v92, v92, v23
    v_mul_f32 v93, v93, v23
    v_mfma_f32_16x16x32_bf16 v[124:127], a[76:79], a[208:211], v[124:127]
    v_mul_f32 v94, v94, v23
    v_mul_f32 v95, v95, v23
    v_mfma_f32_16x16x32_bf16 v[124:127], a[80:83], a[212:215], v[124:127]
    v_cvt_pk_bf16_f32 v62, v92, v93
    v_cvt_pk_bf16_f32 v63, v94, v95
    v_mfma_f32_16x16x32_bf16 v[124:127], a[84:87], a[216:219], v[124:127]
    v_cvt_pk_bf16_f32 v208, v96, v97
    v_cvt_pk_bf16_f32 v209, v98, v99
    v_mfma_f32_16x16x32_bf16 v[124:127], a[88:91], a[220:223], v[124:127]
    v_cvt_pk_bf16_f32 v210, v100, v101
    v_cvt_pk_bf16_f32 v211, v102, v103
    v_mfma_f32_16x16x32_bf16 v[124:127], a[92:95], a[224:227], v[124:127]
    v_cvt_pk_bf16_f32 v212, v104, v105
    v_cvt_pk_bf16_f32 v213, v106, v107
    v_mfma_f32_16x16x32_bf16 v[64:67], v[32:35], v[128:131], 0
    v_cvt_pk_bf16_f32 v214, v108, v109
    v_cvt_pk_bf16_f32 v215, v110, v111
    v_mfma_f32_16x16x32_bf16 v[64:67], v[36:39], v[132:135], v[64:67]
    v_cvt_pk_bf16_f32 v216, v112, v113
    v_cvt_pk_bf16_f32 v217, v114, v115
    v_mfma_f32_16x16x32_bf16 v[68:71], v[32:35], v[136:139], 0
    v_cvt_pk_bf16_f32 v218, v116, v117
    v_cvt_pk_bf16_f32 v219, v118, v119
    v_mfma_f32_16x16x32_bf16 v[68:71], v[36:39], v[140:143], v[68:71]
    v_cvt_pk_bf16_f32 v220, v120, v121
    v_cvt_pk_bf16_f32 v221, v122, v123
    v_mfma_f32_16x16x32_bf16 v[72:75], v[32:35], v[144:147], 0
    buffer_load_dwordx4 a[0:3], v9, s[8:11], s24 offen offset:0 nt
    v_cvt_pk_bf16_f32 v222, v124, v125
    v_mfma_f32_16x16x32_bf16 v[72:75], v[36:39], v[148:151], v[72:75]
    buffer_load_dwordx4 a[4:7], v10, s[8:11], s24 offen offset:0 nt
    v_cvt_pk_bf16_f32 v223, v126, v127
    v_mfma_f32_16x16x32_bf16 v[76:79], v[32:35], v[152:155], 0
    v_cvt_pk_bf16_f32 v224, v64, v68
    v_cvt_pk_bf16_f32 v226, v65, v69
    v_mfma_f32_16x16x32_bf16 v[76:79], v[36:39], v[156:159], v[76:79]
    v_cvt_pk_bf16_f32 v228, v66, v70
    v_cvt_pk_bf16_f32 v230, v67, v71
    v_mfma_f32_16x16x32_bf16 v[80:83], v[40:43], v[128:131], 0
    v_mfma_f32_16x16x32_bf16 v[80:83], v[44:47], v[132:135], v[80:83]
    v_mfma_f32_16x16x32_bf16 v[84:87], v[40:43], v[136:139], 0
    v_cvt_pk_bf16_f32 v225, v72, v76
    v_cvt_pk_bf16_f32 v227, v73, v77
    v_mfma_f32_16x16x32_bf16 v[84:87], v[44:47], v[140:143], v[84:87]
    v_cvt_pk_bf16_f32 v229, v74, v78
    v_cvt_pk_bf16_f32 v231, v75, v79
    v_mfma_f32_16x16x32_bf16 v[88:91], v[40:43], v[144:147], 0
    v_mfma_f32_16x16x32_bf16 v[88:91], v[44:47], v[148:151], v[88:91]
    v_mfma_f32_16x16x32_bf16 v[92:95], v[40:43], v[152:155], 0
    v_cvt_pk_bf16_f32 v232, v80, v84
    v_cvt_pk_bf16_f32 v234, v81, v85
    v_mfma_f32_16x16x32_bf16 v[92:95], v[44:47], v[156:159], v[92:95]
    v_cvt_pk_bf16_f32 v236, v82, v86
    v_cvt_pk_bf16_f32 v238, v83, v87
    v_mfma_f32_16x16x32_bf16 v[96:99], v[48:51], v[128:131], 0
    v_mfma_f32_16x16x32_bf16 v[96:99], v[52:55], v[132:135], v[96:99]
    v_mfma_f32_16x16x32_bf16 v[100:103], v[48:51], v[136:139], 0
    v_cvt_pk_bf16_f32 v233, v88, v92
    v_cvt_pk_bf16_f32 v235, v89, v93
    v_mfma_f32_16x16x32_bf16 v[100:103], v[52:55], v[140:143], v[100:103]
    v_cvt_pk_bf16_f32 v237, v90, v94
    v_cvt_pk_bf16_f32 v239, v91, v95
    v_mfma_f32_16x16x32_bf16 v[104:107], v[48:51], v[144:147], 0
    v_mfma_f32_16x16x32_bf16 v[104:107], v[52:55], v[148:151], v[104:107]
    v_mfma_f32_16x16x32_bf16 v[108:111], v[48:51], v[152:155], 0
    v_cvt_pk_bf16_f32 v240, v96, v100
    v_cvt_pk_bf16_f32 v242, v97, v101
    v_mfma_f32_16x16x32_bf16 v[108:111], v[52:55], v[156:159], v[108:111]
    v_cvt_pk_bf16_f32 v244, v98, v102
    v_cvt_pk_bf16_f32 v246, v99, v103
    v_mfma_f32_16x16x32_bf16 v[112:115], v[56:59], v[128:131], 0
    v_mfma_f32_16x16x32_bf16 v[112:115], v[60:63], v[132:135], v[112:115]
    v_mfma_f32_16x16x32_bf16 v[116:119], v[56:59], v[136:139], 0
    v_cvt_pk_bf16_f32 v241, v104, v108
    v_cvt_pk_bf16_f32 v243, v105, v109
    v_mfma_f32_16x16x32_bf16 v[116:119], v[60:63], v[140:143], v[116:119]
    v_cvt_pk_bf16_f32 v245, v106, v110
    v_cvt_pk_bf16_f32 v247, v107, v111
    v_mfma_f32_16x16x32_bf16 v[120:123], v[56:59], v[144:147], 0
    buffer_store_dwordx2 v[224:225], v11, s[12:15], s32 offen offset:0 sc1
    v_mfma_f32_16x16x32_bf16 v[120:123], v[60:63], v[148:151], v[120:123]
    v_mfma_f32_16x16x32_bf16 v[124:127], v[56:59], v[152:155], 0
    v_cvt_pk_bf16_f32 v248, v112, v116
    v_cvt_pk_bf16_f32 v250, v113, v117
    v_mfma_f32_16x16x32_bf16 v[124:127], v[60:63], v[156:159], v[124:127]
    v_cvt_pk_bf16_f32 v252, v114, v118
    v_cvt_pk_bf16_f32 v254, v115, v119
    v_mfma_f32_16x16x32_bf16 v[64:67], v[32:35], v[160:163], 0
    v_mfma_f32_16x16x32_bf16 v[64:67], v[36:39], v[164:167], v[64:67]
    v_mfma_f32_16x16x32_bf16 v[68:71], v[32:35], v[168:171], 0
    v_cvt_pk_bf16_f32 v249, v120, v124
    v_cvt_pk_bf16_f32 v251, v121, v125
    v_mfma_f32_16x16x32_bf16 v[68:71], v[36:39], v[172:175], v[68:71]
    v_cvt_pk_bf16_f32 v253, v122, v126
    v_cvt_pk_bf16_f32 v255, v123, v127
    v_mfma_f32_16x16x32_bf16 v[72:75], v[32:35], v[176:179], 0
    v_mfma_f32_16x16x32_bf16 v[72:75], v[36:39], v[180:183], v[72:75]
    v_mfma_f32_16x16x32_bf16 v[76:79], v[32:35], v[184:187], 0
    v_cvt_pk_bf16_f32 v128, v64, v68
    v_cvt_pk_bf16_f32 v130, v65, v69
    v_mfma_f32_16x16x32_bf16 v[76:79], v[36:39], v[188:191], v[76:79]
    buffer_store_dwordx2 v[226:227], v11, s[12:15], s32 offen offset:384 sc1
    v_mfma_f32_16x16x32_bf16 v[80:83], v[40:43], v[160:163], 0
    v_cvt_pk_bf16_f32 v132, v66, v70
    v_cvt_pk_bf16_f32 v134, v67, v71
    v_mfma_f32_16x16x32_bf16 v[80:83], v[44:47], v[164:167], v[80:83]
    v_mfma_f32_16x16x32_bf16 v[84:87], v[40:43], v[168:171], 0
    v_cvt_pk_bf16_f32 v129, v72, v76
    v_cvt_pk_bf16_f32 v131, v73, v77
    v_mfma_f32_16x16x32_bf16 v[84:87], v[44:47], v[172:175], v[84:87]
    v_cvt_pk_bf16_f32 v133, v74, v78
    v_cvt_pk_bf16_f32 v135, v75, v79
    v_mfma_f32_16x16x32_bf16 v[88:91], v[40:43], v[176:179], 0
    v_mfma_f32_16x16x32_bf16 v[88:91], v[44:47], v[180:183], v[88:91]
    v_mfma_f32_16x16x32_bf16 v[92:95], v[40:43], v[184:187], 0
    v_cvt_pk_bf16_f32 v136, v80, v84
    v_cvt_pk_bf16_f32 v138, v81, v85
    v_mfma_f32_16x16x32_bf16 v[92:95], v[44:47], v[188:191], v[92:95]
    v_cvt_pk_bf16_f32 v140, v82, v86
    v_cvt_pk_bf16_f32 v142, v83, v87
    v_mfma_f32_16x16x32_bf16 v[96:99], v[48:51], v[160:163], 0
    s_waitcnt vmcnt(8)
    ds_write_b32 v4, a120 offset:0
    v_mfma_f32_16x16x32_bf16 v[96:99], v[52:55], v[164:167], v[96:99]
    ds_write_b32 v4, a121 offset:4
    v_mfma_f32_16x16x32_bf16 v[100:103], v[48:51], v[168:171], 0
    ds_write_b32 v4, a122 offset:1024
    v_mfma_f32_16x16x32_bf16 v[100:103], v[52:55], v[172:175], v[100:103]
    buffer_store_dwordx2 v[228:229], v11, s[12:15], s32 offen offset:768 sc1
    v_mfma_f32_16x16x32_bf16 v[104:107], v[48:51], v[176:179], 0
    ds_write_b32 v4, a123 offset:1028
    v_mfma_f32_16x16x32_bf16 v[104:107], v[52:55], v[180:183], v[104:107]
    ds_write_b32 v4, a124 offset:512
    v_mfma_f32_16x16x32_bf16 v[108:111], v[48:51], v[184:187], 0
    ds_write_b32 v4, a125 offset:516
    v_mfma_f32_16x16x32_bf16 v[108:111], v[52:55], v[188:191], v[108:111]
    ds_write_b32 v4, a126 offset:1536
    v_mfma_f32_16x16x32_bf16 v[112:115], v[56:59], v[160:163], 0
    ds_write_b32 v4, a127 offset:1540
    v_mfma_f32_16x16x32_bf16 v[112:115], v[60:63], v[164:167], v[112:115]
    ds_read2_b64 a[120:123], v5 offset0:0 offset1:128
    v_cvt_pk_bf16_f32 v137, v88, v92
    v_mfma_f32_16x16x32_bf16 v[116:119], v[56:59], v[168:171], 0
    ds_read2_b64 a[124:127], v6 offset0:0 offset1:128
    v_cvt_pk_bf16_f32 v139, v89, v93
    v_mfma_f32_16x16x32_bf16 v[116:119], v[60:63], v[172:175], v[116:119]
    v_cvt_pk_bf16_f32 v141, v90, v94
    v_cvt_pk_bf16_f32 v143, v91, v95
    v_mfma_f32_16x16x32_bf16 v[120:123], v[56:59], v[176:179], 0
    buffer_load_dwordx4 a[8:11], v9, s[8:11], s24 offen offset:128 nt
    v_cvt_pk_bf16_f32 v144, v96, v100
    v_mfma_f32_16x16x32_bf16 v[120:123], v[60:63], v[180:183], v[120:123]
    buffer_load_dwordx4 a[12:15], v10, s[8:11], s24 offen offset:128 nt
    v_cvt_pk_bf16_f32 v146, v97, v101
    v_mfma_f32_16x16x32_bf16 v[124:127], v[56:59], v[184:187], 0
    v_cvt_pk_bf16_f32 v148, v98, v102
    v_cvt_pk_bf16_f32 v150, v99, v103
    v_mfma_f32_16x16x32_bf16 v[124:127], v[60:63], v[188:191], v[124:127]
    buffer_store_dwordx2 v[230:231], v11, s[12:15], s32 offen offset:1152 sc1
    v_mfma_f32_16x16x32_bf16 v[64:67], v[32:35], v[192:195], 0
    s_waitcnt vmcnt(27)
    ds_write_b32 v4, a128 offset:0
    v_mfma_f32_16x16x32_bf16 v[64:67], v[36:39], v[196:199], v[64:67]
    ds_write_b32 v4, a129 offset:4
    v_mfma_f32_16x16x32_bf16 v[68:71], v[32:35], v[200:203], 0
    ds_write_b32 v4, a130 offset:1024
    v_mfma_f32_16x16x32_bf16 v[68:71], v[36:39], v[204:207], v[68:71]
    ds_write_b32 v4, a131 offset:1028
    v_mfma_f32_16x16x32_bf16 v[72:75], v[32:35], v[208:211], 0
    ds_write_b32 v4, a132 offset:512
    v_mfma_f32_16x16x32_bf16 v[72:75], v[36:39], v[212:215], v[72:75]
    ds_write_b32 v4, a133 offset:516
    v_mfma_f32_16x16x32_bf16 v[76:79], v[32:35], v[216:219], 0
    ds_read_b128 a[228:231], v1 offset:0
    v_cvt_pk_bf16_f32 v145, v104, v108
    v_mfma_f32_16x16x32_bf16 v[76:79], v[36:39], v[220:223], v[76:79]
    ds_write_b32 v4, a134 offset:1536
    v_mfma_f32_16x16x32_bf16 v[80:83], v[40:43], v[192:195], 0
    ds_read_b128 a[232:235], v1 offset:1024
    v_cvt_pk_bf16_f32 v147, v105, v109
    v_mfma_f32_16x16x32_bf16 v[80:83], v[44:47], v[196:199], v[80:83]
    ds_write_b32 v4, a135 offset:1540
    v_mfma_f32_16x16x32_bf16 v[84:87], v[40:43], v[200:203], 0
    buffer_store_dwordx2 v[232:233], v11, s[12:15], s34 offen offset:0 sc1
    v_mfma_f32_16x16x32_bf16 v[84:87], v[44:47], v[204:207], v[84:87]
    ds_read_b128 a[236:239], v1 offset:2048
    v_cvt_pk_bf16_f32 v149, v106, v110
    v_mfma_f32_16x16x32_bf16 v[88:91], v[40:43], v[208:211], 0
    ds_read_b128 a[240:243], v1 offset:3072
    v_cvt_pk_bf16_f32 v151, v107, v111
    v_mfma_f32_16x16x32_bf16 v[88:91], v[44:47], v[212:215], v[88:91]
    ds_read2_b64 a[128:131], v5 offset0:0 offset1:128
    v_cvt_pk_bf16_f32 v152, v112, v116
    v_mfma_f32_16x16x32_bf16 v[92:95], v[40:43], v[216:219], 0
    ds_read_b128 a[244:247], v1 offset:4096
    v_cvt_pk_bf16_f32 v154, v113, v117
    v_mfma_f32_16x16x32_bf16 v[92:95], v[44:47], v[220:223], v[92:95]
    ds_read2_b64 a[132:135], v6 offset0:0 offset1:128
    v_cvt_pk_bf16_f32 v156, v114, v118
    v_mfma_f32_16x16x32_bf16 v[96:99], v[48:51], v[192:195], 0
    ds_read_b128 a[248:251], v1 offset:5120
    v_cvt_pk_bf16_f32 v158, v115, v119
    v_mfma_f32_16x16x32_bf16 v[96:99], v[52:55], v[196:199], v[96:99]
    s_waitcnt vmcnt(24)
    ds_write_b32 v4, a136 offset:0
    v_mfma_f32_16x16x32_bf16 v[100:103], v[48:51], v[200:203], 0
    ds_read_b128 a[192:195], v1 offset:6144
    v_cvt_pk_bf16_f32 v153, v120, v124
    v_mfma_f32_16x16x32_bf16 v[100:103], v[52:55], v[204:207], v[100:103]
    ds_write_b32 v4, a137 offset:4
    v_mfma_f32_16x16x32_bf16 v[104:107], v[48:51], v[208:211], 0
    ds_read_b128 a[196:199], v1 offset:7168
    v_cvt_pk_bf16_f32 v155, v121, v125
    v_mfma_f32_16x16x32_bf16 v[104:107], v[52:55], v[212:215], v[104:107]
    ds_write_b32 v4, a138 offset:1024
    v_mfma_f32_16x16x32_bf16 v[108:111], v[48:51], v[216:219], 0
    buffer_store_dwordx2 v[234:235], v11, s[12:15], s34 offen offset:384 sc1
    v_mfma_f32_16x16x32_bf16 v[108:111], v[52:55], v[220:223], v[108:111]
    ds_read_b128 a[200:203], v1 offset:8192
    v_cvt_pk_bf16_f32 v157, v122, v126
    v_mfma_f32_16x16x32_bf16 v[112:115], v[56:59], v[192:195], 0
    ds_read_b128 a[204:207], v1 offset:9216
    v_cvt_pk_bf16_f32 v159, v123, v127
    v_mfma_f32_16x16x32_bf16 v[112:115], v[60:63], v[196:199], v[112:115]
    ds_write_b32 v4, a139 offset:1028
    v_mfma_f32_16x16x32_bf16 v[116:119], v[56:59], v[200:203], 0
    ds_read_b128 a[208:211], v1 offset:10240
    v_cvt_pk_bf16_f32 v176, v96, v100
    v_mfma_f32_16x16x32_bf16 v[116:119], v[60:63], v[204:207], v[116:119]
    ds_write_b32 v4, a140 offset:512
    v_mfma_f32_16x16x32_bf16 v[120:123], v[56:59], v[208:211], 0
    ds_write_b32 v4, a141 offset:516
    v_mfma_f32_16x16x32_bf16 v[120:123], v[60:63], v[212:215], v[120:123]
    ds_write_b32 v4, a142 offset:1536
    v_mfma_f32_16x16x32_bf16 v[124:127], v[56:59], v[216:219], 0
    ds_write_b32 v4, a143 offset:1540
    v_mfma_f32_16x16x32_bf16 v[124:127], v[60:63], v[220:223], v[124:127]
    s_waitcnt lgkmcnt(11)
    ds_read2_b64 a[136:139], v5 offset0:0 offset1:128
    v_cvt_pk_bf16_f32 v178, v97, v101
    v_cvt_pk_bf16_f32 v180, v98, v102
    v_cvt_pk_bf16_f32 v182, v99, v103
    v_mfma_f32_16x16x32_bf16 v[96:99], a[228:231], a[96:99], 0
    ds_read_b128 a[212:215], v1 offset:11264
    v_cvt_pk_bf16_f32 v184, v112, v116
    v_mfma_f32_16x16x32_bf16 v[96:99], a[232:235], a[100:103], v[96:99]
    ds_read2_b64 a[140:143], v6 offset0:0 offset1:128
    v_cvt_pk_bf16_f32 v186, v113, v117
    v_mfma_f32_16x16x32_bf16 v[96:99], a[236:239], a[104:107], v[96:99]
    ds_read_b128 a[216:219], v1 offset:12288
    v_cvt_pk_bf16_f32 v188, v114, v118
    v_mfma_f32_16x16x32_bf16 v[96:99], a[240:243], a[108:111], v[96:99]
    ds_read_b128 a[220:223], v1 offset:13312
    v_cvt_pk_bf16_f32 v190, v115, v119
    v_mfma_f32_16x16x32_bf16 v[96:99], a[244:247], a[112:115], v[96:99]
    buffer_store_dwordx2 v[236:237], v11, s[12:15], s34 offen offset:768 sc1
    v_mfma_f32_16x16x32_bf16 v[96:99], a[248:251], a[116:119], v[96:99]
    ds_read_b128 a[224:227], v1 offset:14336
    v_cvt_pk_bf16_f32 v177, v104, v108
    v_mfma_f32_16x16x32_bf16 v[100:103], a[228:231], a[120:123], 0
    s_waitcnt vmcnt(13)
    ds_write_b32 v4, a144 offset:0
    v_mfma_f32_16x16x32_bf16 v[100:103], a[232:235], a[124:127], v[100:103]
    ds_read_b128 a[228:231], v1 offset:15360
    v_cvt_pk_bf16_f32 v179, v105, v109
    v_mfma_f32_16x16x32_bf16 v[100:103], a[236:239], a[128:131], v[100:103]
    ds_read_b128 a[232:235], v1 offset:16384
    v_cvt_pk_bf16_f32 v192, v96, v97
    v_mfma_f32_16x16x32_bf16 v[100:103], a[240:243], a[132:135], v[100:103]
    s_waitcnt lgkmcnt(8)
    ds_read_b128 a[236:239], v1 offset:17408
    v_cvt_pk_bf16_f32 v193, v98, v99
    v_mfma_f32_16x16x32_bf16 v[100:103], a[244:247], a[136:139], v[100:103]
    s_waitcnt lgkmcnt(7)
    ds_read_b128 a[240:243], v1 offset:18432
    v_cvt_pk_bf16_f32 v181, v106, v110
    v_mfma_f32_16x16x32_bf16 v[100:103], a[248:251], a[140:143], v[100:103]
    ds_write_b32 v4, a145 offset:4
    v_mfma_f32_16x16x32_bf16 v[112:115], a[192:195], a[96:99], 0
    ds_read_b128 a[244:247], v1 offset:19456
    v_cvt_pk_bf16_f32 v183, v107, v111
    v_mfma_f32_16x16x32_bf16 v[112:115], a[196:199], a[100:103], v[112:115]
    buffer_store_dwordx2 v[238:239], v11, s[12:15], s34 offen offset:1152 sc1
    v_mfma_f32_16x16x32_bf16 v[112:115], a[200:203], a[104:107], v[112:115]
    ds_read_b128 a[248:251], v1 offset:20480
    v_cvt_pk_bf16_f32 v196, v100, v101
    v_mfma_f32_16x16x32_bf16 v[112:115], a[204:207], a[108:111], v[112:115]
    ds_write_b32 v4, a146 offset:1024
    v_mfma_f32_16x16x32_bf16 v[112:115], a[208:211], a[112:115], v[112:115]
    ds_write_b32 v4, a147 offset:1028
    v_mfma_f32_16x16x32_bf16 v[112:115], a[212:215], a[116:119], v[112:115]
    ds_write_b32 v4, a148 offset:512
    v_mfma_f32_16x16x32_bf16 v[116:119], a[192:195], a[120:123], 0
    ds_write_b32 v4, a149 offset:516
    v_mfma_f32_16x16x32_bf16 v[116:119], a[196:199], a[124:127], v[116:119]
    ds_read_b128 a[192:195], v1 offset:21504
    v_cvt_pk_bf16_f32 v197, v102, v103
    v_mfma_f32_16x16x32_bf16 v[116:119], a[200:203], a[128:131], v[116:119]
    buffer_load_dwordx4 a[16:19], v9, s[8:11], s24 offen offset:256 nt
    v_cvt_pk_bf16_f32 v194, v112, v113
    v_mfma_f32_16x16x32_bf16 v[116:119], a[204:207], a[132:135], v[116:119]
    buffer_load_dwordx4 a[20:23], v10, s[8:11], s24 offen offset:256 nt
    v_cvt_pk_bf16_f32 v195, v114, v115
    v_mfma_f32_16x16x32_bf16 v[116:119], a[208:211], a[136:139], v[116:119]
    s_add_u32 s24, s16, 9437184
    ds_read_b128 a[196:199], v1 offset:22528
    v_cvt_pk_bf16_f32 v185, v120, v124
    v_mfma_f32_16x16x32_bf16 v[116:119], a[212:215], a[140:143], v[116:119]
    s_waitcnt lgkmcnt(9)
    ds_read_b128 a[200:203], v1 offset:23552
    v_cvt_pk_bf16_f32 v187, v121, v125
    v_mfma_f32_16x16x32_bf16 v[96:99], a[216:219], a[96:99], 0
    ds_read_b128 a[204:207], v1 offset:24576
    v_cvt_pk_bf16_f32 v189, v122, v126
    v_mfma_f32_16x16x32_bf16 v[96:99], a[220:223], a[100:103], v[96:99]
    ds_read_b128 a[208:211], v1 offset:25600
    v_cvt_pk_bf16_f32 v191, v123, v127
    v_mfma_f32_16x16x32_bf16 v[96:99], a[224:227], a[104:107], v[96:99]
    buffer_store_dwordx2 v[240:241], v11, s[12:15], s36 offen offset:0 sc1
    v_mfma_f32_16x16x32_bf16 v[96:99], a[228:231], a[108:111], v[96:99]
    ds_read_b128 a[212:215], v1 offset:26624
    v_cvt_pk_bf16_f32 v198, v116, v117
    v_mfma_f32_16x16x32_bf16 v[96:99], a[232:235], a[112:115], v[96:99]
    ds_write_b32 v4, a150 offset:1536
    v_mfma_f32_16x16x32_bf16 v[96:99], a[236:239], a[116:119], v[96:99]
    ds_write_b32 v4, a151 offset:1540
    v_mfma_f32_16x16x32_bf16 v[100:103], a[216:219], a[120:123], 0
    ds_read2_b64 a[144:147], v5 offset0:0 offset1:128
    v_cvt_pk_bf16_f32 v199, v118, v119
    v_mfma_f32_16x16x32_bf16 v[100:103], a[220:223], a[124:127], v[100:103]
    ds_read_b128 a[216:219], v1 offset:27648
    v_cvt_pk_bf16_f32 v160, v64, v68
    v_mfma_f32_16x16x32_bf16 v[100:103], a[224:227], a[128:131], v[100:103]
    ds_read_b128 a[220:223], v1 offset:28672
    v_cvt_pk_bf16_f32 v208, v96, v97
    v_mfma_f32_16x16x32_bf16 v[100:103], a[228:231], a[132:135], v[100:103]
    ds_read_b128 a[224:227], v1 offset:29696
    v_cvt_pk_bf16_f32 v209, v98, v99
    v_mfma_f32_16x16x32_bf16 v[100:103], a[232:235], a[136:139], v[100:103]
    ds_read2_b64 a[148:151], v6 offset0:0 offset1:128
    v_cvt_pk_bf16_f32 v162, v65, v69
    v_mfma_f32_16x16x32_bf16 v[100:103], a[236:239], a[140:143], v[100:103]
    ds_write_b32 v4, a168 offset:0
    v_mfma_f32_16x16x32_bf16 v[112:115], a[240:243], a[96:99], 0
    s_waitcnt lgkmcnt(11)
    ds_write_b32 v4, a169 offset:4
    v_mfma_f32_16x16x32_bf16 v[112:115], a[244:247], a[100:103], v[112:115]
    buffer_store_dwordx2 v[242:243], v11, s[12:15], s36 offen offset:384 sc1
    v_mfma_f32_16x16x32_bf16 v[112:115], a[248:251], a[104:107], v[112:115]
    ds_write_b32 v4, a170 offset:1024
    v_mfma_f32_16x16x32_bf16 v[112:115], a[192:195], a[108:111], v[112:115]
    ds_write_b32 v4, a171 offset:1028
    v_mfma_f32_16x16x32_bf16 v[112:115], a[196:199], a[112:115], v[112:115]
    ds_write_b32 v4, a172 offset:512
    v_mfma_f32_16x16x32_bf16 v[112:115], a[200:203], a[116:119], v[112:115]
    ds_write_b32 v4, a173 offset:516
    v_mfma_f32_16x16x32_bf16 v[116:119], a[240:243], a[120:123], 0
    ds_write_b32 v4, a174 offset:1536
    v_mfma_f32_16x16x32_bf16 v[116:119], a[244:247], a[124:127], v[116:119]
    ds_write_b32 v4, a175 offset:1540
    v_mfma_f32_16x16x32_bf16 v[116:119], a[248:251], a[128:131], v[116:119]
    ds_read2_b64 a[168:171], v5 offset0:0 offset1:128
    v_cvt_pk_bf16_f32 v212, v100, v101
    v_mfma_f32_16x16x32_bf16 v[116:119], a[192:195], a[132:135], v[116:119]
    ds_read2_b64 a[172:175], v6 offset0:0 offset1:128
    v_cvt_pk_bf16_f32 v213, v102, v103
    v_mfma_f32_16x16x32_bf16 v[116:119], a[196:199], a[136:139], v[116:119]
    ds_write_b32 v4, a152 offset:0
    v_mfma_f32_16x16x32_bf16 v[116:119], a[200:203], a[140:143], v[116:119]
    s_waitcnt lgkmcnt(11)
    ds_write_b32 v4, a153 offset:4
    v_mfma_f32_16x16x32_bf16 v[96:99], a[204:207], a[96:99], 0
    ds_write_b32 v4, a154 offset:1024
    v_mfma_f32_16x16x32_bf16 v[96:99], a[208:211], a[100:103], v[96:99]
    buffer_store_dwordx2 v[244:245], v11, s[12:15], s36 offen offset:768 sc1
    v_mfma_f32_16x16x32_bf16 v[96:99], a[212:215], a[104:107], v[96:99]
    ds_read_b128 a[228:231], v1 offset:30720
    v_cvt_pk_bf16_f32 v210, v112, v113
    v_mfma_f32_16x16x32_bf16 v[96:99], a[216:219], a[108:111], v[96:99]
    ds_write_b32 v4, a155 offset:1028
    v_mfma_f32_16x16x32_bf16 v[96:99], a[220:223], a[112:115], v[96:99]
    ds_read_b128 a[232:235], v1 offset:31744
    v_cvt_pk_bf16_f32 v211, v114, v115
    v_mfma_f32_16x16x32_bf16 v[96:99], a[224:227], a[116:119], v[96:99]
    ds_write_b32 v4, a156 offset:512
    v_mfma_f32_16x16x32_bf16 v[100:103], a[204:207], a[120:123], 0
    ds_read_b128 a[236:239], v1 offset:32768
    v_cvt_pk_bf16_f32 v214, v116, v117
    v_mfma_f32_16x16x32_bf16 v[100:103], a[208:211], a[124:127], v[100:103]
    ds_write_b32 v4, a157 offset:516
    v_mfma_f32_16x16x32_bf16 v[100:103], a[212:215], a[128:131], v[100:103]
    ds_read_b128 a[240:243], v1 offset:33792
    v_cvt_pk_bf16_f32 v215, v118, v119
    v_mfma_f32_16x16x32_bf16 v[100:103], a[216:219], a[132:135], v[100:103]
    ds_write_b32 v4, a158 offset:1536
    v_mfma_f32_16x16x32_bf16 v[100:103], a[220:223], a[136:139], v[100:103]
    ds_read_b128 a[244:247], v1 offset:34816
    v_cvt_pk_bf16_f32 v164, v66, v70
    v_mfma_f32_16x16x32_bf16 v[100:103], a[224:227], a[140:143], v[100:103]
    ds_write_b32 v4, a159 offset:1540
    v_mfma_f32_16x16x32_bf16 v[32:35], a[96:99], v[192:195], 0
    buffer_store_dwordx2 v[246:247], v11, s[12:15], s36 offen offset:1152 sc1
    v_mfma_f32_16x16x32_bf16 v[32:35], a[100:103], v[208:211], v[32:35]
    ds_read_b128 a[248:251], v1 offset:35840
    v_cvt_pk_bf16_f32 v166, v67, v71
    v_mfma_f32_16x16x32_bf16 v[36:39], a[120:123], v[192:195], 0
    ds_read_b128 a[192:195], v1 offset:36864
    v_cvt_pk_bf16_f32 v161, v72, v76
    v_mfma_f32_16x16x32_bf16 v[36:39], a[124:127], v[208:211], v[36:39]
    ds_read2_b64 a[152:155], v5 offset0:0 offset1:128
    v_cvt_pk_bf16_f32 v163, v73, v77
    v_mfma_f32_16x16x32_bf16 v[40:43], a[144:147], v[192:195], 0
    ds_read_b128 a[196:199], v1 offset:37888
    v_cvt_pk_bf16_f32 v165, v74, v78
    v_mfma_f32_16x16x32_bf16 v[40:43], a[148:151], v[208:211], v[40:43]
    s_waitcnt lgkmcnt(11)
    ds_read2_b64 a[156:159], v6 offset0:0 offset1:128
    v_cvt_pk_bf16_f32 v167, v75, v79
    v_mfma_f32_16x16x32_bf16 v[44:47], a[168:171], v[192:195], 0
    ds_read_b128 a[200:203], v1 offset:38912
    v_cvt_pk_bf16_f32 v192, v96, v97
    v_mfma_f32_16x16x32_bf16 v[44:47], a[172:175], v[208:211], v[44:47]
    s_waitcnt vmcnt(17)
    ds_write_b32 v16, a0 offset:0
    v_mfma_f32_16x16x32_bf16 v[48:51], a[96:99], v[196:199], 0
    ds_read_b128 a[204:207], v1 offset:39936
    v_cvt_pk_bf16_f32 v193, v98, v99
    v_mfma_f32_16x16x32_bf16 v[48:51], a[100:103], v[212:215], v[48:51]
    ds_write_b32 v16, a1 offset:4
    v_mfma_f32_16x16x32_bf16 v[52:55], a[120:123], v[196:199], 0
    ds_read_b128 a[208:211], v1 offset:40960
    v_cvt_pk_bf16_f32 v168, v80, v84
    v_mfma_f32_16x16x32_bf16 v[52:55], a[124:127], v[212:215], v[52:55]
    ds_write_b32 v16, a2 offset:1024
    v_mfma_f32_16x16x32_bf16 v[56:59], a[144:147], v[196:199], 0
    buffer_store_dwordx2 v[248:249], v11, s[12:15], s38 offen offset:0 sc1
    v_mfma_f32_16x16x32_bf16 v[56:59], a[148:151], v[212:215], v[56:59]
    ds_read_b128 a[212:215], v1 offset:41984
    v_cvt_pk_bf16_f32 v170, v81, v85
    v_mfma_f32_16x16x32_bf16 v[60:63], a[168:171], v[196:199], 0
    ds_read_b128 a[216:219], v1 offset:43008
    v_cvt_pk_bf16_f32 v196, v100, v101
    v_mfma_f32_16x16x32_bf16 v[60:63], a[172:175], v[212:215], v[60:63]
    ds_write_b32 v16, a3 offset:1028
    v_mfma_f32_16x16x32_bf16 v[112:115], a[228:231], a[96:99], 0
    buffer_load_dwordx4 a[24:27], v9, s[8:11], s26 offen offset:0 nt
    v_cvt_pk_bf16_f32 v197, v102, v103
    v_mfma_f32_16x16x32_bf16 v[112:115], a[232:235], a[100:103], v[112:115]
    s_waitcnt lgkmcnt(10)
    buffer_load_dwordx4 a[28:31], v10, s[8:11], s26 offen offset:0 nt
    v_cvt_pk_bf16_f32 v172, v82, v86
    v_mfma_f32_16x16x32_bf16 v[112:115], a[236:239], a[104:107], v[112:115]
    ds_read_b128 a[220:223], v1 offset:44032
    v_cvt_pk_bf16_f32 v174, v83, v87
    v_mfma_f32_16x16x32_bf16 v[112:115], a[240:243], a[108:111], v[112:115]
    ds_read_b128 a[224:227], v1 offset:45056
    v_cvt_pk_bf16_f32 v169, v88, v92
    v_mfma_f32_16x16x32_bf16 v[112:115], a[244:247], a[112:115], v[112:115]
    s_waitcnt vmcnt(19)
    ds_write_b32 v16, a4 offset:512
    v_mfma_f32_16x16x32_bf16 v[112:115], a[248:251], a[116:119], v[112:115]
    ds_write_b32 v16, a5 offset:516
    v_mfma_f32_16x16x32_bf16 v[116:119], a[228:231], a[120:123], 0
    ds_write_b32 v16, a6 offset:1536
    v_mfma_f32_16x16x32_bf16 v[116:119], a[232:235], a[124:127], v[116:119]
    ds_read_b128 a[228:231], v1 offset:46080
    v_cvt_pk_bf16_f32 v171, v89, v93
    v_mfma_f32_16x16x32_bf16 v[116:119], a[236:239], a[128:131], v[116:119]
    ds_write_b32 v16, a7 offset:1540
    v_mfma_f32_16x16x32_bf16 v[116:119], a[240:243], a[132:135], v[116:119]
    buffer_store_dwordx2 v[250:251], v11, s[12:15], s38 offen offset:384 sc1
    v_mfma_f32_16x16x32_bf16 v[116:119], a[244:247], a[136:139], v[116:119]
    ds_read2_b64 a[0:3], v17 offset0:0 offset1:128
    v_cvt_pk_bf16_f32 v194, v112, v113
    v_mfma_f32_16x16x32_bf16 v[116:119], a[248:251], a[140:143], v[116:119]
    ds_read2_b64 a[4:7], v18 offset0:0 offset1:128
    v_cvt_pk_bf16_f32 v195, v114, v115
    v_mfma_f32_16x16x32_bf16 v[96:99], a[192:195], a[96:99], 0
    ds_read_b128 a[232:235], v1 offset:47104
    v_cvt_pk_bf16_f32 v173, v90, v94
    v_mfma_f32_16x16x32_bf16 v[96:99], a[196:199], a[100:103], v[96:99]
    s_waitcnt lgkmcnt(10)
    ds_read_b128 a[236:239], v1 offset:48128
    v_cvt_pk_bf16_f32 v175, v91, v95
    v_mfma_f32_16x16x32_bf16 v[96:99], a[200:203], a[104:107], v[96:99]
    ds_read_b128 a[240:243], v1 offset:49152
    v_cvt_pk_bf16_f32 v198, v116, v117
    v_mfma_f32_16x16x32_bf16 v[96:99], a[204:207], a[108:111], v[96:99]
    ds_read_b128 a[244:247], v1 offset:50176
    v_cvt_pk_bf16_f32 v199, v118, v119
    v_mfma_f32_16x16x32_bf16 v[96:99], a[208:211], a[112:115], v[96:99]
    ds_read_b128 a[248:251], v1 offset:51200
    v_mfma_f32_16x16x32_bf16 v[96:99], a[212:215], a[116:119], v[96:99]
    ds_write_b32 v4, a176 offset:0
    v_mfma_f32_16x16x32_bf16 v[100:103], a[192:195], a[120:123], 0
    ds_write_b32 v4, a177 offset:4
    v_mfma_f32_16x16x32_bf16 v[100:103], a[196:199], a[124:127], v[100:103]
    buffer_store_dwordx2 v[252:253], v11, s[12:15], s38 offen offset:768 sc1
    v_mfma_f32_16x16x32_bf16 v[100:103], a[200:203], a[128:131], v[100:103]
    ds_read_b128 a[192:195], v1 offset:52224
    v_cvt_pk_bf16_f32 v208, v96, v97
    v_mfma_f32_16x16x32_bf16 v[100:103], a[204:207], a[132:135], v[100:103]
    ds_read_b128 a[196:199], v1 offset:53248
    v_cvt_pk_bf16_f32 v209, v98, v99
    v_mfma_f32_16x16x32_bf16 v[100:103], a[208:211], a[136:139], v[100:103]
    ds_read_b128 a[200:203], v1 offset:54272
    v_mfma_f32_16x16x32_bf16 v[100:103], a[212:215], a[140:143], v[100:103]
    ds_write_b32 v4, a178 offset:1024
    v_mfma_f32_16x16x32_bf16 v[112:115], a[216:219], a[96:99], 0
    s_waitcnt lgkmcnt(11)
    ds_write_b32 v4, a179 offset:1028
    v_mfma_f32_16x16x32_bf16 v[112:115], a[220:223], a[100:103], v[112:115]
    ds_write_b32 v4, a180 offset:512
    v_mfma_f32_16x16x32_bf16 v[112:115], a[224:227], a[104:107], v[112:115]
    ds_write_b32 v4, a181 offset:516
    v_mfma_f32_16x16x32_bf16 v[112:115], a[228:231], a[108:111], v[112:115]
    s_waitcnt lgkmcnt(11)
    ds_write_b32 v4, a182 offset:1536
    v_mfma_f32_16x16x32_bf16 v[112:115], a[232:235], a[112:115], v[112:115]
    ds_write_b32 v4, a183 offset:1540
    v_mfma_f32_16x16x32_bf16 v[112:115], a[236:239], a[116:119], v[112:115]
    ds_read2_b64 a[176:179], v5 offset0:0 offset1:128
    v_cvt_pk_bf16_f32 v212, v100, v101
    v_mfma_f32_16x16x32_bf16 v[116:119], a[216:219], a[120:123], 0
    ds_read2_b64 a[180:183], v6 offset0:0 offset1:128
    v_cvt_pk_bf16_f32 v213, v102, v103
    v_mfma_f32_16x16x32_bf16 v[116:119], a[220:223], a[124:127], v[116:119]
    buffer_store_dwordx2 v[254:255], v11, s[12:15], s38 offen offset:1152 sc1
    v_mfma_f32_16x16x32_bf16 v[116:119], a[224:227], a[128:131], v[116:119]
    v_cvt_pk_bf16_f32 v210, v112, v113
    v_cvt_pk_bf16_f32 v211, v114, v115
    v_mfma_f32_16x16x32_bf16 v[116:119], a[228:231], a[132:135], v[116:119]
    v_mfma_f32_16x16x32_bf16 v[116:119], a[232:235], a[136:139], v[116:119]
    v_mfma_f32_16x16x32_bf16 v[116:119], a[236:239], a[140:143], v[116:119]
    s_waitcnt vmcnt(18)
    ds_write_b32 v16, a8 offset:0
    v_mfma_f32_16x16x32_bf16 v[96:99], a[240:243], a[96:99], 0
    s_waitcnt lgkmcnt(8)
    ds_write_b32 v16, a9 offset:4
    v_mfma_f32_16x16x32_bf16 v[96:99], a[244:247], a[100:103], v[96:99]
    ds_write_b32 v16, a10 offset:1024
    v_mfma_f32_16x16x32_bf16 v[96:99], a[248:251], a[104:107], v[96:99]
    ds_read_b128 a[204:207], v1 offset:55296
    v_cvt_pk_bf16_f32 v214, v116, v117
    v_mfma_f32_16x16x32_bf16 v[96:99], a[192:195], a[108:111], v[96:99]
    ds_write_b32 v16, a11 offset:1028
    v_mfma_f32_16x16x32_bf16 v[96:99], a[196:199], a[112:115], v[96:99]
    ds_read_b128 a[208:211], v1 offset:56320
    v_cvt_pk_bf16_f32 v215, v118, v119
    v_mfma_f32_16x16x32_bf16 v[96:99], a[200:203], a[116:119], v[96:99]
    s_waitcnt vmcnt(17)
    ds_write_b32 v16, a12 offset:512
    v_mfma_f32_16x16x32_bf16 v[100:103], a[240:243], a[120:123], 0
    ds_read_b128 a[212:215], v1 offset:57344
    v_mfma_f32_16x16x32_bf16 v[100:103], a[244:247], a[124:127], v[100:103]
    buffer_store_dwordx2 v[128:129], v11, s[12:15], s32 offen offset:128 sc1
    v_mfma_f32_16x16x32_bf16 v[100:103], a[248:251], a[128:131], v[100:103]
    ds_read_b128 a[216:219], v1 offset:58368
    v_mfma_f32_16x16x32_bf16 v[100:103], a[192:195], a[132:135], v[100:103]
    ds_write_b32 v16, a13 offset:516
    v_mfma_f32_16x16x32_bf16 v[100:103], a[196:199], a[136:139], v[100:103]
    ds_read_b128 a[220:223], v1 offset:59392
    v_mfma_f32_16x16x32_bf16 v[100:103], a[200:203], a[140:143], v[100:103]
    ds_write_b32 v16, a14 offset:1536
    v_mfma_f32_16x16x32_bf16 v[32:35], a[104:107], v[192:195], v[32:35]
    ds_read_b128 a[224:227], v1 offset:60416
    v_mfma_f32_16x16x32_bf16 v[32:35], a[108:111], v[208:211], v[32:35]
    ds_write_b32 v16, a15 offset:1540
    v_mfma_f32_16x16x32_bf16 v[36:39], a[128:131], v[192:195], v[36:39]
    ds_read_b128 a[228:231], v1 offset:61440
    v_mfma_f32_16x16x32_bf16 v[36:39], a[132:135], v[208:211], v[36:39]
    ds_read2_b64 a[8:11], v17 offset0:0 offset1:128
    v_mfma_f32_16x16x32_bf16 v[40:43], a[152:155], v[192:195], v[40:43]
    ds_read_b128 a[232:235], v1 offset:62464
    v_mfma_f32_16x16x32_bf16 v[40:43], a[156:159], v[208:211], v[40:43]
    s_waitcnt lgkmcnt(11)
    ds_read2_b64 a[12:15], v18 offset0:0 offset1:128
    v_mfma_f32_16x16x32_bf16 v[44:47], a[176:179], v[192:195], v[44:47]
    buffer_store_dwordx2 v[130:131], v11, s[12:15], s32 offen offset:512 sc1
    v_mfma_f32_16x16x32_bf16 v[44:47], a[180:183], v[208:211], v[44:47]
    ds_read_b128 a[236:239], v1 offset:63488
    v_cvt_pk_bf16_f32 v192, v96, v97
    v_mfma_f32_16x16x32_bf16 v[48:51], a[104:107], v[196:199], v[48:51]
    buffer_load_dwordx4 a[32:35], v9, s[8:11], s26 offen offset:128 nt
    v_cvt_pk_bf16_f32 v193, v98, v99
    v_mfma_f32_16x16x32_bf16 v[48:51], a[108:111], v[212:215], v[48:51]
    buffer_load_dwordx4 a[36:39], v10, s[8:11], s26 offen offset:128 nt
    v_mfma_f32_16x16x32_bf16 v[52:55], a[128:131], v[196:199], v[52:55]
    ds_read_b128 a[240:243], v1 offset:64512
    v_mfma_f32_16x16x32_bf16 v[52:55], a[132:135], v[212:215], v[52:55]
    ds_read_b128 a[244:247], v2 offset:0
    v_mfma_f32_16x16x32_bf16 v[56:59], a[152:155], v[196:199], v[56:59]
    ds_write_b32 v4, a160 offset:0
    v_mfma_f32_16x16x32_bf16 v[56:59], a[156:159], v[212:215], v[56:59]
    ds_write_b32 v4, a161 offset:4
    v_mfma_f32_16x16x32_bf16 v[60:63], a[176:179], v[196:199], v[60:63]
    ds_write_b32 v4, a162 offset:1024
    v_mfma_f32_16x16x32_bf16 v[60:63], a[180:183], v[212:215], v[60:63]
    ds_write_b32 v4, a163 offset:1028
    v_mfma_f32_16x16x32_bf16 v[112:115], a[204:207], a[96:99], 0
    ds_write_b32 v4, a164 offset:512
    v_mfma_f32_16x16x32_bf16 v[112:115], a[208:211], a[100:103], v[112:115]
    s_waitcnt lgkmcnt(9)
    ds_write_b32 v4, a165 offset:516
    v_mfma_f32_16x16x32_bf16 v[112:115], a[212:215], a[104:107], v[112:115]
    ds_write_b32 v4, a166 offset:1536
    v_mfma_f32_16x16x32_bf16 v[112:115], a[216:219], a[108:111], v[112:115]
    ds_write_b32 v4, a167 offset:1540
    v_mfma_f32_16x16x32_bf16 v[112:115], a[220:223], a[112:115], v[112:115]
    ds_read2_b64 a[160:163], v5 offset0:0 offset1:128
    v_cvt_pk_bf16_f32 v196, v100, v101
    v_mfma_f32_16x16x32_bf16 v[112:115], a[224:227], a[116:119], v[112:115]
    ds_read2_b64 a[164:167], v6 offset0:0 offset1:128
    v_cvt_pk_bf16_f32 v197, v102, v103
    v_mfma_f32_16x16x32_bf16 v[116:119], a[204:207], a[120:123], 0
    ds_read_b128 a[248:251], v2 offset:1024
    v_mfma_f32_16x16x32_bf16 v[116:119], a[208:211], a[124:127], v[116:119]
    ds_read_b128 a[192:195], v2 offset:2048
    v_mfma_f32_16x16x32_bf16 v[116:119], a[212:215], a[128:131], v[116:119]
    ds_read_b128 a[196:199], v2 offset:3072
    v_cvt_pk_bf16_f32 v194, v112, v113
    v_mfma_f32_16x16x32_bf16 v[116:119], a[216:219], a[132:135], v[116:119]
    buffer_store_dwordx2 v[132:133], v11, s[12:15], s32 offen offset:896 sc1
    v_mfma_f32_16x16x32_bf16 v[116:119], a[220:223], a[136:139], v[116:119]
    ds_read_b128 a[200:203], v2 offset:4096
    v_cvt_pk_bf16_f32 v195, v114, v115
    v_mfma_f32_16x16x32_bf16 v[116:119], a[224:227], a[140:143], v[116:119]
    ds_read_b128 a[204:207], v2 offset:5120
    v_mfma_f32_16x16x32_bf16 v[96:99], a[228:231], a[96:99], 0
    ds_read_b128 a[208:211], v2 offset:6144
    v_mfma_f32_16x16x32_bf16 v[96:99], a[232:235], a[100:103], v[96:99]
    s_waitcnt lgkmcnt(11)
    ds_read_b128 a[212:215], v2 offset:7168
    v_mfma_f32_16x16x32_bf16 v[96:99], a[236:239], a[104:107], v[96:99]
    ds_read_b128 a[216:219], v1 offset:0
    v_cvt_pk_bf16_f32 v198, v116, v117
    v_mfma_f32_16x16x32_bf16 v[96:99], a[240:243], a[108:111], v[96:99]
    ds_read_b128 a[220:223], v1 offset:1024
    v_cvt_pk_bf16_f32 v199, v118, v119
    v_mfma_f32_16x16x32_bf16 v[96:99], a[244:247], a[112:115], v[96:99]
    s_waitcnt lgkmcnt(8)
    buffer_store_dwordx2 v[134:135], v11, s[12:15], s32 offen offset:1280 sc1
    v_mfma_f32_16x16x32_bf16 v[96:99], a[248:251], a[116:119], v[96:99]
    ds_read_b128 a[224:227], v1 offset:2048
    v_mfma_f32_16x16x32_bf16 v[100:103], a[228:231], a[120:123], 0
    ds_write_b32 v4, a184 offset:0
    v_mfma_f32_16x16x32_bf16 v[100:103], a[232:235], a[124:127], v[100:103]
    ds_read_b128 a[228:231], v1 offset:3072
    v_mfma_f32_16x16x32_bf16 v[100:103], a[236:239], a[128:131], v[100:103]
    ds_read_b128 a[232:235], v1 offset:4096
    v_cvt_pk_bf16_f32 v208, v96, v97
    v_mfma_f32_16x16x32_bf16 v[100:103], a[240:243], a[132:135], v[100:103]
    ds_read_b128 a[236:239], v1 offset:5120
    v_cvt_pk_bf16_f32 v209, v98, v99
    v_mfma_f32_16x16x32_bf16 v[100:103], a[244:247], a[136:139], v[100:103]
    ds_write_b32 v4, a185 offset:4
    v_mfma_f32_16x16x32_bf16 v[100:103], a[248:251], a[140:143], v[100:103]
    s_waitcnt lgkmcnt(11)
    ds_write_b32 v4, a186 offset:1024
    v_mfma_f32_16x16x32_bf16 v[112:115], a[192:195], a[96:99], 0
    ds_write_b32 v4, a187 offset:1028
    v_mfma_f32_16x16x32_bf16 v[112:115], a[196:199], a[100:103], v[112:115]
    ds_write_b32 v4, a188 offset:512
    v_mfma_f32_16x16x32_bf16 v[112:115], a[200:203], a[104:107], v[112:115]
    s_waitcnt lgkmcnt(11)
    ds_write_b32 v4, a189 offset:516
    v_mfma_f32_16x16x32_bf16 v[112:115], a[204:207], a[108:111], v[112:115]
    ds_write_b32 v4, a190 offset:1536
    v_mfma_f32_16x16x32_bf16 v[112:115], a[208:211], a[112:115], v[112:115]
    ds_write_b32 v4, a191 offset:1540
    v_mfma_f32_16x16x32_bf16 v[112:115], a[212:215], a[116:119], v[112:115]
    buffer_store_dwordx2 v[136:137], v11, s[12:15], s34 offen offset:128 sc1
    v_mfma_f32_16x16x32_bf16 v[116:119], a[192:195], a[120:123], 0
    ds_read2_b64 a[184:187], v5 offset0:0 offset1:128
    v_cvt_pk_bf16_f32 v212, v100, v101
    v_mfma_f32_16x16x32_bf16 v[116:119], a[196:199], a[124:127], v[116:119]
    ds_read2_b64 a[188:191], v6 offset0:0 offset1:128
    v_cvt_pk_bf16_f32 v213, v102, v103
    v_mfma_f32_16x16x32_bf16 v[116:119], a[200:203], a[128:131], v[116:119]
    s_waitcnt vmcnt(18)
    ds_write_b32 v16, a16 offset:0
    v_mfma_f32_16x16x32_bf16 v[116:119], a[204:207], a[132:135], v[116:119]
    ds_write_b32 v16, a17 offset:4
    v_mfma_f32_16x16x32_bf16 v[116:119], a[208:211], a[136:139], v[116:119]
    ds_write_b32 v16, a18 offset:1024
    v_mfma_f32_16x16x32_bf16 v[116:119], a[212:215], a[140:143], v[116:119]
    s_waitcnt lgkmcnt(11)
    ds_write_b32 v16, a19 offset:1028
    v_mfma_f32_16x16x32_bf16 v[104:107], a[216:219], a[144:147], 0
    s_waitcnt vmcnt(17)
    ds_write_b32 v16, a20 offset:512
    v_mfma_f32_16x16x32_bf16 v[104:107], a[220:223], a[148:151], v[104:107]
    buffer_store_dwordx2 v[138:139], v11, s[12:15], s34 offen offset:512 sc1
    v_mfma_f32_16x16x32_bf16 v[104:107], a[224:227], a[152:155], v[104:107]
    ds_read_b128 a[240:243], v1 offset:6144
    v_cvt_pk_bf16_f32 v210, v112, v113
    v_mfma_f32_16x16x32_bf16 v[104:107], a[228:231], a[156:159], v[104:107]
    ds_write_b32 v16, a21 offset:516
    v_mfma_f32_16x16x32_bf16 v[104:107], a[232:235], a[160:163], v[104:107]
    ds_read_b128 a[244:247], v1 offset:7168
    v_cvt_pk_bf16_f32 v211, v114, v115
    v_mfma_f32_16x16x32_bf16 v[104:107], a[236:239], a[164:167], v[104:107]
    ds_write_b32 v16, a22 offset:1536
    v_mfma_f32_16x16x32_bf16 v[108:111], a[216:219], a[168:171], 0
    ds_read_b128 a[248:251], v1 offset:8192
    v_cvt_pk_bf16_f32 v214, v116, v117
    v_mfma_f32_16x16x32_bf16 v[108:111], a[220:223], a[172:175], v[108:111]
    ds_write_b32 v16, a23 offset:1540
    v_mfma_f32_16x16x32_bf16 v[108:111], a[224:227], a[176:179], v[108:111]
    ds_read2_b64 a[16:19], v17 offset0:0 offset1:128
    v_cvt_pk_bf16_f32 v215, v118, v119
    v_mfma_f32_16x16x32_bf16 v[108:111], a[228:231], a[180:183], v[108:111]
    s_waitcnt lgkmcnt(11)
    ds_read2_b64 a[20:23], v18 offset0:0 offset1:128
    v_cvt_pk_bf16_f32 v200, v104, v105
    v_mfma_f32_16x16x32_bf16 v[108:111], a[232:235], a[184:187], v[108:111]
    ds_read_b128 a[192:195], v1 offset:9216
    v_cvt_pk_bf16_f32 v201, v106, v107
    v_mfma_f32_16x16x32_bf16 v[108:111], a[236:239], a[188:191], v[108:111]
    ds_read_b128 a[196:199], v1 offset:10240
    v_mfma_f32_16x16x32_bf16 v[32:35], a[112:115], v[192:195], v[32:35]
    buffer_load_dwordx4 a[40:43], v9, s[8:11], s26 offen offset:256 nt
    v_mfma_f32_16x16x32_bf16 v[32:35], a[116:119], v[208:211], v[32:35]
    buffer_load_dwordx4 a[44:47], v10, s[8:11], s26 offen offset:256 nt
    s_add_u32 s26, s16, 9830400
    v_mfma_f32_16x16x32_bf16 v[36:39], a[136:139], v[192:195], v[36:39]
    ds_read_b128 a[200:203], v1 offset:11264
    v_cvt_pk_bf16_f32 v204, v108, v109
    v_mfma_f32_16x16x32_bf16 v[36:39], a[140:143], v[208:211], v[36:39]
    buffer_store_dwordx2 v[140:141], v11, s[12:15], s34 offen offset:896 sc1
    v_mfma_f32_16x16x32_bf16 v[40:43], a[160:163], v[192:195], v[40:43]
    ds_read_b128 a[204:207], v1 offset:12288
    v_cvt_pk_bf16_f32 v205, v110, v111
    v_mfma_f32_16x16x32_bf16 v[40:43], a[164:167], v[208:211], v[40:43]
    ds_read_b128 a[208:211], v1 offset:13312
    v_max3_f32 v12, v32, v33, v34
    v_mfma_f32_16x16x32_bf16 v[44:47], a[184:187], v[192:195], v[44:47]
    ds_read_b128 a[212:215], v1 offset:14336
    v_max3_f32 v12, v12, v35, v36
    v_mfma_f32_16x16x32_bf16 v[44:47], a[188:191], v[208:211], v[44:47]
    v_max3_f32 v12, v12, v37, v38
    v_mfma_f32_16x16x32_bf16 v[48:51], a[112:115], v[196:199], v[48:51]
    ds_read_b128 a[216:219], v1 offset:15360
    v_max3_f32 v12, v12, v39, v40
    v_mfma_f32_16x16x32_bf16 v[48:51], a[116:119], v[212:215], v[48:51]
    v_max3_f32 v12, v12, v41, v42
    v_mfma_f32_16x16x32_bf16 v[52:55], a[136:139], v[196:199], v[52:55]
    ds_read_b128 a[220:223], v1 offset:16384
    v_max3_f32 v12, v12, v43, v44
    v_mfma_f32_16x16x32_bf16 v[52:55], a[140:143], v[212:215], v[52:55]
    v_max3_f32 v12, v12, v45, v46
    v_max_f32 v12, v12, v47
    v_mfma_f32_16x16x32_bf16 v[56:59], a[160:163], v[196:199], v[56:59]
    ds_read_b128 a[224:227], v1 offset:17408
    v_max3_f32 v13, v48, v49, v50
    v_mfma_f32_16x16x32_bf16 v[56:59], a[164:167], v[212:215], v[56:59]
    buffer_store_dwordx2 v[142:143], v11, s[12:15], s34 offen offset:1280 sc1
    v_mfma_f32_16x16x32_bf16 v[60:63], a[184:187], v[196:199], v[60:63]
    ds_read_b128 a[228:231], v1 offset:18432
    v_max3_f32 v13, v13, v51, v52
    v_mfma_f32_16x16x32_bf16 v[60:63], a[188:191], v[212:215], v[60:63]
    s_waitcnt lgkmcnt(7)
    v_max3_f32 v13, v13, v53, v54
    v_mfma_f32_16x16x32_bf16 v[120:123], a[240:243], a[144:147], 0
    ds_read_b128 a[232:235], v1 offset:19456
    v_max3_f32 v13, v13, v55, v56
    v_mfma_f32_16x16x32_bf16 v[120:123], a[244:247], a[148:151], v[120:123]
    v_max3_f32 v13, v13, v57, v58
    v_mfma_f32_16x16x32_bf16 v[120:123], a[248:251], a[152:155], v[120:123]
    ds_read_b128 a[236:239], v1 offset:20480
    v_max3_f32 v13, v13, v59, v60
    v_mfma_f32_16x16x32_bf16 v[120:123], a[192:195], a[156:159], v[120:123]
    v_max3_f32 v13, v13, v61, v62
    v_max_f32 v13, v13, v63
    v_mfma_f32_16x16x32_bf16 v[120:123], a[196:199], a[160:163], v[120:123]
    v_mfma_f32_16x16x32_bf16 v[120:123], a[200:203], a[164:167], v[120:123]
    v_permlane16_swap_b32 v12, v13
    v_mfma_f32_16x16x32_bf16 v[124:127], a[240:243], a[168:171], 0
    v_max_f32 v12, v12, v13
    v_mov_b32 v13, v12
    v_mfma_f32_16x16x32_bf16 v[124:127], a[244:247], a[172:175], v[124:127]
    ds_read_b128 a[240:243], v1 offset:21504
    v_mfma_f32_16x16x32_bf16 v[124:127], a[248:251], a[176:179], v[124:127]
    buffer_store_dwordx2 v[144:145], v11, s[12:15], s36 offen offset:128 sc1
    v_mfma_f32_16x16x32_bf16 v[124:127], a[192:195], a[180:183], v[124:127]
    ds_read_b128 a[244:247], v1 offset:22528
    v_cvt_pk_bf16_f32 v202, v120, v121
    v_mfma_f32_16x16x32_bf16 v[124:127], a[196:199], a[184:187], v[124:127]
    ds_read_b128 a[248:251], v1 offset:23552
    v_cvt_pk_bf16_f32 v203, v122, v123
    v_mfma_f32_16x16x32_bf16 v[124:127], a[200:203], a[188:191], v[124:127]
    s_waitcnt lgkmcnt(5)
    ds_read_b128 a[192:195], v1 offset:24576
    v_mfma_f32_16x16x32_bf16 v[104:107], a[204:207], a[144:147], 0
    ds_read_b128 a[196:199], v1 offset:25600
    v_mfma_f32_16x16x32_bf16 v[104:107], a[208:211], a[148:151], v[104:107]
    v_permlane32_swap_b32 v12, v13
    v_mfma_f32_16x16x32_bf16 v[104:107], a[212:215], a[152:155], v[104:107]
    ds_read_b128 a[200:203], v1 offset:26624
    v_cvt_pk_bf16_f32 v206, v124, v125
    v_mfma_f32_16x16x32_bf16 v[104:107], a[216:219], a[156:159], v[104:107]
    v_cvt_pk_bf16_f32 v207, v126, v127
    v_max_f32 v12, v12, v13
    v_mfma_f32_16x16x32_bf16 v[104:107], a[220:223], a[160:163], v[104:107]
    v_mov_b32 v13, v12
    v_mfma_f32_16x16x32_bf16 v[104:107], a[224:227], a[164:167], v[104:107]
    v_mfma_f32_16x16x32_bf16 v[108:111], a[204:207], a[168:171], 0
    v_permlane16_swap_b32 v12, v13
    v_mfma_f32_16x16x32_bf16 v[108:111], a[208:211], a[172:175], v[108:111]
    ds_read_b128 a[204:207], v1 offset:27648
    v_sub_f32 v32, v32, v12
    v_mfma_f32_16x16x32_bf16 v[108:111], a[212:215], a[176:179], v[108:111]
    buffer_store_dwordx2 v[146:147], v11, s[12:15], s36 offen offset:512 sc1
    v_mfma_f32_16x16x32_bf16 v[108:111], a[216:219], a[180:183], v[108:111]
    ds_read_b128 a[208:211], v1 offset:28672
    v_cvt_pk_bf16_f32 v216, v104, v105
    v_mfma_f32_16x16x32_bf16 v[108:111], a[220:223], a[184:187], v[108:111]
    ds_read_b128 a[212:215], v1 offset:29696
    v_cvt_pk_bf16_f32 v217, v106, v107
    v_mfma_f32_16x16x32_bf16 v[108:111], a[224:227], a[188:191], v[108:111]
    v_sub_f32 v33, v33, v12
    v_sub_f32 v48, v48, v13
    v_mfma_f32_16x16x32_bf16 v[120:123], a[228:231], a[144:147], 0
    s_waitcnt lgkmcnt(5)
    v_sub_f32 v49, v49, v13
    v_sub_f32 v34, v34, v12
    v_mfma_f32_16x16x32_bf16 v[120:123], a[232:235], a[148:151], v[120:123]
    v_exp_f32 v32, v32
    v_mfma_f32_16x16x32_bf16 v[120:123], a[236:239], a[152:155], v[120:123]
    v_cvt_pk_bf16_f32 v220, v108, v109
    v_cvt_pk_bf16_f32 v221, v110, v111
    v_mfma_f32_16x16x32_bf16 v[120:123], a[240:243], a[156:159], v[120:123]
    v_exp_f32 v33, v33
    v_mfma_f32_16x16x32_bf16 v[120:123], a[244:247], a[160:163], v[120:123]
    v_exp_f32 v48, v48
    v_mfma_f32_16x16x32_bf16 v[120:123], a[248:251], a[164:167], v[120:123]
    v_exp_f32 v49, v49
    v_mfma_f32_16x16x32_bf16 v[124:127], a[228:231], a[168:171], 0
    v_sub_f32 v50, v50, v13
    v_sub_f32 v35, v35, v12
    v_mfma_f32_16x16x32_bf16 v[124:127], a[232:235], a[172:175], v[124:127]
    v_exp_f32 v34, v34
    v_mfma_f32_16x16x32_bf16 v[124:127], a[236:239], a[176:179], v[124:127]
    buffer_store_dwordx2 v[148:149], v11, s[12:15], s36 offen offset:896 sc1
    v_mfma_f32_16x16x32_bf16 v[124:127], a[240:243], a[180:183], v[124:127]
    v_cvt_pk_bf16_f32 v218, v120, v121
    v_cvt_pk_bf16_f32 v219, v122, v123
    v_mfma_f32_16x16x32_bf16 v[124:127], a[244:247], a[184:187], v[124:127]
    v_exp_f32 v50, v50
    v_mfma_f32_16x16x32_bf16 v[124:127], a[248:251], a[188:191], v[124:127]
    v_sub_f32 v51, v51, v13
    v_sub_f32 v36, v36, v12
    v_mfma_f32_16x16x32_bf16 v[104:107], a[192:195], a[144:147], 0
    s_waitcnt lgkmcnt(0)
    v_exp_f32 v35, v35
    v_mfma_f32_16x16x32_bf16 v[104:107], a[196:199], a[148:151], v[104:107]
    v_exp_f32 v51, v51
    v_mfma_f32_16x16x32_bf16 v[104:107], a[200:203], a[152:155], v[104:107]
    ds_read_b128 a[216:219], v1 offset:30720
    v_cvt_pk_bf16_f32 v222, v124, v125
    v_mfma_f32_16x16x32_bf16 v[104:107], a[204:207], a[156:159], v[104:107]
    v_cvt_pk_bf16_f32 v223, v126, v127
    v_sub_f32 v52, v52, v13
    v_mfma_f32_16x16x32_bf16 v[104:107], a[208:211], a[160:163], v[104:107]
    buffer_load_dwordx4 a[48:51], v9, s[8:11], s28 offen offset:0 nt
    v_add_f32 v20, v32, v33
    v_mfma_f32_16x16x32_bf16 v[104:107], a[212:215], a[164:167], v[104:107]
    buffer_load_dwordx4 a[52:55], v10, s[8:11], s28 offen offset:0 nt
    v_sub_f32 v37, v37, v12
    v_mfma_f32_16x16x32_bf16 v[108:111], a[192:195], a[168:171], 0
    ds_read_b128 a[220:223], v1 offset:31744
    v_add_f32 v21, v48, v49
    v_mfma_f32_16x16x32_bf16 v[108:111], a[196:199], a[172:175], v[108:111]
    ds_read_b128 a[224:227], v1 offset:32768
    v_sub_f32 v53, v53, v13
    v_mfma_f32_16x16x32_bf16 v[108:111], a[200:203], a[176:179], v[108:111]
    buffer_store_dwordx2 v[150:151], v11, s[12:15], s36 offen offset:1280 sc1
    v_mfma_f32_16x16x32_bf16 v[108:111], a[204:207], a[180:183], v[108:111]
    ds_read_b128 a[228:231], v1 offset:33792
    v_add_f32 v20, v20, v34
    v_mfma_f32_16x16x32_bf16 v[108:111], a[208:211], a[184:187], v[108:111]
    ds_read_b128 a[232:235], v1 offset:34816
    v_sub_f32 v38, v38, v12
    v_mfma_f32_16x16x32_bf16 v[108:111], a[212:215], a[188:191], v[108:111]
    v_exp_f32 v36, v36
    v_mfma_f32_16x16x32_bf16 v[64:67], a[96:99], v[200:203], 0
    ds_read_b128 a[236:239], v1 offset:35840
    v_add_f32 v21, v21, v50
    v_mfma_f32_16x16x32_bf16 v[64:67], a[100:103], v[216:219], v[64:67]
    v_exp_f32 v52, v52
    v_mfma_f32_16x16x32_bf16 v[68:71], a[120:123], v[200:203], 0
    ds_read_b128 a[240:243], v1 offset:36864
    v_sub_f32 v54, v54, v13
    v_mfma_f32_16x16x32_bf16 v[68:71], a[124:127], v[216:219], v[68:71]
    v_exp_f32 v37, v37
    v_mfma_f32_16x16x32_bf16 v[72:75], a[144:147], v[200:203], 0
    ds_read_b128 a[244:247], v1 offset:37888
    v_add_f32 v20, v20, v35
    v_mfma_f32_16x16x32_bf16 v[72:75], a[148:151], v[216:219], v[72:75]
    v_exp_f32 v53, v53
    v_mfma_f32_16x16x32_bf16 v[76:79], a[168:171], v[200:203], 0
    ds_read_b128 a[248:251], v1 offset:38912
    v_cvt_pk_bf16_f32 v200, v104, v105
    v_mfma_f32_16x16x32_bf16 v[76:79], a[172:175], v[216:219], v[76:79]
    buffer_store_dwordx2 v[152:153], v11, s[12:15], s38 offen offset:128 sc1
    v_mfma_f32_16x16x32_bf16 v[80:83], a[96:99], v[204:207], 0
    ds_read_b128 a[192:195], v1 offset:39936
    v_cvt_pk_bf16_f32 v201, v106, v107
    v_mfma_f32_16x16x32_bf16 v[80:83], a[100:103], v[220:223], v[80:83]
    v_exp_f32 v38, v38
    v_mfma_f32_16x16x32_bf16 v[84:87], a[120:123], v[204:207], 0
    ds_read_b128 a[196:199], v1 offset:40960
    v_sub_f32 v39, v39, v12
    v_mfma_f32_16x16x32_bf16 v[84:87], a[124:127], v[220:223], v[84:87]
    v_add_f32 v21, v21, v51
    v_sub_f32 v55, v55, v13
    v_mfma_f32_16x16x32_bf16 v[88:91], a[144:147], v[204:207], 0
    ds_read_b128 a[200:203], v1 offset:41984
    v_add_f32 v20, v20, v36
    v_mfma_f32_16x16x32_bf16 v[88:91], a[148:151], v[220:223], v[88:91]
    v_exp_f32 v54, v54
    v_mfma_f32_16x16x32_bf16 v[92:95], a[168:171], v[204:207], 0
    ds_read_b128 a[204:207], v1 offset:43008
    v_cvt_pk_bf16_f32 v204, v108, v109
    v_mfma_f32_16x16x32_bf16 v[92:95], a[172:175], v[220:223], v[92:95]
    s_waitcnt lgkmcnt(6)
    v_cvt_pk_bf16_f32 v205, v110, v111
    v_sub_f32 v40, v40, v12
    v_mfma_f32_16x16x32_bf16 v[120:123], a[216:219], a[144:147], 0
    ds_read_b128 a[208:211], v1 offset:44032
    v_add_f32 v21, v21, v52
    v_mfma_f32_16x16x32_bf16 v[120:123], a[220:223], a[148:151], v[120:123]
    v_exp_f32 v39, v39
    v_mfma_f32_16x16x32_bf16 v[120:123], a[224:227], a[152:155], v[120:123]
    ds_read_b128 a[212:215], v1 offset:45056
    v_sub_f32 v56, v56, v13
    v_mfma_f32_16x16x32_bf16 v[120:123], a[228:231], a[156:159], v[120:123]
    buffer_store_dwordx2 v[154:155], v11, s[12:15], s38 offen offset:512 sc1
    v_mfma_f32_16x16x32_bf16 v[120:123], a[232:235], a[160:163], v[120:123]
    v_exp_f32 v55, v55
    v_mfma_f32_16x16x32_bf16 v[120:123], a[236:239], a[164:167], v[120:123]
    v_add_f32 v20, v20, v37
    v_sub_f32 v41, v41, v12
    v_mfma_f32_16x16x32_bf16 v[124:127], a[216:219], a[168:171], 0
    v_exp_f32 v40, v40
    v_mfma_f32_16x16x32_bf16 v[124:127], a[220:223], a[172:175], v[124:127]
    ds_read_b128 a[216:219], v1 offset:46080
    v_add_f32 v21, v21, v53
    v_mfma_f32_16x16x32_bf16 v[124:127], a[224:227], a[176:179], v[124:127]
    ds_read_b128 a[220:223], v1 offset:47104
    v_cvt_pk_bf16_f32 v202, v120, v121
    v_mfma_f32_16x16x32_bf16 v[124:127], a[228:231], a[180:183], v[124:127]
    ds_read_b128 a[224:227], v1 offset:48128
    v_cvt_pk_bf16_f32 v203, v122, v123
    v_mfma_f32_16x16x32_bf16 v[124:127], a[232:235], a[184:187], v[124:127]
    ds_read_b128 a[228:231], v1 offset:49152
    v_sub_f32 v57, v57, v13
    v_mfma_f32_16x16x32_bf16 v[124:127], a[236:239], a[188:191], v[124:127]
    v_exp_f32 v56, v56
    v_mfma_f32_16x16x32_bf16 v[104:107], a[240:243], a[144:147], 0
    s_waitcnt lgkmcnt(6)
    ds_read_b128 a[232:235], v1 offset:50176
    v_add_f32 v20, v20, v38
    v_mfma_f32_16x16x32_bf16 v[104:107], a[244:247], a[148:151], v[104:107]
    v_exp_f32 v41, v41
    v_mfma_f32_16x16x32_bf16 v[104:107], a[248:251], a[152:155], v[104:107]
    ds_read_b128 a[236:239], v1 offset:51200
    v_cvt_pk_bf16_f32 v206, v124, v125
    v_mfma_f32_16x16x32_bf16 v[104:107], a[192:195], a[156:159], v[104:107]
    buffer_store_dwordx2 v[156:157], v11, s[12:15], s38 offen offset:896 sc1
    v_mfma_f32_16x16x32_bf16 v[104:107], a[196:199], a[160:163], v[104:107]
    v_cvt_pk_bf16_f32 v207, v126, v127
    v_sub_f32 v42, v42, v12
    v_mfma_f32_16x16x32_bf16 v[104:107], a[200:203], a[164:167], v[104:107]
    v_add_f32 v21, v21, v54
    v_sub_f32 v58, v58, v13
    v_mfma_f32_16x16x32_bf16 v[108:111], a[240:243], a[168:171], 0
    v_exp_f32 v57, v57
    v_mfma_f32_16x16x32_bf16 v[108:111], a[244:247], a[172:175], v[108:111]
    ds_read_b128 a[240:243], v1 offset:52224
    v_add_f32 v20, v20, v39
    v_mfma_f32_16x16x32_bf16 v[108:111], a[248:251], a[176:179], v[108:111]
    ds_read_b128 a[244:247], v1 offset:53248
    v_cvt_pk_bf16_f32 v216, v104, v105
    v_mfma_f32_16x16x32_bf16 v[108:111], a[192:195], a[180:183], v[108:111]
    ds_read_b128 a[248:251], v1 offset:54272
    v_cvt_pk_bf16_f32 v217, v106, v107
    v_mfma_f32_16x16x32_bf16 v[108:111], a[196:199], a[184:187], v[108:111]
    v_exp_f32 v42, v42
    v_mfma_f32_16x16x32_bf16 v[108:111], a[200:203], a[188:191], v[108:111]
    v_sub_f32 v43, v43, v12
    v_add_f32 v21, v21, v55
    v_mfma_f32_16x16x32_bf16 v[120:123], a[204:207], a[144:147], 0
    s_waitcnt lgkmcnt(5)
    v_exp_f32 v58, v58
    v_mfma_f32_16x16x32_bf16 v[120:123], a[208:211], a[148:151], v[120:123]
    v_sub_f32 v59, v59, v13
    v_add_f32 v20, v20, v40
    v_mfma_f32_16x16x32_bf16 v[120:123], a[212:215], a[152:155], v[120:123]
    buffer_store_dwordx2 v[158:159], v11, s[12:15], s38 offen offset:1280 sc1
    v_mfma_f32_16x16x32_bf16 v[120:123], a[216:219], a[156:159], v[120:123]
    v_cvt_pk_bf16_f32 v220, v108, v109
    v_cvt_pk_bf16_f32 v221, v110, v111
    v_mfma_f32_16x16x32_bf16 v[120:123], a[220:223], a[160:163], v[120:123]
    v_exp_f32 v43, v43
    v_mfma_f32_16x16x32_bf16 v[120:123], a[224:227], a[164:167], v[120:123]
    v_sub_f32 v44, v44, v12
    v_add_f32 v21, v21, v56
    v_mfma_f32_16x16x32_bf16 v[124:127], a[204:207], a[168:171], 0
    v_exp_f32 v59, v59
    v_mfma_f32_16x16x32_bf16 v[124:127], a[208:211], a[172:175], v[124:127]
    v_sub_f32 v60, v60, v13
    v_add_f32 v20, v20, v41
    v_mfma_f32_16x16x32_bf16 v[124:127], a[212:215], a[176:179], v[124:127]
    buffer_load_dwordx4 a[56:59], v9, s[8:11], s28 offen offset:128 nt
    v_cvt_pk_bf16_f32 v218, v120, v121
    v_mfma_f32_16x16x32_bf16 v[124:127], a[216:219], a[180:183], v[124:127]
    buffer_load_dwordx4 a[60:63], v10, s[8:11], s28 offen offset:128 nt
    v_cvt_pk_bf16_f32 v219, v122, v123
    v_mfma_f32_16x16x32_bf16 v[124:127], a[220:223], a[184:187], v[124:127]
    v_exp_f32 v44, v44
    v_mfma_f32_16x16x32_bf16 v[124:127], a[224:227], a[188:191], v[124:127]
    v_sub_f32 v45, v45, v12
    v_add_f32 v21, v21, v57
    v_mfma_f32_16x16x32_bf16 v[104:107], a[228:231], a[144:147], 0
    s_waitcnt lgkmcnt(0)
    v_exp_f32 v60, v60
    v_mfma_f32_16x16x32_bf16 v[104:107], a[232:235], a[148:151], v[104:107]
    v_sub_f32 v61, v61, v13
    v_add_f32 v20, v20, v42
    v_mfma_f32_16x16x32_bf16 v[104:107], a[236:239], a[152:155], v[104:107]
    buffer_store_dwordx2 v[160:161], v11, s[12:15], s32 offen offset:256 sc1
    v_mfma_f32_16x16x32_bf16 v[104:107], a[240:243], a[156:159], v[104:107]
    ds_read_b128 a[192:195], v1 offset:55296
    v_cvt_pk_bf16_f32 v222, v124, v125
    v_mfma_f32_16x16x32_bf16 v[104:107], a[244:247], a[160:163], v[104:107]
    ds_read_b128 a[196:199], v1 offset:56320
    v_cvt_pk_bf16_f32 v223, v126, v127
    v_mfma_f32_16x16x32_bf16 v[104:107], a[248:251], a[164:167], v[104:107]
    v_exp_f32 v45, v45
    v_mfma_f32_16x16x32_bf16 v[108:111], a[228:231], a[168:171], 0
    ds_read_b128 a[200:203], v1 offset:57344
    v_sub_f32 v46, v46, v12
    v_mfma_f32_16x16x32_bf16 v[108:111], a[232:235], a[172:175], v[108:111]
    v_add_f32 v21, v21, v58
    v_sub_f32 v62, v62, v13
    v_mfma_f32_16x16x32_bf16 v[108:111], a[236:239], a[176:179], v[108:111]
    ds_read_b128 a[204:207], v1 offset:58368
    v_add_f32 v20, v20, v43
    v_mfma_f32_16x16x32_bf16 v[108:111], a[240:243], a[180:183], v[108:111]
    v_exp_f32 v61, v61
    v_mfma_f32_16x16x32_bf16 v[108:111], a[244:247], a[184:187], v[108:111]
    ds_read_b128 a[208:211], v1 offset:59392
    v_sub_f32 v47, v47, v12
    v_mfma_f32_16x16x32_bf16 v[108:111], a[248:251], a[188:191], v[108:111]
    v_exp_f32 v46, v46
    v_mfma_f32_16x16x32_bf16 v[64:67], a[104:107], v[200:203], v[64:67]
    ds_read_b128 a[212:215], v1 offset:60416
    v_add_f32 v21, v21, v59
    v_mfma_f32_16x16x32_bf16 v[64:67], a[108:111], v[216:219], v[64:67]
    v_exp_f32 v62, v62
    v_mfma_f32_16x16x32_bf16 v[68:71], a[128:131], v[200:203], v[68:71]
    buffer_store_dwordx2 v[162:163], v11, s[12:15], s32 offen offset:640 sc1
    v_mfma_f32_16x16x32_bf16 v[68:71], a[132:135], v[216:219], v[68:71]
    ds_read_b128 a[216:219], v1 offset:61440
    v_sub_f32 v63, v63, v13
    v_mfma_f32_16x16x32_bf16 v[72:75], a[152:155], v[200:203], v[72:75]
    ds_read_b128 a[220:223], v1 offset:62464
    v_add_f32 v20, v20, v44
    v_mfma_f32_16x16x32_bf16 v[72:75], a[156:159], v[216:219], v[72:75]
    v_exp_f32 v47, v47
    v_mfma_f32_16x16x32_bf16 v[76:79], a[176:179], v[200:203], v[76:79]
    ds_read_b128 a[224:227], v1 offset:63488
    v_cvt_pk_bf16_f32 v200, v104, v105
    v_mfma_f32_16x16x32_bf16 v[76:79], a[180:183], v[216:219], v[76:79]
    v_cvt_pk_bf16_f32 v201, v106, v107
    v_add_f32 v21, v21, v60
    v_mfma_f32_16x16x32_bf16 v[80:83], a[104:107], v[204:207], v[80:83]
    ds_read_b128 a[228:231], v1 offset:64512
    v_add_f32 v20, v20, v45
    v_mfma_f32_16x16x32_bf16 v[80:83], a[108:111], v[220:223], v[80:83]
    v_exp_f32 v63, v63
    v_mfma_f32_16x16x32_bf16 v[84:87], a[128:131], v[204:207], v[84:87]
    ds_read_b128 a[232:235], v2 offset:0
    v_add_f32 v21, v21, v61
    v_mfma_f32_16x16x32_bf16 v[84:87], a[132:135], v[220:223], v[84:87]
    v_add_f32 v20, v20, v46
    v_add_f32 v21, v21, v62
    v_mfma_f32_16x16x32_bf16 v[88:91], a[152:155], v[204:207], v[88:91]
    ds_read_b128 a[236:239], v2 offset:1024
    v_add_f32 v20, v20, v47
    v_mfma_f32_16x16x32_bf16 v[88:91], a[156:159], v[220:223], v[88:91]
    buffer_store_dwordx2 v[164:165], v11, s[12:15], s32 offen offset:1024 sc1
    v_mfma_f32_16x16x32_bf16 v[92:95], a[176:179], v[204:207], v[92:95]
    ds_read_b128 a[240:243], v2 offset:2048
    v_cvt_pk_bf16_f32 v204, v108, v109
    v_mfma_f32_16x16x32_bf16 v[92:95], a[180:183], v[220:223], v[92:95]
    s_waitcnt lgkmcnt(7)
    v_cvt_pk_bf16_f32 v205, v110, v111
    v_add_f32 v21, v21, v63
    v_mfma_f32_16x16x32_bf16 v[120:123], a[192:195], a[144:147], 0
    ds_read_b128 a[244:247], v2 offset:3072
    v_mfma_f32_16x16x32_bf16 v[120:123], a[196:199], a[148:151], v[120:123]
    v_permlane16_swap_b32 v20, v21
    v_mfma_f32_16x16x32_bf16 v[120:123], a[200:203], a[152:155], v[120:123]
    ds_read_b128 a[248:251], v2 offset:4096
    v_add_f32 v20, v20, v21
    v_mfma_f32_16x16x32_bf16 v[120:123], a[204:207], a[156:159], v[120:123]
    v_mov_b32 v21, v20
    v_mfma_f32_16x16x32_bf16 v[120:123], a[208:211], a[160:163], v[120:123]
    v_mfma_f32_16x16x32_bf16 v[120:123], a[212:215], a[164:167], v[120:123]
    v_permlane32_swap_b32 v20, v21
    v_mfma_f32_16x16x32_bf16 v[124:127], a[192:195], a[168:171], 0
    v_add_f32 v20, v20, v21
    v_mfma_f32_16x16x32_bf16 v[124:127], a[196:199], a[172:175], v[124:127]
    ds_read_b128 a[192:195], v2 offset:5120
    v_mfma_f32_16x16x32_bf16 v[124:127], a[200:203], a[176:179], v[124:127]
    ds_read_b128 a[196:199], v2 offset:6144
    v_cvt_pk_bf16_f32 v202, v120, v121
    v_mfma_f32_16x16x32_bf16 v[124:127], a[204:207], a[180:183], v[124:127]
    buffer_store_dwordx2 v[166:167], v11, s[12:15], s32 offen offset:1408 sc1
    v_mfma_f32_16x16x32_bf16 v[124:127], a[208:211], a[184:187], v[124:127]
    ds_read_b128 a[200:203], v2 offset:7168
    v_cvt_pk_bf16_f32 v203, v122, v123
    v_mfma_f32_16x16x32_bf16 v[124:127], a[212:215], a[188:191], v[124:127]
    s_waitcnt lgkmcnt(5)
    ds_read_b128 a[204:207], v2 offset:8192
    v_mfma_f32_16x16x32_bf16 v[104:107], a[216:219], a[144:147], 0
    ds_read_b128 a[208:211], v2 offset:9216
    v_mfma_f32_16x16x32_bf16 v[104:107], a[220:223], a[148:151], v[104:107]
    v_rcp_f32 v20, v20
    v_mfma_f32_16x16x32_bf16 v[104:107], a[224:227], a[152:155], v[104:107]
    ds_read_b128 a[212:215], v2 offset:10240
    v_cvt_pk_bf16_f32 v206, v124, v125
    v_mfma_f32_16x16x32_bf16 v[104:107], a[228:231], a[156:159], v[104:107]
    v_cvt_pk_bf16_f32 v207, v126, v127
    v_mov_b32 v21, v20
    v_mfma_f32_16x16x32_bf16 v[104:107], a[232:235], a[160:163], v[104:107]
    v_mfma_f32_16x16x32_bf16 v[104:107], a[236:239], a[164:167], v[104:107]
    v_permlane16_swap_b32 v20, v21
    v_mfma_f32_16x16x32_bf16 v[108:111], a[216:219], a[168:171], 0
    v_mul_f32 v32, v32, v20
    v_mul_f32 v33, v33, v20
    v_mfma_f32_16x16x32_bf16 v[108:111], a[220:223], a[172:175], v[108:111]
    ds_read_b128 a[216:219], v2 offset:11264
    v_cvt_pk_bf16_f32 v32, v32, v33
    v_mfma_f32_16x16x32_bf16 v[108:111], a[224:227], a[176:179], v[108:111]
    ds_read_b128 a[220:223], v2 offset:12288
    v_cvt_pk_bf16_f32 v216, v104, v105
    v_mfma_f32_16x16x32_bf16 v[108:111], a[228:231], a[180:183], v[108:111]
    buffer_store_dwordx2 v[168:169], v11, s[12:15], s34 offen offset:256 sc1
    v_mfma_f32_16x16x32_bf16 v[108:111], a[232:235], a[184:187], v[108:111]
    ds_read_b128 a[224:227], v2 offset:13312
    v_cvt_pk_bf16_f32 v217, v106, v107
    v_mfma_f32_16x16x32_bf16 v[108:111], a[236:239], a[188:191], v[108:111]
    v_mul_f32 v34, v34, v20
    v_mul_f32 v35, v35, v20
    v_mfma_f32_16x16x32_bf16 v[120:123], a[240:243], a[144:147], 0
    s_waitcnt lgkmcnt(5)
    buffer_load_dwordx4 a[64:67], v9, s[8:11], s28 offen offset:256 nt
    v_cvt_pk_bf16_f32 v33, v34, v35
    v_mfma_f32_16x16x32_bf16 v[120:123], a[244:247], a[148:151], v[120:123]
    buffer_load_dwordx4 a[68:71], v10, s[8:11], s28 offen offset:256 nt
    v_mul_f32 v36, v36, v20
    v_mfma_f32_16x16x32_bf16 v[120:123], a[248:251], a[152:155], v[120:123]
    s_add_u32 s28, s16, 10223616
    v_cvt_pk_bf16_f32 v220, v108, v109
    v_cvt_pk_bf16_f32 v221, v110, v111
    v_mfma_f32_16x16x32_bf16 v[120:123], a[192:195], a[156:159], v[120:123]
    v_mul_f32 v37, v37, v20
    v_mul_f32 v38, v38, v20
    v_mfma_f32_16x16x32_bf16 v[120:123], a[196:199], a[160:163], v[120:123]
    v_mul_f32 v39, v39, v20
    v_cvt_pk_bf16_f32 v34, v36, v37
    v_mfma_f32_16x16x32_bf16 v[120:123], a[200:203], a[164:167], v[120:123]
    v_cvt_pk_bf16_f32 v35, v38, v39
    v_mul_f32 v40, v40, v20
    v_mfma_f32_16x16x32_bf16 v[124:127], a[240:243], a[168:171], 0
    v_mul_f32 v41, v41, v20
    v_mul_f32 v42, v42, v20
    v_mfma_f32_16x16x32_bf16 v[124:127], a[244:247], a[172:175], v[124:127]
    v_mul_f32 v43, v43, v20
    v_mul_f32 v44, v44, v20
    v_mfma_f32_16x16x32_bf16 v[124:127], a[248:251], a[176:179], v[124:127]
    buffer_store_dwordx2 v[170:171], v11, s[12:15], s34 offen offset:640 sc1
    v_mfma_f32_16x16x32_bf16 v[124:127], a[192:195], a[180:183], v[124:127]
    v_cvt_pk_bf16_f32 v218, v120, v121
    v_cvt_pk_bf16_f32 v219, v122, v123
    v_mfma_f32_16x16x32_bf16 v[124:127], a[196:199], a[184:187], v[124:127]
    v_mul_f32 v45, v45, v20
    v_mul_f32 v46, v46, v20
    v_mfma_f32_16x16x32_bf16 v[124:127], a[200:203], a[188:191], v[124:127]
    v_mul_f32 v47, v47, v20
    v_cvt_pk_bf16_f32 v36, v40, v41
    v_mfma_f32_16x16x32_bf16 v[96:99], a[96:99], a[204:207], 0
    s_waitcnt lgkmcnt(0)
    v_cvt_pk_bf16_f32 v37, v42, v43
    v_cvt_pk_bf16_f32 v38, v44, v45
    v_mfma_f32_16x16x32_bf16 v[96:99], a[100:103], a[208:211], v[96:99]
    v_cvt_pk_bf16_f32 v39, v46, v47
    v_mul_f32 v48, v48, v21
    v_mfma_f32_16x16x32_bf16 v[96:99], a[104:107], a[212:215], v[96:99]
    v_cvt_pk_bf16_f32 v222, v124, v125
    v_cvt_pk_bf16_f32 v223, v126, v127
    v_mfma_f32_16x16x32_bf16 v[96:99], a[108:111], a[216:219], v[96:99]
    v_mul_f32 v49, v49, v21
    v_mul_f32 v50, v50, v21
    v_mfma_f32_16x16x32_bf16 v[96:99], a[112:115], a[220:223], v[96:99]
    v_mul_f32 v51, v51, v21
    v_mul_f32 v52, v52, v21
    v_mfma_f32_16x16x32_bf16 v[96:99], a[116:119], a[224:227], v[96:99]
    v_mul_f32 v53, v53, v21
    v_mul_f32 v54, v54, v21
    v_mfma_f32_16x16x32_bf16 v[100:103], a[120:123], a[204:207], 0
    v_mul_f32 v55, v55, v21
    v_cvt_pk_bf16_f32 v40, v48, v49
    v_mfma_f32_16x16x32_bf16 v[100:103], a[124:127], a[208:211], v[100:103]
    v_cvt_pk_bf16_f32 v41, v50, v51
    v_cvt_pk_bf16_f32 v42, v52, v53
    v_mfma_f32_16x16x32_bf16 v[100:103], a[128:131], a[212:215], v[100:103]
    buffer_store_dwordx2 v[172:173], v11, s[12:15], s34 offen offset:1024 sc1
    v_mfma_f32_16x16x32_bf16 v[100:103], a[132:135], a[216:219], v[100:103]
    v_cvt_pk_bf16_f32 v128, v96, v97
    v_cvt_pk_bf16_f32 v129, v98, v99
    v_mfma_f32_16x16x32_bf16 v[100:103], a[136:139], a[220:223], v[100:103]
    v_cvt_pk_bf16_f32 v43, v54, v55
    v_mul_f32 v56, v56, v21
    v_mfma_f32_16x16x32_bf16 v[100:103], a[140:143], a[224:227], v[100:103]
    v_mul_f32 v57, v57, v21
    v_mul_f32 v58, v58, v21
    v_mfma_f32_16x16x32_bf16 v[64:67], a[112:115], v[200:203], v[64:67]
    v_mul_f32 v59, v59, v21
    v_mul_f32 v60, v60, v21
    v_mfma_f32_16x16x32_bf16 v[64:67], a[116:119], v[216:219], v[64:67]
    v_mul_f32 v61, v61, v21
    v_mul_f32 v62, v62, v21
    v_mfma_f32_16x16x32_bf16 v[68:71], a[136:139], v[200:203], v[68:71]
    ds_read_b128 a[228:231], v2 offset:14336
    v_cvt_pk_bf16_f32 v130, v100, v101
    v_mfma_f32_16x16x32_bf16 v[68:71], a[140:143], v[216:219], v[68:71]
    v_cvt_pk_bf16_f32 v131, v102, v103
    v_mul_f32 v63, v63, v21
    v_mfma_f32_16x16x32_bf16 v[72:75], a[160:163], v[200:203], v[72:75]
    ds_read_b128 a[232:235], v2 offset:15360
    v_cvt_pk_bf16_f32 v44, v56, v57
    v_mfma_f32_16x16x32_bf16 v[72:75], a[164:167], v[216:219], v[72:75]
    v_cvt_pk_bf16_f32 v45, v58, v59
    v_cvt_pk_bf16_f32 v46, v60, v61
    v_mfma_f32_16x16x32_bf16 v[76:79], a[184:187], v[200:203], v[76:79]
    ds_read_b128 a[236:239], v2 offset:16384
    v_cvt_pk_bf16_f32 v47, v62, v63
    v_mfma_f32_16x16x32_bf16 v[76:79], a[188:191], v[216:219], v[76:79]
    v_max3_f32 v14, v64, v65, v66
    v_max3_f32 v14, v14, v67, v68
    v_mfma_f32_16x16x32_bf16 v[80:83], a[112:115], v[204:207], v[80:83]
    buffer_store_dwordx2 v[174:175], v11, s[12:15], s34 offen offset:1408 sc1
    v_mfma_f32_16x16x32_bf16 v[80:83], a[116:119], v[220:223], v[80:83]
    ds_read_b128 a[240:243], v2 offset:17408
    v_max3_f32 v14, v14, v69, v70
    v_mfma_f32_16x16x32_bf16 v[84:87], a[136:139], v[204:207], v[84:87]
    ds_read_b128 a[244:247], v2 offset:18432
    v_max3_f32 v14, v14, v71, v72
    v_mfma_f32_16x16x32_bf16 v[84:87], a[140:143], v[220:223], v[84:87]
    v_max3_f32 v14, v14, v73, v74
    v_max3_f32 v14, v14, v75, v76
    v_mfma_f32_16x16x32_bf16 v[88:91], a[160:163], v[204:207], v[88:91]
    ds_read_b128 a[248:251], v2 offset:19456
    v_max3_f32 v15, v80, v81, v82
    v_mfma_f32_16x16x32_bf16 v[88:91], a[164:167], v[220:223], v[88:91]
    v_max3_f32 v14, v14, v77, v78
    v_max_f32 v14, v14, v79
    v_mfma_f32_16x16x32_bf16 v[92:95], a[184:187], v[204:207], v[92:95]
    v_max3_f32 v15, v15, v83, v84
    v_max3_f32 v15, v15, v85, v86
    v_mfma_f32_16x16x32_bf16 v[92:95], a[188:191], v[220:223], v[92:95]
    v_mfma_f32_16x16x32_bf16 v[104:107], a[144:147], a[204:207], 0
    v_max3_f32 v15, v15, v87, v88
    v_max3_f32 v15, v15, v89, v90
    v_mfma_f32_16x16x32_bf16 v[104:107], a[148:151], a[208:211], v[104:107]
    v_mfma_f32_16x16x32_bf16 v[104:107], a[152:155], a[212:215], v[104:107]
    v_max3_f32 v15, v15, v91, v92
    v_max3_f32 v15, v15, v93, v94
    v_mfma_f32_16x16x32_bf16 v[104:107], a[156:159], a[216:219], v[104:107]
    v_max_f32 v15, v15, v95
    v_mfma_f32_16x16x32_bf16 v[104:107], a[160:163], a[220:223], v[104:107]
    buffer_store_dwordx2 v[176:177], v11, s[12:15], s36 offen offset:256 sc1
    v_mfma_f32_16x16x32_bf16 v[104:107], a[164:167], a[224:227], v[104:107]
    v_permlane16_swap_b32 v14, v15
    v_mfma_f32_16x16x32_bf16 v[108:111], a[168:171], a[204:207], 0
    v_max_f32 v14, v14, v15
    v_mov_b32 v15, v14
    v_mfma_f32_16x16x32_bf16 v[108:111], a[172:175], a[208:211], v[108:111]
    v_mfma_f32_16x16x32_bf16 v[108:111], a[176:179], a[212:215], v[108:111]
    v_cvt_pk_bf16_f32 v132, v104, v105
    v_cvt_pk_bf16_f32 v133, v106, v107
    v_mfma_f32_16x16x32_bf16 v[108:111], a[180:183], a[216:219], v[108:111]
    v_permlane32_swap_b32 v14, v15
    v_mfma_f32_16x16x32_bf16 v[108:111], a[184:187], a[220:223], v[108:111]
    ds_read_b128 a[192:195], v2 offset:20480
    v_max_f32 v14, v14, v15
    v_mfma_f32_16x16x32_bf16 v[108:111], a[188:191], a[224:227], v[108:111]
    s_waitcnt lgkmcnt(1)
    v_mov_b32 v15, v14
    v_mfma_f32_16x16x32_bf16 v[112:115], a[96:99], a[228:231], 0
    ds_read_b128 a[196:199], v2 offset:21504
    v_mfma_f32_16x16x32_bf16 v[112:115], a[100:103], a[232:235], v[112:115]
    v_permlane16_swap_b32 v14, v15
    v_mfma_f32_16x16x32_bf16 v[112:115], a[104:107], a[236:239], v[112:115]
    ds_read_b128 a[200:203], v2 offset:22528
    v_cvt_pk_bf16_f32 v134, v108, v109
    v_mfma_f32_16x16x32_bf16 v[112:115], a[108:111], a[240:243], v[112:115]
    buffer_store_dwordx2 v[178:179], v11, s[12:15], s36 offen offset:640 sc1
    v_mfma_f32_16x16x32_bf16 v[112:115], a[112:115], a[244:247], v[112:115]
    buffer_load_dwordx4 a[72:75], v9, s[8:11], s30 offen offset:0 nt
    v_cvt_pk_bf16_f32 v135, v110, v111
    v_mfma_f32_16x16x32_bf16 v[112:115], a[116:119], a[248:251], v[112:115]
    buffer_load_dwordx4 a[76:79], v10, s[8:11], s30 offen offset:0 nt
    v_sub_f32 v64, v64, v14
    v_mfma_f32_16x16x32_bf16 v[116:119], a[120:123], a[228:231], 0
    ds_read_b128 a[204:207], v2 offset:23552
    v_sub_f32 v65, v65, v14
    v_mfma_f32_16x16x32_bf16 v[116:119], a[124:127], a[232:235], v[116:119]
    ds_read_b128 a[208:211], v2 offset:24576
    v_sub_f32 v80, v80, v15
    v_mfma_f32_16x16x32_bf16 v[116:119], a[128:131], a[236:239], v[116:119]
    ds_read_b128 a[212:215], v2 offset:25600
    v_cvt_pk_bf16_f32 v136, v112, v113
    v_mfma_f32_16x16x32_bf16 v[116:119], a[132:135], a[240:243], v[116:119]
    v_cvt_pk_bf16_f32 v137, v114, v115
    v_sub_f32 v81, v81, v15
    v_mfma_f32_16x16x32_bf16 v[116:119], a[136:139], a[244:247], v[116:119]
    v_exp_f32 v64, v64
    v_mfma_f32_16x16x32_bf16 v[116:119], a[140:143], a[248:251], v[116:119]
    v_exp_f32 v65, v65
    v_mfma_f32_16x16x32_bf16 v[120:123], a[144:147], a[228:231], 0
    v_sub_f32 v66, v66, v14
    v_sub_f32 v82, v82, v15
    v_mfma_f32_16x16x32_bf16 v[120:123], a[148:151], a[232:235], v[120:123]
    v_exp_f32 v80, v80
    v_mfma_f32_16x16x32_bf16 v[120:123], a[152:155], a[236:239], v[120:123]
    v_cvt_pk_bf16_f32 v138, v116, v117
    v_cvt_pk_bf16_f32 v139, v118, v119
    v_mfma_f32_16x16x32_bf16 v[120:123], a[156:159], a[240:243], v[120:123]
    buffer_store_dwordx2 v[180:181], v11, s[12:15], s36 offen offset:1024 sc1
    v_mfma_f32_16x16x32_bf16 v[120:123], a[160:163], a[244:247], v[120:123]
    v_exp_f32 v81, v81
    v_mfma_f32_16x16x32_bf16 v[120:123], a[164:167], a[248:251], v[120:123]
    v_exp_f32 v66, v66
    v_mfma_f32_16x16x32_bf16 v[124:127], a[168:171], a[228:231], 0
    v_sub_f32 v67, v67, v14
    v_sub_f32 v83, v83, v15
    v_mfma_f32_16x16x32_bf16 v[124:127], a[172:175], a[232:235], v[124:127]
    v_exp_f32 v82, v82
    v_mfma_f32_16x16x32_bf16 v[124:127], a[176:179], a[236:239], v[124:127]
    v_cvt_pk_bf16_f32 v140, v120, v121
    v_cvt_pk_bf16_f32 v141, v122, v123
    v_mfma_f32_16x16x32_bf16 v[124:127], a[180:183], a[240:243], v[124:127]
    v_exp_f32 v67, v67
    v_mfma_f32_16x16x32_bf16 v[124:127], a[184:187], a[244:247], v[124:127]
    ds_read_b128 a[216:219], v2 offset:26624
    v_sub_f32 v68, v68, v14
    v_mfma_f32_16x16x32_bf16 v[124:127], a[188:191], a[248:251], v[124:127]
    s_waitcnt lgkmcnt(1)
    v_exp_f32 v83, v83
    v_mfma_f32_16x16x32_bf16 v[96:99], a[96:99], a[192:195], 0
    ds_read_b128 a[220:223], v2 offset:27648
    v_sub_f32 v84, v84, v15
    v_mfma_f32_16x16x32_bf16 v[96:99], a[100:103], a[196:199], v[96:99]
    v_add_f32 v22, v64, v65
    v_sub_f32 v69, v69, v14
    v_mfma_f32_16x16x32_bf16 v[96:99], a[104:107], a[200:203], v[96:99]
    ds_read_b128 a[224:227], v2 offset:28672
    v_cvt_pk_bf16_f32 v142, v124, v125
    v_mfma_f32_16x16x32_bf16 v[96:99], a[108:111], a[204:207], v[96:99]
    buffer_store_dwordx2 v[182:183], v11, s[12:15], s36 offen offset:1408 sc1
    v_mfma_f32_16x16x32_bf16 v[96:99], a[112:115], a[208:211], v[96:99]
    ds_read_b128 a[228:231], v2 offset:29696
    v_cvt_pk_bf16_f32 v143, v126, v127
    v_mfma_f32_16x16x32_bf16 v[96:99], a[116:119], a[212:215], v[96:99]
    v_exp_f32 v68, v68
    v_mfma_f32_16x16x32_bf16 v[100:103], a[120:123], a[192:195], 0
    ds_read_b128 a[232:235], v2 offset:30720
    v_add_f32 v23, v80, v81
    v_mfma_f32_16x16x32_bf16 v[100:103], a[124:127], a[196:199], v[100:103]
    v_exp_f32 v84, v84
    v_mfma_f32_16x16x32_bf16 v[100:103], a[128:131], a[200:203], v[100:103]
    ds_read_b128 a[236:239], v2 offset:31744
    v_cvt_pk_bf16_f32 v144, v96, v97
    v_mfma_f32_16x16x32_bf16 v[100:103], a[132:135], a[204:207], v[100:103]
    v_cvt_pk_bf16_f32 v145, v98, v99
    v_sub_f32 v85, v85, v15
    v_mfma_f32_16x16x32_bf16 v[100:103], a[136:139], a[208:211], v[100:103]
    v_add_f32 v22, v22, v66
    v_sub_f32 v70, v70, v14
    v_mfma_f32_16x16x32_bf16 v[100:103], a[140:143], a[212:215], v[100:103]
    v_exp_f32 v69, v69
    v_mfma_f32_16x16x32_bf16 v[104:107], a[144:147], a[192:195], 0
    v_add_f32 v23, v23, v82
    v_sub_f32 v86, v86, v15
    v_mfma_f32_16x16x32_bf16 v[104:107], a[148:151], a[196:199], v[104:107]
    v_exp_f32 v85, v85
    v_mfma_f32_16x16x32_bf16 v[104:107], a[152:155], a[200:203], v[104:107]
    buffer_store_dwordx2 v[184:185], v11, s[12:15], s38 offen offset:256 sc1
    v_mfma_f32_16x16x32_bf16 v[104:107], a[156:159], a[204:207], v[104:107]
    v_cvt_pk_bf16_f32 v146, v100, v101
    v_cvt_pk_bf16_f32 v147, v102, v103
    v_mfma_f32_16x16x32_bf16 v[104:107], a[160:163], a[208:211], v[104:107]
    v_add_f32 v22, v22, v67
    v_sub_f32 v71, v71, v14
    v_mfma_f32_16x16x32_bf16 v[104:107], a[164:167], a[212:215], v[104:107]
    v_exp_f32 v70, v70
    v_mfma_f32_16x16x32_bf16 v[108:111], a[168:171], a[192:195], 0
    v_add_f32 v23, v23, v83
    v_sub_f32 v87, v87, v15
    v_mfma_f32_16x16x32_bf16 v[108:111], a[172:175], a[196:199], v[108:111]
    v_exp_f32 v86, v86
    v_mfma_f32_16x16x32_bf16 v[108:111], a[176:179], a[200:203], v[108:111]
    v_cvt_pk_bf16_f32 v148, v104, v105
    v_cvt_pk_bf16_f32 v149, v106, v107
    v_mfma_f32_16x16x32_bf16 v[108:111], a[180:183], a[204:207], v[108:111]
    v_add_f32 v22, v22, v68
    v_sub_f32 v72, v72, v14
    v_mfma_f32_16x16x32_bf16 v[108:111], a[184:187], a[208:211], v[108:111]
    v_exp_f32 v71, v71
    v_mfma_f32_16x16x32_bf16 v[108:111], a[188:191], a[212:215], v[108:111]
    s_waitcnt lgkmcnt(0)
    v_add_f32 v23, v23, v84
    v_sub_f32 v88, v88, v15
    v_mfma_f32_16x16x32_bf16 v[112:115], a[96:99], a[216:219], 0
    v_exp_f32 v87, v87
    v_mfma_f32_16x16x32_bf16 v[112:115], a[100:103], a[220:223], v[112:115]
    v_add_f32 v22, v22, v69
    v_sub_f32 v73, v73, v14
    v_mfma_f32_16x16x32_bf16 v[112:115], a[104:107], a[224:227], v[112:115]
    buffer_store_dwordx2 v[186:187], v11, s[12:15], s38 offen offset:640 sc1
    v_mfma_f32_16x16x32_bf16 v[112:115], a[108:111], a[228:231], v[112:115]
    v_cvt_pk_bf16_f32 v150, v108, v109
    v_cvt_pk_bf16_f32 v151, v110, v111
    v_mfma_f32_16x16x32_bf16 v[112:115], a[112:115], a[232:235], v[112:115]
    v_exp_f32 v72, v72
    v_mfma_f32_16x16x32_bf16 v[112:115], a[116:119], a[236:239], v[112:115]
    v_add_f32 v23, v23, v85
    v_sub_f32 v89, v89, v15
    v_mfma_f32_16x16x32_bf16 v[116:119], a[120:123], a[216:219], 0
    v_exp_f32 v88, v88
    v_mfma_f32_16x16x32_bf16 v[116:119], a[124:127], a[220:223], v[116:119]
    v_add_f32 v22, v22, v70
    v_sub_f32 v74, v74, v14
    v_mfma_f32_16x16x32_bf16 v[116:119], a[128:131], a[224:227], v[116:119]
    v_cvt_pk_bf16_f32 v152, v112, v113
    v_cvt_pk_bf16_f32 v153, v114, v115
    v_mfma_f32_16x16x32_bf16 v[116:119], a[132:135], a[228:231], v[116:119]
    v_exp_f32 v73, v73
    v_mfma_f32_16x16x32_bf16 v[116:119], a[136:139], a[232:235], v[116:119]
    v_add_f32 v23, v23, v86
    v_sub_f32 v90, v90, v15
    v_mfma_f32_16x16x32_bf16 v[116:119], a[140:143], a[236:239], v[116:119]
    v_exp_f32 v89, v89
    v_mfma_f32_16x16x32_bf16 v[120:123], a[144:147], a[216:219], 0
    buffer_load_dwordx4 a[80:83], v9, s[8:11], s30 offen offset:128 nt
    v_add_f32 v22, v22, v71
    v_mfma_f32_16x16x32_bf16 v[120:123], a[148:151], a[220:223], v[120:123]
    buffer_load_dwordx4 a[84:87], v10, s[8:11], s30 offen offset:128 nt
    v_sub_f32 v75, v75, v14
    v_mfma_f32_16x16x32_bf16 v[120:123], a[152:155], a[224:227], v[120:123]
    buffer_store_dwordx2 v[188:189], v11, s[12:15], s38 offen offset:1024 sc1
    v_mfma_f32_16x16x32_bf16 v[120:123], a[156:159], a[228:231], v[120:123]
    ds_read_b128 a[240:243], v2 offset:32768
    v_cvt_pk_bf16_f32 v154, v116, v117
    v_mfma_f32_16x16x32_bf16 v[120:123], a[160:163], a[232:235], v[120:123]
    ds_read_b128 a[244:247], v2 offset:33792
    v_cvt_pk_bf16_f32 v155, v118, v119
    v_mfma_f32_16x16x32_bf16 v[120:123], a[164:167], a[236:239], v[120:123]
    v_exp_f32 v74, v74
    v_mfma_f32_16x16x32_bf16 v[124:127], a[168:171], a[216:219], 0
    ds_read_b128 a[248:251], v2 offset:34816
    v_add_f32 v23, v23, v87
    v_mfma_f32_16x16x32_bf16 v[124:127], a[172:175], a[220:223], v[124:127]
    v_exp_f32 v90, v90
    v_mfma_f32_16x16x32_bf16 v[124:127], a[176:179], a[224:227], v[124:127]
    ds_read_b128 a[192:195], v2 offset:35840
    v_cvt_pk_bf16_f32 v156, v120, v121
    v_mfma_f32_16x16x32_bf16 v[124:127], a[180:183], a[228:231], v[124:127]
    v_cvt_pk_bf16_f32 v157, v122, v123
    v_sub_f32 v91, v91, v15
    v_mfma_f32_16x16x32_bf16 v[124:127], a[184:187], a[232:235], v[124:127]
    ds_read_b128 a[196:199], v2 offset:36864
    v_add_f32 v22, v22, v72
    v_mfma_f32_16x16x32_bf16 v[124:127], a[188:191], a[236:239], v[124:127]
    v_exp_f32 v75, v75
    v_mfma_f32_16x16x32_bf16 v[192:195], v[32:35], v[128:131], 0
    ds_read_b128 a[200:203], v2 offset:37888
    v_sub_f32 v76, v76, v14
    v_mfma_f32_16x16x32_bf16 v[192:195], v[36:39], v[132:135], v[192:195]
    buffer_store_dwordx2 v[190:191], v11, s[12:15], s38 offen offset:1408 sc1
    v_mfma_f32_16x16x32_bf16 v[196:199], v[32:35], v[136:139], 0
    v_cvt_pk_bf16_f32 v158, v124, v125
    v_cvt_pk_bf16_f32 v159, v126, v127
    v_mfma_f32_16x16x32_bf16 v[196:199], v[36:39], v[140:143], v[196:199]
    v_add_f32 v23, v23, v88
    v_sub_f32 v92, v92, v15
    v_mfma_f32_16x16x32_bf16 v[200:203], v[32:35], v[144:147], 0
    v_exp_f32 v91, v91
    v_mfma_f32_16x16x32_bf16 v[200:203], v[36:39], v[148:151], v[200:203]
    v_add_f32 v22, v22, v73
    v_sub_f32 v77, v77, v14
    v_mfma_f32_16x16x32_bf16 v[204:207], v[32:35], v[152:155], 0
    v_cvt_pk_bf16_f32 v224, v192, v196
    v_cvt_pk_bf16_f32 v226, v193, v197
    v_mfma_f32_16x16x32_bf16 v[204:207], v[36:39], v[156:159], v[204:207]
    v_cvt_pk_bf16_f32 v228, v194, v198
    v_cvt_pk_bf16_f32 v230, v195, v199
    v_mfma_f32_16x16x32_bf16 v[208:211], v[40:43], v[128:131], 0
    v_exp_f32 v76, v76
    v_mfma_f32_16x16x32_bf16 v[208:211], v[44:47], v[132:135], v[208:211]
    v_add_f32 v23, v23, v89
    v_sub_f32 v93, v93, v15
    v_mfma_f32_16x16x32_bf16 v[212:215], v[40:43], v[136:139], 0
    v_cvt_pk_bf16_f32 v225, v200, v204
    v_cvt_pk_bf16_f32 v227, v201, v205
    v_mfma_f32_16x16x32_bf16 v[212:215], v[44:47], v[140:143], v[212:215]
    v_cvt_pk_bf16_f32 v229, v202, v206
    v_cvt_pk_bf16_f32 v231, v203, v207
    v_mfma_f32_16x16x32_bf16 v[216:219], v[40:43], v[144:147], 0
    v_exp_f32 v92, v92
    v_mfma_f32_16x16x32_bf16 v[216:219], v[44:47], v[148:151], v[216:219]
    v_add_f32 v22, v22, v74
    v_sub_f32 v78, v78, v14
    v_mfma_f32_16x16x32_bf16 v[220:223], v[40:43], v[152:155], 0
    ds_read_b128 a[204:207], v2 offset:38912
    v_add_f32 v23, v23, v90
    v_mfma_f32_16x16x32_bf16 v[220:223], v[44:47], v[156:159], v[220:223]
    s_waitcnt lgkmcnt(1)
    v_exp_f32 v77, v77
    v_mfma_f32_16x16x32_bf16 v[96:99], a[96:99], a[240:243], 0
    ds_read_b128 a[208:211], v2 offset:39936
    v_sub_f32 v94, v94, v15
    v_mfma_f32_16x16x32_bf16 v[96:99], a[100:103], a[244:247], v[96:99]
    v_exp_f32 v93, v93
    v_mfma_f32_16x16x32_bf16 v[96:99], a[104:107], a[248:251], v[96:99]
    ds_read_b128 a[212:215], v2 offset:40960
    v_add_f32 v22, v22, v75
    v_mfma_f32_16x16x32_bf16 v[96:99], a[108:111], a[192:195], v[96:99]
    v_exp_f32 v78, v78
    v_mfma_f32_16x16x32_bf16 v[96:99], a[112:115], a[196:199], v[96:99]
    ds_read_b128 a[216:219], v2 offset:41984
    v_sub_f32 v79, v79, v14
    v_mfma_f32_16x16x32_bf16 v[96:99], a[116:119], a[200:203], v[96:99]
    v_add_f32 v23, v23, v91
    v_sub_f32 v95, v95, v15
    v_mfma_f32_16x16x32_bf16 v[100:103], a[120:123], a[240:243], 0
    ds_read_b128 a[220:223], v2 offset:43008
    v_add_f32 v22, v22, v76
    v_mfma_f32_16x16x32_bf16 v[100:103], a[124:127], a[244:247], v[100:103]
    v_exp_f32 v94, v94
    v_mfma_f32_16x16x32_bf16 v[100:103], a[128:131], a[248:251], v[100:103]
    ds_read_b128 a[224:227], v2 offset:44032
    v_add_f32 v23, v23, v92
    v_mfma_f32_16x16x32_bf16 v[100:103], a[132:135], a[192:195], v[100:103]
    buffer_store_dwordx2 v[224:225], v11, s[12:15], s33 offen offset:0 sc1
    v_mfma_f32_16x16x32_bf16 v[100:103], a[136:139], a[196:199], v[100:103]
    v_exp_f32 v79, v79
    v_mfma_f32_16x16x32_bf16 v[100:103], a[140:143], a[200:203], v[100:103]
    v_exp_f32 v95, v95
    v_mfma_f32_16x16x32_bf16 v[104:107], a[144:147], a[240:243], 0
    v_add_f32 v22, v22, v77
    v_add_f32 v23, v23, v93
    v_mfma_f32_16x16x32_bf16 v[104:107], a[148:151], a[244:247], v[104:107]
    v_add_f32 v22, v22, v78
    v_add_f32 v23, v23, v94
    v_mfma_f32_16x16x32_bf16 v[104:107], a[152:155], a[248:251], v[104:107]
    v_add_f32 v22, v22, v79
    v_add_f32 v23, v23, v95
    v_mfma_f32_16x16x32_bf16 v[104:107], a[156:159], a[192:195], v[104:107]
    v_cvt_pk_bf16_f32 v232, v208, v212
    v_cvt_pk_bf16_f32 v233, v216, v220
    v_mfma_f32_16x16x32_bf16 v[104:107], a[160:163], a[196:199], v[104:107]
    buffer_store_dwordx2 v[226:227], v11, s[12:15], s33 offen offset:384 sc1
    v_mfma_f32_16x16x32_bf16 v[104:107], a[164:167], a[200:203], v[104:107]
    v_permlane16_swap_b32 v22, v23
    v_mfma_f32_16x16x32_bf16 v[108:111], a[168:171], a[240:243], 0
    v_add_f32 v22, v22, v23
    v_mov_b32 v23, v22
    v_mfma_f32_16x16x32_bf16 v[108:111], a[172:175], a[244:247], v[108:111]
    v_cvt_pk_bf16_f32 v234, v209, v213
    v_cvt_pk_bf16_f32 v235, v217, v221
    v_mfma_f32_16x16x32_bf16 v[108:111], a[176:179], a[248:251], v[108:111]
    v_permlane32_swap_b32 v22, v23
    v_mfma_f32_16x16x32_bf16 v[108:111], a[180:183], a[192:195], v[108:111]
    v_add_f32 v22, v22, v23
    v_cvt_pk_bf16_f32 v236, v210, v214
    v_mfma_f32_16x16x32_bf16 v[108:111], a[184:187], a[196:199], v[108:111]
    v_rcp_f32 v22, v22
    v_mfma_f32_16x16x32_bf16 v[108:111], a[188:191], a[200:203], v[108:111]
    s_waitcnt lgkmcnt(0)
    buffer_store_dwordx2 v[228:229], v11, s[12:15], s33 offen offset:768 sc1
    v_mfma_f32_16x16x32_bf16 v[112:115], a[96:99], a[204:207], 0
    v_mov_b32 v23, v22
    v_cvt_pk_bf16_f32 v237, v218, v222
    v_mfma_f32_16x16x32_bf16 v[112:115], a[100:103], a[208:211], v[112:115]
    v_permlane16_swap_b32 v22, v23
    v_mfma_f32_16x16x32_bf16 v[112:115], a[104:107], a[212:215], v[112:115]
    v_mul_f32 v64, v64, v22
    v_mul_f32 v65, v65, v22
    v_mfma_f32_16x16x32_bf16 v[112:115], a[108:111], a[216:219], v[112:115]
    v_mul_f32 v66, v66, v22
    v_mul_f32 v67, v67, v22
    v_mfma_f32_16x16x32_bf16 v[112:115], a[112:115], a[220:223], v[112:115]
    buffer_load_dwordx4 a[88:91], v9, s[8:11], s30 offen offset:256 nt
    v_mul_f32 v68, v68, v22
    v_mfma_f32_16x16x32_bf16 v[112:115], a[116:119], a[224:227], v[112:115]
    buffer_load_dwordx4 a[92:95], v10, s[8:11], s30 offen offset:256 nt
    v_mul_f32 v69, v69, v22
    v_mfma_f32_16x16x32_bf16 v[116:119], a[120:123], a[204:207], 0
    s_add_u32 s30, s16, 10616832
    buffer_store_dwordx2 v[230:231], v11, s[12:15], s33 offen offset:1152 sc1
    v_mfma_f32_16x16x32_bf16 v[116:119], a[124:127], a[208:211], v[116:119]
    s_add_u32 s16, s16, 6291456
    v_mul_f32 v70, v70, v22
    v_mul_f32 v71, v71, v22
    v_mfma_f32_16x16x32_bf16 v[116:119], a[128:131], a[212:215], v[116:119]
    s_add_u32 s32, s16, 0
    v_cvt_pk_bf16_f32 v48, v64, v65
    v_cvt_pk_bf16_f32 v49, v66, v67
    v_mfma_f32_16x16x32_bf16 v[116:119], a[132:135], a[216:219], v[116:119]
    s_add_u32 s34, s16, 393216
    v_cvt_pk_bf16_f32 v50, v68, v69
    v_cvt_pk_bf16_f32 v51, v70, v71
    v_mfma_f32_16x16x32_bf16 v[116:119], a[136:139], a[220:223], v[116:119]
    s_add_u32 s36, s16, 786432
    v_mul_f32 v72, v72, v22
    v_mul_f32 v73, v73, v22
    v_mfma_f32_16x16x32_bf16 v[116:119], a[140:143], a[224:227], v[116:119]
    s_add_u32 s38, s16, 1179648
    v_mul_f32 v74, v74, v22
    v_mul_f32 v75, v75, v22
    v_mfma_f32_16x16x32_bf16 v[120:123], a[144:147], a[204:207], 0
    v_mul_f32 v76, v76, v22
    v_mul_f32 v77, v77, v22
    v_mfma_f32_16x16x32_bf16 v[120:123], a[148:151], a[208:211], v[120:123]
    buffer_store_dwordx2 v[232:233], v11, s[12:15], s35 offen offset:0 sc1
    v_mfma_f32_16x16x32_bf16 v[120:123], a[152:155], a[212:215], v[120:123]
    ds_read_b128 a[228:231], v2 offset:45056
    v_mul_f32 v78, v78, v22
    v_mfma_f32_16x16x32_bf16 v[120:123], a[156:159], a[216:219], v[120:123]
    v_mul_f32 v79, v79, v22
    v_cvt_pk_bf16_f32 v52, v72, v73
    v_mfma_f32_16x16x32_bf16 v[120:123], a[160:163], a[220:223], v[120:123]
    ds_read_b128 a[232:235], v2 offset:46080
    v_cvt_pk_bf16_f32 v53, v74, v75
    v_mfma_f32_16x16x32_bf16 v[120:123], a[164:167], a[224:227], v[120:123]
    v_cvt_pk_bf16_f32 v54, v76, v77
    v_cvt_pk_bf16_f32 v55, v78, v79
    v_mfma_f32_16x16x32_bf16 v[124:127], a[168:171], a[204:207], 0
    ds_read_b128 a[236:239], v2 offset:47104
    v_mul_f32 v80, v80, v23
    v_mfma_f32_16x16x32_bf16 v[124:127], a[172:175], a[208:211], v[124:127]
    v_mul_f32 v81, v81, v23
    v_mul_f32 v82, v82, v23
    v_mfma_f32_16x16x32_bf16 v[124:127], a[176:179], a[212:215], v[124:127]
    buffer_store_dwordx2 v[234:235], v11, s[12:15], s35 offen offset:384 sc1
    v_mfma_f32_16x16x32_bf16 v[124:127], a[180:183], a[216:219], v[124:127]
    ds_read_b128 a[240:243], v2 offset:48128
    v_mul_f32 v83, v83, v23
    v_mfma_f32_16x16x32_bf16 v[124:127], a[184:187], a[220:223], v[124:127]
    ds_read_b128 a[244:247], v2 offset:49152
    v_mul_f32 v84, v84, v23
    v_mfma_f32_16x16x32_bf16 v[124:127], a[188:191], a[224:227], v[124:127]
    v_mul_f32 v85, v85, v23
    v_mul_f32 v86, v86, v23
    v_mfma_f32_16x16x32_bf16 v[64:67], v[48:51], v[128:131], 0
    ds_read_b128 a[248:251], v2 offset:50176
    v_mul_f32 v87, v87, v23
    v_mfma_f32_16x16x32_bf16 v[64:67], v[52:55], v[132:135], v[64:67]
    v_cvt_pk_bf16_f32 v56, v80, v81
    v_cvt_pk_bf16_f32 v57, v82, v83
    v_mfma_f32_16x16x32_bf16 v[68:71], v[48:51], v[136:139], 0
    v_cvt_pk_bf16_f32 v58, v84, v85
    v_cvt_pk_bf16_f32 v59, v86, v87
    v_mfma_f32_16x16x32_bf16 v[68:71], v[52:55], v[140:143], v[68:71]
    buffer_store_dwordx2 v[236:237], v11, s[12:15], s35 offen offset:768 sc1
    v_mfma_f32_16x16x32_bf16 v[72:75], v[48:51], v[144:147], 0
    v_mul_f32 v88, v88, v23
    v_mul_f32 v89, v89, v23
    v_mfma_f32_16x16x32_bf16 v[72:75], v[52:55], v[148:151], v[72:75]
    v_mul_f32 v90, v90, v23
    v_mul_f32 v91, v91, v23
    v_mfma_f32_16x16x32_bf16 v[76:79], v[48:51], v[152:155], 0
    v_mul_f32 v92, v92, v23
    v_mul_f32 v93, v93, v23
    v_mfma_f32_16x16x32_bf16 v[76:79], v[52:55], v[156:159], v[76:79]
    v_mul_f32 v94, v94, v23
    v_mul_f32 v95, v95, v23
    v_mfma_f32_16x16x32_bf16 v[80:83], v[56:59], v[128:131], 0
    v_cvt_pk_bf16_f32 v60, v88, v89
    v_cvt_pk_bf16_f32 v61, v90, v91
    v_cvt_pk_bf16_f32 v62, v92, v93
    v_cvt_pk_bf16_f32 v63, v94, v95
    s_nop 1
    v_mfma_f32_16x16x32_bf16 v[80:83], v[60:63], v[132:135], v[80:83]
    v_cvt_pk_bf16_f32 v238, v211, v215
    v_cvt_pk_bf16_f32 v239, v219, v223
    v_mfma_f32_16x16x32_bf16 v[84:87], v[56:59], v[136:139], 0
    buffer_store_dwordx2 v[238:239], v11, s[12:15], s35 offen offset:1152 sc1
    v_mfma_f32_16x16x32_bf16 v[84:87], v[60:63], v[140:143], v[84:87]
    v_cvt_pk_bf16_f32 v160, v96, v97
    v_cvt_pk_bf16_f32 v161, v98, v99
    v_mfma_f32_16x16x32_bf16 v[88:91], v[56:59], v[144:147], 0
    v_cvt_pk_bf16_f32 v162, v100, v101
    v_cvt_pk_bf16_f32 v163, v102, v103
    v_mfma_f32_16x16x32_bf16 v[88:91], v[60:63], v[148:151], v[88:91]
    v_cvt_pk_bf16_f32 v164, v104, v105
    v_cvt_pk_bf16_f32 v165, v106, v107
    v_mfma_f32_16x16x32_bf16 v[92:95], v[56:59], v[152:155], 0
    ds_read_b128 a[192:195], v2 offset:51200
    v_cvt_pk_bf16_f32 v240, v64, v68
    v_mfma_f32_16x16x32_bf16 v[92:95], v[60:63], v[156:159], v[92:95]
    s_waitcnt lgkmcnt(1)
    v_cvt_pk_bf16_f32 v241, v72, v76
    v_cvt_pk_bf16_f32 v166, v108, v109
    v_mfma_f32_16x16x32_bf16 v[96:99], a[96:99], a[228:231], 0
    ds_read_b128 a[196:199], v2 offset:52224
    v_cvt_pk_bf16_f32 v167, v110, v111
    v_mfma_f32_16x16x32_bf16 v[96:99], a[100:103], a[232:235], v[96:99]
    v_cvt_pk_bf16_f32 v242, v65, v69
    v_cvt_pk_bf16_f32 v243, v73, v77
    v_mfma_f32_16x16x32_bf16 v[96:99], a[104:107], a[236:239], v[96:99]
    ds_read_b128 a[200:203], v2 offset:53248
    v_cvt_pk_bf16_f32 v168, v112, v113
    v_mfma_f32_16x16x32_bf16 v[96:99], a[108:111], a[240:243], v[96:99]
    v_cvt_pk_bf16_f32 v169, v114, v115
    v_cvt_pk_bf16_f32 v170, v116, v117
    v_mfma_f32_16x16x32_bf16 v[96:99], a[112:115], a[244:247], v[96:99]
    ds_read_b128 a[204:207], v2 offset:54272
    v_cvt_pk_bf16_f32 v171, v118, v119
    v_mfma_f32_16x16x32_bf16 v[96:99], a[116:119], a[248:251], v[96:99]
    v_cvt_pk_bf16_f32 v244, v66, v70
    v_cvt_pk_bf16_f32 v245, v74, v78
    v_mfma_f32_16x16x32_bf16 v[100:103], a[120:123], a[228:231], 0
    ds_read_b128 a[208:211], v2 offset:55296
    v_cvt_pk_bf16_f32 v172, v120, v121
    v_mfma_f32_16x16x32_bf16 v[100:103], a[124:127], a[232:235], v[100:103]
    v_cvt_pk_bf16_f32 v173, v122, v123
    v_cvt_pk_bf16_f32 v246, v67, v71
    v_mfma_f32_16x16x32_bf16 v[100:103], a[128:131], a[236:239], v[100:103]
    buffer_store_dwordx2 v[240:241], v11, s[12:15], s37 offen offset:0 sc1
    v_mfma_f32_16x16x32_bf16 v[100:103], a[132:135], a[240:243], v[100:103]
    ds_read_b128 a[212:215], v2 offset:56320
    v_cvt_pk_bf16_f32 v247, v75, v79
    v_mfma_f32_16x16x32_bf16 v[100:103], a[136:139], a[244:247], v[100:103]
    s_waitcnt vmcnt(60)
    ds_write_b32 v16, a24 offset:0
    v_mfma_f32_16x16x32_bf16 v[100:103], a[140:143], a[248:251], v[100:103]
    ds_write_b32 v16, a25 offset:4
    v_mfma_f32_16x16x32_bf16 v[104:107], a[144:147], a[228:231], 0
    ds_write_b32 v16, a26 offset:1024
    v_mfma_f32_16x16x32_bf16 v[104:107], a[148:151], a[232:235], v[104:107]
    ds_write_b32 v16, a27 offset:1028
    v_mfma_f32_16x16x32_bf16 v[104:107], a[152:155], a[236:239], v[104:107]
    ds_write_b32 v16, a28 offset:512
    v_mfma_f32_16x16x32_bf16 v[104:107], a[156:159], a[240:243], v[104:107]
    ds_write_b32 v16, a29 offset:516
    v_mfma_f32_16x16x32_bf16 v[104:107], a[160:163], a[244:247], v[104:107]
    buffer_store_dwordx2 v[242:243], v11, s[12:15], s37 offen offset:384 sc1
    v_mfma_f32_16x16x32_bf16 v[104:107], a[164:167], a[248:251], v[104:107]
    ds_write_b32 v16, a30 offset:1536
    v_mfma_f32_16x16x32_bf16 v[108:111], a[168:171], a[228:231], 0
    ds_write_b32 v16, a31 offset:1540
    v_mfma_f32_16x16x32_bf16 v[108:111], a[172:175], a[232:235], v[108:111]
    ds_read2_b64 a[24:27], v17 offset0:0 offset1:128
    v_cvt_pk_bf16_f32 v174, v124, v125
    v_mfma_f32_16x16x32_bf16 v[108:111], a[176:179], a[236:239], v[108:111]
    ds_read2_b64 a[28:31], v18 offset0:0 offset1:128
    v_cvt_pk_bf16_f32 v175, v126, v127
    v_mfma_f32_16x16x32_bf16 v[108:111], a[180:183], a[240:243], v[108:111]
    v_cvt_pk_bf16_f32 v248, v80, v84
    v_cvt_pk_bf16_f32 v249, v88, v92
    v_mfma_f32_16x16x32_bf16 v[108:111], a[184:187], a[244:247], v[108:111]
    v_cvt_pk_bf16_f32 v176, v96, v97
    v_cvt_pk_bf16_f32 v177, v98, v99
    v_mfma_f32_16x16x32_bf16 v[108:111], a[188:191], a[248:251], v[108:111]
    s_waitcnt lgkmcnt(9)
    v_cvt_pk_bf16_f32 v178, v100, v101
    v_cvt_pk_bf16_f32 v179, v102, v103
    v_mfma_f32_16x16x32_bf16 v[112:115], a[96:99], a[192:195], 0
    buffer_store_dwordx2 v[244:245], v11, s[12:15], s37 offen offset:768 sc1
    v_mfma_f32_16x16x32_bf16 v[112:115], a[100:103], a[196:199], v[112:115]
    v_cvt_pk_bf16_f32 v180, v104, v105
    v_cvt_pk_bf16_f32 v181, v106, v107
    v_mfma_f32_16x16x32_bf16 v[112:115], a[104:107], a[200:203], v[112:115]
    v_cvt_pk_bf16_f32 v182, v108, v109
    v_cvt_pk_bf16_f32 v183, v110, v111
    v_mfma_f32_16x16x32_bf16 v[112:115], a[108:111], a[204:207], v[112:115]
    v_cvt_pk_bf16_f32 v250, v81, v85
    v_cvt_pk_bf16_f32 v251, v89, v93
    v_mfma_f32_16x16x32_bf16 v[112:115], a[112:115], a[208:211], v[112:115]
    v_cvt_pk_bf16_f32 v252, v82, v86
    v_cvt_pk_bf16_f32 v254, v83, v87
    v_mfma_f32_16x16x32_bf16 v[112:115], a[116:119], a[212:215], v[112:115]
    v_cvt_pk_bf16_f32 v253, v90, v94
    v_cvt_pk_bf16_f32 v255, v91, v95
    v_mfma_f32_16x16x32_bf16 v[116:119], a[120:123], a[192:195], 0
    s_waitcnt vmcnt(55)
    ds_write_b32 v16, a32 offset:0
    v_mfma_f32_16x16x32_bf16 v[116:119], a[124:127], a[196:199], v[116:119]
    ds_write_b32 v16, a33 offset:4
    v_mfma_f32_16x16x32_bf16 v[116:119], a[128:131], a[200:203], v[116:119]
    buffer_store_dwordx2 v[246:247], v11, s[12:15], s37 offen offset:1152 sc1
    v_mfma_f32_16x16x32_bf16 v[116:119], a[132:135], a[204:207], v[116:119]
    ds_write_b32 v16, a34 offset:1024
    v_mfma_f32_16x16x32_bf16 v[116:119], a[136:139], a[208:211], v[116:119]
    ds_write_b32 v16, a35 offset:1028
    v_mfma_f32_16x16x32_bf16 v[116:119], a[140:143], a[212:215], v[116:119]
    ds_write_b32 v16, a36 offset:512
    v_mfma_f32_16x16x32_bf16 v[120:123], a[144:147], a[192:195], 0
    ds_write_b32 v16, a37 offset:516
    v_mfma_f32_16x16x32_bf16 v[120:123], a[148:151], a[196:199], v[120:123]
    ds_write_b32 v16, a38 offset:1536
    v_mfma_f32_16x16x32_bf16 v[120:123], a[152:155], a[200:203], v[120:123]
    ds_write_b32 v16, a39 offset:1540
    v_mfma_f32_16x16x32_bf16 v[120:123], a[156:159], a[204:207], v[120:123]
    ds_read2_b64 a[32:35], v17 offset0:0 offset1:128
    v_cvt_pk_bf16_f32 v184, v112, v113
    v_mfma_f32_16x16x32_bf16 v[120:123], a[160:163], a[208:211], v[120:123]
    buffer_store_dwordx2 v[248:249], v11, s[12:15], s39 offen offset:0 sc1
    v_mfma_f32_16x16x32_bf16 v[120:123], a[164:167], a[212:215], v[120:123]
    ds_read2_b64 a[36:39], v18 offset0:0 offset1:128
    v_cvt_pk_bf16_f32 v185, v114, v115
    v_mfma_f32_16x16x32_bf16 v[124:127], a[168:171], a[192:195], 0
    v_cvt_pk_bf16_f32 v186, v116, v117
    v_cvt_pk_bf16_f32 v187, v118, v119
    v_mfma_f32_16x16x32_bf16 v[124:127], a[172:175], a[196:199], v[124:127]
    v_mfma_f32_16x16x32_bf16 v[124:127], a[176:179], a[200:203], v[124:127]
    v_cvt_pk_bf16_f32 v188, v120, v121
    v_cvt_pk_bf16_f32 v189, v122, v123
    v_mfma_f32_16x16x32_bf16 v[124:127], a[180:183], a[204:207], v[124:127]
    v_mfma_f32_16x16x32_bf16 v[124:127], a[184:187], a[208:211], v[124:127]
    v_mfma_f32_16x16x32_bf16 v[124:127], a[188:191], a[212:215], v[124:127]
    v_mfma_f32_16x16x32_bf16 v[64:67], v[32:35], v[160:163], 0
    buffer_store_dwordx2 v[250:251], v11, s[12:15], s39 offen offset:384 sc1
    v_mfma_f32_16x16x32_bf16 v[64:67], v[36:39], v[164:167], v[64:67]
    v_mfma_f32_16x16x32_bf16 v[68:71], v[32:35], v[168:171], 0
    s_waitcnt vmcnt(52)
    ds_write_b32 v16, a40 offset:0
    v_mfma_f32_16x16x32_bf16 v[68:71], v[36:39], v[172:175], v[68:71]
    ds_write_b32 v16, a41 offset:4
    v_mfma_f32_16x16x32_bf16 v[72:75], v[32:35], v[176:179], 0
    ds_write_b32 v16, a42 offset:1024
    v_mfma_f32_16x16x32_bf16 v[72:75], v[36:39], v[180:183], v[72:75]
    ds_write_b32 v16, a43 offset:1028
    v_mfma_f32_16x16x32_bf16 v[76:79], v[32:35], v[184:187], 0
    ds_read_b128 a[216:219], v2 offset:57344
    v_cvt_pk_bf16_f32 v190, v124, v125
    v_cvt_pk_bf16_f32 v191, v126, v127
    s_nop 1
    v_mfma_f32_16x16x32_bf16 v[76:79], v[36:39], v[188:191], v[76:79]
    ds_write_b32 v16, a44 offset:512
    v_mfma_f32_16x16x32_bf16 v[80:83], v[40:43], v[160:163], 0
    buffer_store_dwordx2 v[252:253], v11, s[12:15], s39 offen offset:768 sc1
    v_mfma_f32_16x16x32_bf16 v[80:83], v[44:47], v[164:167], v[80:83]
    ds_read_b128 a[220:223], v2 offset:58368
    v_cvt_pk_bf16_f32 v128, v64, v68
    v_mfma_f32_16x16x32_bf16 v[84:87], v[40:43], v[168:171], 0
    ds_read_b128 a[224:227], v2 offset:59392
    v_cvt_pk_bf16_f32 v129, v72, v76
    v_mfma_f32_16x16x32_bf16 v[84:87], v[44:47], v[172:175], v[84:87]
    ds_write_b32 v16, a45 offset:516
    v_mfma_f32_16x16x32_bf16 v[88:91], v[40:43], v[176:179], 0
    ds_read_b128 a[228:231], v2 offset:60416
    v_cvt_pk_bf16_f32 v130, v65, v69
    v_mfma_f32_16x16x32_bf16 v[88:91], v[44:47], v[180:183], v[88:91]
    ds_write_b32 v16, a46 offset:1536
    v_mfma_f32_16x16x32_bf16 v[92:95], v[40:43], v[184:187], 0
    ds_read_b128 a[232:235], v2 offset:61440
    v_cvt_pk_bf16_f32 v131, v73, v77
    v_mfma_f32_16x16x32_bf16 v[92:95], v[44:47], v[188:191], v[92:95]
    ds_write_b32 v16, a47 offset:1540
    v_mfma_f32_16x16x32_bf16 v[192:195], v[48:51], v[160:163], 0
    buffer_store_dwordx2 v[254:255], v11, s[12:15], s39 offen offset:1152 sc1
    v_mfma_f32_16x16x32_bf16 v[192:195], v[52:55], v[164:167], v[192:195]
    ds_read_b128 a[236:239], v2 offset:62464
    v_cvt_pk_bf16_f32 v132, v66, v70
    v_mfma_f32_16x16x32_bf16 v[196:199], v[48:51], v[168:171], 0
    ds_read2_b64 a[40:43], v17 offset0:0 offset1:128
    v_cvt_pk_bf16_f32 v133, v74, v78
    v_mfma_f32_16x16x32_bf16 v[196:199], v[52:55], v[172:175], v[196:199]
    ds_read2_b64 a[44:47], v18 offset0:0 offset1:128
    v_cvt_pk_bf16_f32 v134, v67, v71
    v_mfma_f32_16x16x32_bf16 v[200:203], v[48:51], v[176:179], 0
    v_cvt_pk_bf16_f32 v135, v75, v79
    v_cvt_pk_bf16_f32 v136, v80, v84
    v_mfma_f32_16x16x32_bf16 v[200:203], v[52:55], v[180:183], v[200:203]
    v_cvt_pk_bf16_f32 v137, v88, v92
    v_cvt_pk_bf16_f32 v138, v81, v85
    v_mfma_f32_16x16x32_bf16 v[204:207], v[48:51], v[184:187], 0
    s_waitcnt vmcnt(47)
    ds_write_b32 v16, a48 offset:0
    v_mfma_f32_16x16x32_bf16 v[204:207], v[52:55], v[188:191], v[204:207]
    ds_write_b32 v16, a49 offset:4
    v_mfma_f32_16x16x32_bf16 v[208:211], v[56:59], v[160:163], 0
    ds_write_b32 v16, a50 offset:1024
    v_mfma_f32_16x16x32_bf16 v[208:211], v[60:63], v[164:167], v[208:211]
    ds_write_b32 v16, a51 offset:1028
    v_mfma_f32_16x16x32_bf16 v[212:215], v[56:59], v[168:171], 0
    ds_write_b32 v16, a52 offset:512
    v_mfma_f32_16x16x32_bf16 v[212:215], v[60:63], v[172:175], v[212:215]
    ds_write_b32 v16, a53 offset:516
    v_mfma_f32_16x16x32_bf16 v[216:219], v[56:59], v[176:179], 0
    ds_write_b32 v16, a54 offset:1536
    v_mfma_f32_16x16x32_bf16 v[216:219], v[60:63], v[180:183], v[216:219]
    ds_write_b32 v16, a55 offset:1540
    v_mfma_f32_16x16x32_bf16 v[220:223], v[56:59], v[184:187], 0
    ds_read_b128 a[240:243], v2 offset:63488
    v_cvt_pk_bf16_f32 v139, v89, v93
    v_mfma_f32_16x16x32_bf16 v[220:223], v[60:63], v[188:191], v[220:223]
    s_waitcnt lgkmcnt(11)
    ds_read2_b64 a[48:51], v17 offset0:0 offset1:128
    v_cvt_pk_bf16_f32 v140, v82, v86
    v_mfma_f32_16x16x32_bf16 v[96:99], a[96:99], a[216:219], 0
    ds_read_b128 a[244:247], v2 offset:64512
    v_cvt_pk_bf16_f32 v141, v90, v94
    v_mfma_f32_16x16x32_bf16 v[96:99], a[100:103], a[220:223], v[96:99]
    ds_read2_b64 a[52:55], v18 offset0:0 offset1:128
    v_cvt_pk_bf16_f32 v144, v192, v196
    v_mfma_f32_16x16x32_bf16 v[96:99], a[104:107], a[224:227], v[96:99]
    ds_read_b128 a[248:251], v3 offset:0
    v_cvt_pk_bf16_f32 v146, v193, v197
    v_mfma_f32_16x16x32_bf16 v[96:99], a[108:111], a[228:231], v[96:99]
    v_cvt_pk_bf16_f32 v142, v83, v87
    v_cvt_pk_bf16_f32 v143, v91, v95
    v_mfma_f32_16x16x32_bf16 v[96:99], a[112:115], a[232:235], v[96:99]
    ds_read_b128 a[192:195], v3 offset:1024
    v_cvt_pk_bf16_f32 v148, v194, v198
    v_mfma_f32_16x16x32_bf16 v[96:99], a[116:119], a[236:239], v[96:99]
    v_cvt_pk_bf16_f32 v150, v195, v199
    v_cvt_pk_bf16_f32 v145, v200, v204
    v_mfma_f32_16x16x32_bf16 v[100:103], a[120:123], a[216:219], 0
    ds_read_b128 a[196:199], v3 offset:2048
    v_cvt_pk_bf16_f32 v147, v201, v205
    v_mfma_f32_16x16x32_bf16 v[100:103], a[124:127], a[220:223], v[100:103]
    v_cvt_pk_bf16_f32 v149, v202, v206
    v_cvt_pk_bf16_f32 v151, v203, v207
    v_mfma_f32_16x16x32_bf16 v[100:103], a[128:131], a[224:227], v[100:103]
    ds_read_b128 a[200:203], v3 offset:3072
    v_cvt_pk_bf16_f32 v192, v96, v97
    v_mfma_f32_16x16x32_bf16 v[100:103], a[132:135], a[228:231], v[100:103]
    v_cvt_pk_bf16_f32 v193, v98, v99
    v_cvt_pk_bf16_f32 v152, v208, v212
    v_mfma_f32_16x16x32_bf16 v[100:103], a[136:139], a[232:235], v[100:103]
    buffer_store_dwordx2 v[128:129], v11, s[12:15], s33 offen offset:128 sc1
    v_mfma_f32_16x16x32_bf16 v[100:103], a[140:143], a[236:239], v[100:103]
    s_waitcnt vmcnt(41)
    ds_write_b32 v16, a56 offset:0
    v_mfma_f32_16x16x32_bf16 v[104:107], a[144:147], a[216:219], 0
    ds_write_b32 v16, a57 offset:4
    v_mfma_f32_16x16x32_bf16 v[104:107], a[148:151], a[220:223], v[104:107]
    ds_write_b32 v16, a58 offset:1024
    v_mfma_f32_16x16x32_bf16 v[104:107], a[152:155], a[224:227], v[104:107]
    ds_write_b32 v16, a59 offset:1028
    v_mfma_f32_16x16x32_bf16 v[104:107], a[156:159], a[228:231], v[104:107]
    buffer_store_dwordx2 v[130:131], v11, s[12:15], s33 offen offset:512 sc1
    v_mfma_f32_16x16x32_bf16 v[104:107], a[160:163], a[232:235], v[104:107]
    ds_write_b32 v16, a60 offset:512
    v_mfma_f32_16x16x32_bf16 v[104:107], a[164:167], a[236:239], v[104:107]
    ds_write_b32 v16, a61 offset:516
    v_mfma_f32_16x16x32_bf16 v[108:111], a[168:171], a[216:219], 0
    ds_write_b32 v16, a62 offset:1536
    v_mfma_f32_16x16x32_bf16 v[108:111], a[172:175], a[220:223], v[108:111]
    ds_write_b32 v16, a63 offset:1540
    v_mfma_f32_16x16x32_bf16 v[108:111], a[176:179], a[224:227], v[108:111]
    buffer_store_dwordx2 v[132:133], v11, s[12:15], s33 offen offset:896 sc1
    v_mfma_f32_16x16x32_bf16 v[108:111], a[180:183], a[228:231], v[108:111]
    ds_read2_b64 a[56:59], v17 offset0:0 offset1:128
    v_cvt_pk_bf16_f32 v194, v100, v101
    v_mfma_f32_16x16x32_bf16 v[108:111], a[184:187], a[232:235], v[108:111]
    ds_read_b128 a[204:207], v3 offset:4096
    v_cvt_pk_bf16_f32 v195, v102, v103
    v_mfma_f32_16x16x32_bf16 v[108:111], a[188:191], a[236:239], v[108:111]
    s_waitcnt lgkmcnt(10)
    ds_read2_b64 a[60:63], v18 offset0:0 offset1:128
    v_cvt_pk_bf16_f32 v196, v104, v105
    v_mfma_f32_16x16x32_bf16 v[112:115], a[96:99], a[240:243], 0
    ds_read_b128 a[208:211], v3 offset:5120
    v_cvt_pk_bf16_f32 v197, v106, v107
    v_mfma_f32_16x16x32_bf16 v[112:115], a[100:103], a[244:247], v[112:115]
    buffer_store_dwordx2 v[134:135], v11, s[12:15], s33 offen offset:1280 sc1
    v_mfma_f32_16x16x32_bf16 v[112:115], a[104:107], a[248:251], v[112:115]
    ds_read_b128 a[212:215], v3 offset:6144
    v_cvt_pk_bf16_f32 v198, v108, v109
    v_mfma_f32_16x16x32_bf16 v[112:115], a[108:111], a[192:195], v[112:115]
    v_cvt_pk_bf16_f32 v199, v110, v111
    v_cvt_pk_bf16_f32 v153, v216, v220
    v_mfma_f32_16x16x32_bf16 v[112:115], a[112:115], a[196:199], v[112:115]
    ds_read_b128 a[216:219], v3 offset:7168
    v_cvt_pk_bf16_f32 v154, v209, v213
    v_mfma_f32_16x16x32_bf16 v[112:115], a[116:119], a[200:203], v[112:115]
    v_cvt_pk_bf16_f32 v155, v217, v221
    v_cvt_pk_bf16_f32 v156, v210, v214
    v_mfma_f32_16x16x32_bf16 v[116:119], a[120:123], a[240:243], 0
    buffer_store_dwordx2 v[136:137], v11, s[12:15], s35 offen offset:128 sc1
    v_mfma_f32_16x16x32_bf16 v[116:119], a[124:127], a[244:247], v[116:119]
    ds_read_b128 a[220:223], v3 offset:8192
    v_cvt_pk_bf16_f32 v157, v218, v222
    v_mfma_f32_16x16x32_bf16 v[116:119], a[128:131], a[248:251], v[116:119]
    ds_read_b128 a[224:227], v3 offset:9216
    v_cvt_pk_bf16_f32 v200, v112, v113
    v_mfma_f32_16x16x32_bf16 v[116:119], a[132:135], a[192:195], v[116:119]
    s_waitcnt vmcnt(38)
    ds_write_b32 v16, a64 offset:0
    v_mfma_f32_16x16x32_bf16 v[116:119], a[136:139], a[196:199], v[116:119]
    ds_write_b32 v16, a65 offset:4
    v_mfma_f32_16x16x32_bf16 v[116:119], a[140:143], a[200:203], v[116:119]
    buffer_store_dwordx2 v[138:139], v11, s[12:15], s35 offen offset:512 sc1
    v_mfma_f32_16x16x32_bf16 v[120:123], a[144:147], a[240:243], 0
    ds_write_b32 v16, a66 offset:1024
    v_mfma_f32_16x16x32_bf16 v[120:123], a[148:151], a[244:247], v[120:123]
    ds_write_b32 v16, a67 offset:1028
    v_mfma_f32_16x16x32_bf16 v[120:123], a[152:155], a[248:251], v[120:123]
    ds_write_b32 v16, a68 offset:512
    v_mfma_f32_16x16x32_bf16 v[120:123], a[156:159], a[192:195], v[120:123]
    ds_write_b32 v16, a69 offset:516
    v_mfma_f32_16x16x32_bf16 v[120:123], a[160:163], a[196:199], v[120:123]
    buffer_store_dwordx2 v[140:141], v11, s[12:15], s35 offen offset:896 sc1
    v_mfma_f32_16x16x32_bf16 v[120:123], a[164:167], a[200:203], v[120:123]
    ds_write_b32 v16, a70 offset:1536
    v_mfma_f32_16x16x32_bf16 v[124:127], a[168:171], a[240:243], 0
    ds_write_b32 v16, a71 offset:1540
    v_mfma_f32_16x16x32_bf16 v[124:127], a[172:175], a[244:247], v[124:127]
    ds_read2_b64 a[64:67], v17 offset0:0 offset1:128
    v_cvt_pk_bf16_f32 v201, v114, v115
    v_mfma_f32_16x16x32_bf16 v[124:127], a[176:179], a[248:251], v[124:127]
    ds_read2_b64 a[68:71], v18 offset0:0 offset1:128
    v_cvt_pk_bf16_f32 v202, v116, v117
    v_mfma_f32_16x16x32_bf16 v[124:127], a[180:183], a[192:195], v[124:127]
    buffer_store_dwordx2 v[142:143], v11, s[12:15], s35 offen offset:1280 sc1
    v_mfma_f32_16x16x32_bf16 v[124:127], a[184:187], a[196:199], v[124:127]
    ds_read_b128 a[228:231], v3 offset:10240
    v_cvt_pk_bf16_f32 v203, v118, v119
    v_mfma_f32_16x16x32_bf16 v[124:127], a[188:191], a[200:203], v[124:127]
    s_waitcnt lgkmcnt(9)
    v_cvt_pk_bf16_f32 v204, v120, v121
    v_cvt_pk_bf16_f32 v205, v122, v123
    v_mfma_f32_16x16x32_bf16 v[96:99], a[96:99], a[204:207], 0
    ds_read_b128 a[232:235], v3 offset:11264
    v_cvt_pk_bf16_f32 v158, v211, v215
    v_mfma_f32_16x16x32_bf16 v[96:99], a[100:103], a[208:211], v[96:99]
    v_cvt_pk_bf16_f32 v159, v219, v223
    v_mfma_f32_16x16x32_bf16 v[96:99], a[104:107], a[212:215], v[96:99]
    buffer_store_dwordx2 v[144:145], v11, s[12:15], s37 offen offset:128 sc1
    v_mfma_f32_16x16x32_bf16 v[96:99], a[108:111], a[216:219], v[96:99]
    ds_read_b128 a[236:239], v3 offset:12288
    v_cvt_pk_bf16_f32 v206, v124, v125
    v_mfma_f32_16x16x32_bf16 v[96:99], a[112:115], a[220:223], v[96:99]
    ds_read_b128 a[240:243], v3 offset:13312
    v_cvt_pk_bf16_f32 v207, v126, v127
    v_mfma_f32_16x16x32_bf16 v[96:99], a[116:119], a[224:227], v[96:99]
    s_waitcnt vmcnt(35)
    ds_write_b32 v16, a72 offset:0
    v_mfma_f32_16x16x32_bf16 v[100:103], a[120:123], a[204:207], 0
    ds_read_b128 a[244:247], v3 offset:14336
    v_mfma_f32_16x16x32_bf16 v[100:103], a[124:127], a[208:211], v[100:103]
    buffer_store_dwordx2 v[146:147], v11, s[12:15], s37 offen offset:512 sc1
    v_mfma_f32_16x16x32_bf16 v[100:103], a[128:131], a[212:215], v[100:103]
    ds_read_b128 a[248:251], v3 offset:15360
    v_cvt_pk_bf16_f32 v208, v96, v97
    v_mfma_f32_16x16x32_bf16 v[100:103], a[132:135], a[216:219], v[100:103]
    ds_write_b32 v16, a73 offset:4
    v_mfma_f32_16x16x32_bf16 v[100:103], a[136:139], a[220:223], v[100:103]
    ds_write_b32 v16, a74 offset:1024
    v_mfma_f32_16x16x32_bf16 v[100:103], a[140:143], a[224:227], v[100:103]
    ds_write_b32 v16, a75 offset:1028
    v_mfma_f32_16x16x32_bf16 v[104:107], a[144:147], a[204:207], 0
    buffer_store_dwordx2 v[148:149], v11, s[12:15], s37 offen offset:896 sc1
    v_mfma_f32_16x16x32_bf16 v[104:107], a[148:151], a[208:211], v[104:107]
    ds_write_b32 v16, a76 offset:512
    v_mfma_f32_16x16x32_bf16 v[104:107], a[152:155], a[212:215], v[104:107]
    ds_write_b32 v16, a77 offset:516
    v_mfma_f32_16x16x32_bf16 v[104:107], a[156:159], a[216:219], v[104:107]
    ds_write_b32 v16, a78 offset:1536
    v_mfma_f32_16x16x32_bf16 v[104:107], a[160:163], a[220:223], v[104:107]
    ds_write_b32 v16, a79 offset:1540
    v_mfma_f32_16x16x32_bf16 v[104:107], a[164:167], a[224:227], v[104:107]
    buffer_store_dwordx2 v[150:151], v11, s[12:15], s37 offen offset:1280 sc1
    v_mfma_f32_16x16x32_bf16 v[108:111], a[168:171], a[204:207], 0
    ds_read2_b64 a[72:75], v17 offset0:0 offset1:128
    v_cvt_pk_bf16_f32 v209, v98, v99
    v_mfma_f32_16x16x32_bf16 v[108:111], a[172:175], a[208:211], v[108:111]
    ds_read2_b64 a[76:79], v18 offset0:0 offset1:128
    v_cvt_pk_bf16_f32 v210, v100, v101
    v_mfma_f32_16x16x32_bf16 v[108:111], a[176:179], a[212:215], v[108:111]
    v_cvt_pk_bf16_f32 v211, v102, v103
    v_cvt_pk_bf16_f32 v212, v104, v105
    v_mfma_f32_16x16x32_bf16 v[108:111], a[180:183], a[216:219], v[108:111]
    v_cvt_pk_bf16_f32 v213, v106, v107
    v_mfma_f32_16x16x32_bf16 v[108:111], a[184:187], a[220:223], v[108:111]
    buffer_store_dwordx2 v[152:153], v11, s[12:15], s39 offen offset:128 sc1
    v_mfma_f32_16x16x32_bf16 v[108:111], a[188:191], a[224:227], v[108:111]
    s_waitcnt vmcnt(33) lgkmcnt(7)
    ds_write_b32 v16, a80 offset:0
    v_mfma_f32_16x16x32_bf16 v[112:115], a[96:99], a[228:231], 0
    ds_write_b32 v16, a81 offset:4
    v_mfma_f32_16x16x32_bf16 v[112:115], a[100:103], a[232:235], v[112:115]
    ds_write_b32 v16, a82 offset:1024
    v_mfma_f32_16x16x32_bf16 v[112:115], a[104:107], a[236:239], v[112:115]
    ds_write_b32 v16, a83 offset:1028
    v_mfma_f32_16x16x32_bf16 v[112:115], a[108:111], a[240:243], v[112:115]
    buffer_store_dwordx2 v[154:155], v11, s[12:15], s39 offen offset:512 sc1
    v_mfma_f32_16x16x32_bf16 v[112:115], a[112:115], a[244:247], v[112:115]
    ds_write_b32 v16, a84 offset:512
    v_mfma_f32_16x16x32_bf16 v[112:115], a[116:119], a[248:251], v[112:115]
    ds_write_b32 v16, a85 offset:516
    v_mfma_f32_16x16x32_bf16 v[116:119], a[120:123], a[228:231], 0
    ds_write_b32 v16, a86 offset:1536
    v_mfma_f32_16x16x32_bf16 v[116:119], a[124:127], a[232:235], v[116:119]
    ds_write_b32 v16, a87 offset:1540
    v_mfma_f32_16x16x32_bf16 v[116:119], a[128:131], a[236:239], v[116:119]
    buffer_store_dwordx2 v[156:157], v11, s[12:15], s39 offen offset:896 sc1
    v_mfma_f32_16x16x32_bf16 v[116:119], a[132:135], a[240:243], v[116:119]
    ds_read2_b64 a[80:83], v17 offset0:0 offset1:128
    v_cvt_pk_bf16_f32 v214, v108, v109
    v_mfma_f32_16x16x32_bf16 v[116:119], a[136:139], a[244:247], v[116:119]
    ds_read2_b64 a[84:87], v18 offset0:0 offset1:128
    v_cvt_pk_bf16_f32 v215, v110, v111
    v_mfma_f32_16x16x32_bf16 v[116:119], a[140:143], a[248:251], v[116:119]
    v_cvt_pk_bf16_f32 v216, v112, v113
    v_cvt_pk_bf16_f32 v217, v114, v115
    v_mfma_f32_16x16x32_bf16 v[120:123], a[144:147], a[228:231], 0
    v_mfma_f32_16x16x32_bf16 v[120:123], a[148:151], a[232:235], v[120:123]
    buffer_store_dwordx2 v[158:159], v11, s[12:15], s39 offen offset:1280 sc1
    v_mfma_f32_16x16x32_bf16 v[120:123], a[152:155], a[236:239], v[120:123]
    v_cvt_pk_bf16_f32 v218, v116, v117
    v_cvt_pk_bf16_f32 v219, v118, v119
    v_mfma_f32_16x16x32_bf16 v[120:123], a[156:159], a[240:243], v[120:123]
    v_mfma_f32_16x16x32_bf16 v[120:123], a[160:163], a[244:247], v[120:123]
    v_mfma_f32_16x16x32_bf16 v[120:123], a[164:167], a[248:251], v[120:123]
    v_mfma_f32_16x16x32_bf16 v[124:127], a[168:171], a[228:231], 0
    s_waitcnt vmcnt(29)
    ds_write_b32 v16, a88 offset:0
    v_mfma_f32_16x16x32_bf16 v[124:127], a[172:175], a[232:235], v[124:127]
    ds_write_b32 v16, a89 offset:4
    v_mfma_f32_16x16x32_bf16 v[124:127], a[176:179], a[236:239], v[124:127]
    ds_write_b32 v16, a90 offset:1024
    v_mfma_f32_16x16x32_bf16 v[124:127], a[180:183], a[240:243], v[124:127]
    ds_write_b32 v16, a91 offset:1028
    v_mfma_f32_16x16x32_bf16 v[124:127], a[184:187], a[244:247], v[124:127]
    ds_write_b32 v16, a92 offset:512
    v_mfma_f32_16x16x32_bf16 v[124:127], a[188:191], a[248:251], v[124:127]
    ds_write_b32 v16, a93 offset:516
    v_mfma_f32_16x16x32_bf16 v[64:67], v[32:35], v[192:195], 0
    ds_write_b32 v16, a94 offset:1536
    v_mfma_f32_16x16x32_bf16 v[64:67], v[36:39], v[196:199], v[64:67]
    ds_write_b32 v16, a95 offset:1540
    v_mfma_f32_16x16x32_bf16 v[68:71], v[32:35], v[200:203], 0
    ds_read2_b64 a[88:91], v17 offset0:0 offset1:128
    v_cvt_pk_bf16_f32 v220, v120, v121
    v_mfma_f32_16x16x32_bf16 v[68:71], v[36:39], v[204:207], v[68:71]
    ds_read2_b64 a[92:95], v18 offset0:0 offset1:128
    v_cvt_pk_bf16_f32 v221, v122, v123
    v_mfma_f32_16x16x32_bf16 v[72:75], v[32:35], v[208:211], 0
    v_cvt_pk_bf16_f32 v222, v124, v125
    v_cvt_pk_bf16_f32 v223, v126, v127
    v_mfma_f32_16x16x32_bf16 v[72:75], v[36:39], v[212:215], v[72:75]
    v_mfma_f32_16x16x32_bf16 v[76:79], v[32:35], v[216:219], 0
    buffer_load_dwordx4 a[96:99], v9, s[8:11], s24 offen offset:0 nt
    v_cvt_pk_bf16_f32 v160, v64, v68
    v_mfma_f32_16x16x32_bf16 v[76:79], v[36:39], v[220:223], v[76:79]
    buffer_load_dwordx4 a[100:103], v10, s[8:11], s24 offen offset:0 nt
    v_cvt_pk_bf16_f32 v162, v65, v69
    v_mfma_f32_16x16x32_bf16 v[80:83], v[40:43], v[192:195], 0
    ds_read_b128 a[192:195], v1 offset:0
    v_cvt_pk_bf16_f32 v164, v66, v70
    v_mfma_f32_16x16x32_bf16 v[80:83], v[44:47], v[196:199], v[80:83]
    ds_read_b128 a[196:199], v1 offset:1024
    v_cvt_pk_bf16_f32 v166, v67, v71
    v_mfma_f32_16x16x32_bf16 v[84:87], v[40:43], v[200:203], 0
    ds_read_b128 a[200:203], v1 offset:2048
    v_cvt_pk_bf16_f32 v161, v72, v76
    v_mfma_f32_16x16x32_bf16 v[84:87], v[44:47], v[204:207], v[84:87]
    v_cvt_pk_bf16_f32 v163, v73, v77
    v_cvt_pk_bf16_f32 v165, v74, v78
    v_mfma_f32_16x16x32_bf16 v[88:91], v[40:43], v[208:211], 0
    ds_read_b128 a[204:207], v1 offset:3072
    v_cvt_pk_bf16_f32 v167, v75, v79
    v_mfma_f32_16x16x32_bf16 v[88:91], v[44:47], v[212:215], v[88:91]
    v_mfma_f32_16x16x32_bf16 v[92:95], v[40:43], v[216:219], 0
    ds_read_b128 a[208:211], v1 offset:4096
    v_cvt_pk_bf16_f32 v168, v80, v84
    v_mfma_f32_16x16x32_bf16 v[92:95], v[44:47], v[220:223], v[92:95]
    v_cvt_pk_bf16_f32 v170, v81, v85
    v_cvt_pk_bf16_f32 v172, v82, v86
    v_mfma_f32_16x16x32_bf16 v[96:99], v[48:51], v[192:195], 0
    ds_read_b128 a[212:215], v1 offset:5120
    v_cvt_pk_bf16_f32 v174, v83, v87
    v_mfma_f32_16x16x32_bf16 v[96:99], v[52:55], v[196:199], v[96:99]
    v_mfma_f32_16x16x32_bf16 v[100:103], v[48:51], v[200:203], 0
    buffer_store_dwordx2 v[160:161], v11, s[12:15], s33 offen offset:256 sc1
    v_mfma_f32_16x16x32_bf16 v[100:103], v[52:55], v[204:207], v[100:103]
    v_cvt_pk_bf16_f32 v169, v88, v92
    v_cvt_pk_bf16_f32 v171, v89, v93
    v_mfma_f32_16x16x32_bf16 v[104:107], v[48:51], v[208:211], 0
    v_cvt_pk_bf16_f32 v173, v90, v94
    v_cvt_pk_bf16_f32 v175, v91, v95
    v_mfma_f32_16x16x32_bf16 v[104:107], v[52:55], v[212:215], v[104:107]
    buffer_store_dwordx2 v[162:163], v11, s[12:15], s33 offen offset:640 sc1
    v_mfma_f32_16x16x32_bf16 v[108:111], v[48:51], v[216:219], 0
    v_cvt_pk_bf16_f32 v176, v96, v100
    v_cvt_pk_bf16_f32 v178, v97, v101
    v_mfma_f32_16x16x32_bf16 v[108:111], v[52:55], v[220:223], v[108:111]
    v_cvt_pk_bf16_f32 v180, v98, v102
    v_cvt_pk_bf16_f32 v182, v99, v103
    v_mfma_f32_16x16x32_bf16 v[112:115], v[56:59], v[192:195], 0
    buffer_store_dwordx2 v[164:165], v11, s[12:15], s33 offen offset:1024 sc1
    v_mfma_f32_16x16x32_bf16 v[112:115], v[60:63], v[196:199], v[112:115]
    v_mfma_f32_16x16x32_bf16 v[116:119], v[56:59], v[200:203], 0
    v_cvt_pk_bf16_f32 v177, v104, v108
    v_cvt_pk_bf16_f32 v179, v105, v109
    v_mfma_f32_16x16x32_bf16 v[116:119], v[60:63], v[204:207], v[116:119]
    buffer_store_dwordx2 v[166:167], v11, s[12:15], s33 offen offset:1408 sc1
    v_mfma_f32_16x16x32_bf16 v[120:123], v[56:59], v[208:211], 0
    s_add_u32 s33, s16, 3145728
    v_cvt_pk_bf16_f32 v181, v106, v110
    v_cvt_pk_bf16_f32 v183, v107, v111
    v_mfma_f32_16x16x32_bf16 v[120:123], v[60:63], v[212:215], v[120:123]
    v_mfma_f32_16x16x32_bf16 v[124:127], v[56:59], v[216:219], 0
    ds_read_b128 a[216:219], v1 offset:6144
    v_cvt_pk_bf16_f32 v184, v112, v116
    v_mfma_f32_16x16x32_bf16 v[124:127], v[60:63], v[220:223], v[124:127]
    v_cvt_pk_bf16_f32 v186, v113, v117
    v_cvt_pk_bf16_f32 v188, v114, v118
    s_cmp_eq_u32 s18, 1
    s_cbranch_scc0 L_more
L_tail:
    buffer_store_dwordx2 v[168:169], v11, s[12:15], s35 offen offset:256 sc1
    buffer_store_dwordx2 v[170:171], v11, s[12:15], s35 offen offset:640 sc1
    buffer_store_dwordx2 v[172:173], v11, s[12:15], s35 offen offset:1024 sc1
    buffer_store_dwordx2 v[174:175], v11, s[12:15], s35 offen offset:1408 sc1
    buffer_store_dwordx2 v[176:177], v11, s[12:15], s37 offen offset:256 sc1
    buffer_store_dwordx2 v[178:179], v11, s[12:15], s37 offen offset:640 sc1
    buffer_store_dwordx2 v[180:181], v11, s[12:15], s37 offen offset:1024 sc1
    buffer_store_dwordx2 v[182:183], v11, s[12:15], s37 offen offset:1408 sc1
    v_cvt_pk_bf16_f32 v190, v115, v119
    v_cvt_pk_bf16_f32 v185, v120, v124
    v_cvt_pk_bf16_f32 v187, v121, v125
    v_cvt_pk_bf16_f32 v189, v122, v126
    v_cvt_pk_bf16_f32 v191, v123, v127
    buffer_store_dwordx2 v[184:185], v11, s[12:15], s39 offen offset:256 sc1
    buffer_store_dwordx2 v[186:187], v11, s[12:15], s39 offen offset:640 sc1
    buffer_store_dwordx2 v[188:189], v11, s[12:15], s39 offen offset:1024 sc1
    buffer_store_dwordx2 v[190:191], v11, s[12:15], s39 offen offset:1408 sc1
L_end:
    s_endpgm
L_more:
    s_waitcnt lgkmcnt(1)
    v_mfma_f32_16x16x32_bf16 v[96:99], a[192:195], a[0:3], 0
    ds_read_b128 a[220:223], v1 offset:7168
    v_cvt_pk_bf16_f32 v190, v115, v119
    v_mfma_f32_16x16x32_bf16 v[96:99], a[196:199], a[4:7], v[96:99]
    v_mfma_f32_16x16x32_bf16 v[96:99], a[200:203], a[8:11], v[96:99]
    ds_read_b128 a[224:227], v1 offset:8192
    v_cvt_pk_bf16_f32 v185, v120, v124
    v_mfma_f32_16x16x32_bf16 v[96:99], a[204:207], a[12:15], v[96:99]
    v_cvt_pk_bf16_f32 v187, v121, v125
    v_cvt_pk_bf16_f32 v189, v122, v126
    v_mfma_f32_16x16x32_bf16 v[96:99], a[208:211], a[16:19], v[96:99]
    ds_read_b128 a[228:231], v1 offset:9216
    v_cvt_pk_bf16_f32 v191, v123, v127
    v_mfma_f32_16x16x32_bf16 v[96:99], a[212:215], a[20:23], v[96:99]
    v_mfma_f32_16x16x32_bf16 v[100:103], a[192:195], a[24:27], 0
    ds_read_b128 a[232:235], v1 offset:10240
    v_mfma_f32_16x16x32_bf16 v[100:103], a[196:199], a[28:31], v[100:103]
    v_mfma_f32_16x16x32_bf16 v[100:103], a[200:203], a[32:35], v[100:103]
    ds_read_b128 a[236:239], v1 offset:11264
    v_cvt_pk_bf16_f32 v192, v96, v97
    v_mfma_f32_16x16x32_bf16 v[100:103], a[204:207], a[36:39], v[100:103]
    v_cvt_pk_bf16_f32 v193, v98, v99
    v_mfma_f32_16x16x32_bf16 v[100:103], a[208:211], a[40:43], v[100:103]
    v_mfma_f32_16x16x32_bf16 v[100:103], a[212:215], a[44:47], v[100:103]
    v_mfma_f32_16x16x32_bf16 v[104:107], a[192:195], a[48:51], 0
    v_mfma_f32_16x16x32_bf16 v[104:107], a[196:199], a[52:55], v[104:107]
    v_mfma_f32_16x16x32_bf16 v[104:107], a[200:203], a[56:59], v[104:107]
    v_cvt_pk_bf16_f32 v196, v100, v101
    v_cvt_pk_bf16_f32 v197, v102, v103
    v_mfma_f32_16x16x32_bf16 v[104:107], a[204:207], a[60:63], v[104:107]
    v_mfma_f32_16x16x32_bf16 v[104:107], a[208:211], a[64:67], v[104:107]
    v_mfma_f32_16x16x32_bf16 v[104:107], a[212:215], a[68:71], v[104:107]
    v_mfma_f32_16x16x32_bf16 v[108:111], a[192:195], a[72:75], 0
    v_mfma_f32_16x16x32_bf16 v[108:111], a[196:199], a[76:79], v[108:111]
    v_mfma_f32_16x16x32_bf16 v[108:111], a[200:203], a[80:83], v[108:111]
    v_cvt_pk_bf16_f32 v200, v104, v105
    v_cvt_pk_bf16_f32 v201, v106, v107
    v_mfma_f32_16x16x32_bf16 v[108:111], a[204:207], a[84:87], v[108:111]
    v_mfma_f32_16x16x32_bf16 v[108:111], a[208:211], a[88:91], v[108:111]
    ds_read_b128 a[240:243], v1 offset:12288
    v_mfma_f32_16x16x32_bf16 v[108:111], a[212:215], a[92:95], v[108:111]
    s_waitcnt lgkmcnt(1)
    v_mfma_f32_16x16x32_bf16 v[112:115], a[216:219], a[0:3], 0
    ds_read_b128 a[244:247], v1 offset:13312
    v_mfma_f32_16x16x32_bf16 v[112:115], a[220:223], a[4:7], v[112:115]
    v_mfma_f32_16x16x32_bf16 v[112:115], a[224:227], a[8:11], v[112:115]
    ds_read_b128 a[248:251], v1 offset:14336
    v_cvt_pk_bf16_f32 v204, v108, v109
    v_mfma_f32_16x16x32_bf16 v[112:115], a[228:231], a[12:15], v[112:115]
    v_cvt_pk_bf16_f32 v205, v110, v111
    v_mfma_f32_16x16x32_bf16 v[112:115], a[232:235], a[16:19], v[112:115]
    ds_read_b128 a[192:195], v1 offset:15360
    v_mfma_f32_16x16x32_bf16 v[112:115], a[236:239], a[20:23], v[112:115]
    v_mfma_f32_16x16x32_bf16 v[116:119], a[216:219], a[24:27], 0
    buffer_load_dwordx4 a[104:107], v9, s[8:11], s24 offen offset:128 nt
    v_mfma_f32_16x16x32_bf16 v[116:119], a[220:223], a[28:31], v[116:119]
    buffer_load_dwordx4 a[108:111], v10, s[8:11], s24 offen offset:128 nt
    v_mfma_f32_16x16x32_bf16 v[116:119], a[224:227], a[32:35], v[116:119]
    ds_read_b128 a[196:199], v1 offset:16384
    v_cvt_pk_bf16_f32 v194, v112, v113
    v_mfma_f32_16x16x32_bf16 v[116:119], a[228:231], a[36:39], v[116:119]
    buffer_store_dwordx2 v[168:169], v11, s[12:15], s35 offen offset:256 sc1
    v_mfma_f32_16x16x32_bf16 v[116:119], a[232:235], a[40:43], v[116:119]
    ds_read_b128 a[200:203], v1 offset:17408
    v_cvt_pk_bf16_f32 v195, v114, v115
    v_mfma_f32_16x16x32_bf16 v[116:119], a[236:239], a[44:47], v[116:119]
    v_mfma_f32_16x16x32_bf16 v[120:123], a[216:219], a[48:51], 0
    v_mfma_f32_16x16x32_bf16 v[120:123], a[220:223], a[52:55], v[120:123]
    v_mfma_f32_16x16x32_bf16 v[120:123], a[224:227], a[56:59], v[120:123]
    v_cvt_pk_bf16_f32 v198, v116, v117
    v_cvt_pk_bf16_f32 v199, v118, v119
    v_mfma_f32_16x16x32_bf16 v[120:123], a[228:231], a[60:63], v[120:123]
    v_mfma_f32_16x16x32_bf16 v[120:123], a[232:235], a[64:67], v[120:123]
    v_mfma_f32_16x16x32_bf16 v[120:123], a[236:239], a[68:71], v[120:123]
    v_mfma_f32_16x16x32_bf16 v[124:127], a[216:219], a[72:75], 0
    v_mfma_f32_16x16x32_bf16 v[124:127], a[220:223], a[76:79], v[124:127]
    v_mfma_f32_16x16x32_bf16 v[124:127], a[224:227], a[80:83], v[124:127]
    v_cvt_pk_bf16_f32 v202, v120, v121
    v_cvt_pk_bf16_f32 v203, v122, v123
    v_mfma_f32_16x16x32_bf16 v[124:127], a[228:231], a[84:87], v[124:127]
    v_mfma_f32_16x16x32_bf16 v[124:127], a[232:235], a[88:91], v[124:127]
    ds_read_b128 a[204:207], v1 offset:18432
    v_mfma_f32_16x16x32_bf16 v[124:127], a[236:239], a[92:95], v[124:127]
    s_waitcnt lgkmcnt(2)
    v_mfma_f32_16x16x32_bf16 v[96:99], a[240:243], a[0:3], 0
    ds_read_b128 a[208:211], v1 offset:19456
    v_mfma_f32_16x16x32_bf16 v[96:99], a[244:247], a[4:7], v[96:99]
    v_mfma_f32_16x16x32_bf16 v[96:99], a[248:251], a[8:11], v[96:99]
    ds_read_b128 a[212:215], v1 offset:20480
    v_cvt_pk_bf16_f32 v206, v124, v125
    v_mfma_f32_16x16x32_bf16 v[96:99], a[192:195], a[12:15], v[96:99]
    v_cvt_pk_bf16_f32 v207, v126, v127
    v_mfma_f32_16x16x32_bf16 v[96:99], a[196:199], a[16:19], v[96:99]
    s_waitcnt lgkmcnt(3)
    ds_read_b128 a[216:219], v1 offset:21504
    v_mfma_f32_16x16x32_bf16 v[96:99], a[200:203], a[20:23], v[96:99]
    v_mfma_f32_16x16x32_bf16 v[100:103], a[240:243], a[24:27], 0
    ds_read_b128 a[220:223], v1 offset:22528
    v_mfma_f32_16x16x32_bf16 v[100:103], a[244:247], a[28:31], v[100:103]
    v_mfma_f32_16x16x32_bf16 v[100:103], a[248:251], a[32:35], v[100:103]
    ds_read_b128 a[224:227], v1 offset:23552
    v_cvt_pk_bf16_f32 v208, v96, v97
    v_mfma_f32_16x16x32_bf16 v[100:103], a[192:195], a[36:39], v[100:103]
    buffer_store_dwordx2 v[170:171], v11, s[12:15], s35 offen offset:640 sc1
    v_mfma_f32_16x16x32_bf16 v[100:103], a[196:199], a[40:43], v[100:103]
    v_cvt_pk_bf16_f32 v209, v98, v99
    v_mfma_f32_16x16x32_bf16 v[100:103], a[200:203], a[44:47], v[100:103]
    v_mfma_f32_16x16x32_bf16 v[104:107], a[240:243], a[48:51], 0
    v_mfma_f32_16x16x32_bf16 v[104:107], a[244:247], a[52:55], v[104:107]
    v_mfma_f32_16x16x32_bf16 v[104:107], a[248:251], a[56:59], v[104:107]
    v_cvt_pk_bf16_f32 v212, v100, v101
    v_cvt_pk_bf16_f32 v213, v102, v103
    v_mfma_f32_16x16x32_bf16 v[104:107], a[192:195], a[60:63], v[104:107]
    v_mfma_f32_16x16x32_bf16 v[104:107], a[196:199], a[64:67], v[104:107]
    v_mfma_f32_16x16x32_bf16 v[104:107], a[200:203], a[68:71], v[104:107]
    v_mfma_f32_16x16x32_bf16 v[108:111], a[240:243], a[72:75], 0
    v_mfma_f32_16x16x32_bf16 v[108:111], a[244:247], a[76:79], v[108:111]
    v_mfma_f32_16x16x32_bf16 v[108:111], a[248:251], a[80:83], v[108:111]
    v_cvt_pk_bf16_f32 v216, v104, v105
    v_cvt_pk_bf16_f32 v217, v106, v107
    v_mfma_f32_16x16x32_bf16 v[108:111], a[192:195], a[84:87], v[108:111]
    v_mfma_f32_16x16x32_bf16 v[108:111], a[196:199], a[88:91], v[108:111]
    ds_read_b128 a[228:231], v1 offset:24576
    v_mfma_f32_16x16x32_bf16 v[108:111], a[200:203], a[92:95], v[108:111]
    s_waitcnt lgkmcnt(1)
    v_mfma_f32_16x16x32_bf16 v[112:115], a[204:207], a[0:3], 0
    ds_read_b128 a[232:235], v1 offset:25600
    v_mfma_f32_16x16x32_bf16 v[112:115], a[208:211], a[4:7], v[112:115]
    v_mfma_f32_16x16x32_bf16 v[112:115], a[212:215], a[8:11], v[112:115]
    ds_read_b128 a[236:239], v1 offset:26624
    v_cvt_pk_bf16_f32 v220, v108, v109
    v_mfma_f32_16x16x32_bf16 v[112:115], a[216:219], a[12:15], v[112:115]
    v_cvt_pk_bf16_f32 v221, v110, v111
    v_mfma_f32_16x16x32_bf16 v[112:115], a[220:223], a[16:19], v[112:115]
    ds_read_b128 a[240:243], v1 offset:27648
    v_mfma_f32_16x16x32_bf16 v[112:115], a[224:227], a[20:23], v[112:115]
    v_mfma_f32_16x16x32_bf16 v[116:119], a[204:207], a[24:27], 0
    ds_read_b128 a[244:247], v1 offset:28672
    v_mfma_f32_16x16x32_bf16 v[116:119], a[208:211], a[28:31], v[116:119]
    v_mfma_f32_16x16x32_bf16 v[116:119], a[212:215], a[32:35], v[116:119]
    ds_read_b128 a[248:251], v1 offset:29696
    v_cvt_pk_bf16_f32 v210, v112, v113
    v_mfma_f32_16x16x32_bf16 v[116:119], a[216:219], a[36:39], v[116:119]
    v_cvt_pk_bf16_f32 v211, v114, v115
    v_mfma_f32_16x16x32_bf16 v[116:119], a[220:223], a[40:43], v[116:119]
    buffer_store_dwordx2 v[172:173], v11, s[12:15], s35 offen offset:1024 sc1
    v_mfma_f32_16x16x32_bf16 v[116:119], a[224:227], a[44:47], v[116:119]
    v_mfma_f32_16x16x32_bf16 v[120:123], a[204:207], a[48:51], 0
    v_mfma_f32_16x16x32_bf16 v[120:123], a[208:211], a[52:55], v[120:123]
    v_mfma_f32_16x16x32_bf16 v[120:123], a[212:215], a[56:59], v[120:123]
    buffer_load_dwordx4 a[112:115], v9, s[8:11], s24 offen offset:256 nt
    v_cvt_pk_bf16_f32 v214, v116, v117
    v_mfma_f32_16x16x32_bf16 v[120:123], a[216:219], a[60:63], v[120:123]
    buffer_load_dwordx4 a[116:119], v10, s[8:11], s24 offen offset:256 nt
    v_cvt_pk_bf16_f32 v215, v118, v119
    v_mfma_f32_16x16x32_bf16 v[120:123], a[220:223], a[64:67], v[120:123]
    s_add_u32 s24, s16, 6291456
    v_mfma_f32_16x16x32_bf16 v[120:123], a[224:227], a[68:71], v[120:123]
    v_mfma_f32_16x16x32_bf16 v[124:127], a[204:207], a[72:75], 0
    v_mfma_f32_16x16x32_bf16 v[124:127], a[208:211], a[76:79], v[124:127]
    v_mfma_f32_16x16x32_bf16 v[124:127], a[212:215], a[80:83], v[124:127]
    v_cvt_pk_bf16_f32 v218, v120, v121
    v_cvt_pk_bf16_f32 v219, v122, v123
    v_mfma_f32_16x16x32_bf16 v[124:127], a[216:219], a[84:87], v[124:127]
    v_mfma_f32_16x16x32_bf16 v[124:127], a[220:223], a[88:91], v[124:127]
    v_mfma_f32_16x16x32_bf16 v[124:127], a[224:227], a[92:95], v[124:127]
    s_waitcnt lgkmcnt(0)
    v_mfma_f32_16x16x32_bf16 v[96:99], a[228:231], a[0:3], 0
    v_mfma_f32_16x16x32_bf16 v[96:99], a[232:235], a[4:7], v[96:99]
    v_mfma_f32_16x16x32_bf16 v[96:99], a[236:239], a[8:11], v[96:99]
    v_cvt_pk_bf16_f32 v222, v124, v125
    v_cvt_pk_bf16_f32 v223, v126, v127
    v_mfma_f32_16x16x32_bf16 v[96:99], a[240:243], a[12:15], v[96:99]
    v_mfma_f32_16x16x32_bf16 v[96:99], a[244:247], a[16:19], v[96:99]
    v_mfma_f32_16x16x32_bf16 v[96:99], a[248:251], a[20:23], v[96:99]
    v_mfma_f32_16x16x32_bf16 v[100:103], a[228:231], a[24:27], 0
    v_mfma_f32_16x16x32_bf16 v[100:103], a[232:235], a[28:31], v[100:103]
    v_mfma_f32_16x16x32_bf16 v[100:103], a[236:239], a[32:35], v[100:103]
    v_mfma_f32_16x16x32_bf16 v[100:103], a[240:243], a[36:39], v[100:103]
    v_mfma_f32_16x16x32_bf16 v[100:103], a[244:247], a[40:43], v[100:103]
    v_mfma_f32_16x16x32_bf16 v[100:103], a[248:251], a[44:47], v[100:103]
    buffer_store_dwordx2 v[174:175], v11, s[12:15], s35 offen offset:1408 sc1
    v_mfma_f32_16x16x32_bf16 v[32:35], a[0:3], v[192:195], 0
    s_add_u32 s35, s16, 3538944
    v_mfma_f32_16x16x32_bf16 v[32:35], a[4:7], v[208:211], v[32:35]
    v_mfma_f32_16x16x32_bf16 v[36:39], a[24:27], v[192:195], 0
    v_mfma_f32_16x16x32_bf16 v[36:39], a[28:31], v[208:211], v[36:39]
    v_mfma_f32_16x16x32_bf16 v[40:43], a[48:51], v[192:195], 0
    v_mfma_f32_16x16x32_bf16 v[40:43], a[52:55], v[208:211], v[40:43]
    v_mfma_f32_16x16x32_bf16 v[44:47], a[72:75], v[192:195], 0
    v_cvt_pk_bf16_f32 v192, v96, v97
    v_cvt_pk_bf16_f32 v193, v98, v99
    v_mfma_f32_16x16x32_bf16 v[44:47], a[76:79], v[208:211], v[44:47]
    v_mfma_f32_16x16x32_bf16 v[48:51], a[0:3], v[196:199], 0
    v_mfma_f32_16x16x32_bf16 v[48:51], a[4:7], v[212:215], v[48:51]
    v_mfma_f32_16x16x32_bf16 v[52:55], a[24:27], v[196:199], 0
    v_mfma_f32_16x16x32_bf16 v[52:55], a[28:31], v[212:215], v[52:55]
    v_mfma_f32_16x16x32_bf16 v[56:59], a[48:51], v[196:199], 0
    v_mfma_f32_16x16x32_bf16 v[56:59], a[52:55], v[212:215], v[56:59]
    v_mfma_f32_16x16x32_bf16 v[60:63], a[72:75], v[196:199], 0
    v_cvt_pk_bf16_f32 v196, v100, v101
    v_cvt_pk_bf16_f32 v197, v102, v103
    v_mfma_f32_16x16x32_bf16 v[60:63], a[76:79], v[212:215], v[60:63]
    v_mfma_f32_16x16x32_bf16 v[64:67], a[0:3], v[200:203], 0
    v_mfma_f32_16x16x32_bf16 v[64:67], a[4:7], v[216:219], v[64:67]
    v_mfma_f32_16x16x32_bf16 v[68:71], a[24:27], v[200:203], 0
    ds_read_b128 a[192:195], v1 offset:30720
    v_mfma_f32_16x16x32_bf16 v[68:71], a[28:31], v[216:219], v[68:71]
    v_mfma_f32_16x16x32_bf16 v[72:75], a[48:51], v[200:203], 0
    ds_read_b128 a[196:199], v1 offset:31744
    v_mfma_f32_16x16x32_bf16 v[72:75], a[52:55], v[216:219], v[72:75]
    v_mfma_f32_16x16x32_bf16 v[76:79], a[72:75], v[200:203], 0
    ds_read_b128 a[200:203], v1 offset:32768
    v_mfma_f32_16x16x32_bf16 v[76:79], a[76:79], v[216:219], v[76:79]
    v_mfma_f32_16x16x32_bf16 v[80:83], a[0:3], v[204:207], 0
    buffer_store_dwordx2 v[176:177], v11, s[12:15], s37 offen offset:256 sc1
    v_mfma_f32_16x16x32_bf16 v[80:83], a[4:7], v[220:223], v[80:83]
    ds_read_b128 a[204:207], v1 offset:33792
    v_mfma_f32_16x16x32_bf16 v[84:87], a[24:27], v[204:207], 0
    ds_read_b128 a[208:211], v1 offset:34816
    v_mfma_f32_16x16x32_bf16 v[84:87], a[28:31], v[220:223], v[84:87]
    v_mfma_f32_16x16x32_bf16 v[88:91], a[48:51], v[204:207], 0
    ds_read_b128 a[212:215], v1 offset:35840
    v_mfma_f32_16x16x32_bf16 v[88:91], a[52:55], v[220:223], v[88:91]
    v_mfma_f32_16x16x32_bf16 v[92:95], a[72:75], v[204:207], 0
    v_mfma_f32_16x16x32_bf16 v[92:95], a[76:79], v[220:223], v[92:95]
    v_mfma_f32_16x16x32_bf16 v[104:107], a[228:231], a[48:51], 0
    v_mfma_f32_16x16x32_bf16 v[104:107], a[232:235], a[52:55], v[104:107]
    v_mfma_f32_16x16x32_bf16 v[104:107], a[236:239], a[56:59], v[104:107]
    buffer_load_dwordx4 a[120:123], v9, s[8:11], s26 offen offset:0 nt
    v_mfma_f32_16x16x32_bf16 v[104:107], a[240:243], a[60:63], v[104:107]
    buffer_load_dwordx4 a[124:127], v10, s[8:11], s26 offen offset:0 nt
    v_mfma_f32_16x16x32_bf16 v[104:107], a[244:247], a[64:67], v[104:107]
    v_mfma_f32_16x16x32_bf16 v[104:107], a[248:251], a[68:71], v[104:107]
    v_mfma_f32_16x16x32_bf16 v[108:111], a[228:231], a[72:75], 0
    v_mfma_f32_16x16x32_bf16 v[108:111], a[232:235], a[76:79], v[108:111]
    v_mfma_f32_16x16x32_bf16 v[108:111], a[236:239], a[80:83], v[108:111]
    v_cvt_pk_bf16_f32 v200, v104, v105
    v_cvt_pk_bf16_f32 v201, v106, v107
    v_mfma_f32_16x16x32_bf16 v[108:111], a[240:243], a[84:87], v[108:111]
    v_mfma_f32_16x16x32_bf16 v[108:111], a[244:247], a[88:91], v[108:111]
    ds_read_b128 a[216:219], v1 offset:36864
    v_mfma_f32_16x16x32_bf16 v[108:111], a[248:251], a[92:95], v[108:111]
    s_waitcnt lgkmcnt(1)
    v_mfma_f32_16x16x32_bf16 v[112:115], a[192:195], a[0:3], 0
    ds_read_b128 a[220:223], v1 offset:37888
    v_mfma_f32_16x16x32_bf16 v[112:115], a[196:199], a[4:7], v[112:115]
    v_mfma_f32_16x16x32_bf16 v[112:115], a[200:203], a[8:11], v[112:115]
    ds_read_b128 a[224:227], v1 offset:38912
    v_cvt_pk_bf16_f32 v204, v108, v109
    v_mfma_f32_16x16x32_bf16 v[112:115], a[204:207], a[12:15], v[112:115]
    v_cvt_pk_bf16_f32 v205, v110, v111
    v_mfma_f32_16x16x32_bf16 v[112:115], a[208:211], a[16:19], v[112:115]
    ds_read_b128 a[228:231], v1 offset:39936
    v_mfma_f32_16x16x32_bf16 v[112:115], a[212:215], a[20:23], v[112:115]
    buffer_store_dwordx2 v[178:179], v11, s[12:15], s37 offen offset:640 sc1
    v_mfma_f32_16x16x32_bf16 v[116:119], a[192:195], a[24:27], 0
    ds_read_b128 a[232:235], v1 offset:40960
    v_mfma_f32_16x16x32_bf16 v[116:119], a[196:199], a[28:31], v[116:119]
    v_mfma_f32_16x16x32_bf16 v[116:119], a[200:203], a[32:35], v[116:119]
    ds_read_b128 a[236:239], v1 offset:41984
    v_cvt_pk_bf16_f32 v194, v112, v113
    v_mfma_f32_16x16x32_bf16 v[116:119], a[204:207], a[36:39], v[116:119]
    v_cvt_pk_bf16_f32 v195, v114, v115
    v_mfma_f32_16x16x32_bf16 v[116:119], a[208:211], a[40:43], v[116:119]
    v_mfma_f32_16x16x32_bf16 v[116:119], a[212:215], a[44:47], v[116:119]
    v_mfma_f32_16x16x32_bf16 v[120:123], a[192:195], a[48:51], 0
    v_mfma_f32_16x16x32_bf16 v[120:123], a[196:199], a[52:55], v[120:123]
    v_mfma_f32_16x16x32_bf16 v[120:123], a[200:203], a[56:59], v[120:123]
    v_cvt_pk_bf16_f32 v198, v116, v117
    v_cvt_pk_bf16_f32 v199, v118, v119
    v_mfma_f32_16x16x32_bf16 v[120:123], a[204:207], a[60:63], v[120:123]
    v_mfma_f32_16x16x32_bf16 v[120:123], a[208:211], a[64:67], v[120:123]
    v_mfma_f32_16x16x32_bf16 v[120:123], a[212:215], a[68:71], v[120:123]
    v_mfma_f32_16x16x32_bf16 v[124:127], a[192:195], a[72:75], 0
    v_mfma_f32_16x16x32_bf16 v[124:127], a[196:199], a[76:79], v[124:127]
    v_mfma_f32_16x16x32_bf16 v[124:127], a[200:203], a[80:83], v[124:127]
    v_cvt_pk_bf16_f32 v202, v120, v121
    v_cvt_pk_bf16_f32 v203, v122, v123
    v_mfma_f32_16x16x32_bf16 v[124:127], a[204:207], a[84:87], v[124:127]
    v_mfma_f32_16x16x32_bf16 v[124:127], a[208:211], a[88:91], v[124:127]
    ds_read_b128 a[240:243], v1 offset:43008
    v_mfma_f32_16x16x32_bf16 v[124:127], a[212:215], a[92:95], v[124:127]
    s_waitcnt lgkmcnt(1)
    v_mfma_f32_16x16x32_bf16 v[96:99], a[216:219], a[0:3], 0
    ds_read_b128 a[244:247], v1 offset:44032
    v_mfma_f32_16x16x32_bf16 v[96:99], a[220:223], a[4:7], v[96:99]
    v_mfma_f32_16x16x32_bf16 v[96:99], a[224:227], a[8:11], v[96:99]
    ds_read_b128 a[248:251], v1 offset:45056
    v_cvt_pk_bf16_f32 v206, v124, v125
    v_mfma_f32_16x16x32_bf16 v[96:99], a[228:231], a[12:15], v[96:99]
    v_cvt_pk_bf16_f32 v207, v126, v127
    v_mfma_f32_16x16x32_bf16 v[96:99], a[232:235], a[16:19], v[96:99]
    ds_read_b128 a[192:195], v1 offset:46080
    v_mfma_f32_16x16x32_bf16 v[96:99], a[236:239], a[20:23], v[96:99]
    v_mfma_f32_16x16x32_bf16 v[100:103], a[216:219], a[24:27], 0
    buffer_store_dwordx2 v[180:181], v11, s[12:15], s37 offen offset:1024 sc1
    v_mfma_f32_16x16x32_bf16 v[100:103], a[220:223], a[28:31], v[100:103]
    ds_read_b128 a[196:199], v1 offset:47104
    v_mfma_f32_16x16x32_bf16 v[100:103], a[224:227], a[32:35], v[100:103]
    ds_read_b128 a[200:203], v1 offset:48128
    v_cvt_pk_bf16_f32 v208, v96, v97
    v_mfma_f32_16x16x32_bf16 v[100:103], a[228:231], a[36:39], v[100:103]
    v_cvt_pk_bf16_f32 v209, v98, v99
    v_mfma_f32_16x16x32_bf16 v[100:103], a[232:235], a[40:43], v[100:103]
    v_mfma_f32_16x16x32_bf16 v[100:103], a[236:239], a[44:47], v[100:103]
    v_mfma_f32_16x16x32_bf16 v[104:107], a[216:219], a[48:51], 0
    v_mfma_f32_16x16x32_bf16 v[104:107], a[220:223], a[52:55], v[104:107]
    v_mfma_f32_16x16x32_bf16 v[104:107], a[224:227], a[56:59], v[104:107]
    v_cvt_pk_bf16_f32 v212, v100, v101
    v_cvt_pk_bf16_f32 v213, v102, v103
    v_mfma_f32_16x16x32_bf16 v[104:107], a[228:231], a[60:63], v[104:107]
    v_mfma_f32_16x16x32_bf16 v[104:107], a[232:235], a[64:67], v[104:107]
    v_mfma_f32_16x16x32_bf16 v[104:107], a[236:239], a[68:71], v[104:107]
    v_mfma_f32_16x16x32_bf16 v[108:111], a[216:219], a[72:75], 0
    v_mfma_f32_16x16x32_bf16 v[108:111], a[220:223], a[76:79], v[108:111]
    v_mfma_f32_16x16x32_bf16 v[108:111], a[224:227], a[80:83], v[108:111]
    v_cvt_pk_bf16_f32 v216, v104, v105
    v_cvt_pk_bf16_f32 v217, v106, v107
    v_mfma_f32_16x16x32_bf16 v[108:111], a[228:231], a[84:87], v[108:111]
    v_mfma_f32_16x16x32_bf16 v[108:111], a[232:235], a[88:91], v[108:111]
    buffer_load_dwordx4 a[128:131], v9, s[8:11], s26 offen offset:128 nt
    v_mfma_f32_16x16x32_bf16 v[108:111], a[236:239], a[92:95], v[108:111]
    s_waitcnt lgkmcnt(0)
    buffer_load_dwordx4 a[132:135], v10, s[8:11], s26 offen offset:128 nt
    v_mfma_f32_16x16x32_bf16 v[112:115], a[240:243], a[0:3], 0
    ds_read_b128 a[204:207], v1 offset:49152
    v_mfma_f32_16x16x32_bf16 v[112:115], a[244:247], a[4:7], v[112:115]
    ds_read_b128 a[208:211], v1 offset:50176
    v_mfma_f32_16x16x32_bf16 v[112:115], a[248:251], a[8:11], v[112:115]
    ds_read_b128 a[212:215], v1 offset:51200
    v_cvt_pk_bf16_f32 v220, v108, v109
    v_mfma_f32_16x16x32_bf16 v[112:115], a[192:195], a[12:15], v[112:115]
    v_cvt_pk_bf16_f32 v221, v110, v111
    v_mfma_f32_16x16x32_bf16 v[112:115], a[196:199], a[16:19], v[112:115]
    ds_read_b128 a[216:219], v1 offset:52224
    v_mfma_f32_16x16x32_bf16 v[112:115], a[200:203], a[20:23], v[112:115]
    v_mfma_f32_16x16x32_bf16 v[116:119], a[240:243], a[24:27], 0
    ds_read_b128 a[220:223], v1 offset:53248
    v_mfma_f32_16x16x32_bf16 v[116:119], a[244:247], a[28:31], v[116:119]
    buffer_store_dwordx2 v[182:183], v11, s[12:15], s37 offen offset:1408 sc1
    v_mfma_f32_16x16x32_bf16 v[116:119], a[248:251], a[32:35], v[116:119]
    s_add_u32 s37, s16, 3932160
    ds_read_b128 a[224:227], v1 offset:54272
    v_cvt_pk_bf16_f32 v210, v112, v113
    v_mfma_f32_16x16x32_bf16 v[116:119], a[192:195], a[36:39], v[116:119]
    v_cvt_pk_bf16_f32 v211, v114, v115
    v_mfma_f32_16x16x32_bf16 v[116:119], a[196:199], a[40:43], v[116:119]
    v_mfma_f32_16x16x32_bf16 v[116:119], a[200:203], a[44:47], v[116:119]
    v_mfma_f32_16x16x32_bf16 v[120:123], a[240:243], a[48:51], 0
    v_mfma_f32_16x16x32_bf16 v[120:123], a[244:247], a[52:55], v[120:123]
    v_mfma_f32_16x16x32_bf16 v[120:123], a[248:251], a[56:59], v[120:123]
    v_cvt_pk_bf16_f32 v214, v116, v117
    v_cvt_pk_bf16_f32 v215, v118, v119
    v_mfma_f32_16x16x32_bf16 v[120:123], a[192:195], a[60:63], v[120:123]
    v_mfma_f32_16x16x32_bf16 v[120:123], a[196:199], a[64:67], v[120:123]
    v_mfma_f32_16x16x32_bf16 v[120:123], a[200:203], a[68:71], v[120:123]
    v_mfma_f32_16x16x32_bf16 v[124:127], a[240:243], a[72:75], 0
    v_mfma_f32_16x16x32_bf16 v[124:127], a[244:247], a[76:79], v[124:127]
    v_mfma_f32_16x16x32_bf16 v[124:127], a[248:251], a[80:83], v[124:127]
    v_cvt_pk_bf16_f32 v218, v120, v121
    v_cvt_pk_bf16_f32 v219, v122, v123
    v_mfma_f32_16x16x32_bf16 v[124:127], a[192:195], a[84:87], v[124:127]
    v_mfma_f32_16x16x32_bf16 v[124:127], a[196:199], a[88:91], v[124:127]
    v_mfma_f32_16x16x32_bf16 v[124:127], a[200:203], a[92:95], v[124:127]
    s_waitcnt lgkmcnt(0)
    v_mfma_f32_16x16x32_bf16 v[96:99], a[204:207], a[0:3], 0
    v_mfma_f32_16x16x32_bf16 v[96:99], a[208:211], a[4:7], v[96:99]
    v_mfma_f32_16x16x32_bf16 v[96:99], a[212:215], a[8:11], v[96:99]
    v_cvt_pk_bf16_f32 v222, v124, v125
    v_cvt_pk_bf16_f32 v223, v126, v127
    v_mfma_f32_16x16x32_bf16 v[96:99], a[216:219], a[12:15], v[96:99]
    v_mfma_f32_16x16x32_bf16 v[96:99], a[220:223], a[16:19], v[96:99]
    v_mfma_f32_16x16x32_bf16 v[96:99], a[224:227], a[20:23], v[96:99]
    v_mfma_f32_16x16x32_bf16 v[100:103], a[204:207], a[24:27], 0
    v_mfma_f32_16x16x32_bf16 v[100:103], a[208:211], a[28:31], v[100:103]
    v_mfma_f32_16x16x32_bf16 v[100:103], a[212:215], a[32:35], v[100:103]
    buffer_store_dwordx2 v[184:185], v11, s[12:15], s39 offen offset:256 sc1
    v_mfma_f32_16x16x32_bf16 v[100:103], a[216:219], a[36:39], v[100:103]
    v_mfma_f32_16x16x32_bf16 v[100:103], a[220:223], a[40:43], v[100:103]
    v_mfma_f32_16x16x32_bf16 v[100:103], a[224:227], a[44:47], v[100:103]
    v_mfma_f32_16x16x32_bf16 v[32:35], a[8:11], v[192:195], v[32:35]
    v_mfma_f32_16x16x32_bf16 v[32:35], a[12:15], v[208:211], v[32:35]
    v_mfma_f32_16x16x32_bf16 v[36:39], a[32:35], v[192:195], v[36:39]
    v_mfma_f32_16x16x32_bf16 v[36:39], a[36:39], v[208:211], v[36:39]
    v_mfma_f32_16x16x32_bf16 v[40:43], a[56:59], v[192:195], v[40:43]
    v_mfma_f32_16x16x32_bf16 v[40:43], a[60:63], v[208:211], v[40:43]
    v_mfma_f32_16x16x32_bf16 v[44:47], a[80:83], v[192:195], v[44:47]
    v_cvt_pk_bf16_f32 v192, v96, v97
    v_cvt_pk_bf16_f32 v193, v98, v99
    v_mfma_f32_16x16x32_bf16 v[44:47], a[84:87], v[208:211], v[44:47]
    v_mfma_f32_16x16x32_bf16 v[48:51], a[8:11], v[196:199], v[48:51]
    v_mfma_f32_16x16x32_bf16 v[48:51], a[12:15], v[212:215], v[48:51]
    v_mfma_f32_16x16x32_bf16 v[52:55], a[32:35], v[196:199], v[52:55]
    v_mfma_f32_16x16x32_bf16 v[52:55], a[36:39], v[212:215], v[52:55]
    v_mfma_f32_16x16x32_bf16 v[56:59], a[56:59], v[196:199], v[56:59]
    v_mfma_f32_16x16x32_bf16 v[56:59], a[60:63], v[212:215], v[56:59]
    v_mfma_f32_16x16x32_bf16 v[60:63], a[80:83], v[196:199], v[60:63]
    v_cvt_pk_bf16_f32 v196, v100, v101
    v_cvt_pk_bf16_f32 v197, v102, v103
    v_mfma_f32_16x16x32_bf16 v[60:63], a[84:87], v[212:215], v[60:63]
    v_mfma_f32_16x16x32_bf16 v[64:67], a[8:11], v[200:203], v[64:67]
    v_mfma_f32_16x16x32_bf16 v[64:67], a[12:15], v[216:219], v[64:67]
    v_mfma_f32_16x16x32_bf16 v[68:71], a[32:35], v[200:203], v[68:71]
    buffer_load_dwordx4 a[136:139], v9, s[8:11], s26 offen offset:256 nt
    v_mfma_f32_16x16x32_bf16 v[68:71], a[36:39], v[216:219], v[68:71]
    buffer_load_dwordx4 a[140:143], v10, s[8:11], s26 offen offset:256 nt
    s_add_u32 s26, s16, 6684672
    v_mfma_f32_16x16x32_bf16 v[72:75], a[56:59], v[200:203], v[72:75]
    ds_read_b128 a[228:231], v1 offset:55296
    v_mfma_f32_16x16x32_bf16 v[72:75], a[60:63], v[216:219], v[72:75]
    ds_read_b128 a[232:235], v1 offset:56320
    v_mfma_f32_16x16x32_bf16 v[76:79], a[80:83], v[200:203], v[76:79]
    buffer_store_dwordx2 v[186:187], v11, s[12:15], s39 offen offset:640 sc1
    v_mfma_f32_16x16x32_bf16 v[76:79], a[84:87], v[216:219], v[76:79]
    ds_read_b128 a[236:239], v1 offset:57344
    v_mfma_f32_16x16x32_bf16 v[80:83], a[8:11], v[204:207], v[80:83]
    ds_read_b128 a[240:243], v1 offset:58368
    v_mfma_f32_16x16x32_bf16 v[80:83], a[12:15], v[220:223], v[80:83]
    v_mfma_f32_16x16x32_bf16 v[84:87], a[32:35], v[204:207], v[84:87]
    ds_read_b128 a[244:247], v1 offset:59392
    v_mfma_f32_16x16x32_bf16 v[84:87], a[36:39], v[220:223], v[84:87]
    v_mfma_f32_16x16x32_bf16 v[88:91], a[56:59], v[204:207], v[88:91]
    ds_read_b128 a[248:251], v1 offset:60416
    v_mfma_f32_16x16x32_bf16 v[88:91], a[60:63], v[220:223], v[88:91]
    v_mfma_f32_16x16x32_bf16 v[92:95], a[80:83], v[204:207], v[92:95]
    v_mfma_f32_16x16x32_bf16 v[92:95], a[84:87], v[220:223], v[92:95]
    v_mfma_f32_16x16x32_bf16 v[104:107], a[204:207], a[48:51], 0
    v_mfma_f32_16x16x32_bf16 v[104:107], a[208:211], a[52:55], v[104:107]
    v_mfma_f32_16x16x32_bf16 v[104:107], a[212:215], a[56:59], v[104:107]
    v_mfma_f32_16x16x32_bf16 v[104:107], a[216:219], a[60:63], v[104:107]
    v_mfma_f32_16x16x32_bf16 v[104:107], a[220:223], a[64:67], v[104:107]
    v_mfma_f32_16x16x32_bf16 v[104:107], a[224:227], a[68:71], v[104:107]
    v_mfma_f32_16x16x32_bf16 v[108:111], a[204:207], a[72:75], 0
    v_mfma_f32_16x16x32_bf16 v[108:111], a[208:211], a[76:79], v[108:111]
    v_mfma_f32_16x16x32_bf16 v[108:111], a[212:215], a[80:83], v[108:111]
    v_cvt_pk_bf16_f32 v200, v104, v105
    v_cvt_pk_bf16_f32 v201, v106, v107
    v_mfma_f32_16x16x32_bf16 v[108:111], a[216:219], a[84:87], v[108:111]
    v_mfma_f32_16x16x32_bf16 v[108:111], a[220:223], a[88:91], v[108:111]
    ds_read_b128 a[192:195], v1 offset:61440
    v_mfma_f32_16x16x32_bf16 v[108:111], a[224:227], a[92:95], v[108:111]
    s_waitcnt lgkmcnt(1)
    v_mfma_f32_16x16x32_bf16 v[112:115], a[228:231], a[0:3], 0
    ds_read_b128 a[196:199], v1 offset:62464
    v_mfma_f32_16x16x32_bf16 v[112:115], a[232:235], a[4:7], v[112:115]
    v_mfma_f32_16x16x32_bf16 v[112:115], a[236:239], a[8:11], v[112:115]
    buffer_store_dwordx2 v[188:189], v11, s[12:15], s39 offen offset:1024 sc1
    v_mfma_f32_16x16x32_bf16 v[112:115], a[240:243], a[12:15], v[112:115]
    ds_read_b128 a[200:203], v1 offset:63488
    v_cvt_pk_bf16_f32 v204, v108, v109
    v_mfma_f32_16x16x32_bf16 v[112:115], a[244:247], a[16:19], v[112:115]
    ds_read_b128 a[204:207], v1 offset:64512
    v_cvt_pk_bf16_f32 v205, v110, v111
    v_mfma_f32_16x16x32_bf16 v[112:115], a[248:251], a[20:23], v[112:115]
    v_mfma_f32_16x16x32_bf16 v[116:119], a[228:231], a[24:27], 0
    ds_read_b128 a[208:211], v2 offset:0
    v_mfma_f32_16x16x32_bf16 v[116:119], a[232:235], a[28:31], v[116:119]
    v_mfma_f32_16x16x32_bf16 v[116:119], a[236:239], a[32:35], v[116:119]
    ds_read_b128 a[212:215], v2 offset:1024
    v_cvt_pk_bf16_f32 v194, v112, v113
    v_mfma_f32_16x16x32_bf16 v[116:119], a[240:243], a[36:39], v[116:119]
    v_cvt_pk_bf16_f32 v195, v114, v115
    v_mfma_f32_16x16x32_bf16 v[116:119], a[244:247], a[40:43], v[116:119]
    v_mfma_f32_16x16x32_bf16 v[116:119], a[248:251], a[44:47], v[116:119]
    v_mfma_f32_16x16x32_bf16 v[120:123], a[228:231], a[48:51], 0
    v_mfma_f32_16x16x32_bf16 v[120:123], a[232:235], a[52:55], v[120:123]
    v_mfma_f32_16x16x32_bf16 v[120:123], a[236:239], a[56:59], v[120:123]
    v_cvt_pk_bf16_f32 v198, v116, v117
    v_cvt_pk_bf16_f32 v199, v118, v119
    v_mfma_f32_16x16x32_bf16 v[120:123], a[240:243], a[60:63], v[120:123]
    v_mfma_f32_16x16x32_bf16 v[120:123], a[244:247], a[64:67], v[120:123]
    v_mfma_f32_16x16x32_bf16 v[120:123], a[248:251], a[68:71], v[120:123]
    v_mfma_f32_16x16x32_bf16 v[124:127], a[228:231], a[72:75], 0
    v_mfma_f32_16x16x32_bf16 v[124:127], a[232:235], a[76:79], v[124:127]
    v_mfma_f32_16x16x32_bf16 v[124:127], a[236:239], a[80:83], v[124:127]
    v_cvt_pk_bf16_f32 v202, v120, v121
    v_cvt_pk_bf16_f32 v203, v122, v123
    v_mfma_f32_16x16x32_bf16 v[124:127], a[240:243], a[84:87], v[124:127]
    v_mfma_f32_16x16x32_bf16 v[124:127], a[244:247], a[88:91], v[124:127]
    ds_read_b128 a[216:219], v2 offset:2048
    v_mfma_f32_16x16x32_bf16 v[124:127], a[248:251], a[92:95], v[124:127]
    s_waitcnt lgkmcnt(1)
    v_mfma_f32_16x16x32_bf16 v[96:99], a[192:195], a[0:3], 0
    ds_read_b128 a[220:223], v2 offset:3072
    v_mfma_f32_16x16x32_bf16 v[96:99], a[196:199], a[4:7], v[96:99]
    v_mfma_f32_16x16x32_bf16 v[96:99], a[200:203], a[8:11], v[96:99]
    ds_read_b128 a[224:227], v2 offset:4096
    v_cvt_pk_bf16_f32 v206, v124, v125
    v_mfma_f32_16x16x32_bf16 v[96:99], a[204:207], a[12:15], v[96:99]
    buffer_store_dwordx2 v[190:191], v11, s[12:15], s39 offen offset:1408 sc1
    v_mfma_f32_16x16x32_bf16 v[96:99], a[208:211], a[16:19], v[96:99]
    s_add_u32 s39, s16, 4325376
    ds_read_b128 a[228:231], v2 offset:5120
    v_cvt_pk_bf16_f32 v207, v126, v127
    v_mfma_f32_16x16x32_bf16 v[96:99], a[212:215], a[20:23], v[96:99]
    v_mfma_f32_16x16x32_bf16 v[100:103], a[192:195], a[24:27], 0
    buffer_load_dwordx4 a[144:147], v9, s[8:11], s28 offen offset:0 nt
    v_mfma_f32_16x16x32_bf16 v[100:103], a[196:199], a[28:31], v[100:103]
    buffer_load_dwordx4 a[148:151], v10, s[8:11], s28 offen offset:0 nt
    v_mfma_f32_16x16x32_bf16 v[100:103], a[200:203], a[32:35], v[100:103]
    ds_read_b128 a[232:235], v2 offset:6144
    v_cvt_pk_bf16_f32 v208, v96, v97
    v_mfma_f32_16x16x32_bf16 v[100:103], a[204:207], a[36:39], v[100:103]
    ds_read_b128 a[236:239], v2 offset:7168
    v_cvt_pk_bf16_f32 v209, v98, v99
    v_mfma_f32_16x16x32_bf16 v[100:103], a[208:211], a[40:43], v[100:103]
    s_waitcnt vmcnt(28)
    ds_write_b32 v4, a96 offset:0
    v_mfma_f32_16x16x32_bf16 v[100:103], a[212:215], a[44:47], v[100:103]
    ds_write_b32 v4, a97 offset:4
    v_mfma_f32_16x16x32_bf16 v[104:107], a[192:195], a[48:51], 0
    ds_write_b32 v4, a98 offset:1024
    v_mfma_f32_16x16x32_bf16 v[104:107], a[196:199], a[52:55], v[104:107]
    ds_write_b32 v4, a99 offset:1028
    v_mfma_f32_16x16x32_bf16 v[104:107], a[200:203], a[56:59], v[104:107]
    ds_write_b32 v4, a100 offset:512
    v_mfma_f32_16x16x32_bf16 v[104:107], a[204:207], a[60:63], v[104:107]
    ds_write_b32 v4, a101 offset:516
    v_mfma_f32_16x16x32_bf16 v[104:107], a[208:211], a[64:67], v[104:107]
    ds_write_b32 v4, a102 offset:1536
    v_mfma_f32_16x16x32_bf16 v[104:107], a[212:215], a[68:71], v[104:107]
    ds_write_b32 v4, a103 offset:1540
    v_mfma_f32_16x16x32_bf16 v[108:111], a[192:195], a[72:75], 0
    ds_read2_b64 a[96:99], v5 offset0:0 offset1:128
    v_cvt_pk_bf16_f32 v212, v100, v101
    v_mfma_f32_16x16x32_bf16 v[108:111], a[196:199], a[76:79], v[108:111]
    ds_read2_b64 a[100:103], v6 offset0:0 offset1:128
    v_cvt_pk_bf16_f32 v213, v102, v103
    v_mfma_f32_16x16x32_bf16 v[108:111], a[200:203], a[80:83], v[108:111]
    v_cvt_pk_bf16_f32 v216, v104, v105
    v_cvt_pk_bf16_f32 v217, v106, v107
    v_mfma_f32_16x16x32_bf16 v[108:111], a[204:207], a[84:87], v[108:111]
    v_mfma_f32_16x16x32_bf16 v[108:111], a[208:211], a[88:91], v[108:111]
    ds_read_b128 a[240:243], v2 offset:8192
    v_mfma_f32_16x16x32_bf16 v[108:111], a[212:215], a[92:95], v[108:111]
    s_waitcnt lgkmcnt(11)
    v_mfma_f32_16x16x32_bf16 v[112:115], a[216:219], a[0:3], 0
    ds_read_b128 a[244:247], v2 offset:9216
    v_mfma_f32_16x16x32_bf16 v[112:115], a[220:223], a[4:7], v[112:115]
    v_mfma_f32_16x16x32_bf16 v[112:115], a[224:227], a[8:11], v[112:115]
    ds_read_b128 a[248:251], v2 offset:10240
    v_cvt_pk_bf16_f32 v220, v108, v109
    v_mfma_f32_16x16x32_bf16 v[112:115], a[228:231], a[12:15], v[112:115]
    v_cvt_pk_bf16_f32 v221, v110, v111
    v_mfma_f32_16x16x32_bf16 v[112:115], a[232:235], a[16:19], v[112:115]
    ds_read_b128 a[192:195], v2 offset:11264
    v_mfma_f32_16x16x32_bf16 v[112:115], a[236:239], a[20:23], v[112:115]
    v_mfma_f32_16x16x32_bf16 v[116:119], a[216:219], a[24:27], 0
    ds_read_b128 a[196:199], v2 offset:12288
    v_mfma_f32_16x16x32_bf16 v[116:119], a[220:223], a[28:31], v[116:119]
    s_waitcnt vmcnt(22)
    ds_write_b32 v4, a104 offset:0
    v_mfma_f32_16x16x32_bf16 v[116:119], a[224:227], a[32:35], v[116:119]
    ds_read_b128 a[200:203], v2 offset:13312
    v_cvt_pk_bf16_f32 v210, v112, v113
    v_mfma_f32_16x16x32_bf16 v[116:119], a[228:231], a[36:39], v[116:119]
    ds_write_b32 v4, a105 offset:4
    v_mfma_f32_16x16x32_bf16 v[116:119], a[232:235], a[40:43], v[116:119]
    ds_write_b32 v4, a106 offset:1024
    v_mfma_f32_16x16x32_bf16 v[116:119], a[236:239], a[44:47], v[116:119]
    ds_write_b32 v4, a107 offset:1028
    v_mfma_f32_16x16x32_bf16 v[120:123], a[216:219], a[48:51], 0
    ds_write_b32 v4, a108 offset:512
    v_mfma_f32_16x16x32_bf16 v[120:123], a[220:223], a[52:55], v[120:123]
    ds_write_b32 v4, a109 offset:516
    v_mfma_f32_16x16x32_bf16 v[120:123], a[224:227], a[56:59], v[120:123]
    ds_write_b32 v4, a110 offset:1536
    v_mfma_f32_16x16x32_bf16 v[120:123], a[228:231], a[60:63], v[120:123]
    ds_write_b32 v4, a111 offset:1540
    v_mfma_f32_16x16x32_bf16 v[120:123], a[232:235], a[64:67], v[120:123]
    ds_read2_b64 a[104:107], v5 offset0:0 offset1:128
    v_cvt_pk_bf16_f32 v211, v114, v115
    v_mfma_f32_16x16x32_bf16 v[120:123], a[236:239], a[68:71], v[120:123]
    ds_read2_b64 a[108:111], v6 offset0:0 offset1:128
    v_cvt_pk_bf16_f32 v214, v116, v117
    v_mfma_f32_16x16x32_bf16 v[124:127], a[216:219], a[72:75], 0
    v_cvt_pk_bf16_f32 v215, v118, v119
    v_mfma_f32_16x16x32_bf16 v[124:127], a[220:223], a[76:79], v[124:127]
    v_mfma_f32_16x16x32_bf16 v[124:127], a[224:227], a[80:83], v[124:127]
    v_cvt_pk_bf16_f32 v218, v120, v121
    v_cvt_pk_bf16_f32 v219, v122, v123
    v_mfma_f32_16x16x32_bf16 v[124:127], a[228:231], a[84:87], v[124:127]
    v_mfma_f32_16x16x32_bf16 v[124:127], a[232:235], a[88:91], v[124:127]
    v_mfma_f32_16x16x32_bf16 v[124:127], a[236:239], a[92:95], v[124:127]
    s_waitcnt lgkmcnt(8)
    v_mfma_f32_16x16x32_bf16 v[96:99], a[0:3], a[240:243], 0
    v_mfma_f32_16x16x32_bf16 v[96:99], a[4:7], a[244:247], v[96:99]
    v_mfma_f32_16x16x32_bf16 v[96:99], a[8:11], a[248:251], v[96:99]
    v_cvt_pk_bf16_f32 v222, v124, v125
    v_cvt_pk_bf16_f32 v223, v126, v127
    v_mfma_f32_16x16x32_bf16 v[96:99], a[12:15], a[192:195], v[96:99]
    v_mfma_f32_16x16x32_bf16 v[96:99], a[16:19], a[196:199], v[96:99]
    v_mfma_f32_16x16x32_bf16 v[96:99], a[20:23], a[200:203], v[96:99]
    v_mfma_f32_16x16x32_bf16 v[100:103], a[24:27], a[240:243], 0
    v_mfma_f32_16x16x32_bf16 v[100:103], a[28:31], a[244:247], v[100:103]
    v_mfma_f32_16x16x32_bf16 v[100:103], a[32:35], a[248:251], v[100:103]
    s_waitcnt vmcnt(17)
    ds_write_b32 v4, a112 offset:0
    v_mfma_f32_16x16x32_bf16 v[100:103], a[36:39], a[192:195], v[100:103]
    ds_write_b32 v4, a113 offset:4
    v_mfma_f32_16x16x32_bf16 v[100:103], a[40:43], a[196:199], v[100:103]
    ds_write_b32 v4, a114 offset:1024
    v_mfma_f32_16x16x32_bf16 v[100:103], a[44:47], a[200:203], v[100:103]
    ds_write_b32 v4, a115 offset:1028
    v_mfma_f32_16x16x32_bf16 v[32:35], a[16:19], v[192:195], v[32:35]
    ds_write_b32 v4, a116 offset:512
    v_mfma_f32_16x16x32_bf16 v[32:35], a[20:23], v[208:211], v[32:35]
    ds_write_b32 v4, a117 offset:516
    v_mfma_f32_16x16x32_bf16 v[36:39], a[40:43], v[192:195], v[36:39]
    buffer_load_dwordx4 a[168:171], v9, s[8:11], s30 offen offset:0 nt
    v_cvt_pk_bf16_f32 v128, v96, v97
    v_mfma_f32_16x16x32_bf16 v[36:39], a[44:47], v[208:211], v[36:39]
    buffer_load_dwordx4 a[172:175], v10, s[8:11], s30 offen offset:0 nt
    v_cvt_pk_bf16_f32 v129, v98, v99
    s_mov_b32 s18, 1
    s_mov_b32 s19, 0
    s_branch L_loop
L_slow0:
    s_sub_u32 s43, s43, 1
    s_cbranch_scc1 L_end
    ds_read_b32 v30, v29
    s_waitcnt lgkmcnt(0)
    v_readfirstlane_b32 s41, v30
    s_nop 1
    s_andn2_b32 s41, 1, s41
    s_cbranch_scc1 L_slow0
    s_branch L_ok0
L_slow1:
    s_sub_u32 s43, s43, 1
    s_cbranch_scc1 L_end
    ds_read_b32 v30, v29
    s_waitcnt lgkmcnt(0)
    v_readfirstlane_b32 s41, v30
    s_nop 1
    s_andn2_b32 s41, 2, s41
    s_cbranch_scc1 L_slow1
    s_branch L_ok1
L_slow2:
    s_sub_u32 s43, s43, 1
    s_cbranch_scc1 L_end
    ds_read_b32 v30, v29
    s_waitcnt lgkmcnt(0)
    v_readfirstlane_b32 s41, v30
    s_nop 1
    s_andn2_b32 s41, 4, s41
    s_cbranch_scc1 L_slow2
    s_branch L_ok2
L_slow3:
    s_sub_u32 s43, s43, 1
    s_cbranch_scc1 L_end
    ds_read_b32 v30, v29
    s_waitcnt lgkmcnt(0)
    v_readfirstlane_b32 s41, v30
    s_nop 1
    s_andn2_b32 s41, 8, s41
    s_cbranch_scc1 L_slow3
    s_branch L_ok3
L_slow4:
    s_sub_u32 s43, s43, 1
    s_cbranch_scc1 L_end
    ds_read_b32 v30, v29
    s_waitcnt lgkmcnt(0)
    v_readfirstlane_b32 s41, v30
    s_nop 1
    s_andn2_b32 s41, 16, s41
    s_cbranch_scc1 L_slow4
    s_branch L_ok4
L_slow5:
    s_sub_u32 s43, s43, 1
    s_cbranch_scc1 L_end
    ds_read_b32 v30, v29
    s_waitcnt lgkmcnt(0)
    v_readfirstlane_b32 s41, v30
    s_nop 1
    s_andn2_b32 s41, 32, s41
    s_cbranch_scc1 L_slow5
    s_branch L_ok5
L_slow6:
    s_sub_u32 s43, s43, 1
    s_cbranch_scc1 L_end
    ds_read_b32 v30, v29
    s_waitcnt lgkmcnt(0)
    v_readfirstlane_b32 s41, v30
    s_nop 1
    s_andn2_b32 s41, 960, s41
    s_cbranch_scc1 L_slow6
    s_branch L_ok6
L_fb:
    s_mov_b32 s60, 0
    s_cmp_lt_u32 s2, 192
    s_cbranch_scc0 L_fb_task
L_fbw:
    s_sub_u32 s43, s43, 1
    s_cbranch_scc1 L_end
    ds_read_b32 v34, v29 offset:4
    s_waitcnt lgkmcnt(0)
    v_readfirstlane_b32 s61, v34
    s_nop 1
    s_cmp_eq_u32 s61, 3
    s_cbranch_scc0 L_fbw
L_fb_task:
    s_mov_b32 s63, 3
    s_branch L_raw
L_fb_raw:
    s_bitcmp1_b32 s63, 1
    s_mov_b32 s63, 1
    s_cbranch_scc1 L_raw
    s_branch L_prod
L_fb_next:
    s_waitcnt vmcnt(0)
    s_add_u32 s60, s60, 1
    s_cmp_lt_u32 s60, 72
    s_cbranch_scc1 L_fb_task
    s_branch L_go
L_code_end:
.section .rodata,"a"
.p2align 6
.amdhsa_kernel standalone__swin_window_attn__vision_kernel
  .amdhsa_next_free_vgpr 512
  .amdhsa_next_free_sgpr 102
  .amdhsa_accum_offset 256
  .amdhsa_group_segment_fixed_size 0
  .amdhsa_kernarg_size 48
  .amdhsa_user_sgpr_count 2
  .amdhsa_user_sgpr_kernarg_segment_ptr 1
  .amdhsa_system_sgpr_workgroup_id_x 1
.end_amdhsa_kernel
```

```asm
; @launch grid=(256,1,1) block=(256,1,1) lds=163840
.amdgcn_target "amdgcn-amd-amdhsa--gfx950"
.text
.globl standalone__swin_window_attn__vision_kernel
.p2align 8
.type standalone__swin_window_attn__vision_kernel,@function
standalone__swin_window_attn__vision_kernel:
    s_cmp_ge_u32 s2, 256
    s_cbranch_scc1 L_end
    s_load_dwordx4 s[4:7], s[0:1], 0
    s_load_dwordx4 s[20:23], s[0:1], 16
    s_load_dwordx4 s[56:59], s[0:1], 32
    v_lshrrev_b32 v16, 6, v0
    v_and_b32 v0, 63, v0
    s_getpc_b64 s[44:45]
L_pc_ref:
    v_readfirstlane_b32 s49, v16
    s_mov_b32 s46, L_code_end-L_pc_ref
    s_mov_b32 s47, 0x00020000
    v_lshlrev_b32 v7, 6, v0
    s_lshr_b32 s60, s2, 3

    s_lshl_b32 s42, s60, 2
    s_add_u32 s42, s42, s49
    s_lshl_b32 s42, s42, 7
    v_lshrrev_b32 v8, 1, v0
    v_and_b32 v7, 1, v0
    v_lshlrev_b32 v7, 6, v7
    v_lshl_add_u32 v8, v8, 14, v7
    buffer_load_dword v8, v8, s[44:47], s42 offen
    s_cmp_lt_u32 s60, 24
    s_cbranch_scc0 L_setup
    s_cmp_ge_u32 s60, 12
    s_cselect_b32 s61, 12, 0
    s_cselect_b32 s62, 36, 0
    s_sub_u32 s61, s60, s61
    s_and_b32 s64, s61, 1
    s_mul_i32 s64, s64, 3
    s_max_u32 s65, s49, 1
    s_add_u32 s64, s64, s65
    s_sub_u32 s64, s64, 1
    s_mul_i32 s64, s64, 6
    s_lshr_b32 s61, s61, 1
    s_add_u32 s60, s64, s61
    s_add_u32 s60, s60, s62
    s_cmp_eq_u32 s49, 0
    s_cselect_b32 s63, 2, 0
L_raw:
    s_cmp_ge_u32 s60, 36
    s_cselect_b32 s65, 36, 0
    s_cselect_b32 s97, 768, 0
    s_sub_u32 s65, s60, s65
    s_mul_i32 s66, s65, 43
    s_lshr_b32 s66, s66, 8
    s_mul_i32 s67, s66, 6
    s_sub_u32 s67, s65, s67
    s_max_u32 s64, s49, 1
    s_mul_i32 s64, s64, 12288
    s_mul_i32 s61, s66, 36864
    s_add_u32 s61, s61, 384
    s_mul_i32 s62, s67, 36864
    s_add_u32 s62, s62, s97
    s_bitcmp1_b32 s63, 1
    s_cselect_b32 s61, s62, s61
    s_cselect_b32 s64, 0, s64
    s_cselect_b32 s97, 0, s97
    s_movk_i32 s62, 128
    s_movk_i32 s65, 9216
    s_mov_b32 s96, 32
    v_lshrrev_b32 v16, 3, v0
    v_and_b32 v17, 7, v0
    v_bfe_u32 v18, v0, 4, 1
    v_xor_b32 v17, v17, v18
    v_lshlrev_b32 v17, 4, v17
    v_mul_u32_u24 v16, 1152, v16
    s_cmp_eq_u32 s97, 0
    s_mov_b32 s18, 221184
    s_cbranch_scc1 L_raw_rows
    s_mov_b32 s18, 73728
    s_lshl_b32 s61, s66, 6
    s_movk_i32 s62, 6144
    s_movk_i32 s65, 18432
    s_mov_b32 s96, 0
    v_lshrrev_b32 v16, 2, v0
    v_mul_u32_u24 v16, 384, v16
    v_and_b32 v17, 3, v0
    v_lshlrev_b32 v17, 4, v17
L_raw_rows:
    s_waitcnt lgkmcnt(0)
    s_cmp_eq_u32 s97, 0
    s_cselect_b32 s16, s6, s20
    s_cselect_b32 s17, s7, s21
    s_mov_b32 s19, 0x00020000
    s_mov_b32 m0, s64
    s_mov_b32 s97, 4
L_raw_lp:
    v_add_u32 v18, v16, v17
    s_add_u32 s42, s61, s62
    buffer_load_dwordx4 v18, s[16:19], s61 offen lds
    s_add_u32 m0, m0, 1024
    s_add_u32 s41, s42, s62
    buffer_load_dwordx4 v18, s[16:19], s42 offen lds
    s_add_u32 m0, m0, 1024
    s_add_u32 s61, s61, s65
    buffer_load_dwordx4 v18, s[16:19], s41 offen lds
    s_add_u32 m0, m0, 1024
    s_and_b32 s42, s97, 1
    s_mul_i32 s42, s42, s96
    s_lshl_b32 s42, s42, 1
    s_add_u32 s42, s42, s96
    v_xor_b32 v17, s42, v17
    s_sub_u32 s97, s97, 1
    s_cmp_lg_u32 s97, 0
    s_cbranch_scc1 L_raw_lp
    s_bitcmp1_b32 s63, 0
    s_cbranch_scc1 L_fb_raw
L_setup:
    s_mov_b32 s43, 0x400000
    v_lshlrev_b32 v1, 4, v0
    v_add_u32 v2, 0x10000, v1
    v_add_u32 v3, 0x20000, v1
    v_lshrrev_b32 v16, 3, v0
    v_and_b32 v17, 7, v0
    v_lshrrev_b32 v18, 4, v0
    v_xor_b32 v17, v17, v18
    v_lshlrev_b32 v17, 4, v17
    v_mul_u32_u24 v16, 384, v16
    v_add_u32 v9, v16, v17
    v_xor_b32 v10, 64, v9
    v_add_u32 v10, 196608, v10
    s_lshl_b32 s52, s49, 11
    s_add_u32 s52, s52, 147456
    v_lshlrev_b32 v16, 3, v0
    v_add_u32 v4, s52, v16
    v_and_b32 v16, 15, v0
    v_lshrrev_b32 v17, 4, v0
    v_lshrrev_b32 v18, 1, v16
    v_xor_b32 v18, v18, v17
    v_lshlrev_b32 v18, 3, v18
    v_lshl_add_u32 v18, v16, 6, v18
    v_add_u32 v5, s52, v18
    v_xor_b32 v6, 32, v5
    v_lshrrev_b32 v16, 5, v0
    v_mul_u32_u24 v16, 196608, v16
    v_lshrrev_b32 v17, 4, v0
    v_and_b32 v17, 1, v17
    v_mul_u32_u24 v17, 1536, v17
    v_and_b32 v18, 15, v0
    v_lshlrev_b32 v18, 3, v18
    v_add3_u32 v11, v16, v17, v18
    s_nop 0
    s_and_b32 s53, s2, 7
    s_lshl_b32 s53, s53, 3
    s_lshr_b32 s54, s2, 7
    s_add_u32 s53, s53, s54
    s_lshr_b32 s54, s2, 3
    s_and_b32 s54, s54, 15
    s_mul_i32 s53, s53, 1572864
    s_lshl_b32 s54, s54, 2
    s_add_u32 s54, s54, s49
    s_mul_i32 s54, s54, 3072
    s_add_u32 s53, s53, s54
    s_add_u32 s24, s53, 0
    s_add_u32 s26, s53, 393216
    s_add_u32 s28, s53, 786432
    s_add_u32 s30, s53, 1179648
    v_mov_b32 v29, 155648
    v_mov_b32 v30, 0
    v_mov_b32 v31, 0
    ds_write_b64 v29, v[30:31]
    s_getreg_b32 s48, hwreg(HW_REG_XCC_ID, 0, 3)
    s_waitcnt lgkmcnt(0)
    s_mov_b32 s8, s4
    s_mov_b32 s9, s5
    s_mov_b32 s10, 100663296
    s_mov_b32 s11, 0x00020000
    s_barrier
    s_cmp_eq_u32 s49, 0
    s_cbranch_scc0 L_nox0
    buffer_load_dwordx4 a[0:3], v9, s[8:11], s24 offen offset:0 nt
    buffer_load_dwordx4 a[4:7], v10, s[8:11], s24 offen offset:0 nt
    buffer_load_dwordx4 a[8:11], v9, s[8:11], s24 offen offset:128 nt
    buffer_load_dwordx4 a[12:15], v10, s[8:11], s24 offen offset:128 nt
    buffer_load_dwordx4 a[16:19], v9, s[8:11], s24 offen offset:256 nt
    buffer_load_dwordx4 a[20:23], v10, s[8:11], s24 offen offset:256 nt
    buffer_load_dwordx4 a[24:27], v9, s[8:11], s26 offen offset:0 nt
    buffer_load_dwordx4 a[28:31], v10, s[8:11], s26 offen offset:0 nt
    buffer_load_dwordx4 a[32:35], v9, s[8:11], s26 offen offset:128 nt
    buffer_load_dwordx4 a[36:39], v10, s[8:11], s26 offen offset:128 nt
    buffer_load_dwordx4 a[40:43], v9, s[8:11], s26 offen offset:256 nt
    buffer_load_dwordx4 a[44:47], v10, s[8:11], s26 offen offset:256 nt
    buffer_load_dwordx4 a[48:51], v9, s[8:11], s28 offen offset:0 nt
    buffer_load_dwordx4 a[52:55], v10, s[8:11], s28 offen offset:0 nt
    buffer_load_dwordx4 a[56:59], v9, s[8:11], s28 offen offset:128 nt
    buffer_load_dwordx4 a[60:63], v10, s[8:11], s28 offen offset:128 nt
    buffer_load_dwordx4 a[64:67], v9, s[8:11], s28 offen offset:256 nt
    buffer_load_dwordx4 a[68:71], v10, s[8:11], s28 offen offset:256 nt
    buffer_load_dwordx4 a[72:75], v9, s[8:11], s30 offen offset:0 nt
    buffer_load_dwordx4 a[76:79], v10, s[8:11], s30 offen offset:0 nt
    buffer_load_dwordx4 a[80:83], v9, s[8:11], s30 offen offset:128 nt
    buffer_load_dwordx4 a[84:87], v10, s[8:11], s30 offen offset:128 nt
    buffer_load_dwordx4 a[88:91], v9, s[8:11], s30 offen offset:256 nt
    buffer_load_dwordx4 a[92:95], v10, s[8:11], s30 offen offset:256 nt
L_nox0:
    s_mov_b32 s3, s53
    s_mov_b32 s12, s22
    s_mov_b32 s13, s23
    s_mov_b32 s14, 100663296
    s_mov_b32 s15, 0x00020000
    s_mov_b32 s40, 0x3dd53b95
    s_mov_b32 s50, s58
    s_mov_b32 s51, s59
    s_mov_b32 s58, 256
    s_mov_b32 s59, 0x00020000
    s_mul_i32 s52, s48, 147456
    s_add_u32 s52, s50, s52
    s_addc_u32 s53, s51, 0
    s_mov_b32 s54, 147456
    s_mov_b32 s55, 0x00020000
    s_lshl_b32 s48, s48, 5
    s_lshl_b32 s42, 4096, s49
    v_mov_b32 v31, s42
    s_cmp_eq_u32 s49, 0
    s_cbranch_scc1 L_w0
    s_cmp_lt_u32 s2, 192
    s_cbranch_scc0 L_noprod
L_prod:
    s_mul_i32 s61, s66, 12
    s_add_u32 s61, s61, s67
    s_lshl_b32 s61, s61, 10
    s_add_u32 s62, s61, 6144
    v_mov_b32 v27, v1
    v_bfe_u32 v22, v0, 2, 2
    v_and_b32 v23, 3, v0
    v_lshrrev_b32 v26, 4, v0
    s_cmp_ge_u32 s60, 36
    s_cbranch_scc0 L_prod_A
    v_mul_u32_u24 v27, 6144, v23
    v_lshlrev_b32 v24, 8, v26
    v_lshlrev_b32 v25, 4, v22
    v_add3_u32 v27, v27, v24, v25
    s_lshr_b32 s61, s66, 1
    s_mul_i32 s61, s61, 24576
    s_and_b32 s62, s66, 1
    s_lshl_b32 s62, s62, 7
    s_add_u32 s61, s61, s62
    s_lshl_b32 s62, s67, 10
    s_add_u32 s61, s61, s62
    s_add_u32 s61, s61, 73728
    s_add_u32 s62, s61, 64
L_prod_A:
    v_mul_u32_u24 v24, 3072, v22
    v_lshl_add_u32 v24, v23, 7, v24
    v_bfe_u32 v25, v0, 1, 1
    v_lshl_add_u32 v25, v22, 1, v25
    v_xor_b32 v25, v25, v26
    v_lshl_add_u32 v24, v25, 4, v24
    v_xor_b32 v25, 64, v24
    v_lshl_add_u32 v26, v26, 3, v22
    v_lshlrev_b32 v26, 6, v26
    v_lshl_add_u32 v26, v23, 3, v26
    v_add_u32 v26, s64, v26
    s_waitcnt vmcnt(0)
    s_bitcmp1_b32 s63, 0
    s_cbranch_scc1 L_gotA
L_wA:
    s_sub_u32 s43, s43, 1
    s_cbranch_scc1 L_end
    ds_read_b32 v30, v29
    s_waitcnt lgkmcnt(0)
    v_readfirstlane_b32 s41, v30
    s_nop 1
    s_and_b32 s42, s41, 0x100000
    s_cmp_eq_u32 s42, 0x100000
    s_cbranch_scc0 L_wA
L_gotA:
    ds_read_b128 v[32:35], v24 offset:0
    ds_read_b128 v[56:59], v24 offset:512
    ds_read_b128 v[36:39], v25 offset:0
    ds_read_b128 v[60:63], v25 offset:512
    ds_read_b128 v[40:43], v24 offset:1024
    ds_read_b128 v[64:67], v24 offset:1536
    ds_read_b128 v[44:47], v25 offset:1024
    ds_read_b128 v[68:71], v25 offset:1536
    ds_read_b128 v[48:51], v24 offset:2048
    ds_read_b128 v[72:75], v24 offset:2560
    ds_read_b128 v[52:55], v25 offset:2048
    ds_read_b128 v[76:79], v25 offset:2560
    s_cmp_ge_u32 s60, 36
    s_cbranch_scc1 L_prod_N2
    v_add_u32 v24, s64, v24
    v_add_u32 v25, s64, v25
    ds_read_b128 v[80:83], v24 offset:0
    ds_read_b128 v[104:107], v24 offset:512
    ds_read_b128 v[84:87], v25 offset:0
    ds_read_b128 v[108:111], v25 offset:512
    ds_read_b128 v[88:91], v24 offset:1024
    ds_read_b128 v[112:115], v24 offset:1536
    ds_read_b128 v[92:95], v25 offset:1024
    ds_read_b128 v[116:119], v25 offset:1536
    ds_read_b128 v[96:99], v24 offset:2048
    ds_read_b128 v[120:123], v24 offset:2560
    ds_read_b128 v[100:103], v25 offset:2048
    ds_read_b128 v[124:127], v25 offset:2560
    s_branch L_prod_mm
L_prod_N2:
    ds_read_b64_tr_b16 v[80:81], v26 offset:0
    ds_read_b64_tr_b16 v[82:83], v26 offset:256
    ds_read_b64_tr_b16 v[104:105], v26 offset:32
    ds_read_b64_tr_b16 v[106:107], v26 offset:288
    ds_read_b64_tr_b16 v[84:85], v26 offset:2048
    ds_read_b64_tr_b16 v[86:87], v26 offset:2304
    ds_read_b64_tr_b16 v[108:109], v26 offset:2080
    ds_read_b64_tr_b16 v[110:111], v26 offset:2336
    ds_read_b64_tr_b16 v[88:89], v26 offset:4096
    ds_read_b64_tr_b16 v[90:91], v26 offset:4352
    ds_read_b64_tr_b16 v[112:113], v26 offset:4128
    ds_read_b64_tr_b16 v[114:115], v26 offset:4384
    ds_read_b64_tr_b16 v[92:93], v26 offset:6144
    ds_read_b64_tr_b16 v[94:95], v26 offset:6400
    ds_read_b64_tr_b16 v[116:117], v26 offset:6176
    ds_read_b64_tr_b16 v[118:119], v26 offset:6432
    ds_read_b64_tr_b16 v[96:97], v26 offset:8192
    ds_read_b64_tr_b16 v[98:99], v26 offset:8448
    ds_read_b64_tr_b16 v[120:121], v26 offset:8224
    ds_read_b64_tr_b16 v[122:123], v26 offset:8480
    ds_read_b64_tr_b16 v[100:101], v26 offset:10240
    ds_read_b64_tr_b16 v[102:103], v26 offset:10496
    ds_read_b64_tr_b16 v[124:125], v26 offset:10272
    ds_read_b64_tr_b16 v[126:127], v26 offset:10528
L_prod_mm:
    s_cmp_ge_u32 s60, 36
    s_cselect_b32 s65, 1.0, s40
    s_waitcnt lgkmcnt(0)
    v_mfma_f32_16x16x32_bf16 v[128:131], v[32:35], v[80:83], 0
    v_mfma_f32_16x16x32_bf16 v[132:135], v[56:59], v[80:83], 0
    v_mfma_f32_16x16x32_bf16 v[128:131], v[36:39], v[84:87], v[128:131]
    v_mfma_f32_16x16x32_bf16 v[132:135], v[60:63], v[84:87], v[132:135]
    v_mfma_f32_16x16x32_bf16 v[128:131], v[40:43], v[88:91], v[128:131]
    v_mfma_f32_16x16x32_bf16 v[132:135], v[64:67], v[88:91], v[132:135]
    v_mfma_f32_16x16x32_bf16 v[128:131], v[44:47], v[92:95], v[128:131]
    v_mfma_f32_16x16x32_bf16 v[132:135], v[68:71], v[92:95], v[132:135]
    v_mfma_f32_16x16x32_bf16 v[128:131], v[48:51], v[96:99], v[128:131]
    v_mfma_f32_16x16x32_bf16 v[132:135], v[72:75], v[96:99], v[132:135]
    v_mfma_f32_16x16x32_bf16 v[128:131], v[52:55], v[100:103], v[128:131]
    v_mfma_f32_16x16x32_bf16 v[132:135], v[76:79], v[100:103], v[132:135]
    v_mfma_f32_16x16x32_bf16 v[136:139], v[32:35], v[104:107], 0
    v_mfma_f32_16x16x32_bf16 v[140:143], v[56:59], v[104:107], 0
    v_mfma_f32_16x16x32_bf16 v[136:139], v[36:39], v[108:111], v[136:139]
    v_mfma_f32_16x16x32_bf16 v[140:143], v[60:63], v[108:111], v[140:143]
    v_mfma_f32_16x16x32_bf16 v[136:139], v[40:43], v[112:115], v[136:139]
    v_mfma_f32_16x16x32_bf16 v[140:143], v[64:67], v[112:115], v[140:143]
    v_mfma_f32_16x16x32_bf16 v[136:139], v[44:47], v[116:119], v[136:139]
    v_mfma_f32_16x16x32_bf16 v[140:143], v[68:71], v[116:119], v[140:143]
    v_mfma_f32_16x16x32_bf16 v[136:139], v[48:51], v[120:123], v[136:139]
    v_mfma_f32_16x16x32_bf16 v[140:143], v[72:75], v[120:123], v[140:143]
    v_mfma_f32_16x16x32_bf16 v[136:139], v[52:55], v[124:127], v[136:139]
    v_mfma_f32_16x16x32_bf16 v[140:143], v[76:79], v[124:127], v[140:143]
    v_mul_f32 v128, s65, v128
    v_mul_f32 v129, s65, v129
    v_mul_f32 v130, s65, v130
    v_mul_f32 v131, s65, v131
    v_mul_f32 v132, s65, v132
    v_mul_f32 v133, s65, v133
    v_mul_f32 v134, s65, v134
    v_mul_f32 v135, s65, v135
    v_cvt_pk_bf16_f32 v144, v128, v129
    v_cvt_pk_bf16_f32 v145, v130, v131
    v_cvt_pk_bf16_f32 v146, v132, v133
    v_cvt_pk_bf16_f32 v147, v134, v135
    buffer_store_dwordx4 v[144:147], v27, s[52:55], s61 offen
    s_nop 7
    v_mul_f32 v136, s65, v136
    v_mul_f32 v137, s65, v137
    v_mul_f32 v138, s65, v138
    v_mul_f32 v139, s65, v139
    v_mul_f32 v140, s65, v140
    v_mul_f32 v141, s65, v141
    v_mul_f32 v142, s65, v142
    v_mul_f32 v143, s65, v143
    v_cvt_pk_bf16_f32 v148, v136, v137
    v_cvt_pk_bf16_f32 v149, v138, v139
    v_cvt_pk_bf16_f32 v150, v140, v141
    v_cvt_pk_bf16_f32 v151, v142, v143
    buffer_store_dwordx4 v[148:151], v27, s[52:55], s62 offen
    s_bitcmp1_b32 s63, 0
    s_cbranch_scc1 L_fb_next
    s_cmp_eq_u32 s49, 1
    s_cbranch_scc0 L_p23
    buffer_load_dwordx4 a[0:3], v9, s[8:11], s24 offen offset:0 nt
    buffer_load_dwordx4 a[4:7], v10, s[8:11], s24 offen offset:0 nt
    buffer_load_dwordx4 a[8:11], v9, s[8:11], s24 offen offset:128 nt
    buffer_load_dwordx4 a[12:15], v10, s[8:11], s24 offen offset:128 nt
    buffer_load_dwordx4 a[16:19], v9, s[8:11], s24 offen offset:256 nt
    buffer_load_dwordx4 a[20:23], v10, s[8:11], s24 offen offset:256 nt
    buffer_load_dwordx4 a[24:27], v9, s[8:11], s26 offen offset:0 nt
    buffer_load_dwordx4 a[28:31], v10, s[8:11], s26 offen offset:0 nt
    buffer_load_dwordx4 a[32:35], v9, s[8:11], s26 offen offset:128 nt
    buffer_load_dwordx4 a[36:39], v10, s[8:11], s26 offen offset:128 nt
    buffer_load_dwordx4 a[40:43], v9, s[8:11], s26 offen offset:256 nt
    buffer_load_dwordx4 a[44:47], v10, s[8:11], s26 offen offset:256 nt
    buffer_load_dwordx4 a[48:51], v9, s[8:11], s28 offen offset:0 nt
    buffer_load_dwordx4 a[52:55], v10, s[8:11], s28 offen offset:0 nt
    buffer_load_dwordx4 a[56:59], v9, s[8:11], s28 offen offset:128 nt
    buffer_load_dwordx4 a[60:63], v10, s[8:11], s28 offen offset:128 nt
    buffer_load_dwordx4 a[64:67], v9, s[8:11], s28 offen offset:256 nt
    buffer_load_dwordx4 a[68:71], v10, s[8:11], s28 offen offset:256 nt
    buffer_load_dwordx4 a[72:75], v9, s[8:11], s30 offen offset:0 nt
    buffer_load_dwordx4 a[76:79], v10, s[8:11], s30 offen offset:0 nt
    buffer_load_dwordx4 a[80:83], v9, s[8:11], s30 offen offset:128 nt
    buffer_load_dwordx4 a[84:87], v10, s[8:11], s30 offen offset:128 nt
    buffer_load_dwordx4 a[88:91], v9, s[8:11], s30 offen offset:256 nt
    buffer_load_dwordx4 a[92:95], v10, s[8:11], s30 offen offset:256 nt
    s_waitcnt vmcnt(24)
    v_mov_b32 v32, 1
    s_lshr_b32 s60, s2, 3
    s_add_u32 s60, s60, s48
    v_mov_b32 v33, s60
    s_mov_b64 exec, 1
    ds_add_rtn_u32 v34, v29, v32 offset:4
    s_waitcnt lgkmcnt(0)
    v_readfirstlane_b32 s61, v34
    s_nop 1
    s_cmp_eq_u32 s61, 2
    s_cbranch_scc0 L_nl1
    buffer_store_byte v32, v33, s[56:59], 0 offen
    v_mov_b32 v32, 0x400000
    ds_or_b32 v29, v32
L_nl1:
    s_mov_b64 exec, -1
    v_mov_b32 v16, v4
    v_mov_b32 v17, v5
    v_mov_b32 v18, v6
    s_waitcnt vmcnt(22)
    ds_write_b64 v16, a[0:1] offset:0
    ds_write_b64 v16, a[2:3] offset:1024
    ds_write_b64 v16, a[4:5] offset:512
    ds_write_b64 v16, a[6:7] offset:1536
    ds_read2_b64 a[0:3], v17 offset0:0 offset1:128
    ds_read2_b64 a[4:7], v18 offset0:0 offset1:128
    s_waitcnt vmcnt(20)
    ds_or_b32 v29, v31
    ds_write_b64 v16, a[8:9] offset:0
    ds_write_b64 v16, a[10:11] offset:1024
    ds_write_b64 v16, a[12:13] offset:512
    ds_write_b64 v16, a[14:15] offset:1536
    ds_read2_b64 a[8:11], v17 offset0:0 offset1:128
    ds_read2_b64 a[12:15], v18 offset0:0 offset1:128
    s_waitcnt vmcnt(18)
    ds_write_b64 v16, a[16:17] offset:0
    ds_write_b64 v16, a[18:19] offset:1024
    ds_write_b64 v16, a[20:21] offset:512
    ds_write_b64 v16, a[22:23] offset:1536
    ds_read2_b64 a[16:19], v17 offset0:0 offset1:128
    ds_read2_b64 a[20:23], v18 offset0:0 offset1:128
    s_waitcnt vmcnt(16)
    ds_write_b64 v16, a[24:25] offset:0
    ds_write_b64 v16, a[26:27] offset:1024
    ds_write_b64 v16, a[28:29] offset:512
    ds_write_b64 v16, a[30:31] offset:1536
    ds_read2_b64 a[24:27], v17 offset0:0 offset1:128
    ds_read2_b64 a[28:31], v18 offset0:0 offset1:128
    s_waitcnt vmcnt(14)
    ds_write_b64 v16, a[32:33] offset:0
    ds_write_b64 v16, a[34:35] offset:1024
    ds_write_b64 v16, a[36:37] offset:512
    ds_write_b64 v16, a[38:39] offset:1536
    ds_read2_b64 a[32:35], v17 offset0:0 offset1:128
    ds_read2_b64 a[36:39], v18 offset0:0 offset1:128
    s_waitcnt vmcnt(12)
    ds_write_b64 v16, a[40:41] offset:0
    ds_write_b64 v16, a[42:43] offset:1024
    ds_write_b64 v16, a[44:45] offset:512
    ds_write_b64 v16, a[46:47] offset:1536
    ds_read2_b64 a[40:43], v17 offset0:0 offset1:128
    ds_read2_b64 a[44:47], v18 offset0:0 offset1:128
    s_waitcnt vmcnt(10)
    ds_write_b64 v16, a[48:49] offset:0
    ds_write_b64 v16, a[50:51] offset:1024
    ds_write_b64 v16, a[52:53] offset:512
    ds_write_b64 v16, a[54:55] offset:1536
    ds_read2_b64 a[48:51], v17 offset0:0 offset1:128
    ds_read2_b64 a[52:55], v18 offset0:0 offset1:128
    s_waitcnt vmcnt(8)
    ds_write_b64 v16, a[56:57] offset:0
    ds_write_b64 v16, a[58:59] offset:1024
    ds_write_b64 v16, a[60:61] offset:512
    ds_write_b64 v16, a[62:63] offset:1536
    ds_read2_b64 a[56:59], v17 offset0:0 offset1:128
    ds_read2_b64 a[60:63], v18 offset0:0 offset1:128
    s_waitcnt vmcnt(6)
    ds_write_b64 v16, a[64:65] offset:0
    ds_write_b64 v16, a[66:67] offset:1024
    ds_write_b64 v16, a[68:69] offset:512
    ds_write_b64 v16, a[70:71] offset:1536
    ds_read2_b64 a[64:67], v17 offset0:0 offset1:128
    ds_read2_b64 a[68:71], v18 offset0:0 offset1:128
    s_waitcnt vmcnt(4)
    ds_write_b64 v16, a[72:73] offset:0
    ds_write_b64 v16, a[74:75] offset:1024
    ds_write_b64 v16, a[76:77] offset:512
    ds_write_b64 v16, a[78:79] offset:1536
    ds_read2_b64 a[72:75], v17 offset0:0 offset1:128
    ds_read2_b64 a[76:79], v18 offset0:0 offset1:128
    s_waitcnt vmcnt(2)
    ds_write_b64 v16, a[80:81] offset:0
    ds_write_b64 v16, a[82:83] offset:1024
    ds_write_b64 v16, a[84:85] offset:512
    ds_write_b64 v16, a[86:87] offset:1536
    ds_read2_b64 a[80:83], v17 offset0:0 offset1:128
    ds_read2_b64 a[84:87], v18 offset0:0 offset1:128
    s_waitcnt vmcnt(0)
    ds_write_b64 v16, a[88:89] offset:0
    ds_write_b64 v16, a[90:91] offset:1024
    ds_write_b64 v16, a[92:93] offset:512
    ds_write_b64 v16, a[94:95] offset:1536
    ds_read2_b64 a[88:91], v17 offset0:0 offset1:128
    ds_read2_b64 a[92:95], v18 offset0:0 offset1:128
    s_branch L_w1go
L_p23:
    s_waitcnt vmcnt(0)
    v_mov_b32 v32, 1
    s_lshr_b32 s60, s2, 3
    s_add_u32 s60, s60, s48
    v_mov_b32 v33, s60
    s_mov_b64 exec, 1
    ds_add_rtn_u32 v34, v29, v32 offset:4
    s_waitcnt lgkmcnt(0)
    v_readfirstlane_b32 s61, v34
    s_nop 1
    s_cmp_eq_u32 s61, 2
    s_cbranch_scc0 L_nl2
    buffer_store_byte v32, v33, s[56:59], 0 offen
    v_mov_b32 v32, 0x400000
    ds_or_b32 v29, v32
L_nl2:
    s_mov_b64 exec, -1
L_noprod:
    s_lshl_b32 s60, 2048, s49
    s_cmp_lt_u32 s2, 192
    s_cselect_b32 s61, 0x400000, 0
    s_or_b32 s60, s60, s61
L_wpace:
    s_sub_u32 s43, s43, 1
    s_cbranch_scc1 L_end
    ds_read_b32 v30, v29
    s_waitcnt lgkmcnt(0)
    v_readfirstlane_b32 s41, v30
    s_nop 1
    s_and_b32 s42, s41, s60
    s_cmp_eq_u32 s42, s60
    s_cbranch_scc0 L_wpace
    buffer_load_dwordx4 a[0:3], v9, s[8:11], s24 offen offset:0 nt
    buffer_load_dwordx4 a[4:7], v10, s[8:11], s24 offen offset:0 nt
    buffer_load_dwordx4 a[8:11], v9, s[8:11], s24 offen offset:128 nt
    buffer_load_dwordx4 a[12:15], v10, s[8:11], s24 offen offset:128 nt
    buffer_load_dwordx4 a[16:19], v9, s[8:11], s24 offen offset:256 nt
    buffer_load_dwordx4 a[20:23], v10, s[8:11], s24 offen offset:256 nt
    buffer_load_dwordx4 a[24:27], v9, s[8:11], s26 offen offset:0 nt
    buffer_load_dwordx4 a[28:31], v10, s[8:11], s26 offen offset:0 nt
    buffer_load_dwordx4 a[32:35], v9, s[8:11], s26 offen offset:128 nt
    buffer_load_dwordx4 a[36:39], v10, s[8:11], s26 offen offset:128 nt
    buffer_load_dwordx4 a[40:43], v9, s[8:11], s26 offen offset:256 nt
    buffer_load_dwordx4 a[44:47], v10, s[8:11], s26 offen offset:256 nt
    buffer_load_dwordx4 a[48:51], v9, s[8:11], s28 offen offset:0 nt
    buffer_load_dwordx4 a[52:55], v10, s[8:11], s28 offen offset:0 nt
    buffer_load_dwordx4 a[56:59], v9, s[8:11], s28 offen offset:128 nt
    buffer_load_dwordx4 a[60:63], v10, s[8:11], s28 offen offset:128 nt
    buffer_load_dwordx4 a[64:67], v9, s[8:11], s28 offen offset:256 nt
    buffer_load_dwordx4 a[68:71], v10, s[8:11], s28 offen offset:256 nt
    buffer_load_dwordx4 a[72:75], v9, s[8:11], s30 offen offset:0 nt
    buffer_load_dwordx4 a[76:79], v10, s[8:11], s30 offen offset:0 nt
    buffer_load_dwordx4 a[80:83], v9, s[8:11], s30 offen offset:128 nt
    buffer_load_dwordx4 a[84:87], v10, s[8:11], s30 offen offset:128 nt
    buffer_load_dwordx4 a[88:91], v9, s[8:11], s30 offen offset:256 nt
    buffer_load_dwordx4 a[92:95], v10, s[8:11], s30 offen offset:256 nt
    v_mov_b32 v16, v4
    v_mov_b32 v17, v5
    v_mov_b32 v18, v6
    s_waitcnt vmcnt(22)
    ds_write_b64 v16, a[0:1] offset:0
    ds_write_b64 v16, a[2:3] offset:1024
    ds_write_b64 v16, a[4:5] offset:512
    ds_write_b64 v16, a[6:7] offset:1536
    ds_read2_b64 a[0:3], v17 offset0:0 offset1:128
    ds_read2_b64 a[4:7], v18 offset0:0 offset1:128
    s_waitcnt vmcnt(20)
    ds_or_b32 v29, v31
    ds_write_b64 v16, a[8:9] offset:0
    ds_write_b64 v16, a[10:11] offset:1024
    ds_write_b64 v16, a[12:13] offset:512
    ds_write_b64 v16, a[14:15] offset:1536
    ds_read2_b64 a[8:11], v17 offset0:0 offset1:128
    ds_read2_b64 a[12:15], v18 offset0:0 offset1:128
    s_waitcnt vmcnt(18)
    ds_write_b64 v16, a[16:17] offset:0
    ds_write_b64 v16, a[18:19] offset:1024
    ds_write_b64 v16, a[20:21] offset:512
    ds_write_b64 v16, a[22:23] offset:1536
    ds_read2_b64 a[16:19], v17 offset0:0 offset1:128
    ds_read2_b64 a[20:23], v18 offset0:0 offset1:128
    s_waitcnt vmcnt(16)
    ds_write_b64 v16, a[24:25] offset:0
    ds_write_b64 v16, a[26:27] offset:1024
    ds_write_b64 v16, a[28:29] offset:512
    ds_write_b64 v16, a[30:31] offset:1536
    ds_read2_b64 a[24:27], v17 offset0:0 offset1:128
    ds_read2_b64 a[28:31], v18 offset0:0 offset1:128
    s_waitcnt vmcnt(14)
    ds_write_b64 v16, a[32:33] offset:0
    ds_write_b64 v16, a[34:35] offset:1024
    ds_write_b64 v16, a[36:37] offset:512
    ds_write_b64 v16, a[38:39] offset:1536
    ds_read2_b64 a[32:35], v17 offset0:0 offset1:128
    ds_read2_b64 a[36:39], v18 offset0:0 offset1:128
    s_waitcnt vmcnt(12)
    ds_write_b64 v16, a[40:41] offset:0
    ds_write_b64 v16, a[42:43] offset:1024
    ds_write_b64 v16, a[44:45] offset:512
    ds_write_b64 v16, a[46:47] offset:1536
    ds_read2_b64 a[40:43], v17 offset0:0 offset1:128
    ds_read2_b64 a[44:47], v18 offset0:0 offset1:128
    s_waitcnt vmcnt(10)
    ds_write_b64 v16, a[48:49] offset:0
    ds_write_b64 v16, a[50:51] offset:1024
    ds_write_b64 v16, a[52:53] offset:512
    ds_write_b64 v16, a[54:55] offset:1536
    ds_read2_b64 a[48:51], v17 offset0:0 offset1:128
    ds_read2_b64 a[52:55], v18 offset0:0 offset1:128
    s_waitcnt vmcnt(8)
    ds_write_b64 v16, a[56:57] offset:0
    ds_write_b64 v16, a[58:59] offset:1024
    ds_write_b64 v16, a[60:61] offset:512
    ds_write_b64 v16, a[62:63] offset:1536
    ds_read2_b64 a[56:59], v17 offset0:0 offset1:128
    ds_read2_b64 a[60:63], v18 offset0:0 offset1:128
    s_waitcnt vmcnt(6)
    ds_write_b64 v16, a[64:65] offset:0
    ds_write_b64 v16, a[66:67] offset:1024
    ds_write_b64 v16, a[68:69] offset:512
    ds_write_b64 v16, a[70:71] offset:1536
    ds_read2_b64 a[64:67], v17 offset0:0 offset1:128
    ds_read2_b64 a[68:71], v18 offset0:0 offset1:128
    s_waitcnt vmcnt(4)
    ds_write_b64 v16, a[72:73] offset:0
    ds_write_b64 v16, a[74:75] offset:1024
    ds_write_b64 v16, a[76:77] offset:512
    ds_write_b64 v16, a[78:79] offset:1536
    ds_read2_b64 a[72:75], v17 offset0:0 offset1:128
    ds_read2_b64 a[76:79], v18 offset0:0 offset1:128
    s_waitcnt vmcnt(2)
    ds_write_b64 v16, a[80:81] offset:0
    ds_write_b64 v16, a[82:83] offset:1024
    ds_write_b64 v16, a[84:85] offset:512
    ds_write_b64 v16, a[86:87] offset:1536
    ds_read2_b64 a[80:83], v17 offset0:0 offset1:128
    ds_read2_b64 a[84:87], v18 offset0:0 offset1:128
    s_waitcnt vmcnt(0)
    ds_write_b64 v16, a[88:89] offset:0
    ds_write_b64 v16, a[90:91] offset:1024
    ds_write_b64 v16, a[92:93] offset:512
    ds_write_b64 v16, a[94:95] offset:1536
    ds_read2_b64 a[88:91], v17 offset0:0 offset1:128
    ds_read2_b64 a[92:95], v18 offset0:0 offset1:128
L_w1go:
    s_cmp_eq_u32 s49, 1
    s_cbranch_scc0 L_enter
L_wgo:
    s_sub_u32 s43, s43, 1
    s_cbranch_scc1 L_end
    ds_read_b32 v30, v29
    s_waitcnt lgkmcnt(0)
    v_readfirstlane_b32 s41, v30
    s_nop 1
    s_and_b32 s42, s41, 0x200000
    s_cmp_eq_u32 s42, 0x200000
    s_cbranch_scc0 L_wgo
    s_mov_b32 s60, 36864
    s_add_u32 s61, s60, 0
    s_mov_b32 m0, s61
    s_nop 0
    buffer_load_dwordx4 v1, s[52:55], s61 offen offset:0 lds
    buffer_load_dwordx4 v1, s[52:55], s61 offen offset:1024 lds
    buffer_load_dwordx4 v1, s[52:55], s61 offen offset:2048 lds
    buffer_load_dwordx4 v1, s[52:55], s61 offen offset:3072 lds
    s_add_u32 s61, s60, 4096
    s_mov_b32 m0, s61
    s_nop 0
    buffer_load_dwordx4 v1, s[52:55], s61 offen offset:0 lds
    buffer_load_dwordx4 v1, s[52:55], s61 offen offset:1024 lds
    buffer_load_dwordx4 v1, s[52:55], s61 offen offset:2048 lds
    buffer_load_dwordx4 v1, s[52:55], s61 offen offset:3072 lds
    s_add_u32 s61, s60, 8192
    s_mov_b32 m0, s61
    s_nop 0
    buffer_load_dwordx4 v1, s[52:55], s61 offen offset:0 lds
    buffer_load_dwordx4 v1, s[52:55], s61 offen offset:1024 lds
    buffer_load_dwordx4 v1, s[52:55], s61 offen offset:2048 lds
    buffer_load_dwordx4 v1, s[52:55], s61 offen offset:3072 lds
    s_add_u32 s61, s60, 12288
    s_mov_b32 m0, s61
    s_nop 0
    buffer_load_dwordx4 v1, s[52:55], s61 offen offset:0 lds
    buffer_load_dwordx4 v1, s[52:55], s61 offen offset:1024 lds
    buffer_load_dwordx4 v1, s[52:55], s61 offen offset:2048 lds
    buffer_load_dwordx4 v1, s[52:55], s61 offen offset:3072 lds
    s_add_u32 s61, s60, 16384
    s_mov_b32 m0, s61
    s_nop 0
    buffer_load_dwordx4 v1, s[52:55], s61 offen offset:0 lds
    buffer_load_dwordx4 v1, s[52:55], s61 offen offset:1024 lds
    buffer_load_dwordx4 v1, s[52:55], s61 offen offset:2048 lds
    buffer_load_dwordx4 v1, s[52:55], s61 offen offset:3072 lds
    s_add_u32 s61, s60, 20480
    s_mov_b32 m0, s61
    s_nop 0
    buffer_load_dwordx4 v1, s[52:55], s61 offen offset:0 lds
    buffer_load_dwordx4 v1, s[52:55], s61 offen offset:1024 lds
    buffer_load_dwordx4 v1, s[52:55], s61 offen offset:2048 lds
    buffer_load_dwordx4 v1, s[52:55], s61 offen offset:3072 lds
    s_add_u32 s61, s60, 24576
    s_mov_b32 m0, s61
    s_nop 0
    buffer_load_dwordx4 v1, s[52:55], s61 offen offset:0 lds
    buffer_load_dwordx4 v1, s[52:55], s61 offen offset:1024 lds
    buffer_load_dwordx4 v1, s[52:55], s61 offen offset:2048 lds
    buffer_load_dwordx4 v1, s[52:55], s61 offen offset:3072 lds
    s_add_u32 s61, s60, 28672
    s_mov_b32 m0, s61
    s_nop 0
    buffer_load_dwordx4 v1, s[52:55], s61 offen offset:0 lds
    buffer_load_dwordx4 v1, s[52:55], s61 offen offset:1024 lds
    buffer_load_dwordx4 v1, s[52:55], s61 offen offset:2048 lds
    buffer_load_dwordx4 v1, s[52:55], s61 offen offset:3072 lds
    s_add_u32 s61, s60, 32768
    s_mov_b32 m0, s61
    s_nop 0
    buffer_load_dwordx4 v1, s[52:55], s61 offen offset:0 lds
    buffer_load_dwordx4 v1, s[52:55], s61 offen offset:1024 lds
    buffer_load_dwordx4 v1, s[52:55], s61 offen offset:2048 lds
    buffer_load_dwordx4 v1, s[52:55], s61 offen offset:3072 lds
    v_mov_b32 v26, 8
    v_mov_b32 v27, 16
    v_mov_b32 v28, 32
    s_branch L_enter
L_w0:
    s_waitcnt vmcnt(24)
    v_mov_b32 v30, 1048576
    ds_or_b32 v29, v30
    v_mov_b32 v16, v4
    v_mov_b32 v17, v5
    v_mov_b32 v18, v6
    s_waitcnt vmcnt(22)
    ds_write_b64 v16, a[0:1] offset:0
    ds_write_b64 v16, a[2:3] offset:1024
    ds_write_b64 v16, a[4:5] offset:512
    ds_write_b64 v16, a[6:7] offset:1536
    ds_read2_b64 a[0:3], v17 offset0:0 offset1:128
    ds_read2_b64 a[4:7], v18 offset0:0 offset1:128
    s_waitcnt vmcnt(20)
    ds_or_b32 v29, v31
    ds_write_b64 v16, a[8:9] offset:0
    ds_write_b64 v16, a[10:11] offset:1024
    ds_write_b64 v16, a[12:13] offset:512
    ds_write_b64 v16, a[14:15] offset:1536
    ds_read2_b64 a[8:11], v17 offset0:0 offset1:128
    ds_read2_b64 a[12:15], v18 offset0:0 offset1:128
    s_waitcnt vmcnt(18)
    ds_write_b64 v16, a[16:17] offset:0
    ds_write_b64 v16, a[18:19] offset:1024
    ds_write_b64 v16, a[20:21] offset:512
    ds_write_b64 v16, a[22:23] offset:1536
    ds_read2_b64 a[16:19], v17 offset0:0 offset1:128
    ds_read2_b64 a[20:23], v18 offset0:0 offset1:128
    s_waitcnt vmcnt(16)
    ds_write_b64 v16, a[24:25] offset:0
    ds_write_b64 v16, a[26:27] offset:1024
    ds_write_b64 v16, a[28:29] offset:512
    ds_write_b64 v16, a[30:31] offset:1536
    ds_read2_b64 a[24:27], v17 offset0:0 offset1:128
    ds_read2_b64 a[28:31], v18 offset0:0 offset1:128
    s_waitcnt vmcnt(14)
    ds_write_b64 v16, a[32:33] offset:0
    ds_write_b64 v16, a[34:35] offset:1024
    ds_write_b64 v16, a[36:37] offset:512
    ds_write_b64 v16, a[38:39] offset:1536
    ds_read2_b64 a[32:35], v17 offset0:0 offset1:128
    ds_read2_b64 a[36:39], v18 offset0:0 offset1:128
    s_waitcnt vmcnt(12)
    ds_write_b64 v16, a[40:41] offset:0
    ds_write_b64 v16, a[42:43] offset:1024
    ds_write_b64 v16, a[44:45] offset:512
    ds_write_b64 v16, a[46:47] offset:1536
    ds_read2_b64 a[40:43], v17 offset0:0 offset1:128
    ds_read2_b64 a[44:47], v18 offset0:0 offset1:128
    s_waitcnt vmcnt(10)
    ds_write_b64 v16, a[48:49] offset:0
    ds_write_b64 v16, a[50:51] offset:1024
    ds_write_b64 v16, a[52:53] offset:512
    ds_write_b64 v16, a[54:55] offset:1536
    ds_read2_b64 a[48:51], v17 offset0:0 offset1:128
    ds_read2_b64 a[52:55], v18 offset0:0 offset1:128
    s_waitcnt vmcnt(8)
    ds_write_b64 v16, a[56:57] offset:0
    ds_write_b64 v16, a[58:59] offset:1024
    ds_write_b64 v16, a[60:61] offset:512
    ds_write_b64 v16, a[62:63] offset:1536
    ds_read2_b64 a[56:59], v17 offset0:0 offset1:128
    ds_read2_b64 a[60:63], v18 offset0:0 offset1:128
    s_waitcnt vmcnt(6)
    ds_write_b64 v16, a[64:65] offset:0
    ds_write_b64 v16, a[66:67] offset:1024
    ds_write_b64 v16, a[68:69] offset:512
    ds_write_b64 v16, a[70:71] offset:1536
    ds_read2_b64 a[64:67], v17 offset0:0 offset1:128
    ds_read2_b64 a[68:71], v18 offset0:0 offset1:128
    s_waitcnt vmcnt(4)
    ds_write_b64 v16, a[72:73] offset:0
    ds_write_b64 v16, a[74:75] offset:1024
    ds_write_b64 v16, a[76:77] offset:512
    ds_write_b64 v16, a[78:79] offset:1536
    ds_read2_b64 a[72:75], v17 offset0:0 offset1:128
    ds_read2_b64 a[76:79], v18 offset0:0 offset1:128
    s_waitcnt vmcnt(2)
    ds_write_b64 v16, a[80:81] offset:0
    ds_write_b64 v16, a[82:83] offset:1024
    ds_write_b64 v16, a[84:85] offset:512
    ds_write_b64 v16, a[86:87] offset:1536
    ds_read2_b64 a[80:83], v17 offset0:0 offset1:128
    ds_read2_b64 a[84:87], v18 offset0:0 offset1:128
    s_waitcnt vmcnt(0)
    ds_write_b64 v16, a[88:89] offset:0
    ds_write_b64 v16, a[90:91] offset:1024
    ds_write_b64 v16, a[92:93] offset:512
    ds_write_b64 v16, a[94:95] offset:1536
    ds_read2_b64 a[88:91], v17 offset0:0 offset1:128
    ds_read2_b64 a[92:95], v18 offset0:0 offset1:128
L_poll0:
    s_mov_b32 s61, 0
    v_min_u32 v33, 5, v0
    v_lshlrev_b32 v33, 2, v33
    s_mov_b32 s62, 0x01010101
    v_mov_b32 v34, 0
L_poll:
    buffer_load_dword v34, v33, s[56:59], s48 offen nt
    s_add_u32 s61, s61, 1
    s_sleep 4
    v_cmp_ne_u32 vcc, s62, v34
    s_nop 4
    s_cbranch_vccz L_go
    s_cmp_lt_u32 s61, 400
    s_cbranch_scc1 L_poll
    s_waitcnt vmcnt(0)
    s_branch L_fb
L_go:
    s_mov_b32 s60, 0
    s_add_u32 s61, s60, 0
    s_mov_b32 m0, s61
    s_nop 0
    buffer_load_dwordx4 v1, s[52:55], s61 offen offset:0 lds
    buffer_load_dwordx4 v1, s[52:55], s61 offen offset:1024 lds
    buffer_load_dwordx4 v1, s[52:55], s61 offen offset:2048 lds
    buffer_load_dwordx4 v1, s[52:55], s61 offen offset:3072 lds
    s_add_u32 s61, s60, 4096
    s_mov_b32 m0, s61
    s_nop 0
    buffer_load_dwordx4 v1, s[52:55], s61 offen offset:0 lds
    buffer_load_dwordx4 v1, s[52:55], s61 offen offset:1024 lds
    buffer_load_dwordx4 v1, s[52:55], s61 offen offset:2048 lds
    buffer_load_dwordx4 v1, s[52:55], s61 offen offset:3072 lds
    s_add_u32 s61, s60, 8192
    s_mov_b32 m0, s61
    s_nop 0
    buffer_load_dwordx4 v1, s[52:55], s61 offen offset:0 lds
    buffer_load_dwordx4 v1, s[52:55], s61 offen offset:1024 lds
    buffer_load_dwordx4 v1, s[52:55], s61 offen offset:2048 lds
    buffer_load_dwordx4 v1, s[52:55], s61 offen offset:3072 lds
    v_mov_b32 v30, 2097152
    ds_or_b32 v29, v30
    s_add_u32 s61, s60, 12288
    s_mov_b32 m0, s61
    s_nop 0
    buffer_load_dwordx4 v1, s[52:55], s61 offen offset:0 lds
    buffer_load_dwordx4 v1, s[52:55], s61 offen offset:1024 lds
    buffer_load_dwordx4 v1, s[52:55], s61 offen offset:2048 lds
    buffer_load_dwordx4 v1, s[52:55], s61 offen offset:3072 lds
    s_add_u32 s61, s60, 16384
    s_mov_b32 m0, s61
    s_nop 0
    buffer_load_dwordx4 v1, s[52:55], s61 offen offset:0 lds
    buffer_load_dwordx4 v1, s[52:55], s61 offen offset:1024 lds
    buffer_load_dwordx4 v1, s[52:55], s61 offen offset:2048 lds
    buffer_load_dwordx4 v1, s[52:55], s61 offen offset:3072 lds
    s_add_u32 s61, s60, 20480
    s_mov_b32 m0, s61
    s_nop 0
    buffer_load_dwordx4 v1, s[52:55], s61 offen offset:0 lds
    buffer_load_dwordx4 v1, s[52:55], s61 offen offset:1024 lds
    buffer_load_dwordx4 v1, s[52:55], s61 offen offset:2048 lds
    buffer_load_dwordx4 v1, s[52:55], s61 offen offset:3072 lds
    s_add_u32 s61, s60, 24576
    s_mov_b32 m0, s61
    s_nop 0
    buffer_load_dwordx4 v1, s[52:55], s61 offen offset:0 lds
    buffer_load_dwordx4 v1, s[52:55], s61 offen offset:1024 lds
    buffer_load_dwordx4 v1, s[52:55], s61 offen offset:2048 lds
    buffer_load_dwordx4 v1, s[52:55], s61 offen offset:3072 lds
    s_add_u32 s61, s60, 28672
    s_mov_b32 m0, s61
    s_nop 0
    buffer_load_dwordx4 v1, s[52:55], s61 offen offset:0 lds
    buffer_load_dwordx4 v1, s[52:55], s61 offen offset:1024 lds
    buffer_load_dwordx4 v1, s[52:55], s61 offen offset:2048 lds
    buffer_load_dwordx4 v1, s[52:55], s61 offen offset:3072 lds
    s_add_u32 s61, s60, 32768
    s_mov_b32 m0, s61
    s_nop 0
    buffer_load_dwordx4 v1, s[52:55], s61 offen offset:0 lds
    buffer_load_dwordx4 v1, s[52:55], s61 offen offset:1024 lds
    buffer_load_dwordx4 v1, s[52:55], s61 offen offset:2048 lds
    buffer_load_dwordx4 v1, s[52:55], s61 offen offset:3072 lds
    v_mov_b32 v26, 2
    v_mov_b32 v27, 4
    s_waitcnt vmcnt(24)
    v_mov_b32 v30, 1
    ds_or_b32 v29, v30
L_enter:
    v_mov_b32 v16, v4
    v_mov_b32 v17, v5
    v_mov_b32 v18, v6
    s_mul_i32 s60, s49, 18432
    s_add_u32 s60, s60, 73728
    v_add_u32 v24, s60, v1
    s_lshl_b32 s61, 64, s49
    v_mov_b32 v25, s61
    s_waitcnt lgkmcnt(0)
    s_sub_u32 s16, s3, 6291456
    s_mov_b32 s19, 100663296
    s_mov_b32 s18, 0
    s_mov_b32 s33, 100663296
    s_mov_b32 s35, 100663296
    s_mov_b32 s37, 100663296
    s_mov_b32 s39, 100663296
    ds_read_b32 v30, v29
    s_waitcnt lgkmcnt(0)
    v_readfirstlane_b32 s41, v30
    s_nop 1
    s_bitcmp1_b32 s41, 0
    s_cbranch_scc0 L_slow0
L_ok0:
    ds_read_b128 a[192:195], v1 offset:0
    ds_read_b128 a[196:199], v1 offset:1024
    ds_read_b128 a[200:203], v1 offset:2048
    ds_read_b128 a[204:207], v1 offset:3072
    ds_read_b128 a[208:211], v1 offset:4096
    ds_read_b128 a[212:215], v1 offset:5120
    ds_read_b128 a[216:219], v1 offset:6144
    ds_read_b128 a[220:223], v1 offset:7168
    s_waitcnt lgkmcnt(7)
    v_mfma_f32_16x16x32_bf16 v[96:99], a[192:195], a[0:3], 0
    s_add_u32 s16, s16, 6291456
    s_add_u32 s24, s16, 3145728
    s_waitcnt lgkmcnt(6)
    v_mfma_f32_16x16x32_bf16 v[96:99], a[196:199], a[4:7], v[96:99]
    s_add_u32 s26, s16, 3538944
    s_add_u32 s28, s16, 3932160
    s_waitcnt lgkmcnt(5)
    v_mfma_f32_16x16x32_bf16 v[96:99], a[200:203], a[8:11], v[96:99]
    s_waitcnt lgkmcnt(4)
    ds_read_b128 a[224:227], v1 offset:8192
    s_add_u32 s30, s16, 4325376
    v_mfma_f32_16x16x32_bf16 v[96:99], a[204:207], a[12:15], v[96:99]
    s_add_u32 s32, s16, 0
    s_add_u32 s34, s16, 393216
    s_waitcnt lgkmcnt(4)
    v_mfma_f32_16x16x32_bf16 v[96:99], a[208:211], a[16:19], v[96:99]
    s_waitcnt lgkmcnt(1)
    ds_read_b128 a[228:231], v1 offset:9216
    s_add_u32 s36, s16, 786432
    v_mfma_f32_16x16x32_bf16 v[96:99], a[212:215], a[20:23], v[96:99]
    s_add_u32 s38, s16, 1179648
    s_add_u32 s33, s16, 3145728
    s_add_u32 s35, s16, 3538944
    v_mfma_f32_16x16x32_bf16 v[100:103], a[212:215], a[44:47], 0
    s_add_u32 s37, s16, 3932160
    ds_read_b128 a[232:235], v1 offset:10240
    s_add_u32 s39, s16, 4325376
    v_mfma_f32_16x16x32_bf16 v[100:103], a[208:211], a[40:43], v[100:103]
    v_mfma_f32_16x16x32_bf16 v[100:103], a[204:207], a[36:39], v[100:103]
    ds_read_b128 a[236:239], v1 offset:11264
    v_cvt_pk_bf16_f32 v192, v96, v97
    v_mfma_f32_16x16x32_bf16 v[100:103], a[200:203], a[32:35], v[100:103]
    v_cvt_pk_bf16_f32 v193, v98, v99
    v_mfma_f32_16x16x32_bf16 v[100:103], a[196:199], a[28:31], v[100:103]
    s_cmp_eq_u32 s49, 0
    s_cbranch_scc0 L_pub0
    s_waitcnt vmcnt(12)
    ds_or_b32 v29, v26
L_pub0:
    v_mfma_f32_16x16x32_bf16 v[100:103], a[192:195], a[24:27], v[100:103]
    ds_read_b32 v30, v29
    v_mfma_f32_16x16x32_bf16 v[104:107], a[192:195], a[48:51], 0
    v_mfma_f32_16x16x32_bf16 v[104:107], a[196:199], a[52:55], v[104:107]
    v_mfma_f32_16x16x32_bf16 v[104:107], a[200:203], a[56:59], v[104:107]
    v_cvt_pk_bf16_f32 v196, v100, v101
    v_cvt_pk_bf16_f32 v197, v102, v103
    v_mfma_f32_16x16x32_bf16 v[104:107], a[204:207], a[60:63], v[104:107]
    v_mfma_f32_16x16x32_bf16 v[104:107], a[208:211], a[64:67], v[104:107]
    v_mfma_f32_16x16x32_bf16 v[104:107], a[212:215], a[68:71], v[104:107]
    v_mfma_f32_16x16x32_bf16 v[108:111], a[212:215], a[92:95], 0
    v_mfma_f32_16x16x32_bf16 v[108:111], a[208:211], a[88:91], v[108:111]
    v_mfma_f32_16x16x32_bf16 v[108:111], a[204:207], a[84:87], v[108:111]
    s_waitcnt lgkmcnt(0)
    v_readfirstlane_b32 s41, v30
    v_cvt_pk_bf16_f32 v200, v104, v105
    v_mfma_f32_16x16x32_bf16 v[108:111], a[200:203], a[80:83], v[108:111]
    s_bitcmp1_b32 s41, 1
    s_cbranch_scc0 L_slow1
L_ok1:
    v_cvt_pk_bf16_f32 v201, v106, v107
    v_mfma_f32_16x16x32_bf16 v[108:111], a[196:199], a[76:79], v[108:111]
    s_add_u32 s61, s60, 0
    ds_read_b128 a[240:243], v1 offset:12288
    v_mfma_f32_16x16x32_bf16 v[108:111], a[192:195], a[72:75], v[108:111]
    v_mfma_f32_16x16x32_bf16 v[124:127], a[216:219], a[72:75], 0
    buffer_load_dwordx4 v[128:131], v1, s[52:55], s61 offen offset:0
    v_mfma_f32_16x16x32_bf16 v[124:127], a[220:223], a[76:79], v[124:127]
    ds_read_b128 a[244:247], v1 offset:13312
    v_mfma_f32_16x16x32_bf16 v[124:127], a[224:227], a[80:83], v[124:127]
    ds_read_b128 a[248:251], v1 offset:14336
    v_cvt_pk_bf16_f32 v204, v108, v109
    v_mfma_f32_16x16x32_bf16 v[124:127], a[228:231], a[84:87], v[124:127]
    v_cvt_pk_bf16_f32 v205, v110, v111
    v_mfma_f32_16x16x32_bf16 v[124:127], a[232:235], a[88:91], v[124:127]
    ds_read_b128 a[192:195], v1 offset:15360
    v_mfma_f32_16x16x32_bf16 v[124:127], a[236:239], a[92:95], v[124:127]
    v_mfma_f32_16x16x32_bf16 v[120:123], a[236:239], a[68:71], 0
    s_cmp_eq_u32 s49, 1
    s_cbranch_scc0 L_pub2
    s_waitcnt vmcnt(25)
    ds_or_b32 v29, v26
L_pub2:
    v_mfma_f32_16x16x32_bf16 v[120:123], a[232:235], a[64:67], v[120:123]
    buffer_load_dwordx4 v[132:135], v1, s[52:55], s61 offen offset:1024
    v_mfma_f32_16x16x32_bf16 v[120:123], a[228:231], a[60:63], v[120:123]
    ds_read_b128 a[196:199], v1 offset:16384
    v_cvt_pk_bf16_f32 v206, v124, v125
    v_mfma_f32_16x16x32_bf16 v[120:123], a[224:227], a[56:59], v[120:123]
    ds_read_b128 a[200:203], v1 offset:17408
    v_cvt_pk_bf16_f32 v207, v126, v127
    v_mfma_f32_16x16x32_bf16 v[120:123], a[220:223], a[52:55], v[120:123]
    v_mfma_f32_16x16x32_bf16 v[120:123], a[216:219], a[48:51], v[120:123]
    v_mfma_f32_16x16x32_bf16 v[116:119], a[216:219], a[24:27], 0
    buffer_load_dwordx4 v[136:139], v1, s[52:55], s61 offen offset:2048
    v_mfma_f32_16x16x32_bf16 v[116:119], a[220:223], a[28:31], v[116:119]
    v_mfma_f32_16x16x32_bf16 v[116:119], a[224:227], a[32:35], v[116:119]
    v_cvt_pk_bf16_f32 v202, v120, v121
    v_cvt_pk_bf16_f32 v203, v122, v123
    v_mfma_f32_16x16x32_bf16 v[116:119], a[228:231], a[36:39], v[116:119]
    v_mfma_f32_16x16x32_bf16 v[116:119], a[232:235], a[40:43], v[116:119]
    v_mfma_f32_16x16x32_bf16 v[116:119], a[236:239], a[44:47], v[116:119]
    v_mfma_f32_16x16x32_bf16 v[112:115], a[236:239], a[20:23], 0
    buffer_load_dwordx4 v[140:143], v1, s[52:55], s61 offen offset:3072
    v_mfma_f32_16x16x32_bf16 v[112:115], a[232:235], a[16:19], v[112:115]
    v_mfma_f32_16x16x32_bf16 v[112:115], a[228:231], a[12:15], v[112:115]
    v_cvt_pk_bf16_f32 v198, v116, v117
    v_cvt_pk_bf16_f32 v199, v118, v119
    v_mfma_f32_16x16x32_bf16 v[112:115], a[224:227], a[8:11], v[112:115]
    v_mfma_f32_16x16x32_bf16 v[112:115], a[220:223], a[4:7], v[112:115]
    s_add_u32 s61, s60, 4096
    ds_read_b128 a[204:207], v1 offset:18432
    v_mfma_f32_16x16x32_bf16 v[112:115], a[216:219], a[0:3], v[112:115]
    s_waitcnt lgkmcnt(1)
    v_mfma_f32_16x16x32_bf16 v[96:99], a[240:243], a[0:3], 0
    buffer_load_dwordx4 v[144:147], v1, s[52:55], s61 offen offset:0
    v_mfma_f32_16x16x32_bf16 v[96:99], a[244:247], a[4:7], v[96:99]
    ds_read_b128 a[208:211], v1 offset:19456
    v_mfma_f32_16x16x32_bf16 v[96:99], a[248:251], a[8:11], v[96:99]
    ds_read_b128 a[212:215], v1 offset:20480
    v_cvt_pk_bf16_f32 v194, v112, v113
    v_mfma_f32_16x16x32_bf16 v[96:99], a[192:195], a[12:15], v[96:99]
    v_cvt_pk_bf16_f32 v195, v114, v115
    v_mfma_f32_16x16x32_bf16 v[96:99], a[196:199], a[16:19], v[96:99]
    ds_read_b128 a[216:219], v1 offset:21504
    v_mfma_f32_16x16x32_bf16 v[96:99], a[200:203], a[20:23], v[96:99]
    v_mfma_f32_16x16x32_bf16 v[100:103], a[200:203], a[44:47], 0
    buffer_load_dwordx4 v[148:151], v1, s[52:55], s61 offen offset:1024
    v_mfma_f32_16x16x32_bf16 v[100:103], a[196:199], a[40:43], v[100:103]
    ds_read_b128 a[220:223], v1 offset:22528
    v_mfma_f32_16x16x32_bf16 v[100:103], a[192:195], a[36:39], v[100:103]
    ds_read_b128 a[224:227], v1 offset:23552
    v_cvt_pk_bf16_f32 v208, v96, v97
    v_mfma_f32_16x16x32_bf16 v[100:103], a[248:251], a[32:35], v[100:103]
    v_cvt_pk_bf16_f32 v209, v98, v99
    v_mfma_f32_16x16x32_bf16 v[100:103], a[244:247], a[28:31], v[100:103]
    v_mfma_f32_16x16x32_bf16 v[100:103], a[240:243], a[24:27], v[100:103]
    v_mfma_f32_16x16x32_bf16 v[104:107], a[240:243], a[48:51], 0
    s_cmp_eq_u32 s49, 0
    s_cbranch_scc0 L_pub1
    s_waitcnt vmcnt(6)
    ds_or_b32 v29, v27
L_pub1:
    v_mfma_f32_16x16x32_bf16 v[104:107], a[244:247], a[52:55], v[104:107]
    ds_read_b32 v30, v29
    v_mfma_f32_16x16x32_bf16 v[104:107], a[248:251], a[56:59], v[104:107]
    buffer_load_dwordx4 v[152:155], v1, s[52:55], s61 offen offset:2048
    v_cvt_pk_bf16_f32 v212, v100, v101
    v_mfma_f32_16x16x32_bf16 v[104:107], a[192:195], a[60:63], v[104:107]
    v_cvt_pk_bf16_f32 v213, v102, v103
    v_mfma_f32_16x16x32_bf16 v[104:107], a[196:199], a[64:67], v[104:107]
    v_mfma_f32_16x16x32_bf16 v[104:107], a[200:203], a[68:71], v[104:107]
    v_mfma_f32_16x16x32_bf16 v[108:111], a[200:203], a[92:95], 0
    buffer_load_dwordx4 v[156:159], v1, s[52:55], s61 offen offset:3072
    v_mfma_f32_16x16x32_bf16 v[108:111], a[196:199], a[88:91], v[108:111]
    v_mfma_f32_16x16x32_bf16 v[108:111], a[192:195], a[84:87], v[108:111]
    v_cvt_pk_bf16_f32 v216, v104, v105
    v_cvt_pk_bf16_f32 v217, v106, v107
    v_mfma_f32_16x16x32_bf16 v[108:111], a[248:251], a[80:83], v[108:111]
    v_mfma_f32_16x16x32_bf16 v[108:111], a[244:247], a[76:79], v[108:111]
    s_add_u32 s61, s60, 8192
    s_waitcnt lgkmcnt(0)
    v_readfirstlane_b32 s41, v30
    v_mfma_f32_16x16x32_bf16 v[108:111], a[240:243], a[72:75], v[108:111]
    v_mfma_f32_16x16x32_bf16 v[124:127], a[204:207], a[72:75], 0
    s_bitcmp1_b32 s41, 2
    s_cbranch_scc0 L_slow2
L_ok2:
    v_mfma_f32_16x16x32_bf16 v[124:127], a[208:211], a[76:79], v[124:127]
    ds_read_b128 a[228:231], v1 offset:24576
    v_mfma_f32_16x16x32_bf16 v[124:127], a[212:215], a[80:83], v[124:127]
    buffer_load_dwordx4 v[160:163], v1, s[52:55], s61 offen offset:0
    v_cvt_pk_bf16_f32 v220, v108, v109
    v_mfma_f32_16x16x32_bf16 v[124:127], a[216:219], a[84:87], v[124:127]
    ds_read_b128 a[232:235], v1 offset:25600
    v_cvt_pk_bf16_f32 v221, v110, v111
    v_mfma_f32_16x16x32_bf16 v[124:127], a[220:223], a[88:91], v[124:127]
    ds_read_b128 a[236:239], v1 offset:26624
    v_mfma_f32_16x16x32_bf16 v[124:127], a[224:227], a[92:95], v[124:127]
    ds_read_b128 a[240:243], v1 offset:27648
    v_mfma_f32_16x16x32_bf16 v[120:123], a[224:227], a[68:71], 0
    buffer_load_dwordx4 v[164:167], v1, s[52:55], s61 offen offset:1024
    v_mfma_f32_16x16x32_bf16 v[120:123], a[220:223], a[64:67], v[120:123]
    ds_read_b128 a[244:247], v1 offset:28672
    v_mfma_f32_16x16x32_bf16 v[120:123], a[216:219], a[60:63], v[120:123]
    s_cmp_eq_u32 s49, 1
    s_cbranch_scc0 L_pub3
    s_waitcnt vmcnt(22)
    ds_or_b32 v29, v27
L_pub3:
    v_cvt_pk_bf16_f32 v222, v124, v125
    v_mfma_f32_16x16x32_bf16 v[120:123], a[212:215], a[56:59], v[120:123]
    ds_read_b128 a[248:251], v1 offset:29696
    v_cvt_pk_bf16_f32 v223, v126, v127
    v_mfma_f32_16x16x32_bf16 v[120:123], a[208:211], a[52:55], v[120:123]
    v_mfma_f32_16x16x32_bf16 v[120:123], a[204:207], a[48:51], v[120:123]
    v_mfma_f32_16x16x32_bf16 v[116:119], a[204:207], a[24:27], 0
    buffer_load_dwordx4 v[168:171], v1, s[52:55], s61 offen offset:2048
    v_mfma_f32_16x16x32_bf16 v[116:119], a[208:211], a[28:31], v[116:119]
    v_mfma_f32_16x16x32_bf16 v[116:119], a[212:215], a[32:35], v[116:119]
    v_cvt_pk_bf16_f32 v218, v120, v121
    v_cvt_pk_bf16_f32 v219, v122, v123
    v_mfma_f32_16x16x32_bf16 v[116:119], a[216:219], a[36:39], v[116:119]
    v_mfma_f32_16x16x32_bf16 v[116:119], a[220:223], a[40:43], v[116:119]
    v_mfma_f32_16x16x32_bf16 v[116:119], a[224:227], a[44:47], v[116:119]
    v_mfma_f32_16x16x32_bf16 v[112:115], a[224:227], a[20:23], 0
    buffer_load_dwordx4 v[172:175], v1, s[52:55], s61 offen offset:3072
    v_mfma_f32_16x16x32_bf16 v[112:115], a[220:223], a[16:19], v[112:115]
    v_mfma_f32_16x16x32_bf16 v[112:115], a[216:219], a[12:15], v[112:115]
    v_cvt_pk_bf16_f32 v214, v116, v117
    v_cvt_pk_bf16_f32 v215, v118, v119
    v_mfma_f32_16x16x32_bf16 v[112:115], a[212:215], a[8:11], v[112:115]
    v_mfma_f32_16x16x32_bf16 v[112:115], a[208:211], a[4:7], v[112:115]
    s_add_u32 s61, s60, 12288
    v_mfma_f32_16x16x32_bf16 v[112:115], a[204:207], a[0:3], v[112:115]
    s_waitcnt lgkmcnt(0)
    v_mfma_f32_16x16x32_bf16 v[96:99], a[228:231], a[0:3], 0
    buffer_load_dwordx4 v[176:179], v1, s[52:55], s61 offen offset:0
    v_mfma_f32_16x16x32_bf16 v[96:99], a[232:235], a[4:7], v[96:99]
    v_mfma_f32_16x16x32_bf16 v[96:99], a[236:239], a[8:11], v[96:99]
    v_cvt_pk_bf16_f32 v210, v112, v113
    v_cvt_pk_bf16_f32 v211, v114, v115
    v_mfma_f32_16x16x32_bf16 v[96:99], a[240:243], a[12:15], v[96:99]
    v_mfma_f32_16x16x32_bf16 v[96:99], a[244:247], a[16:19], v[96:99]
    v_mfma_f32_16x16x32_bf16 v[96:99], a[248:251], a[20:23], v[96:99]
    v_mfma_f32_16x16x32_bf16 v[100:103], a[248:251], a[44:47], 0
    buffer_load_dwordx4 v[180:183], v1, s[52:55], s61 offen offset:1024
    v_mfma_f32_16x16x32_bf16 v[100:103], a[244:247], a[40:43], v[100:103]
    v_mfma_f32_16x16x32_bf16 v[100:103], a[240:243], a[36:39], v[100:103]
    s_waitcnt vmcnt(13)
    ds_write_b64 v24, v[128:129] offset:0
    v_mfma_f32_16x16x32_bf16 v[100:103], a[236:239], a[32:35], v[100:103]
    ds_write_b64 v24, v[130:131] offset:8
    v_mfma_f32_16x16x32_bf16 v[100:103], a[232:235], a[28:31], v[100:103]
    v_mfma_f32_16x16x32_bf16 v[100:103], a[228:231], a[24:27], v[100:103]
    v_mfma_f32_16x16x32_bf16 v[32:35], a[0:3], v[192:195], 0
    buffer_load_dwordx4 v[184:187], v1, s[52:55], s61 offen offset:2048
    v_mfma_f32_16x16x32_bf16 v[32:35], a[4:7], v[208:211], v[32:35]
    v_mfma_f32_16x16x32_bf16 v[36:39], a[28:31], v[208:211], 0
    v_mfma_f32_16x16x32_bf16 v[36:39], a[24:27], v[192:195], v[36:39]
    s_waitcnt vmcnt(13)
    ds_write_b64 v24, v[132:133] offset:1024
    v_mfma_f32_16x16x32_bf16 v[40:43], a[48:51], v[192:195], 0
    ds_write_b64 v24, v[134:135] offset:1032
    v_mfma_f32_16x16x32_bf16 v[40:43], a[52:55], v[208:211], v[40:43]
    v_mfma_f32_16x16x32_bf16 v[44:47], a[76:79], v[208:211], 0
    buffer_load_dwordx4 v[188:191], v1, s[52:55], s61 offen offset:3072
    v_mfma_f32_16x16x32_bf16 v[44:47], a[72:75], v[192:195], v[44:47]
    v_cvt_pk_bf16_f32 v192, v96, v97
    v_cvt_pk_bf16_f32 v193, v98, v99
    v_mfma_f32_16x16x32_bf16 v[60:63], a[72:75], v[196:199], 0
    s_waitcnt vmcnt(13)
    ds_write_b64 v24, v[136:137] offset:2048
    v_mfma_f32_16x16x32_bf16 v[60:63], a[76:79], v[212:215], v[60:63]
    ds_write_b64 v24, v[138:139] offset:2056
    v_mfma_f32_16x16x32_bf16 v[56:59], a[52:55], v[212:215], 0
    s_add_u32 s61, s60, 16384
    v_mfma_f32_16x16x32_bf16 v[56:59], a[48:51], v[196:199], v[56:59]
    v_mfma_f32_16x16x32_bf16 v[52:55], a[24:27], v[196:199], 0
    buffer_load_dwordx4 v[224:227], v1, s[52:55], s61 offen offset:0
    v_mfma_f32_16x16x32_bf16 v[52:55], a[28:31], v[212:215], v[52:55]
    v_mfma_f32_16x16x32_bf16 v[48:51], a[4:7], v[212:215], 0
    s_waitcnt vmcnt(13)
    ds_write_b64 v24, v[140:141] offset:3072
    v_mfma_f32_16x16x32_bf16 v[48:51], a[0:3], v[196:199], v[48:51]
    ds_write_b64 v24, v[142:143] offset:3080
    v_mfma_f32_16x16x32_bf16 v[64:67], a[0:3], v[200:203], 0
    v_cvt_pk_bf16_f32 v196, v100, v101
    v_cvt_pk_bf16_f32 v197, v102, v103
    v_mfma_f32_16x16x32_bf16 v[64:67], a[4:7], v[216:219], v[64:67]
    v_mfma_f32_16x16x32_bf16 v[68:71], a[28:31], v[216:219], 0
    buffer_load_dwordx4 v[228:231], v1, s[52:55], s61 offen offset:1024
    v_mfma_f32_16x16x32_bf16 v[68:71], a[24:27], v[200:203], v[68:71]
    ds_read_b128 a[192:195], v1 offset:30720
    v_mfma_f32_16x16x32_bf16 v[72:75], a[48:51], v[200:203], 0
    ds_read_b128 a[196:199], v1 offset:31744
    v_mfma_f32_16x16x32_bf16 v[72:75], a[52:55], v[216:219], v[72:75]
    s_waitcnt vmcnt(13)
    ds_write_b64 v24, v[144:145] offset:4096
    v_mfma_f32_16x16x32_bf16 v[76:79], a[76:79], v[216:219], 0
    s_cmp_eq_u32 s49, 1
    s_cbranch_scc0 L_pub4
    s_waitcnt vmcnt(18)
    ds_or_b32 v29, v28
L_pub4:
    v_mfma_f32_16x16x32_bf16 v[76:79], a[72:75], v[200:203], v[76:79]
    ds_read_b128 a[200:203], v1 offset:32768
    v_mfma_f32_16x16x32_bf16 v[92:95], a[72:75], v[204:207], 0
    ds_read_b128 a[204:207], v1 offset:33792
    v_mfma_f32_16x16x32_bf16 v[92:95], a[76:79], v[220:223], v[92:95]
    ds_write_b64 v24, v[146:147] offset:4104
    v_mfma_f32_16x16x32_bf16 v[88:91], a[52:55], v[220:223], 0
    ds_read_b128 a[208:211], v1 offset:34816
    v_mfma_f32_16x16x32_bf16 v[88:91], a[48:51], v[204:207], v[88:91]
    s_waitcnt vmcnt(12)
    ds_write_b64 v24, v[148:149] offset:5120
    v_mfma_f32_16x16x32_bf16 v[84:87], a[24:27], v[204:207], 0
    ds_read_b32 v30, v29
    v_mfma_f32_16x16x32_bf16 v[84:87], a[28:31], v[220:223], v[84:87]
    ds_read_b128 a[212:215], v1 offset:35840
    v_mfma_f32_16x16x32_bf16 v[80:83], a[4:7], v[220:223], 0
    ds_write_b64 v24, v[150:151] offset:5128
    v_mfma_f32_16x16x32_bf16 v[80:83], a[0:3], v[204:207], v[80:83]
    v_mfma_f32_16x16x32_bf16 v[104:107], a[228:231], a[48:51], 0
    s_waitcnt vmcnt(11)
    ds_write_b64 v24, v[152:153] offset:6144
    v_mfma_f32_16x16x32_bf16 v[104:107], a[232:235], a[52:55], v[104:107]
    ds_write_b64 v24, v[154:155] offset:6152
    v_mfma_f32_16x16x32_bf16 v[104:107], a[236:239], a[56:59], v[104:107]
    v_mfma_f32_16x16x32_bf16 v[104:107], a[240:243], a[60:63], v[104:107]
    v_mfma_f32_16x16x32_bf16 v[104:107], a[244:247], a[64:67], v[104:107]
    s_waitcnt lgkmcnt(4)
    v_readfirstlane_b32 s41, v30
    v_mfma_f32_16x16x32_bf16 v[104:107], a[248:251], a[68:71], v[104:107]
    v_mfma_f32_16x16x32_bf16 v[108:111], a[248:251], a[92:95], 0
    s_bitcmp1_b32 s41, 3
    s_cbranch_scc0 L_slow3
L_ok3:
    v_mfma_f32_16x16x32_bf16 v[108:111], a[244:247], a[88:91], v[108:111]
    s_waitcnt vmcnt(10)
    ds_write_b64 v24, v[156:157] offset:7168
    v_mfma_f32_16x16x32_bf16 v[108:111], a[240:243], a[84:87], v[108:111]
    ds_write_b64 v24, v[158:159] offset:7176
    v_mfma_f32_16x16x32_bf16 v[108:111], a[236:239], a[80:83], v[108:111]
    v_cvt_pk_bf16_f32 v200, v104, v105
    v_cvt_pk_bf16_f32 v201, v106, v107
    v_mfma_f32_16x16x32_bf16 v[108:111], a[232:235], a[76:79], v[108:111]
    buffer_load_dwordx4 a[96:99], v9, s[8:11], s24 offen offset:0 nt
    v_mfma_f32_16x16x32_bf16 v[108:111], a[228:231], a[72:75], v[108:111]
    buffer_load_dwordx4 a[100:103], v10, s[8:11], s24 offen offset:0 nt
    v_mfma_f32_16x16x32_bf16 v[124:127], a[192:195], a[72:75], 0
    ds_read_b128 a[216:219], v1 offset:36864
    v_mfma_f32_16x16x32_bf16 v[124:127], a[196:199], a[76:79], v[124:127]
    ds_read_b128 a[220:223], v1 offset:37888
    v_mfma_f32_16x16x32_bf16 v[124:127], a[200:203], a[80:83], v[124:127]
    ds_read_b128 a[224:227], v1 offset:38912
    v_cvt_pk_bf16_f32 v204, v108, v109
    v_mfma_f32_16x16x32_bf16 v[124:127], a[204:207], a[84:87], v[124:127]
    s_waitcnt vmcnt(11)
    ds_write_b64 v24, v[160:161] offset:8192
    v_mfma_f32_16x16x32_bf16 v[124:127], a[208:211], a[88:91], v[124:127]
    s_waitcnt lgkmcnt(6)
    ds_read_b128 a[228:231], v1 offset:39936
    v_cvt_pk_bf16_f32 v205, v110, v111
    v_mfma_f32_16x16x32_bf16 v[124:127], a[212:215], a[92:95], v[124:127]
    ds_write_b64 v24, v[162:163] offset:8200
    v_mfma_f32_16x16x32_bf16 v[120:123], a[212:215], a[68:71], 0
    ds_read_b128 a[232:235], v1 offset:40960
    v_mfma_f32_16x16x32_bf16 v[120:123], a[208:211], a[64:67], v[120:123]
    s_waitcnt vmcnt(10)
    ds_write_b64 v24, v[164:165] offset:9216
    v_mfma_f32_16x16x32_bf16 v[120:123], a[204:207], a[60:63], v[120:123]
    ds_read_b128 a[236:239], v1 offset:41984
    v_cvt_pk_bf16_f32 v206, v124, v125
    v_mfma_f32_16x16x32_bf16 v[120:123], a[200:203], a[56:59], v[120:123]
    ds_write_b64 v24, v[166:167] offset:9224
    v_mfma_f32_16x16x32_bf16 v[120:123], a[196:199], a[52:55], v[120:123]
    v_cvt_pk_bf16_f32 v207, v126, v127
    v_mfma_f32_16x16x32_bf16 v[120:123], a[192:195], a[48:51], v[120:123]
    v_mfma_f32_16x16x32_bf16 v[116:119], a[192:195], a[24:27], 0
    s_waitcnt vmcnt(9)
    ds_write_b64 v24, v[168:169] offset:10240
    v_mfma_f32_16x16x32_bf16 v[116:119], a[196:199], a[28:31], v[116:119]
    ds_write_b64 v24, v[170:171] offset:10248
    v_mfma_f32_16x16x32_bf16 v[116:119], a[200:203], a[32:35], v[116:119]
    v_cvt_pk_bf16_f32 v202, v120, v121
    v_cvt_pk_bf16_f32 v203, v122, v123
    v_mfma_f32_16x16x32_bf16 v[116:119], a[204:207], a[36:39], v[116:119]
    v_mfma_f32_16x16x32_bf16 v[116:119], a[208:211], a[40:43], v[116:119]
    v_mfma_f32_16x16x32_bf16 v[116:119], a[212:215], a[44:47], v[116:119]
    v_mfma_f32_16x16x32_bf16 v[112:115], a[212:215], a[20:23], 0
    s_waitcnt vmcnt(8)
    ds_write_b64 v24, v[172:173] offset:11264
    v_mfma_f32_16x16x32_bf16 v[112:115], a[208:211], a[16:19], v[112:115]
    ds_write_b64 v24, v[174:175] offset:11272
    v_mfma_f32_16x16x32_bf16 v[112:115], a[204:207], a[12:15], v[112:115]
    buffer_load_dwordx4 a[104:107], v9, s[8:11], s24 offen offset:128 nt
    v_cvt_pk_bf16_f32 v198, v116, v117
    v_mfma_f32_16x16x32_bf16 v[112:115], a[200:203], a[8:11], v[112:115]
    buffer_load_dwordx4 a[108:111], v10, s[8:11], s24 offen offset:128 nt
    v_cvt_pk_bf16_f32 v199, v118, v119
    v_mfma_f32_16x16x32_bf16 v[112:115], a[196:199], a[4:7], v[112:115]
    ds_read_b128 a[240:243], v1 offset:43008
    v_mfma_f32_16x16x32_bf16 v[112:115], a[192:195], a[0:3], v[112:115]
    s_waitcnt lgkmcnt(5)
    v_mfma_f32_16x16x32_bf16 v[96:99], a[216:219], a[0:3], 0
    ds_read_b128 a[244:247], v1 offset:44032
    v_mfma_f32_16x16x32_bf16 v[96:99], a[220:223], a[4:7], v[96:99]
    s_waitcnt vmcnt(9)
    ds_write_b64 v24, v[176:177] offset:12288
    v_mfma_f32_16x16x32_bf16 v[96:99], a[224:227], a[8:11], v[96:99]
    ds_read_b128 a[248:251], v1 offset:45056
    v_cvt_pk_bf16_f32 v194, v112, v113
    v_mfma_f32_16x16x32_bf16 v[96:99], a[228:231], a[12:15], v[96:99]
    ds_write_b64 v24, v[178:179] offset:12296
    v_mfma_f32_16x16x32_bf16 v[96:99], a[232:235], a[16:19], v[96:99]
    ds_read_b128 a[192:195], v1 offset:46080
    v_cvt_pk_bf16_f32 v195, v114, v115
    v_mfma_f32_16x16x32_bf16 v[96:99], a[236:239], a[20:23], v[96:99]
    v_mfma_f32_16x16x32_bf16 v[100:103], a[236:239], a[44:47], 0
    ds_read_b128 a[196:199], v1 offset:47104
    v_mfma_f32_16x16x32_bf16 v[100:103], a[232:235], a[40:43], v[100:103]
    s_waitcnt vmcnt(8)
    ds_write_b64 v24, v[180:181] offset:13312
    v_mfma_f32_16x16x32_bf16 v[100:103], a[228:231], a[36:39], v[100:103]
    ds_read_b32 v30, v29
    v_cvt_pk_bf16_f32 v208, v96, v97
    v_mfma_f32_16x16x32_bf16 v[100:103], a[224:227], a[32:35], v[100:103]
    ds_read_b128 a[200:203], v1 offset:48128
    v_cvt_pk_bf16_f32 v209, v98, v99
    v_mfma_f32_16x16x32_bf16 v[100:103], a[220:223], a[28:31], v[100:103]
    ds_write_b64 v24, v[182:183] offset:13320
    v_mfma_f32_16x16x32_bf16 v[100:103], a[216:219], a[24:27], v[100:103]
    v_mfma_f32_16x16x32_bf16 v[104:107], a[216:219], a[48:51], 0
    s_waitcnt vmcnt(7)
    ds_write_b64 v24, v[184:185] offset:14336
    v_mfma_f32_16x16x32_bf16 v[104:107], a[220:223], a[52:55], v[104:107]
    ds_write_b64 v24, v[186:187] offset:14344
    v_mfma_f32_16x16x32_bf16 v[104:107], a[224:227], a[56:59], v[104:107]
    v_cvt_pk_bf16_f32 v212, v100, v101
    v_cvt_pk_bf16_f32 v213, v102, v103
    v_mfma_f32_16x16x32_bf16 v[104:107], a[228:231], a[60:63], v[104:107]
    v_mfma_f32_16x16x32_bf16 v[104:107], a[232:235], a[64:67], v[104:107]
    s_waitcnt lgkmcnt(4)
    v_readfirstlane_b32 s41, v30
    v_mfma_f32_16x16x32_bf16 v[104:107], a[236:239], a[68:71], v[104:107]
    v_mfma_f32_16x16x32_bf16 v[108:111], a[236:239], a[92:95], 0
    s_bitcmp1_b32 s41, 4
    s_cbranch_scc0 L_slow4
L_ok4:
    v_mfma_f32_16x16x32_bf16 v[108:111], a[232:235], a[88:91], v[108:111]
    buffer_load_dwordx4 a[112:115], v9, s[8:11], s24 offen offset:256 nt
    v_mfma_f32_16x16x32_bf16 v[108:111], a[228:231], a[84:87], v[108:111]
    buffer_load_dwordx4 a[116:119], v10, s[8:11], s24 offen offset:256 nt
    v_cvt_pk_bf16_f32 v216, v104, v105
    v_mfma_f32_16x16x32_bf16 v[108:111], a[224:227], a[80:83], v[108:111]
    s_add_u32 s24, s16, 6291456
    v_cvt_pk_bf16_f32 v217, v106, v107
    v_mfma_f32_16x16x32_bf16 v[108:111], a[220:223], a[76:79], v[108:111]
    ds_read_b128 a[204:207], v1 offset:49152
    v_mfma_f32_16x16x32_bf16 v[108:111], a[216:219], a[72:75], v[108:111]
    s_waitcnt vmcnt(8)
    ds_write_b64 v24, v[188:189] offset:15360
    v_mfma_f32_16x16x32_bf16 v[124:127], a[240:243], a[72:75], 0
    ds_read_b128 a[208:211], v1 offset:50176
    v_mfma_f32_16x16x32_bf16 v[124:127], a[244:247], a[76:79], v[124:127]
    ds_write_b64 v24, v[190:191] offset:15368
    v_mfma_f32_16x16x32_bf16 v[124:127], a[248:251], a[80:83], v[124:127]
    ds_read_b128 a[212:215], v1 offset:51200
    v_cvt_pk_bf16_f32 v220, v108, v109
    v_mfma_f32_16x16x32_bf16 v[124:127], a[192:195], a[84:87], v[124:127]
    s_waitcnt vmcnt(7)
    ds_write_b64 v24, v[224:225] offset:16384
    v_mfma_f32_16x16x32_bf16 v[124:127], a[196:199], a[88:91], v[124:127]
    s_waitcnt lgkmcnt(6)
    ds_read_b128 a[216:219], v1 offset:52224
    v_cvt_pk_bf16_f32 v221, v110, v111
    v_mfma_f32_16x16x32_bf16 v[124:127], a[200:203], a[92:95], v[124:127]
    ds_write_b64 v24, v[226:227] offset:16392
    v_mfma_f32_16x16x32_bf16 v[120:123], a[200:203], a[68:71], 0
    ds_read_b128 a[220:223], v1 offset:53248
    v_mfma_f32_16x16x32_bf16 v[120:123], a[196:199], a[64:67], v[120:123]
    s_waitcnt vmcnt(6)
    ds_write_b64 v24, v[228:229] offset:17408
    v_mfma_f32_16x16x32_bf16 v[120:123], a[192:195], a[60:63], v[120:123]
    ds_read_b128 a[224:227], v1 offset:54272
    v_cvt_pk_bf16_f32 v222, v124, v125
    v_mfma_f32_16x16x32_bf16 v[120:123], a[248:251], a[56:59], v[120:123]
    ds_write_b64 v24, v[230:231] offset:17416
    v_mfma_f32_16x16x32_bf16 v[120:123], a[244:247], a[52:55], v[120:123]
    ds_or_b32 v29, v25
    v_mfma_f32_16x16x32_bf16 v[120:123], a[240:243], a[48:51], v[120:123]
    v_cvt_pk_bf16_f32 v223, v126, v127
    v_mfma_f32_16x16x32_bf16 v[116:119], a[240:243], a[24:27], 0
    v_mfma_f32_16x16x32_bf16 v[116:119], a[244:247], a[28:31], v[116:119]
    v_mfma_f32_16x16x32_bf16 v[116:119], a[248:251], a[32:35], v[116:119]
    v_cvt_pk_bf16_f32 v218, v120, v121
    v_cvt_pk_bf16_f32 v219, v122, v123
    v_mfma_f32_16x16x32_bf16 v[116:119], a[192:195], a[36:39], v[116:119]
    v_mfma_f32_16x16x32_bf16 v[116:119], a[196:199], a[40:43], v[116:119]
    buffer_load_dwordx4 a[120:123], v9, s[8:11], s26 offen offset:0 nt
    v_mfma_f32_16x16x32_bf16 v[116:119], a[200:203], a[44:47], v[116:119]
    buffer_load_dwordx4 a[124:127], v10, s[8:11], s26 offen offset:0 nt
    v_mfma_f32_16x16x32_bf16 v[112:115], a[200:203], a[20:23], 0
    v_mfma_f32_16x16x32_bf16 v[112:115], a[196:199], a[16:19], v[112:115]
    v_mfma_f32_16x16x32_bf16 v[112:115], a[192:195], a[12:15], v[112:115]
    v_cvt_pk_bf16_f32 v214, v116, v117
    v_cvt_pk_bf16_f32 v215, v118, v119
    v_mfma_f32_16x16x32_bf16 v[112:115], a[248:251], a[8:11], v[112:115]
    v_mfma_f32_16x16x32_bf16 v[112:115], a[244:247], a[4:7], v[112:115]
    v_mfma_f32_16x16x32_bf16 v[112:115], a[240:243], a[0:3], v[112:115]
    s_waitcnt lgkmcnt(0)
    v_mfma_f32_16x16x32_bf16 v[96:99], a[204:207], a[0:3], 0
    v_mfma_f32_16x16x32_bf16 v[96:99], a[208:211], a[4:7], v[96:99]
    v_mfma_f32_16x16x32_bf16 v[96:99], a[212:215], a[8:11], v[96:99]
    v_cvt_pk_bf16_f32 v210, v112, v113
    v_cvt_pk_bf16_f32 v211, v114, v115
    v_mfma_f32_16x16x32_bf16 v[96:99], a[216:219], a[12:15], v[96:99]
    v_mfma_f32_16x16x32_bf16 v[96:99], a[220:223], a[16:19], v[96:99]
    v_mfma_f32_16x16x32_bf16 v[96:99], a[224:227], a[20:23], v[96:99]
    v_mfma_f32_16x16x32_bf16 v[100:103], a[224:227], a[44:47], 0
    v_mfma_f32_16x16x32_bf16 v[100:103], a[220:223], a[40:43], v[100:103]
    v_mfma_f32_16x16x32_bf16 v[100:103], a[216:219], a[36:39], v[100:103]
    v_mfma_f32_16x16x32_bf16 v[100:103], a[212:215], a[32:35], v[100:103]
    v_mfma_f32_16x16x32_bf16 v[100:103], a[208:211], a[28:31], v[100:103]
    v_mfma_f32_16x16x32_bf16 v[100:103], a[204:207], a[24:27], v[100:103]
    v_mfma_f32_16x16x32_bf16 v[32:35], a[8:11], v[192:195], v[32:35]
    v_mfma_f32_16x16x32_bf16 v[32:35], a[12:15], v[208:211], v[32:35]
    v_mfma_f32_16x16x32_bf16 v[36:39], a[36:39], v[208:211], v[36:39]
    buffer_load_dwordx4 a[128:131], v9, s[8:11], s26 offen offset:128 nt
    v_mfma_f32_16x16x32_bf16 v[36:39], a[32:35], v[192:195], v[36:39]
    buffer_load_dwordx4 a[132:135], v10, s[8:11], s26 offen offset:128 nt
    v_mfma_f32_16x16x32_bf16 v[40:43], a[56:59], v[192:195], v[40:43]
    v_mfma_f32_16x16x32_bf16 v[40:43], a[60:63], v[208:211], v[40:43]
    v_mfma_f32_16x16x32_bf16 v[44:47], a[84:87], v[208:211], v[44:47]
    v_mfma_f32_16x16x32_bf16 v[44:47], a[80:83], v[192:195], v[44:47]
    v_cvt_pk_bf16_f32 v192, v96, v97
    v_cvt_pk_bf16_f32 v193, v98, v99
    v_mfma_f32_16x16x32_bf16 v[60:63], a[80:83], v[196:199], v[60:63]
    v_mfma_f32_16x16x32_bf16 v[60:63], a[84:87], v[212:215], v[60:63]
    v_mfma_f32_16x16x32_bf16 v[56:59], a[60:63], v[212:215], v[56:59]
    v_mfma_f32_16x16x32_bf16 v[56:59], a[56:59], v[196:199], v[56:59]
    v_mfma_f32_16x16x32_bf16 v[52:55], a[32:35], v[196:199], v[52:55]
    v_mfma_f32_16x16x32_bf16 v[52:55], a[36:39], v[212:215], v[52:55]
    v_mfma_f32_16x16x32_bf16 v[48:51], a[12:15], v[212:215], v[48:51]
    v_mfma_f32_16x16x32_bf16 v[48:51], a[8:11], v[196:199], v[48:51]
    v_cvt_pk_bf16_f32 v196, v100, v101
    v_cvt_pk_bf16_f32 v197, v102, v103
    v_mfma_f32_16x16x32_bf16 v[64:67], a[8:11], v[200:203], v[64:67]
    v_mfma_f32_16x16x32_bf16 v[64:67], a[12:15], v[216:219], v[64:67]
    v_mfma_f32_16x16x32_bf16 v[68:71], a[36:39], v[216:219], v[68:71]
    ds_read_b128 a[228:231], v1 offset:55296
    v_mfma_f32_16x16x32_bf16 v[68:71], a[32:35], v[200:203], v[68:71]
    v_mfma_f32_16x16x32_bf16 v[72:75], a[56:59], v[200:203], v[72:75]
    ds_read_b128 a[232:235], v1 offset:56320
    v_mfma_f32_16x16x32_bf16 v[72:75], a[60:63], v[216:219], v[72:75]
    v_mfma_f32_16x16x32_bf16 v[76:79], a[84:87], v[216:219], v[76:79]
    ds_read_b128 a[236:239], v1 offset:57344
    v_mfma_f32_16x16x32_bf16 v[76:79], a[80:83], v[200:203], v[76:79]
    v_mfma_f32_16x16x32_bf16 v[92:95], a[80:83], v[204:207], v[92:95]
    buffer_load_dwordx4 a[136:139], v9, s[8:11], s26 offen offset:256 nt
    v_mfma_f32_16x16x32_bf16 v[92:95], a[84:87], v[220:223], v[92:95]
    buffer_load_dwordx4 a[140:143], v10, s[8:11], s26 offen offset:256 nt
    s_add_u32 s26, s16, 6684672
    v_mfma_f32_16x16x32_bf16 v[88:91], a[60:63], v[220:223], v[88:91]
    ds_read_b128 a[240:243], v1 offset:58368
    v_mfma_f32_16x16x32_bf16 v[88:91], a[56:59], v[204:207], v[88:91]
    ds_read_b128 a[244:247], v1 offset:59392
    v_mfma_f32_16x16x32_bf16 v[84:87], a[32:35], v[204:207], v[84:87]
    ds_read_b32 v30, v29
    v_mfma_f32_16x16x32_bf16 v[84:87], a[36:39], v[220:223], v[84:87]
    ds_read_b128 a[248:251], v1 offset:60416
    v_mfma_f32_16x16x32_bf16 v[80:83], a[12:15], v[220:223], v[80:83]
    v_mfma_f32_16x16x32_bf16 v[80:83], a[8:11], v[204:207], v[80:83]
    v_mfma_f32_16x16x32_bf16 v[104:107], a[204:207], a[48:51], 0
    v_mfma_f32_16x16x32_bf16 v[104:107], a[208:211], a[52:55], v[104:107]
    v_mfma_f32_16x16x32_bf16 v[104:107], a[212:215], a[56:59], v[104:107]
    v_mfma_f32_16x16x32_bf16 v[104:107], a[216:219], a[60:63], v[104:107]
    v_mfma_f32_16x16x32_bf16 v[104:107], a[220:223], a[64:67], v[104:107]
    v_mfma_f32_16x16x32_bf16 v[104:107], a[224:227], a[68:71], v[104:107]
    s_waitcnt lgkmcnt(1)
    v_readfirstlane_b32 s41, v30
    v_mfma_f32_16x16x32_bf16 v[108:111], a[224:227], a[92:95], 0
    v_mfma_f32_16x16x32_bf16 v[108:111], a[220:223], a[88:91], v[108:111]
    s_bitcmp1_b32 s41, 5
    s_cbranch_scc0 L_slow5
L_ok5:
    v_mfma_f32_16x16x32_bf16 v[108:111], a[216:219], a[84:87], v[108:111]
    v_cvt_pk_bf16_f32 v200, v104, v105
    v_cvt_pk_bf16_f32 v201, v106, v107
    v_mfma_f32_16x16x32_bf16 v[108:111], a[212:215], a[80:83], v[108:111]
    v_mfma_f32_16x16x32_bf16 v[108:111], a[208:211], a[76:79], v[108:111]
    ds_read_b128 a[192:195], v1 offset:61440
    v_mfma_f32_16x16x32_bf16 v[108:111], a[204:207], a[72:75], v[108:111]
    v_mfma_f32_16x16x32_bf16 v[124:127], a[228:231], a[72:75], 0
    ds_read_b128 a[196:199], v1 offset:62464
    v_mfma_f32_16x16x32_bf16 v[124:127], a[232:235], a[76:79], v[124:127]
    v_mfma_f32_16x16x32_bf16 v[124:127], a[236:239], a[80:83], v[124:127]
    buffer_load_dwordx4 a[144:147], v9, s[8:11], s28 offen offset:0 nt
    v_cvt_pk_bf16_f32 v204, v108, v109
    v_mfma_f32_16x16x32_bf16 v[124:127], a[240:243], a[84:87], v[124:127]
    buffer_load_dwordx4 a[148:151], v10, s[8:11], s28 offen offset:0 nt
    v_cvt_pk_bf16_f32 v205, v110, v111
    v_mfma_f32_16x16x32_bf16 v[124:127], a[244:247], a[88:91], v[124:127]
    s_waitcnt lgkmcnt(2)
    ds_read_b128 a[200:203], v1 offset:63488
    v_mfma_f32_16x16x32_bf16 v[124:127], a[248:251], a[92:95], v[124:127]
    ds_read_b128 a[204:207], v1 offset:64512
    v_mfma_f32_16x16x32_bf16 v[120:123], a[248:251], a[68:71], 0
    ds_read_b128 a[208:211], v2 offset:0
    v_mfma_f32_16x16x32_bf16 v[120:123], a[244:247], a[64:67], v[120:123]
    v_mfma_f32_16x16x32_bf16 v[120:123], a[240:243], a[60:63], v[120:123]
    ds_read_b128 a[212:215], v2 offset:1024
    v_cvt_pk_bf16_f32 v206, v124, v125
    v_mfma_f32_16x16x32_bf16 v[120:123], a[236:239], a[56:59], v[120:123]
    v_cvt_pk_bf16_f32 v207, v126, v127
    v_mfma_f32_16x16x32_bf16 v[120:123], a[232:235], a[52:55], v[120:123]
    v_mfma_f32_16x16x32_bf16 v[120:123], a[228:231], a[48:51], v[120:123]
    v_mfma_f32_16x16x32_bf16 v[116:119], a[228:231], a[24:27], 0
    v_mfma_f32_16x16x32_bf16 v[116:119], a[232:235], a[28:31], v[116:119]
    v_mfma_f32_16x16x32_bf16 v[116:119], a[236:239], a[32:35], v[116:119]
    v_cvt_pk_bf16_f32 v202, v120, v121
    v_cvt_pk_bf16_f32 v203, v122, v123
    v_mfma_f32_16x16x32_bf16 v[116:119], a[240:243], a[36:39], v[116:119]
    v_mfma_f32_16x16x32_bf16 v[116:119], a[244:247], a[40:43], v[116:119]
    v_mfma_f32_16x16x32_bf16 v[116:119], a[248:251], a[44:47], v[116:119]
    v_mfma_f32_16x16x32_bf16 v[112:115], a[248:251], a[20:23], 0
    v_mfma_f32_16x16x32_bf16 v[112:115], a[244:247], a[16:19], v[112:115]
    v_mfma_f32_16x16x32_bf16 v[112:115], a[240:243], a[12:15], v[112:115]
    v_cvt_pk_bf16_f32 v198, v116, v117
    v_cvt_pk_bf16_f32 v199, v118, v119
    v_mfma_f32_16x16x32_bf16 v[112:115], a[236:239], a[8:11], v[112:115]
    v_mfma_f32_16x16x32_bf16 v[112:115], a[232:235], a[4:7], v[112:115]
    ds_read_b128 a[216:219], v2 offset:2048
    v_mfma_f32_16x16x32_bf16 v[112:115], a[228:231], a[0:3], v[112:115]
    s_waitcnt lgkmcnt(1)
    v_mfma_f32_16x16x32_bf16 v[96:99], a[192:195], a[0:3], 0
    buffer_load_dwordx4 a[168:171], v9, s[8:11], s30 offen offset:0 nt
    v_mfma_f32_16x16x32_bf16 v[96:99], a[196:199], a[4:7], v[96:99]
    buffer_load_dwordx4 a[172:175], v10, s[8:11], s30 offen offset:0 nt
    v_mfma_f32_16x16x32_bf16 v[96:99], a[200:203], a[8:11], v[96:99]
    ds_read_b128 a[220:223], v2 offset:3072
    v_cvt_pk_bf16_f32 v194, v112, v113
    v_mfma_f32_16x16x32_bf16 v[96:99], a[204:207], a[12:15], v[96:99]
    ds_read_b128 a[224:227], v2 offset:4096
    v_cvt_pk_bf16_f32 v195, v114, v115
    v_mfma_f32_16x16x32_bf16 v[96:99], a[208:211], a[16:19], v[96:99]
    ds_read_b128 a[228:231], v2 offset:5120
    v_mfma_f32_16x16x32_bf16 v[96:99], a[212:215], a[20:23], v[96:99]
    v_mfma_f32_16x16x32_bf16 v[100:103], a[212:215], a[44:47], 0
    ds_read_b128 a[232:235], v2 offset:6144
    v_mfma_f32_16x16x32_bf16 v[100:103], a[208:211], a[40:43], v[100:103]
    s_waitcnt vmcnt(15)
    ds_write_b32 v4, a96 offset:0
    v_mfma_f32_16x16x32_bf16 v[100:103], a[204:207], a[36:39], v[100:103]
    ds_read_b32 v30, v29
    v_cvt_pk_bf16_f32 v208, v96, v97
    v_mfma_f32_16x16x32_bf16 v[100:103], a[200:203], a[32:35], v[100:103]
    ds_read_b128 a[236:239], v2 offset:7168
    v_cvt_pk_bf16_f32 v209, v98, v99
    v_mfma_f32_16x16x32_bf16 v[100:103], a[196:199], a[28:31], v[100:103]
    ds_write_b32 v4, a97 offset:4
    v_mfma_f32_16x16x32_bf16 v[100:103], a[192:195], a[24:27], v[100:103]
    ds_write_b32 v4, a98 offset:1024
    v_mfma_f32_16x16x32_bf16 v[104:107], a[192:195], a[48:51], 0
    ds_write_b32 v4, a99 offset:1028
    v_mfma_f32_16x16x32_bf16 v[104:107], a[196:199], a[52:55], v[104:107]
    s_waitcnt vmcnt(14)
    ds_write_b32 v4, a100 offset:512
    v_mfma_f32_16x16x32_bf16 v[104:107], a[200:203], a[56:59], v[104:107]
    ds_write_b32 v4, a101 offset:516
    v_mfma_f32_16x16x32_bf16 v[104:107], a[204:207], a[60:63], v[104:107]
    ds_write_b32 v4, a102 offset:1536
    v_mfma_f32_16x16x32_bf16 v[104:107], a[208:211], a[64:67], v[104:107]
    ds_write_b32 v4, a103 offset:1540
    v_mfma_f32_16x16x32_bf16 v[104:107], a[212:215], a[68:71], v[104:107]
    s_waitcnt lgkmcnt(8)
    ds_read2_b64 a[96:99], v5 offset0:0 offset1:128
    v_readfirstlane_b32 s41, v30
    v_mfma_f32_16x16x32_bf16 v[108:111], a[212:215], a[92:95], 0
    ds_read2_b64 a[100:103], v6 offset0:0 offset1:128
    v_cvt_pk_bf16_f32 v212, v100, v101
    v_mfma_f32_16x16x32_bf16 v[108:111], a[208:211], a[88:91], v[108:111]
    s_andn2_b32 s41, 960, s41
    s_cbranch_scc1 L_slow6
L_ok6:
    v_cvt_pk_bf16_f32 v213, v102, v103
    v_mfma_f32_16x16x32_bf16 v[108:111], a[204:207], a[84:87], v[108:111]
    v_cvt_pk_bf16_f32 v216, v104, v105
    v_cvt_pk_bf16_f32 v217, v106, v107
    v_mfma_f32_16x16x32_bf16 v[108:111], a[200:203], a[80:83], v[108:111]
    v_mfma_f32_16x16x32_bf16 v[108:111], a[196:199], a[76:79], v[108:111]
    ds_read_b128 a[240:243], v2 offset:8192
    v_mfma_f32_16x16x32_bf16 v[108:111], a[192:195], a[72:75], v[108:111]
    v_mfma_f32_16x16x32_bf16 v[124:127], a[216:219], a[72:75], 0
    ds_read_b128 a[244:247], v2 offset:9216
    v_mfma_f32_16x16x32_bf16 v[124:127], a[220:223], a[76:79], v[124:127]
    v_mfma_f32_16x16x32_bf16 v[124:127], a[224:227], a[80:83], v[124:127]
    ds_read_b128 a[248:251], v2 offset:10240
    v_cvt_pk_bf16_f32 v220, v108, v109
    v_mfma_f32_16x16x32_bf16 v[124:127], a[228:231], a[84:87], v[124:127]
    v_cvt_pk_bf16_f32 v221, v110, v111
    v_mfma_f32_16x16x32_bf16 v[124:127], a[232:235], a[88:91], v[124:127]
    s_waitcnt lgkmcnt(7)
    ds_read_b128 a[192:195], v2 offset:11264
    v_mfma_f32_16x16x32_bf16 v[124:127], a[236:239], a[92:95], v[124:127]
    v_mfma_f32_16x16x32_bf16 v[120:123], a[236:239], a[68:71], 0
    ds_read_b128 a[196:199], v2 offset:12288
    v_mfma_f32_16x16x32_bf16 v[120:123], a[232:235], a[64:67], v[120:123]
    s_waitcnt vmcnt(13)
    ds_write_b32 v4, a104 offset:0
    v_mfma_f32_16x16x32_bf16 v[120:123], a[228:231], a[60:63], v[120:123]
    ds_read_b128 a[200:203], v2 offset:13312
    v_cvt_pk_bf16_f32 v222, v124, v125
    v_mfma_f32_16x16x32_bf16 v[120:123], a[224:227], a[56:59], v[120:123]
    ds_write_b32 v4, a105 offset:4
    v_mfma_f32_16x16x32_bf16 v[120:123], a[220:223], a[52:55], v[120:123]
    ds_write_b32 v4, a106 offset:1024
    v_mfma_f32_16x16x32_bf16 v[120:123], a[216:219], a[48:51], v[120:123]
    ds_write_b32 v4, a107 offset:1028
    v_mfma_f32_16x16x32_bf16 v[116:119], a[216:219], a[24:27], 0
    s_waitcnt vmcnt(12)
    ds_write_b32 v4, a108 offset:512
    v_mfma_f32_16x16x32_bf16 v[116:119], a[220:223], a[28:31], v[116:119]
    ds_write_b32 v4, a109 offset:516
    v_mfma_f32_16x16x32_bf16 v[116:119], a[224:227], a[32:35], v[116:119]
    ds_write_b32 v4, a110 offset:1536
    v_mfma_f32_16x16x32_bf16 v[116:119], a[228:231], a[36:39], v[116:119]
    ds_write_b32 v4, a111 offset:1540
    v_mfma_f32_16x16x32_bf16 v[116:119], a[232:235], a[40:43], v[116:119]
    ds_read2_b64 a[104:107], v5 offset0:0 offset1:128
    v_cvt_pk_bf16_f32 v218, v120, v121
    v_mfma_f32_16x16x32_bf16 v[116:119], a[236:239], a[44:47], v[116:119]
    ds_read2_b64 a[108:111], v6 offset0:0 offset1:128
    v_cvt_pk_bf16_f32 v219, v122, v123
    v_mfma_f32_16x16x32_bf16 v[112:115], a[236:239], a[20:23], 0
    v_cvt_pk_bf16_f32 v223, v126, v127
    v_mfma_f32_16x16x32_bf16 v[112:115], a[232:235], a[16:19], v[112:115]
    v_mfma_f32_16x16x32_bf16 v[112:115], a[228:231], a[12:15], v[112:115]
    v_cvt_pk_bf16_f32 v214, v116, v117
    v_cvt_pk_bf16_f32 v215, v118, v119
    v_mfma_f32_16x16x32_bf16 v[112:115], a[224:227], a[8:11], v[112:115]
    v_mfma_f32_16x16x32_bf16 v[112:115], a[220:223], a[4:7], v[112:115]
    v_mfma_f32_16x16x32_bf16 v[112:115], a[216:219], a[0:3], v[112:115]
    s_waitcnt lgkmcnt(8)
    v_mfma_f32_16x16x32_bf16 v[96:99], a[0:3], a[240:243], 0
    v_mfma_f32_16x16x32_bf16 v[96:99], a[4:7], a[244:247], v[96:99]
    v_mfma_f32_16x16x32_bf16 v[96:99], a[8:11], a[248:251], v[96:99]
    v_cvt_pk_bf16_f32 v210, v112, v113
    v_cvt_pk_bf16_f32 v211, v114, v115
    v_mfma_f32_16x16x32_bf16 v[96:99], a[12:15], a[192:195], v[96:99]
    v_mfma_f32_16x16x32_bf16 v[96:99], a[16:19], a[196:199], v[96:99]
    v_mfma_f32_16x16x32_bf16 v[96:99], a[20:23], a[200:203], v[96:99]
    v_mfma_f32_16x16x32_bf16 v[100:103], a[44:47], a[200:203], 0
    v_mfma_f32_16x16x32_bf16 v[100:103], a[40:43], a[196:199], v[100:103]
    v_mfma_f32_16x16x32_bf16 v[100:103], a[36:39], a[192:195], v[100:103]
    s_waitcnt vmcnt(11)
    ds_write_b32 v4, a112 offset:0
    v_mfma_f32_16x16x32_bf16 v[100:103], a[32:35], a[248:251], v[100:103]
    ds_write_b32 v4, a113 offset:4
    v_mfma_f32_16x16x32_bf16 v[100:103], a[28:31], a[244:247], v[100:103]
    ds_write_b32 v4, a114 offset:1024
    v_mfma_f32_16x16x32_bf16 v[100:103], a[24:27], a[240:243], v[100:103]
    ds_write_b32 v4, a115 offset:1028
    v_mfma_f32_16x16x32_bf16 v[32:35], a[16:19], v[192:195], v[32:35]
    s_waitcnt vmcnt(10)
    ds_write_b32 v4, a116 offset:512
    v_mfma_f32_16x16x32_bf16 v[32:35], a[20:23], v[208:211], v[32:35]
    ds_write_b32 v4, a117 offset:516
    v_mfma_f32_16x16x32_bf16 v[36:39], a[44:47], v[208:211], v[36:39]
    v_cvt_pk_bf16_f32 v128, v96, v97
    v_cvt_pk_bf16_f32 v129, v98, v99
    v_mfma_f32_16x16x32_bf16 v[36:39], a[40:43], v[192:195], v[36:39]
L_loop:
    v_mfma_f32_16x16x32_bf16 v[40:43], a[64:67], v[192:195], v[40:43]
    ds_write_b32 v4, a118 offset:1536
    v_mfma_f32_16x16x32_bf16 v[40:43], a[68:71], v[208:211], v[40:43]
    ds_write_b32 v4, a119 offset:1540
    v_mfma_f32_16x16x32_bf16 v[44:47], a[92:95], v[208:211], v[44:47]
    ds_read2_b64 a[112:115], v5 offset0:0 offset1:128
    v_cvt_pk_bf16_f32 v130, v100, v101
    v_mfma_f32_16x16x32_bf16 v[44:47], a[88:91], v[192:195], v[44:47]
    ds_read2_b64 a[116:119], v6 offset0:0 offset1:128
    v_cvt_pk_bf16_f32 v131, v102, v103
    v_mfma_f32_16x16x32_bf16 v[60:63], a[88:91], v[196:199], v[60:63]
    v_max3_f32 v12, v32, v33, v34
    v_max3_f32 v12, v12, v35, v36
    v_mfma_f32_16x16x32_bf16 v[60:63], a[92:95], v[212:215], v[60:63]
    v_max3_f32 v12, v12, v37, v38
    v_max3_f32 v12, v12, v39, v40
    v_mfma_f32_16x16x32_bf16 v[56:59], a[68:71], v[212:215], v[56:59]
    v_max3_f32 v12, v12, v41, v42
    v_max3_f32 v12, v12, v43, v44
    v_mfma_f32_16x16x32_bf16 v[56:59], a[64:67], v[196:199], v[56:59]
    v_max3_f32 v12, v12, v45, v46
    v_max_f32 v12, v12, v47
    v_mfma_f32_16x16x32_bf16 v[52:55], a[40:43], v[196:199], v[52:55]
    v_mfma_f32_16x16x32_bf16 v[52:55], a[44:47], v[212:215], v[52:55]
    v_mfma_f32_16x16x32_bf16 v[48:51], a[20:23], v[212:215], v[48:51]
    v_mfma_f32_16x16x32_bf16 v[48:51], a[16:19], v[196:199], v[48:51]
    v_mfma_f32_16x16x32_bf16 v[64:67], a[16:19], v[200:203], v[64:67]
    v_mfma_f32_16x16x32_bf16 v[64:67], a[20:23], v[216:219], v[64:67]
    v_mfma_f32_16x16x32_bf16 v[68:71], a[44:47], v[216:219], v[68:71]
    ds_read_b128 a[204:207], v2 offset:14336
    v_max3_f32 v13, v48, v49, v50
    v_mfma_f32_16x16x32_bf16 v[68:71], a[40:43], v[200:203], v[68:71]
    v_max3_f32 v13, v13, v51, v52
    v_max3_f32 v13, v13, v53, v54
    v_mfma_f32_16x16x32_bf16 v[72:75], a[64:67], v[200:203], v[72:75]
    ds_read_b128 a[208:211], v2 offset:15360
    v_max3_f32 v14, v64, v65, v66
    v_mfma_f32_16x16x32_bf16 v[72:75], a[68:71], v[216:219], v[72:75]
    v_max3_f32 v13, v13, v55, v56
    v_max3_f32 v13, v13, v57, v58
    v_mfma_f32_16x16x32_bf16 v[76:79], a[92:95], v[216:219], v[76:79]
    ds_read_b128 a[212:215], v2 offset:16384
    v_max3_f32 v14, v14, v67, v68
    v_mfma_f32_16x16x32_bf16 v[76:79], a[88:91], v[200:203], v[76:79]
    v_max3_f32 v14, v14, v69, v70
    v_max3_f32 v13, v13, v59, v60
    v_mfma_f32_16x16x32_bf16 v[92:95], a[88:91], v[204:207], v[92:95]
    ds_read_b128 a[216:219], v2 offset:17408
    v_max3_f32 v14, v14, v71, v72
    v_mfma_f32_16x16x32_bf16 v[92:95], a[92:95], v[220:223], v[92:95]
    v_max3_f32 v14, v14, v73, v74
    v_max3_f32 v13, v13, v61, v62
    v_mfma_f32_16x16x32_bf16 v[88:91], a[68:71], v[220:223], v[88:91]
    ds_read_b128 a[220:223], v2 offset:18432
    v_max3_f32 v14, v14, v75, v76
    v_mfma_f32_16x16x32_bf16 v[88:91], a[64:67], v[204:207], v[88:91]
    v_max3_f32 v14, v14, v77, v78
    v_max_f32 v13, v13, v63
    v_mfma_f32_16x16x32_bf16 v[84:87], a[40:43], v[204:207], v[84:87]
    ds_read_b128 a[224:227], v2 offset:19456
    v_max_f32 v14, v14, v79
    v_mfma_f32_16x16x32_bf16 v[84:87], a[44:47], v[220:223], v[84:87]
    v_permlane16_swap_b32 v12, v13
    v_mfma_f32_16x16x32_bf16 v[80:83], a[20:23], v[220:223], v[80:83]
    v_max_f32 v12, v12, v13
    v_mfma_f32_16x16x32_bf16 v[80:83], a[16:19], v[204:207], v[80:83]
    v_mfma_f32_16x16x32_bf16 v[104:107], a[48:51], a[240:243], 0
    v_mfma_f32_16x16x32_bf16 v[104:107], a[52:55], a[244:247], v[104:107]
    v_mfma_f32_16x16x32_bf16 v[104:107], a[56:59], a[248:251], v[104:107]
    v_max3_f32 v15, v80, v81, v82
    v_max3_f32 v15, v15, v83, v84
    v_mfma_f32_16x16x32_bf16 v[104:107], a[60:63], a[192:195], v[104:107]
    v_max3_f32 v15, v15, v85, v86
    v_max3_f32 v15, v15, v87, v88
    v_mfma_f32_16x16x32_bf16 v[104:107], a[64:67], a[196:199], v[104:107]
    v_max3_f32 v15, v15, v89, v90
    v_max3_f32 v15, v15, v91, v92
    v_mfma_f32_16x16x32_bf16 v[104:107], a[68:71], a[200:203], v[104:107]
    v_max3_f32 v15, v15, v93, v94
    v_max_f32 v15, v15, v95
    v_mfma_f32_16x16x32_bf16 v[108:111], a[92:95], a[200:203], 0
    v_mfma_f32_16x16x32_bf16 v[108:111], a[88:91], a[196:199], v[108:111]
    v_permlane16_swap_b32 v14, v15
    v_mfma_f32_16x16x32_bf16 v[108:111], a[84:87], a[192:195], v[108:111]
    v_cvt_pk_bf16_f32 v132, v104, v105
    v_cvt_pk_bf16_f32 v133, v106, v107
    v_mfma_f32_16x16x32_bf16 v[108:111], a[80:83], a[248:251], v[108:111]
    v_max_f32 v14, v14, v15
    v_mfma_f32_16x16x32_bf16 v[108:111], a[76:79], a[244:247], v[108:111]
    ds_read_b128 a[228:231], v2 offset:20480
    v_mfma_f32_16x16x32_bf16 v[108:111], a[72:75], a[240:243], v[108:111]
    s_waitcnt lgkmcnt(1)
    v_permlane32_swap_b32 v12, v14
    v_mfma_f32_16x16x32_bf16 v[124:127], a[72:75], a[204:207], 0
    ds_read_b128 a[232:235], v2 offset:21504
    v_max_f32 v12, v12, v14
    v_mfma_f32_16x16x32_bf16 v[124:127], a[76:79], a[208:211], v[124:127]
    v_mov_b32 v14, v12
    v_mfma_f32_16x16x32_bf16 v[124:127], a[80:83], a[212:215], v[124:127]
    ds_read_b128 a[236:239], v2 offset:22528
    v_cvt_pk_bf16_f32 v134, v108, v109
    v_mfma_f32_16x16x32_bf16 v[124:127], a[84:87], a[216:219], v[124:127]
    v_cvt_pk_bf16_f32 v135, v110, v111
    v_mfma_f32_16x16x32_bf16 v[124:127], a[88:91], a[220:223], v[124:127]
    ds_read_b128 a[240:243], v2 offset:23552
    v_mfma_f32_16x16x32_bf16 v[124:127], a[92:95], a[224:227], v[124:127]
    v_permlane32_swap_b32 v12, v14
    v_mfma_f32_16x16x32_bf16 v[120:123], a[68:71], a[224:227], 0
    ds_read_b128 a[244:247], v2 offset:24576
    v_mov_b32 v13, v12
    v_mfma_f32_16x16x32_bf16 v[120:123], a[64:67], a[220:223], v[120:123]
    v_mov_b32 v15, v14
    v_mfma_f32_16x16x32_bf16 v[120:123], a[60:63], a[216:219], v[120:123]
    ds_read_b128 a[248:251], v2 offset:25600
    v_cvt_pk_bf16_f32 v142, v124, v125
    v_mfma_f32_16x16x32_bf16 v[120:123], a[56:59], a[212:215], v[120:123]
    v_cvt_pk_bf16_f32 v143, v126, v127
    v_mfma_f32_16x16x32_bf16 v[120:123], a[52:55], a[208:211], v[120:123]
    v_permlane16_swap_b32 v12, v13
    v_mfma_f32_16x16x32_bf16 v[120:123], a[48:51], a[204:207], v[120:123]
    v_permlane16_swap_b32 v14, v15
    v_mfma_f32_16x16x32_bf16 v[116:119], a[24:27], a[204:207], 0
    v_sub_f32 v32, v32, v12
    v_sub_f32 v33, v33, v12
    v_mfma_f32_16x16x32_bf16 v[116:119], a[28:31], a[208:211], v[116:119]
    v_sub_f32 v48, v48, v13
    v_sub_f32 v49, v49, v13
    v_mfma_f32_16x16x32_bf16 v[116:119], a[32:35], a[212:215], v[116:119]
    buffer_load_dwordx4 a[152:155], v9, s[8:11], s28 offen offset:128 nt
    v_cvt_pk_bf16_f32 v140, v120, v121
    v_mfma_f32_16x16x32_bf16 v[116:119], a[36:39], a[216:219], v[116:119]
    buffer_load_dwordx4 a[156:159], v10, s[8:11], s28 offen offset:128 nt
    v_cvt_pk_bf16_f32 v141, v122, v123
    v_mfma_f32_16x16x32_bf16 v[116:119], a[40:43], a[220:223], v[116:119]
    v_sub_f32 v64, v64, v14
    v_sub_f32 v65, v65, v14
    v_mfma_f32_16x16x32_bf16 v[116:119], a[44:47], a[224:227], v[116:119]
    v_sub_f32 v80, v80, v15
    v_sub_f32 v81, v81, v15
    v_mfma_f32_16x16x32_bf16 v[112:115], a[20:23], a[224:227], 0
    v_exp_f32 v32, v32
    v_mfma_f32_16x16x32_bf16 v[112:115], a[16:19], a[220:223], v[112:115]
    v_exp_f32 v33, v33
    v_mfma_f32_16x16x32_bf16 v[112:115], a[12:15], a[216:219], v[112:115]
    v_cvt_pk_bf16_f32 v138, v116, v117
    v_cvt_pk_bf16_f32 v139, v118, v119
    v_mfma_f32_16x16x32_bf16 v[112:115], a[8:11], a[212:215], v[112:115]
    v_sub_f32 v34, v34, v12
    v_sub_f32 v50, v50, v13
    v_mfma_f32_16x16x32_bf16 v[112:115], a[4:7], a[208:211], v[112:115]
    ds_read_b128 a[192:195], v2 offset:26624
    v_sub_f32 v66, v66, v14
    v_mfma_f32_16x16x32_bf16 v[112:115], a[0:3], a[204:207], v[112:115]
    s_waitcnt lgkmcnt(1)
    v_exp_f32 v48, v48
    v_mfma_f32_16x16x32_bf16 v[96:99], a[0:3], a[228:231], 0
    ds_read_b128 a[196:199], v2 offset:27648
    v_sub_f32 v82, v82, v15
    v_mfma_f32_16x16x32_bf16 v[96:99], a[4:7], a[232:235], v[96:99]
    v_exp_f32 v49, v49
    v_mfma_f32_16x16x32_bf16 v[96:99], a[8:11], a[236:239], v[96:99]
    ds_read_b128 a[200:203], v2 offset:28672
    v_cvt_pk_bf16_f32 v136, v112, v113
    v_mfma_f32_16x16x32_bf16 v[96:99], a[12:15], a[240:243], v[96:99]
    v_cvt_pk_bf16_f32 v137, v114, v115
    v_sub_f32 v35, v35, v12
    v_mfma_f32_16x16x32_bf16 v[96:99], a[16:19], a[244:247], v[96:99]
    ds_read_b128 a[204:207], v2 offset:29696
    v_sub_f32 v51, v51, v13
    v_mfma_f32_16x16x32_bf16 v[96:99], a[20:23], a[248:251], v[96:99]
    v_exp_f32 v64, v64
    v_mfma_f32_16x16x32_bf16 v[100:103], a[44:47], a[248:251], 0
    ds_read_b128 a[208:211], v2 offset:30720
    v_sub_f32 v67, v67, v14
    v_mfma_f32_16x16x32_bf16 v[100:103], a[40:43], a[244:247], v[100:103]
    v_exp_f32 v65, v65
    v_mfma_f32_16x16x32_bf16 v[100:103], a[36:39], a[240:243], v[100:103]
    ds_read_b128 a[212:215], v2 offset:31744
    v_cvt_pk_bf16_f32 v144, v96, v97
    v_mfma_f32_16x16x32_bf16 v[100:103], a[32:35], a[236:239], v[100:103]
    v_cvt_pk_bf16_f32 v145, v98, v99
    v_sub_f32 v83, v83, v15
    v_mfma_f32_16x16x32_bf16 v[100:103], a[28:31], a[232:235], v[100:103]
    v_exp_f32 v80, v80
    v_mfma_f32_16x16x32_bf16 v[100:103], a[24:27], a[228:231], v[100:103]
    v_exp_f32 v81, v81
    v_mfma_f32_16x16x32_bf16 v[104:107], a[48:51], a[228:231], 0
    v_exp_f32 v34, v34
    v_mfma_f32_16x16x32_bf16 v[104:107], a[52:55], a[232:235], v[104:107]
    v_exp_f32 v50, v50
    v_mfma_f32_16x16x32_bf16 v[104:107], a[56:59], a[236:239], v[104:107]
    v_cvt_pk_bf16_f32 v146, v100, v101
    v_cvt_pk_bf16_f32 v147, v102, v103
    v_mfma_f32_16x16x32_bf16 v[104:107], a[60:63], a[240:243], v[104:107]
    v_exp_f32 v66, v66
    v_mfma_f32_16x16x32_bf16 v[104:107], a[64:67], a[244:247], v[104:107]
    v_exp_f32 v82, v82
    v_mfma_f32_16x16x32_bf16 v[104:107], a[68:71], a[248:251], v[104:107]
    v_exp_f32 v35, v35
    v_mfma_f32_16x16x32_bf16 v[108:111], a[92:95], a[248:251], 0
    v_sub_f32 v36, v36, v12
    v_sub_f32 v52, v52, v13
    v_mfma_f32_16x16x32_bf16 v[108:111], a[88:91], a[244:247], v[108:111]
    v_exp_f32 v51, v51
    v_mfma_f32_16x16x32_bf16 v[108:111], a[84:87], a[240:243], v[108:111]
    v_cvt_pk_bf16_f32 v148, v104, v105
    v_cvt_pk_bf16_f32 v149, v106, v107
    v_mfma_f32_16x16x32_bf16 v[108:111], a[80:83], a[236:239], v[108:111]
    v_exp_f32 v67, v67
    v_mfma_f32_16x16x32_bf16 v[108:111], a[76:79], a[232:235], v[108:111]
    ds_read_b128 a[216:219], v2 offset:32768
    v_sub_f32 v68, v68, v14
    v_mfma_f32_16x16x32_bf16 v[108:111], a[72:75], a[228:231], v[108:111]
    s_waitcnt lgkmcnt(1)
    v_exp_f32 v83, v83
    v_mfma_f32_16x16x32_bf16 v[124:127], a[72:75], a[192:195], 0
    ds_read_b128 a[220:223], v2 offset:33792
    v_sub_f32 v84, v84, v15
    v_mfma_f32_16x16x32_bf16 v[124:127], a[76:79], a[196:199], v[124:127]
    v_add_f32 v20, v32, v33
    v_sub_f32 v37, v37, v12
    v_mfma_f32_16x16x32_bf16 v[124:127], a[80:83], a[200:203], v[124:127]
    ds_read_b128 a[224:227], v2 offset:34816
    v_cvt_pk_bf16_f32 v150, v108, v109
    v_mfma_f32_16x16x32_bf16 v[124:127], a[84:87], a[204:207], v[124:127]
    v_cvt_pk_bf16_f32 v151, v110, v111
    v_add_f32 v21, v48, v49
    v_mfma_f32_16x16x32_bf16 v[124:127], a[88:91], a[208:211], v[124:127]
    ds_read_b128 a[228:231], v2 offset:35840
    v_sub_f32 v53, v53, v13
    v_mfma_f32_16x16x32_bf16 v[124:127], a[92:95], a[212:215], v[124:127]
    v_exp_f32 v36, v36
    v_mfma_f32_16x16x32_bf16 v[120:123], a[68:71], a[212:215], 0
    ds_read_b128 a[232:235], v2 offset:36864
    v_add_f32 v22, v64, v65
    v_mfma_f32_16x16x32_bf16 v[120:123], a[64:67], a[208:211], v[120:123]
    v_exp_f32 v52, v52
    v_mfma_f32_16x16x32_bf16 v[120:123], a[60:63], a[204:207], v[120:123]
    ds_read_b128 a[236:239], v2 offset:37888
    v_cvt_pk_bf16_f32 v158, v124, v125
    v_mfma_f32_16x16x32_bf16 v[120:123], a[56:59], a[200:203], v[120:123]
    v_cvt_pk_bf16_f32 v159, v126, v127
    v_sub_f32 v69, v69, v14
    v_mfma_f32_16x16x32_bf16 v[120:123], a[52:55], a[196:199], v[120:123]
    v_exp_f32 v68, v68
    v_mfma_f32_16x16x32_bf16 v[120:123], a[48:51], a[192:195], v[120:123]
    v_add_f32 v23, v80, v81
    v_sub_f32 v85, v85, v15
    v_mfma_f32_16x16x32_bf16 v[116:119], a[24:27], a[192:195], 0
    v_exp_f32 v84, v84
    v_mfma_f32_16x16x32_bf16 v[116:119], a[28:31], a[196:199], v[116:119]
    v_add_f32 v20, v20, v34
    v_sub_f32 v38, v38, v12
    v_mfma_f32_16x16x32_bf16 v[116:119], a[32:35], a[200:203], v[116:119]
    v_cvt_pk_bf16_f32 v156, v120, v121
    v_cvt_pk_bf16_f32 v157, v122, v123
    v_mfma_f32_16x16x32_bf16 v[116:119], a[36:39], a[204:207], v[116:119]
    v_exp_f32 v37, v37
    v_mfma_f32_16x16x32_bf16 v[116:119], a[40:43], a[208:211], v[116:119]
    v_add_f32 v21, v21, v50
    v_sub_f32 v54, v54, v13
    v_mfma_f32_16x16x32_bf16 v[116:119], a[44:47], a[212:215], v[116:119]
    v_exp_f32 v53, v53
    v_mfma_f32_16x16x32_bf16 v[112:115], a[20:23], a[212:215], 0
    v_add_f32 v22, v22, v66
    v_sub_f32 v70, v70, v14
    v_mfma_f32_16x16x32_bf16 v[112:115], a[16:19], a[208:211], v[112:115]
    v_exp_f32 v69, v69
    v_mfma_f32_16x16x32_bf16 v[112:115], a[12:15], a[204:207], v[112:115]
    v_cvt_pk_bf16_f32 v154, v116, v117
    v_cvt_pk_bf16_f32 v155, v118, v119
    v_mfma_f32_16x16x32_bf16 v[112:115], a[8:11], a[200:203], v[112:115]
    v_add_f32 v23, v23, v82
    v_sub_f32 v86, v86, v15
    v_mfma_f32_16x16x32_bf16 v[112:115], a[4:7], a[196:199], v[112:115]
    buffer_load_dwordx4 a[176:179], v9, s[8:11], s30 offen offset:128 nt
    v_add_f32 v20, v20, v35
    v_mfma_f32_16x16x32_bf16 v[112:115], a[0:3], a[192:195], v[112:115]
    s_waitcnt lgkmcnt(0)
    buffer_load_dwordx4 a[180:183], v10, s[8:11], s30 offen offset:128 nt
    v_sub_f32 v39, v39, v12
    v_mfma_f32_16x16x32_bf16 v[96:99], a[0:3], a[216:219], 0
    ds_read_b128 a[240:243], v2 offset:38912
    v_add_f32 v21, v21, v51
    v_mfma_f32_16x16x32_bf16 v[96:99], a[4:7], a[220:223], v[96:99]
    ds_read_b128 a[244:247], v2 offset:39936
    v_sub_f32 v55, v55, v13
    v_mfma_f32_16x16x32_bf16 v[96:99], a[8:11], a[224:227], v[96:99]
    ds_read_b128 a[248:251], v2 offset:40960
    v_cvt_pk_bf16_f32 v152, v112, v113
    v_mfma_f32_16x16x32_bf16 v[96:99], a[12:15], a[228:231], v[96:99]
    v_cvt_pk_bf16_f32 v153, v114, v115
    v_add_f32 v22, v22, v67
    v_mfma_f32_16x16x32_bf16 v[96:99], a[16:19], a[232:235], v[96:99]
    ds_read_b128 a[192:195], v2 offset:41984
    v_sub_f32 v71, v71, v14
    v_mfma_f32_16x16x32_bf16 v[96:99], a[20:23], a[236:239], v[96:99]
    v_exp_f32 v85, v85
    v_mfma_f32_16x16x32_bf16 v[100:103], a[44:47], a[236:239], 0
    ds_read_b128 a[196:199], v2 offset:43008
    v_add_f32 v23, v23, v83
    v_mfma_f32_16x16x32_bf16 v[100:103], a[40:43], a[232:235], v[100:103]
    v_exp_f32 v38, v38
    v_mfma_f32_16x16x32_bf16 v[100:103], a[36:39], a[228:231], v[100:103]
    ds_read_b128 a[200:203], v2 offset:44032
    v_cvt_pk_bf16_f32 v160, v96, v97
    v_mfma_f32_16x16x32_bf16 v[100:103], a[32:35], a[224:227], v[100:103]
    v_cvt_pk_bf16_f32 v161, v98, v99
    v_sub_f32 v87, v87, v15
    v_mfma_f32_16x16x32_bf16 v[100:103], a[28:31], a[220:223], v[100:103]
    v_exp_f32 v54, v54
    v_mfma_f32_16x16x32_bf16 v[100:103], a[24:27], a[216:219], v[100:103]
    v_exp_f32 v70, v70
    v_mfma_f32_16x16x32_bf16 v[104:107], a[48:51], a[216:219], 0
    v_exp_f32 v86, v86
    v_mfma_f32_16x16x32_bf16 v[104:107], a[52:55], a[220:223], v[104:107]
    v_add_f32 v20, v20, v36
    v_sub_f32 v40, v40, v12
    v_mfma_f32_16x16x32_bf16 v[104:107], a[56:59], a[224:227], v[104:107]
    v_cvt_pk_bf16_f32 v162, v100, v101
    v_cvt_pk_bf16_f32 v163, v102, v103
    v_mfma_f32_16x16x32_bf16 v[104:107], a[60:63], a[228:231], v[104:107]
    v_exp_f32 v39, v39
    v_mfma_f32_16x16x32_bf16 v[104:107], a[64:67], a[232:235], v[104:107]
    v_add_f32 v21, v21, v52
    v_sub_f32 v56, v56, v13
    v_mfma_f32_16x16x32_bf16 v[104:107], a[68:71], a[236:239], v[104:107]
    v_exp_f32 v55, v55
    v_mfma_f32_16x16x32_bf16 v[108:111], a[92:95], a[236:239], 0
    v_add_f32 v22, v22, v68
    v_sub_f32 v72, v72, v14
    v_mfma_f32_16x16x32_bf16 v[108:111], a[88:91], a[232:235], v[108:111]
    v_exp_f32 v71, v71
    v_mfma_f32_16x16x32_bf16 v[108:111], a[84:87], a[228:231], v[108:111]
    v_cvt_pk_bf16_f32 v164, v104, v105
    v_cvt_pk_bf16_f32 v165, v106, v107
    v_mfma_f32_16x16x32_bf16 v[108:111], a[80:83], a[224:227], v[108:111]
    v_add_f32 v23, v23, v84
    v_sub_f32 v88, v88, v15
    v_mfma_f32_16x16x32_bf16 v[108:111], a[76:79], a[220:223], v[108:111]
    ds_read_b128 a[204:207], v2 offset:45056
    v_add_f32 v20, v20, v37
    v_mfma_f32_16x16x32_bf16 v[108:111], a[72:75], a[216:219], v[108:111]
    s_waitcnt lgkmcnt(1)
    v_exp_f32 v87, v87
    v_mfma_f32_16x16x32_bf16 v[124:127], a[72:75], a[240:243], 0
    ds_read_b128 a[208:211], v2 offset:46080
    v_sub_f32 v41, v41, v12
    v_mfma_f32_16x16x32_bf16 v[124:127], a[76:79], a[244:247], v[124:127]
    v_exp_f32 v40, v40
    v_mfma_f32_16x16x32_bf16 v[124:127], a[80:83], a[248:251], v[124:127]
    ds_read_b128 a[212:215], v2 offset:47104
    v_cvt_pk_bf16_f32 v166, v108, v109
    v_mfma_f32_16x16x32_bf16 v[124:127], a[84:87], a[192:195], v[124:127]
    v_cvt_pk_bf16_f32 v167, v110, v111
    v_add_f32 v21, v21, v53
    v_mfma_f32_16x16x32_bf16 v[124:127], a[88:91], a[196:199], v[124:127]
    ds_read_b128 a[216:219], v2 offset:48128
    v_sub_f32 v57, v57, v13
    v_mfma_f32_16x16x32_bf16 v[124:127], a[92:95], a[200:203], v[124:127]
    v_exp_f32 v56, v56
    v_mfma_f32_16x16x32_bf16 v[120:123], a[68:71], a[200:203], 0
    ds_read_b128 a[220:223], v2 offset:49152
    v_add_f32 v22, v22, v69
    v_mfma_f32_16x16x32_bf16 v[120:123], a[64:67], a[196:199], v[120:123]
    v_exp_f32 v72, v72
    v_mfma_f32_16x16x32_bf16 v[120:123], a[60:63], a[192:195], v[120:123]
    ds_read_b128 a[224:227], v2 offset:50176
    v_cvt_pk_bf16_f32 v174, v124, v125
    v_mfma_f32_16x16x32_bf16 v[120:123], a[56:59], a[248:251], v[120:123]
    v_cvt_pk_bf16_f32 v175, v126, v127
    v_sub_f32 v73, v73, v14
    v_mfma_f32_16x16x32_bf16 v[120:123], a[52:55], a[244:247], v[120:123]
    v_add_f32 v23, v23, v85
    v_sub_f32 v89, v89, v15
    v_mfma_f32_16x16x32_bf16 v[120:123], a[48:51], a[240:243], v[120:123]
    v_exp_f32 v88, v88
    v_mfma_f32_16x16x32_bf16 v[116:119], a[24:27], a[240:243], 0
    v_add_f32 v20, v20, v38
    v_sub_f32 v42, v42, v12
    v_mfma_f32_16x16x32_bf16 v[116:119], a[28:31], a[244:247], v[116:119]
    v_exp_f32 v41, v41
    v_mfma_f32_16x16x32_bf16 v[116:119], a[32:35], a[248:251], v[116:119]
    v_cvt_pk_bf16_f32 v172, v120, v121
    v_cvt_pk_bf16_f32 v173, v122, v123
    v_mfma_f32_16x16x32_bf16 v[116:119], a[36:39], a[192:195], v[116:119]
    v_add_f32 v21, v21, v54
    v_sub_f32 v58, v58, v13
    v_mfma_f32_16x16x32_bf16 v[116:119], a[40:43], a[196:199], v[116:119]
    v_exp_f32 v57, v57
    v_mfma_f32_16x16x32_bf16 v[116:119], a[44:47], a[200:203], v[116:119]
    v_add_f32 v22, v22, v70
    v_sub_f32 v74, v74, v14
    v_mfma_f32_16x16x32_bf16 v[112:115], a[20:23], a[200:203], 0
    v_exp_f32 v73, v73
    v_mfma_f32_16x16x32_bf16 v[112:115], a[16:19], a[196:199], v[112:115]
    v_add_f32 v23, v23, v86
    v_sub_f32 v90, v90, v15
    v_mfma_f32_16x16x32_bf16 v[112:115], a[12:15], a[192:195], v[112:115]
    v_cvt_pk_bf16_f32 v170, v116, v117
    v_cvt_pk_bf16_f32 v171, v118, v119
    v_mfma_f32_16x16x32_bf16 v[112:115], a[8:11], a[248:251], v[112:115]
    v_exp_f32 v89, v89
    v_mfma_f32_16x16x32_bf16 v[112:115], a[4:7], a[244:247], v[112:115]
    ds_read_b128 a[228:231], v2 offset:51200
    v_add_f32 v20, v20, v39
    v_mfma_f32_16x16x32_bf16 v[112:115], a[0:3], a[240:243], v[112:115]
    s_waitcnt lgkmcnt(1)
    v_exp_f32 v42, v42
    v_mfma_f32_16x16x32_bf16 v[96:99], a[0:3], a[204:207], 0
    ds_read_b128 a[232:235], v2 offset:52224
    v_sub_f32 v43, v43, v12
    v_mfma_f32_16x16x32_bf16 v[96:99], a[4:7], a[208:211], v[96:99]
    v_add_f32 v21, v21, v55
    v_sub_f32 v59, v59, v13
    v_mfma_f32_16x16x32_bf16 v[96:99], a[8:11], a[212:215], v[96:99]
    ds_read_b128 a[236:239], v2 offset:53248
    v_cvt_pk_bf16_f32 v168, v112, v113
    v_mfma_f32_16x16x32_bf16 v[96:99], a[12:15], a[216:219], v[96:99]
    v_cvt_pk_bf16_f32 v169, v114, v115
    v_add_f32 v22, v22, v71
    v_mfma_f32_16x16x32_bf16 v[96:99], a[16:19], a[220:223], v[96:99]
    ds_read_b128 a[240:243], v2 offset:54272
    v_sub_f32 v75, v75, v14
    v_mfma_f32_16x16x32_bf16 v[96:99], a[20:23], a[224:227], v[96:99]
    v_exp_f32 v58, v58
    v_mfma_f32_16x16x32_bf16 v[100:103], a[44:47], a[224:227], 0
    buffer_load_dwordx4 a[160:163], v9, s[8:11], s28 offen offset:256 nt
    v_add_f32 v23, v23, v87
    v_mfma_f32_16x16x32_bf16 v[100:103], a[40:43], a[220:223], v[100:103]
    buffer_load_dwordx4 a[164:167], v10, s[8:11], s28 offen offset:256 nt
    v_sub_f32 v91, v91, v15
    v_mfma_f32_16x16x32_bf16 v[100:103], a[36:39], a[216:219], v[100:103]
    s_add_u32 s28, s16, 7077888
    ds_read_b128 a[244:247], v2 offset:55296
    v_cvt_pk_bf16_f32 v176, v96, v97
    v_mfma_f32_16x16x32_bf16 v[100:103], a[32:35], a[212:215], v[100:103]
    ds_read_b128 a[248:251], v2 offset:56320
    v_cvt_pk_bf16_f32 v177, v98, v99
    v_mfma_f32_16x16x32_bf16 v[100:103], a[28:31], a[208:211], v[100:103]
    v_exp_f32 v74, v74
    v_mfma_f32_16x16x32_bf16 v[100:103], a[24:27], a[204:207], v[100:103]
    v_exp_f32 v90, v90
    v_mfma_f32_16x16x32_bf16 v[104:107], a[48:51], a[204:207], 0
    v_add_f32 v20, v20, v40
    v_sub_f32 v44, v44, v12
    v_mfma_f32_16x16x32_bf16 v[104:107], a[52:55], a[208:211], v[104:107]
    v_exp_f32 v43, v43
    v_mfma_f32_16x16x32_bf16 v[104:107], a[56:59], a[212:215], v[104:107]
    v_cvt_pk_bf16_f32 v178, v100, v101
    v_cvt_pk_bf16_f32 v179, v102, v103
    v_mfma_f32_16x16x32_bf16 v[104:107], a[60:63], a[216:219], v[104:107]
    v_add_f32 v21, v21, v56
    v_sub_f32 v60, v60, v13
    v_mfma_f32_16x16x32_bf16 v[104:107], a[64:67], a[220:223], v[104:107]
    v_exp_f32 v59, v59
    v_mfma_f32_16x16x32_bf16 v[104:107], a[68:71], a[224:227], v[104:107]
    v_add_f32 v22, v22, v72
    v_sub_f32 v76, v76, v14
    v_mfma_f32_16x16x32_bf16 v[108:111], a[92:95], a[224:227], 0
    v_exp_f32 v75, v75
    v_mfma_f32_16x16x32_bf16 v[108:111], a[88:91], a[220:223], v[108:111]
    v_add_f32 v23, v23, v88
    v_sub_f32 v92, v92, v15
    v_mfma_f32_16x16x32_bf16 v[108:111], a[84:87], a[216:219], v[108:111]
    v_cvt_pk_bf16_f32 v180, v104, v105
    v_cvt_pk_bf16_f32 v181, v106, v107
    v_mfma_f32_16x16x32_bf16 v[108:111], a[80:83], a[212:215], v[108:111]
    v_exp_f32 v91, v91
    v_mfma_f32_16x16x32_bf16 v[108:111], a[76:79], a[208:211], v[108:111]
    ds_read_b128 a[192:195], v2 offset:57344
    v_add_f32 v20, v20, v41
    v_mfma_f32_16x16x32_bf16 v[108:111], a[72:75], a[204:207], v[108:111]
    s_waitcnt lgkmcnt(1)
    v_exp_f32 v44, v44
    v_mfma_f32_16x16x32_bf16 v[124:127], a[72:75], a[228:231], 0
    ds_read_b128 a[196:199], v2 offset:58368
    v_sub_f32 v45, v45, v12
    v_mfma_f32_16x16x32_bf16 v[124:127], a[76:79], a[232:235], v[124:127]
    v_add_f32 v21, v21, v57
    v_sub_f32 v61, v61, v13
    v_mfma_f32_16x16x32_bf16 v[124:127], a[80:83], a[236:239], v[124:127]
    ds_read_b128 a[200:203], v2 offset:59392
    v_cvt_pk_bf16_f32 v182, v108, v109
    v_mfma_f32_16x16x32_bf16 v[124:127], a[84:87], a[240:243], v[124:127]
    v_cvt_pk_bf16_f32 v183, v110, v111
    v_add_f32 v22, v22, v73
    v_mfma_f32_16x16x32_bf16 v[124:127], a[88:91], a[244:247], v[124:127]
    ds_read_b128 a[204:207], v2 offset:60416
    v_sub_f32 v77, v77, v14
    v_mfma_f32_16x16x32_bf16 v[124:127], a[92:95], a[248:251], v[124:127]
    v_exp_f32 v60, v60
    v_mfma_f32_16x16x32_bf16 v[120:123], a[68:71], a[248:251], 0
    ds_read_b128 a[208:211], v2 offset:61440
    v_add_f32 v23, v23, v89
    v_mfma_f32_16x16x32_bf16 v[120:123], a[64:67], a[244:247], v[120:123]
    v_exp_f32 v76, v76
    v_mfma_f32_16x16x32_bf16 v[120:123], a[60:63], a[240:243], v[120:123]
    ds_read_b128 a[212:215], v2 offset:62464
    v_cvt_pk_bf16_f32 v190, v124, v125
    v_mfma_f32_16x16x32_bf16 v[120:123], a[56:59], a[236:239], v[120:123]
    v_cvt_pk_bf16_f32 v191, v126, v127
    v_sub_f32 v93, v93, v15
    v_mfma_f32_16x16x32_bf16 v[120:123], a[52:55], a[232:235], v[120:123]
    v_exp_f32 v92, v92
    v_mfma_f32_16x16x32_bf16 v[120:123], a[48:51], a[228:231], v[120:123]
    v_add_f32 v20, v20, v42
    v_sub_f32 v46, v46, v12
    v_mfma_f32_16x16x32_bf16 v[116:119], a[24:27], a[228:231], 0
    v_exp_f32 v45, v45
    v_mfma_f32_16x16x32_bf16 v[116:119], a[28:31], a[232:235], v[116:119]
    v_add_f32 v21, v21, v58
    v_sub_f32 v62, v62, v13
    v_mfma_f32_16x16x32_bf16 v[116:119], a[32:35], a[236:239], v[116:119]
    v_cvt_pk_bf16_f32 v188, v120, v121
    v_cvt_pk_bf16_f32 v189, v122, v123
    v_mfma_f32_16x16x32_bf16 v[116:119], a[36:39], a[240:243], v[116:119]
    v_exp_f32 v61, v61
    v_mfma_f32_16x16x32_bf16 v[116:119], a[40:43], a[244:247], v[116:119]
    v_add_f32 v22, v22, v74
    v_sub_f32 v78, v78, v14
    v_mfma_f32_16x16x32_bf16 v[116:119], a[44:47], a[248:251], v[116:119]
    v_exp_f32 v77, v77
    v_mfma_f32_16x16x32_bf16 v[112:115], a[20:23], a[248:251], 0
    v_add_f32 v23, v23, v90
    v_sub_f32 v94, v94, v15
    v_mfma_f32_16x16x32_bf16 v[112:115], a[16:19], a[244:247], v[112:115]
    v_exp_f32 v93, v93
    v_mfma_f32_16x16x32_bf16 v[112:115], a[12:15], a[240:243], v[112:115]
    v_cvt_pk_bf16_f32 v186, v116, v117
    v_cvt_pk_bf16_f32 v187, v118, v119
    v_mfma_f32_16x16x32_bf16 v[112:115], a[8:11], a[236:239], v[112:115]
    v_add_f32 v20, v20, v43
    v_sub_f32 v47, v47, v12
    v_mfma_f32_16x16x32_bf16 v[112:115], a[4:7], a[232:235], v[112:115]
    ds_read_b128 a[216:219], v2 offset:63488
    v_add_f32 v21, v21, v59
    v_mfma_f32_16x16x32_bf16 v[112:115], a[0:3], a[228:231], v[112:115]
    s_waitcnt lgkmcnt(1)
    v_exp_f32 v46, v46
    v_mfma_f32_16x16x32_bf16 v[96:99], a[0:3], a[192:195], 0
    ds_read_b128 a[220:223], v2 offset:64512
    v_sub_f32 v63, v63, v13
    v_mfma_f32_16x16x32_bf16 v[96:99], a[4:7], a[196:199], v[96:99]
    v_exp_f32 v62, v62
    v_mfma_f32_16x16x32_bf16 v[96:99], a[8:11], a[200:203], v[96:99]
    ds_read_b128 a[224:227], v3 offset:0
    v_cvt_pk_bf16_f32 v184, v112, v113
    v_mfma_f32_16x16x32_bf16 v[96:99], a[12:15], a[204:207], v[96:99]
    v_cvt_pk_bf16_f32 v185, v114, v115
    v_add_f32 v22, v22, v75
    v_mfma_f32_16x16x32_bf16 v[96:99], a[16:19], a[208:211], v[96:99]
    ds_read_b128 a[228:231], v3 offset:1024
    v_sub_f32 v79, v79, v14
    v_mfma_f32_16x16x32_bf16 v[96:99], a[20:23], a[212:215], v[96:99]
    v_exp_f32 v78, v78
    v_mfma_f32_16x16x32_bf16 v[100:103], a[44:47], a[212:215], 0
    ds_read_b128 a[232:235], v3 offset:2048
    v_add_f32 v23, v23, v91
    v_mfma_f32_16x16x32_bf16 v[100:103], a[40:43], a[208:211], v[100:103]
    v_exp_f32 v94, v94
    v_mfma_f32_16x16x32_bf16 v[100:103], a[36:39], a[204:207], v[100:103]
    ds_read_b128 a[236:239], v3 offset:3072
    v_cvt_pk_bf16_f32 v192, v96, v97
    v_mfma_f32_16x16x32_bf16 v[100:103], a[32:35], a[200:203], v[100:103]
    v_cvt_pk_bf16_f32 v193, v98, v99
    v_sub_f32 v95, v95, v15
    v_mfma_f32_16x16x32_bf16 v[100:103], a[28:31], a[196:199], v[100:103]
    v_add_f32 v20, v20, v44
    v_add_f32 v21, v21, v60
    v_mfma_f32_16x16x32_bf16 v[100:103], a[24:27], a[192:195], v[100:103]
    v_exp_f32 v47, v47
    v_mfma_f32_16x16x32_bf16 v[104:107], a[48:51], a[192:195], 0
    v_exp_f32 v63, v63
    v_mfma_f32_16x16x32_bf16 v[104:107], a[52:55], a[196:199], v[104:107]
    v_add_f32 v22, v22, v76
    v_add_f32 v23, v23, v92
    v_mfma_f32_16x16x32_bf16 v[104:107], a[56:59], a[200:203], v[104:107]
    buffer_load_dwordx4 a[184:187], v9, s[8:11], s30 offen offset:256 nt
    v_cvt_pk_bf16_f32 v194, v100, v101
    v_mfma_f32_16x16x32_bf16 v[104:107], a[60:63], a[204:207], v[104:107]
    buffer_load_dwordx4 a[188:191], v10, s[8:11], s30 offen offset:256 nt
    v_cvt_pk_bf16_f32 v195, v102, v103
    v_mfma_f32_16x16x32_bf16 v[104:107], a[64:67], a[208:211], v[104:107]
    s_add_u32 s30, s16, 7471104
    v_exp_f32 v79, v79
    v_mfma_f32_16x16x32_bf16 v[104:107], a[68:71], a[212:215], v[104:107]
    v_exp_f32 v95, v95
    v_mfma_f32_16x16x32_bf16 v[108:111], a[92:95], a[212:215], 0
    v_add_f32 v20, v20, v45
    v_add_f32 v21, v21, v61
    v_mfma_f32_16x16x32_bf16 v[108:111], a[88:91], a[208:211], v[108:111]
    v_add_f32 v22, v22, v77
    v_add_f32 v23, v23, v93
    v_mfma_f32_16x16x32_bf16 v[108:111], a[84:87], a[204:207], v[108:111]
    v_cvt_pk_bf16_f32 v196, v104, v105
    v_cvt_pk_bf16_f32 v197, v106, v107
    v_mfma_f32_16x16x32_bf16 v[108:111], a[80:83], a[200:203], v[108:111]
    v_add_f32 v20, v20, v46
    v_add_f32 v21, v21, v62
    v_mfma_f32_16x16x32_bf16 v[108:111], a[76:79], a[196:199], v[108:111]
    ds_read_b128 a[240:243], v3 offset:4096
    v_add_f32 v22, v22, v78
    v_mfma_f32_16x16x32_bf16 v[108:111], a[72:75], a[192:195], v[108:111]
    s_waitcnt lgkmcnt(1)
    v_add_f32 v23, v23, v94
    v_add_f32 v20, v20, v47
    v_mfma_f32_16x16x32_bf16 v[124:127], a[72:75], a[216:219], 0
    ds_read_b128 a[244:247], v3 offset:5120
    v_add_f32 v21, v21, v63
    v_mfma_f32_16x16x32_bf16 v[124:127], a[76:79], a[220:223], v[124:127]
    v_add_f32 v22, v22, v79
    v_add_f32 v23, v23, v95
    v_mfma_f32_16x16x32_bf16 v[124:127], a[80:83], a[224:227], v[124:127]
    ds_read_b128 a[248:251], v3 offset:6144
    v_cvt_pk_bf16_f32 v198, v108, v109
    v_mfma_f32_16x16x32_bf16 v[124:127], a[84:87], a[228:231], v[124:127]
    v_cvt_pk_bf16_f32 v199, v110, v111
    v_mfma_f32_16x16x32_bf16 v[124:127], a[88:91], a[232:235], v[124:127]
    ds_read_b128 a[192:195], v3 offset:7168
    v_mfma_f32_16x16x32_bf16 v[124:127], a[92:95], a[236:239], v[124:127]
    v_permlane16_swap_b32 v20, v21
    v_mfma_f32_16x16x32_bf16 v[120:123], a[68:71], a[236:239], 0
    ds_read_b128 a[196:199], v3 offset:8192
    v_add_f32 v20, v20, v21
    v_mfma_f32_16x16x32_bf16 v[120:123], a[64:67], a[232:235], v[120:123]
    v_permlane16_swap_b32 v22, v23
    v_mfma_f32_16x16x32_bf16 v[120:123], a[60:63], a[228:231], v[120:123]
    ds_read_b128 a[200:203], v3 offset:9216
    v_cvt_pk_bf16_f32 v206, v124, v125
    v_mfma_f32_16x16x32_bf16 v[120:123], a[56:59], a[224:227], v[120:123]
    v_cvt_pk_bf16_f32 v207, v126, v127
    v_add_f32 v22, v22, v23
    v_mfma_f32_16x16x32_bf16 v[120:123], a[52:55], a[220:223], v[120:123]
    v_mfma_f32_16x16x32_bf16 v[120:123], a[48:51], a[216:219], v[120:123]
    v_permlane32_swap_b32 v20, v22
    v_mfma_f32_16x16x32_bf16 v[116:119], a[24:27], a[216:219], 0
    v_add_f32 v20, v20, v22
    v_mfma_f32_16x16x32_bf16 v[116:119], a[28:31], a[220:223], v[116:119]
    v_rcp_f32 v20, v20
    v_mfma_f32_16x16x32_bf16 v[116:119], a[32:35], a[224:227], v[116:119]
    v_cvt_pk_bf16_f32 v204, v120, v121
    v_cvt_pk_bf16_f32 v205, v122, v123
    v_mfma_f32_16x16x32_bf16 v[116:119], a[36:39], a[228:231], v[116:119]
    v_mov_b32 v22, v20
    v_mfma_f32_16x16x32_bf16 v[116:119], a[40:43], a[232:235], v[116:119]
    v_mfma_f32_16x16x32_bf16 v[116:119], a[44:47], a[236:239], v[116:119]
    v_permlane32_swap_b32 v20, v22
    v_mfma_f32_16x16x32_bf16 v[112:115], a[20:23], a[236:239], 0
    v_mov_b32 v21, v20
    v_mov_b32 v23, v22
    v_mfma_f32_16x16x32_bf16 v[112:115], a[16:19], a[232:235], v[112:115]
    v_permlane16_swap_b32 v20, v21
    v_mfma_f32_16x16x32_bf16 v[112:115], a[12:15], a[228:231], v[112:115]
    v_cvt_pk_bf16_f32 v202, v116, v117
    v_cvt_pk_bf16_f32 v203, v118, v119
    v_mfma_f32_16x16x32_bf16 v[112:115], a[8:11], a[224:227], v[112:115]
    v_mul_f32 v32, v32, v20
    v_mul_f32 v33, v33, v20
    v_mfma_f32_16x16x32_bf16 v[112:115], a[4:7], a[220:223], v[112:115]
    ds_read_b128 a[204:207], v3 offset:10240
    v_cvt_pk_bf16_f32 v32, v32, v33
    v_mfma_f32_16x16x32_bf16 v[112:115], a[0:3], a[216:219], v[112:115]
    s_waitcnt lgkmcnt(1)
    v_mul_f32 v34, v34, v20
    v_mul_f32 v35, v35, v20
    v_mfma_f32_16x16x32_bf16 v[96:99], a[0:3], a[240:243], 0
    ds_read_b128 a[208:211], v3 offset:11264
    v_cvt_pk_bf16_f32 v33, v34, v35
    v_mfma_f32_16x16x32_bf16 v[96:99], a[4:7], a[244:247], v[96:99]
    v_mul_f32 v36, v36, v20
    v_mul_f32 v37, v37, v20
    v_mfma_f32_16x16x32_bf16 v[96:99], a[8:11], a[248:251], v[96:99]
    ds_read_b128 a[212:215], v3 offset:12288
    v_cvt_pk_bf16_f32 v200, v112, v113
    v_mfma_f32_16x16x32_bf16 v[96:99], a[12:15], a[192:195], v[96:99]
    v_cvt_pk_bf16_f32 v201, v114, v115
    v_cvt_pk_bf16_f32 v34, v36, v37
    v_mfma_f32_16x16x32_bf16 v[96:99], a[16:19], a[196:199], v[96:99]
    ds_read_b128 a[216:219], v3 offset:13312
    v_mul_f32 v38, v38, v20
    v_mfma_f32_16x16x32_bf16 v[96:99], a[20:23], a[200:203], v[96:99]
    v_permlane16_swap_b32 v22, v23
    v_mfma_f32_16x16x32_bf16 v[100:103], a[44:47], a[200:203], 0
    ds_read_b128 a[220:223], v3 offset:14336
    v_mul_f32 v39, v39, v20
    v_mfma_f32_16x16x32_bf16 v[100:103], a[40:43], a[196:199], v[100:103]
    v_mul_f32 v40, v40, v20
    v_mul_f32 v41, v41, v20
    v_mfma_f32_16x16x32_bf16 v[100:103], a[36:39], a[192:195], v[100:103]
    ds_read_b128 a[224:227], v3 offset:15360
    v_cvt_pk_bf16_f32 v35, v38, v39
    v_mfma_f32_16x16x32_bf16 v[100:103], a[32:35], a[248:251], v[100:103]
    v_cvt_pk_bf16_f32 v36, v40, v41
    v_mul_f32 v48, v48, v21
    v_mfma_f32_16x16x32_bf16 v[100:103], a[28:31], a[244:247], v[100:103]
    v_mul_f32 v49, v49, v21
    v_cvt_pk_bf16_f32 v40, v48, v49
    v_mfma_f32_16x16x32_bf16 v[100:103], a[24:27], a[240:243], v[100:103]
    v_mul_f32 v64, v64, v22
    v_mul_f32 v65, v65, v22
    v_mfma_f32_16x16x32_bf16 v[104:107], a[48:51], a[240:243], 0
    v_mul_f32 v66, v66, v22
    v_mul_f32 v67, v67, v22
    v_mfma_f32_16x16x32_bf16 v[104:107], a[52:55], a[244:247], v[104:107]
    v_cvt_pk_bf16_f32 v48, v64, v65
    v_cvt_pk_bf16_f32 v49, v66, v67
    v_mfma_f32_16x16x32_bf16 v[104:107], a[56:59], a[248:251], v[104:107]
    v_mul_f32 v42, v42, v20
    v_mul_f32 v43, v43, v20
    v_mfma_f32_16x16x32_bf16 v[104:107], a[60:63], a[192:195], v[104:107]
    v_mul_f32 v44, v44, v20
    v_mul_f32 v45, v45, v20
    v_mfma_f32_16x16x32_bf16 v[104:107], a[64:67], a[196:199], v[104:107]
    v_mul_f32 v46, v46, v20
    v_mul_f32 v47, v47, v20
    v_mfma_f32_16x16x32_bf16 v[104:107], a[68:71], a[200:203], v[104:107]
    v_cvt_pk_bf16_f32 v37, v42, v43
    v_cvt_pk_bf16_f32 v38, v44, v45
    v_mfma_f32_16x16x32_bf16 v[108:111], a[92:95], a[200:203], 0
    v_cvt_pk_bf16_f32 v39, v46, v47
    v_mul_f32 v50, v50, v21
    v_mfma_f32_16x16x32_bf16 v[108:111], a[88:91], a[196:199], v[108:111]
    v_mul_f32 v51, v51, v21
    v_cvt_pk_bf16_f32 v41, v50, v51
    v_mfma_f32_16x16x32_bf16 v[108:111], a[84:87], a[192:195], v[108:111]
    v_mul_f32 v68, v68, v22
    v_mul_f32 v69, v69, v22
    v_mfma_f32_16x16x32_bf16 v[108:111], a[80:83], a[248:251], v[108:111]
    v_mul_f32 v70, v70, v22
    v_mul_f32 v71, v71, v22
    v_mfma_f32_16x16x32_bf16 v[108:111], a[76:79], a[244:247], v[108:111]
    v_cvt_pk_bf16_f32 v50, v68, v69
    v_cvt_pk_bf16_f32 v51, v70, v71
    v_mfma_f32_16x16x32_bf16 v[108:111], a[72:75], a[240:243], v[108:111]
    s_waitcnt lgkmcnt(0)
    v_mul_f32 v52, v52, v21
    v_mul_f32 v53, v53, v21
    v_mfma_f32_16x16x32_bf16 v[124:127], a[72:75], a[204:207], 0
    v_cvt_pk_bf16_f32 v42, v52, v53
    v_mul_f32 v72, v72, v22
    v_mfma_f32_16x16x32_bf16 v[124:127], a[76:79], a[208:211], v[124:127]
    v_mul_f32 v73, v73, v22
    v_mul_f32 v74, v74, v22
    v_mfma_f32_16x16x32_bf16 v[124:127], a[80:83], a[212:215], v[124:127]
    v_mul_f32 v75, v75, v22
    v_cvt_pk_bf16_f32 v52, v72, v73
    v_mfma_f32_16x16x32_bf16 v[124:127], a[84:87], a[216:219], v[124:127]
    v_cvt_pk_bf16_f32 v53, v74, v75
    v_mul_f32 v54, v54, v21
    v_mfma_f32_16x16x32_bf16 v[124:127], a[88:91], a[220:223], v[124:127]
    v_mul_f32 v55, v55, v21
    v_cvt_pk_bf16_f32 v43, v54, v55
    v_mfma_f32_16x16x32_bf16 v[124:127], a[92:95], a[224:227], v[124:127]
    v_mul_f32 v76, v76, v22
    v_mul_f32 v77, v77, v22
    v_mfma_f32_16x16x32_bf16 v[120:123], a[68:71], a[224:227], 0
    v_mul_f32 v78, v78, v22
    v_mul_f32 v79, v79, v22
    v_mfma_f32_16x16x32_bf16 v[120:123], a[64:67], a[220:223], v[120:123]
    v_cvt_pk_bf16_f32 v54, v76, v77
    v_cvt_pk_bf16_f32 v55, v78, v79
    v_mfma_f32_16x16x32_bf16 v[120:123], a[60:63], a[216:219], v[120:123]
    v_mul_f32 v62, v62, v21
    v_mul_f32 v63, v63, v21
    v_mfma_f32_16x16x32_bf16 v[120:123], a[56:59], a[212:215], v[120:123]
    v_cvt_pk_bf16_f32 v47, v62, v63
    v_mul_f32 v92, v92, v23
    v_mfma_f32_16x16x32_bf16 v[120:123], a[52:55], a[208:211], v[120:123]
    v_mul_f32 v93, v93, v23
    v_mul_f32 v94, v94, v23
    v_mfma_f32_16x16x32_bf16 v[120:123], a[48:51], a[204:207], v[120:123]
    v_mul_f32 v95, v95, v23
    v_cvt_pk_bf16_f32 v62, v92, v93
    v_mfma_f32_16x16x32_bf16 v[116:119], a[24:27], a[204:207], 0
    s_mov_b32 s10, s19
    v_cvt_pk_bf16_f32 v63, v94, v95
    v_mul_f32 v56, v56, v21
    v_mfma_f32_16x16x32_bf16 v[116:119], a[28:31], a[208:211], v[116:119]
    v_mul_f32 v57, v57, v21
    v_mul_f32 v58, v58, v21
    v_mfma_f32_16x16x32_bf16 v[116:119], a[32:35], a[212:215], v[116:119]
    v_mul_f32 v59, v59, v21
    v_mul_f32 v60, v60, v21
    v_mfma_f32_16x16x32_bf16 v[116:119], a[36:39], a[216:219], v[116:119]
    v_mul_f32 v61, v61, v21
    v_cvt_pk_bf16_f32 v44, v56, v57
    v_mfma_f32_16x16x32_bf16 v[116:119], a[40:43], a[220:223], v[116:119]
    v_cvt_pk_bf16_f32 v45, v58, v59
    v_cvt_pk_bf16_f32 v46, v60, v61
    v_mfma_f32_16x16x32_bf16 v[116:119], a[44:47], a[224:227], v[116:119]
    v_mul_f32 v88, v88, v23
    v_mul_f32 v89, v89, v23
    v_mfma_f32_16x16x32_bf16 v[112:115], a[20:23], a[224:227], 0
    v_mul_f32 v90, v90, v23
    v_mul_f32 v91, v91, v23
    v_mfma_f32_16x16x32_bf16 v[112:115], a[16:19], a[220:223], v[112:115]
    v_cvt_pk_bf16_f32 v60, v88, v89
    v_cvt_pk_bf16_f32 v61, v90, v91
    v_mfma_f32_16x16x32_bf16 v[112:115], a[12:15], a[216:219], v[112:115]
    v_mul_f32 v84, v84, v23
    v_mul_f32 v85, v85, v23
    v_mfma_f32_16x16x32_bf16 v[112:115], a[8:11], a[212:215], v[112:115]
    v_mul_f32 v86, v86, v23
    v_mul_f32 v87, v87, v23
    v_mfma_f32_16x16x32_bf16 v[112:115], a[4:7], a[208:211], v[112:115]
    v_cvt_pk_bf16_f32 v58, v84, v85
    v_cvt_pk_bf16_f32 v59, v86, v87
    v_mfma_f32_16x16x32_bf16 v[112:115], a[0:3], a[204:207], v[112:115]
    v_mul_f32 v80, v80, v23
    v_mul_f32 v81, v81, v23
    v_mfma_f32_16x16x32_bf16 v[64:67], v[32:35], v[128:131], 0
    v_mul_f32 v82, v82, v23
    v_mul_f32 v83, v83, v23
    v_mfma_f32_16x16x32_bf16 v[64:67], v[36:39], v[132:135], v[64:67]
    v_cvt_pk_bf16_f32 v56, v80, v81
    v_cvt_pk_bf16_f32 v57, v82, v83
    v_mfma_f32_16x16x32_bf16 v[68:71], v[36:39], v[140:143], 0
    v_cvt_pk_bf16_f32 v208, v96, v97
    v_cvt_pk_bf16_f32 v209, v98, v99
    v_mfma_f32_16x16x32_bf16 v[68:71], v[32:35], v[136:139], v[68:71]
    v_cvt_pk_bf16_f32 v210, v100, v101
    v_cvt_pk_bf16_f32 v211, v102, v103
    v_mfma_f32_16x16x32_bf16 v[72:75], v[32:35], v[144:147], 0
    buffer_load_dwordx4 a[0:3], v9, s[8:11], s24 offen offset:0 nt
    v_cvt_pk_bf16_f32 v212, v104, v105
    v_mfma_f32_16x16x32_bf16 v[72:75], v[36:39], v[148:151], v[72:75]
    buffer_load_dwordx4 a[4:7], v10, s[8:11], s24 offen offset:0 nt
    v_cvt_pk_bf16_f32 v213, v106, v107
    v_mfma_f32_16x16x32_bf16 v[76:79], v[36:39], v[156:159], 0
    v_cvt_pk_bf16_f32 v214, v108, v109
    v_cvt_pk_bf16_f32 v215, v110, v111
    v_mfma_f32_16x16x32_bf16 v[76:79], v[32:35], v[152:155], v[76:79]
    v_cvt_pk_bf16_f32 v222, v124, v125
    v_cvt_pk_bf16_f32 v223, v126, v127
    v_mfma_f32_16x16x32_bf16 v[92:95], v[40:43], v[152:155], 0
    v_cvt_pk_bf16_f32 v220, v120, v121
    v_cvt_pk_bf16_f32 v221, v122, v123
    v_mfma_f32_16x16x32_bf16 v[92:95], v[44:47], v[156:159], v[92:95]
    v_cvt_pk_bf16_f32 v218, v116, v117
    v_cvt_pk_bf16_f32 v219, v118, v119
    v_mfma_f32_16x16x32_bf16 v[88:91], v[44:47], v[148:151], 0
    v_cvt_pk_bf16_f32 v216, v112, v113
    v_cvt_pk_bf16_f32 v217, v114, v115
    v_mfma_f32_16x16x32_bf16 v[88:91], v[40:43], v[144:147], v[88:91]
    v_cvt_pk_bf16_f32 v224, v64, v68
    v_cvt_pk_bf16_f32 v226, v65, v69
    v_mfma_f32_16x16x32_bf16 v[84:87], v[40:43], v[136:139], 0
    v_cvt_pk_bf16_f32 v228, v66, v70
    v_cvt_pk_bf16_f32 v230, v67, v71
    v_mfma_f32_16x16x32_bf16 v[84:87], v[44:47], v[140:143], v[84:87]
    v_cvt_pk_bf16_f32 v225, v72, v76
    v_cvt_pk_bf16_f32 v227, v73, v77
    v_mfma_f32_16x16x32_bf16 v[80:83], v[44:47], v[132:135], 0
    v_cvt_pk_bf16_f32 v229, v74, v78
    v_cvt_pk_bf16_f32 v231, v75, v79
    v_mfma_f32_16x16x32_bf16 v[80:83], v[40:43], v[128:131], v[80:83]
    v_cvt_pk_bf16_f32 v233, v88, v92
    v_cvt_pk_bf16_f32 v235, v89, v93
    v_mfma_f32_16x16x32_bf16 v[96:99], v[48:51], v[128:131], 0
    v_cvt_pk_bf16_f32 v237, v90, v94
    v_cvt_pk_bf16_f32 v239, v91, v95
    v_mfma_f32_16x16x32_bf16 v[96:99], v[52:55], v[132:135], v[96:99]
    v_mfma_f32_16x16x32_bf16 v[100:103], v[52:55], v[140:143], 0
    v_cvt_pk_bf16_f32 v232, v80, v84
    v_cvt_pk_bf16_f32 v234, v81, v85
    v_mfma_f32_16x16x32_bf16 v[100:103], v[48:51], v[136:139], v[100:103]
    v_cvt_pk_bf16_f32 v236, v82, v86
    v_cvt_pk_bf16_f32 v238, v83, v87
    v_mfma_f32_16x16x32_bf16 v[104:107], v[48:51], v[144:147], 0
    v_mfma_f32_16x16x32_bf16 v[104:107], v[52:55], v[148:151], v[104:107]
    v_mfma_f32_16x16x32_bf16 v[108:111], v[52:55], v[156:159], 0
    v_cvt_pk_bf16_f32 v240, v96, v100
    v_cvt_pk_bf16_f32 v242, v97, v101
    v_mfma_f32_16x16x32_bf16 v[108:111], v[48:51], v[152:155], v[108:111]
    v_cvt_pk_bf16_f32 v244, v98, v102
    v_cvt_pk_bf16_f32 v246, v99, v103
    v_mfma_f32_16x16x32_bf16 v[124:127], v[56:59], v[152:155], 0
    v_mfma_f32_16x16x32_bf16 v[124:127], v[60:63], v[156:159], v[124:127]
    v_mfma_f32_16x16x32_bf16 v[120:123], v[60:63], v[148:151], 0
    v_cvt_pk_bf16_f32 v241, v104, v108
    v_cvt_pk_bf16_f32 v243, v105, v109
    v_mfma_f32_16x16x32_bf16 v[120:123], v[56:59], v[144:147], v[120:123]
    v_cvt_pk_bf16_f32 v245, v106, v110
    v_cvt_pk_bf16_f32 v247, v107, v111
    v_mfma_f32_16x16x32_bf16 v[116:119], v[56:59], v[136:139], 0
    buffer_store_dwordx2 v[224:225], v11, s[12:15], s32 offen offset:0 sc1
    v_mfma_f32_16x16x32_bf16 v[116:119], v[60:63], v[140:143], v[116:119]
    v_mfma_f32_16x16x32_bf16 v[112:115], v[60:63], v[132:135], 0
    v_cvt_pk_bf16_f32 v249, v120, v124
    v_cvt_pk_bf16_f32 v251, v121, v125
    v_mfma_f32_16x16x32_bf16 v[112:115], v[56:59], v[128:131], v[112:115]
    v_cvt_pk_bf16_f32 v253, v122, v126
    v_cvt_pk_bf16_f32 v255, v123, v127
    v_mfma_f32_16x16x32_bf16 v[64:67], v[32:35], v[160:163], 0
    v_mfma_f32_16x16x32_bf16 v[64:67], v[36:39], v[164:167], v[64:67]
    v_mfma_f32_16x16x32_bf16 v[68:71], v[36:39], v[172:175], 0
    v_cvt_pk_bf16_f32 v248, v112, v116
    v_cvt_pk_bf16_f32 v250, v113, v117
    v_mfma_f32_16x16x32_bf16 v[68:71], v[32:35], v[168:171], v[68:71]
    v_cvt_pk_bf16_f32 v252, v114, v118
    v_cvt_pk_bf16_f32 v254, v115, v119
    v_mfma_f32_16x16x32_bf16 v[72:75], v[32:35], v[176:179], 0
    v_mfma_f32_16x16x32_bf16 v[72:75], v[36:39], v[180:183], v[72:75]
    v_mfma_f32_16x16x32_bf16 v[76:79], v[36:39], v[188:191], 0
    v_cvt_pk_bf16_f32 v128, v64, v68
    v_cvt_pk_bf16_f32 v130, v65, v69
    v_mfma_f32_16x16x32_bf16 v[76:79], v[32:35], v[184:187], v[76:79]
    buffer_store_dwordx2 v[226:227], v11, s[12:15], s32 offen offset:384 sc1
    v_mfma_f32_16x16x32_bf16 v[92:95], v[40:43], v[184:187], 0
    v_cvt_pk_bf16_f32 v132, v66, v70
    v_cvt_pk_bf16_f32 v134, v67, v71
    v_mfma_f32_16x16x32_bf16 v[92:95], v[44:47], v[188:191], v[92:95]
    v_mfma_f32_16x16x32_bf16 v[88:91], v[44:47], v[180:183], 0
    v_cvt_pk_bf16_f32 v129, v72, v76
    v_cvt_pk_bf16_f32 v131, v73, v77
    v_mfma_f32_16x16x32_bf16 v[88:91], v[40:43], v[176:179], v[88:91]
    v_cvt_pk_bf16_f32 v133, v74, v78
    v_cvt_pk_bf16_f32 v135, v75, v79
    v_mfma_f32_16x16x32_bf16 v[84:87], v[40:43], v[168:171], 0
    v_mfma_f32_16x16x32_bf16 v[84:87], v[44:47], v[172:175], v[84:87]
    v_mfma_f32_16x16x32_bf16 v[80:83], v[44:47], v[164:167], 0
    v_cvt_pk_bf16_f32 v137, v88, v92
    v_cvt_pk_bf16_f32 v139, v89, v93
    v_mfma_f32_16x16x32_bf16 v[80:83], v[40:43], v[160:163], v[80:83]
    v_cvt_pk_bf16_f32 v141, v90, v94
    v_cvt_pk_bf16_f32 v143, v91, v95
    v_mfma_f32_16x16x32_bf16 v[96:99], v[48:51], v[160:163], 0
    s_waitcnt vmcnt(8)
    ds_write_b32 v4, a120 offset:0
    v_mfma_f32_16x16x32_bf16 v[96:99], v[52:55], v[164:167], v[96:99]
    ds_write_b32 v4, a121 offset:4
    v_mfma_f32_16x16x32_bf16 v[100:103], v[52:55], v[172:175], 0
    ds_write_b32 v4, a122 offset:1024
    v_mfma_f32_16x16x32_bf16 v[100:103], v[48:51], v[168:171], v[100:103]
    buffer_store_dwordx2 v[228:229], v11, s[12:15], s32 offen offset:768 sc1
    v_mfma_f32_16x16x32_bf16 v[104:107], v[48:51], v[176:179], 0
    ds_write_b32 v4, a123 offset:1028
    v_mfma_f32_16x16x32_bf16 v[104:107], v[52:55], v[180:183], v[104:107]
    ds_write_b32 v4, a124 offset:512
    v_mfma_f32_16x16x32_bf16 v[108:111], v[52:55], v[188:191], 0
    ds_write_b32 v4, a125 offset:516
    v_mfma_f32_16x16x32_bf16 v[108:111], v[48:51], v[184:187], v[108:111]
    ds_write_b32 v4, a126 offset:1536
    v_mfma_f32_16x16x32_bf16 v[124:127], v[56:59], v[184:187], 0
    ds_write_b32 v4, a127 offset:1540
    v_mfma_f32_16x16x32_bf16 v[124:127], v[60:63], v[188:191], v[124:127]
    ds_read2_b64 a[120:123], v5 offset0:0 offset1:128
    v_cvt_pk_bf16_f32 v136, v80, v84
    v_mfma_f32_16x16x32_bf16 v[120:123], v[60:63], v[180:183], 0
    ds_read2_b64 a[124:127], v6 offset0:0 offset1:128
    v_cvt_pk_bf16_f32 v138, v81, v85
    v_mfma_f32_16x16x32_bf16 v[120:123], v[56:59], v[176:179], v[120:123]
    v_cvt_pk_bf16_f32 v140, v82, v86
    v_cvt_pk_bf16_f32 v142, v83, v87
    v_mfma_f32_16x16x32_bf16 v[116:119], v[56:59], v[168:171], 0
    buffer_load_dwordx4 a[8:11], v9, s[8:11], s24 offen offset:128 nt
    v_cvt_pk_bf16_f32 v144, v96, v100
    v_mfma_f32_16x16x32_bf16 v[116:119], v[60:63], v[172:175], v[116:119]
    buffer_load_dwordx4 a[12:15], v10, s[8:11], s24 offen offset:128 nt
    v_cvt_pk_bf16_f32 v146, v97, v101
    v_mfma_f32_16x16x32_bf16 v[112:115], v[60:63], v[164:167], 0
    v_cvt_pk_bf16_f32 v148, v98, v102
    v_cvt_pk_bf16_f32 v150, v99, v103
    v_mfma_f32_16x16x32_bf16 v[112:115], v[56:59], v[160:163], v[112:115]
    buffer_store_dwordx2 v[230:231], v11, s[12:15], s32 offen offset:1152 sc1
    v_mfma_f32_16x16x32_bf16 v[64:67], v[32:35], v[192:195], 0
    s_waitcnt vmcnt(27)
    ds_write_b32 v4, a128 offset:0
    v_mfma_f32_16x16x32_bf16 v[64:67], v[36:39], v[196:199], v[64:67]
    ds_write_b32 v4, a129 offset:4
    v_mfma_f32_16x16x32_bf16 v[68:71], v[36:39], v[204:207], 0
    ds_write_b32 v4, a130 offset:1024
    v_mfma_f32_16x16x32_bf16 v[68:71], v[32:35], v[200:203], v[68:71]
    ds_write_b32 v4, a131 offset:1028
    v_mfma_f32_16x16x32_bf16 v[72:75], v[32:35], v[208:211], 0
    ds_write_b32 v4, a132 offset:512
    v_mfma_f32_16x16x32_bf16 v[72:75], v[36:39], v[212:215], v[72:75]
    ds_write_b32 v4, a133 offset:516
    v_mfma_f32_16x16x32_bf16 v[76:79], v[36:39], v[220:223], 0
    ds_read_b128 a[228:231], v1 offset:0
    v_cvt_pk_bf16_f32 v145, v104, v108
    v_mfma_f32_16x16x32_bf16 v[76:79], v[32:35], v[216:219], v[76:79]
    ds_write_b32 v4, a134 offset:1536
    v_mfma_f32_16x16x32_bf16 v[92:95], v[40:43], v[216:219], 0
    ds_read_b128 a[232:235], v1 offset:1024
    v_cvt_pk_bf16_f32 v147, v105, v109
    v_mfma_f32_16x16x32_bf16 v[92:95], v[44:47], v[220:223], v[92:95]
    ds_write_b32 v4, a135 offset:1540
    v_mfma_f32_16x16x32_bf16 v[88:91], v[44:47], v[212:215], 0
    buffer_store_dwordx2 v[232:233], v11, s[12:15], s34 offen offset:0 sc1
    v_mfma_f32_16x16x32_bf16 v[88:91], v[40:43], v[208:211], v[88:91]
    ds_read_b128 a[236:239], v1 offset:2048
    v_cvt_pk_bf16_f32 v149, v106, v110
    v_mfma_f32_16x16x32_bf16 v[84:87], v[40:43], v[200:203], 0
    ds_read_b128 a[240:243], v1 offset:3072
    v_cvt_pk_bf16_f32 v151, v107, v111
    v_mfma_f32_16x16x32_bf16 v[84:87], v[44:47], v[204:207], v[84:87]
    ds_read2_b64 a[128:131], v5 offset0:0 offset1:128
    v_cvt_pk_bf16_f32 v153, v120, v124
    v_mfma_f32_16x16x32_bf16 v[80:83], v[44:47], v[196:199], 0
    ds_read_b128 a[244:247], v1 offset:4096
    v_cvt_pk_bf16_f32 v155, v121, v125
    v_mfma_f32_16x16x32_bf16 v[80:83], v[40:43], v[192:195], v[80:83]
    ds_read2_b64 a[132:135], v6 offset0:0 offset1:128
    v_cvt_pk_bf16_f32 v157, v122, v126
    v_mfma_f32_16x16x32_bf16 v[96:99], v[48:51], v[192:195], 0
    ds_read_b128 a[248:251], v1 offset:5120
    v_cvt_pk_bf16_f32 v159, v123, v127
    v_mfma_f32_16x16x32_bf16 v[96:99], v[52:55], v[196:199], v[96:99]
    s_waitcnt vmcnt(24)
    ds_write_b32 v4, a136 offset:0
    v_mfma_f32_16x16x32_bf16 v[100:103], v[52:55], v[204:207], 0
    ds_read_b128 a[192:195], v1 offset:6144
    v_cvt_pk_bf16_f32 v152, v112, v116
    v_mfma_f32_16x16x32_bf16 v[100:103], v[48:51], v[200:203], v[100:103]
    ds_write_b32 v4, a137 offset:4
    v_mfma_f32_16x16x32_bf16 v[104:107], v[48:51], v[208:211], 0
    ds_read_b128 a[196:199], v1 offset:7168
    v_cvt_pk_bf16_f32 v154, v113, v117
    v_mfma_f32_16x16x32_bf16 v[104:107], v[52:55], v[212:215], v[104:107]
    ds_write_b32 v4, a138 offset:1024
    v_mfma_f32_16x16x32_bf16 v[108:111], v[52:55], v[220:223], 0
    buffer_store_dwordx2 v[234:235], v11, s[12:15], s34 offen offset:384 sc1
    v_mfma_f32_16x16x32_bf16 v[108:111], v[48:51], v[216:219], v[108:111]
    ds_read_b128 a[200:203], v1 offset:8192
    v_cvt_pk_bf16_f32 v156, v114, v118
    v_mfma_f32_16x16x32_bf16 v[124:127], v[56:59], v[216:219], 0
    ds_write_b32 v4, a139 offset:1028
    v_mfma_f32_16x16x32_bf16 v[124:127], v[60:63], v[220:223], v[124:127]
    ds_write_b32 v4, a140 offset:512
    v_mfma_f32_16x16x32_bf16 v[120:123], v[60:63], v[212:215], 0
    ds_write_b32 v4, a141 offset:516
    v_mfma_f32_16x16x32_bf16 v[120:123], v[56:59], v[208:211], v[120:123]
    ds_write_b32 v4, a142 offset:1536
    v_cvt_pk_bf16_f32 v158, v115, v119
    v_mfma_f32_16x16x32_bf16 v[116:119], v[56:59], v[200:203], 0
    ds_write_b32 v4, a143 offset:1540
    v_mfma_f32_16x16x32_bf16 v[116:119], v[60:63], v[204:207], v[116:119]
    ds_read2_b64 a[140:143], v6 offset0:0 offset1:128
    v_cvt_pk_bf16_f32 v176, v96, v100
    v_mfma_f32_16x16x32_bf16 v[112:115], v[60:63], v[196:199], 0
    ds_read_b128 a[204:207], v1 offset:9216
    v_cvt_pk_bf16_f32 v178, v97, v101
    v_mfma_f32_16x16x32_bf16 v[112:115], v[56:59], v[192:195], v[112:115]
    s_waitcnt lgkmcnt(11)
    ds_read2_b64 a[136:139], v5 offset0:0 offset1:128
    v_cvt_pk_bf16_f32 v180, v98, v102
    v_cvt_pk_bf16_f32 v182, v99, v103
    v_mfma_f32_16x16x32_bf16 v[96:99], a[228:231], a[96:99], 0
    ds_read_b128 a[208:211], v1 offset:10240
    v_cvt_pk_bf16_f32 v177, v104, v108
    v_mfma_f32_16x16x32_bf16 v[96:99], a[232:235], a[100:103], v[96:99]
    ds_read_b128 a[212:215], v1 offset:11264
    v_cvt_pk_bf16_f32 v179, v105, v109
    v_mfma_f32_16x16x32_bf16 v[96:99], a[236:239], a[104:107], v[96:99]
    ds_read_b128 a[216:219], v1 offset:12288
    v_cvt_pk_bf16_f32 v184, v112, v116
    v_mfma_f32_16x16x32_bf16 v[96:99], a[240:243], a[108:111], v[96:99]
    ds_read_b128 a[220:223], v1 offset:13312
    v_cvt_pk_bf16_f32 v186, v113, v117
    v_mfma_f32_16x16x32_bf16 v[96:99], a[244:247], a[112:115], v[96:99]
    buffer_store_dwordx2 v[236:237], v11, s[12:15], s34 offen offset:768 sc1
    v_mfma_f32_16x16x32_bf16 v[96:99], a[248:251], a[116:119], v[96:99]
    s_waitcnt lgkmcnt(6)
    ds_read_b128 a[224:227], v1 offset:14336
    v_cvt_pk_bf16_f32 v188, v114, v118
    v_mfma_f32_16x16x32_bf16 v[100:103], a[248:251], a[140:143], 0
    s_waitcnt vmcnt(13) lgkmcnt(5)
    ds_write_b32 v4, a144 offset:0
    v_mfma_f32_16x16x32_bf16 v[100:103], a[244:247], a[136:139], v[100:103]
    ds_write_b32 v4, a145 offset:4
    v_mfma_f32_16x16x32_bf16 v[100:103], a[240:243], a[132:135], v[100:103]
    ds_write_b32 v4, a146 offset:1024
    v_mfma_f32_16x16x32_bf16 v[100:103], a[236:239], a[128:131], v[100:103]
    ds_write_b32 v4, a147 offset:1028
    v_mfma_f32_16x16x32_bf16 v[100:103], a[232:235], a[124:127], v[100:103]
    ds_write_b32 v4, a148 offset:512
    v_mfma_f32_16x16x32_bf16 v[100:103], a[228:231], a[120:123], v[100:103]
    ds_write_b32 v4, a149 offset:516
    v_cvt_pk_bf16_f32 v190, v115, v119
    v_mfma_f32_16x16x32_bf16 v[116:119], a[192:195], a[120:123], 0
    ds_read_b128 a[228:231], v1 offset:15360
    v_cvt_pk_bf16_f32 v192, v96, v97
    v_mfma_f32_16x16x32_bf16 v[116:119], a[196:199], a[124:127], v[116:119]
    ds_read_b128 a[232:235], v1 offset:16384
    v_cvt_pk_bf16_f32 v193, v98, v99
    v_mfma_f32_16x16x32_bf16 v[116:119], a[200:203], a[128:131], v[116:119]
    ds_read_b128 a[236:239], v1 offset:17408
    v_cvt_pk_bf16_f32 v196, v100, v101
    v_mfma_f32_16x16x32_bf16 v[116:119], a[204:207], a[132:135], v[116:119]
    s_waitcnt lgkmcnt(10)
    ds_read_b128 a[240:243], v1 offset:18432
    v_cvt_pk_bf16_f32 v197, v102, v103
    v_mfma_f32_16x16x32_bf16 v[116:119], a[208:211], a[136:139], v[116:119]
    ds_read_b128 a[244:247], v1 offset:19456
    v_cvt_pk_bf16_f32 v181, v106, v110
    v_mfma_f32_16x16x32_bf16 v[116:119], a[212:215], a[140:143], v[116:119]
    buffer_store_dwordx2 v[238:239], v11, s[12:15], s34 offen offset:1152 sc1
    v_mfma_f32_16x16x32_bf16 v[112:115], a[212:215], a[116:119], 0
    ds_read_b128 a[248:251], v1 offset:20480
    v_cvt_pk_bf16_f32 v183, v107, v111
    v_mfma_f32_16x16x32_bf16 v[112:115], a[208:211], a[112:115], v[112:115]
    ds_write_b32 v4, a150 offset:1536
    v_mfma_f32_16x16x32_bf16 v[112:115], a[204:207], a[108:111], v[112:115]
    buffer_load_dwordx4 a[16:19], v9, s[8:11], s24 offen offset:256 nt
    v_cvt_pk_bf16_f32 v198, v116, v117
    v_mfma_f32_16x16x32_bf16 v[112:115], a[200:203], a[104:107], v[112:115]
    buffer_load_dwordx4 a[20:23], v10, s[8:11], s24 offen offset:256 nt
    v_cvt_pk_bf16_f32 v199, v118, v119
    v_mfma_f32_16x16x32_bf16 v[112:115], a[196:199], a[100:103], v[112:115]
    s_add_u32 s24, s16, 9437184
    ds_write_b32 v4, a151 offset:1540
    v_mfma_f32_16x16x32_bf16 v[112:115], a[192:195], a[96:99], v[112:115]
    ds_read2_b64 a[144:147], v5 offset0:0 offset1:128
    v_cvt_pk_bf16_f32 v185, v120, v124
    v_mfma_f32_16x16x32_bf16 v[96:99], a[216:219], a[96:99], 0
    ds_read_b128 a[192:195], v1 offset:21504
    v_cvt_pk_bf16_f32 v187, v121, v125
    v_mfma_f32_16x16x32_bf16 v[96:99], a[220:223], a[100:103], v[96:99]
    s_waitcnt lgkmcnt(9)
    ds_read_b128 a[196:199], v1 offset:22528
    v_cvt_pk_bf16_f32 v189, v122, v126
    v_mfma_f32_16x16x32_bf16 v[96:99], a[224:227], a[104:107], v[96:99]
    ds_read_b128 a[200:203], v1 offset:23552
    v_cvt_pk_bf16_f32 v194, v112, v113
    v_mfma_f32_16x16x32_bf16 v[96:99], a[228:231], a[108:111], v[96:99]
    s_waitcnt lgkmcnt(9)
    ds_read_b128 a[204:207], v1 offset:24576
    v_cvt_pk_bf16_f32 v195, v114, v115
    v_mfma_f32_16x16x32_bf16 v[96:99], a[232:235], a[112:115], v[96:99]
    ds_read_b128 a[208:211], v1 offset:25600
    v_cvt_pk_bf16_f32 v191, v123, v127
    v_mfma_f32_16x16x32_bf16 v[96:99], a[236:239], a[116:119], v[96:99]
    buffer_store_dwordx2 v[240:241], v11, s[12:15], s36 offen offset:0 sc1
    v_mfma_f32_16x16x32_bf16 v[100:103], a[236:239], a[140:143], 0
    ds_read_b128 a[212:215], v1 offset:26624
    v_cvt_pk_bf16_f32 v160, v64, v68
    v_mfma_f32_16x16x32_bf16 v[100:103], a[232:235], a[136:139], v[100:103]
    ds_read2_b64 a[148:151], v6 offset0:0 offset1:128
    v_cvt_pk_bf16_f32 v162, v65, v69
    v_mfma_f32_16x16x32_bf16 v[100:103], a[228:231], a[132:135], v[100:103]
    ds_write_b32 v4, a168 offset:0
    v_mfma_f32_16x16x32_bf16 v[100:103], a[224:227], a[128:131], v[100:103]
    ds_write_b32 v4, a169 offset:4
    v_mfma_f32_16x16x32_bf16 v[100:103], a[220:223], a[124:127], v[100:103]
    ds_write_b32 v4, a170 offset:1024
    v_mfma_f32_16x16x32_bf16 v[100:103], a[216:219], a[120:123], v[100:103]
    s_waitcnt lgkmcnt(11)
    ds_write_b32 v4, a171 offset:1028
    v_mfma_f32_16x16x32_bf16 v[116:119], a[240:243], a[120:123], 0
    ds_read_b128 a[216:219], v1 offset:27648
    v_cvt_pk_bf16_f32 v208, v96, v97
    v_mfma_f32_16x16x32_bf16 v[116:119], a[244:247], a[124:127], v[116:119]
    ds_read_b128 a[220:223], v1 offset:28672
    v_cvt_pk_bf16_f32 v209, v98, v99
    v_mfma_f32_16x16x32_bf16 v[116:119], a[248:251], a[128:131], v[116:119]
    s_waitcnt lgkmcnt(11)
    ds_read_b128 a[224:227], v1 offset:29696
    v_cvt_pk_bf16_f32 v212, v100, v101
    v_mfma_f32_16x16x32_bf16 v[116:119], a[192:195], a[132:135], v[116:119]
    buffer_store_dwordx2 v[242:243], v11, s[12:15], s36 offen offset:384 sc1
    v_mfma_f32_16x16x32_bf16 v[116:119], a[196:199], a[136:139], v[116:119]
    s_waitcnt lgkmcnt(10)
    ds_write_b32 v4, a172 offset:512
    v_mfma_f32_16x16x32_bf16 v[116:119], a[200:203], a[140:143], v[116:119]
    ds_write_b32 v4, a173 offset:516
    v_mfma_f32_16x16x32_bf16 v[112:115], a[200:203], a[116:119], 0
    ds_write_b32 v4, a174 offset:1536
    v_mfma_f32_16x16x32_bf16 v[112:115], a[196:199], a[112:115], v[112:115]
    ds_write_b32 v4, a175 offset:1540
    v_mfma_f32_16x16x32_bf16 v[112:115], a[192:195], a[108:111], v[112:115]
    ds_read2_b64 a[172:175], v6 offset0:0 offset1:128
    v_cvt_pk_bf16_f32 v213, v102, v103
    v_mfma_f32_16x16x32_bf16 v[112:115], a[248:251], a[104:107], v[112:115]
    ds_read2_b64 a[168:171], v5 offset0:0 offset1:128
    v_cvt_pk_bf16_f32 v214, v116, v117
    v_mfma_f32_16x16x32_bf16 v[112:115], a[244:247], a[100:103], v[112:115]
    ds_write_b32 v4, a152 offset:0
    v_mfma_f32_16x16x32_bf16 v[112:115], a[240:243], a[96:99], v[112:115]
    ds_write_b32 v4, a153 offset:4
    v_mfma_f32_16x16x32_bf16 v[96:99], a[204:207], a[96:99], 0
    s_waitcnt lgkmcnt(11)
    ds_write_b32 v4, a154 offset:1024
    v_mfma_f32_16x16x32_bf16 v[96:99], a[208:211], a[100:103], v[96:99]
    buffer_store_dwordx2 v[244:245], v11, s[12:15], s36 offen offset:768 sc1
    v_mfma_f32_16x16x32_bf16 v[96:99], a[212:215], a[104:107], v[96:99]
    s_waitcnt lgkmcnt(10)
    ds_read_b128 a[228:231], v1 offset:30720
    v_cvt_pk_bf16_f32 v210, v112, v113
    v_mfma_f32_16x16x32_bf16 v[96:99], a[216:219], a[108:111], v[96:99]
    ds_write_b32 v4, a155 offset:1028
    v_mfma_f32_16x16x32_bf16 v[96:99], a[220:223], a[112:115], v[96:99]
    s_waitcnt lgkmcnt(11)
    ds_read_b128 a[232:235], v1 offset:31744
    v_cvt_pk_bf16_f32 v211, v114, v115
    v_mfma_f32_16x16x32_bf16 v[96:99], a[224:227], a[116:119], v[96:99]
    ds_write_b32 v4, a156 offset:512
    v_mfma_f32_16x16x32_bf16 v[100:103], a[224:227], a[140:143], 0
    ds_read_b128 a[236:239], v1 offset:32768
    v_cvt_pk_bf16_f32 v215, v118, v119
    v_mfma_f32_16x16x32_bf16 v[100:103], a[220:223], a[136:139], v[100:103]
    ds_write_b32 v4, a157 offset:516
    v_mfma_f32_16x16x32_bf16 v[100:103], a[216:219], a[132:135], v[100:103]
    ds_read_b128 a[240:243], v1 offset:33792
    v_cvt_pk_bf16_f32 v164, v66, v70
    v_mfma_f32_16x16x32_bf16 v[100:103], a[212:215], a[128:131], v[100:103]
    ds_write_b32 v4, a158 offset:1536
    v_mfma_f32_16x16x32_bf16 v[100:103], a[208:211], a[124:127], v[100:103]
    ds_read_b128 a[244:247], v1 offset:34816
    v_cvt_pk_bf16_f32 v166, v67, v71
    v_mfma_f32_16x16x32_bf16 v[100:103], a[204:207], a[120:123], v[100:103]
    ds_write_b32 v4, a159 offset:1540
    v_mfma_f32_16x16x32_bf16 v[32:35], a[96:99], v[192:195], 0
    buffer_store_dwordx2 v[246:247], v11, s[12:15], s36 offen offset:1152 sc1
    v_mfma_f32_16x16x32_bf16 v[32:35], a[100:103], v[208:211], v[32:35]
    ds_read_b128 a[248:251], v1 offset:35840
    v_cvt_pk_bf16_f32 v161, v72, v76
    v_mfma_f32_16x16x32_bf16 v[36:39], a[124:127], v[208:211], 0
    ds_read_b128 a[192:195], v1 offset:36864
    v_cvt_pk_bf16_f32 v163, v73, v77
    v_mfma_f32_16x16x32_bf16 v[36:39], a[120:123], v[192:195], v[36:39]
    ds_read2_b64 a[152:155], v5 offset0:0 offset1:128
    v_cvt_pk_bf16_f32 v165, v74, v78
    v_mfma_f32_16x16x32_bf16 v[40:43], a[144:147], v[192:195], 0
    ds_read_b128 a[196:199], v1 offset:37888
    v_cvt_pk_bf16_f32 v167, v75, v79
    v_mfma_f32_16x16x32_bf16 v[40:43], a[148:151], v[208:211], v[40:43]
    s_waitcnt lgkmcnt(11)
    ds_read2_b64 a[156:159], v6 offset0:0 offset1:128
    v_cvt_pk_bf16_f32 v169, v88, v92
    v_mfma_f32_16x16x32_bf16 v[44:47], a[172:175], v[208:211], 0
    ds_read_b128 a[200:203], v1 offset:38912
    v_cvt_pk_bf16_f32 v171, v89, v93
    v_mfma_f32_16x16x32_bf16 v[44:47], a[168:171], v[192:195], v[44:47]
    s_waitcnt vmcnt(17)
    ds_write_b32 v16, a0 offset:0
    v_mfma_f32_16x16x32_bf16 v[60:63], a[168:171], v[196:199], 0
    ds_read_b128 a[204:207], v1 offset:39936
    v_cvt_pk_bf16_f32 v192, v96, v97
    v_mfma_f32_16x16x32_bf16 v[60:63], a[172:175], v[212:215], v[60:63]
    ds_write_b32 v16, a1 offset:4
    v_mfma_f32_16x16x32_bf16 v[56:59], a[148:151], v[212:215], 0
    ds_read_b128 a[208:211], v1 offset:40960
    v_cvt_pk_bf16_f32 v193, v98, v99
    v_mfma_f32_16x16x32_bf16 v[56:59], a[144:147], v[196:199], v[56:59]
    ds_write_b32 v16, a2 offset:1024
    v_mfma_f32_16x16x32_bf16 v[52:55], a[120:123], v[196:199], 0
    buffer_store_dwordx2 v[248:249], v11, s[12:15], s38 offen offset:0 sc1
    v_mfma_f32_16x16x32_bf16 v[52:55], a[124:127], v[212:215], v[52:55]
    ds_read_b128 a[212:215], v1 offset:41984
    v_cvt_pk_bf16_f32 v173, v90, v94
    v_mfma_f32_16x16x32_bf16 v[48:51], a[100:103], v[212:215], 0
    ds_read_b128 a[216:219], v1 offset:43008
    v_cvt_pk_bf16_f32 v175, v91, v95
    v_mfma_f32_16x16x32_bf16 v[48:51], a[96:99], v[196:199], v[48:51]
    ds_write_b32 v16, a3 offset:1028
    v_mfma_f32_16x16x32_bf16 v[116:119], a[228:231], a[120:123], 0
    buffer_load_dwordx4 a[24:27], v9, s[8:11], s26 offen offset:0 nt
    v_cvt_pk_bf16_f32 v196, v100, v101
    v_mfma_f32_16x16x32_bf16 v[116:119], a[232:235], a[124:127], v[116:119]
    s_waitcnt lgkmcnt(10)
    buffer_load_dwordx4 a[28:31], v10, s[8:11], s26 offen offset:0 nt
    v_cvt_pk_bf16_f32 v197, v102, v103
    v_mfma_f32_16x16x32_bf16 v[116:119], a[236:239], a[128:131], v[116:119]
    ds_read_b128 a[220:223], v1 offset:44032
    v_cvt_pk_bf16_f32 v168, v80, v84
    v_mfma_f32_16x16x32_bf16 v[116:119], a[240:243], a[132:135], v[116:119]
    ds_read_b128 a[224:227], v1 offset:45056
    v_cvt_pk_bf16_f32 v170, v81, v85
    v_mfma_f32_16x16x32_bf16 v[116:119], a[244:247], a[136:139], v[116:119]
    s_waitcnt vmcnt(19)
    ds_write_b32 v16, a4 offset:512
    v_mfma_f32_16x16x32_bf16 v[116:119], a[248:251], a[140:143], v[116:119]
    ds_write_b32 v16, a5 offset:516
    v_mfma_f32_16x16x32_bf16 v[112:115], a[248:251], a[116:119], 0
    ds_write_b32 v16, a6 offset:1536
    v_mfma_f32_16x16x32_bf16 v[112:115], a[244:247], a[112:115], v[112:115]
    ds_write_b32 v16, a7 offset:1540
    v_mfma_f32_16x16x32_bf16 v[112:115], a[240:243], a[108:111], v[112:115]
    buffer_store_dwordx2 v[250:251], v11, s[12:15], s38 offen offset:384 sc1
    v_mfma_f32_16x16x32_bf16 v[112:115], a[236:239], a[104:107], v[112:115]
    ds_read2_b64 a[0:3], v17 offset0:0 offset1:128
    v_cvt_pk_bf16_f32 v198, v116, v117
    v_mfma_f32_16x16x32_bf16 v[112:115], a[232:235], a[100:103], v[112:115]
    ds_read2_b64 a[4:7], v18 offset0:0 offset1:128
    v_cvt_pk_bf16_f32 v199, v118, v119
    v_mfma_f32_16x16x32_bf16 v[112:115], a[228:231], a[96:99], v[112:115]
    ds_write_b32 v4, a176 offset:0
    v_mfma_f32_16x16x32_bf16 v[96:99], a[192:195], a[96:99], 0
    ds_read_b128 a[228:231], v1 offset:46080
    v_cvt_pk_bf16_f32 v172, v82, v86
    v_mfma_f32_16x16x32_bf16 v[96:99], a[196:199], a[100:103], v[96:99]
    s_waitcnt lgkmcnt(10)
    ds_read_b128 a[232:235], v1 offset:47104
    v_cvt_pk_bf16_f32 v174, v83, v87
    v_mfma_f32_16x16x32_bf16 v[96:99], a[200:203], a[104:107], v[96:99]
    ds_read_b128 a[236:239], v1 offset:48128
    v_cvt_pk_bf16_f32 v194, v112, v113
    v_mfma_f32_16x16x32_bf16 v[96:99], a[204:207], a[108:111], v[96:99]
    ds_read_b128 a[240:243], v1 offset:49152
    v_cvt_pk_bf16_f32 v195, v114, v115
    v_mfma_f32_16x16x32_bf16 v[96:99], a[208:211], a[112:115], v[96:99]
    ds_read_b128 a[244:247], v1 offset:50176
    v_mfma_f32_16x16x32_bf16 v[96:99], a[212:215], a[116:119], v[96:99]
    ds_read_b128 a[248:251], v1 offset:51200
    v_mfma_f32_16x16x32_bf16 v[100:103], a[212:215], a[140:143], 0
    ds_write_b32 v4, a177 offset:4
    v_mfma_f32_16x16x32_bf16 v[100:103], a[208:211], a[136:139], v[100:103]
    buffer_store_dwordx2 v[252:253], v11, s[12:15], s38 offen offset:768 sc1
    v_mfma_f32_16x16x32_bf16 v[100:103], a[204:207], a[132:135], v[100:103]
    ds_write_b32 v4, a178 offset:1024
    v_mfma_f32_16x16x32_bf16 v[100:103], a[200:203], a[128:131], v[100:103]
    ds_write_b32 v4, a179 offset:1028
    v_mfma_f32_16x16x32_bf16 v[100:103], a[196:199], a[124:127], v[100:103]
    ds_write_b32 v4, a180 offset:512
    v_mfma_f32_16x16x32_bf16 v[100:103], a[192:195], a[120:123], v[100:103]
    ds_write_b32 v4, a181 offset:516
    v_mfma_f32_16x16x32_bf16 v[116:119], a[216:219], a[120:123], 0
    s_waitcnt lgkmcnt(11)
    ds_read_b128 a[192:195], v1 offset:52224
    v_cvt_pk_bf16_f32 v208, v96, v97
    v_mfma_f32_16x16x32_bf16 v[116:119], a[220:223], a[124:127], v[116:119]
    ds_read_b128 a[196:199], v1 offset:53248
    v_cvt_pk_bf16_f32 v209, v98, v99
    v_mfma_f32_16x16x32_bf16 v[116:119], a[224:227], a[128:131], v[116:119]
    s_waitcnt lgkmcnt(11)
    ds_read_b128 a[200:203], v1 offset:54272
    v_cvt_pk_bf16_f32 v212, v100, v101
    v_mfma_f32_16x16x32_bf16 v[116:119], a[228:231], a[132:135], v[116:119]
    ds_write_b32 v4, a182 offset:1536
    v_mfma_f32_16x16x32_bf16 v[116:119], a[232:235], a[136:139], v[116:119]
    s_waitcnt lgkmcnt(11)
    ds_write_b32 v4, a183 offset:1540
    v_mfma_f32_16x16x32_bf16 v[116:119], a[236:239], a[140:143], v[116:119]
    ds_read2_b64 a[176:179], v5 offset0:0 offset1:128
    v_cvt_pk_bf16_f32 v213, v102, v103
    v_mfma_f32_16x16x32_bf16 v[112:115], a[236:239], a[116:119], 0
    ds_read2_b64 a[180:183], v6 offset0:0 offset1:128
    v_mfma_f32_16x16x32_bf16 v[112:115], a[232:235], a[112:115], v[112:115]
    buffer_store_dwordx2 v[254:255], v11, s[12:15], s38 offen offset:1152 sc1
    v_mfma_f32_16x16x32_bf16 v[112:115], a[228:231], a[108:111], v[112:115]
    v_cvt_pk_bf16_f32 v214, v116, v117
    v_cvt_pk_bf16_f32 v215, v118, v119
    v_mfma_f32_16x16x32_bf16 v[112:115], a[224:227], a[104:107], v[112:115]
    v_mfma_f32_16x16x32_bf16 v[112:115], a[220:223], a[100:103], v[112:115]
    s_waitcnt vmcnt(18)
    ds_write_b32 v16, a8 offset:0
    v_mfma_f32_16x16x32_bf16 v[112:115], a[216:219], a[96:99], v[112:115]
    ds_write_b32 v16, a9 offset:4
    v_mfma_f32_16x16x32_bf16 v[96:99], a[240:243], a[96:99], 0
    s_waitcnt lgkmcnt(9)
    ds_write_b32 v16, a10 offset:1024
    v_mfma_f32_16x16x32_bf16 v[96:99], a[244:247], a[100:103], v[96:99]
    ds_write_b32 v16, a11 offset:1028
    v_mfma_f32_16x16x32_bf16 v[96:99], a[248:251], a[104:107], v[96:99]
    s_waitcnt lgkmcnt(9)
    ds_read_b128 a[204:207], v1 offset:55296
    v_cvt_pk_bf16_f32 v210, v112, v113
    v_mfma_f32_16x16x32_bf16 v[96:99], a[192:195], a[108:111], v[96:99]
    s_waitcnt vmcnt(17)
    ds_write_b32 v16, a12 offset:512
    v_mfma_f32_16x16x32_bf16 v[96:99], a[196:199], a[112:115], v[96:99]
    s_waitcnt lgkmcnt(9)
    ds_read_b128 a[208:211], v1 offset:56320
    v_cvt_pk_bf16_f32 v211, v114, v115
    v_mfma_f32_16x16x32_bf16 v[96:99], a[200:203], a[116:119], v[96:99]
    ds_write_b32 v16, a13 offset:516
    v_mfma_f32_16x16x32_bf16 v[100:103], a[200:203], a[140:143], 0
    ds_read_b128 a[212:215], v1 offset:57344
    v_mfma_f32_16x16x32_bf16 v[100:103], a[196:199], a[136:139], v[100:103]
    buffer_store_dwordx2 v[128:129], v11, s[12:15], s32 offen offset:128 sc1
    v_mfma_f32_16x16x32_bf16 v[100:103], a[192:195], a[132:135], v[100:103]
    ds_read_b128 a[216:219], v1 offset:58368
    v_mfma_f32_16x16x32_bf16 v[100:103], a[248:251], a[128:131], v[100:103]
    ds_write_b32 v16, a14 offset:1536
    v_mfma_f32_16x16x32_bf16 v[100:103], a[244:247], a[124:127], v[100:103]
    ds_read_b128 a[220:223], v1 offset:59392
    v_mfma_f32_16x16x32_bf16 v[100:103], a[240:243], a[120:123], v[100:103]
    ds_write_b32 v16, a15 offset:1540
    v_mfma_f32_16x16x32_bf16 v[32:35], a[104:107], v[192:195], v[32:35]
    ds_read_b128 a[224:227], v1 offset:60416
    v_mfma_f32_16x16x32_bf16 v[32:35], a[108:111], v[208:211], v[32:35]
    ds_read2_b64 a[8:11], v17 offset0:0 offset1:128
    v_mfma_f32_16x16x32_bf16 v[36:39], a[132:135], v[208:211], v[36:39]
    ds_read_b128 a[228:231], v1 offset:61440
    v_mfma_f32_16x16x32_bf16 v[36:39], a[128:131], v[192:195], v[36:39]
    ds_read2_b64 a[12:15], v18 offset0:0 offset1:128
    v_mfma_f32_16x16x32_bf16 v[40:43], a[152:155], v[192:195], v[40:43]
    ds_read_b128 a[232:235], v1 offset:62464
    v_mfma_f32_16x16x32_bf16 v[40:43], a[156:159], v[208:211], v[40:43]
    s_waitcnt lgkmcnt(11)
    ds_write_b32 v4, a160 offset:0
    v_mfma_f32_16x16x32_bf16 v[44:47], a[180:183], v[208:211], v[44:47]
    buffer_store_dwordx2 v[130:131], v11, s[12:15], s32 offen offset:512 sc1
    v_mfma_f32_16x16x32_bf16 v[44:47], a[176:179], v[192:195], v[44:47]
    ds_read_b128 a[236:239], v1 offset:63488
    v_cvt_pk_bf16_f32 v192, v96, v97
    v_mfma_f32_16x16x32_bf16 v[60:63], a[176:179], v[196:199], v[60:63]
    buffer_load_dwordx4 a[32:35], v9, s[8:11], s26 offen offset:128 nt
    v_cvt_pk_bf16_f32 v193, v98, v99
    v_mfma_f32_16x16x32_bf16 v[60:63], a[180:183], v[212:215], v[60:63]
    buffer_load_dwordx4 a[36:39], v10, s[8:11], s26 offen offset:128 nt
    v_mfma_f32_16x16x32_bf16 v[56:59], a[156:159], v[212:215], v[56:59]
    ds_read_b128 a[240:243], v1 offset:64512
    v_mfma_f32_16x16x32_bf16 v[56:59], a[152:155], v[196:199], v[56:59]
    ds_read_b128 a[244:247], v2 offset:0
    v_mfma_f32_16x16x32_bf16 v[52:55], a[128:131], v[196:199], v[52:55]
    ds_write_b32 v4, a161 offset:4
    v_mfma_f32_16x16x32_bf16 v[52:55], a[132:135], v[212:215], v[52:55]
    ds_write_b32 v4, a162 offset:1024
    v_mfma_f32_16x16x32_bf16 v[48:51], a[108:111], v[212:215], v[48:51]
    ds_write_b32 v4, a163 offset:1028
    v_mfma_f32_16x16x32_bf16 v[48:51], a[104:107], v[196:199], v[48:51]
    ds_write_b32 v4, a164 offset:512
    v_mfma_f32_16x16x32_bf16 v[116:119], a[204:207], a[120:123], 0
    ds_write_b32 v4, a165 offset:516
    v_mfma_f32_16x16x32_bf16 v[116:119], a[208:211], a[124:127], v[116:119]
    s_waitcnt lgkmcnt(9)
    ds_write_b32 v4, a166 offset:1536
    v_mfma_f32_16x16x32_bf16 v[116:119], a[212:215], a[128:131], v[116:119]
    ds_write_b32 v4, a167 offset:1540
    v_mfma_f32_16x16x32_bf16 v[116:119], a[216:219], a[132:135], v[116:119]
    ds_read2_b64 a[160:163], v5 offset0:0 offset1:128
    v_cvt_pk_bf16_f32 v196, v100, v101
    v_mfma_f32_16x16x32_bf16 v[116:119], a[220:223], a[136:139], v[116:119]
    ds_read2_b64 a[164:167], v6 offset0:0 offset1:128
    v_cvt_pk_bf16_f32 v197, v102, v103
    v_mfma_f32_16x16x32_bf16 v[116:119], a[224:227], a[140:143], v[116:119]
    ds_read_b128 a[248:251], v2 offset:1024
    v_mfma_f32_16x16x32_bf16 v[112:115], a[224:227], a[116:119], 0
    ds_read_b128 a[192:195], v2 offset:2048
    v_mfma_f32_16x16x32_bf16 v[112:115], a[220:223], a[112:115], v[112:115]
    ds_read_b128 a[196:199], v2 offset:3072
    v_mfma_f32_16x16x32_bf16 v[112:115], a[216:219], a[108:111], v[112:115]
    buffer_store_dwordx2 v[132:133], v11, s[12:15], s32 offen offset:896 sc1
    v_mfma_f32_16x16x32_bf16 v[112:115], a[212:215], a[104:107], v[112:115]
    ds_read_b128 a[200:203], v2 offset:4096
    v_cvt_pk_bf16_f32 v198, v116, v117
    v_mfma_f32_16x16x32_bf16 v[112:115], a[208:211], a[100:103], v[112:115]
    ds_write_b32 v4, a184 offset:0
    v_mfma_f32_16x16x32_bf16 v[112:115], a[204:207], a[96:99], v[112:115]
    ds_write_b32 v4, a185 offset:4
    v_mfma_f32_16x16x32_bf16 v[96:99], a[228:231], a[96:99], 0
    ds_read_b128 a[204:207], v2 offset:5120
    v_cvt_pk_bf16_f32 v199, v118, v119
    v_mfma_f32_16x16x32_bf16 v[96:99], a[232:235], a[100:103], v[96:99]
    s_waitcnt lgkmcnt(11)
    ds_read_b128 a[208:211], v2 offset:6144
    v_mfma_f32_16x16x32_bf16 v[96:99], a[236:239], a[104:107], v[96:99]
    ds_read_b128 a[212:215], v2 offset:7168
    v_cvt_pk_bf16_f32 v194, v112, v113
    v_mfma_f32_16x16x32_bf16 v[96:99], a[240:243], a[108:111], v[96:99]
    ds_read_b128 a[216:219], v1 offset:0
    v_cvt_pk_bf16_f32 v195, v114, v115
    v_mfma_f32_16x16x32_bf16 v[96:99], a[244:247], a[112:115], v[96:99]
    s_waitcnt lgkmcnt(9)
    ds_read_b128 a[220:223], v1 offset:1024
    v_mfma_f32_16x16x32_bf16 v[96:99], a[248:251], a[116:119], v[96:99]
    buffer_store_dwordx2 v[134:135], v11, s[12:15], s32 offen offset:1280 sc1
    v_mfma_f32_16x16x32_bf16 v[100:103], a[248:251], a[140:143], 0
    ds_read_b128 a[224:227], v1 offset:2048
    v_mfma_f32_16x16x32_bf16 v[100:103], a[244:247], a[136:139], v[100:103]
    ds_write_b32 v4, a186 offset:1024
    v_mfma_f32_16x16x32_bf16 v[100:103], a[240:243], a[132:135], v[100:103]
    ds_write_b32 v4, a187 offset:1028
    v_mfma_f32_16x16x32_bf16 v[100:103], a[236:239], a[128:131], v[100:103]
    ds_write_b32 v4, a188 offset:512
    v_mfma_f32_16x16x32_bf16 v[100:103], a[232:235], a[124:127], v[100:103]
    ds_write_b32 v4, a189 offset:516
    v_mfma_f32_16x16x32_bf16 v[100:103], a[228:231], a[120:123], v[100:103]
    s_waitcnt lgkmcnt(11)
    ds_write_b32 v4, a190 offset:1536
    v_mfma_f32_16x16x32_bf16 v[116:119], a[192:195], a[120:123], 0
    ds_read_b128 a[228:231], v1 offset:3072
    v_cvt_pk_bf16_f32 v208, v96, v97
    v_mfma_f32_16x16x32_bf16 v[116:119], a[196:199], a[124:127], v[116:119]
    ds_read_b128 a[232:235], v1 offset:4096
    v_cvt_pk_bf16_f32 v209, v98, v99
    v_mfma_f32_16x16x32_bf16 v[116:119], a[200:203], a[128:131], v[116:119]
    s_waitcnt lgkmcnt(11)
    ds_read_b128 a[236:239], v1 offset:5120
    v_cvt_pk_bf16_f32 v212, v100, v101
    v_mfma_f32_16x16x32_bf16 v[116:119], a[204:207], a[132:135], v[116:119]
    ds_write_b32 v4, a191 offset:1540
    v_mfma_f32_16x16x32_bf16 v[116:119], a[208:211], a[136:139], v[116:119]
    s_waitcnt lgkmcnt(11)
    buffer_store_dwordx2 v[136:137], v11, s[12:15], s34 offen offset:128 sc1
    v_mfma_f32_16x16x32_bf16 v[116:119], a[212:215], a[140:143], v[116:119]
    ds_read2_b64 a[184:187], v5 offset0:0 offset1:128
    v_cvt_pk_bf16_f32 v213, v102, v103
    v_mfma_f32_16x16x32_bf16 v[112:115], a[212:215], a[116:119], 0
    ds_read2_b64 a[188:191], v6 offset0:0 offset1:128
    v_mfma_f32_16x16x32_bf16 v[112:115], a[208:211], a[112:115], v[112:115]
    s_waitcnt vmcnt(18)
    ds_write_b32 v16, a16 offset:0
    v_mfma_f32_16x16x32_bf16 v[112:115], a[204:207], a[108:111], v[112:115]
    ds_write_b32 v16, a17 offset:4
    v_mfma_f32_16x16x32_bf16 v[112:115], a[200:203], a[104:107], v[112:115]
    ds_write_b32 v16, a18 offset:1024
    v_mfma_f32_16x16x32_bf16 v[112:115], a[196:199], a[100:103], v[112:115]
    ds_write_b32 v16, a19 offset:1028
    v_mfma_f32_16x16x32_bf16 v[112:115], a[192:195], a[96:99], v[112:115]
    s_waitcnt vmcnt(17)
    ds_write_b32 v16, a20 offset:512
    v_mfma_f32_16x16x32_bf16 v[104:107], a[216:219], a[144:147], 0
    s_waitcnt lgkmcnt(11)
    ds_write_b32 v16, a21 offset:516
    v_mfma_f32_16x16x32_bf16 v[104:107], a[220:223], a[148:151], v[104:107]
    buffer_store_dwordx2 v[138:139], v11, s[12:15], s34 offen offset:512 sc1
    v_mfma_f32_16x16x32_bf16 v[104:107], a[224:227], a[152:155], v[104:107]
    s_waitcnt lgkmcnt(10)
    ds_read_b128 a[240:243], v1 offset:6144
    v_cvt_pk_bf16_f32 v210, v112, v113
    v_mfma_f32_16x16x32_bf16 v[104:107], a[228:231], a[156:159], v[104:107]
    ds_write_b32 v16, a22 offset:1536
    v_mfma_f32_16x16x32_bf16 v[104:107], a[232:235], a[160:163], v[104:107]
    s_waitcnt lgkmcnt(10)
    ds_read_b128 a[244:247], v1 offset:7168
    v_cvt_pk_bf16_f32 v211, v114, v115
    v_mfma_f32_16x16x32_bf16 v[104:107], a[236:239], a[164:167], v[104:107]
    s_waitcnt lgkmcnt(9)
    ds_write_b32 v16, a23 offset:1540
    v_mfma_f32_16x16x32_bf16 v[108:111], a[236:239], a[188:191], 0
    ds_read_b128 a[248:251], v1 offset:8192
    v_cvt_pk_bf16_f32 v214, v116, v117
    v_mfma_f32_16x16x32_bf16 v[108:111], a[232:235], a[184:187], v[108:111]
    ds_read2_b64 a[16:19], v17 offset0:0 offset1:128
    v_cvt_pk_bf16_f32 v215, v118, v119
    v_mfma_f32_16x16x32_bf16 v[108:111], a[228:231], a[180:183], v[108:111]
    ds_read2_b64 a[20:23], v18 offset0:0 offset1:128
    v_cvt_pk_bf16_f32 v200, v104, v105
    v_mfma_f32_16x16x32_bf16 v[108:111], a[224:227], a[176:179], v[108:111]
    ds_read_b128 a[192:195], v1 offset:9216
    v_cvt_pk_bf16_f32 v201, v106, v107
    v_mfma_f32_16x16x32_bf16 v[108:111], a[220:223], a[172:175], v[108:111]
    ds_read_b128 a[196:199], v1 offset:10240
    v_mfma_f32_16x16x32_bf16 v[108:111], a[216:219], a[168:171], v[108:111]
    v_mfma_f32_16x16x32_bf16 v[32:35], a[112:115], v[192:195], v[32:35]
    buffer_load_dwordx4 a[40:43], v9, s[8:11], s26 offen offset:256 nt
    v_mfma_f32_16x16x32_bf16 v[32:35], a[116:119], v[208:211], v[32:35]
    buffer_load_dwordx4 a[44:47], v10, s[8:11], s26 offen offset:256 nt
    s_add_u32 s26, s16, 9830400
    v_mfma_f32_16x16x32_bf16 v[36:39], a[140:143], v[208:211], v[36:39]
    ds_read_b128 a[200:203], v1 offset:11264
    v_cvt_pk_bf16_f32 v204, v108, v109
    v_mfma_f32_16x16x32_bf16 v[36:39], a[136:139], v[192:195], v[36:39]
    buffer_store_dwordx2 v[140:141], v11, s[12:15], s34 offen offset:896 sc1
    v_mfma_f32_16x16x32_bf16 v[40:43], a[160:163], v[192:195], v[40:43]
    ds_read_b128 a[204:207], v1 offset:12288
    v_cvt_pk_bf16_f32 v205, v110, v111
    v_mfma_f32_16x16x32_bf16 v[40:43], a[164:167], v[208:211], v[40:43]
    ds_read_b128 a[208:211], v1 offset:13312
    v_max3_f32 v12, v32, v33, v34
    v_mfma_f32_16x16x32_bf16 v[44:47], a[188:191], v[208:211], v[44:47]
    ds_read_b128 a[212:215], v1 offset:14336
    v_max3_f32 v12, v12, v35, v36
    v_mfma_f32_16x16x32_bf16 v[44:47], a[184:187], v[192:195], v[44:47]
    v_max3_f32 v12, v12, v37, v38
    v_mfma_f32_16x16x32_bf16 v[60:63], a[184:187], v[196:199], v[60:63]
    ds_read_b128 a[216:219], v1 offset:15360
    v_max3_f32 v12, v12, v39, v40
    v_mfma_f32_16x16x32_bf16 v[60:63], a[188:191], v[212:215], v[60:63]
    v_max3_f32 v12, v12, v41, v42
    v_mfma_f32_16x16x32_bf16 v[56:59], a[164:167], v[212:215], v[56:59]
    ds_read_b128 a[220:223], v1 offset:16384
    v_max3_f32 v12, v12, v43, v44
    v_mfma_f32_16x16x32_bf16 v[56:59], a[160:163], v[196:199], v[56:59]
    v_max3_f32 v12, v12, v45, v46
    v_max_f32 v12, v12, v47
    v_mfma_f32_16x16x32_bf16 v[52:55], a[136:139], v[196:199], v[52:55]
    ds_read_b128 a[224:227], v1 offset:17408
    v_mfma_f32_16x16x32_bf16 v[52:55], a[140:143], v[212:215], v[52:55]
    buffer_store_dwordx2 v[142:143], v11, s[12:15], s34 offen offset:1280 sc1
    v_mfma_f32_16x16x32_bf16 v[48:51], a[116:119], v[212:215], v[48:51]
    ds_read_b128 a[228:231], v1 offset:18432
    v_mfma_f32_16x16x32_bf16 v[48:51], a[112:115], v[196:199], v[48:51]
    s_waitcnt lgkmcnt(7)
    v_mfma_f32_16x16x32_bf16 v[124:127], a[240:243], a[168:171], 0
    ds_read_b128 a[232:235], v1 offset:19456
    v_mfma_f32_16x16x32_bf16 v[124:127], a[244:247], a[172:175], v[124:127]
    v_mfma_f32_16x16x32_bf16 v[124:127], a[248:251], a[176:179], v[124:127]
    ds_read_b128 a[236:239], v1 offset:20480
    v_max3_f32 v13, v48, v49, v50
    v_mfma_f32_16x16x32_bf16 v[124:127], a[192:195], a[180:183], v[124:127]
    v_max3_f32 v13, v13, v51, v52
    v_max3_f32 v13, v13, v53, v54
    v_mfma_f32_16x16x32_bf16 v[124:127], a[196:199], a[184:187], v[124:127]
    v_max3_f32 v13, v13, v55, v56
    v_max3_f32 v13, v13, v57, v58
    v_mfma_f32_16x16x32_bf16 v[124:127], a[200:203], a[188:191], v[124:127]
    v_max3_f32 v13, v13, v59, v60
    v_max3_f32 v13, v13, v61, v62
    v_mfma_f32_16x16x32_bf16 v[120:123], a[200:203], a[164:167], 0
    v_max_f32 v13, v13, v63
    v_mfma_f32_16x16x32_bf16 v[120:123], a[196:199], a[160:163], v[120:123]
    v_mfma_f32_16x16x32_bf16 v[120:123], a[192:195], a[156:159], v[120:123]
    buffer_store_dwordx2 v[144:145], v11, s[12:15], s36 offen offset:128 sc1
    v_mfma_f32_16x16x32_bf16 v[120:123], a[248:251], a[152:155], v[120:123]
    v_cvt_pk_bf16_f32 v206, v124, v125
    v_cvt_pk_bf16_f32 v207, v126, v127
    v_mfma_f32_16x16x32_bf16 v[120:123], a[244:247], a[148:151], v[120:123]
    v_permlane16_swap_b32 v12, v13
    v_mfma_f32_16x16x32_bf16 v[120:123], a[240:243], a[144:147], v[120:123]
    s_waitcnt lgkmcnt(2)
    v_max_f32 v12, v12, v13
    v_mov_b32 v13, v12
    v_mfma_f32_16x16x32_bf16 v[104:107], a[204:207], a[144:147], 0
    ds_read_b128 a[240:243], v1 offset:21504
    v_mfma_f32_16x16x32_bf16 v[104:107], a[208:211], a[148:151], v[104:107]
    ds_read_b128 a[244:247], v1 offset:22528
    v_mfma_f32_16x16x32_bf16 v[104:107], a[212:215], a[152:155], v[104:107]
    ds_read_b128 a[248:251], v1 offset:23552
    v_cvt_pk_bf16_f32 v202, v120, v121
    v_mfma_f32_16x16x32_bf16 v[104:107], a[216:219], a[156:159], v[104:107]
    ds_read_b128 a[192:195], v1 offset:24576
    v_cvt_pk_bf16_f32 v203, v122, v123
    v_mfma_f32_16x16x32_bf16 v[104:107], a[220:223], a[160:163], v[104:107]
    ds_read_b128 a[196:199], v1 offset:25600
    v_mfma_f32_16x16x32_bf16 v[104:107], a[224:227], a[164:167], v[104:107]
    ds_read_b128 a[200:203], v1 offset:26624
    v_mfma_f32_16x16x32_bf16 v[108:111], a[224:227], a[188:191], 0
    v_permlane32_swap_b32 v12, v13
    v_mfma_f32_16x16x32_bf16 v[108:111], a[220:223], a[184:187], v[108:111]
    v_max_f32 v12, v12, v13
    v_mov_b32 v13, v12
    v_mfma_f32_16x16x32_bf16 v[108:111], a[216:219], a[180:183], v[108:111]
    buffer_store_dwordx2 v[146:147], v11, s[12:15], s36 offen offset:512 sc1
    v_mfma_f32_16x16x32_bf16 v[108:111], a[212:215], a[176:179], v[108:111]
    v_cvt_pk_bf16_f32 v216, v104, v105
    v_cvt_pk_bf16_f32 v217, v106, v107
    v_mfma_f32_16x16x32_bf16 v[108:111], a[208:211], a[172:175], v[108:111]
    v_permlane16_swap_b32 v12, v13
    v_mfma_f32_16x16x32_bf16 v[108:111], a[204:207], a[168:171], v[108:111]
    v_sub_f32 v32, v32, v12
    v_sub_f32 v33, v33, v12
    v_mfma_f32_16x16x32_bf16 v[124:127], a[228:231], a[168:171], 0
    s_waitcnt lgkmcnt(6)
    ds_read_b128 a[204:207], v1 offset:27648
    v_sub_f32 v48, v48, v13
    v_mfma_f32_16x16x32_bf16 v[124:127], a[232:235], a[172:175], v[124:127]
    ds_read_b128 a[208:211], v1 offset:28672
    v_sub_f32 v49, v49, v13
    v_mfma_f32_16x16x32_bf16 v[124:127], a[236:239], a[176:179], v[124:127]
    s_waitcnt lgkmcnt(6)
    ds_read_b128 a[212:215], v1 offset:29696
    v_cvt_pk_bf16_f32 v220, v108, v109
    v_mfma_f32_16x16x32_bf16 v[124:127], a[240:243], a[180:183], v[124:127]
    v_cvt_pk_bf16_f32 v221, v110, v111
    v_sub_f32 v34, v34, v12
    v_mfma_f32_16x16x32_bf16 v[124:127], a[244:247], a[184:187], v[124:127]
    s_waitcnt lgkmcnt(5)
    v_exp_f32 v32, v32
    v_mfma_f32_16x16x32_bf16 v[124:127], a[248:251], a[188:191], v[124:127]
    v_exp_f32 v33, v33
    v_mfma_f32_16x16x32_bf16 v[120:123], a[248:251], a[164:167], 0
    v_exp_f32 v48, v48
    v_mfma_f32_16x16x32_bf16 v[120:123], a[244:247], a[160:163], v[120:123]
    v_exp_f32 v49, v49
    v_mfma_f32_16x16x32_bf16 v[120:123], a[240:243], a[156:159], v[120:123]
    buffer_store_dwordx2 v[148:149], v11, s[12:15], s36 offen offset:896 sc1
    v_mfma_f32_16x16x32_bf16 v[120:123], a[236:239], a[152:155], v[120:123]
    v_cvt_pk_bf16_f32 v222, v124, v125
    v_cvt_pk_bf16_f32 v223, v126, v127
    v_mfma_f32_16x16x32_bf16 v[120:123], a[232:235], a[148:151], v[120:123]
    v_sub_f32 v50, v50, v13
    v_sub_f32 v35, v35, v12
    v_mfma_f32_16x16x32_bf16 v[120:123], a[228:231], a[144:147], v[120:123]
    v_exp_f32 v34, v34
    v_mfma_f32_16x16x32_bf16 v[104:107], a[192:195], a[144:147], 0
    s_waitcnt lgkmcnt(3)
    v_exp_f32 v50, v50
    v_mfma_f32_16x16x32_bf16 v[104:107], a[196:199], a[148:151], v[104:107]
    v_sub_f32 v51, v51, v13
    v_sub_f32 v36, v36, v12
    v_mfma_f32_16x16x32_bf16 v[104:107], a[200:203], a[152:155], v[104:107]
    s_waitcnt lgkmcnt(1)
    ds_read_b128 a[216:219], v1 offset:30720
    v_cvt_pk_bf16_f32 v218, v120, v121
    v_mfma_f32_16x16x32_bf16 v[104:107], a[204:207], a[156:159], v[104:107]
    v_cvt_pk_bf16_f32 v219, v122, v123
    v_sub_f32 v52, v52, v13
    v_mfma_f32_16x16x32_bf16 v[104:107], a[208:211], a[160:163], v[104:107]
    s_waitcnt lgkmcnt(1)
    buffer_load_dwordx4 a[48:51], v9, s[8:11], s28 offen offset:0 nt
    v_add_f32 v20, v32, v33
    v_mfma_f32_16x16x32_bf16 v[104:107], a[212:215], a[164:167], v[104:107]
    buffer_load_dwordx4 a[52:55], v10, s[8:11], s28 offen offset:0 nt
    v_sub_f32 v37, v37, v12
    v_mfma_f32_16x16x32_bf16 v[108:111], a[212:215], a[188:191], 0
    ds_read_b128 a[220:223], v1 offset:31744
    v_add_f32 v21, v48, v49
    v_mfma_f32_16x16x32_bf16 v[108:111], a[208:211], a[184:187], v[108:111]
    ds_read_b128 a[224:227], v1 offset:32768
    v_sub_f32 v53, v53, v13
    v_mfma_f32_16x16x32_bf16 v[108:111], a[204:207], a[180:183], v[108:111]
    buffer_store_dwordx2 v[150:151], v11, s[12:15], s36 offen offset:1280 sc1
    v_mfma_f32_16x16x32_bf16 v[108:111], a[200:203], a[176:179], v[108:111]
    ds_read_b128 a[228:231], v1 offset:33792
    v_add_f32 v20, v20, v34
    v_mfma_f32_16x16x32_bf16 v[108:111], a[196:199], a[172:175], v[108:111]
    ds_read_b128 a[232:235], v1 offset:34816
    v_sub_f32 v38, v38, v12
    v_mfma_f32_16x16x32_bf16 v[108:111], a[192:195], a[168:171], v[108:111]
    v_exp_f32 v35, v35
    v_mfma_f32_16x16x32_bf16 v[64:67], a[96:99], v[200:203], 0
    ds_read_b128 a[236:239], v1 offset:35840
    v_add_f32 v21, v21, v50
    v_mfma_f32_16x16x32_bf16 v[64:67], a[100:103], v[216:219], v[64:67]
    v_exp_f32 v51, v51
    v_mfma_f32_16x16x32_bf16 v[68:71], a[124:127], v[216:219], 0
    ds_read_b128 a[240:243], v1 offset:36864
    v_sub_f32 v54, v54, v13
    v_mfma_f32_16x16x32_bf16 v[68:71], a[120:123], v[200:203], v[68:71]
    v_exp_f32 v36, v36
    v_mfma_f32_16x16x32_bf16 v[72:75], a[144:147], v[200:203], 0
    ds_read_b128 a[244:247], v1 offset:37888
    v_add_f32 v20, v20, v35
    v_mfma_f32_16x16x32_bf16 v[72:75], a[148:151], v[216:219], v[72:75]
    v_exp_f32 v52, v52
    v_mfma_f32_16x16x32_bf16 v[76:79], a[172:175], v[216:219], 0
    ds_read_b128 a[248:251], v1 offset:38912
    v_sub_f32 v39, v39, v12
    v_mfma_f32_16x16x32_bf16 v[76:79], a[168:171], v[200:203], v[76:79]
    buffer_store_dwordx2 v[152:153], v11, s[12:15], s38 offen offset:128 sc1
    v_mfma_f32_16x16x32_bf16 v[92:95], a[168:171], v[204:207], 0
    ds_read_b128 a[192:195], v1 offset:39936
    v_cvt_pk_bf16_f32 v200, v104, v105
    v_mfma_f32_16x16x32_bf16 v[92:95], a[172:175], v[220:223], v[92:95]
    v_cvt_pk_bf16_f32 v201, v106, v107
    v_add_f32 v21, v21, v51
    v_mfma_f32_16x16x32_bf16 v[88:91], a[148:151], v[220:223], 0
    ds_read_b128 a[196:199], v1 offset:40960
    v_sub_f32 v55, v55, v13
    v_mfma_f32_16x16x32_bf16 v[88:91], a[144:147], v[204:207], v[88:91]
    v_exp_f32 v37, v37
    v_mfma_f32_16x16x32_bf16 v[84:87], a[120:123], v[204:207], 0
    ds_read_b128 a[200:203], v1 offset:41984
    v_add_f32 v20, v20, v36
    v_mfma_f32_16x16x32_bf16 v[84:87], a[124:127], v[220:223], v[84:87]
    v_exp_f32 v53, v53
    v_mfma_f32_16x16x32_bf16 v[80:83], a[100:103], v[220:223], 0
    ds_read_b128 a[204:207], v1 offset:43008
    v_sub_f32 v40, v40, v12
    v_mfma_f32_16x16x32_bf16 v[80:83], a[96:99], v[204:207], v[80:83]
    s_waitcnt lgkmcnt(6)
    v_cvt_pk_bf16_f32 v204, v108, v109
    v_cvt_pk_bf16_f32 v205, v110, v111
    v_mfma_f32_16x16x32_bf16 v[124:127], a[216:219], a[168:171], 0
    ds_read_b128 a[208:211], v1 offset:44032
    v_add_f32 v21, v21, v52
    v_mfma_f32_16x16x32_bf16 v[124:127], a[220:223], a[172:175], v[124:127]
    v_exp_f32 v38, v38
    v_mfma_f32_16x16x32_bf16 v[124:127], a[224:227], a[176:179], v[124:127]
    ds_read_b128 a[212:215], v1 offset:45056
    v_sub_f32 v56, v56, v13
    v_mfma_f32_16x16x32_bf16 v[124:127], a[228:231], a[180:183], v[124:127]
    buffer_store_dwordx2 v[154:155], v11, s[12:15], s38 offen offset:512 sc1
    v_mfma_f32_16x16x32_bf16 v[124:127], a[232:235], a[184:187], v[124:127]
    v_exp_f32 v54, v54
    v_mfma_f32_16x16x32_bf16 v[124:127], a[236:239], a[188:191], v[124:127]
    v_exp_f32 v39, v39
    v_mfma_f32_16x16x32_bf16 v[120:123], a[236:239], a[164:167], 0
    v_exp_f32 v55, v55
    v_mfma_f32_16x16x32_bf16 v[120:123], a[232:235], a[160:163], v[120:123]
    v_add_f32 v20, v20, v37
    v_sub_f32 v41, v41, v12
    v_mfma_f32_16x16x32_bf16 v[120:123], a[228:231], a[156:159], v[120:123]
    v_cvt_pk_bf16_f32 v206, v124, v125
    v_cvt_pk_bf16_f32 v207, v126, v127
    v_mfma_f32_16x16x32_bf16 v[120:123], a[224:227], a[152:155], v[120:123]
    v_exp_f32 v40, v40
    v_mfma_f32_16x16x32_bf16 v[120:123], a[220:223], a[148:151], v[120:123]
    v_add_f32 v21, v21, v53
    v_sub_f32 v57, v57, v13
    v_mfma_f32_16x16x32_bf16 v[120:123], a[216:219], a[144:147], v[120:123]
    v_exp_f32 v56, v56
    v_mfma_f32_16x16x32_bf16 v[104:107], a[240:243], a[144:147], 0
    s_waitcnt lgkmcnt(2)
    ds_read_b128 a[216:219], v1 offset:46080
    v_add_f32 v20, v20, v38
    v_mfma_f32_16x16x32_bf16 v[104:107], a[244:247], a[148:151], v[104:107]
    ds_read_b128 a[220:223], v1 offset:47104
    v_sub_f32 v42, v42, v12
    v_mfma_f32_16x16x32_bf16 v[104:107], a[248:251], a[152:155], v[104:107]
    ds_read_b128 a[224:227], v1 offset:48128
    v_cvt_pk_bf16_f32 v202, v120, v121
    v_mfma_f32_16x16x32_bf16 v[104:107], a[192:195], a[156:159], v[104:107]
    ds_read_b128 a[228:231], v1 offset:49152
    v_cvt_pk_bf16_f32 v203, v122, v123
    v_mfma_f32_16x16x32_bf16 v[104:107], a[196:199], a[160:163], v[104:107]
    ds_read_b128 a[232:235], v1 offset:50176
    v_add_f32 v21, v21, v54
    v_mfma_f32_16x16x32_bf16 v[104:107], a[200:203], a[164:167], v[104:107]
    ds_read_b128 a[236:239], v1 offset:51200
    v_sub_f32 v58, v58, v13
    v_mfma_f32_16x16x32_bf16 v[108:111], a[200:203], a[188:191], 0
    buffer_store_dwordx2 v[156:157], v11, s[12:15], s38 offen offset:896 sc1
    v_mfma_f32_16x16x32_bf16 v[108:111], a[196:199], a[184:187], v[108:111]
    v_exp_f32 v41, v41
    v_mfma_f32_16x16x32_bf16 v[108:111], a[192:195], a[180:183], v[108:111]
    v_cvt_pk_bf16_f32 v216, v104, v105
    v_cvt_pk_bf16_f32 v217, v106, v107
    v_mfma_f32_16x16x32_bf16 v[108:111], a[248:251], a[176:179], v[108:111]
    v_exp_f32 v57, v57
    v_mfma_f32_16x16x32_bf16 v[108:111], a[244:247], a[172:175], v[108:111]
    v_add_f32 v20, v20, v39
    v_sub_f32 v43, v43, v12
    v_mfma_f32_16x16x32_bf16 v[108:111], a[240:243], a[168:171], v[108:111]
    v_exp_f32 v42, v42
    v_mfma_f32_16x16x32_bf16 v[124:127], a[204:207], a[168:171], 0
    s_waitcnt lgkmcnt(6)
    ds_read_b128 a[240:243], v1 offset:52224
    v_add_f32 v21, v21, v55
    v_mfma_f32_16x16x32_bf16 v[124:127], a[208:211], a[172:175], v[124:127]
    ds_read_b128 a[244:247], v1 offset:53248
    v_sub_f32 v59, v59, v13
    v_mfma_f32_16x16x32_bf16 v[124:127], a[212:215], a[176:179], v[124:127]
    s_waitcnt lgkmcnt(6)
    ds_read_b128 a[248:251], v1 offset:54272
    v_cvt_pk_bf16_f32 v220, v108, v109
    v_mfma_f32_16x16x32_bf16 v[124:127], a[216:219], a[180:183], v[124:127]
    buffer_store_dwordx2 v[158:159], v11, s[12:15], s38 offen offset:1280 sc1
    v_mfma_f32_16x16x32_bf16 v[124:127], a[220:223], a[184:187], v[124:127]
    s_waitcnt lgkmcnt(5)
    v_cvt_pk_bf16_f32 v221, v110, v111
    v_add_f32 v20, v20, v40
    v_mfma_f32_16x16x32_bf16 v[124:127], a[224:227], a[188:191], v[124:127]
    v_exp_f32 v58, v58
    v_mfma_f32_16x16x32_bf16 v[120:123], a[224:227], a[164:167], 0
    v_exp_f32 v43, v43
    v_mfma_f32_16x16x32_bf16 v[120:123], a[220:223], a[160:163], v[120:123]
    v_sub_f32 v44, v44, v12
    v_add_f32 v21, v21, v56
    v_mfma_f32_16x16x32_bf16 v[120:123], a[216:219], a[156:159], v[120:123]
    buffer_load_dwordx4 a[56:59], v9, s[8:11], s28 offen offset:128 nt
    v_cvt_pk_bf16_f32 v222, v124, v125
    v_mfma_f32_16x16x32_bf16 v[120:123], a[212:215], a[152:155], v[120:123]
    buffer_load_dwordx4 a[60:63], v10, s[8:11], s28 offen offset:128 nt
    v_cvt_pk_bf16_f32 v223, v126, v127
    v_mfma_f32_16x16x32_bf16 v[120:123], a[208:211], a[148:151], v[120:123]
    v_exp_f32 v59, v59
    v_mfma_f32_16x16x32_bf16 v[120:123], a[204:207], a[144:147], v[120:123]
    v_sub_f32 v60, v60, v13
    v_add_f32 v20, v20, v41
    v_mfma_f32_16x16x32_bf16 v[104:107], a[228:231], a[144:147], 0
    s_waitcnt lgkmcnt(3)
    v_exp_f32 v44, v44
    v_mfma_f32_16x16x32_bf16 v[104:107], a[232:235], a[148:151], v[104:107]
    v_sub_f32 v45, v45, v12
    v_add_f32 v21, v21, v57
    v_mfma_f32_16x16x32_bf16 v[104:107], a[236:239], a[152:155], v[104:107]
    s_waitcnt lgkmcnt(1)
    buffer_store_dwordx2 v[160:161], v11, s[12:15], s32 offen offset:256 sc1
    v_mfma_f32_16x16x32_bf16 v[104:107], a[240:243], a[156:159], v[104:107]
    ds_read_b128 a[192:195], v1 offset:55296
    v_cvt_pk_bf16_f32 v218, v120, v121
    v_mfma_f32_16x16x32_bf16 v[104:107], a[244:247], a[160:163], v[104:107]
    s_waitcnt lgkmcnt(1)
    ds_read_b128 a[196:199], v1 offset:56320
    v_cvt_pk_bf16_f32 v219, v122, v123
    v_mfma_f32_16x16x32_bf16 v[104:107], a[248:251], a[164:167], v[104:107]
    v_exp_f32 v60, v60
    v_mfma_f32_16x16x32_bf16 v[108:111], a[248:251], a[188:191], 0
    ds_read_b128 a[200:203], v1 offset:57344
    v_sub_f32 v61, v61, v13
    v_mfma_f32_16x16x32_bf16 v[108:111], a[244:247], a[184:187], v[108:111]
    v_add_f32 v20, v20, v42
    v_sub_f32 v46, v46, v12
    v_mfma_f32_16x16x32_bf16 v[108:111], a[240:243], a[180:183], v[108:111]
    ds_read_b128 a[204:207], v1 offset:58368
    v_add_f32 v21, v21, v58
    v_mfma_f32_16x16x32_bf16 v[108:111], a[236:239], a[176:179], v[108:111]
    v_exp_f32 v45, v45
    v_mfma_f32_16x16x32_bf16 v[108:111], a[232:235], a[172:175], v[108:111]
    ds_read_b128 a[208:211], v1 offset:59392
    v_sub_f32 v62, v62, v13
    v_mfma_f32_16x16x32_bf16 v[108:111], a[228:231], a[168:171], v[108:111]
    v_exp_f32 v61, v61
    v_mfma_f32_16x16x32_bf16 v[64:67], a[104:107], v[200:203], v[64:67]
    ds_read_b128 a[212:215], v1 offset:60416
    v_add_f32 v20, v20, v43
    v_mfma_f32_16x16x32_bf16 v[64:67], a[108:111], v[216:219], v[64:67]
    v_exp_f32 v46, v46
    v_mfma_f32_16x16x32_bf16 v[68:71], a[132:135], v[216:219], v[68:71]
    buffer_store_dwordx2 v[162:163], v11, s[12:15], s32 offen offset:640 sc1
    v_mfma_f32_16x16x32_bf16 v[68:71], a[128:131], v[200:203], v[68:71]
    ds_read_b128 a[216:219], v1 offset:61440
    v_sub_f32 v47, v47, v12
    v_mfma_f32_16x16x32_bf16 v[72:75], a[152:155], v[200:203], v[72:75]
    ds_read_b128 a[220:223], v1 offset:62464
    v_add_f32 v21, v21, v59
    v_mfma_f32_16x16x32_bf16 v[72:75], a[156:159], v[216:219], v[72:75]
    v_exp_f32 v62, v62
    v_mfma_f32_16x16x32_bf16 v[76:79], a[180:183], v[216:219], v[76:79]
    ds_read_b128 a[224:227], v1 offset:63488
    v_sub_f32 v63, v63, v13
    v_mfma_f32_16x16x32_bf16 v[76:79], a[176:179], v[200:203], v[76:79]
    v_cvt_pk_bf16_f32 v200, v104, v105
    v_cvt_pk_bf16_f32 v201, v106, v107
    v_mfma_f32_16x16x32_bf16 v[92:95], a[176:179], v[204:207], v[92:95]
    ds_read_b128 a[228:231], v1 offset:64512
    v_add_f32 v20, v20, v44
    v_mfma_f32_16x16x32_bf16 v[92:95], a[180:183], v[220:223], v[92:95]
    v_exp_f32 v47, v47
    v_mfma_f32_16x16x32_bf16 v[88:91], a[156:159], v[220:223], v[88:91]
    ds_read_b128 a[232:235], v2 offset:0
    v_add_f32 v21, v21, v60
    v_mfma_f32_16x16x32_bf16 v[88:91], a[152:155], v[204:207], v[88:91]
    v_exp_f32 v63, v63
    v_mfma_f32_16x16x32_bf16 v[84:87], a[128:131], v[204:207], v[84:87]
    ds_read_b128 a[236:239], v2 offset:1024
    v_add_f32 v20, v20, v45
    v_mfma_f32_16x16x32_bf16 v[84:87], a[132:135], v[220:223], v[84:87]
    buffer_store_dwordx2 v[164:165], v11, s[12:15], s32 offen offset:1024 sc1
    v_mfma_f32_16x16x32_bf16 v[80:83], a[108:111], v[220:223], v[80:83]
    ds_read_b128 a[240:243], v2 offset:2048
    v_add_f32 v21, v21, v61
    v_mfma_f32_16x16x32_bf16 v[80:83], a[104:107], v[204:207], v[80:83]
    s_waitcnt lgkmcnt(7)
    v_cvt_pk_bf16_f32 v204, v108, v109
    v_cvt_pk_bf16_f32 v205, v110, v111
    v_mfma_f32_16x16x32_bf16 v[124:127], a[192:195], a[168:171], 0
    ds_read_b128 a[244:247], v2 offset:3072
    v_add_f32 v20, v20, v46
    v_mfma_f32_16x16x32_bf16 v[124:127], a[196:199], a[172:175], v[124:127]
    v_add_f32 v21, v21, v62
    v_add_f32 v20, v20, v47
    v_mfma_f32_16x16x32_bf16 v[124:127], a[200:203], a[176:179], v[124:127]
    ds_read_b128 a[248:251], v2 offset:4096
    v_add_f32 v21, v21, v63
    v_mfma_f32_16x16x32_bf16 v[124:127], a[204:207], a[180:183], v[124:127]
    v_mfma_f32_16x16x32_bf16 v[124:127], a[208:211], a[184:187], v[124:127]
    v_permlane16_swap_b32 v20, v21
    v_mfma_f32_16x16x32_bf16 v[124:127], a[212:215], a[188:191], v[124:127]
    v_add_f32 v20, v20, v21
    v_mov_b32 v21, v20
    v_mfma_f32_16x16x32_bf16 v[120:123], a[212:215], a[164:167], 0
    v_mfma_f32_16x16x32_bf16 v[120:123], a[208:211], a[160:163], v[120:123]
    v_permlane32_swap_b32 v20, v21
    v_mfma_f32_16x16x32_bf16 v[120:123], a[204:207], a[156:159], v[120:123]
    v_cvt_pk_bf16_f32 v206, v124, v125
    v_cvt_pk_bf16_f32 v207, v126, v127
    v_mfma_f32_16x16x32_bf16 v[120:123], a[200:203], a[152:155], v[120:123]
    buffer_store_dwordx2 v[166:167], v11, s[12:15], s32 offen offset:1408 sc1
    v_mfma_f32_16x16x32_bf16 v[120:123], a[196:199], a[148:151], v[120:123]
    v_add_f32 v20, v20, v21
    v_mfma_f32_16x16x32_bf16 v[120:123], a[192:195], a[144:147], v[120:123]
    s_waitcnt lgkmcnt(2)
    v_rcp_f32 v20, v20
    v_mfma_f32_16x16x32_bf16 v[104:107], a[216:219], a[144:147], 0
    ds_read_b128 a[192:195], v2 offset:5120
    v_mov_b32 v21, v20
    v_mfma_f32_16x16x32_bf16 v[104:107], a[220:223], a[148:151], v[104:107]
    ds_read_b128 a[196:199], v2 offset:6144
    v_mfma_f32_16x16x32_bf16 v[104:107], a[224:227], a[152:155], v[104:107]
    ds_read_b128 a[200:203], v2 offset:7168
    v_cvt_pk_bf16_f32 v202, v120, v121
    v_mfma_f32_16x16x32_bf16 v[104:107], a[228:231], a[156:159], v[104:107]
    ds_read_b128 a[204:207], v2 offset:8192
    v_cvt_pk_bf16_f32 v203, v122, v123
    v_mfma_f32_16x16x32_bf16 v[104:107], a[232:235], a[160:163], v[104:107]
    ds_read_b128 a[208:211], v2 offset:9216
    v_mfma_f32_16x16x32_bf16 v[104:107], a[236:239], a[164:167], v[104:107]
    ds_read_b128 a[212:215], v2 offset:10240
    v_mfma_f32_16x16x32_bf16 v[108:111], a[236:239], a[188:191], 0
    v_permlane16_swap_b32 v20, v21
    v_mfma_f32_16x16x32_bf16 v[108:111], a[232:235], a[184:187], v[108:111]
    v_mul_f32 v32, v32, v20
    v_mul_f32 v33, v33, v20
    v_mfma_f32_16x16x32_bf16 v[108:111], a[228:231], a[180:183], v[108:111]
    v_cvt_pk_bf16_f32 v216, v104, v105
    v_cvt_pk_bf16_f32 v217, v106, v107
    v_mfma_f32_16x16x32_bf16 v[108:111], a[224:227], a[176:179], v[108:111]
    buffer_store_dwordx2 v[168:169], v11, s[12:15], s34 offen offset:256 sc1
    v_mfma_f32_16x16x32_bf16 v[108:111], a[220:223], a[172:175], v[108:111]
    v_cvt_pk_bf16_f32 v32, v32, v33
    v_mul_f32 v34, v34, v20
    v_mfma_f32_16x16x32_bf16 v[108:111], a[216:219], a[168:171], v[108:111]
    v_mul_f32 v35, v35, v20
    v_cvt_pk_bf16_f32 v33, v34, v35
    v_mfma_f32_16x16x32_bf16 v[124:127], a[240:243], a[168:171], 0
    s_waitcnt lgkmcnt(6)
    ds_read_b128 a[216:219], v2 offset:11264
    v_mul_f32 v36, v36, v20
    v_mfma_f32_16x16x32_bf16 v[124:127], a[244:247], a[172:175], v[124:127]
    buffer_load_dwordx4 a[64:67], v9, s[8:11], s28 offen offset:256 nt
    v_mul_f32 v37, v37, v20
    v_mfma_f32_16x16x32_bf16 v[124:127], a[248:251], a[176:179], v[124:127]
    s_waitcnt lgkmcnt(5)
    buffer_load_dwordx4 a[68:71], v10, s[8:11], s28 offen offset:256 nt
    v_cvt_pk_bf16_f32 v220, v108, v109
    v_mfma_f32_16x16x32_bf16 v[124:127], a[192:195], a[180:183], v[124:127]
    s_add_u32 s28, s16, 10223616
    ds_read_b128 a[220:223], v2 offset:12288
    v_cvt_pk_bf16_f32 v221, v110, v111
    v_mfma_f32_16x16x32_bf16 v[124:127], a[196:199], a[184:187], v[124:127]
    s_waitcnt lgkmcnt(4)
    ds_read_b128 a[224:227], v2 offset:13312
    v_mul_f32 v38, v38, v20
    v_mfma_f32_16x16x32_bf16 v[124:127], a[200:203], a[188:191], v[124:127]
    v_mul_f32 v39, v39, v20
    v_cvt_pk_bf16_f32 v34, v36, v37
    v_mfma_f32_16x16x32_bf16 v[120:123], a[200:203], a[164:167], 0
    v_cvt_pk_bf16_f32 v35, v38, v39
    v_mul_f32 v40, v40, v20
    v_mfma_f32_16x16x32_bf16 v[120:123], a[196:199], a[160:163], v[120:123]
    v_mul_f32 v41, v41, v20
    v_mul_f32 v42, v42, v20
    v_mfma_f32_16x16x32_bf16 v[120:123], a[192:195], a[156:159], v[120:123]
    buffer_store_dwordx2 v[170:171], v11, s[12:15], s34 offen offset:640 sc1
    v_mfma_f32_16x16x32_bf16 v[120:123], a[248:251], a[152:155], v[120:123]
    v_cvt_pk_bf16_f32 v222, v124, v125
    v_cvt_pk_bf16_f32 v223, v126, v127
    v_mfma_f32_16x16x32_bf16 v[120:123], a[244:247], a[148:151], v[120:123]
    v_mul_f32 v43, v43, v20
    v_mul_f32 v44, v44, v20
    v_mfma_f32_16x16x32_bf16 v[120:123], a[240:243], a[144:147], v[120:123]
    v_mul_f32 v45, v45, v20
    v_mul_f32 v46, v46, v20
    v_mfma_f32_16x16x32_bf16 v[96:99], a[96:99], a[204:207], 0
    s_waitcnt lgkmcnt(3)
    v_mul_f32 v47, v47, v20
    v_cvt_pk_bf16_f32 v36, v40, v41
    v_mfma_f32_16x16x32_bf16 v[96:99], a[100:103], a[208:211], v[96:99]
    v_cvt_pk_bf16_f32 v37, v42, v43
    v_cvt_pk_bf16_f32 v38, v44, v45
    v_mfma_f32_16x16x32_bf16 v[96:99], a[104:107], a[212:215], v[96:99]
    s_waitcnt lgkmcnt(2)
    v_cvt_pk_bf16_f32 v218, v120, v121
    v_cvt_pk_bf16_f32 v219, v122, v123
    v_mfma_f32_16x16x32_bf16 v[96:99], a[108:111], a[216:219], v[96:99]
    s_waitcnt lgkmcnt(1)
    v_cvt_pk_bf16_f32 v39, v46, v47
    v_mul_f32 v48, v48, v21
    v_mfma_f32_16x16x32_bf16 v[96:99], a[112:115], a[220:223], v[96:99]
    s_waitcnt lgkmcnt(0)
    v_mul_f32 v49, v49, v21
    v_mul_f32 v50, v50, v21
    v_mfma_f32_16x16x32_bf16 v[96:99], a[116:119], a[224:227], v[96:99]
    v_mul_f32 v51, v51, v21
    v_mul_f32 v52, v52, v21
    v_mfma_f32_16x16x32_bf16 v[100:103], a[140:143], a[224:227], 0
    v_mul_f32 v53, v53, v21
    v_mul_f32 v54, v54, v21
    v_mfma_f32_16x16x32_bf16 v[100:103], a[136:139], a[220:223], v[100:103]
    v_mul_f32 v55, v55, v21
    v_cvt_pk_bf16_f32 v40, v48, v49
    v_mfma_f32_16x16x32_bf16 v[100:103], a[132:135], a[216:219], v[100:103]
    buffer_store_dwordx2 v[172:173], v11, s[12:15], s34 offen offset:1024 sc1
    v_mfma_f32_16x16x32_bf16 v[100:103], a[128:131], a[212:215], v[100:103]
    v_cvt_pk_bf16_f32 v128, v96, v97
    v_cvt_pk_bf16_f32 v129, v98, v99
    v_mfma_f32_16x16x32_bf16 v[100:103], a[124:127], a[208:211], v[100:103]
    v_cvt_pk_bf16_f32 v41, v50, v51
    v_cvt_pk_bf16_f32 v42, v52, v53
    v_mfma_f32_16x16x32_bf16 v[100:103], a[120:123], a[204:207], v[100:103]
    v_cvt_pk_bf16_f32 v43, v54, v55
    v_mul_f32 v56, v56, v21
    v_mfma_f32_16x16x32_bf16 v[64:67], a[112:115], v[200:203], v[64:67]
    v_mul_f32 v57, v57, v21
    v_mul_f32 v58, v58, v21
    v_mfma_f32_16x16x32_bf16 v[64:67], a[116:119], v[216:219], v[64:67]
    v_mul_f32 v59, v59, v21
    v_mul_f32 v60, v60, v21
    v_mfma_f32_16x16x32_bf16 v[68:71], a[140:143], v[216:219], v[68:71]
    ds_read_b128 a[228:231], v2 offset:14336
    v_cvt_pk_bf16_f32 v130, v100, v101
    v_mfma_f32_16x16x32_bf16 v[68:71], a[136:139], v[200:203], v[68:71]
    v_cvt_pk_bf16_f32 v131, v102, v103
    v_mul_f32 v61, v61, v21
    v_mfma_f32_16x16x32_bf16 v[72:75], a[160:163], v[200:203], v[72:75]
    ds_read_b128 a[232:235], v2 offset:15360
    v_mul_f32 v62, v62, v21
    v_mfma_f32_16x16x32_bf16 v[72:75], a[164:167], v[216:219], v[72:75]
    v_mul_f32 v63, v63, v21
    v_cvt_pk_bf16_f32 v44, v56, v57
    v_mfma_f32_16x16x32_bf16 v[76:79], a[188:191], v[216:219], v[76:79]
    ds_read_b128 a[236:239], v2 offset:16384
    v_cvt_pk_bf16_f32 v45, v58, v59
    v_mfma_f32_16x16x32_bf16 v[76:79], a[184:187], v[200:203], v[76:79]
    v_cvt_pk_bf16_f32 v46, v60, v61
    v_cvt_pk_bf16_f32 v47, v62, v63
    v_mfma_f32_16x16x32_bf16 v[92:95], a[184:187], v[204:207], v[92:95]
    buffer_store_dwordx2 v[174:175], v11, s[12:15], s34 offen offset:1408 sc1
    v_mfma_f32_16x16x32_bf16 v[92:95], a[188:191], v[220:223], v[92:95]
    ds_read_b128 a[240:243], v2 offset:17408
    v_max3_f32 v14, v64, v65, v66
    v_mfma_f32_16x16x32_bf16 v[88:91], a[164:167], v[220:223], v[88:91]
    ds_read_b128 a[244:247], v2 offset:18432
    v_max3_f32 v14, v14, v67, v68
    v_mfma_f32_16x16x32_bf16 v[88:91], a[160:163], v[204:207], v[88:91]
    v_max3_f32 v14, v14, v69, v70
    v_max3_f32 v14, v14, v71, v72
    v_mfma_f32_16x16x32_bf16 v[84:87], a[136:139], v[204:207], v[84:87]
    ds_read_b128 a[248:251], v2 offset:19456
    v_max3_f32 v14, v14, v73, v74
    v_mfma_f32_16x16x32_bf16 v[84:87], a[140:143], v[220:223], v[84:87]
    v_max3_f32 v14, v14, v75, v76
    v_max3_f32 v14, v14, v77, v78
    v_mfma_f32_16x16x32_bf16 v[80:83], a[116:119], v[220:223], v[80:83]
    v_max_f32 v14, v14, v79
    v_mfma_f32_16x16x32_bf16 v[80:83], a[112:115], v[204:207], v[80:83]
    v_mfma_f32_16x16x32_bf16 v[104:107], a[144:147], a[204:207], 0
    v_mfma_f32_16x16x32_bf16 v[104:107], a[148:151], a[208:211], v[104:107]
    v_mfma_f32_16x16x32_bf16 v[104:107], a[152:155], a[212:215], v[104:107]
    v_max3_f32 v15, v80, v81, v82
    v_max3_f32 v15, v15, v83, v84
    v_mfma_f32_16x16x32_bf16 v[104:107], a[156:159], a[216:219], v[104:107]
    v_max3_f32 v15, v15, v85, v86
    v_max3_f32 v15, v15, v87, v88
    v_mfma_f32_16x16x32_bf16 v[104:107], a[160:163], a[220:223], v[104:107]
    buffer_store_dwordx2 v[176:177], v11, s[12:15], s36 offen offset:256 sc1
    v_mfma_f32_16x16x32_bf16 v[104:107], a[164:167], a[224:227], v[104:107]
    v_max3_f32 v15, v15, v89, v90
    v_max3_f32 v15, v15, v91, v92
    v_mfma_f32_16x16x32_bf16 v[108:111], a[188:191], a[224:227], 0
    v_max3_f32 v15, v15, v93, v94
    v_max_f32 v15, v15, v95
    v_mfma_f32_16x16x32_bf16 v[108:111], a[184:187], a[220:223], v[108:111]
    v_mfma_f32_16x16x32_bf16 v[108:111], a[180:183], a[216:219], v[108:111]
    v_cvt_pk_bf16_f32 v132, v104, v105
    v_cvt_pk_bf16_f32 v133, v106, v107
    v_mfma_f32_16x16x32_bf16 v[108:111], a[176:179], a[212:215], v[108:111]
    v_permlane16_swap_b32 v14, v15
    v_mfma_f32_16x16x32_bf16 v[108:111], a[172:175], a[208:211], v[108:111]
    ds_read_b128 a[192:195], v2 offset:20480
    v_max_f32 v14, v14, v15
    v_mfma_f32_16x16x32_bf16 v[108:111], a[168:171], a[204:207], v[108:111]
    s_waitcnt lgkmcnt(1)
    v_mov_b32 v15, v14
    v_mfma_f32_16x16x32_bf16 v[124:127], a[168:171], a[228:231], 0
    ds_read_b128 a[196:199], v2 offset:21504
    v_mfma_f32_16x16x32_bf16 v[124:127], a[172:175], a[232:235], v[124:127]
    v_permlane32_swap_b32 v14, v15
    v_mfma_f32_16x16x32_bf16 v[124:127], a[176:179], a[236:239], v[124:127]
    ds_read_b128 a[200:203], v2 offset:22528
    v_cvt_pk_bf16_f32 v134, v108, v109
    v_mfma_f32_16x16x32_bf16 v[124:127], a[180:183], a[240:243], v[124:127]
    buffer_store_dwordx2 v[178:179], v11, s[12:15], s36 offen offset:640 sc1
    v_mfma_f32_16x16x32_bf16 v[124:127], a[184:187], a[244:247], v[124:127]
    buffer_load_dwordx4 a[72:75], v9, s[8:11], s30 offen offset:0 nt
    v_cvt_pk_bf16_f32 v135, v110, v111
    v_mfma_f32_16x16x32_bf16 v[124:127], a[188:191], a[248:251], v[124:127]
    buffer_load_dwordx4 a[76:79], v10, s[8:11], s30 offen offset:0 nt
    v_max_f32 v14, v14, v15
    v_mfma_f32_16x16x32_bf16 v[120:123], a[164:167], a[248:251], 0
    ds_read_b128 a[204:207], v2 offset:23552
    v_mov_b32 v15, v14
    v_mfma_f32_16x16x32_bf16 v[120:123], a[160:163], a[244:247], v[120:123]
    ds_read_b128 a[208:211], v2 offset:24576
    v_mfma_f32_16x16x32_bf16 v[120:123], a[156:159], a[240:243], v[120:123]
    ds_read_b128 a[212:215], v2 offset:25600
    v_cvt_pk_bf16_f32 v142, v124, v125
    v_mfma_f32_16x16x32_bf16 v[120:123], a[152:155], a[236:239], v[120:123]
    v_cvt_pk_bf16_f32 v143, v126, v127
    v_mfma_f32_16x16x32_bf16 v[120:123], a[148:151], a[232:235], v[120:123]
    v_permlane16_swap_b32 v14, v15
    v_mfma_f32_16x16x32_bf16 v[120:123], a[144:147], a[228:231], v[120:123]
    v_sub_f32 v64, v64, v14
    v_sub_f32 v65, v65, v14
    v_mfma_f32_16x16x32_bf16 v[116:119], a[120:123], a[228:231], 0
    v_sub_f32 v80, v80, v15
    v_sub_f32 v81, v81, v15
    v_mfma_f32_16x16x32_bf16 v[116:119], a[124:127], a[232:235], v[116:119]
    v_exp_f32 v64, v64
    v_mfma_f32_16x16x32_bf16 v[116:119], a[128:131], a[236:239], v[116:119]
    v_cvt_pk_bf16_f32 v140, v120, v121
    v_cvt_pk_bf16_f32 v141, v122, v123
    v_mfma_f32_16x16x32_bf16 v[116:119], a[132:135], a[240:243], v[116:119]
    buffer_store_dwordx2 v[180:181], v11, s[12:15], s36 offen offset:1024 sc1
    v_mfma_f32_16x16x32_bf16 v[116:119], a[136:139], a[244:247], v[116:119]
    v_exp_f32 v65, v65
    v_mfma_f32_16x16x32_bf16 v[116:119], a[140:143], a[248:251], v[116:119]
    v_sub_f32 v66, v66, v14
    v_sub_f32 v82, v82, v15
    v_mfma_f32_16x16x32_bf16 v[112:115], a[116:119], a[248:251], 0
    v_exp_f32 v80, v80
    v_mfma_f32_16x16x32_bf16 v[112:115], a[112:115], a[244:247], v[112:115]
    v_exp_f32 v81, v81
    v_mfma_f32_16x16x32_bf16 v[112:115], a[108:111], a[240:243], v[112:115]
    v_cvt_pk_bf16_f32 v138, v116, v117
    v_cvt_pk_bf16_f32 v139, v118, v119
    v_mfma_f32_16x16x32_bf16 v[112:115], a[104:107], a[236:239], v[112:115]
    v_exp_f32 v66, v66
    v_mfma_f32_16x16x32_bf16 v[112:115], a[100:103], a[232:235], v[112:115]
    ds_read_b128 a[216:219], v2 offset:26624
    v_sub_f32 v67, v67, v14
    v_mfma_f32_16x16x32_bf16 v[112:115], a[96:99], a[228:231], v[112:115]
    s_waitcnt lgkmcnt(1)
    v_exp_f32 v82, v82
    v_mfma_f32_16x16x32_bf16 v[96:99], a[96:99], a[192:195], 0
    ds_read_b128 a[220:223], v2 offset:27648
    v_sub_f32 v83, v83, v15
    v_mfma_f32_16x16x32_bf16 v[96:99], a[100:103], a[196:199], v[96:99]
    v_exp_f32 v67, v67
    v_mfma_f32_16x16x32_bf16 v[96:99], a[104:107], a[200:203], v[96:99]
    ds_read_b128 a[224:227], v2 offset:28672
    v_cvt_pk_bf16_f32 v136, v112, v113
    v_mfma_f32_16x16x32_bf16 v[96:99], a[108:111], a[204:207], v[96:99]
    buffer_store_dwordx2 v[182:183], v11, s[12:15], s36 offen offset:1408 sc1
    v_mfma_f32_16x16x32_bf16 v[96:99], a[112:115], a[208:211], v[96:99]
    ds_read_b128 a[228:231], v2 offset:29696
    v_cvt_pk_bf16_f32 v137, v114, v115
    v_mfma_f32_16x16x32_bf16 v[96:99], a[116:119], a[212:215], v[96:99]
    v_sub_f32 v68, v68, v14
    v_sub_f32 v84, v84, v15
    v_mfma_f32_16x16x32_bf16 v[100:103], a[140:143], a[212:215], 0
    ds_read_b128 a[232:235], v2 offset:30720
    v_add_f32 v22, v64, v65
    v_mfma_f32_16x16x32_bf16 v[100:103], a[136:139], a[208:211], v[100:103]
    v_exp_f32 v83, v83
    v_mfma_f32_16x16x32_bf16 v[100:103], a[132:135], a[204:207], v[100:103]
    ds_read_b128 a[236:239], v2 offset:31744
    v_cvt_pk_bf16_f32 v144, v96, v97
    v_mfma_f32_16x16x32_bf16 v[100:103], a[128:131], a[200:203], v[100:103]
    v_cvt_pk_bf16_f32 v145, v98, v99
    v_sub_f32 v69, v69, v14
    v_mfma_f32_16x16x32_bf16 v[100:103], a[124:127], a[196:199], v[100:103]
    v_exp_f32 v68, v68
    v_mfma_f32_16x16x32_bf16 v[100:103], a[120:123], a[192:195], v[100:103]
    v_add_f32 v23, v80, v81
    v_sub_f32 v85, v85, v15
    v_mfma_f32_16x16x32_bf16 v[104:107], a[144:147], a[192:195], 0
    v_exp_f32 v84, v84
    v_mfma_f32_16x16x32_bf16 v[104:107], a[148:151], a[196:199], v[104:107]
    v_add_f32 v22, v22, v66
    v_sub_f32 v70, v70, v14
    v_mfma_f32_16x16x32_bf16 v[104:107], a[152:155], a[200:203], v[104:107]
    buffer_store_dwordx2 v[184:185], v11, s[12:15], s38 offen offset:256 sc1
    v_mfma_f32_16x16x32_bf16 v[104:107], a[156:159], a[204:207], v[104:107]
    v_cvt_pk_bf16_f32 v146, v100, v101
    v_cvt_pk_bf16_f32 v147, v102, v103
    v_mfma_f32_16x16x32_bf16 v[104:107], a[160:163], a[208:211], v[104:107]
    v_exp_f32 v69, v69
    v_mfma_f32_16x16x32_bf16 v[104:107], a[164:167], a[212:215], v[104:107]
    v_add_f32 v23, v23, v82
    v_sub_f32 v86, v86, v15
    v_mfma_f32_16x16x32_bf16 v[108:111], a[188:191], a[212:215], 0
    v_exp_f32 v85, v85
    v_mfma_f32_16x16x32_bf16 v[108:111], a[184:187], a[208:211], v[108:111]
    v_add_f32 v22, v22, v67
    v_sub_f32 v71, v71, v14
    v_mfma_f32_16x16x32_bf16 v[108:111], a[180:183], a[204:207], v[108:111]
    v_cvt_pk_bf16_f32 v148, v104, v105
    v_cvt_pk_bf16_f32 v149, v106, v107
    v_mfma_f32_16x16x32_bf16 v[108:111], a[176:179], a[200:203], v[108:111]
    v_exp_f32 v70, v70
    v_mfma_f32_16x16x32_bf16 v[108:111], a[172:175], a[196:199], v[108:111]
    v_add_f32 v23, v23, v83
    v_sub_f32 v87, v87, v15
    v_mfma_f32_16x16x32_bf16 v[108:111], a[168:171], a[192:195], v[108:111]
    s_waitcnt lgkmcnt(0)
    v_exp_f32 v86, v86
    v_mfma_f32_16x16x32_bf16 v[124:127], a[168:171], a[216:219], 0
    v_add_f32 v22, v22, v68
    v_sub_f32 v72, v72, v14
    v_mfma_f32_16x16x32_bf16 v[124:127], a[172:175], a[220:223], v[124:127]
    v_exp_f32 v71, v71
    v_mfma_f32_16x16x32_bf16 v[124:127], a[176:179], a[224:227], v[124:127]
    buffer_store_dwordx2 v[186:187], v11, s[12:15], s38 offen offset:640 sc1
    v_mfma_f32_16x16x32_bf16 v[124:127], a[180:183], a[228:231], v[124:127]
    v_cvt_pk_bf16_f32 v150, v108, v109
    v_cvt_pk_bf16_f32 v151, v110, v111
    v_mfma_f32_16x16x32_bf16 v[124:127], a[184:187], a[232:235], v[124:127]
    v_add_f32 v23, v23, v84
    v_sub_f32 v88, v88, v15
    v_mfma_f32_16x16x32_bf16 v[124:127], a[188:191], a[236:239], v[124:127]
    v_exp_f32 v87, v87
    v_mfma_f32_16x16x32_bf16 v[120:123], a[164:167], a[236:239], 0
    v_add_f32 v22, v22, v69
    v_sub_f32 v73, v73, v14
    v_mfma_f32_16x16x32_bf16 v[120:123], a[160:163], a[232:235], v[120:123]
    v_exp_f32 v72, v72
    v_mfma_f32_16x16x32_bf16 v[120:123], a[156:159], a[228:231], v[120:123]
    v_cvt_pk_bf16_f32 v158, v124, v125
    v_cvt_pk_bf16_f32 v159, v126, v127
    v_mfma_f32_16x16x32_bf16 v[120:123], a[152:155], a[224:227], v[120:123]
    v_add_f32 v23, v23, v85
    v_sub_f32 v89, v89, v15
    v_mfma_f32_16x16x32_bf16 v[120:123], a[148:151], a[220:223], v[120:123]
    v_exp_f32 v88, v88
    v_mfma_f32_16x16x32_bf16 v[120:123], a[144:147], a[216:219], v[120:123]
    v_add_f32 v22, v22, v70
    v_sub_f32 v74, v74, v14
    v_mfma_f32_16x16x32_bf16 v[116:119], a[120:123], a[216:219], 0
    buffer_load_dwordx4 a[80:83], v9, s[8:11], s30 offen offset:128 nt
    v_add_f32 v23, v23, v86
    v_mfma_f32_16x16x32_bf16 v[116:119], a[124:127], a[220:223], v[116:119]
    buffer_load_dwordx4 a[84:87], v10, s[8:11], s30 offen offset:128 nt
    v_sub_f32 v90, v90, v15
    v_mfma_f32_16x16x32_bf16 v[116:119], a[128:131], a[224:227], v[116:119]
    buffer_store_dwordx2 v[188:189], v11, s[12:15], s38 offen offset:1024 sc1
    v_mfma_f32_16x16x32_bf16 v[116:119], a[132:135], a[228:231], v[116:119]
    ds_read_b128 a[240:243], v2 offset:32768
    v_cvt_pk_bf16_f32 v156, v120, v121
    v_mfma_f32_16x16x32_bf16 v[116:119], a[136:139], a[232:235], v[116:119]
    ds_read_b128 a[244:247], v2 offset:33792
    v_cvt_pk_bf16_f32 v157, v122, v123
    v_mfma_f32_16x16x32_bf16 v[116:119], a[140:143], a[236:239], v[116:119]
    v_exp_f32 v73, v73
    v_mfma_f32_16x16x32_bf16 v[112:115], a[116:119], a[236:239], 0
    ds_read_b128 a[248:251], v2 offset:34816
    v_add_f32 v22, v22, v71
    v_mfma_f32_16x16x32_bf16 v[112:115], a[112:115], a[232:235], v[112:115]
    v_exp_f32 v89, v89
    v_mfma_f32_16x16x32_bf16 v[112:115], a[108:111], a[228:231], v[112:115]
    ds_read_b128 a[192:195], v2 offset:35840
    v_cvt_pk_bf16_f32 v154, v116, v117
    v_mfma_f32_16x16x32_bf16 v[112:115], a[104:107], a[224:227], v[112:115]
    v_cvt_pk_bf16_f32 v155, v118, v119
    v_sub_f32 v75, v75, v14
    v_mfma_f32_16x16x32_bf16 v[112:115], a[100:103], a[220:223], v[112:115]
    ds_read_b128 a[196:199], v2 offset:36864
    v_add_f32 v23, v23, v87
    v_mfma_f32_16x16x32_bf16 v[112:115], a[96:99], a[216:219], v[112:115]
    v_exp_f32 v74, v74
    v_mfma_f32_16x16x32_bf16 v[192:195], v[32:35], v[128:131], 0
    ds_read_b128 a[200:203], v2 offset:37888
    v_sub_f32 v91, v91, v15
    v_mfma_f32_16x16x32_bf16 v[192:195], v[36:39], v[132:135], v[192:195]
    buffer_store_dwordx2 v[190:191], v11, s[12:15], s38 offen offset:1408 sc1
    v_mfma_f32_16x16x32_bf16 v[196:199], v[36:39], v[140:143], 0
    v_cvt_pk_bf16_f32 v152, v112, v113
    v_cvt_pk_bf16_f32 v153, v114, v115
    v_mfma_f32_16x16x32_bf16 v[196:199], v[32:35], v[136:139], v[196:199]
    v_exp_f32 v90, v90
    v_mfma_f32_16x16x32_bf16 v[200:203], v[32:35], v[144:147], 0
    v_add_f32 v22, v22, v72
    v_sub_f32 v76, v76, v14
    v_mfma_f32_16x16x32_bf16 v[200:203], v[36:39], v[148:151], v[200:203]
    v_exp_f32 v75, v75
    v_mfma_f32_16x16x32_bf16 v[204:207], v[36:39], v[156:159], 0
    v_cvt_pk_bf16_f32 v224, v192, v196
    v_cvt_pk_bf16_f32 v226, v193, v197
    v_mfma_f32_16x16x32_bf16 v[204:207], v[32:35], v[152:155], v[204:207]
    v_cvt_pk_bf16_f32 v228, v194, v198
    v_cvt_pk_bf16_f32 v230, v195, v199
    v_mfma_f32_16x16x32_bf16 v[220:223], v[40:43], v[152:155], 0
    v_add_f32 v23, v23, v88
    v_sub_f32 v92, v92, v15
    v_mfma_f32_16x16x32_bf16 v[220:223], v[44:47], v[156:159], v[220:223]
    v_exp_f32 v91, v91
    v_mfma_f32_16x16x32_bf16 v[216:219], v[44:47], v[148:151], 0
    v_cvt_pk_bf16_f32 v225, v200, v204
    v_cvt_pk_bf16_f32 v227, v201, v205
    v_mfma_f32_16x16x32_bf16 v[216:219], v[40:43], v[144:147], v[216:219]
    v_cvt_pk_bf16_f32 v229, v202, v206
    v_cvt_pk_bf16_f32 v231, v203, v207
    v_mfma_f32_16x16x32_bf16 v[212:215], v[40:43], v[136:139], 0
    v_add_f32 v22, v22, v73
    v_sub_f32 v77, v77, v14
    v_mfma_f32_16x16x32_bf16 v[212:215], v[44:47], v[140:143], v[212:215]
    v_exp_f32 v76, v76
    v_mfma_f32_16x16x32_bf16 v[208:211], v[44:47], v[132:135], 0
    ds_read_b128 a[204:207], v2 offset:38912
    v_add_f32 v23, v23, v89
    v_mfma_f32_16x16x32_bf16 v[208:211], v[40:43], v[128:131], v[208:211]
    s_waitcnt lgkmcnt(1)
    v_exp_f32 v92, v92
    v_mfma_f32_16x16x32_bf16 v[96:99], a[96:99], a[240:243], 0
    ds_read_b128 a[208:211], v2 offset:39936
    v_sub_f32 v93, v93, v15
    v_mfma_f32_16x16x32_bf16 v[96:99], a[100:103], a[244:247], v[96:99]
    v_add_f32 v22, v22, v74
    v_sub_f32 v78, v78, v14
    v_mfma_f32_16x16x32_bf16 v[96:99], a[104:107], a[248:251], v[96:99]
    ds_read_b128 a[212:215], v2 offset:40960
    v_add_f32 v23, v23, v90
    v_mfma_f32_16x16x32_bf16 v[96:99], a[108:111], a[192:195], v[96:99]
    v_exp_f32 v77, v77
    v_mfma_f32_16x16x32_bf16 v[96:99], a[112:115], a[196:199], v[96:99]
    ds_read_b128 a[216:219], v2 offset:41984
    v_sub_f32 v94, v94, v15
    v_mfma_f32_16x16x32_bf16 v[96:99], a[116:119], a[200:203], v[96:99]
    v_exp_f32 v93, v93
    v_mfma_f32_16x16x32_bf16 v[100:103], a[140:143], a[200:203], 0
    ds_read_b128 a[220:223], v2 offset:43008
    v_add_f32 v22, v22, v75
    v_mfma_f32_16x16x32_bf16 v[100:103], a[136:139], a[196:199], v[100:103]
    v_exp_f32 v78, v78
    v_mfma_f32_16x16x32_bf16 v[100:103], a[132:135], a[192:195], v[100:103]
    ds_read_b128 a[224:227], v2 offset:44032
    v_sub_f32 v79, v79, v14
    v_mfma_f32_16x16x32_bf16 v[100:103], a[128:131], a[248:251], v[100:103]
    buffer_store_dwordx2 v[224:225], v11, s[12:15], s33 offen offset:0 sc1
    v_mfma_f32_16x16x32_bf16 v[100:103], a[124:127], a[244:247], v[100:103]
    v_add_f32 v23, v23, v91
    v_sub_f32 v95, v95, v15
    v_mfma_f32_16x16x32_bf16 v[100:103], a[120:123], a[240:243], v[100:103]
    v_exp_f32 v94, v94
    v_mfma_f32_16x16x32_bf16 v[104:107], a[144:147], a[240:243], 0
    v_add_f32 v22, v22, v76
    v_add_f32 v23, v23, v92
    v_mfma_f32_16x16x32_bf16 v[104:107], a[148:151], a[244:247], v[104:107]
    v_exp_f32 v79, v79
    v_mfma_f32_16x16x32_bf16 v[104:107], a[152:155], a[248:251], v[104:107]
    v_exp_f32 v95, v95
    v_mfma_f32_16x16x32_bf16 v[104:107], a[156:159], a[192:195], v[104:107]
    v_add_f32 v22, v22, v77
    v_add_f32 v23, v23, v93
    v_mfma_f32_16x16x32_bf16 v[104:107], a[160:163], a[196:199], v[104:107]
    buffer_store_dwordx2 v[226:227], v11, s[12:15], s33 offen offset:384 sc1
    v_mfma_f32_16x16x32_bf16 v[104:107], a[164:167], a[200:203], v[104:107]
    v_add_f32 v22, v22, v78
    v_add_f32 v23, v23, v94
    v_mfma_f32_16x16x32_bf16 v[108:111], a[188:191], a[200:203], 0
    v_add_f32 v22, v22, v79
    v_add_f32 v23, v23, v95
    v_mfma_f32_16x16x32_bf16 v[108:111], a[184:187], a[196:199], v[108:111]
    v_cvt_pk_bf16_f32 v232, v208, v212
    v_cvt_pk_bf16_f32 v233, v216, v220
    v_mfma_f32_16x16x32_bf16 v[108:111], a[180:183], a[192:195], v[108:111]
    v_permlane16_swap_b32 v22, v23
    v_mfma_f32_16x16x32_bf16 v[108:111], a[176:179], a[248:251], v[108:111]
    v_add_f32 v22, v22, v23
    v_mov_b32 v23, v22
    v_mfma_f32_16x16x32_bf16 v[108:111], a[172:175], a[244:247], v[108:111]
    v_cvt_pk_bf16_f32 v234, v209, v213
    v_cvt_pk_bf16_f32 v235, v217, v221
    v_mfma_f32_16x16x32_bf16 v[108:111], a[168:171], a[240:243], v[108:111]
    s_waitcnt lgkmcnt(0)
    buffer_store_dwordx2 v[228:229], v11, s[12:15], s33 offen offset:768 sc1
    v_mfma_f32_16x16x32_bf16 v[124:127], a[168:171], a[204:207], 0
    v_permlane32_swap_b32 v22, v23
    v_mfma_f32_16x16x32_bf16 v[124:127], a[172:175], a[208:211], v[124:127]
    v_add_f32 v22, v22, v23
    v_cvt_pk_bf16_f32 v236, v210, v214
    v_mfma_f32_16x16x32_bf16 v[124:127], a[176:179], a[212:215], v[124:127]
    v_rcp_f32 v22, v22
    v_mfma_f32_16x16x32_bf16 v[124:127], a[180:183], a[216:219], v[124:127]
    v_mov_b32 v23, v22
    v_cvt_pk_bf16_f32 v237, v218, v222
    v_mfma_f32_16x16x32_bf16 v[124:127], a[184:187], a[220:223], v[124:127]
    buffer_load_dwordx4 a[88:91], v9, s[8:11], s30 offen offset:256 nt
    v_cvt_pk_bf16_f32 v238, v211, v215
    v_mfma_f32_16x16x32_bf16 v[124:127], a[188:191], a[224:227], v[124:127]
    buffer_load_dwordx4 a[92:95], v10, s[8:11], s30 offen offset:256 nt
    v_cvt_pk_bf16_f32 v239, v219, v223
    v_mfma_f32_16x16x32_bf16 v[120:123], a[164:167], a[224:227], 0
    s_add_u32 s30, s16, 10616832
    buffer_store_dwordx2 v[230:231], v11, s[12:15], s33 offen offset:1152 sc1
    v_mfma_f32_16x16x32_bf16 v[120:123], a[160:163], a[220:223], v[120:123]
    s_add_u32 s16, s16, 6291456
    v_permlane16_swap_b32 v22, v23
    v_mfma_f32_16x16x32_bf16 v[120:123], a[156:159], a[216:219], v[120:123]
    s_add_u32 s32, s16, 0
    v_mul_f32 v64, v64, v22
    v_mul_f32 v65, v65, v22
    v_mfma_f32_16x16x32_bf16 v[120:123], a[152:155], a[212:215], v[120:123]
    s_add_u32 s34, s16, 393216
    v_mul_f32 v66, v66, v22
    v_mul_f32 v67, v67, v22
    v_mfma_f32_16x16x32_bf16 v[120:123], a[148:151], a[208:211], v[120:123]
    s_add_u32 s36, s16, 786432
    v_mul_f32 v68, v68, v22
    v_mul_f32 v69, v69, v22
    v_mfma_f32_16x16x32_bf16 v[120:123], a[144:147], a[204:207], v[120:123]
    s_add_u32 s38, s16, 1179648
    v_mul_f32 v70, v70, v22
    v_mul_f32 v71, v71, v22
    v_mfma_f32_16x16x32_bf16 v[116:119], a[120:123], a[204:207], 0
    v_cvt_pk_bf16_f32 v48, v64, v65
    v_cvt_pk_bf16_f32 v49, v66, v67
    v_mfma_f32_16x16x32_bf16 v[116:119], a[124:127], a[208:211], v[116:119]
    buffer_store_dwordx2 v[232:233], v11, s[12:15], s35 offen offset:0 sc1
    v_mfma_f32_16x16x32_bf16 v[116:119], a[128:131], a[212:215], v[116:119]
    ds_read_b128 a[228:231], v2 offset:45056
    v_cvt_pk_bf16_f32 v50, v68, v69
    v_mfma_f32_16x16x32_bf16 v[116:119], a[132:135], a[216:219], v[116:119]
    v_cvt_pk_bf16_f32 v51, v70, v71
    v_mul_f32 v72, v72, v22
    v_mfma_f32_16x16x32_bf16 v[116:119], a[136:139], a[220:223], v[116:119]
    ds_read_b128 a[232:235], v2 offset:46080
    v_mul_f32 v73, v73, v22
    v_mfma_f32_16x16x32_bf16 v[116:119], a[140:143], a[224:227], v[116:119]
    v_mul_f32 v74, v74, v22
    v_mul_f32 v75, v75, v22
    v_mfma_f32_16x16x32_bf16 v[112:115], a[116:119], a[224:227], 0
    ds_read_b128 a[236:239], v2 offset:47104
    v_mul_f32 v76, v76, v22
    v_mfma_f32_16x16x32_bf16 v[112:115], a[112:115], a[220:223], v[112:115]
    v_mul_f32 v77, v77, v22
    v_mul_f32 v78, v78, v22
    v_mfma_f32_16x16x32_bf16 v[112:115], a[108:111], a[216:219], v[112:115]
    buffer_store_dwordx2 v[234:235], v11, s[12:15], s35 offen offset:384 sc1
    v_mfma_f32_16x16x32_bf16 v[112:115], a[104:107], a[212:215], v[112:115]
    ds_read_b128 a[240:243], v2 offset:48128
    v_mul_f32 v79, v79, v22
    v_mfma_f32_16x16x32_bf16 v[112:115], a[100:103], a[208:211], v[112:115]
    ds_read_b128 a[244:247], v2 offset:49152
    v_cvt_pk_bf16_f32 v52, v72, v73
    v_mfma_f32_16x16x32_bf16 v[112:115], a[96:99], a[204:207], v[112:115]
    v_cvt_pk_bf16_f32 v53, v74, v75
    v_cvt_pk_bf16_f32 v54, v76, v77
    v_mfma_f32_16x16x32_bf16 v[64:67], v[48:51], v[128:131], 0
    ds_read_b128 a[248:251], v2 offset:50176
    v_cvt_pk_bf16_f32 v55, v78, v79
    s_nop 1
    v_mfma_f32_16x16x32_bf16 v[64:67], v[52:55], v[132:135], v[64:67]
    v_mul_f32 v80, v80, v23
    v_mul_f32 v81, v81, v23
    v_mfma_f32_16x16x32_bf16 v[68:71], v[52:55], v[140:143], 0
    v_mul_f32 v82, v82, v23
    v_mul_f32 v83, v83, v23
    v_mfma_f32_16x16x32_bf16 v[68:71], v[48:51], v[136:139], v[68:71]
    buffer_store_dwordx2 v[236:237], v11, s[12:15], s35 offen offset:768 sc1
    v_mfma_f32_16x16x32_bf16 v[72:75], v[48:51], v[144:147], 0
    v_mul_f32 v84, v84, v23
    v_mul_f32 v85, v85, v23
    v_mfma_f32_16x16x32_bf16 v[72:75], v[52:55], v[148:151], v[72:75]
    v_mul_f32 v86, v86, v23
    v_mul_f32 v87, v87, v23
    v_mfma_f32_16x16x32_bf16 v[76:79], v[52:55], v[156:159], 0
    v_cvt_pk_bf16_f32 v56, v80, v81
    v_cvt_pk_bf16_f32 v57, v82, v83
    v_mfma_f32_16x16x32_bf16 v[76:79], v[48:51], v[152:155], v[76:79]
    v_cvt_pk_bf16_f32 v58, v84, v85
    v_cvt_pk_bf16_f32 v59, v86, v87
    v_mul_f32 v92, v92, v23
    v_mul_f32 v93, v93, v23
    v_cvt_pk_bf16_f32 v62, v92, v93
    v_mul_f32 v94, v94, v23
    v_mul_f32 v95, v95, v23
    v_cvt_pk_bf16_f32 v63, v94, v95
    v_mfma_f32_16x16x32_bf16 v[92:95], v[56:59], v[152:155], 0
    v_mul_f32 v88, v88, v23
    v_mul_f32 v89, v89, v23
    v_cvt_pk_bf16_f32 v60, v88, v89
    v_mul_f32 v90, v90, v23
    v_mul_f32 v91, v91, v23
    v_cvt_pk_bf16_f32 v61, v90, v91
    s_nop 1
    v_mfma_f32_16x16x32_bf16 v[92:95], v[60:63], v[156:159], v[92:95]
    v_cvt_pk_bf16_f32 v160, v96, v97
    v_cvt_pk_bf16_f32 v161, v98, v99
    v_mfma_f32_16x16x32_bf16 v[88:91], v[60:63], v[148:151], 0
    buffer_store_dwordx2 v[238:239], v11, s[12:15], s35 offen offset:1152 sc1
    v_mfma_f32_16x16x32_bf16 v[88:91], v[56:59], v[144:147], v[88:91]
    v_cvt_pk_bf16_f32 v162, v100, v101
    v_cvt_pk_bf16_f32 v163, v102, v103
    v_mfma_f32_16x16x32_bf16 v[84:87], v[56:59], v[136:139], 0
    v_cvt_pk_bf16_f32 v164, v104, v105
    v_cvt_pk_bf16_f32 v165, v106, v107
    v_mfma_f32_16x16x32_bf16 v[84:87], v[60:63], v[140:143], v[84:87]
    v_cvt_pk_bf16_f32 v240, v64, v68
    v_cvt_pk_bf16_f32 v241, v72, v76
    v_mfma_f32_16x16x32_bf16 v[80:83], v[60:63], v[132:135], 0
    ds_read_b128 a[192:195], v2 offset:51200
    v_cvt_pk_bf16_f32 v166, v108, v109
    v_mfma_f32_16x16x32_bf16 v[80:83], v[56:59], v[128:131], v[80:83]
    s_waitcnt lgkmcnt(1)
    v_cvt_pk_bf16_f32 v167, v110, v111
    v_cvt_pk_bf16_f32 v242, v65, v69
    v_mfma_f32_16x16x32_bf16 v[96:99], a[96:99], a[228:231], 0
    ds_read_b128 a[196:199], v2 offset:52224
    v_cvt_pk_bf16_f32 v243, v73, v77
    v_mfma_f32_16x16x32_bf16 v[96:99], a[100:103], a[232:235], v[96:99]
    v_cvt_pk_bf16_f32 v174, v124, v125
    v_cvt_pk_bf16_f32 v175, v126, v127
    v_mfma_f32_16x16x32_bf16 v[96:99], a[104:107], a[236:239], v[96:99]
    ds_read_b128 a[200:203], v2 offset:53248
    v_cvt_pk_bf16_f32 v172, v120, v121
    v_mfma_f32_16x16x32_bf16 v[96:99], a[108:111], a[240:243], v[96:99]
    v_cvt_pk_bf16_f32 v173, v122, v123
    v_cvt_pk_bf16_f32 v244, v66, v70
    v_mfma_f32_16x16x32_bf16 v[96:99], a[112:115], a[244:247], v[96:99]
    ds_read_b128 a[204:207], v2 offset:54272
    v_cvt_pk_bf16_f32 v245, v74, v78
    v_mfma_f32_16x16x32_bf16 v[96:99], a[116:119], a[248:251], v[96:99]
    v_cvt_pk_bf16_f32 v170, v116, v117
    v_cvt_pk_bf16_f32 v171, v118, v119
    v_mfma_f32_16x16x32_bf16 v[100:103], a[140:143], a[248:251], 0
    ds_read_b128 a[208:211], v2 offset:55296
    v_cvt_pk_bf16_f32 v246, v67, v71
    v_mfma_f32_16x16x32_bf16 v[100:103], a[136:139], a[244:247], v[100:103]
    v_cvt_pk_bf16_f32 v247, v75, v79
    v_cvt_pk_bf16_f32 v168, v112, v113
    v_mfma_f32_16x16x32_bf16 v[100:103], a[132:135], a[240:243], v[100:103]
    buffer_store_dwordx2 v[240:241], v11, s[12:15], s37 offen offset:0 sc1
    v_mfma_f32_16x16x32_bf16 v[100:103], a[128:131], a[236:239], v[100:103]
    ds_read_b128 a[212:215], v2 offset:56320
    v_cvt_pk_bf16_f32 v169, v114, v115
    v_mfma_f32_16x16x32_bf16 v[100:103], a[124:127], a[232:235], v[100:103]
    s_waitcnt vmcnt(60)
    ds_write_b32 v16, a24 offset:0
    v_mfma_f32_16x16x32_bf16 v[100:103], a[120:123], a[228:231], v[100:103]
    ds_write_b32 v16, a25 offset:4
    v_mfma_f32_16x16x32_bf16 v[104:107], a[144:147], a[228:231], 0
    ds_write_b32 v16, a26 offset:1024
    v_mfma_f32_16x16x32_bf16 v[104:107], a[148:151], a[232:235], v[104:107]
    ds_write_b32 v16, a27 offset:1028
    v_mfma_f32_16x16x32_bf16 v[104:107], a[152:155], a[236:239], v[104:107]
    ds_write_b32 v16, a28 offset:512
    v_mfma_f32_16x16x32_bf16 v[104:107], a[156:159], a[240:243], v[104:107]
    ds_write_b32 v16, a29 offset:516
    v_mfma_f32_16x16x32_bf16 v[104:107], a[160:163], a[244:247], v[104:107]
    buffer_store_dwordx2 v[242:243], v11, s[12:15], s37 offen offset:384 sc1
    v_mfma_f32_16x16x32_bf16 v[104:107], a[164:167], a[248:251], v[104:107]
    ds_write_b32 v16, a30 offset:1536
    v_mfma_f32_16x16x32_bf16 v[108:111], a[188:191], a[248:251], 0
    ds_write_b32 v16, a31 offset:1540
    v_mfma_f32_16x16x32_bf16 v[108:111], a[184:187], a[244:247], v[108:111]
    ds_read2_b64 a[24:27], v17 offset0:0 offset1:128
    v_cvt_pk_bf16_f32 v248, v80, v84
    v_mfma_f32_16x16x32_bf16 v[108:111], a[180:183], a[240:243], v[108:111]
    ds_read2_b64 a[28:31], v18 offset0:0 offset1:128
    v_cvt_pk_bf16_f32 v249, v88, v92
    v_mfma_f32_16x16x32_bf16 v[108:111], a[176:179], a[236:239], v[108:111]
    v_cvt_pk_bf16_f32 v176, v96, v97
    v_cvt_pk_bf16_f32 v177, v98, v99
    v_mfma_f32_16x16x32_bf16 v[108:111], a[172:175], a[232:235], v[108:111]
    v_cvt_pk_bf16_f32 v178, v100, v101
    v_cvt_pk_bf16_f32 v179, v102, v103
    v_mfma_f32_16x16x32_bf16 v[108:111], a[168:171], a[228:231], v[108:111]
    s_waitcnt lgkmcnt(9)
    v_cvt_pk_bf16_f32 v180, v104, v105
    v_cvt_pk_bf16_f32 v181, v106, v107
    v_mfma_f32_16x16x32_bf16 v[124:127], a[168:171], a[192:195], 0
    buffer_store_dwordx2 v[244:245], v11, s[12:15], s37 offen offset:768 sc1
    v_mfma_f32_16x16x32_bf16 v[124:127], a[172:175], a[196:199], v[124:127]
    v_cvt_pk_bf16_f32 v250, v81, v85
    v_cvt_pk_bf16_f32 v251, v89, v93
    v_mfma_f32_16x16x32_bf16 v[124:127], a[176:179], a[200:203], v[124:127]
    v_cvt_pk_bf16_f32 v182, v108, v109
    v_cvt_pk_bf16_f32 v183, v110, v111
    v_mfma_f32_16x16x32_bf16 v[124:127], a[180:183], a[204:207], v[124:127]
    v_cvt_pk_bf16_f32 v253, v90, v94
    v_cvt_pk_bf16_f32 v255, v91, v95
    v_mfma_f32_16x16x32_bf16 v[124:127], a[184:187], a[208:211], v[124:127]
    v_cvt_pk_bf16_f32 v252, v82, v86
    v_cvt_pk_bf16_f32 v254, v83, v87
    v_mfma_f32_16x16x32_bf16 v[124:127], a[188:191], a[212:215], v[124:127]
    v_mfma_f32_16x16x32_bf16 v[120:123], a[164:167], a[212:215], 0
    s_waitcnt vmcnt(55)
    ds_write_b32 v16, a32 offset:0
    v_mfma_f32_16x16x32_bf16 v[120:123], a[160:163], a[208:211], v[120:123]
    ds_write_b32 v16, a33 offset:4
    v_mfma_f32_16x16x32_bf16 v[120:123], a[156:159], a[204:207], v[120:123]
    buffer_store_dwordx2 v[246:247], v11, s[12:15], s37 offen offset:1152 sc1
    v_mfma_f32_16x16x32_bf16 v[120:123], a[152:155], a[200:203], v[120:123]
    ds_write_b32 v16, a34 offset:1024
    v_mfma_f32_16x16x32_bf16 v[120:123], a[148:151], a[196:199], v[120:123]
    ds_write_b32 v16, a35 offset:1028
    v_mfma_f32_16x16x32_bf16 v[120:123], a[144:147], a[192:195], v[120:123]
    ds_write_b32 v16, a36 offset:512
    v_mfma_f32_16x16x32_bf16 v[116:119], a[120:123], a[192:195], 0
    ds_write_b32 v16, a37 offset:516
    v_mfma_f32_16x16x32_bf16 v[116:119], a[124:127], a[196:199], v[116:119]
    ds_write_b32 v16, a38 offset:1536
    v_mfma_f32_16x16x32_bf16 v[116:119], a[128:131], a[200:203], v[116:119]
    ds_write_b32 v16, a39 offset:1540
    v_mfma_f32_16x16x32_bf16 v[116:119], a[132:135], a[204:207], v[116:119]
    ds_read2_b64 a[32:35], v17 offset0:0 offset1:128
    v_cvt_pk_bf16_f32 v188, v120, v121
    v_mfma_f32_16x16x32_bf16 v[116:119], a[136:139], a[208:211], v[116:119]
    buffer_store_dwordx2 v[248:249], v11, s[12:15], s39 offen offset:0 sc1
    v_mfma_f32_16x16x32_bf16 v[116:119], a[140:143], a[212:215], v[116:119]
    ds_read2_b64 a[36:39], v18 offset0:0 offset1:128
    v_cvt_pk_bf16_f32 v189, v122, v123
    v_mfma_f32_16x16x32_bf16 v[112:115], a[116:119], a[212:215], 0
    v_cvt_pk_bf16_f32 v190, v124, v125
    v_cvt_pk_bf16_f32 v191, v126, v127
    v_mfma_f32_16x16x32_bf16 v[112:115], a[112:115], a[208:211], v[112:115]
    v_mfma_f32_16x16x32_bf16 v[112:115], a[108:111], a[204:207], v[112:115]
    v_cvt_pk_bf16_f32 v186, v116, v117
    v_cvt_pk_bf16_f32 v187, v118, v119
    v_mfma_f32_16x16x32_bf16 v[112:115], a[104:107], a[200:203], v[112:115]
    v_mfma_f32_16x16x32_bf16 v[112:115], a[100:103], a[196:199], v[112:115]
    v_mfma_f32_16x16x32_bf16 v[112:115], a[96:99], a[192:195], v[112:115]
    v_mfma_f32_16x16x32_bf16 v[64:67], v[32:35], v[160:163], 0
    buffer_store_dwordx2 v[250:251], v11, s[12:15], s39 offen offset:384 sc1
    v_mfma_f32_16x16x32_bf16 v[64:67], v[36:39], v[164:167], v[64:67]
    v_mfma_f32_16x16x32_bf16 v[68:71], v[36:39], v[172:175], 0
    s_waitcnt vmcnt(52)
    ds_write_b32 v16, a40 offset:0
    v_mfma_f32_16x16x32_bf16 v[68:71], v[32:35], v[168:171], v[68:71]
    ds_write_b32 v16, a41 offset:4
    v_mfma_f32_16x16x32_bf16 v[72:75], v[32:35], v[176:179], 0
    ds_write_b32 v16, a42 offset:1024
    v_mfma_f32_16x16x32_bf16 v[72:75], v[36:39], v[180:183], v[72:75]
    ds_write_b32 v16, a43 offset:1028
    v_mfma_f32_16x16x32_bf16 v[76:79], v[36:39], v[188:191], 0
    ds_read_b128 a[216:219], v2 offset:57344
    v_cvt_pk_bf16_f32 v184, v112, v113
    v_cvt_pk_bf16_f32 v185, v114, v115
    s_nop 1
    v_mfma_f32_16x16x32_bf16 v[76:79], v[32:35], v[184:187], v[76:79]
    ds_write_b32 v16, a44 offset:512
    v_mfma_f32_16x16x32_bf16 v[92:95], v[40:43], v[184:187], 0
    buffer_store_dwordx2 v[252:253], v11, s[12:15], s39 offen offset:768 sc1
    v_mfma_f32_16x16x32_bf16 v[92:95], v[44:47], v[188:191], v[92:95]
    ds_read_b128 a[220:223], v2 offset:58368
    v_cvt_pk_bf16_f32 v128, v64, v68
    v_mfma_f32_16x16x32_bf16 v[88:91], v[44:47], v[180:183], 0
    ds_read_b128 a[224:227], v2 offset:59392
    v_cvt_pk_bf16_f32 v129, v72, v76
    v_mfma_f32_16x16x32_bf16 v[88:91], v[40:43], v[176:179], v[88:91]
    ds_write_b32 v16, a45 offset:516
    v_mfma_f32_16x16x32_bf16 v[84:87], v[40:43], v[168:171], 0
    ds_read_b128 a[228:231], v2 offset:60416
    v_cvt_pk_bf16_f32 v130, v65, v69
    v_mfma_f32_16x16x32_bf16 v[84:87], v[44:47], v[172:175], v[84:87]
    ds_write_b32 v16, a46 offset:1536
    v_mfma_f32_16x16x32_bf16 v[80:83], v[44:47], v[164:167], 0
    ds_read_b128 a[232:235], v2 offset:61440
    v_cvt_pk_bf16_f32 v131, v73, v77
    v_mfma_f32_16x16x32_bf16 v[80:83], v[40:43], v[160:163], v[80:83]
    ds_write_b32 v16, a47 offset:1540
    v_mfma_f32_16x16x32_bf16 v[192:195], v[48:51], v[160:163], 0
    buffer_store_dwordx2 v[254:255], v11, s[12:15], s39 offen offset:1152 sc1
    v_mfma_f32_16x16x32_bf16 v[192:195], v[52:55], v[164:167], v[192:195]
    ds_read_b128 a[236:239], v2 offset:62464
    v_cvt_pk_bf16_f32 v132, v66, v70
    v_mfma_f32_16x16x32_bf16 v[196:199], v[52:55], v[172:175], 0
    ds_read2_b64 a[40:43], v17 offset0:0 offset1:128
    v_cvt_pk_bf16_f32 v133, v74, v78
    v_mfma_f32_16x16x32_bf16 v[196:199], v[48:51], v[168:171], v[196:199]
    ds_read2_b64 a[44:47], v18 offset0:0 offset1:128
    v_cvt_pk_bf16_f32 v134, v67, v71
    v_mfma_f32_16x16x32_bf16 v[200:203], v[48:51], v[176:179], 0
    v_cvt_pk_bf16_f32 v135, v75, v79
    v_cvt_pk_bf16_f32 v136, v80, v84
    v_mfma_f32_16x16x32_bf16 v[200:203], v[52:55], v[180:183], v[200:203]
    v_cvt_pk_bf16_f32 v137, v88, v92
    v_cvt_pk_bf16_f32 v138, v81, v85
    v_mfma_f32_16x16x32_bf16 v[204:207], v[52:55], v[188:191], 0
    s_waitcnt vmcnt(47)
    ds_write_b32 v16, a48 offset:0
    v_mfma_f32_16x16x32_bf16 v[204:207], v[48:51], v[184:187], v[204:207]
    ds_write_b32 v16, a49 offset:4
    v_mfma_f32_16x16x32_bf16 v[220:223], v[56:59], v[184:187], 0
    ds_write_b32 v16, a50 offset:1024
    v_mfma_f32_16x16x32_bf16 v[220:223], v[60:63], v[188:191], v[220:223]
    ds_write_b32 v16, a51 offset:1028
    v_mfma_f32_16x16x32_bf16 v[216:219], v[60:63], v[180:183], 0
    ds_write_b32 v16, a52 offset:512
    v_mfma_f32_16x16x32_bf16 v[216:219], v[56:59], v[176:179], v[216:219]
    ds_write_b32 v16, a53 offset:516
    v_mfma_f32_16x16x32_bf16 v[212:215], v[56:59], v[168:171], 0
    ds_write_b32 v16, a54 offset:1536
    v_mfma_f32_16x16x32_bf16 v[212:215], v[60:63], v[172:175], v[212:215]
    ds_write_b32 v16, a55 offset:1540
    v_mfma_f32_16x16x32_bf16 v[208:211], v[60:63], v[164:167], 0
    ds_read_b128 a[240:243], v2 offset:63488
    v_cvt_pk_bf16_f32 v139, v89, v93
    v_mfma_f32_16x16x32_bf16 v[208:211], v[56:59], v[160:163], v[208:211]
    s_waitcnt lgkmcnt(11)
    ds_read2_b64 a[48:51], v17 offset0:0 offset1:128
    v_cvt_pk_bf16_f32 v140, v82, v86
    v_mfma_f32_16x16x32_bf16 v[96:99], a[96:99], a[216:219], 0
    ds_read_b128 a[244:247], v2 offset:64512
    v_cvt_pk_bf16_f32 v141, v90, v94
    v_mfma_f32_16x16x32_bf16 v[96:99], a[100:103], a[220:223], v[96:99]
    ds_read2_b64 a[52:55], v18 offset0:0 offset1:128
    v_cvt_pk_bf16_f32 v144, v192, v196
    v_mfma_f32_16x16x32_bf16 v[96:99], a[104:107], a[224:227], v[96:99]
    ds_read_b128 a[248:251], v3 offset:0
    v_cvt_pk_bf16_f32 v146, v193, v197
    v_mfma_f32_16x16x32_bf16 v[96:99], a[108:111], a[228:231], v[96:99]
    v_cvt_pk_bf16_f32 v142, v83, v87
    v_cvt_pk_bf16_f32 v143, v91, v95
    v_mfma_f32_16x16x32_bf16 v[96:99], a[112:115], a[232:235], v[96:99]
    ds_read_b128 a[192:195], v3 offset:1024
    v_cvt_pk_bf16_f32 v148, v194, v198
    v_mfma_f32_16x16x32_bf16 v[96:99], a[116:119], a[236:239], v[96:99]
    v_cvt_pk_bf16_f32 v150, v195, v199
    v_cvt_pk_bf16_f32 v145, v200, v204
    v_mfma_f32_16x16x32_bf16 v[100:103], a[140:143], a[236:239], 0
    ds_read_b128 a[196:199], v3 offset:2048
    v_cvt_pk_bf16_f32 v147, v201, v205
    v_mfma_f32_16x16x32_bf16 v[100:103], a[136:139], a[232:235], v[100:103]
    v_cvt_pk_bf16_f32 v149, v202, v206
    v_cvt_pk_bf16_f32 v151, v203, v207
    v_mfma_f32_16x16x32_bf16 v[100:103], a[132:135], a[228:231], v[100:103]
    ds_read_b128 a[200:203], v3 offset:3072
    v_cvt_pk_bf16_f32 v192, v96, v97
    v_mfma_f32_16x16x32_bf16 v[100:103], a[128:131], a[224:227], v[100:103]
    v_cvt_pk_bf16_f32 v193, v98, v99
    v_cvt_pk_bf16_f32 v152, v208, v212
    v_mfma_f32_16x16x32_bf16 v[100:103], a[124:127], a[220:223], v[100:103]
    buffer_store_dwordx2 v[128:129], v11, s[12:15], s33 offen offset:128 sc1
    v_mfma_f32_16x16x32_bf16 v[100:103], a[120:123], a[216:219], v[100:103]
    s_waitcnt vmcnt(41)
    ds_write_b32 v16, a56 offset:0
    v_mfma_f32_16x16x32_bf16 v[104:107], a[144:147], a[216:219], 0
    ds_write_b32 v16, a57 offset:4
    v_mfma_f32_16x16x32_bf16 v[104:107], a[148:151], a[220:223], v[104:107]
    ds_write_b32 v16, a58 offset:1024
    v_mfma_f32_16x16x32_bf16 v[104:107], a[152:155], a[224:227], v[104:107]
    ds_write_b32 v16, a59 offset:1028
    v_mfma_f32_16x16x32_bf16 v[104:107], a[156:159], a[228:231], v[104:107]
    buffer_store_dwordx2 v[130:131], v11, s[12:15], s33 offen offset:512 sc1
    v_mfma_f32_16x16x32_bf16 v[104:107], a[160:163], a[232:235], v[104:107]
    ds_write_b32 v16, a60 offset:512
    v_mfma_f32_16x16x32_bf16 v[104:107], a[164:167], a[236:239], v[104:107]
    ds_write_b32 v16, a61 offset:516
    v_mfma_f32_16x16x32_bf16 v[108:111], a[188:191], a[236:239], 0
    ds_write_b32 v16, a62 offset:1536
    v_mfma_f32_16x16x32_bf16 v[108:111], a[184:187], a[232:235], v[108:111]
    ds_write_b32 v16, a63 offset:1540
    v_mfma_f32_16x16x32_bf16 v[108:111], a[180:183], a[228:231], v[108:111]
    buffer_store_dwordx2 v[132:133], v11, s[12:15], s33 offen offset:896 sc1
    v_mfma_f32_16x16x32_bf16 v[108:111], a[176:179], a[224:227], v[108:111]
    ds_read2_b64 a[56:59], v17 offset0:0 offset1:128
    v_cvt_pk_bf16_f32 v194, v100, v101
    v_mfma_f32_16x16x32_bf16 v[108:111], a[172:175], a[220:223], v[108:111]
    ds_read_b128 a[204:207], v3 offset:4096
    v_cvt_pk_bf16_f32 v195, v102, v103
    v_mfma_f32_16x16x32_bf16 v[108:111], a[168:171], a[216:219], v[108:111]
    s_waitcnt lgkmcnt(10)
    ds_read2_b64 a[60:63], v18 offset0:0 offset1:128
    v_cvt_pk_bf16_f32 v196, v104, v105
    v_mfma_f32_16x16x32_bf16 v[124:127], a[168:171], a[240:243], 0
    ds_read_b128 a[208:211], v3 offset:5120
    v_cvt_pk_bf16_f32 v197, v106, v107
    v_mfma_f32_16x16x32_bf16 v[124:127], a[172:175], a[244:247], v[124:127]
    buffer_store_dwordx2 v[134:135], v11, s[12:15], s33 offen offset:1280 sc1
    v_mfma_f32_16x16x32_bf16 v[124:127], a[176:179], a[248:251], v[124:127]
    ds_read_b128 a[212:215], v3 offset:6144
    v_cvt_pk_bf16_f32 v198, v108, v109
    v_mfma_f32_16x16x32_bf16 v[124:127], a[180:183], a[192:195], v[124:127]
    v_cvt_pk_bf16_f32 v199, v110, v111
    v_cvt_pk_bf16_f32 v153, v216, v220
    v_mfma_f32_16x16x32_bf16 v[124:127], a[184:187], a[196:199], v[124:127]
    ds_read_b128 a[216:219], v3 offset:7168
    v_cvt_pk_bf16_f32 v154, v209, v213
    v_mfma_f32_16x16x32_bf16 v[124:127], a[188:191], a[200:203], v[124:127]
    v_cvt_pk_bf16_f32 v155, v217, v221
    v_cvt_pk_bf16_f32 v156, v210, v214
    v_mfma_f32_16x16x32_bf16 v[120:123], a[164:167], a[200:203], 0
    buffer_store_dwordx2 v[136:137], v11, s[12:15], s35 offen offset:128 sc1
    v_mfma_f32_16x16x32_bf16 v[120:123], a[160:163], a[196:199], v[120:123]
    ds_read_b128 a[220:223], v3 offset:8192
    v_cvt_pk_bf16_f32 v157, v218, v222
    v_mfma_f32_16x16x32_bf16 v[120:123], a[156:159], a[192:195], v[120:123]
    ds_read_b128 a[224:227], v3 offset:9216
    v_cvt_pk_bf16_f32 v206, v124, v125
    v_mfma_f32_16x16x32_bf16 v[120:123], a[152:155], a[248:251], v[120:123]
    s_waitcnt vmcnt(38)
    ds_write_b32 v16, a64 offset:0
    v_mfma_f32_16x16x32_bf16 v[120:123], a[148:151], a[244:247], v[120:123]
    ds_write_b32 v16, a65 offset:4
    v_mfma_f32_16x16x32_bf16 v[120:123], a[144:147], a[240:243], v[120:123]
    buffer_store_dwordx2 v[138:139], v11, s[12:15], s35 offen offset:512 sc1
    v_mfma_f32_16x16x32_bf16 v[116:119], a[120:123], a[240:243], 0
    ds_write_b32 v16, a66 offset:1024
    v_mfma_f32_16x16x32_bf16 v[116:119], a[124:127], a[244:247], v[116:119]
    ds_write_b32 v16, a67 offset:1028
    v_mfma_f32_16x16x32_bf16 v[116:119], a[128:131], a[248:251], v[116:119]
    ds_write_b32 v16, a68 offset:512
    v_mfma_f32_16x16x32_bf16 v[116:119], a[132:135], a[192:195], v[116:119]
    ds_write_b32 v16, a69 offset:516
    v_mfma_f32_16x16x32_bf16 v[116:119], a[136:139], a[196:199], v[116:119]
    buffer_store_dwordx2 v[140:141], v11, s[12:15], s35 offen offset:896 sc1
    v_mfma_f32_16x16x32_bf16 v[116:119], a[140:143], a[200:203], v[116:119]
    ds_write_b32 v16, a70 offset:1536
    v_mfma_f32_16x16x32_bf16 v[112:115], a[116:119], a[200:203], 0
    ds_write_b32 v16, a71 offset:1540
    v_mfma_f32_16x16x32_bf16 v[112:115], a[112:115], a[196:199], v[112:115]
    ds_read2_b64 a[64:67], v17 offset0:0 offset1:128
    v_cvt_pk_bf16_f32 v207, v126, v127
    v_mfma_f32_16x16x32_bf16 v[112:115], a[108:111], a[192:195], v[112:115]
    ds_read2_b64 a[68:71], v18 offset0:0 offset1:128
    v_cvt_pk_bf16_f32 v204, v120, v121
    v_mfma_f32_16x16x32_bf16 v[112:115], a[104:107], a[248:251], v[112:115]
    buffer_store_dwordx2 v[142:143], v11, s[12:15], s35 offen offset:1280 sc1
    v_mfma_f32_16x16x32_bf16 v[112:115], a[100:103], a[244:247], v[112:115]
    ds_read_b128 a[228:231], v3 offset:10240
    v_cvt_pk_bf16_f32 v205, v122, v123
    v_mfma_f32_16x16x32_bf16 v[112:115], a[96:99], a[240:243], v[112:115]
    s_waitcnt lgkmcnt(9)
    v_cvt_pk_bf16_f32 v202, v116, v117
    v_cvt_pk_bf16_f32 v203, v118, v119
    v_mfma_f32_16x16x32_bf16 v[96:99], a[96:99], a[204:207], 0
    ds_read_b128 a[232:235], v3 offset:11264
    v_cvt_pk_bf16_f32 v158, v211, v215
    v_mfma_f32_16x16x32_bf16 v[96:99], a[100:103], a[208:211], v[96:99]
    v_cvt_pk_bf16_f32 v159, v219, v223
    v_mfma_f32_16x16x32_bf16 v[96:99], a[104:107], a[212:215], v[96:99]
    buffer_store_dwordx2 v[144:145], v11, s[12:15], s37 offen offset:128 sc1
    v_mfma_f32_16x16x32_bf16 v[96:99], a[108:111], a[216:219], v[96:99]
    ds_read_b128 a[236:239], v3 offset:12288
    v_cvt_pk_bf16_f32 v200, v112, v113
    v_mfma_f32_16x16x32_bf16 v[96:99], a[112:115], a[220:223], v[96:99]
    ds_read_b128 a[240:243], v3 offset:13312
    v_cvt_pk_bf16_f32 v201, v114, v115
    v_mfma_f32_16x16x32_bf16 v[96:99], a[116:119], a[224:227], v[96:99]
    s_waitcnt vmcnt(35)
    ds_write_b32 v16, a72 offset:0
    v_mfma_f32_16x16x32_bf16 v[100:103], a[140:143], a[224:227], 0
    ds_read_b128 a[244:247], v3 offset:14336
    v_mfma_f32_16x16x32_bf16 v[100:103], a[136:139], a[220:223], v[100:103]
    buffer_store_dwordx2 v[146:147], v11, s[12:15], s37 offen offset:512 sc1
    v_mfma_f32_16x16x32_bf16 v[100:103], a[132:135], a[216:219], v[100:103]
    ds_read_b128 a[248:251], v3 offset:15360
    v_cvt_pk_bf16_f32 v208, v96, v97
    v_mfma_f32_16x16x32_bf16 v[100:103], a[128:131], a[212:215], v[100:103]
    ds_write_b32 v16, a73 offset:4
    v_mfma_f32_16x16x32_bf16 v[100:103], a[124:127], a[208:211], v[100:103]
    ds_write_b32 v16, a74 offset:1024
    v_mfma_f32_16x16x32_bf16 v[100:103], a[120:123], a[204:207], v[100:103]
    ds_write_b32 v16, a75 offset:1028
    v_mfma_f32_16x16x32_bf16 v[104:107], a[144:147], a[204:207], 0
    buffer_store_dwordx2 v[148:149], v11, s[12:15], s37 offen offset:896 sc1
    v_mfma_f32_16x16x32_bf16 v[104:107], a[148:151], a[208:211], v[104:107]
    ds_write_b32 v16, a76 offset:512
    v_mfma_f32_16x16x32_bf16 v[104:107], a[152:155], a[212:215], v[104:107]
    ds_write_b32 v16, a77 offset:516
    v_mfma_f32_16x16x32_bf16 v[104:107], a[156:159], a[216:219], v[104:107]
    ds_write_b32 v16, a78 offset:1536
    v_mfma_f32_16x16x32_bf16 v[104:107], a[160:163], a[220:223], v[104:107]
    ds_write_b32 v16, a79 offset:1540
    v_mfma_f32_16x16x32_bf16 v[104:107], a[164:167], a[224:227], v[104:107]
    buffer_store_dwordx2 v[150:151], v11, s[12:15], s37 offen offset:1280 sc1
    v_mfma_f32_16x16x32_bf16 v[108:111], a[188:191], a[224:227], 0
    ds_read2_b64 a[72:75], v17 offset0:0 offset1:128
    v_cvt_pk_bf16_f32 v209, v98, v99
    v_mfma_f32_16x16x32_bf16 v[108:111], a[184:187], a[220:223], v[108:111]
    ds_read2_b64 a[76:79], v18 offset0:0 offset1:128
    v_cvt_pk_bf16_f32 v210, v100, v101
    v_mfma_f32_16x16x32_bf16 v[108:111], a[180:183], a[216:219], v[108:111]
    v_cvt_pk_bf16_f32 v211, v102, v103
    v_cvt_pk_bf16_f32 v212, v104, v105
    v_mfma_f32_16x16x32_bf16 v[108:111], a[176:179], a[212:215], v[108:111]
    v_cvt_pk_bf16_f32 v213, v106, v107
    v_mfma_f32_16x16x32_bf16 v[108:111], a[172:175], a[208:211], v[108:111]
    buffer_store_dwordx2 v[152:153], v11, s[12:15], s39 offen offset:128 sc1
    v_mfma_f32_16x16x32_bf16 v[108:111], a[168:171], a[204:207], v[108:111]
    s_waitcnt vmcnt(33) lgkmcnt(7)
    ds_write_b32 v16, a80 offset:0
    v_mfma_f32_16x16x32_bf16 v[124:127], a[168:171], a[228:231], 0
    ds_write_b32 v16, a81 offset:4
    v_mfma_f32_16x16x32_bf16 v[124:127], a[172:175], a[232:235], v[124:127]
    ds_write_b32 v16, a82 offset:1024
    v_mfma_f32_16x16x32_bf16 v[124:127], a[176:179], a[236:239], v[124:127]
    ds_write_b32 v16, a83 offset:1028
    v_mfma_f32_16x16x32_bf16 v[124:127], a[180:183], a[240:243], v[124:127]
    buffer_store_dwordx2 v[154:155], v11, s[12:15], s39 offen offset:512 sc1
    v_mfma_f32_16x16x32_bf16 v[124:127], a[184:187], a[244:247], v[124:127]
    ds_write_b32 v16, a84 offset:512
    v_mfma_f32_16x16x32_bf16 v[124:127], a[188:191], a[248:251], v[124:127]
    ds_write_b32 v16, a85 offset:516
    v_mfma_f32_16x16x32_bf16 v[120:123], a[164:167], a[248:251], 0
    ds_write_b32 v16, a86 offset:1536
    v_mfma_f32_16x16x32_bf16 v[120:123], a[160:163], a[244:247], v[120:123]
    ds_write_b32 v16, a87 offset:1540
    v_mfma_f32_16x16x32_bf16 v[120:123], a[156:159], a[240:243], v[120:123]
    buffer_store_dwordx2 v[156:157], v11, s[12:15], s39 offen offset:896 sc1
    v_mfma_f32_16x16x32_bf16 v[120:123], a[152:155], a[236:239], v[120:123]
    ds_read2_b64 a[80:83], v17 offset0:0 offset1:128
    v_cvt_pk_bf16_f32 v214, v108, v109
    v_mfma_f32_16x16x32_bf16 v[120:123], a[148:151], a[232:235], v[120:123]
    ds_read2_b64 a[84:87], v18 offset0:0 offset1:128
    v_cvt_pk_bf16_f32 v215, v110, v111
    v_mfma_f32_16x16x32_bf16 v[120:123], a[144:147], a[228:231], v[120:123]
    v_cvt_pk_bf16_f32 v222, v124, v125
    v_cvt_pk_bf16_f32 v223, v126, v127
    v_mfma_f32_16x16x32_bf16 v[116:119], a[120:123], a[228:231], 0
    v_mfma_f32_16x16x32_bf16 v[116:119], a[124:127], a[232:235], v[116:119]
    buffer_store_dwordx2 v[158:159], v11, s[12:15], s39 offen offset:1280 sc1
    v_mfma_f32_16x16x32_bf16 v[116:119], a[128:131], a[236:239], v[116:119]
    v_cvt_pk_bf16_f32 v220, v120, v121
    v_cvt_pk_bf16_f32 v221, v122, v123
    v_mfma_f32_16x16x32_bf16 v[116:119], a[132:135], a[240:243], v[116:119]
    v_mfma_f32_16x16x32_bf16 v[116:119], a[136:139], a[244:247], v[116:119]
    v_mfma_f32_16x16x32_bf16 v[116:119], a[140:143], a[248:251], v[116:119]
    v_mfma_f32_16x16x32_bf16 v[112:115], a[116:119], a[248:251], 0
    s_waitcnt vmcnt(29)
    ds_write_b32 v16, a88 offset:0
    v_mfma_f32_16x16x32_bf16 v[112:115], a[112:115], a[244:247], v[112:115]
    ds_write_b32 v16, a89 offset:4
    v_mfma_f32_16x16x32_bf16 v[112:115], a[108:111], a[240:243], v[112:115]
    ds_write_b32 v16, a90 offset:1024
    v_mfma_f32_16x16x32_bf16 v[112:115], a[104:107], a[236:239], v[112:115]
    ds_write_b32 v16, a91 offset:1028
    v_mfma_f32_16x16x32_bf16 v[112:115], a[100:103], a[232:235], v[112:115]
    ds_write_b32 v16, a92 offset:512
    v_mfma_f32_16x16x32_bf16 v[112:115], a[96:99], a[228:231], v[112:115]
    ds_write_b32 v16, a93 offset:516
    v_mfma_f32_16x16x32_bf16 v[64:67], v[32:35], v[192:195], 0
    ds_write_b32 v16, a94 offset:1536
    v_mfma_f32_16x16x32_bf16 v[64:67], v[36:39], v[196:199], v[64:67]
    ds_write_b32 v16, a95 offset:1540
    v_mfma_f32_16x16x32_bf16 v[68:71], v[36:39], v[204:207], 0
    ds_read2_b64 a[88:91], v17 offset0:0 offset1:128
    v_cvt_pk_bf16_f32 v216, v112, v113
    v_mfma_f32_16x16x32_bf16 v[68:71], v[32:35], v[200:203], v[68:71]
    ds_read2_b64 a[92:95], v18 offset0:0 offset1:128
    v_cvt_pk_bf16_f32 v217, v114, v115
    v_mfma_f32_16x16x32_bf16 v[72:75], v[32:35], v[208:211], 0
    v_cvt_pk_bf16_f32 v218, v116, v117
    v_cvt_pk_bf16_f32 v219, v118, v119
    v_mfma_f32_16x16x32_bf16 v[72:75], v[36:39], v[212:215], v[72:75]
    v_mfma_f32_16x16x32_bf16 v[76:79], v[36:39], v[220:223], 0
    buffer_load_dwordx4 a[96:99], v9, s[8:11], s24 offen offset:0 nt
    v_cvt_pk_bf16_f32 v160, v64, v68
    v_mfma_f32_16x16x32_bf16 v[76:79], v[32:35], v[216:219], v[76:79]
    buffer_load_dwordx4 a[100:103], v10, s[8:11], s24 offen offset:0 nt
    v_cvt_pk_bf16_f32 v162, v65, v69
    v_mfma_f32_16x16x32_bf16 v[92:95], v[40:43], v[216:219], 0
    ds_read_b128 a[192:195], v1 offset:0
    v_cvt_pk_bf16_f32 v164, v66, v70
    v_mfma_f32_16x16x32_bf16 v[92:95], v[44:47], v[220:223], v[92:95]
    ds_read_b128 a[196:199], v1 offset:1024
    v_cvt_pk_bf16_f32 v166, v67, v71
    v_mfma_f32_16x16x32_bf16 v[88:91], v[44:47], v[212:215], 0
    ds_read_b128 a[200:203], v1 offset:2048
    v_cvt_pk_bf16_f32 v161, v72, v76
    v_mfma_f32_16x16x32_bf16 v[88:91], v[40:43], v[208:211], v[88:91]
    v_cvt_pk_bf16_f32 v163, v73, v77
    v_cvt_pk_bf16_f32 v165, v74, v78
    v_mfma_f32_16x16x32_bf16 v[84:87], v[40:43], v[200:203], 0
    ds_read_b128 a[204:207], v1 offset:3072
    v_cvt_pk_bf16_f32 v167, v75, v79
    v_mfma_f32_16x16x32_bf16 v[84:87], v[44:47], v[204:207], v[84:87]
    v_mfma_f32_16x16x32_bf16 v[80:83], v[44:47], v[196:199], 0
    ds_read_b128 a[208:211], v1 offset:4096
    v_cvt_pk_bf16_f32 v169, v88, v92
    v_mfma_f32_16x16x32_bf16 v[80:83], v[40:43], v[192:195], v[80:83]
    v_cvt_pk_bf16_f32 v171, v89, v93
    v_cvt_pk_bf16_f32 v173, v90, v94
    v_mfma_f32_16x16x32_bf16 v[96:99], v[48:51], v[192:195], 0
    ds_read_b128 a[212:215], v1 offset:5120
    v_cvt_pk_bf16_f32 v175, v91, v95
    v_mfma_f32_16x16x32_bf16 v[96:99], v[52:55], v[196:199], v[96:99]
    v_mfma_f32_16x16x32_bf16 v[100:103], v[52:55], v[204:207], 0
    buffer_store_dwordx2 v[160:161], v11, s[12:15], s33 offen offset:256 sc1
    v_mfma_f32_16x16x32_bf16 v[100:103], v[48:51], v[200:203], v[100:103]
    v_cvt_pk_bf16_f32 v168, v80, v84
    v_cvt_pk_bf16_f32 v170, v81, v85
    v_mfma_f32_16x16x32_bf16 v[104:107], v[48:51], v[208:211], 0
    v_cvt_pk_bf16_f32 v172, v82, v86
    v_cvt_pk_bf16_f32 v174, v83, v87
    v_mfma_f32_16x16x32_bf16 v[104:107], v[52:55], v[212:215], v[104:107]
    buffer_store_dwordx2 v[162:163], v11, s[12:15], s33 offen offset:640 sc1
    v_mfma_f32_16x16x32_bf16 v[108:111], v[52:55], v[220:223], 0
    v_cvt_pk_bf16_f32 v176, v96, v100
    v_cvt_pk_bf16_f32 v178, v97, v101
    v_mfma_f32_16x16x32_bf16 v[108:111], v[48:51], v[216:219], v[108:111]
    v_cvt_pk_bf16_f32 v180, v98, v102
    v_cvt_pk_bf16_f32 v182, v99, v103
    v_mfma_f32_16x16x32_bf16 v[124:127], v[56:59], v[216:219], 0
    buffer_store_dwordx2 v[164:165], v11, s[12:15], s33 offen offset:1024 sc1
    v_mfma_f32_16x16x32_bf16 v[124:127], v[60:63], v[220:223], v[124:127]
    v_mfma_f32_16x16x32_bf16 v[120:123], v[60:63], v[212:215], 0
    v_cvt_pk_bf16_f32 v177, v104, v108
    v_cvt_pk_bf16_f32 v179, v105, v109
    v_mfma_f32_16x16x32_bf16 v[120:123], v[56:59], v[208:211], v[120:123]
    buffer_store_dwordx2 v[166:167], v11, s[12:15], s33 offen offset:1408 sc1
    v_mfma_f32_16x16x32_bf16 v[116:119], v[56:59], v[200:203], 0
    s_add_u32 s33, s16, 3145728
    v_cvt_pk_bf16_f32 v181, v106, v110
    v_cvt_pk_bf16_f32 v183, v107, v111
    v_mfma_f32_16x16x32_bf16 v[116:119], v[60:63], v[204:207], v[116:119]
    v_mfma_f32_16x16x32_bf16 v[112:115], v[60:63], v[196:199], 0
    ds_read_b128 a[216:219], v1 offset:6144
    v_cvt_pk_bf16_f32 v185, v120, v124
    v_mfma_f32_16x16x32_bf16 v[112:115], v[56:59], v[192:195], v[112:115]
    v_cvt_pk_bf16_f32 v187, v121, v125
    v_cvt_pk_bf16_f32 v189, v122, v126
    s_cmp_eq_u32 s18, 1
    s_cbranch_scc0 L_more
L_tail:
    buffer_store_dwordx2 v[168:169], v11, s[12:15], s35 offen offset:256 sc1
    buffer_store_dwordx2 v[170:171], v11, s[12:15], s35 offen offset:640 sc1
    buffer_store_dwordx2 v[172:173], v11, s[12:15], s35 offen offset:1024 sc1
    buffer_store_dwordx2 v[174:175], v11, s[12:15], s35 offen offset:1408 sc1
    buffer_store_dwordx2 v[176:177], v11, s[12:15], s37 offen offset:256 sc1
    buffer_store_dwordx2 v[178:179], v11, s[12:15], s37 offen offset:640 sc1
    buffer_store_dwordx2 v[180:181], v11, s[12:15], s37 offen offset:1024 sc1
    buffer_store_dwordx2 v[182:183], v11, s[12:15], s37 offen offset:1408 sc1
    v_cvt_pk_bf16_f32 v191, v123, v127
    v_cvt_pk_bf16_f32 v184, v112, v116
    v_cvt_pk_bf16_f32 v186, v113, v117
    v_cvt_pk_bf16_f32 v188, v114, v118
    v_cvt_pk_bf16_f32 v190, v115, v119
    buffer_store_dwordx2 v[184:185], v11, s[12:15], s39 offen offset:256 sc1
    buffer_store_dwordx2 v[186:187], v11, s[12:15], s39 offen offset:640 sc1
    buffer_store_dwordx2 v[188:189], v11, s[12:15], s39 offen offset:1024 sc1
    buffer_store_dwordx2 v[190:191], v11, s[12:15], s39 offen offset:1408 sc1
L_end:
    s_endpgm
L_more:
    s_waitcnt lgkmcnt(1)
    v_mfma_f32_16x16x32_bf16 v[96:99], a[192:195], a[0:3], 0
    ds_read_b128 a[220:223], v1 offset:7168
    v_cvt_pk_bf16_f32 v191, v123, v127
    v_mfma_f32_16x16x32_bf16 v[96:99], a[196:199], a[4:7], v[96:99]
    v_mfma_f32_16x16x32_bf16 v[96:99], a[200:203], a[8:11], v[96:99]
    ds_read_b128 a[224:227], v1 offset:8192
    v_cvt_pk_bf16_f32 v184, v112, v116
    v_mfma_f32_16x16x32_bf16 v[96:99], a[204:207], a[12:15], v[96:99]
    v_cvt_pk_bf16_f32 v186, v113, v117
    v_cvt_pk_bf16_f32 v188, v114, v118
    v_mfma_f32_16x16x32_bf16 v[96:99], a[208:211], a[16:19], v[96:99]
    ds_read_b128 a[228:231], v1 offset:9216
    v_cvt_pk_bf16_f32 v190, v115, v119
    v_mfma_f32_16x16x32_bf16 v[96:99], a[212:215], a[20:23], v[96:99]
    v_mfma_f32_16x16x32_bf16 v[100:103], a[212:215], a[44:47], 0
    ds_read_b128 a[232:235], v1 offset:10240
    v_mfma_f32_16x16x32_bf16 v[100:103], a[208:211], a[40:43], v[100:103]
    v_mfma_f32_16x16x32_bf16 v[100:103], a[204:207], a[36:39], v[100:103]
    ds_read_b128 a[236:239], v1 offset:11264
    v_cvt_pk_bf16_f32 v192, v96, v97
    v_mfma_f32_16x16x32_bf16 v[100:103], a[200:203], a[32:35], v[100:103]
    v_cvt_pk_bf16_f32 v193, v98, v99
    v_mfma_f32_16x16x32_bf16 v[100:103], a[196:199], a[28:31], v[100:103]
    v_mfma_f32_16x16x32_bf16 v[100:103], a[192:195], a[24:27], v[100:103]
    v_mfma_f32_16x16x32_bf16 v[104:107], a[192:195], a[48:51], 0
    v_mfma_f32_16x16x32_bf16 v[104:107], a[196:199], a[52:55], v[104:107]
    v_mfma_f32_16x16x32_bf16 v[104:107], a[200:203], a[56:59], v[104:107]
    v_cvt_pk_bf16_f32 v196, v100, v101
    v_cvt_pk_bf16_f32 v197, v102, v103
    v_mfma_f32_16x16x32_bf16 v[104:107], a[204:207], a[60:63], v[104:107]
    v_mfma_f32_16x16x32_bf16 v[104:107], a[208:211], a[64:67], v[104:107]
    v_mfma_f32_16x16x32_bf16 v[104:107], a[212:215], a[68:71], v[104:107]
    v_mfma_f32_16x16x32_bf16 v[108:111], a[212:215], a[92:95], 0
    v_mfma_f32_16x16x32_bf16 v[108:111], a[208:211], a[88:91], v[108:111]
    v_mfma_f32_16x16x32_bf16 v[108:111], a[204:207], a[84:87], v[108:111]
    v_cvt_pk_bf16_f32 v200, v104, v105
    v_cvt_pk_bf16_f32 v201, v106, v107
    v_mfma_f32_16x16x32_bf16 v[108:111], a[200:203], a[80:83], v[108:111]
    v_mfma_f32_16x16x32_bf16 v[108:111], a[196:199], a[76:79], v[108:111]
    ds_read_b128 a[240:243], v1 offset:12288
    v_mfma_f32_16x16x32_bf16 v[108:111], a[192:195], a[72:75], v[108:111]
    s_waitcnt lgkmcnt(1)
    v_mfma_f32_16x16x32_bf16 v[124:127], a[216:219], a[72:75], 0
    ds_read_b128 a[244:247], v1 offset:13312
    v_mfma_f32_16x16x32_bf16 v[124:127], a[220:223], a[76:79], v[124:127]
    v_mfma_f32_16x16x32_bf16 v[124:127], a[224:227], a[80:83], v[124:127]
    ds_read_b128 a[248:251], v1 offset:14336
    v_cvt_pk_bf16_f32 v204, v108, v109
    v_mfma_f32_16x16x32_bf16 v[124:127], a[228:231], a[84:87], v[124:127]
    v_cvt_pk_bf16_f32 v205, v110, v111
    v_mfma_f32_16x16x32_bf16 v[124:127], a[232:235], a[88:91], v[124:127]
    ds_read_b128 a[192:195], v1 offset:15360
    v_mfma_f32_16x16x32_bf16 v[124:127], a[236:239], a[92:95], v[124:127]
    v_mfma_f32_16x16x32_bf16 v[120:123], a[236:239], a[68:71], 0
    buffer_load_dwordx4 a[104:107], v9, s[8:11], s24 offen offset:128 nt
    v_mfma_f32_16x16x32_bf16 v[120:123], a[232:235], a[64:67], v[120:123]
    buffer_load_dwordx4 a[108:111], v10, s[8:11], s24 offen offset:128 nt
    v_mfma_f32_16x16x32_bf16 v[120:123], a[228:231], a[60:63], v[120:123]
    ds_read_b128 a[196:199], v1 offset:16384
    v_cvt_pk_bf16_f32 v206, v124, v125
    v_mfma_f32_16x16x32_bf16 v[120:123], a[224:227], a[56:59], v[120:123]
    buffer_store_dwordx2 v[168:169], v11, s[12:15], s35 offen offset:256 sc1
    v_mfma_f32_16x16x32_bf16 v[120:123], a[220:223], a[52:55], v[120:123]
    ds_read_b128 a[200:203], v1 offset:17408
    v_cvt_pk_bf16_f32 v207, v126, v127
    v_mfma_f32_16x16x32_bf16 v[120:123], a[216:219], a[48:51], v[120:123]
    v_mfma_f32_16x16x32_bf16 v[116:119], a[216:219], a[24:27], 0
    v_mfma_f32_16x16x32_bf16 v[116:119], a[220:223], a[28:31], v[116:119]
    v_mfma_f32_16x16x32_bf16 v[116:119], a[224:227], a[32:35], v[116:119]
    v_cvt_pk_bf16_f32 v202, v120, v121
    v_cvt_pk_bf16_f32 v203, v122, v123
    v_mfma_f32_16x16x32_bf16 v[116:119], a[228:231], a[36:39], v[116:119]
    v_mfma_f32_16x16x32_bf16 v[116:119], a[232:235], a[40:43], v[116:119]
    v_mfma_f32_16x16x32_bf16 v[116:119], a[236:239], a[44:47], v[116:119]
    v_mfma_f32_16x16x32_bf16 v[112:115], a[236:239], a[20:23], 0
    v_mfma_f32_16x16x32_bf16 v[112:115], a[232:235], a[16:19], v[112:115]
    v_mfma_f32_16x16x32_bf16 v[112:115], a[228:231], a[12:15], v[112:115]
    v_cvt_pk_bf16_f32 v198, v116, v117
    v_cvt_pk_bf16_f32 v199, v118, v119
    v_mfma_f32_16x16x32_bf16 v[112:115], a[224:227], a[8:11], v[112:115]
    v_mfma_f32_16x16x32_bf16 v[112:115], a[220:223], a[4:7], v[112:115]
    ds_read_b128 a[204:207], v1 offset:18432
    v_mfma_f32_16x16x32_bf16 v[112:115], a[216:219], a[0:3], v[112:115]
    s_waitcnt lgkmcnt(2)
    v_mfma_f32_16x16x32_bf16 v[96:99], a[240:243], a[0:3], 0
    ds_read_b128 a[208:211], v1 offset:19456
    v_mfma_f32_16x16x32_bf16 v[96:99], a[244:247], a[4:7], v[96:99]
    v_mfma_f32_16x16x32_bf16 v[96:99], a[248:251], a[8:11], v[96:99]
    ds_read_b128 a[212:215], v1 offset:20480
    v_cvt_pk_bf16_f32 v194, v112, v113
    v_mfma_f32_16x16x32_bf16 v[96:99], a[192:195], a[12:15], v[96:99]
    v_cvt_pk_bf16_f32 v195, v114, v115
    v_mfma_f32_16x16x32_bf16 v[96:99], a[196:199], a[16:19], v[96:99]
    s_waitcnt lgkmcnt(3)
    ds_read_b128 a[216:219], v1 offset:21504
    v_mfma_f32_16x16x32_bf16 v[96:99], a[200:203], a[20:23], v[96:99]
    v_mfma_f32_16x16x32_bf16 v[100:103], a[200:203], a[44:47], 0
    ds_read_b128 a[220:223], v1 offset:22528
    v_mfma_f32_16x16x32_bf16 v[100:103], a[196:199], a[40:43], v[100:103]
    v_mfma_f32_16x16x32_bf16 v[100:103], a[192:195], a[36:39], v[100:103]
    ds_read_b128 a[224:227], v1 offset:23552
    v_cvt_pk_bf16_f32 v208, v96, v97
    v_mfma_f32_16x16x32_bf16 v[100:103], a[248:251], a[32:35], v[100:103]
    buffer_store_dwordx2 v[170:171], v11, s[12:15], s35 offen offset:640 sc1
    v_mfma_f32_16x16x32_bf16 v[100:103], a[244:247], a[28:31], v[100:103]
    v_cvt_pk_bf16_f32 v209, v98, v99
    v_mfma_f32_16x16x32_bf16 v[100:103], a[240:243], a[24:27], v[100:103]
    v_mfma_f32_16x16x32_bf16 v[104:107], a[240:243], a[48:51], 0
    v_mfma_f32_16x16x32_bf16 v[104:107], a[244:247], a[52:55], v[104:107]
    v_mfma_f32_16x16x32_bf16 v[104:107], a[248:251], a[56:59], v[104:107]
    v_cvt_pk_bf16_f32 v212, v100, v101
    v_cvt_pk_bf16_f32 v213, v102, v103
    v_mfma_f32_16x16x32_bf16 v[104:107], a[192:195], a[60:63], v[104:107]
    v_mfma_f32_16x16x32_bf16 v[104:107], a[196:199], a[64:67], v[104:107]
    v_mfma_f32_16x16x32_bf16 v[104:107], a[200:203], a[68:71], v[104:107]
    v_mfma_f32_16x16x32_bf16 v[108:111], a[200:203], a[92:95], 0
    v_mfma_f32_16x16x32_bf16 v[108:111], a[196:199], a[88:91], v[108:111]
    v_mfma_f32_16x16x32_bf16 v[108:111], a[192:195], a[84:87], v[108:111]
    v_cvt_pk_bf16_f32 v216, v104, v105
    v_cvt_pk_bf16_f32 v217, v106, v107
    v_mfma_f32_16x16x32_bf16 v[108:111], a[248:251], a[80:83], v[108:111]
    v_mfma_f32_16x16x32_bf16 v[108:111], a[244:247], a[76:79], v[108:111]
    ds_read_b128 a[228:231], v1 offset:24576
    v_mfma_f32_16x16x32_bf16 v[108:111], a[240:243], a[72:75], v[108:111]
    s_waitcnt lgkmcnt(1)
    v_mfma_f32_16x16x32_bf16 v[124:127], a[204:207], a[72:75], 0
    ds_read_b128 a[232:235], v1 offset:25600
    v_mfma_f32_16x16x32_bf16 v[124:127], a[208:211], a[76:79], v[124:127]
    v_mfma_f32_16x16x32_bf16 v[124:127], a[212:215], a[80:83], v[124:127]
    ds_read_b128 a[236:239], v1 offset:26624
    v_cvt_pk_bf16_f32 v220, v108, v109
    v_mfma_f32_16x16x32_bf16 v[124:127], a[216:219], a[84:87], v[124:127]
    v_cvt_pk_bf16_f32 v221, v110, v111
    v_mfma_f32_16x16x32_bf16 v[124:127], a[220:223], a[88:91], v[124:127]
    ds_read_b128 a[240:243], v1 offset:27648
    v_mfma_f32_16x16x32_bf16 v[124:127], a[224:227], a[92:95], v[124:127]
    v_mfma_f32_16x16x32_bf16 v[120:123], a[224:227], a[68:71], 0
    ds_read_b128 a[244:247], v1 offset:28672
    v_mfma_f32_16x16x32_bf16 v[120:123], a[220:223], a[64:67], v[120:123]
    v_mfma_f32_16x16x32_bf16 v[120:123], a[216:219], a[60:63], v[120:123]
    ds_read_b128 a[248:251], v1 offset:29696
    v_cvt_pk_bf16_f32 v222, v124, v125
    v_mfma_f32_16x16x32_bf16 v[120:123], a[212:215], a[56:59], v[120:123]
    v_cvt_pk_bf16_f32 v223, v126, v127
    v_mfma_f32_16x16x32_bf16 v[120:123], a[208:211], a[52:55], v[120:123]
    buffer_store_dwordx2 v[172:173], v11, s[12:15], s35 offen offset:1024 sc1
    v_mfma_f32_16x16x32_bf16 v[120:123], a[204:207], a[48:51], v[120:123]
    v_mfma_f32_16x16x32_bf16 v[116:119], a[204:207], a[24:27], 0
    v_mfma_f32_16x16x32_bf16 v[116:119], a[208:211], a[28:31], v[116:119]
    v_mfma_f32_16x16x32_bf16 v[116:119], a[212:215], a[32:35], v[116:119]
    buffer_load_dwordx4 a[112:115], v9, s[8:11], s24 offen offset:256 nt
    v_cvt_pk_bf16_f32 v218, v120, v121
    v_mfma_f32_16x16x32_bf16 v[116:119], a[216:219], a[36:39], v[116:119]
    buffer_load_dwordx4 a[116:119], v10, s[8:11], s24 offen offset:256 nt
    v_cvt_pk_bf16_f32 v219, v122, v123
    v_mfma_f32_16x16x32_bf16 v[116:119], a[220:223], a[40:43], v[116:119]
    s_add_u32 s24, s16, 6291456
    v_mfma_f32_16x16x32_bf16 v[116:119], a[224:227], a[44:47], v[116:119]
    v_mfma_f32_16x16x32_bf16 v[112:115], a[224:227], a[20:23], 0
    v_mfma_f32_16x16x32_bf16 v[112:115], a[220:223], a[16:19], v[112:115]
    v_mfma_f32_16x16x32_bf16 v[112:115], a[216:219], a[12:15], v[112:115]
    v_cvt_pk_bf16_f32 v214, v116, v117
    v_cvt_pk_bf16_f32 v215, v118, v119
    v_mfma_f32_16x16x32_bf16 v[112:115], a[212:215], a[8:11], v[112:115]
    v_mfma_f32_16x16x32_bf16 v[112:115], a[208:211], a[4:7], v[112:115]
    v_mfma_f32_16x16x32_bf16 v[112:115], a[204:207], a[0:3], v[112:115]
    s_waitcnt lgkmcnt(0)
    v_mfma_f32_16x16x32_bf16 v[96:99], a[228:231], a[0:3], 0
    v_mfma_f32_16x16x32_bf16 v[96:99], a[232:235], a[4:7], v[96:99]
    v_mfma_f32_16x16x32_bf16 v[96:99], a[236:239], a[8:11], v[96:99]
    v_cvt_pk_bf16_f32 v210, v112, v113
    v_cvt_pk_bf16_f32 v211, v114, v115
    v_mfma_f32_16x16x32_bf16 v[96:99], a[240:243], a[12:15], v[96:99]
    v_mfma_f32_16x16x32_bf16 v[96:99], a[244:247], a[16:19], v[96:99]
    v_mfma_f32_16x16x32_bf16 v[96:99], a[248:251], a[20:23], v[96:99]
    v_mfma_f32_16x16x32_bf16 v[100:103], a[248:251], a[44:47], 0
    v_mfma_f32_16x16x32_bf16 v[100:103], a[244:247], a[40:43], v[100:103]
    v_mfma_f32_16x16x32_bf16 v[100:103], a[240:243], a[36:39], v[100:103]
    v_mfma_f32_16x16x32_bf16 v[100:103], a[236:239], a[32:35], v[100:103]
    v_mfma_f32_16x16x32_bf16 v[100:103], a[232:235], a[28:31], v[100:103]
    v_mfma_f32_16x16x32_bf16 v[100:103], a[228:231], a[24:27], v[100:103]
    buffer_store_dwordx2 v[174:175], v11, s[12:15], s35 offen offset:1408 sc1
    v_mfma_f32_16x16x32_bf16 v[32:35], a[0:3], v[192:195], 0
    s_add_u32 s35, s16, 3538944
    v_mfma_f32_16x16x32_bf16 v[32:35], a[4:7], v[208:211], v[32:35]
    v_mfma_f32_16x16x32_bf16 v[36:39], a[28:31], v[208:211], 0
    v_mfma_f32_16x16x32_bf16 v[36:39], a[24:27], v[192:195], v[36:39]
    v_mfma_f32_16x16x32_bf16 v[40:43], a[48:51], v[192:195], 0
    v_mfma_f32_16x16x32_bf16 v[40:43], a[52:55], v[208:211], v[40:43]
    v_mfma_f32_16x16x32_bf16 v[44:47], a[76:79], v[208:211], 0
    v_mfma_f32_16x16x32_bf16 v[44:47], a[72:75], v[192:195], v[44:47]
    v_cvt_pk_bf16_f32 v192, v96, v97
    v_cvt_pk_bf16_f32 v193, v98, v99
    v_mfma_f32_16x16x32_bf16 v[60:63], a[72:75], v[196:199], 0
    v_mfma_f32_16x16x32_bf16 v[60:63], a[76:79], v[212:215], v[60:63]
    v_mfma_f32_16x16x32_bf16 v[56:59], a[52:55], v[212:215], 0
    v_mfma_f32_16x16x32_bf16 v[56:59], a[48:51], v[196:199], v[56:59]
    v_mfma_f32_16x16x32_bf16 v[52:55], a[24:27], v[196:199], 0
    v_mfma_f32_16x16x32_bf16 v[52:55], a[28:31], v[212:215], v[52:55]
    v_mfma_f32_16x16x32_bf16 v[48:51], a[4:7], v[212:215], 0
    v_mfma_f32_16x16x32_bf16 v[48:51], a[0:3], v[196:199], v[48:51]
    v_cvt_pk_bf16_f32 v196, v100, v101
    v_cvt_pk_bf16_f32 v197, v102, v103
    v_mfma_f32_16x16x32_bf16 v[64:67], a[0:3], v[200:203], 0
    v_mfma_f32_16x16x32_bf16 v[64:67], a[4:7], v[216:219], v[64:67]
    v_mfma_f32_16x16x32_bf16 v[68:71], a[28:31], v[216:219], 0
    ds_read_b128 a[192:195], v1 offset:30720
    v_mfma_f32_16x16x32_bf16 v[68:71], a[24:27], v[200:203], v[68:71]
    v_mfma_f32_16x16x32_bf16 v[72:75], a[48:51], v[200:203], 0
    ds_read_b128 a[196:199], v1 offset:31744
    v_mfma_f32_16x16x32_bf16 v[72:75], a[52:55], v[216:219], v[72:75]
    v_mfma_f32_16x16x32_bf16 v[76:79], a[76:79], v[216:219], 0
    ds_read_b128 a[200:203], v1 offset:32768
    v_mfma_f32_16x16x32_bf16 v[76:79], a[72:75], v[200:203], v[76:79]
    v_mfma_f32_16x16x32_bf16 v[92:95], a[72:75], v[204:207], 0
    buffer_store_dwordx2 v[176:177], v11, s[12:15], s37 offen offset:256 sc1
    v_mfma_f32_16x16x32_bf16 v[92:95], a[76:79], v[220:223], v[92:95]
    ds_read_b128 a[204:207], v1 offset:33792
    v_mfma_f32_16x16x32_bf16 v[88:91], a[52:55], v[220:223], 0
    ds_read_b128 a[208:211], v1 offset:34816
    v_mfma_f32_16x16x32_bf16 v[88:91], a[48:51], v[204:207], v[88:91]
    v_mfma_f32_16x16x32_bf16 v[84:87], a[24:27], v[204:207], 0
    ds_read_b128 a[212:215], v1 offset:35840
    v_mfma_f32_16x16x32_bf16 v[84:87], a[28:31], v[220:223], v[84:87]
    v_mfma_f32_16x16x32_bf16 v[80:83], a[4:7], v[220:223], 0
    v_mfma_f32_16x16x32_bf16 v[80:83], a[0:3], v[204:207], v[80:83]
    v_mfma_f32_16x16x32_bf16 v[104:107], a[228:231], a[48:51], 0
    v_mfma_f32_16x16x32_bf16 v[104:107], a[232:235], a[52:55], v[104:107]
    v_mfma_f32_16x16x32_bf16 v[104:107], a[236:239], a[56:59], v[104:107]
    buffer_load_dwordx4 a[120:123], v9, s[8:11], s26 offen offset:0 nt
    v_mfma_f32_16x16x32_bf16 v[104:107], a[240:243], a[60:63], v[104:107]
    buffer_load_dwordx4 a[124:127], v10, s[8:11], s26 offen offset:0 nt
    v_mfma_f32_16x16x32_bf16 v[104:107], a[244:247], a[64:67], v[104:107]
    v_mfma_f32_16x16x32_bf16 v[104:107], a[248:251], a[68:71], v[104:107]
    v_mfma_f32_16x16x32_bf16 v[108:111], a[248:251], a[92:95], 0
    v_mfma_f32_16x16x32_bf16 v[108:111], a[244:247], a[88:91], v[108:111]
    v_mfma_f32_16x16x32_bf16 v[108:111], a[240:243], a[84:87], v[108:111]
    v_cvt_pk_bf16_f32 v200, v104, v105
    v_cvt_pk_bf16_f32 v201, v106, v107
    v_mfma_f32_16x16x32_bf16 v[108:111], a[236:239], a[80:83], v[108:111]
    v_mfma_f32_16x16x32_bf16 v[108:111], a[232:235], a[76:79], v[108:111]
    ds_read_b128 a[216:219], v1 offset:36864
    v_mfma_f32_16x16x32_bf16 v[108:111], a[228:231], a[72:75], v[108:111]
    s_waitcnt lgkmcnt(1)
    v_mfma_f32_16x16x32_bf16 v[124:127], a[192:195], a[72:75], 0
    ds_read_b128 a[220:223], v1 offset:37888
    v_mfma_f32_16x16x32_bf16 v[124:127], a[196:199], a[76:79], v[124:127]
    v_mfma_f32_16x16x32_bf16 v[124:127], a[200:203], a[80:83], v[124:127]
    ds_read_b128 a[224:227], v1 offset:38912
    v_cvt_pk_bf16_f32 v204, v108, v109
    v_mfma_f32_16x16x32_bf16 v[124:127], a[204:207], a[84:87], v[124:127]
    v_cvt_pk_bf16_f32 v205, v110, v111
    v_mfma_f32_16x16x32_bf16 v[124:127], a[208:211], a[88:91], v[124:127]
    ds_read_b128 a[228:231], v1 offset:39936
    v_mfma_f32_16x16x32_bf16 v[124:127], a[212:215], a[92:95], v[124:127]
    buffer_store_dwordx2 v[178:179], v11, s[12:15], s37 offen offset:640 sc1
    v_mfma_f32_16x16x32_bf16 v[120:123], a[212:215], a[68:71], 0
    ds_read_b128 a[232:235], v1 offset:40960
    v_mfma_f32_16x16x32_bf16 v[120:123], a[208:211], a[64:67], v[120:123]
    v_mfma_f32_16x16x32_bf16 v[120:123], a[204:207], a[60:63], v[120:123]
    ds_read_b128 a[236:239], v1 offset:41984
    v_cvt_pk_bf16_f32 v206, v124, v125
    v_mfma_f32_16x16x32_bf16 v[120:123], a[200:203], a[56:59], v[120:123]
    v_cvt_pk_bf16_f32 v207, v126, v127
    v_mfma_f32_16x16x32_bf16 v[120:123], a[196:199], a[52:55], v[120:123]
    v_mfma_f32_16x16x32_bf16 v[120:123], a[192:195], a[48:51], v[120:123]
    v_mfma_f32_16x16x32_bf16 v[116:119], a[192:195], a[24:27], 0
    v_mfma_f32_16x16x32_bf16 v[116:119], a[196:199], a[28:31], v[116:119]
    v_mfma_f32_16x16x32_bf16 v[116:119], a[200:203], a[32:35], v[116:119]
    v_cvt_pk_bf16_f32 v202, v120, v121
    v_cvt_pk_bf16_f32 v203, v122, v123
    v_mfma_f32_16x16x32_bf16 v[116:119], a[204:207], a[36:39], v[116:119]
    v_mfma_f32_16x16x32_bf16 v[116:119], a[208:211], a[40:43], v[116:119]
    v_mfma_f32_16x16x32_bf16 v[116:119], a[212:215], a[44:47], v[116:119]
    v_mfma_f32_16x16x32_bf16 v[112:115], a[212:215], a[20:23], 0
    v_mfma_f32_16x16x32_bf16 v[112:115], a[208:211], a[16:19], v[112:115]
    v_mfma_f32_16x16x32_bf16 v[112:115], a[204:207], a[12:15], v[112:115]
    v_cvt_pk_bf16_f32 v198, v116, v117
    v_cvt_pk_bf16_f32 v199, v118, v119
    v_mfma_f32_16x16x32_bf16 v[112:115], a[200:203], a[8:11], v[112:115]
    v_mfma_f32_16x16x32_bf16 v[112:115], a[196:199], a[4:7], v[112:115]
    ds_read_b128 a[240:243], v1 offset:43008
    v_mfma_f32_16x16x32_bf16 v[112:115], a[192:195], a[0:3], v[112:115]
    s_waitcnt lgkmcnt(1)
    v_mfma_f32_16x16x32_bf16 v[96:99], a[216:219], a[0:3], 0
    ds_read_b128 a[244:247], v1 offset:44032
    v_mfma_f32_16x16x32_bf16 v[96:99], a[220:223], a[4:7], v[96:99]
    v_mfma_f32_16x16x32_bf16 v[96:99], a[224:227], a[8:11], v[96:99]
    ds_read_b128 a[248:251], v1 offset:45056
    v_cvt_pk_bf16_f32 v194, v112, v113
    v_mfma_f32_16x16x32_bf16 v[96:99], a[228:231], a[12:15], v[96:99]
    v_cvt_pk_bf16_f32 v195, v114, v115
    v_mfma_f32_16x16x32_bf16 v[96:99], a[232:235], a[16:19], v[96:99]
    ds_read_b128 a[192:195], v1 offset:46080
    v_mfma_f32_16x16x32_bf16 v[96:99], a[236:239], a[20:23], v[96:99]
    v_mfma_f32_16x16x32_bf16 v[100:103], a[236:239], a[44:47], 0
    buffer_store_dwordx2 v[180:181], v11, s[12:15], s37 offen offset:1024 sc1
    v_mfma_f32_16x16x32_bf16 v[100:103], a[232:235], a[40:43], v[100:103]
    ds_read_b128 a[196:199], v1 offset:47104
    v_mfma_f32_16x16x32_bf16 v[100:103], a[228:231], a[36:39], v[100:103]
    ds_read_b128 a[200:203], v1 offset:48128
    v_cvt_pk_bf16_f32 v208, v96, v97
    v_mfma_f32_16x16x32_bf16 v[100:103], a[224:227], a[32:35], v[100:103]
    v_cvt_pk_bf16_f32 v209, v98, v99
    v_mfma_f32_16x16x32_bf16 v[100:103], a[220:223], a[28:31], v[100:103]
    v_mfma_f32_16x16x32_bf16 v[100:103], a[216:219], a[24:27], v[100:103]
    v_mfma_f32_16x16x32_bf16 v[104:107], a[216:219], a[48:51], 0
    v_mfma_f32_16x16x32_bf16 v[104:107], a[220:223], a[52:55], v[104:107]
    v_mfma_f32_16x16x32_bf16 v[104:107], a[224:227], a[56:59], v[104:107]
    v_cvt_pk_bf16_f32 v212, v100, v101
    v_cvt_pk_bf16_f32 v213, v102, v103
    v_mfma_f32_16x16x32_bf16 v[104:107], a[228:231], a[60:63], v[104:107]
    v_mfma_f32_16x16x32_bf16 v[104:107], a[232:235], a[64:67], v[104:107]
    v_mfma_f32_16x16x32_bf16 v[104:107], a[236:239], a[68:71], v[104:107]
    v_mfma_f32_16x16x32_bf16 v[108:111], a[236:239], a[92:95], 0
    v_mfma_f32_16x16x32_bf16 v[108:111], a[232:235], a[88:91], v[108:111]
    v_mfma_f32_16x16x32_bf16 v[108:111], a[228:231], a[84:87], v[108:111]
    v_cvt_pk_bf16_f32 v216, v104, v105
    v_cvt_pk_bf16_f32 v217, v106, v107
    v_mfma_f32_16x16x32_bf16 v[108:111], a[224:227], a[80:83], v[108:111]
    v_mfma_f32_16x16x32_bf16 v[108:111], a[220:223], a[76:79], v[108:111]
    buffer_load_dwordx4 a[128:131], v9, s[8:11], s26 offen offset:128 nt
    v_mfma_f32_16x16x32_bf16 v[108:111], a[216:219], a[72:75], v[108:111]
    s_waitcnt lgkmcnt(0)
    buffer_load_dwordx4 a[132:135], v10, s[8:11], s26 offen offset:128 nt
    v_mfma_f32_16x16x32_bf16 v[124:127], a[240:243], a[72:75], 0
    ds_read_b128 a[204:207], v1 offset:49152
    v_mfma_f32_16x16x32_bf16 v[124:127], a[244:247], a[76:79], v[124:127]
    ds_read_b128 a[208:211], v1 offset:50176
    v_mfma_f32_16x16x32_bf16 v[124:127], a[248:251], a[80:83], v[124:127]
    ds_read_b128 a[212:215], v1 offset:51200
    v_cvt_pk_bf16_f32 v220, v108, v109
    v_mfma_f32_16x16x32_bf16 v[124:127], a[192:195], a[84:87], v[124:127]
    v_cvt_pk_bf16_f32 v221, v110, v111
    v_mfma_f32_16x16x32_bf16 v[124:127], a[196:199], a[88:91], v[124:127]
    ds_read_b128 a[216:219], v1 offset:52224
    v_mfma_f32_16x16x32_bf16 v[124:127], a[200:203], a[92:95], v[124:127]
    v_mfma_f32_16x16x32_bf16 v[120:123], a[200:203], a[68:71], 0
    ds_read_b128 a[220:223], v1 offset:53248
    v_mfma_f32_16x16x32_bf16 v[120:123], a[196:199], a[64:67], v[120:123]
    buffer_store_dwordx2 v[182:183], v11, s[12:15], s37 offen offset:1408 sc1
    v_mfma_f32_16x16x32_bf16 v[120:123], a[192:195], a[60:63], v[120:123]
    s_add_u32 s37, s16, 3932160
    ds_read_b128 a[224:227], v1 offset:54272
    v_cvt_pk_bf16_f32 v222, v124, v125
    v_mfma_f32_16x16x32_bf16 v[120:123], a[248:251], a[56:59], v[120:123]
    v_cvt_pk_bf16_f32 v223, v126, v127
    v_mfma_f32_16x16x32_bf16 v[120:123], a[244:247], a[52:55], v[120:123]
    v_mfma_f32_16x16x32_bf16 v[120:123], a[240:243], a[48:51], v[120:123]
    v_mfma_f32_16x16x32_bf16 v[116:119], a[240:243], a[24:27], 0
    v_mfma_f32_16x16x32_bf16 v[116:119], a[244:247], a[28:31], v[116:119]
    v_mfma_f32_16x16x32_bf16 v[116:119], a[248:251], a[32:35], v[116:119]
    v_cvt_pk_bf16_f32 v218, v120, v121
    v_cvt_pk_bf16_f32 v219, v122, v123
    v_mfma_f32_16x16x32_bf16 v[116:119], a[192:195], a[36:39], v[116:119]
    v_mfma_f32_16x16x32_bf16 v[116:119], a[196:199], a[40:43], v[116:119]
    v_mfma_f32_16x16x32_bf16 v[116:119], a[200:203], a[44:47], v[116:119]
    v_mfma_f32_16x16x32_bf16 v[112:115], a[200:203], a[20:23], 0
    v_mfma_f32_16x16x32_bf16 v[112:115], a[196:199], a[16:19], v[112:115]
    v_mfma_f32_16x16x32_bf16 v[112:115], a[192:195], a[12:15], v[112:115]
    v_cvt_pk_bf16_f32 v214, v116, v117
    v_cvt_pk_bf16_f32 v215, v118, v119
    v_mfma_f32_16x16x32_bf16 v[112:115], a[248:251], a[8:11], v[112:115]
    v_mfma_f32_16x16x32_bf16 v[112:115], a[244:247], a[4:7], v[112:115]
    v_mfma_f32_16x16x32_bf16 v[112:115], a[240:243], a[0:3], v[112:115]
    s_waitcnt lgkmcnt(0)
    v_mfma_f32_16x16x32_bf16 v[96:99], a[204:207], a[0:3], 0
    v_mfma_f32_16x16x32_bf16 v[96:99], a[208:211], a[4:7], v[96:99]
    v_mfma_f32_16x16x32_bf16 v[96:99], a[212:215], a[8:11], v[96:99]
    v_cvt_pk_bf16_f32 v210, v112, v113
    v_cvt_pk_bf16_f32 v211, v114, v115
    v_mfma_f32_16x16x32_bf16 v[96:99], a[216:219], a[12:15], v[96:99]
    v_mfma_f32_16x16x32_bf16 v[96:99], a[220:223], a[16:19], v[96:99]
    v_mfma_f32_16x16x32_bf16 v[96:99], a[224:227], a[20:23], v[96:99]
    v_mfma_f32_16x16x32_bf16 v[100:103], a[224:227], a[44:47], 0
    v_mfma_f32_16x16x32_bf16 v[100:103], a[220:223], a[40:43], v[100:103]
    v_mfma_f32_16x16x32_bf16 v[100:103], a[216:219], a[36:39], v[100:103]
    buffer_store_dwordx2 v[184:185], v11, s[12:15], s39 offen offset:256 sc1
    v_mfma_f32_16x16x32_bf16 v[100:103], a[212:215], a[32:35], v[100:103]
    v_mfma_f32_16x16x32_bf16 v[100:103], a[208:211], a[28:31], v[100:103]
    v_mfma_f32_16x16x32_bf16 v[100:103], a[204:207], a[24:27], v[100:103]
    v_mfma_f32_16x16x32_bf16 v[32:35], a[8:11], v[192:195], v[32:35]
    v_mfma_f32_16x16x32_bf16 v[32:35], a[12:15], v[208:211], v[32:35]
    v_mfma_f32_16x16x32_bf16 v[36:39], a[36:39], v[208:211], v[36:39]
    v_mfma_f32_16x16x32_bf16 v[36:39], a[32:35], v[192:195], v[36:39]
    v_mfma_f32_16x16x32_bf16 v[40:43], a[56:59], v[192:195], v[40:43]
    v_mfma_f32_16x16x32_bf16 v[40:43], a[60:63], v[208:211], v[40:43]
    v_mfma_f32_16x16x32_bf16 v[44:47], a[84:87], v[208:211], v[44:47]
    v_mfma_f32_16x16x32_bf16 v[44:47], a[80:83], v[192:195], v[44:47]
    v_cvt_pk_bf16_f32 v192, v96, v97
    v_cvt_pk_bf16_f32 v193, v98, v99
    v_mfma_f32_16x16x32_bf16 v[60:63], a[80:83], v[196:199], v[60:63]
    v_mfma_f32_16x16x32_bf16 v[60:63], a[84:87], v[212:215], v[60:63]
    v_mfma_f32_16x16x32_bf16 v[56:59], a[60:63], v[212:215], v[56:59]
    v_mfma_f32_16x16x32_bf16 v[56:59], a[56:59], v[196:199], v[56:59]
    v_mfma_f32_16x16x32_bf16 v[52:55], a[32:35], v[196:199], v[52:55]
    v_mfma_f32_16x16x32_bf16 v[52:55], a[36:39], v[212:215], v[52:55]
    v_mfma_f32_16x16x32_bf16 v[48:51], a[12:15], v[212:215], v[48:51]
    v_mfma_f32_16x16x32_bf16 v[48:51], a[8:11], v[196:199], v[48:51]
    v_cvt_pk_bf16_f32 v196, v100, v101
    v_cvt_pk_bf16_f32 v197, v102, v103
    v_mfma_f32_16x16x32_bf16 v[64:67], a[8:11], v[200:203], v[64:67]
    v_mfma_f32_16x16x32_bf16 v[64:67], a[12:15], v[216:219], v[64:67]
    v_mfma_f32_16x16x32_bf16 v[68:71], a[36:39], v[216:219], v[68:71]
    buffer_load_dwordx4 a[136:139], v9, s[8:11], s26 offen offset:256 nt
    v_mfma_f32_16x16x32_bf16 v[68:71], a[32:35], v[200:203], v[68:71]
    buffer_load_dwordx4 a[140:143], v10, s[8:11], s26 offen offset:256 nt
    s_add_u32 s26, s16, 6684672
    v_mfma_f32_16x16x32_bf16 v[72:75], a[56:59], v[200:203], v[72:75]
    ds_read_b128 a[228:231], v1 offset:55296
    v_mfma_f32_16x16x32_bf16 v[72:75], a[60:63], v[216:219], v[72:75]
    ds_read_b128 a[232:235], v1 offset:56320
    v_mfma_f32_16x16x32_bf16 v[76:79], a[84:87], v[216:219], v[76:79]
    buffer_store_dwordx2 v[186:187], v11, s[12:15], s39 offen offset:640 sc1
    v_mfma_f32_16x16x32_bf16 v[76:79], a[80:83], v[200:203], v[76:79]
    ds_read_b128 a[236:239], v1 offset:57344
    v_mfma_f32_16x16x32_bf16 v[92:95], a[80:83], v[204:207], v[92:95]
    ds_read_b128 a[240:243], v1 offset:58368
    v_mfma_f32_16x16x32_bf16 v[92:95], a[84:87], v[220:223], v[92:95]
    v_mfma_f32_16x16x32_bf16 v[88:91], a[60:63], v[220:223], v[88:91]
    ds_read_b128 a[244:247], v1 offset:59392
    v_mfma_f32_16x16x32_bf16 v[88:91], a[56:59], v[204:207], v[88:91]
    v_mfma_f32_16x16x32_bf16 v[84:87], a[32:35], v[204:207], v[84:87]
    ds_read_b128 a[248:251], v1 offset:60416
    v_mfma_f32_16x16x32_bf16 v[84:87], a[36:39], v[220:223], v[84:87]
    v_mfma_f32_16x16x32_bf16 v[80:83], a[12:15], v[220:223], v[80:83]
    v_mfma_f32_16x16x32_bf16 v[80:83], a[8:11], v[204:207], v[80:83]
    v_mfma_f32_16x16x32_bf16 v[104:107], a[204:207], a[48:51], 0
    v_mfma_f32_16x16x32_bf16 v[104:107], a[208:211], a[52:55], v[104:107]
    v_mfma_f32_16x16x32_bf16 v[104:107], a[212:215], a[56:59], v[104:107]
    v_mfma_f32_16x16x32_bf16 v[104:107], a[216:219], a[60:63], v[104:107]
    v_mfma_f32_16x16x32_bf16 v[104:107], a[220:223], a[64:67], v[104:107]
    v_mfma_f32_16x16x32_bf16 v[104:107], a[224:227], a[68:71], v[104:107]
    v_mfma_f32_16x16x32_bf16 v[108:111], a[224:227], a[92:95], 0
    v_mfma_f32_16x16x32_bf16 v[108:111], a[220:223], a[88:91], v[108:111]
    v_mfma_f32_16x16x32_bf16 v[108:111], a[216:219], a[84:87], v[108:111]
    v_cvt_pk_bf16_f32 v200, v104, v105
    v_cvt_pk_bf16_f32 v201, v106, v107
    v_mfma_f32_16x16x32_bf16 v[108:111], a[212:215], a[80:83], v[108:111]
    v_mfma_f32_16x16x32_bf16 v[108:111], a[208:211], a[76:79], v[108:111]
    ds_read_b128 a[192:195], v1 offset:61440
    v_mfma_f32_16x16x32_bf16 v[108:111], a[204:207], a[72:75], v[108:111]
    s_waitcnt lgkmcnt(1)
    v_mfma_f32_16x16x32_bf16 v[124:127], a[228:231], a[72:75], 0
    ds_read_b128 a[196:199], v1 offset:62464
    v_mfma_f32_16x16x32_bf16 v[124:127], a[232:235], a[76:79], v[124:127]
    v_mfma_f32_16x16x32_bf16 v[124:127], a[236:239], a[80:83], v[124:127]
    buffer_store_dwordx2 v[188:189], v11, s[12:15], s39 offen offset:1024 sc1
    v_mfma_f32_16x16x32_bf16 v[124:127], a[240:243], a[84:87], v[124:127]
    ds_read_b128 a[200:203], v1 offset:63488
    v_cvt_pk_bf16_f32 v204, v108, v109
    v_mfma_f32_16x16x32_bf16 v[124:127], a[244:247], a[88:91], v[124:127]
    ds_read_b128 a[204:207], v1 offset:64512
    v_cvt_pk_bf16_f32 v205, v110, v111
    v_mfma_f32_16x16x32_bf16 v[124:127], a[248:251], a[92:95], v[124:127]
    v_mfma_f32_16x16x32_bf16 v[120:123], a[248:251], a[68:71], 0
    ds_read_b128 a[208:211], v2 offset:0
    v_mfma_f32_16x16x32_bf16 v[120:123], a[244:247], a[64:67], v[120:123]
    v_mfma_f32_16x16x32_bf16 v[120:123], a[240:243], a[60:63], v[120:123]
    ds_read_b128 a[212:215], v2 offset:1024
    v_cvt_pk_bf16_f32 v206, v124, v125
    v_mfma_f32_16x16x32_bf16 v[120:123], a[236:239], a[56:59], v[120:123]
    v_cvt_pk_bf16_f32 v207, v126, v127
    v_mfma_f32_16x16x32_bf16 v[120:123], a[232:235], a[52:55], v[120:123]
    v_mfma_f32_16x16x32_bf16 v[120:123], a[228:231], a[48:51], v[120:123]
    v_mfma_f32_16x16x32_bf16 v[116:119], a[228:231], a[24:27], 0
    v_mfma_f32_16x16x32_bf16 v[116:119], a[232:235], a[28:31], v[116:119]
    v_mfma_f32_16x16x32_bf16 v[116:119], a[236:239], a[32:35], v[116:119]
    v_cvt_pk_bf16_f32 v202, v120, v121
    v_cvt_pk_bf16_f32 v203, v122, v123
    v_mfma_f32_16x16x32_bf16 v[116:119], a[240:243], a[36:39], v[116:119]
    v_mfma_f32_16x16x32_bf16 v[116:119], a[244:247], a[40:43], v[116:119]
    v_mfma_f32_16x16x32_bf16 v[116:119], a[248:251], a[44:47], v[116:119]
    v_mfma_f32_16x16x32_bf16 v[112:115], a[248:251], a[20:23], 0
    v_mfma_f32_16x16x32_bf16 v[112:115], a[244:247], a[16:19], v[112:115]
    v_mfma_f32_16x16x32_bf16 v[112:115], a[240:243], a[12:15], v[112:115]
    v_cvt_pk_bf16_f32 v198, v116, v117
    v_cvt_pk_bf16_f32 v199, v118, v119
    v_mfma_f32_16x16x32_bf16 v[112:115], a[236:239], a[8:11], v[112:115]
    v_mfma_f32_16x16x32_bf16 v[112:115], a[232:235], a[4:7], v[112:115]
    ds_read_b128 a[216:219], v2 offset:2048
    v_mfma_f32_16x16x32_bf16 v[112:115], a[228:231], a[0:3], v[112:115]
    s_waitcnt lgkmcnt(1)
    v_mfma_f32_16x16x32_bf16 v[96:99], a[192:195], a[0:3], 0
    ds_read_b128 a[220:223], v2 offset:3072
    v_mfma_f32_16x16x32_bf16 v[96:99], a[196:199], a[4:7], v[96:99]
    v_mfma_f32_16x16x32_bf16 v[96:99], a[200:203], a[8:11], v[96:99]
    ds_read_b128 a[224:227], v2 offset:4096
    v_cvt_pk_bf16_f32 v194, v112, v113
    v_mfma_f32_16x16x32_bf16 v[96:99], a[204:207], a[12:15], v[96:99]
    buffer_store_dwordx2 v[190:191], v11, s[12:15], s39 offen offset:1408 sc1
    v_mfma_f32_16x16x32_bf16 v[96:99], a[208:211], a[16:19], v[96:99]
    s_add_u32 s39, s16, 4325376
    ds_read_b128 a[228:231], v2 offset:5120
    v_cvt_pk_bf16_f32 v195, v114, v115
    v_mfma_f32_16x16x32_bf16 v[96:99], a[212:215], a[20:23], v[96:99]
    v_mfma_f32_16x16x32_bf16 v[100:103], a[212:215], a[44:47], 0
    buffer_load_dwordx4 a[144:147], v9, s[8:11], s28 offen offset:0 nt
    v_mfma_f32_16x16x32_bf16 v[100:103], a[208:211], a[40:43], v[100:103]
    buffer_load_dwordx4 a[148:151], v10, s[8:11], s28 offen offset:0 nt
    v_mfma_f32_16x16x32_bf16 v[100:103], a[204:207], a[36:39], v[100:103]
    ds_read_b128 a[232:235], v2 offset:6144
    v_cvt_pk_bf16_f32 v208, v96, v97
    v_mfma_f32_16x16x32_bf16 v[100:103], a[200:203], a[32:35], v[100:103]
    ds_read_b128 a[236:239], v2 offset:7168
    v_cvt_pk_bf16_f32 v209, v98, v99
    v_mfma_f32_16x16x32_bf16 v[100:103], a[196:199], a[28:31], v[100:103]
    s_waitcnt vmcnt(28)
    ds_write_b32 v4, a96 offset:0
    v_mfma_f32_16x16x32_bf16 v[100:103], a[192:195], a[24:27], v[100:103]
    ds_write_b32 v4, a97 offset:4
    v_mfma_f32_16x16x32_bf16 v[104:107], a[192:195], a[48:51], 0
    ds_write_b32 v4, a98 offset:1024
    v_mfma_f32_16x16x32_bf16 v[104:107], a[196:199], a[52:55], v[104:107]
    ds_write_b32 v4, a99 offset:1028
    v_mfma_f32_16x16x32_bf16 v[104:107], a[200:203], a[56:59], v[104:107]
    ds_write_b32 v4, a100 offset:512
    v_mfma_f32_16x16x32_bf16 v[104:107], a[204:207], a[60:63], v[104:107]
    ds_write_b32 v4, a101 offset:516
    v_mfma_f32_16x16x32_bf16 v[104:107], a[208:211], a[64:67], v[104:107]
    ds_write_b32 v4, a102 offset:1536
    v_mfma_f32_16x16x32_bf16 v[104:107], a[212:215], a[68:71], v[104:107]
    ds_write_b32 v4, a103 offset:1540
    v_mfma_f32_16x16x32_bf16 v[108:111], a[212:215], a[92:95], 0
    ds_read2_b64 a[96:99], v5 offset0:0 offset1:128
    v_cvt_pk_bf16_f32 v212, v100, v101
    v_mfma_f32_16x16x32_bf16 v[108:111], a[208:211], a[88:91], v[108:111]
    ds_read2_b64 a[100:103], v6 offset0:0 offset1:128
    v_cvt_pk_bf16_f32 v213, v102, v103
    v_mfma_f32_16x16x32_bf16 v[108:111], a[204:207], a[84:87], v[108:111]
    v_cvt_pk_bf16_f32 v216, v104, v105
    v_cvt_pk_bf16_f32 v217, v106, v107
    v_mfma_f32_16x16x32_bf16 v[108:111], a[200:203], a[80:83], v[108:111]
    v_mfma_f32_16x16x32_bf16 v[108:111], a[196:199], a[76:79], v[108:111]
    ds_read_b128 a[240:243], v2 offset:8192
    v_mfma_f32_16x16x32_bf16 v[108:111], a[192:195], a[72:75], v[108:111]
    s_waitcnt lgkmcnt(11)
    v_mfma_f32_16x16x32_bf16 v[124:127], a[216:219], a[72:75], 0
    ds_read_b128 a[244:247], v2 offset:9216
    v_mfma_f32_16x16x32_bf16 v[124:127], a[220:223], a[76:79], v[124:127]
    v_mfma_f32_16x16x32_bf16 v[124:127], a[224:227], a[80:83], v[124:127]
    ds_read_b128 a[248:251], v2 offset:10240
    v_cvt_pk_bf16_f32 v220, v108, v109
    v_mfma_f32_16x16x32_bf16 v[124:127], a[228:231], a[84:87], v[124:127]
    v_cvt_pk_bf16_f32 v221, v110, v111
    v_mfma_f32_16x16x32_bf16 v[124:127], a[232:235], a[88:91], v[124:127]
    ds_read_b128 a[192:195], v2 offset:11264
    v_mfma_f32_16x16x32_bf16 v[124:127], a[236:239], a[92:95], v[124:127]
    v_mfma_f32_16x16x32_bf16 v[120:123], a[236:239], a[68:71], 0
    ds_read_b128 a[196:199], v2 offset:12288
    v_mfma_f32_16x16x32_bf16 v[120:123], a[232:235], a[64:67], v[120:123]
    s_waitcnt vmcnt(22)
    ds_write_b32 v4, a104 offset:0
    v_mfma_f32_16x16x32_bf16 v[120:123], a[228:231], a[60:63], v[120:123]
    ds_read_b128 a[200:203], v2 offset:13312
    v_cvt_pk_bf16_f32 v222, v124, v125
    v_mfma_f32_16x16x32_bf16 v[120:123], a[224:227], a[56:59], v[120:123]
    ds_write_b32 v4, a105 offset:4
    v_mfma_f32_16x16x32_bf16 v[120:123], a[220:223], a[52:55], v[120:123]
    ds_write_b32 v4, a106 offset:1024
    v_mfma_f32_16x16x32_bf16 v[120:123], a[216:219], a[48:51], v[120:123]
    ds_write_b32 v4, a107 offset:1028
    v_mfma_f32_16x16x32_bf16 v[116:119], a[216:219], a[24:27], 0
    ds_write_b32 v4, a108 offset:512
    v_mfma_f32_16x16x32_bf16 v[116:119], a[220:223], a[28:31], v[116:119]
    ds_write_b32 v4, a109 offset:516
    v_mfma_f32_16x16x32_bf16 v[116:119], a[224:227], a[32:35], v[116:119]
    ds_write_b32 v4, a110 offset:1536
    v_mfma_f32_16x16x32_bf16 v[116:119], a[228:231], a[36:39], v[116:119]
    ds_write_b32 v4, a111 offset:1540
    v_mfma_f32_16x16x32_bf16 v[116:119], a[232:235], a[40:43], v[116:119]
    ds_read2_b64 a[104:107], v5 offset0:0 offset1:128
    v_cvt_pk_bf16_f32 v218, v120, v121
    v_mfma_f32_16x16x32_bf16 v[116:119], a[236:239], a[44:47], v[116:119]
    ds_read2_b64 a[108:111], v6 offset0:0 offset1:128
    v_cvt_pk_bf16_f32 v219, v122, v123
    v_mfma_f32_16x16x32_bf16 v[112:115], a[236:239], a[20:23], 0
    v_cvt_pk_bf16_f32 v223, v126, v127
    v_mfma_f32_16x16x32_bf16 v[112:115], a[232:235], a[16:19], v[112:115]
    v_mfma_f32_16x16x32_bf16 v[112:115], a[228:231], a[12:15], v[112:115]
    v_cvt_pk_bf16_f32 v214, v116, v117
    v_cvt_pk_bf16_f32 v215, v118, v119
    v_mfma_f32_16x16x32_bf16 v[112:115], a[224:227], a[8:11], v[112:115]
    v_mfma_f32_16x16x32_bf16 v[112:115], a[220:223], a[4:7], v[112:115]
    v_mfma_f32_16x16x32_bf16 v[112:115], a[216:219], a[0:3], v[112:115]
    s_waitcnt lgkmcnt(8)
    v_mfma_f32_16x16x32_bf16 v[96:99], a[0:3], a[240:243], 0
    v_mfma_f32_16x16x32_bf16 v[96:99], a[4:7], a[244:247], v[96:99]
    v_mfma_f32_16x16x32_bf16 v[96:99], a[8:11], a[248:251], v[96:99]
    v_cvt_pk_bf16_f32 v210, v112, v113
    v_cvt_pk_bf16_f32 v211, v114, v115
    v_mfma_f32_16x16x32_bf16 v[96:99], a[12:15], a[192:195], v[96:99]
    v_mfma_f32_16x16x32_bf16 v[96:99], a[16:19], a[196:199], v[96:99]
    v_mfma_f32_16x16x32_bf16 v[96:99], a[20:23], a[200:203], v[96:99]
    v_mfma_f32_16x16x32_bf16 v[100:103], a[44:47], a[200:203], 0
    v_mfma_f32_16x16x32_bf16 v[100:103], a[40:43], a[196:199], v[100:103]
    v_mfma_f32_16x16x32_bf16 v[100:103], a[36:39], a[192:195], v[100:103]
    s_waitcnt vmcnt(17)
    ds_write_b32 v4, a112 offset:0
    v_mfma_f32_16x16x32_bf16 v[100:103], a[32:35], a[248:251], v[100:103]
    ds_write_b32 v4, a113 offset:4
    v_mfma_f32_16x16x32_bf16 v[100:103], a[28:31], a[244:247], v[100:103]
    ds_write_b32 v4, a114 offset:1024
    v_mfma_f32_16x16x32_bf16 v[100:103], a[24:27], a[240:243], v[100:103]
    ds_write_b32 v4, a115 offset:1028
    v_mfma_f32_16x16x32_bf16 v[32:35], a[16:19], v[192:195], v[32:35]
    ds_write_b32 v4, a116 offset:512
    v_mfma_f32_16x16x32_bf16 v[32:35], a[20:23], v[208:211], v[32:35]
    ds_write_b32 v4, a117 offset:516
    v_mfma_f32_16x16x32_bf16 v[36:39], a[44:47], v[208:211], v[36:39]
    buffer_load_dwordx4 a[168:171], v9, s[8:11], s30 offen offset:0 nt
    v_cvt_pk_bf16_f32 v128, v96, v97
    v_mfma_f32_16x16x32_bf16 v[36:39], a[40:43], v[192:195], v[36:39]
    buffer_load_dwordx4 a[172:175], v10, s[8:11], s30 offen offset:0 nt
    v_cvt_pk_bf16_f32 v129, v98, v99
    s_mov_b32 s18, 1
    s_mov_b32 s19, 0
    s_branch L_loop
L_slow0:
    s_sub_u32 s43, s43, 1
    s_cbranch_scc1 L_end
    ds_read_b32 v30, v29
    s_waitcnt lgkmcnt(0)
    v_readfirstlane_b32 s41, v30
    s_nop 1
    s_andn2_b32 s41, 1, s41
    s_cbranch_scc1 L_slow0
    s_branch L_ok0
L_slow1:
    s_sub_u32 s43, s43, 1
    s_cbranch_scc1 L_end
    ds_read_b32 v30, v29
    s_waitcnt lgkmcnt(0)
    v_readfirstlane_b32 s41, v30
    s_nop 1
    s_andn2_b32 s41, 2, s41
    s_cbranch_scc1 L_slow1
    s_branch L_ok1
L_slow2:
    s_sub_u32 s43, s43, 1
    s_cbranch_scc1 L_end
    ds_read_b32 v30, v29
    s_waitcnt lgkmcnt(0)
    v_readfirstlane_b32 s41, v30
    s_nop 1
    s_andn2_b32 s41, 4, s41
    s_cbranch_scc1 L_slow2
    s_branch L_ok2
L_slow3:
    s_sub_u32 s43, s43, 1
    s_cbranch_scc1 L_end
    ds_read_b32 v30, v29
    s_waitcnt lgkmcnt(0)
    v_readfirstlane_b32 s41, v30
    s_nop 1
    s_andn2_b32 s41, 8, s41
    s_cbranch_scc1 L_slow3
    s_branch L_ok3
L_slow4:
    s_sub_u32 s43, s43, 1
    s_cbranch_scc1 L_end
    ds_read_b32 v30, v29
    s_waitcnt lgkmcnt(0)
    v_readfirstlane_b32 s41, v30
    s_nop 1
    s_andn2_b32 s41, 16, s41
    s_cbranch_scc1 L_slow4
    s_branch L_ok4
L_slow5:
    s_sub_u32 s43, s43, 1
    s_cbranch_scc1 L_end
    ds_read_b32 v30, v29
    s_waitcnt lgkmcnt(0)
    v_readfirstlane_b32 s41, v30
    s_nop 1
    s_andn2_b32 s41, 32, s41
    s_cbranch_scc1 L_slow5
    s_branch L_ok5
L_slow6:
    s_sub_u32 s43, s43, 1
    s_cbranch_scc1 L_end
    ds_read_b32 v30, v29
    s_waitcnt lgkmcnt(0)
    v_readfirstlane_b32 s41, v30
    s_nop 1
    s_andn2_b32 s41, 960, s41
    s_cbranch_scc1 L_slow6
    s_branch L_ok6
L_fb:
    s_mov_b32 s60, 0
    s_cmp_lt_u32 s2, 192
    s_cbranch_scc0 L_fb_task
L_fbw:
    s_sub_u32 s43, s43, 1
    s_cbranch_scc1 L_end
    ds_read_b32 v34, v29 offset:4
    s_waitcnt lgkmcnt(0)
    v_readfirstlane_b32 s61, v34
    s_nop 1
    s_cmp_eq_u32 s61, 3
    s_cbranch_scc0 L_fbw
L_fb_task:
    s_mov_b32 s63, 3
    s_branch L_raw
L_fb_raw:
    s_bitcmp1_b32 s63, 1
    s_mov_b32 s63, 1
    s_cbranch_scc1 L_raw
    s_branch L_prod
L_fb_next:
    s_waitcnt vmcnt(0)
    s_add_u32 s60, s60, 1
    s_cmp_lt_u32 s60, 72
    s_cbranch_scc1 L_fb_task
    s_branch L_go
L_code_end:
.section .rodata,"a"
.p2align 6
.amdhsa_kernel standalone__swin_window_attn__vision_kernel
  .amdhsa_next_free_vgpr 512
  .amdhsa_next_free_sgpr 102
  .amdhsa_accum_offset 256
  .amdhsa_group_segment_fixed_size 0
  .amdhsa_kernarg_size 48
  .amdhsa_user_sgpr_count 2
  .amdhsa_user_sgpr_kernarg_segment_ptr 1
  .amdhsa_system_sgpr_workgroup_id_x 1
.end_amdhsa_kernel
```
